```python
import torch

def _softmax(x, axis=-1):
    return torch.softmax(x, dim=axis)
def _gelu(x):
    return torch.nn.functional.gelu(x, approximate="tanh")
def _silu(x):
    return torch.nn.functional.silu(x)
def _sigmoid(x):
    return torch.sigmoid(x)
def _layernorm(x, axis=-1, eps=1e-5):
    m = x.mean(dim=axis, keepdim=True)
    v = x.var(dim=axis, keepdim=True, unbiased=False)
    return (x - m) / torch.sqrt(v + eps)
def _scatter_add(tgt, idx, src, axis=0):
    return tgt.clone().index_add_(axis, idx, src)
def _segment_sum(src, seg, n):
    out = torch.zeros((n,) + src.shape[1:], dtype=src.dtype)
    return out.index_add_(0, seg, src)
def _pad(x, pw):
    flat = tuple(v for pair in reversed(pw) for v in pair)
    return torch.nn.functional.pad(x, flat)

kernel_name = 'parallel_sum__sliding_local_dilated__glu_gated_glu__prompt'

def setup_inputs():

    _w = (lambda a: (lambda t: t.to(torch.bfloat16) if t.is_floating_point() else t)(torch.as_tensor(a)))
    def _A_setup():
        B, S, D = 1, 2048, 1024
        return {
            "x": _w((lambda *s: torch.randn(*s, dtype=torch.bfloat16) * 0.05)(B, S, D)),
            "wqkv": _w((lambda *s: torch.randn(*s, dtype=torch.bfloat16) * 0.05)(D, 3 * D)),
            "wo": _w((lambda *s: torch.randn(*s, dtype=torch.bfloat16) * 0.05)(D, D)),
        }
    _A_in = _A_setup()

    def _B_setup():
        B, S, D, F = 1, 2048, 1024, 3584
        return {
            "x": _w((lambda *s: torch.randn(*s, dtype=torch.bfloat16) * 0.05)(B, S, D)),
            "w_gate": _w((lambda *s: torch.randn(*s, dtype=torch.bfloat16) * 0.05)(D, F)),
            "w_up": _w((lambda *s: torch.randn(*s, dtype=torch.bfloat16) * 0.05)(D, F)),
            "w_down": _w((lambda *s: torch.randn(*s, dtype=torch.bfloat16) * 0.05)(F, D)),
        }
    _B_in = _B_setup()

    return {
        "A_x": _A_in["x"],
        "A_wqkv": _A_in["wqkv"],
        "A_wo": _A_in["wo"],
        "B_x": _B_in["x"],
        "B_w_gate": _B_in["w_gate"],
        "B_w_up": _B_in["w_up"],
        "B_w_down": _B_in["w_down"],
    }

def reference(A_x, A_wqkv, A_wo, B_x, B_w_gate, B_w_up, B_w_down):
    def _A_ref(x, wqkv, wo):
        B, S, D = x.shape
        H = 32; Dh = D // H
        W, dil = 8, 2
        qkv = (lambda x, *d: x.permute(*d))((x @ wqkv).reshape(B, S, 3, H, Dh), 2, 0, 3, 1, 4)
        q, k, v = qkv[0], qkv[1], qkv[2]
        scale = Dh ** -0.5
        pos = torch.arange(S)
        off = torch.arange(W) * dil
        idx = pos[:, None] - off[None, :]
        mask = idx >= 0
        idx_c = torch.where(mask, idx, 0).reshape(-1)
        kg = k[:, :, idx_c, :].reshape(B, H, S, W, Dh)
        vg = v[:, :, idx_c, :].reshape(B, H, S, W, Dh)
        logits = torch.einsum("bhsd,bhswd->bhsw", q, kg) * scale
        logits = torch.where(mask[None, None, :, :], logits, -1e9)
        attn = _softmax(logits, axis=-1)
        o = torch.einsum("bhsw,bhswd->bhsd", attn, vg)
        return (lambda x, *d: x.permute(*d))(o, 0, 2, 1, 3).reshape(B, S, D) @ wo

    def _B_ref(x, w_gate, w_up, w_down):
        g = torch.einsum("bsd,df->bsf", x, w_gate)
        u = torch.einsum("bsd,df->bsf", x, w_up)
        h = _sigmoid(g) * u
        return torch.einsum("bsf,fd->bsd", h, w_down)

    x = A_x
    xn = _layernorm(x, axis=-1)
    return x + _A_ref(xn, A_wqkv, A_wo) + _B_ref(xn, B_w_gate, B_w_up, B_w_down)
```

```asm
; @launch kernel=parallel_sum__sliding_local_dilated__glu_gated_glu__prompt_kernel grid=(256,1,1) block=(256,1,1) lds=162624
.amdgcn_target "amdgcn-amd-amdhsa--gfx950"
.text
.globl parallel_sum__sliding_local_dilated__glu_gated_glu__prompt_kernel
.p2align 8
.type parallel_sum__sliding_local_dilated__glu_gated_glu__prompt_kernel,@function
parallel_sum__sliding_local_dilated__glu_gated_glu__prompt_kernel:
    s_cmp_ge_u32 s2, 256
    s_cbranch_scc1 L_end
    s_load_dwordx16 s[4:19], s[0:1], 0
    s_load_dwordx4 s[20:23], s[0:1], 64
    s_memrealtime s[96:97]
    v_lshrrev_b32 v208, 6, v0
    v_and_b32 v214, 63, v0
    v_readfirstlane_b32 s64, v208
    s_getpc_b64 s[82:83]
L_pc:
    s_lshr_b32 s84, s2, 3
    s_lshl_b32 s84, s84, 2
    s_add_u32 s84, s84, s64
    s_lshl_b32 s84, s84, 10
    v_and_b32 v237, 7, v214
    v_lshlrev_b32 v237, 7, v237
    v_add_u32 v237, s84, v237
    v_min_u32 v237, L_codeend-L_pc, v237
    global_load_dword v236, v237, s[82:83]
    s_and_b32 s84, s2, 7
    s_lshr_b32 s66, s84, 1
    s_and_b32 s84, s84, 1
    s_lshl_b32 s84, s84, 2
    s_bfe_u32 s65, s2, 131075
    s_add_u32 s65, s65, s84
    s_lshr_b32 s67, s2, 5
    s_and_b32 s80, s65, 3
    s_lshl_b32 s84, s67, 2
    s_add_u32 s84, s84, s80
    s_movk_i32 s73, 5462
    s_cmp_lt_u32 s64, 2
    s_cselect_b32 s72, 14, 12
    s_cselect_b32 s73, 4682, s73
    s_cselect_b32 s85, 7, 6
    s_cselect_b32 s75, 9, 11
    s_cselect_b32 s86, 7, 2
    s_lshl_b32 s74, s85, 15
    s_lshl_b32 s54, s85, 20
    s_mul_i32 s90, s84, s85
    s_lshl_b32 s90, s90, 2
    s_mul_i32 s86, s86, s66
    s_add_u32 s90, s90, s86
    s_lshl_b32 s90, s90, 8
    s_lshr_b32 s85, s65, 2
    s_lshl_b32 s85, s85, 5
    s_add_u32 s84, s84, s85
    s_lshl_b32 s84, s84, 16
    s_cmp_eq_u32 s64, 3
    s_cselect_b32 s72, 2, s72
    s_cselect_b32 s73, 0x8000, s73
    s_cselect_b32 s74, 0x800, s74
    s_cselect_b32 s90, s84, s90
    s_cselect_b32 s54, 4194304, s54
    s_cselect_b32 s85, 16, s72
    s_lshl_b32 s85, s85, 2
    s_sub_u32 s85, s85, 1
    s_mul_i32 s86, s72, 2
    s_bfm_b64 s[88:89], s86, 0
    s_cmp_eq_u32 s64, 3
    s_cselect_b64 s[88:89], -1, s[88:89]
    s_mov_b32 s55, 0x20000
    v_min_u32 v208, s85, v214
    v_mul_u32_u24 v209, s73, v208
    v_lshrrev_b32 v209, 16, v209
    v_mul_u32_u24 v210, s72, v209
    v_sub_u32 v210, v208, v210
    v_mul_u32_u24 v213, s74, v209
    v_lshrrev_b32 v208, 2, v210
    v_lshl_add_u32 v213, v208, s75, v213
    v_and_b32 v210, 3, v210
    v_lshl_add_u32 v213, v210, 7, v213
    s_lshl_b32 s68, s66, 3
    s_add_u32 s68, s68, s67
    s_and_b32 s71, s67, 1
    s_and_b32 s69, s64, 1
    s_lshr_b32 s70, s64, 1
    v_lshlrev_b32 v254, 4, v214
    s_lshl_b32 s72, s65, 19
    s_sub_u32 s73, s72, 32768
    s_cmp_eq_u32 s65, 0
    s_cselect_b32 s73, 2.0, s73
    s_lshl_b32 s74, s68, 6
    s_mul_i32 s75, s68, 224
    v_lshrrev_b32 v208, 3, v214
    v_xor_b32 v209, v208, v214
    v_and_b32 v209, 7, v209
    v_lshlrev_b32 v209, 4, v209
    v_lshl_add_u32 v198, v208, 11, v209
    v_xor_b32 v199, 16400, v198
    s_mov_b32 s26, 4194304
    s_mov_b32 s27, 0x20000
    s_mov_b64 exec, s[88:89]
    s_cmp_eq_u32 s64, 0
    s_waitcnt lgkmcnt(0)
    s_cselect_b64 s[52:53], s[12:13], s[14:15]
    s_cmp_eq_u32 s64, 2
    s_cselect_b64 s[52:53], s[6:7], s[52:53]
    s_cmp_eq_u32 s64, 3
    s_cselect_b64 s[52:53], s[4:5], s[52:53]
    buffer_load_dword v236, v213, s[52:55], s90 offen
    s_mov_b64 exec, -1
    s_cbranch_scc1 L_w3
    s_cmp_eq_u32 s64, 1
    s_cbranch_scc1 L_w1
    s_cmp_eq_u32 s64, 2
    s_cbranch_scc1 L_w2
    s_mov_b64 s[24:25], s[4:5]
    s_mov_b32 s60, s20
    s_mov_b32 s61, s21
    s_mov_b32 s62, 256
    s_mov_b32 s63, 0x20000
    s_mov_b64 s[0:1], s[82:83]
    v_mov_b32 v197, v213
    s_add_u32 s73, s72, 0
    s_add_u32 s72, s72, 128
    v_add_u32 v208, 0, v214
    v_mul_u32_u24 v209, 4682, v208
    v_lshrrev_b32 v209, 16, v209
    v_mul_u32_u24 v210, 14, v209
    v_sub_u32 v210, v208, v210
    v_lshlrev_b32 v192, 4, v210
    v_bfe_u32 v210, v209, 2, 2
    v_lshlrev_b32 v210, 3, v210
    v_lshrrev_b32 v211, 4, v209
    v_lshl_add_u32 v210, v211, 2, v210
    v_and_b32 v211, 3, v209
    v_add_u32 v210, v210, v211
    v_mul_u32_u24 v210, 7168, v210
    v_add_u32 v192, v192, v210
    v_add_u32 v208, 64, v214
    v_mul_u32_u24 v209, 4682, v208
    v_lshrrev_b32 v209, 16, v209
    v_mul_u32_u24 v210, 14, v209
    v_sub_u32 v210, v208, v210
    v_lshlrev_b32 v193, 4, v210
    v_bfe_u32 v210, v209, 2, 2
    v_lshlrev_b32 v210, 3, v210
    v_lshrrev_b32 v211, 4, v209
    v_lshl_add_u32 v210, v211, 2, v210
    v_and_b32 v211, 3, v209
    v_add_u32 v210, v210, v211
    v_mul_u32_u24 v210, 7168, v210
    v_add_u32 v193, v193, v210
    v_add_u32 v208, 128, v214
    v_mul_u32_u24 v209, 4682, v208
    v_lshrrev_b32 v209, 16, v209
    v_mul_u32_u24 v210, 14, v209
    v_sub_u32 v210, v208, v210
    v_lshlrev_b32 v194, 4, v210
    v_bfe_u32 v210, v209, 2, 2
    v_lshlrev_b32 v210, 3, v210
    v_lshrrev_b32 v211, 4, v209
    v_lshl_add_u32 v210, v211, 2, v210
    v_and_b32 v211, 3, v209
    v_add_u32 v210, v210, v211
    v_mul_u32_u24 v210, 7168, v210
    v_add_u32 v194, v194, v210
    v_add_u32 v208, 192, v214
    v_mul_u32_u24 v209, 4682, v208
    v_lshrrev_b32 v209, 16, v209
    v_mul_u32_u24 v210, 14, v209
    v_sub_u32 v210, v208, v210
    v_lshlrev_b32 v195, 4, v210
    v_bfe_u32 v210, v209, 2, 2
    v_lshlrev_b32 v210, 3, v210
    v_lshrrev_b32 v211, 4, v209
    v_lshl_add_u32 v210, v211, 2, v210
    v_and_b32 v211, 3, v209
    v_add_u32 v210, v210, v211
    v_mul_u32_u24 v210, 7168, v210
    v_add_u32 v195, v195, v210
    s_mov_b32 s32, s12
    s_mov_b32 s33, s13
    s_mov_b32 s34, 7340032
    s_mov_b32 s35, 0x20000
    s_mov_b32 s36, s14
    s_mov_b32 s37, s15
    s_mov_b32 s38, 7340032
    s_mov_b32 s39, 0x20000
    s_mov_b32 m0, 118784
    s_nop 0
    buffer_load_dwordx4 v192, s[32:35], s75 offen lds
    s_mov_b32 m0, 119808
    s_nop 0
    buffer_load_dwordx4 v193, s[32:35], s75 offen lds
    s_mov_b32 m0, 120832
    s_nop 0
    buffer_load_dwordx4 v194, s[32:35], s75 offen lds
    s_mov_b32 m0, 121856
    s_nop 0
    buffer_load_dwordx4 v195, s[32:35], s75 offen lds
    s_add_u32 s75, s75, 229376
    s_mov_b32 m0, 125952
    s_nop 0
    buffer_load_dwordx4 v192, s[32:35], s75 offen lds
    s_mov_b32 m0, 126976
    s_nop 0
    buffer_load_dwordx4 v193, s[32:35], s75 offen lds
    s_mov_b32 m0, 128000
    s_nop 0
    buffer_load_dwordx4 v194, s[32:35], s75 offen lds
    s_mov_b32 m0, 129024
    s_nop 0
    buffer_load_dwordx4 v195, s[32:35], s75 offen lds
    s_sub_u32 s75, s75, 229376
    s_mov_b32 m0, 0
    s_nop 0
    buffer_load_dwordx4 v198, s[24:27], s73 offen lds
    s_mov_b32 m0, 1024
    s_nop 0
    buffer_load_dwordx4 v199, s[24:27], s73 offen lds
    s_add_u32 s73, s73, 32768
    s_mov_b32 m0, 2048
    s_nop 0
    buffer_load_dwordx4 v198, s[24:27], s73 offen lds
    s_mov_b32 m0, 3072
    s_nop 0
    buffer_load_dwordx4 v199, s[24:27], s73 offen lds
    s_add_u32 s73, s73, 4294934656
    s_add_u32 s44, s22, 100663296
    s_addc_u32 s45, s23, 0
    s_mov_b32 s46, 2822144
    s_mov_b32 s47, 0x20000
    s_add_u32 s40, s22, 4194304
    s_addc_u32 s41, s23, 0
    s_mov_b32 s42, 18874368
    s_mov_b32 s43, 0x20000
    s_lshl_b32 s79, s65, 3
    s_add_u32 s79, s79, s67
    s_lshl_b32 s77, s65, 2
    s_add_u32 s77, s77, s66
    s_lshl_b32 s77, s77, 10
    v_lshrrev_b32 v208, 4, v214
    v_bfe_u32 v209, v214, 3, 1
    v_xor_b32 v209, v209, v214
    v_xor_b32 v209, v209, v208
    v_and_b32 v209, 7, v209
    v_lshlrev_b32 v209, 4, v209
    v_and_b32 v210, 15, v214
    v_lshl_add_u32 v209, v210, 7, v209
    v_add_u32 v200, 0, v209
    v_xor_b32 v201, 64, v200
    v_bfe_u32 v209, v214, 2, 2
    v_lshl_add_u32 v209, v208, 2, v209
    v_and_b32 v210, 3, v214
    v_lshlrev_b32 v210, 3, v210
    v_mul_u32_u24 v211, 224, v209
    v_add_u32 v211, v211, v210
    v_lshlrev_b32 v204, 6, v209
    v_add_u32 v204, v204, v210
    v_add_u32 v204, 65536, v204
    v_and_b32 v208, 1, v208
    v_lshlrev_b32 v208, 5, v208
    v_sub_u32 v205, v204, v208
    v_add_u32 v204, v204, v208
    s_mul_i32 s84, s71, 160
    s_add_u32 s84, s84, 83968
    v_add_u32 v206, s84, v211
    v_mov_b32 v228, 0x3f803f80
    v_accvgpr_write_b32 a128, -1
    v_mov_b32 v229, 0x3f803f80
    v_accvgpr_write_b32 a129, -1
    v_mov_b32 v230, 0x3f803f80
    v_accvgpr_write_b32 a130, -1
    v_mov_b32 v231, 0x3f803f80
    v_accvgpr_write_b32 a131, -1
    s_lshl_b32 s88, s65, 5
    s_add_u32 s88, s88, s68
    s_lshl_b32 s88, s88, 2
    s_add_u32 s88, s88, 0
    s_lshl_b32 s92, s88, 12
    v_lshrrev_b32 v252, 5, v214
    v_and_b32 v238, 0x1f0, v254
    v_lshl_add_u32 v238, v252, 11, v238
    v_lshlrev_b32 v207, 3, v252
    v_and_b32 v252, 31, v214
    v_cmp_eq_u32 vcc, 0, v252
    s_nop 1
    v_cndmask_b32 v207, 2.0, v207, vcc
    s_lshl_b32 s88, s88, 4
    s_add_u32 s88, s88, 32768
    s_add_u32 s80, s80, 1
    s_cmp_eq_u32 s65, 0
    s_cselect_b32 s80, 0, s80
    s_sub_u32 s82, s80, 1
    s_cmp_lt_u32 s65, 4
    s_cselect_b32 s81, 63, 1
    s_mov_b32 s83, 3
    s_mov_b32 s76, 0
    s_mov_b32 m0, 104448
    s_nop 0
    buffer_load_dwordx4 v192, s[36:39], s75 offen lds
    s_mov_b32 m0, 105472
    s_nop 0
    buffer_load_dwordx4 v193, s[36:39], s75 offen lds
    s_mov_b32 m0, 106496
    s_nop 0
    buffer_load_dwordx4 v194, s[36:39], s75 offen lds
    s_mov_b32 m0, 107520
    s_nop 0
    buffer_load_dwordx4 v195, s[36:39], s75 offen lds
    s_add_u32 s75, s75, 229376
    s_mov_b32 m0, 111616
    s_nop 0
    buffer_load_dwordx4 v192, s[36:39], s75 offen lds
    s_mov_b32 m0, 112640
    s_nop 0
    buffer_load_dwordx4 v193, s[36:39], s75 offen lds
    s_mov_b32 m0, 113664
    s_nop 0
    buffer_load_dwordx4 v194, s[36:39], s75 offen lds
    s_mov_b32 m0, 114688
    s_nop 0
    buffer_load_dwordx4 v195, s[36:39], s75 offen lds
    s_add_u32 s75, s75, 229376
    s_bfm_b64 exec, 28, 28
    buffer_load_dword v236, v197, s[52:55], s90 offen
    s_mov_b64 exec, -1
    s_mov_b32 s56, s18
    s_mov_b32 s57, s19
    s_mov_b32 s58, 4194304
    s_mov_b32 s59, 0x20000
    s_mov_b32 s48, s16
    s_mov_b32 s49, s17
    s_mov_b32 s50, 7340032
    s_mov_b32 s51, 0x20000
    v_lshrrev_b32 v213, 4, v254
    v_and_b32 v211, 15, v213
    v_lshrrev_b32 v212, 4, v213
    v_subrev_u32 v208, 2, v213
    v_subrev_u32 v209, 16, v213
    v_cmp_le_u32 vcc, 18, v213
    s_nop 1
    v_cndmask_b32 v208, v208, v209, vcc
    v_cndmask_b32 v209, 0, 2, vcc
    v_lshrrev_b32 v208, 1, v208
    v_and_b32 v210, 1, v213
    v_add_u32 v209, v209, v210
    v_subrev_u32 v210, 17, v213
    v_cmp_le_u32 vcc, 18, v213
    s_nop 1
    v_cndmask_b32 v208, v208, v210, vcc
    v_cndmask_b32 v209, v209, 2, vcc
    v_cmp_le_u32 vcc, 25, v213
    s_nop 1
    v_cndmask_b32 v208, v208, v213, vcc
    v_cndmask_b32 v209, v209, 3, vcc
    v_cmp_gt_u32 vcc, 4, v213
    s_nop 1
    v_cndmask_b32 v208, v208, 0, vcc
    v_cndmask_b32 v209, v209, v213, vcc
    v_add_u32 v208, s67, v208
    v_and_b32 v208, 7, v208
    v_and_b32 v210, 1, v208
    v_lshl_add_u32 v209, v210, 2, v209
    v_lshlrev_b32 v209, 2, v209
    s_mov_b32 s84, 0x86750312
    v_lshrrev_b32 v209, v209, s84
    v_and_b32 v209, 15, v209
    v_lshrrev_b32 v208, 1, v208
    v_and_b32 v210, 3, v213
    v_cmp_le_u32 vcc, 32, v213
    s_nop 1
    v_cndmask_b32 v208, v208, v210, vcc
    v_cndmask_b32 v209, v209, 4, vcc
    s_lshl_b32 s84, s66, 2
    v_add_u32 v208, s84, v208
    v_mad_u32_u24 v246, v208, 9, v209
    v_lshlrev_b32 v246, 10, v246
    v_mul_u32_u24 v247, 224, v208
    v_lshl_add_u32 v247, v209, 5, v247
    v_subrev_u32 v247, 32, v247
    v_lshlrev_b32 v247, 11, v247
    v_lshrrev_b32 v210, 3, v209
    v_lshl_add_u32 v210, v208, 1, v210
    v_lshlrev_b32 v210, 16, v210
    v_and_b32 v209, 7, v209
    v_cmp_eq_u32 vcc, 0, v209
    s_nop 1
    v_cndmask_b32 v247, v247, v210, vcc
    s_sub_u32 s84, s69, s70
    s_mul_i32 s84, s84, 24576
    v_add_u32 v210, s84, v247
    v_cmp_le_u32 vcc, 32, v213
    s_nop 1
    v_cndmask_b32 v247, v247, v210, vcc
    v_accvgpr_write_b32 a240, v246
    v_accvgpr_write_b32 a237, v247
    s_lshl_b32 s85, s70, 2
    s_add_u32 s85, s85, s69
    s_lshl_b32 s84, s85, 2
    v_add_u32 v208, s84, v212
    v_lshrrev_b32 v209, 1, v213
    v_xor_b32 v209, v209, v208
    v_and_b32 v209, 7, v209
    v_and_b32 v210, 1, v213
    v_lshlrev_b32 v210, 4, v210
    v_lshl_add_u32 v244, v209, 5, v210
    v_lshl_add_u32 v244, v208, 11, v244
    s_lshl_b32 s84, s67, 8
    v_add_u32 v244, s84, v244
    v_add_u32 v245, 16384, v244
    v_accvgpr_write_b32 a238, v244
    v_accvgpr_write_b32 a239, v245
    s_lshl_b32 s3, s85, 10
    s_lshl_b32 s84, s69, 13
    v_add_u32 v208, s84, v254
    v_accvgpr_write_b32 a251, v208
    s_lshl_b32 s84, s65, 1
    s_add_u32 s84, s84, s69
    s_mul_i32 s84, s84, 1179648
    s_lshr_b32 s85, s67, 1
    s_mul_i32 s85, s85, 9
    s_mul_i32 s86, s66, 36
    s_add_u32 s85, s85, s86
    s_lshl_b32 s85, s85, 10
    s_add_u32 s84, s84, s85
    s_mul_i32 s86, s71, 6144
    s_add_u32 s7, s86, s84
    s_lshl_b32 s86, s71, 11
    v_add_u32 v208, s86, v254
    v_accvgpr_write_b32 a250, v208
    s_lshl_b32 s84, s65, 2
    s_add_u32 s84, s84, s64
    s_mul_i32 s84, s84, 589824
    v_add_u32 v208, s84, v254
    v_accvgpr_write_b32 a244, v208
    v_add_u32 v209, 147456, v208
    v_accvgpr_write_b32 a245, v209
    v_add_u32 v209, 294912, v208
    v_accvgpr_write_b32 a246, v209
    v_add_u32 v209, 442368, v208
    v_accvgpr_write_b32 a247, v209
    s_lshl_b32 s84, s64, 12
    v_add_u32 v208, s84, v254
    v_accvgpr_write_b32 a241, v208
    v_bfe_u32 v209, v213, 2, 2
    v_lshl_add_u32 v209, v212, 2, v209
    v_and_b32 v210, 3, v213
    v_lshlrev_b32 v210, 3, v210
    v_lshl_add_u32 v210, v209, 8, v210
    v_add_u32 v210, 81920, v210
    v_and_b32 v209, 7, v209
    v_lshl_add_u32 v210, v209, 5, v210
    s_lshl_b32 s84, s66, 6
    s_add_u32 s85, s84, 64
    s_and_b32 s85, s85, 0xc0
    v_xor_b32 v208, s84, v210
    v_accvgpr_write_b32 a242, v208
    v_xor_b32 v208, 32, v208
    v_accvgpr_write_b32 a243, v208
    v_xor_b32 v208, s85, v210
    v_accvgpr_write_b32 a248, v208
    v_xor_b32 v208, 32, v208
    v_accvgpr_write_b32 a249, v208
    s_lshl_b32 s10, s67, 2
    s_lshl_b32 s11, 15, s10
    s_add_u32 s10, s10, s64
    s_lshl_b32 s10, s10, 2
    s_add_u32 s10, s10, s77
    v_lshrrev_b32 v208, 1, v213
    v_lshlrev_b32 v208, 11, v208
    v_and_b32 v209, 1, v213
    v_lshl_add_u32 v208, v209, 7, v208
    s_lshl_b32 s84, s67, 8
    v_add_u32 v208, s84, v208
    v_accvgpr_write_b32 a252, v208
    s_and_b32 s13, s65, 3
    s_lshl_b32 s84, s64, 2
    s_add_u32 s13, s13, s84
    s_add_u32 s13, s13, 6
    v_lshrrev_b32 v208, 3, v213
    v_mul_u32_u24 v208, 147456, v208
    v_and_b32 v209, 7, v213
    v_lshl_add_u32 v208, v209, 7, v208
    v_accvgpr_write_b32 a253, v208
    s_lshl_b32 s4, s65, 2
    s_add_u32 s4, s4, s64
    s_lshl_b32 s4, s4, 9
    s_add_u32 s4, s4, 32768
    s_lshl_b32 s5, s65, 11
    s_sub_u32 s5, s5, 128
    s_max_i32 s5, s5, 0
    s_add_u32 s5, s5, 32768
    s_mul_i32 s6, s68, 20480
    s_mul_i32 s84, s64, 640
    s_add_u32 s6, s6, s84
    s_add_u32 s6, s6, 65536
    s_lshl_b32 s12, s68, 4
    s_add_u32 s12, s12, s65
    s_lshl_b32 s12, s12, 12
    s_add_u32 s12, s12, 729088
    s_lshl_b32 s84, s64, 10
    s_add_u32 s84, s84, 154880
    v_add_u32 v208, s84, v254
    v_accvgpr_write_b32 a232, v208
    s_lshl_b32 s84, s64, 8
    s_add_u32 s84, s84, 159040
    v_lshl_add_u32 v208, v213, 2, s84
    v_accvgpr_write_b32 a233, v208
    s_mov_b32 s84, 154624
    v_lshl_add_u32 v208, v211, 4, s84
    v_accvgpr_write_b32 a234, v208
    s_mov_b32 s84, 158976
    v_lshl_add_u32 v208, v211, 2, s84
    v_accvgpr_write_b32 a235, v208
    s_mul_i32 s84, s64, 320
    s_add_u32 s84, s84, 161344
    v_min_u32 v208, 39, v213
    v_lshl_add_u32 v208, v208, 3, s84
    v_accvgpr_write_b32 a236, v208
    s_cmp_eq_u32 s80, 0
    s_cselect_b64 vcc, -1, 0
    s_waitcnt vmcnt(9)
    s_barrier
    ds_read_b64_tr_b16 a[200:201], v206 offset:34816
    ds_read_b64_tr_b16 a[202:203], v206 offset:38400
    ds_read_b128 a[136:139], v200 offset:0
    ds_read_b64_tr_b16 a[204:205], v206 offset:41984
    ds_read_b64_tr_b16 a[206:207], v206 offset:45568
    ds_read_b128 a[168:171], v201 offset:0
    ds_read_b64_tr_b16 a[212:213], v206 offset:42016
    ds_read_b64_tr_b16 a[214:215], v206 offset:45600
    ds_read_b64_tr_b16 a[208:209], v206 offset:34848
    ds_read_b64_tr_b16 a[210:211], v206 offset:38432
    ds_read_b128 a[140:143], v200 offset:2048
    ds_read_b128 a[172:175], v201 offset:2048
    ds_read_b128 a[144:147], v200 offset:4096
    ds_read_b128 a[176:179], v201 offset:4096
    ds_read_b128 a[148:151], v200 offset:6144
    ds_read_b128 a[180:183], v201 offset:6144
    ds_read_b128 a[152:155], v200 offset:8192
    ds_read_b128 a[184:187], v201 offset:8192
    ds_read_b128 a[156:159], v200 offset:10240
    ds_read_b128 a[188:191], v201 offset:10240
    ds_read_b128 a[160:163], v200 offset:12288
    ds_read_b128 a[192:195], v201 offset:12288
    ds_read_b128 a[164:167], v200 offset:14336
    ds_read_b128 a[196:199], v201 offset:14336
    s_add_u32 s84, s90, 917504
    s_bfm_b64 exec, 28, 0
    buffer_load_dword v236, v197, s[52:55], s84 offen
    s_mov_b64 exec, -1
    s_waitcnt lgkmcnt(15)
    v_mfma_f32_16x16x32_bf16 a[0:3], a[200:203], a[136:139], 0
    s_mov_b32 m0, 32768
    v_mfma_f32_16x16x32_bf16 a[0:3], a[204:207], a[168:171], a[0:3]
    v_mfma_f32_16x16x32_bf16 a[32:35], a[212:215], a[168:171], 0
    buffer_load_dwordx4 v198, s[24:27], s72 offen lds
    s_waitcnt lgkmcnt(14)
    v_mfma_f32_16x16x32_bf16 a[32:35], a[208:211], a[136:139], a[32:35]
    s_waitcnt lgkmcnt(13)
    v_mfma_f32_16x16x32_bf16 a[36:39], a[208:211], a[140:143], 0
    s_mov_b32 m0, 33792
    s_waitcnt lgkmcnt(12)
    v_mfma_f32_16x16x32_bf16 a[36:39], a[212:215], a[172:175], a[36:39]
    ds_read_b64_tr_b16 a[216:217], v204 offset:14336
    v_mfma_f32_16x16x32_bf16 a[4:7], a[204:207], a[172:175], 0
    buffer_load_dwordx4 v199, s[24:27], s72 offen lds
    v_mfma_f32_16x16x32_bf16 a[4:7], a[200:203], a[140:143], a[4:7]
    s_waitcnt lgkmcnt(9)
    v_mfma_f32_16x16x32_bf16 a[8:11], a[200:203], a[144:147], 0
    ds_read_b64_tr_b16 a[218:219], v204 offset:15360
    v_mfma_f32_16x16x32_bf16 a[8:11], a[204:207], a[176:179], a[8:11]
    s_add_u32 s72, s72, 128
    v_mfma_f32_16x16x32_bf16 a[40:43], a[212:215], a[176:179], 0
    s_mov_b32 m0, 133120
    v_mfma_f32_16x16x32_bf16 a[40:43], a[208:211], a[144:147], a[40:43]
    ds_read_b64_tr_b16 a[220:221], v204 offset:34816
    v_mfma_f32_16x16x32_bf16 a[44:47], a[208:211], a[148:151], 0
    buffer_load_dwordx4 v192, s[32:35], s75 offen lds
    v_mfma_f32_16x16x32_bf16 a[44:47], a[212:215], a[180:183], a[44:47]
    ds_read_b64_tr_b16 a[222:223], v204 offset:35840
    v_mfma_f32_16x16x32_bf16 a[12:15], a[204:207], a[180:183], 0
    s_mov_b32 m0, 134144
    v_mfma_f32_16x16x32_bf16 a[12:15], a[200:203], a[148:151], a[12:15]
    s_waitcnt lgkmcnt(8)
    v_mfma_f32_16x16x32_bf16 a[16:19], a[200:203], a[152:155], 0
    ds_read_b64_tr_b16 a[228:229], v205 offset:34848
    v_mfma_f32_16x16x32_bf16 a[16:19], a[204:207], a[184:187], a[16:19]
    buffer_load_dwordx4 v193, s[32:35], s75 offen lds
    v_mfma_f32_16x16x32_bf16 a[48:51], a[212:215], a[184:187], 0
    ds_read_b64_tr_b16 a[230:231], v205 offset:35872
    v_mfma_f32_16x16x32_bf16 a[48:51], a[208:211], a[152:155], a[48:51]
    s_mov_b32 m0, 135168
    v_mfma_f32_16x16x32_bf16 a[52:55], a[208:211], a[156:159], 0
    ds_read_b64_tr_b16 a[224:225], v205 offset:14368
    v_mfma_f32_16x16x32_bf16 a[52:55], a[212:215], a[188:191], a[52:55]
    buffer_load_dwordx4 v194, s[32:35], s75 offen lds
    v_mfma_f32_16x16x32_bf16 a[20:23], a[204:207], a[188:191], 0
    ds_read_b64_tr_b16 a[226:227], v205 offset:15392
    v_mfma_f32_16x16x32_bf16 a[20:23], a[200:203], a[156:159], a[20:23]
    s_waitcnt lgkmcnt(8)
    v_mfma_f32_16x16x32_bf16 a[24:27], a[200:203], a[160:163], 0
    s_mov_b32 m0, 136192
    v_mfma_f32_16x16x32_bf16 a[24:27], a[204:207], a[192:195], a[24:27]
    buffer_load_dwordx4 v195, s[32:35], s75 offen lds
    v_mfma_f32_16x16x32_bf16 a[56:59], a[212:215], a[192:195], 0
    s_add_u32 s75, s75, 229376
    v_mfma_f32_16x16x32_bf16 a[56:59], a[208:211], a[160:163], a[56:59]
    s_mov_b32 m0, 140288
    v_mfma_f32_16x16x32_bf16 a[60:63], a[208:211], a[164:167], 0
    buffer_load_dwordx4 v192, s[32:35], s75 offen lds
    v_mfma_f32_16x16x32_bf16 a[60:63], a[212:215], a[196:199], a[60:63]
    s_mov_b32 m0, 141312
    v_mfma_f32_16x16x32_bf16 a[28:31], a[204:207], a[196:199], 0
    s_cbranch_vccnz L_skp0_00
L_sbp0_00:
    v_mfma_f32_16x16x32_bf16 a[28:31], a[200:203], a[164:167], a[28:31]
    s_waitcnt lgkmcnt(0)
    v_mfma_f32_16x16x32_bf16 v[92:95], a[216:219], a[164:167], 0
    buffer_load_dwordx4 v193, s[32:35], s75 offen lds
    v_mfma_f32_16x16x32_bf16 v[92:95], a[220:223], a[196:199], v[92:95]
    s_mov_b32 m0, 142336
    v_mfma_f32_16x16x32_bf16 v[124:127], a[228:231], a[196:199], 0
    buffer_load_dwordx4 v194, s[32:35], s75 offen lds
    v_mfma_f32_16x16x32_bf16 v[124:127], a[224:227], a[164:167], v[124:127]
    s_mov_b32 m0, 143360
    v_mfma_f32_16x16x32_bf16 v[120:123], a[224:227], a[160:163], 0
    v_mfma_f32_16x16x32_bf16 v[120:123], a[228:231], a[192:195], v[120:123]
    buffer_load_dwordx4 v195, s[32:35], s75 offen lds
    v_mfma_f32_16x16x32_bf16 v[88:91], a[220:223], a[192:195], 0
    v_mfma_f32_16x16x32_bf16 v[88:91], a[216:219], a[160:163], v[88:91]
    s_sub_u32 s75, s75, 229376
    v_mfma_f32_16x16x32_bf16 v[84:87], a[216:219], a[156:159], 0
    v_mfma_f32_16x16x32_bf16 v[84:87], a[220:223], a[188:191], v[84:87]
    s_add_u32 s84, s90, 917504
    s_bfm_b64 exec, 28, 28
    buffer_load_dword v236, v197, s[52:55], s84 offen
    s_mov_b64 exec, -1
    v_mfma_f32_16x16x32_bf16 v[116:119], a[228:231], a[188:191], 0
    buffer_load_dword v239, off, s[60:63], 0 sc1
    v_mfma_f32_16x16x32_bf16 v[116:119], a[224:227], a[156:159], v[116:119]
    v_mfma_f32_16x16x32_bf16 v[112:115], a[224:227], a[152:155], 0
    v_mfma_f32_16x16x32_bf16 v[112:115], a[228:231], a[184:187], v[112:115]
    v_mfma_f32_16x16x32_bf16 v[80:83], a[220:223], a[184:187], 0
    v_mfma_f32_16x16x32_bf16 v[80:83], a[216:219], a[152:155], v[80:83]
    s_waitcnt vmcnt(14)
    s_barrier
    v_mfma_f32_16x16x32_bf16 v[76:79], a[216:219], a[148:151], 0
    ds_read_b64_tr_b16 a[200:201], v204 offset:16384
    v_mfma_f32_16x16x32_bf16 v[76:79], a[220:223], a[180:183], v[76:79]
    ds_read_b64_tr_b16 a[202:203], v204 offset:17408
    v_mfma_f32_16x16x32_bf16 v[108:111], a[228:231], a[180:183], 0
    ds_read_b64_tr_b16 a[204:205], v204 offset:36864
    v_mfma_f32_16x16x32_bf16 v[108:111], a[224:227], a[148:151], v[108:111]
    ds_read_b64_tr_b16 a[206:207], v204 offset:37888
    v_mfma_f32_16x16x32_bf16 v[104:107], a[224:227], a[144:147], 0
    ds_read_b64_tr_b16 a[212:213], v205 offset:36896
    v_mfma_f32_16x16x32_bf16 v[104:107], a[228:231], a[176:179], v[104:107]
    ds_read_b64_tr_b16 a[214:215], v205 offset:37920
    v_mfma_f32_16x16x32_bf16 v[72:75], a[220:223], a[176:179], 0
    ds_read_b64_tr_b16 a[208:209], v205 offset:16416
    v_mfma_f32_16x16x32_bf16 v[72:75], a[216:219], a[144:147], v[72:75]
    ds_read_b64_tr_b16 a[210:211], v205 offset:17440
    v_mfma_f32_16x16x32_bf16 v[68:71], a[216:219], a[140:143], 0
    s_mov_b32 m0, 83968
    v_mfma_f32_16x16x32_bf16 v[68:71], a[220:223], a[172:175], v[68:71]
    v_mfma_f32_16x16x32_bf16 v[100:103], a[228:231], a[172:175], 0
    buffer_load_dwordx4 v192, s[36:39], s75 offen lds
    v_mfma_f32_16x16x32_bf16 v[100:103], a[224:227], a[140:143], v[100:103]
    v_mfma_f32_16x16x32_bf16 v[96:99], a[224:227], a[136:139], 0
    s_mov_b32 m0, 84992
    v_mfma_f32_16x16x32_bf16 v[96:99], a[228:231], a[168:171], v[96:99]
    buffer_load_dwordx4 v193, s[36:39], s75 offen lds
    v_mfma_f32_16x16x32_bf16 v[64:67], a[220:223], a[168:171], 0
    v_mfma_f32_16x16x32_bf16 v[64:67], a[216:219], a[136:139], v[64:67]
    s_waitcnt lgkmcnt(4)
    v_mfma_f32_16x16x32_bf16 v[128:131], a[136:139], a[200:203], 0
    s_mov_b32 m0, 86016
    v_mfma_f32_16x16x32_bf16 v[128:131], a[168:171], a[204:207], v[128:131]
    s_waitcnt lgkmcnt(0)
    v_mfma_f32_16x16x32_bf16 v[160:163], a[168:171], a[212:215], 0
    ds_read_b64_tr_b16 a[216:217], v204 offset:12288
    v_mfma_f32_16x16x32_bf16 v[160:163], a[136:139], a[208:211], v[160:163]
    buffer_load_dwordx4 v194, s[36:39], s75 offen lds
    v_mfma_f32_16x16x32_bf16 v[164:167], a[140:143], a[208:211], 0
    s_mov_b32 m0, 87040
    v_mfma_f32_16x16x32_bf16 v[164:167], a[172:175], a[212:215], v[164:167]
    ds_read_b64_tr_b16 a[218:219], v204 offset:13312
    v_mfma_f32_16x16x32_bf16 v[132:135], a[172:175], a[204:207], 0
    buffer_load_dwordx4 v195, s[36:39], s75 offen lds
    v_mfma_f32_16x16x32_bf16 v[132:135], a[140:143], a[200:203], v[132:135]
    ds_read_b64_tr_b16 a[220:221], v204 offset:32768
    v_mfma_f32_16x16x32_bf16 v[136:139], a[144:147], a[200:203], 0
    s_add_u32 s75, s75, 229376
    v_mfma_f32_16x16x32_bf16 v[136:139], a[176:179], a[204:207], v[136:139]
    s_mov_b32 m0, 91136
    v_mfma_f32_16x16x32_bf16 v[168:171], a[176:179], a[212:215], 0
    ds_read_b64_tr_b16 a[222:223], v204 offset:33792
    v_mfma_f32_16x16x32_bf16 v[168:171], a[144:147], a[208:211], v[168:171]
    buffer_load_dwordx4 v192, s[36:39], s75 offen lds
    v_mfma_f32_16x16x32_bf16 v[172:175], a[148:151], a[208:211], 0
    ds_read_b64_tr_b16 a[228:229], v205 offset:32800
    v_mfma_f32_16x16x32_bf16 v[172:175], a[180:183], a[212:215], v[172:175]
    s_mov_b32 m0, 92160
    v_mfma_f32_16x16x32_bf16 v[140:143], a[180:183], a[204:207], 0
    ds_read_b64_tr_b16 a[230:231], v205 offset:33824
    v_mfma_f32_16x16x32_bf16 v[140:143], a[148:151], a[200:203], v[140:143]
    buffer_load_dwordx4 v193, s[36:39], s75 offen lds
    v_mfma_f32_16x16x32_bf16 v[144:147], a[152:155], a[200:203], 0
    s_mov_b32 m0, 93184
    v_mfma_f32_16x16x32_bf16 v[144:147], a[184:187], a[204:207], v[144:147]
    ds_read_b64_tr_b16 a[224:225], v205 offset:12320
    v_mfma_f32_16x16x32_bf16 v[176:179], a[184:187], a[212:215], 0
    buffer_load_dwordx4 v194, s[36:39], s75 offen lds
    v_mfma_f32_16x16x32_bf16 v[176:179], a[152:155], a[208:211], v[176:179]
    ds_read_b64_tr_b16 a[226:227], v205 offset:13344
    v_mfma_f32_16x16x32_bf16 v[180:183], a[156:159], a[208:211], 0
    s_mov_b32 m0, 94208
    v_mfma_f32_16x16x32_bf16 v[180:183], a[188:191], a[212:215], v[180:183]
    buffer_load_dwordx4 v195, s[36:39], s75 offen lds
    v_mfma_f32_16x16x32_bf16 v[148:151], a[188:191], a[204:207], 0
    s_add_u32 s75, s75, 229376
    v_mfma_f32_16x16x32_bf16 v[148:151], a[156:159], a[200:203], v[148:151]
    s_mov_b32 m0, 0
    v_mfma_f32_16x16x32_bf16 v[152:155], a[160:163], a[200:203], 0
    buffer_load_dwordx4 v198, s[24:27], s72 offen lds
    v_mfma_f32_16x16x32_bf16 v[152:155], a[192:195], a[204:207], v[152:155]
    s_mov_b32 m0, 1024
    v_mfma_f32_16x16x32_bf16 v[184:187], a[192:195], a[212:215], 0
    buffer_load_dwordx4 v199, s[24:27], s72 offen lds
    v_mfma_f32_16x16x32_bf16 v[184:187], a[160:163], a[208:211], v[184:187]
    v_mfma_f32_16x16x32_bf16 v[188:191], a[164:167], a[208:211], 0
    s_add_u32 s72, s72, 128
    v_mfma_f32_16x16x32_bf16 v[188:191], a[196:199], a[212:215], v[188:191]
    v_mfma_f32_16x16x32_bf16 v[156:159], a[196:199], a[204:207], 0
    s_cbranch_vccnz L_skp0_02
L_sbp0_02:
    v_mfma_f32_16x16x32_bf16 v[156:159], a[164:167], a[200:203], v[156:159]
    s_waitcnt lgkmcnt(0)
    v_mfma_f32_16x16x32_bf16 v[28:31], a[216:219], a[164:167], 0
    s_mov_b32 m0, 118784
    v_mfma_f32_16x16x32_bf16 v[28:31], a[220:223], a[196:199], v[28:31]
    buffer_load_dwordx4 v192, s[32:35], s75 offen lds
    v_mfma_f32_16x16x32_bf16 v[60:63], a[228:231], a[196:199], 0
    ds_read_b64_tr_b16 a[200:201], v206 offset:20480
    v_mfma_f32_16x16x32_bf16 v[60:63], a[224:227], a[164:167], v[60:63]
    s_mov_b32 m0, 119808
    v_mfma_f32_16x16x32_bf16 v[56:59], a[224:227], a[160:163], 0
    buffer_load_dwordx4 v193, s[32:35], s75 offen lds
    v_mfma_f32_16x16x32_bf16 v[56:59], a[228:231], a[192:195], v[56:59]
    ds_read_b64_tr_b16 a[202:203], v206 offset:24064
    v_mfma_f32_16x16x32_bf16 v[24:27], a[220:223], a[192:195], 0
    s_mov_b32 m0, 120832
    v_mfma_f32_16x16x32_bf16 v[24:27], a[216:219], a[160:163], v[24:27]
    ds_read_b64_tr_b16 a[204:205], v206 offset:27648
    v_mfma_f32_16x16x32_bf16 v[20:23], a[216:219], a[156:159], 0
    buffer_load_dwordx4 v194, s[32:35], s75 offen lds
    v_mfma_f32_16x16x32_bf16 v[20:23], a[220:223], a[188:191], v[20:23]
    s_mov_b32 m0, 121856
    v_mfma_f32_16x16x32_bf16 v[52:55], a[228:231], a[188:191], 0
    ds_read_b64_tr_b16 a[206:207], v206 offset:31232
    v_mfma_f32_16x16x32_bf16 v[52:55], a[224:227], a[156:159], v[52:55]
    buffer_load_dwordx4 v195, s[32:35], s75 offen lds
    v_mfma_f32_16x16x32_bf16 v[48:51], a[224:227], a[152:155], 0
    ds_read_b64_tr_b16 a[212:213], v206 offset:27680
    v_mfma_f32_16x16x32_bf16 v[48:51], a[228:231], a[184:187], v[48:51]
    s_add_u32 s75, s75, 229376
    v_mfma_f32_16x16x32_bf16 v[16:19], a[220:223], a[184:187], 0
    ds_read_b64_tr_b16 a[214:215], v206 offset:31264
    v_mfma_f32_16x16x32_bf16 v[16:19], a[216:219], a[152:155], v[16:19]
    s_mov_b32 m0, 125952
    v_mfma_f32_16x16x32_bf16 v[12:15], a[216:219], a[148:151], 0
    buffer_load_dwordx4 v192, s[32:35], s75 offen lds
    v_mfma_f32_16x16x32_bf16 v[12:15], a[220:223], a[180:183], v[12:15]
    ds_read_b64_tr_b16 a[208:209], v206 offset:20512
    v_mfma_f32_16x16x32_bf16 v[44:47], a[228:231], a[180:183], 0
    s_mov_b32 m0, 126976
    v_mfma_f32_16x16x32_bf16 v[44:47], a[224:227], a[148:151], v[44:47]
    ds_read_b64_tr_b16 a[210:211], v206 offset:24096
    v_mfma_f32_16x16x32_bf16 v[40:43], a[224:227], a[144:147], 0
    buffer_load_dwordx4 v193, s[32:35], s75 offen lds
    v_mfma_f32_16x16x32_bf16 v[40:43], a[228:231], a[176:179], v[40:43]
    s_mov_b32 m0, 128000
    v_mfma_f32_16x16x32_bf16 v[8:11], a[220:223], a[176:179], 0
    buffer_load_dwordx4 v194, s[32:35], s75 offen lds
    v_mfma_f32_16x16x32_bf16 v[8:11], a[216:219], a[144:147], v[8:11]
    s_mov_b32 m0, 129024
    v_mfma_f32_16x16x32_bf16 v[4:7], a[216:219], a[140:143], 0
    buffer_load_dwordx4 v195, s[32:35], s75 offen lds
    v_mfma_f32_16x16x32_bf16 v[4:7], a[220:223], a[172:175], v[4:7]
    s_sub_u32 s75, s75, 229376
    v_mfma_f32_16x16x32_bf16 v[36:39], a[228:231], a[172:175], 0
    v_mfma_f32_16x16x32_bf16 v[36:39], a[224:227], a[140:143], v[36:39]
    v_mfma_f32_16x16x32_bf16 v[32:35], a[224:227], a[136:139], 0
    v_mfma_f32_16x16x32_bf16 v[32:35], a[228:231], a[168:171], v[32:35]
    v_mfma_f32_16x16x32_bf16 v[0:3], a[220:223], a[168:171], 0
    v_mfma_f32_16x16x32_bf16 v[0:3], a[216:219], a[136:139], v[0:3]
    s_waitcnt vmcnt(20) lgkmcnt(0)
    s_barrier
    v_mfma_f32_16x16x32_bf16 a[64:67], a[200:203], a[136:139], 0
    ds_read_b64_tr_b16 a[216:217], v206 offset:49152
    v_mfma_f32_16x16x32_bf16 a[64:67], a[204:207], a[168:171], a[64:67]
    s_mov_b32 m0, 104448
    v_mfma_f32_16x16x32_bf16 a[96:99], a[212:215], a[168:171], 0
    ds_read_b64_tr_b16 a[218:219], v206 offset:52736
    v_mfma_f32_16x16x32_bf16 a[96:99], a[208:211], a[136:139], a[96:99]
    buffer_load_dwordx4 v192, s[36:39], s75 offen lds
    v_mfma_f32_16x16x32_bf16 a[100:103], a[208:211], a[140:143], 0
    ds_read_b64_tr_b16 a[220:221], v206 offset:56320
    v_mfma_f32_16x16x32_bf16 a[100:103], a[212:215], a[172:175], a[100:103]
    ds_read_b64_tr_b16 a[222:223], v206 offset:59904
    v_mfma_f32_16x16x32_bf16 a[68:71], a[204:207], a[172:175], 0
    s_mov_b32 m0, 105472
    v_mfma_f32_16x16x32_bf16 a[68:71], a[200:203], a[140:143], a[68:71]
    ds_read_b64_tr_b16 a[228:229], v206 offset:56352
    v_mfma_f32_16x16x32_bf16 a[72:75], a[200:203], a[144:147], 0
    ds_read_b64_tr_b16 a[230:231], v206 offset:59936
    v_mfma_f32_16x16x32_bf16 a[72:75], a[204:207], a[176:179], a[72:75]
    buffer_load_dwordx4 v193, s[36:39], s75 offen lds
    v_mfma_f32_16x16x32_bf16 a[104:107], a[212:215], a[176:179], 0
    ds_read_b64_tr_b16 a[224:225], v206 offset:49184
    v_mfma_f32_16x16x32_bf16 a[104:107], a[208:211], a[144:147], a[104:107]
    ds_read_b128 a[136:139], v200 offset:32768
    v_mfma_f32_16x16x32_bf16 a[108:111], a[208:211], a[148:151], 0
    s_mov_b32 m0, 106496
    v_mfma_f32_16x16x32_bf16 a[108:111], a[212:215], a[180:183], a[108:111]
    ds_read_b64_tr_b16 a[226:227], v206 offset:52768
    v_mfma_f32_16x16x32_bf16 a[76:79], a[204:207], a[180:183], 0
    ds_read_b128 a[168:171], v201 offset:32768
    v_mfma_f32_16x16x32_bf16 a[76:79], a[200:203], a[148:151], a[76:79]
    buffer_load_dwordx4 v194, s[36:39], s75 offen lds
    v_mfma_f32_16x16x32_bf16 a[80:83], a[200:203], a[152:155], 0
    ds_read_b128 a[140:143], v200 offset:34816
    v_mfma_f32_16x16x32_bf16 a[80:83], a[204:207], a[184:187], a[80:83]
    s_mov_b32 m0, 107520
    v_mfma_f32_16x16x32_bf16 a[112:115], a[212:215], a[184:187], 0
    buffer_load_dwordx4 v195, s[36:39], s75 offen lds
    v_mfma_f32_16x16x32_bf16 a[112:115], a[208:211], a[152:155], a[112:115]
    ds_read_b128 a[172:175], v201 offset:34816
    v_mfma_f32_16x16x32_bf16 a[116:119], a[208:211], a[156:159], 0
    s_add_u32 s75, s75, 229376
    v_mfma_f32_16x16x32_bf16 a[116:119], a[212:215], a[188:191], a[116:119]
    ds_read_b128 a[144:147], v200 offset:36864
    v_mfma_f32_16x16x32_bf16 a[84:87], a[204:207], a[188:191], 0
    s_mov_b32 m0, 111616
    v_mfma_f32_16x16x32_bf16 a[84:87], a[200:203], a[156:159], a[84:87]
    ds_read_b128 a[176:179], v201 offset:36864
    v_mfma_f32_16x16x32_bf16 a[88:91], a[200:203], a[160:163], 0
    buffer_load_dwordx4 v192, s[36:39], s75 offen lds
    v_mfma_f32_16x16x32_bf16 a[88:91], a[204:207], a[192:195], a[88:91]
    ds_read_b128 a[148:151], v200 offset:38912
    v_mfma_f32_16x16x32_bf16 a[120:123], a[212:215], a[192:195], 0
    s_mov_b32 m0, 112640
    v_mfma_f32_16x16x32_bf16 a[120:123], a[208:211], a[160:163], a[120:123]
    ds_read_b128 a[180:183], v201 offset:38912
    v_mfma_f32_16x16x32_bf16 a[124:127], a[208:211], a[164:167], 0
    buffer_load_dwordx4 v193, s[36:39], s75 offen lds
    v_mfma_f32_16x16x32_bf16 a[124:127], a[212:215], a[196:199], a[124:127]
    s_mov_b32 m0, 113664
    v_mfma_f32_16x16x32_bf16 a[92:95], a[204:207], a[196:199], 0
    s_cbranch_vccnz L_skp0_04
L_sbp0_04:
    v_mfma_f32_16x16x32_bf16 a[92:95], a[200:203], a[164:167], a[92:95]
    s_waitcnt lgkmcnt(4)
    v_mfma_f32_16x16x32_bf16 a[0:3], a[216:219], a[136:139], a[0:3]
    ds_read_b128 a[152:155], v200 offset:40960
    v_mfma_f32_16x16x32_bf16 a[0:3], a[220:223], a[168:171], a[0:3]
    buffer_load_dwordx4 v194, s[36:39], s75 offen lds
    v_mfma_f32_16x16x32_bf16 a[32:35], a[228:231], a[168:171], a[32:35]
    ds_read_b128 a[184:187], v201 offset:40960
    v_mfma_f32_16x16x32_bf16 a[32:35], a[224:227], a[136:139], a[32:35]
    s_mov_b32 m0, 114688
    v_mfma_f32_16x16x32_bf16 a[36:39], a[224:227], a[140:143], a[36:39]
    ds_read_b128 a[156:159], v200 offset:43008
    v_mfma_f32_16x16x32_bf16 a[36:39], a[228:231], a[172:175], a[36:39]
    buffer_load_dwordx4 v195, s[36:39], s75 offen lds
    v_mfma_f32_16x16x32_bf16 a[4:7], a[220:223], a[172:175], a[4:7]
    ds_read_b128 a[188:191], v201 offset:43008
    v_mfma_f32_16x16x32_bf16 a[4:7], a[216:219], a[140:143], a[4:7]
    s_waitcnt lgkmcnt(4)
    v_mfma_f32_16x16x32_bf16 a[8:11], a[216:219], a[144:147], a[8:11]
    s_add_u32 s75, s75, 229376
    v_mfma_f32_16x16x32_bf16 a[8:11], a[220:223], a[176:179], a[8:11]
    ds_read_b128 a[160:163], v200 offset:45056
    v_mfma_f32_16x16x32_bf16 a[40:43], a[228:231], a[176:179], a[40:43]
    ds_read_b128 a[192:195], v201 offset:45056
    v_mfma_f32_16x16x32_bf16 a[40:43], a[224:227], a[144:147], a[40:43]
    ds_read_b128 a[164:167], v200 offset:47104
    v_mfma_f32_16x16x32_bf16 a[44:47], a[224:227], a[148:151], a[44:47]
    ds_read_b128 a[196:199], v201 offset:47104
    v_mfma_f32_16x16x32_bf16 a[44:47], a[228:231], a[180:183], a[44:47]
    ds_read_b64_tr_b16 a[200:201], v204 offset:2048
    v_mfma_f32_16x16x32_bf16 a[12:15], a[220:223], a[180:183], a[12:15]
    ds_read_b64_tr_b16 a[202:203], v204 offset:3072
    v_mfma_f32_16x16x32_bf16 a[12:15], a[216:219], a[148:151], a[12:15]
    s_waitcnt lgkmcnt(6)
    v_mfma_f32_16x16x32_bf16 a[16:19], a[216:219], a[152:155], a[16:19]
    ds_read_b64_tr_b16 a[204:205], v204 offset:8192
    v_mfma_f32_16x16x32_bf16 a[16:19], a[220:223], a[184:187], a[16:19]
    ds_read_b64_tr_b16 a[206:207], v204 offset:9216
    v_mfma_f32_16x16x32_bf16 a[48:51], a[228:231], a[184:187], a[48:51]
    ds_read_b64_tr_b16 a[212:213], v205 offset:8224
    v_mfma_f32_16x16x32_bf16 a[48:51], a[224:227], a[152:155], a[48:51]
    s_cmp_lt_u32 s65, 4
    s_cselect_b32 s84, 2, 5
    s_mul_i32 s84, s84, 917504
    s_add_u32 s90, s90, s84
    v_mfma_f32_16x16x32_bf16 a[52:55], a[224:227], a[156:159], a[52:55]
    s_bfm_b64 exec, 28, 0
    buffer_load_dword v236, v197, s[52:55], s90 offen
    s_mov_b64 exec, -1
    v_mfma_f32_16x16x32_bf16 a[52:55], a[228:231], a[188:191], a[52:55]
    ds_read_b64_tr_b16 a[214:215], v205 offset:9248
    v_mfma_f32_16x16x32_bf16 a[20:23], a[220:223], a[188:191], a[20:23]
    ds_read_b64_tr_b16 a[208:209], v205 offset:2080
    v_mfma_f32_16x16x32_bf16 a[20:23], a[216:219], a[156:159], a[20:23]
    s_waitcnt lgkmcnt(7)
    v_mfma_f32_16x16x32_bf16 a[24:27], a[216:219], a[160:163], a[24:27]
    ds_read_b64_tr_b16 a[210:211], v205 offset:3104
    v_mfma_f32_16x16x32_bf16 a[24:27], a[220:223], a[192:195], a[24:27]
    v_mfma_f32_16x16x32_bf16 a[56:59], a[228:231], a[192:195], a[56:59]
    v_mfma_f32_16x16x32_bf16 a[56:59], a[224:227], a[160:163], a[56:59]
    v_mfma_f32_16x16x32_bf16 a[60:63], a[224:227], a[164:167], a[60:63]
    v_mfma_f32_16x16x32_bf16 a[60:63], a[228:231], a[196:199], a[60:63]
    v_mfma_f32_16x16x32_bf16 a[28:31], a[220:223], a[196:199], a[28:31]
    v_mfma_f32_16x16x32_bf16 a[28:31], a[216:219], a[164:167], a[28:31]
    s_waitcnt lgkmcnt(0)
    v_mfma_f32_16x16x32_bf16 v[92:95], a[200:203], a[164:167], v[92:95]
    v_mfma_f32_16x16x32_bf16 v[92:95], a[204:207], a[196:199], v[92:95]
    v_mfma_f32_16x16x32_bf16 v[124:127], a[212:215], a[196:199], v[124:127]
    v_mfma_f32_16x16x32_bf16 v[124:127], a[208:211], a[164:167], v[124:127]
    v_mfma_f32_16x16x32_bf16 v[120:123], a[208:211], a[160:163], v[120:123]
    v_mfma_f32_16x16x32_bf16 v[120:123], a[212:215], a[192:195], v[120:123]
    v_mfma_f32_16x16x32_bf16 v[88:91], a[204:207], a[192:195], v[88:91]
    v_mfma_f32_16x16x32_bf16 v[88:91], a[200:203], a[160:163], v[88:91]
    v_mfma_f32_16x16x32_bf16 v[84:87], a[200:203], a[156:159], v[84:87]
    v_mfma_f32_16x16x32_bf16 v[84:87], a[204:207], a[188:191], v[84:87]
    v_mfma_f32_16x16x32_bf16 v[116:119], a[212:215], a[188:191], v[116:119]
    v_mfma_f32_16x16x32_bf16 v[116:119], a[208:211], a[156:159], v[116:119]
    v_mfma_f32_16x16x32_bf16 v[112:115], a[208:211], a[152:155], v[112:115]
    v_mfma_f32_16x16x32_bf16 v[112:115], a[212:215], a[184:187], v[112:115]
    v_mfma_f32_16x16x32_bf16 v[80:83], a[204:207], a[184:187], v[80:83]
    v_mfma_f32_16x16x32_bf16 v[80:83], a[200:203], a[152:155], v[80:83]
L_g1_loop0:
    s_waitcnt vmcnt(19)
    s_barrier
    v_mfma_f32_16x16x32_bf16 v[76:79], a[200:203], a[148:151], v[76:79]
    ds_read_b64_tr_b16 a[216:217], v204 offset:4096
    v_mfma_f32_16x16x32_bf16 v[76:79], a[204:207], a[180:183], v[76:79]
    ds_read_b64_tr_b16 a[218:219], v204 offset:5120
    v_mfma_f32_16x16x32_bf16 v[108:111], a[212:215], a[180:183], v[108:111]
    ds_read_b64_tr_b16 a[220:221], v204 offset:10240
    v_mfma_f32_16x16x32_bf16 v[108:111], a[208:211], a[148:151], v[108:111]
    ds_read_b64_tr_b16 a[222:223], v204 offset:11264
    v_mfma_f32_16x16x32_bf16 v[104:107], a[208:211], a[144:147], v[104:107]
    ds_read_b64_tr_b16 a[228:229], v205 offset:10272
    v_mfma_f32_16x16x32_bf16 v[104:107], a[212:215], a[176:179], v[104:107]
    ds_read_b64_tr_b16 a[230:231], v205 offset:11296
    v_mfma_f32_16x16x32_bf16 v[72:75], a[204:207], a[176:179], v[72:75]
    ds_read_b64_tr_b16 a[224:225], v205 offset:4128
    v_mfma_f32_16x16x32_bf16 v[72:75], a[200:203], a[144:147], v[72:75]
    ds_read_b64_tr_b16 a[226:227], v205 offset:5152
    v_mfma_f32_16x16x32_bf16 v[68:71], a[200:203], a[140:143], v[68:71]
    s_mov_b32 m0, 32768
    v_mfma_f32_16x16x32_bf16 v[68:71], a[204:207], a[172:175], v[68:71]
    v_mfma_f32_16x16x32_bf16 v[100:103], a[212:215], a[172:175], v[100:103]
    v_mfma_f32_16x16x32_bf16 v[100:103], a[208:211], a[140:143], v[100:103]
    buffer_load_dwordx4 v198, s[24:27], s72 offen lds
    v_mfma_f32_16x16x32_bf16 v[96:99], a[208:211], a[136:139], v[96:99]
    s_cbranch_vccnz L_skh0_11
L_sbh0_11:
    v_mfma_f32_16x16x32_bf16 v[96:99], a[212:215], a[168:171], v[96:99]
    v_mfma_f32_16x16x32_bf16 v[64:67], a[204:207], a[168:171], v[64:67]
    s_mov_b32 m0, 33792
    v_mfma_f32_16x16x32_bf16 v[64:67], a[200:203], a[136:139], v[64:67]
    s_waitcnt lgkmcnt(4)
    v_mfma_f32_16x16x32_bf16 v[128:131], a[136:139], a[216:219], v[128:131]
    ds_read_b64_tr_b16 a[200:201], v204 offset:0
    v_mfma_f32_16x16x32_bf16 v[128:131], a[168:171], a[220:223], v[128:131]
    s_waitcnt lgkmcnt(1)
    v_mfma_f32_16x16x32_bf16 v[160:163], a[168:171], a[228:231], v[160:163]
    buffer_load_dwordx4 v199, s[24:27], s72 offen lds
    v_mfma_f32_16x16x32_bf16 v[160:163], a[136:139], a[224:227], v[160:163]
    ds_read_b64_tr_b16 a[202:203], v204 offset:1024
    v_mfma_f32_16x16x32_bf16 v[164:167], a[140:143], a[224:227], v[164:167]
    s_add_u32 s72, s72, 128
    v_mfma_f32_16x16x32_bf16 v[164:167], a[172:175], a[228:231], v[164:167]
    ds_read_b64_tr_b16 a[204:205], v204 offset:6144
    v_mfma_f32_16x16x32_bf16 v[132:135], a[172:175], a[220:223], v[132:135]
    v_mfma_f32_16x16x32_bf16 v[132:135], a[140:143], a[216:219], v[132:135]
    s_mov_b32 m0, 133120
    v_mfma_f32_16x16x32_bf16 v[136:139], a[144:147], a[216:219], v[136:139]
    ds_read_b64_tr_b16 a[206:207], v204 offset:7168
    v_mfma_f32_16x16x32_bf16 v[136:139], a[176:179], a[220:223], v[136:139]
    ds_read_b64_tr_b16 a[212:213], v205 offset:6176
    v_mfma_f32_16x16x32_bf16 v[168:171], a[176:179], a[228:231], v[168:171]
    buffer_load_dwordx4 v192, s[32:35], s75 offen lds
    v_mfma_f32_16x16x32_bf16 v[168:171], a[144:147], a[224:227], v[168:171]
    v_mfma_f32_16x16x32_bf16 v[172:175], a[148:151], a[224:227], v[172:175]
    ds_read_b64_tr_b16 a[214:215], v205 offset:7200
    v_mfma_f32_16x16x32_bf16 v[172:175], a[180:183], a[228:231], v[172:175]
    s_mov_b32 m0, 134144
    v_mfma_f32_16x16x32_bf16 v[140:143], a[180:183], a[220:223], v[140:143]
    ds_read_b64_tr_b16 a[208:209], v205 offset:32
    v_mfma_f32_16x16x32_bf16 v[140:143], a[148:151], a[216:219], v[140:143]
    buffer_load_dwordx4 v193, s[32:35], s75 offen lds
    v_mfma_f32_16x16x32_bf16 v[144:147], a[152:155], a[216:219], v[144:147]
    ds_read_b64_tr_b16 a[210:211], v205 offset:1056
    v_mfma_f32_16x16x32_bf16 v[144:147], a[184:187], a[220:223], v[144:147]
    v_mfma_f32_16x16x32_bf16 v[176:179], a[184:187], a[228:231], v[176:179]
    s_mov_b32 m0, 135168
    v_mfma_f32_16x16x32_bf16 v[176:179], a[152:155], a[224:227], v[176:179]
    v_mfma_f32_16x16x32_bf16 v[180:183], a[156:159], a[224:227], v[180:183]
    v_mfma_f32_16x16x32_bf16 v[180:183], a[188:191], a[228:231], v[180:183]
    buffer_load_dwordx4 v194, s[32:35], s75 offen lds
    v_mfma_f32_16x16x32_bf16 v[148:151], a[188:191], a[220:223], v[148:151]
    v_mfma_f32_16x16x32_bf16 v[148:151], a[156:159], a[216:219], v[148:151]
    v_mfma_f32_16x16x32_bf16 v[152:155], a[160:163], a[216:219], v[152:155]
    s_mov_b32 m0, 136192
    v_mfma_f32_16x16x32_bf16 v[152:155], a[192:195], a[220:223], v[152:155]
    v_mfma_f32_16x16x32_bf16 v[184:187], a[192:195], a[228:231], v[184:187]
    v_mfma_f32_16x16x32_bf16 v[184:187], a[160:163], a[224:227], v[184:187]
    buffer_load_dwordx4 v195, s[32:35], s75 offen lds
    v_mfma_f32_16x16x32_bf16 v[188:191], a[164:167], a[224:227], v[188:191]
    v_mfma_f32_16x16x32_bf16 v[188:191], a[196:199], a[228:231], v[188:191]
    v_mfma_f32_16x16x32_bf16 v[156:159], a[196:199], a[220:223], v[156:159]
    s_add_u32 s75, s75, 229376
    v_mfma_f32_16x16x32_bf16 v[156:159], a[164:167], a[216:219], v[156:159]
    s_waitcnt lgkmcnt(0)
    v_mfma_f32_16x16x32_bf16 v[28:31], a[200:203], a[164:167], v[28:31]
    ds_read_b64_tr_b16 a[216:217], v206 offset:0
    v_mfma_f32_16x16x32_bf16 v[28:31], a[204:207], a[196:199], v[28:31]
    s_mov_b32 m0, 140288
    v_mfma_f32_16x16x32_bf16 v[60:63], a[212:215], a[196:199], v[60:63]
    v_mfma_f32_16x16x32_bf16 v[60:63], a[208:211], a[164:167], v[60:63]
    ds_read_b64_tr_b16 a[218:219], v206 offset:3584
    v_mfma_f32_16x16x32_bf16 v[56:59], a[208:211], a[160:163], v[56:59]
    buffer_load_dwordx4 v192, s[32:35], s75 offen lds
    v_mfma_f32_16x16x32_bf16 v[56:59], a[212:215], a[192:195], v[56:59]
    ds_read_b64_tr_b16 a[220:221], v206 offset:7168
    v_mfma_f32_16x16x32_bf16 v[24:27], a[204:207], a[192:195], v[24:27]
    s_mov_b32 m0, 141312
    v_mfma_f32_16x16x32_bf16 v[24:27], a[200:203], a[160:163], v[24:27]
    ds_read_b64_tr_b16 a[222:223], v206 offset:10752
    v_mfma_f32_16x16x32_bf16 v[20:23], a[200:203], a[156:159], v[20:23]
    v_mfma_f32_16x16x32_bf16 v[20:23], a[204:207], a[188:191], v[20:23]
    buffer_load_dwordx4 v193, s[32:35], s75 offen lds
    v_mfma_f32_16x16x32_bf16 v[52:55], a[212:215], a[188:191], v[52:55]
    ds_read_b64_tr_b16 a[228:229], v206 offset:7200
    v_mfma_f32_16x16x32_bf16 v[52:55], a[208:211], a[156:159], v[52:55]
    v_mfma_f32_16x16x32_bf16 v[48:51], a[208:211], a[152:155], v[48:51]
    ds_read_b64_tr_b16 a[230:231], v206 offset:10784
    v_mfma_f32_16x16x32_bf16 v[48:51], a[212:215], a[184:187], v[48:51]
    s_mov_b32 m0, 142336
    v_mfma_f32_16x16x32_bf16 v[16:19], a[204:207], a[184:187], v[16:19]
    ds_read_b64_tr_b16 a[224:225], v206 offset:32
    v_mfma_f32_16x16x32_bf16 v[16:19], a[200:203], a[152:155], v[16:19]
    buffer_load_dwordx4 v194, s[32:35], s75 offen lds
    v_mfma_f32_16x16x32_bf16 v[12:15], a[200:203], a[148:151], v[12:15]
    ds_read_b64_tr_b16 a[226:227], v206 offset:3616
    v_mfma_f32_16x16x32_bf16 v[12:15], a[204:207], a[180:183], v[12:15]
    v_mfma_f32_16x16x32_bf16 v[44:47], a[212:215], a[180:183], v[44:47]
    s_mov_b32 m0, 143360
    v_mfma_f32_16x16x32_bf16 v[44:47], a[208:211], a[148:151], v[44:47]
    v_mfma_f32_16x16x32_bf16 v[40:43], a[208:211], a[144:147], v[40:43]
    v_mfma_f32_16x16x32_bf16 v[40:43], a[212:215], a[176:179], v[40:43]
    buffer_load_dwordx4 v195, s[32:35], s75 offen lds
    v_mfma_f32_16x16x32_bf16 v[8:11], a[204:207], a[176:179], v[8:11]
    v_mfma_f32_16x16x32_bf16 v[8:11], a[200:203], a[144:147], v[8:11]
    v_mfma_f32_16x16x32_bf16 v[4:7], a[200:203], a[140:143], v[4:7]
    s_sub_u32 s75, s75, 229376
    v_mfma_f32_16x16x32_bf16 v[4:7], a[204:207], a[172:175], v[4:7]
    v_mfma_f32_16x16x32_bf16 v[36:39], a[212:215], a[172:175], v[36:39]
    global_load_dword v236, v237, s[0:1]
    v_mfma_f32_16x16x32_bf16 v[36:39], a[208:211], a[140:143], v[36:39]
    v_mfma_f32_16x16x32_bf16 v[32:35], a[208:211], a[136:139], v[32:35]
    v_mfma_f32_16x16x32_bf16 v[32:35], a[212:215], a[168:171], v[32:35]
    v_mfma_f32_16x16x32_bf16 v[0:3], a[204:207], a[168:171], v[0:3]
    s_cbranch_vccnz L_skh0_13
L_sbh0_13:
    v_mfma_f32_16x16x32_bf16 v[0:3], a[200:203], a[136:139], v[0:3]
    s_cmp_eq_u32 s76, 4
    s_cbranch_scc1 L_hs0
L_hb0:
    s_waitcnt vmcnt(20) lgkmcnt(0)
    s_barrier
    v_mfma_f32_16x16x32_bf16 a[64:67], a[216:219], a[136:139], a[64:67]
    ds_read_b64_tr_b16 a[200:201], v206 offset:34816
    v_mfma_f32_16x16x32_bf16 a[64:67], a[220:223], a[168:171], a[64:67]
    s_mov_b32 m0, 83968
    v_mfma_f32_16x16x32_bf16 a[96:99], a[228:231], a[168:171], a[96:99]
    ds_read_b64_tr_b16 a[202:203], v206 offset:38400
    v_mfma_f32_16x16x32_bf16 a[96:99], a[224:227], a[136:139], a[96:99]
    buffer_load_dwordx4 v192, s[36:39], s75 offen lds
    v_mfma_f32_16x16x32_bf16 a[100:103], a[224:227], a[140:143], a[100:103]
    ds_read_b64_tr_b16 a[204:205], v206 offset:41984
    v_mfma_f32_16x16x32_bf16 a[100:103], a[228:231], a[172:175], a[100:103]
    ds_read_b64_tr_b16 a[206:207], v206 offset:45568
    v_mfma_f32_16x16x32_bf16 a[68:71], a[220:223], a[172:175], a[68:71]
    s_mov_b32 m0, 84992
    v_mfma_f32_16x16x32_bf16 a[68:71], a[216:219], a[140:143], a[68:71]
    ds_read_b64_tr_b16 a[212:213], v206 offset:42016
    v_mfma_f32_16x16x32_bf16 a[72:75], a[216:219], a[144:147], a[72:75]
    ds_read_b64_tr_b16 a[214:215], v206 offset:45600
    v_mfma_f32_16x16x32_bf16 a[72:75], a[220:223], a[176:179], a[72:75]
    buffer_load_dwordx4 v193, s[36:39], s75 offen lds
    v_mfma_f32_16x16x32_bf16 a[104:107], a[228:231], a[176:179], a[104:107]
    ds_read_b64_tr_b16 a[208:209], v206 offset:34848
    v_mfma_f32_16x16x32_bf16 a[104:107], a[224:227], a[144:147], a[104:107]
    ds_read_b128 a[136:139], v200 offset:0
    v_mfma_f32_16x16x32_bf16 a[108:111], a[224:227], a[148:151], a[108:111]
    s_mov_b32 m0, 86016
    v_mfma_f32_16x16x32_bf16 a[108:111], a[228:231], a[180:183], a[108:111]
    ds_read_b64_tr_b16 a[210:211], v206 offset:38432
    v_mfma_f32_16x16x32_bf16 a[76:79], a[220:223], a[180:183], a[76:79]
    ds_read_b128 a[168:171], v201 offset:0
    v_mfma_f32_16x16x32_bf16 a[76:79], a[216:219], a[148:151], a[76:79]
    buffer_load_dwordx4 v194, s[36:39], s75 offen lds
    v_mfma_f32_16x16x32_bf16 a[80:83], a[216:219], a[152:155], a[80:83]
    ds_read_b128 a[140:143], v200 offset:2048
    v_mfma_f32_16x16x32_bf16 a[80:83], a[220:223], a[184:187], a[80:83]
    s_mov_b32 m0, 87040
    v_mfma_f32_16x16x32_bf16 a[112:115], a[228:231], a[184:187], a[112:115]
    buffer_load_dwordx4 v195, s[36:39], s75 offen lds
    v_mfma_f32_16x16x32_bf16 a[112:115], a[224:227], a[152:155], a[112:115]
    ds_read_b128 a[172:175], v201 offset:2048
    v_mfma_f32_16x16x32_bf16 a[116:119], a[224:227], a[156:159], a[116:119]
    s_add_u32 s75, s75, 229376
    v_mfma_f32_16x16x32_bf16 a[116:119], a[228:231], a[188:191], a[116:119]
    ds_read_b128 a[144:147], v200 offset:4096
    v_mfma_f32_16x16x32_bf16 a[84:87], a[220:223], a[188:191], a[84:87]
    s_mov_b32 m0, 91136
    v_mfma_f32_16x16x32_bf16 a[84:87], a[216:219], a[156:159], a[84:87]
    ds_read_b128 a[176:179], v201 offset:4096
    v_mfma_f32_16x16x32_bf16 a[88:91], a[216:219], a[160:163], a[88:91]
    buffer_load_dwordx4 v192, s[36:39], s75 offen lds
    v_mfma_f32_16x16x32_bf16 a[88:91], a[220:223], a[192:195], a[88:91]
    ds_read_b128 a[148:151], v200 offset:6144
    v_mfma_f32_16x16x32_bf16 a[120:123], a[228:231], a[192:195], a[120:123]
    s_mov_b32 m0, 92160
    v_mfma_f32_16x16x32_bf16 a[120:123], a[224:227], a[160:163], a[120:123]
    ds_read_b128 a[180:183], v201 offset:6144
    v_mfma_f32_16x16x32_bf16 a[124:127], a[224:227], a[164:167], a[124:127]
    buffer_load_dwordx4 v193, s[36:39], s75 offen lds
    v_mfma_f32_16x16x32_bf16 a[124:127], a[228:231], a[196:199], a[124:127]
    s_mov_b32 m0, 93184
    v_mfma_f32_16x16x32_bf16 a[92:95], a[220:223], a[196:199], a[92:95]
    ds_read_b128 a[152:155], v200 offset:8192
    v_mfma_f32_16x16x32_bf16 a[92:95], a[216:219], a[164:167], a[92:95]
    s_waitcnt lgkmcnt(5)
    v_mfma_f32_16x16x32_bf16 a[0:3], a[200:203], a[136:139], a[0:3]
    buffer_load_dwordx4 v194, s[36:39], s75 offen lds
    v_mfma_f32_16x16x32_bf16 a[0:3], a[204:207], a[168:171], a[0:3]
    ds_read_b128 a[184:187], v201 offset:8192
    v_mfma_f32_16x16x32_bf16 a[32:35], a[212:215], a[168:171], a[32:35]
    s_mov_b32 m0, 94208
    v_mfma_f32_16x16x32_bf16 a[32:35], a[208:211], a[136:139], a[32:35]
    ds_read_b128 a[156:159], v200 offset:10240
    v_mfma_f32_16x16x32_bf16 a[36:39], a[208:211], a[140:143], a[36:39]
    buffer_load_dwordx4 v195, s[36:39], s75 offen lds
    v_mfma_f32_16x16x32_bf16 a[36:39], a[212:215], a[172:175], a[36:39]
    ds_read_b128 a[188:191], v201 offset:10240
    v_mfma_f32_16x16x32_bf16 a[4:7], a[204:207], a[172:175], a[4:7]
    s_add_u32 s75, s75, 229376
    v_mfma_f32_16x16x32_bf16 a[4:7], a[200:203], a[140:143], a[4:7]
    s_waitcnt lgkmcnt(4)
    v_mfma_f32_16x16x32_bf16 a[8:11], a[200:203], a[144:147], a[8:11]
    ds_read_b128 a[160:163], v200 offset:12288
    v_mfma_f32_16x16x32_bf16 a[8:11], a[204:207], a[176:179], a[8:11]
    ds_read_b128 a[192:195], v201 offset:12288
    v_mfma_f32_16x16x32_bf16 a[40:43], a[212:215], a[176:179], a[40:43]
    ds_read_b128 a[164:167], v200 offset:14336
    v_mfma_f32_16x16x32_bf16 a[40:43], a[208:211], a[144:147], a[40:43]
    ds_read_b128 a[196:199], v201 offset:14336
    v_mfma_f32_16x16x32_bf16 a[44:47], a[208:211], a[148:151], a[44:47]
    ds_read_b64_tr_b16 a[216:217], v204 offset:14336
    v_mfma_f32_16x16x32_bf16 a[44:47], a[212:215], a[180:183], a[44:47]
    ds_read_b64_tr_b16 a[218:219], v204 offset:15360
    v_mfma_f32_16x16x32_bf16 a[12:15], a[204:207], a[180:183], a[12:15]
    ds_read_b64_tr_b16 a[220:221], v204 offset:34816
    v_mfma_f32_16x16x32_bf16 a[12:15], a[200:203], a[148:151], a[12:15]
    s_waitcnt lgkmcnt(7)
    v_mfma_f32_16x16x32_bf16 a[16:19], a[200:203], a[152:155], a[16:19]
    ds_read_b64_tr_b16 a[222:223], v204 offset:35840
    v_mfma_f32_16x16x32_bf16 a[16:19], a[204:207], a[184:187], a[16:19]
    ds_read_b64_tr_b16 a[228:229], v205 offset:34848
    v_mfma_f32_16x16x32_bf16 a[48:51], a[212:215], a[184:187], a[48:51]
    s_cmp_lt_u32 s76, 3
    s_cselect_b32 s84, s90, 2.0
    s_bfm_b64 exec, 28, 28
    buffer_load_dword v236, v197, s[52:55], s84 offen
    s_mov_b64 exec, -1
    s_add_u32 s90, s90, 917504
    v_mfma_f32_16x16x32_bf16 a[48:51], a[208:211], a[152:155], a[48:51]
    ds_read_b64_tr_b16 a[230:231], v205 offset:35872
    v_mfma_f32_16x16x32_bf16 a[52:55], a[208:211], a[156:159], a[52:55]
    ds_read_b64_tr_b16 a[224:225], v205 offset:14368
    v_mfma_f32_16x16x32_bf16 a[52:55], a[212:215], a[188:191], a[52:55]
    ds_read_b64_tr_b16 a[226:227], v205 offset:15392
    v_mfma_f32_16x16x32_bf16 a[20:23], a[204:207], a[188:191], a[20:23]
    v_mfma_f32_16x16x32_bf16 a[20:23], a[200:203], a[156:159], a[20:23]
    s_waitcnt lgkmcnt(8)
    v_mfma_f32_16x16x32_bf16 a[24:27], a[200:203], a[160:163], a[24:27]
    v_mfma_f32_16x16x32_bf16 a[24:27], a[204:207], a[192:195], a[24:27]
    v_mfma_f32_16x16x32_bf16 a[56:59], a[212:215], a[192:195], a[56:59]
    v_mfma_f32_16x16x32_bf16 a[56:59], a[208:211], a[160:163], a[56:59]
    v_mfma_f32_16x16x32_bf16 a[60:63], a[208:211], a[164:167], a[60:63]
    v_mfma_f32_16x16x32_bf16 a[60:63], a[212:215], a[196:199], a[60:63]
    s_cmp_eq_u32 s76, s82
    s_cselect_b64 vcc, -1, 0
    v_mfma_f32_16x16x32_bf16 a[28:31], a[204:207], a[196:199], a[28:31]
    s_cbranch_vccnz L_skh0_00
L_sbh0_00:
    v_mfma_f32_16x16x32_bf16 a[28:31], a[200:203], a[164:167], a[28:31]
    s_waitcnt lgkmcnt(0)
    v_mfma_f32_16x16x32_bf16 v[92:95], a[216:219], a[164:167], v[92:95]
    v_mfma_f32_16x16x32_bf16 v[92:95], a[220:223], a[196:199], v[92:95]
    v_mfma_f32_16x16x32_bf16 v[124:127], a[228:231], a[196:199], v[124:127]
    v_mfma_f32_16x16x32_bf16 v[124:127], a[224:227], a[164:167], v[124:127]
    v_mfma_f32_16x16x32_bf16 v[120:123], a[224:227], a[160:163], v[120:123]
    v_mfma_f32_16x16x32_bf16 v[120:123], a[228:231], a[192:195], v[120:123]
    v_mfma_f32_16x16x32_bf16 v[88:91], a[220:223], a[192:195], v[88:91]
    v_mfma_f32_16x16x32_bf16 v[88:91], a[216:219], a[160:163], v[88:91]
    v_mfma_f32_16x16x32_bf16 v[84:87], a[216:219], a[156:159], v[84:87]
    v_mfma_f32_16x16x32_bf16 v[84:87], a[220:223], a[188:191], v[84:87]
    v_mfma_f32_16x16x32_bf16 v[116:119], a[228:231], a[188:191], v[116:119]
    v_mfma_f32_16x16x32_bf16 v[116:119], a[224:227], a[156:159], v[116:119]
    v_mfma_f32_16x16x32_bf16 v[112:115], a[224:227], a[152:155], v[112:115]
    v_mfma_f32_16x16x32_bf16 v[112:115], a[228:231], a[184:187], v[112:115]
    v_mfma_f32_16x16x32_bf16 v[80:83], a[220:223], a[184:187], v[80:83]
    v_mfma_f32_16x16x32_bf16 v[80:83], a[216:219], a[152:155], v[80:83]
    s_add_u32 s76, s76, 1
    s_cmp_eq_u32 s76, 7
    s_cbranch_scc1 L_tail0
    s_cmp_lg_u32 s76, s81
    s_cbranch_scc1 L_nw0
    s_lshl_b32 s84, s83, 8
    s_add_u32 s72, s72, s84
    s_mul_i32 s84, s83, 917504
    s_add_u32 s75, s75, s84
    s_mov_b32 s81, 4
    s_mov_b32 s83, -6
L_nw0:
    s_waitcnt vmcnt(21)
    s_barrier
    v_mfma_f32_16x16x32_bf16 v[76:79], a[216:219], a[148:151], v[76:79]
    ds_read_b64_tr_b16 a[200:201], v204 offset:16384
    v_mfma_f32_16x16x32_bf16 v[76:79], a[220:223], a[180:183], v[76:79]
    s_cmp_eq_u32 s76, 5
    s_cselect_b32 s84, s88, 2.0
    buffer_store_dwordx2 v[238:239], v207, s[44:47], s84 offen sc1
    v_mfma_f32_16x16x32_bf16 v[108:111], a[228:231], a[180:183], v[108:111]
    ds_read_b64_tr_b16 a[202:203], v204 offset:17408
    v_mfma_f32_16x16x32_bf16 v[108:111], a[224:227], a[148:151], v[108:111]
    ds_read_b64_tr_b16 a[204:205], v204 offset:36864
    v_mfma_f32_16x16x32_bf16 v[104:107], a[224:227], a[144:147], v[104:107]
    ds_read_b64_tr_b16 a[206:207], v204 offset:37888
    v_mfma_f32_16x16x32_bf16 v[104:107], a[228:231], a[176:179], v[104:107]
    ds_read_b64_tr_b16 a[212:213], v205 offset:36896
    v_mfma_f32_16x16x32_bf16 v[72:75], a[220:223], a[176:179], v[72:75]
    ds_read_b64_tr_b16 a[214:215], v205 offset:37920
    v_mfma_f32_16x16x32_bf16 v[72:75], a[216:219], a[144:147], v[72:75]
    ds_read_b64_tr_b16 a[208:209], v205 offset:16416
    v_mfma_f32_16x16x32_bf16 v[68:71], a[216:219], a[140:143], v[68:71]
    ds_read_b64_tr_b16 a[210:211], v205 offset:17440
    v_mfma_f32_16x16x32_bf16 v[68:71], a[220:223], a[172:175], v[68:71]
    s_mov_b32 m0, 0
    v_mfma_f32_16x16x32_bf16 v[100:103], a[228:231], a[172:175], v[100:103]
    v_mfma_f32_16x16x32_bf16 v[100:103], a[224:227], a[140:143], v[100:103]
    buffer_load_dwordx4 v198, s[24:27], s72 offen lds
    v_mfma_f32_16x16x32_bf16 v[96:99], a[224:227], a[136:139], v[96:99]
    v_mfma_f32_16x16x32_bf16 v[96:99], a[228:231], a[168:171], v[96:99]
    v_mfma_f32_16x16x32_bf16 v[64:67], a[220:223], a[168:171], v[64:67]
    s_mov_b32 m0, 1024
    v_mfma_f32_16x16x32_bf16 v[64:67], a[216:219], a[136:139], v[64:67]
    s_waitcnt lgkmcnt(4)
    v_mfma_f32_16x16x32_bf16 v[128:131], a[136:139], a[200:203], v[128:131]
    ds_read_b64_tr_b16 a[216:217], v204 offset:12288
    v_mfma_f32_16x16x32_bf16 v[128:131], a[168:171], a[204:207], v[128:131]
    s_waitcnt lgkmcnt(1)
    v_mfma_f32_16x16x32_bf16 v[160:163], a[168:171], a[212:215], v[160:163]
    buffer_load_dwordx4 v199, s[24:27], s72 offen lds
    v_mfma_f32_16x16x32_bf16 v[160:163], a[136:139], a[208:211], v[160:163]
    ds_read_b64_tr_b16 a[218:219], v204 offset:13312
    v_mfma_f32_16x16x32_bf16 v[164:167], a[140:143], a[208:211], v[164:167]
    s_add_u32 s72, s72, 128
    v_mfma_f32_16x16x32_bf16 v[164:167], a[172:175], a[212:215], v[164:167]
    ds_read_b64_tr_b16 a[220:221], v204 offset:32768
    v_mfma_f32_16x16x32_bf16 v[132:135], a[172:175], a[204:207], v[132:135]
    v_mfma_f32_16x16x32_bf16 v[132:135], a[140:143], a[200:203], v[132:135]
    s_mov_b32 m0, 118784
    v_mfma_f32_16x16x32_bf16 v[136:139], a[144:147], a[200:203], v[136:139]
    ds_read_b64_tr_b16 a[222:223], v204 offset:33792
    v_mfma_f32_16x16x32_bf16 v[136:139], a[176:179], a[204:207], v[136:139]
    ds_read_b64_tr_b16 a[228:229], v205 offset:32800
    v_mfma_f32_16x16x32_bf16 v[168:171], a[176:179], a[212:215], v[168:171]
    buffer_load_dwordx4 v192, s[32:35], s75 offen lds
    v_mfma_f32_16x16x32_bf16 v[168:171], a[144:147], a[208:211], v[168:171]
    v_mfma_f32_16x16x32_bf16 v[172:175], a[148:151], a[208:211], v[172:175]
    ds_read_b64_tr_b16 a[230:231], v205 offset:33824
    v_mfma_f32_16x16x32_bf16 v[172:175], a[180:183], a[212:215], v[172:175]
    s_mov_b32 m0, 119808
    v_mfma_f32_16x16x32_bf16 v[140:143], a[180:183], a[204:207], v[140:143]
    ds_read_b64_tr_b16 a[224:225], v205 offset:12320
    v_mfma_f32_16x16x32_bf16 v[140:143], a[148:151], a[200:203], v[140:143]
    buffer_load_dwordx4 v193, s[32:35], s75 offen lds
    v_mfma_f32_16x16x32_bf16 v[144:147], a[152:155], a[200:203], v[144:147]
    ds_read_b64_tr_b16 a[226:227], v205 offset:13344
    v_mfma_f32_16x16x32_bf16 v[144:147], a[184:187], a[204:207], v[144:147]
    v_mfma_f32_16x16x32_bf16 v[176:179], a[184:187], a[212:215], v[176:179]
    s_mov_b32 m0, 120832
    v_mfma_f32_16x16x32_bf16 v[176:179], a[152:155], a[208:211], v[176:179]
    v_mfma_f32_16x16x32_bf16 v[180:183], a[156:159], a[208:211], v[180:183]
    v_mfma_f32_16x16x32_bf16 v[180:183], a[188:191], a[212:215], v[180:183]
    buffer_load_dwordx4 v194, s[32:35], s75 offen lds
    v_mfma_f32_16x16x32_bf16 v[148:151], a[188:191], a[204:207], v[148:151]
    v_mfma_f32_16x16x32_bf16 v[148:151], a[156:159], a[200:203], v[148:151]
    v_mfma_f32_16x16x32_bf16 v[152:155], a[160:163], a[200:203], v[152:155]
    s_mov_b32 m0, 121856
    v_mfma_f32_16x16x32_bf16 v[152:155], a[192:195], a[204:207], v[152:155]
    v_mfma_f32_16x16x32_bf16 v[184:187], a[192:195], a[212:215], v[184:187]
    v_mfma_f32_16x16x32_bf16 v[184:187], a[160:163], a[208:211], v[184:187]
    buffer_load_dwordx4 v195, s[32:35], s75 offen lds
    v_mfma_f32_16x16x32_bf16 v[188:191], a[164:167], a[208:211], v[188:191]
    v_mfma_f32_16x16x32_bf16 v[188:191], a[196:199], a[212:215], v[188:191]
    v_mfma_f32_16x16x32_bf16 v[156:159], a[196:199], a[204:207], v[156:159]
    s_cbranch_vccnz L_skh0_02
L_sbh0_02:
    v_mfma_f32_16x16x32_bf16 v[156:159], a[164:167], a[200:203], v[156:159]
    s_waitcnt lgkmcnt(0)
    v_mfma_f32_16x16x32_bf16 v[28:31], a[216:219], a[164:167], v[28:31]
    s_add_u32 s75, s75, 229376
    v_mfma_f32_16x16x32_bf16 v[28:31], a[220:223], a[196:199], v[28:31]
    ds_read_b64_tr_b16 a[200:201], v206 offset:20480
    v_mfma_f32_16x16x32_bf16 v[60:63], a[228:231], a[196:199], v[60:63]
    s_mov_b32 m0, 125952
    v_mfma_f32_16x16x32_bf16 v[60:63], a[224:227], a[164:167], v[60:63]
    ds_read_b64_tr_b16 a[202:203], v206 offset:24064
    v_mfma_f32_16x16x32_bf16 v[56:59], a[224:227], a[160:163], v[56:59]
    buffer_load_dwordx4 v192, s[32:35], s75 offen lds
    v_mfma_f32_16x16x32_bf16 v[56:59], a[228:231], a[192:195], v[56:59]
    ds_read_b64_tr_b16 a[204:205], v206 offset:27648
    v_mfma_f32_16x16x32_bf16 v[24:27], a[220:223], a[192:195], v[24:27]
    s_mov_b32 m0, 126976
    v_mfma_f32_16x16x32_bf16 v[24:27], a[216:219], a[160:163], v[24:27]
    ds_read_b64_tr_b16 a[206:207], v206 offset:31232
    v_mfma_f32_16x16x32_bf16 v[20:23], a[216:219], a[156:159], v[20:23]
    v_mfma_f32_16x16x32_bf16 v[20:23], a[220:223], a[188:191], v[20:23]
    buffer_load_dwordx4 v193, s[32:35], s75 offen lds
    v_mfma_f32_16x16x32_bf16 v[52:55], a[228:231], a[188:191], v[52:55]
    ds_read_b64_tr_b16 a[212:213], v206 offset:27680
    v_mfma_f32_16x16x32_bf16 v[52:55], a[224:227], a[156:159], v[52:55]
    v_mfma_f32_16x16x32_bf16 v[48:51], a[224:227], a[152:155], v[48:51]
    ds_read_b64_tr_b16 a[214:215], v206 offset:31264
    v_mfma_f32_16x16x32_bf16 v[48:51], a[228:231], a[184:187], v[48:51]
    s_mov_b32 m0, 128000
    v_mfma_f32_16x16x32_bf16 v[16:19], a[220:223], a[184:187], v[16:19]
    ds_read_b64_tr_b16 a[208:209], v206 offset:20512
    v_mfma_f32_16x16x32_bf16 v[16:19], a[216:219], a[152:155], v[16:19]
    buffer_load_dwordx4 v194, s[32:35], s75 offen lds
    v_mfma_f32_16x16x32_bf16 v[12:15], a[216:219], a[148:151], v[12:15]
    ds_read_b64_tr_b16 a[210:211], v206 offset:24096
    v_mfma_f32_16x16x32_bf16 v[12:15], a[220:223], a[180:183], v[12:15]
    v_mfma_f32_16x16x32_bf16 v[44:47], a[228:231], a[180:183], v[44:47]
    s_mov_b32 m0, 129024
    v_mfma_f32_16x16x32_bf16 v[44:47], a[224:227], a[148:151], v[44:47]
    v_mfma_f32_16x16x32_bf16 v[40:43], a[224:227], a[144:147], v[40:43]
    v_mfma_f32_16x16x32_bf16 v[40:43], a[228:231], a[176:179], v[40:43]
    buffer_load_dwordx4 v195, s[32:35], s75 offen lds
    v_mfma_f32_16x16x32_bf16 v[8:11], a[220:223], a[176:179], v[8:11]
    v_mfma_f32_16x16x32_bf16 v[8:11], a[216:219], a[144:147], v[8:11]
    v_mfma_f32_16x16x32_bf16 v[4:7], a[216:219], a[140:143], v[4:7]
    s_sub_u32 s75, s75, 229376
    v_mfma_f32_16x16x32_bf16 v[4:7], a[220:223], a[172:175], v[4:7]
    v_mfma_f32_16x16x32_bf16 v[36:39], a[228:231], a[172:175], v[36:39]
    v_mfma_f32_16x16x32_bf16 v[36:39], a[224:227], a[140:143], v[36:39]
    v_mfma_f32_16x16x32_bf16 v[32:35], a[224:227], a[136:139], v[32:35]
    v_mfma_f32_16x16x32_bf16 v[32:35], a[228:231], a[168:171], v[32:35]
    v_mfma_f32_16x16x32_bf16 v[0:3], a[220:223], a[168:171], v[0:3]
    v_mfma_f32_16x16x32_bf16 v[0:3], a[216:219], a[136:139], v[0:3]
    s_waitcnt vmcnt(21) lgkmcnt(0)
    s_barrier
    v_mfma_f32_16x16x32_bf16 a[64:67], a[200:203], a[136:139], a[64:67]
    ds_read_b64_tr_b16 a[216:217], v206 offset:49152
    v_mfma_f32_16x16x32_bf16 a[64:67], a[204:207], a[168:171], a[64:67]
    s_mov_b32 m0, 104448
    v_mfma_f32_16x16x32_bf16 a[96:99], a[212:215], a[168:171], a[96:99]
    ds_read_b64_tr_b16 a[218:219], v206 offset:52736
    v_mfma_f32_16x16x32_bf16 a[96:99], a[208:211], a[136:139], a[96:99]
    buffer_load_dwordx4 v192, s[36:39], s75 offen lds
    v_mfma_f32_16x16x32_bf16 a[100:103], a[208:211], a[140:143], a[100:103]
    ds_read_b64_tr_b16 a[220:221], v206 offset:56320
    v_mfma_f32_16x16x32_bf16 a[100:103], a[212:215], a[172:175], a[100:103]
    ds_read_b64_tr_b16 a[222:223], v206 offset:59904
    v_mfma_f32_16x16x32_bf16 a[68:71], a[204:207], a[172:175], a[68:71]
    s_mov_b32 m0, 105472
    v_mfma_f32_16x16x32_bf16 a[68:71], a[200:203], a[140:143], a[68:71]
    ds_read_b64_tr_b16 a[228:229], v206 offset:56352
    v_mfma_f32_16x16x32_bf16 a[72:75], a[200:203], a[144:147], a[72:75]
    ds_read_b64_tr_b16 a[230:231], v206 offset:59936
    v_mfma_f32_16x16x32_bf16 a[72:75], a[204:207], a[176:179], a[72:75]
    buffer_load_dwordx4 v193, s[36:39], s75 offen lds
    v_mfma_f32_16x16x32_bf16 a[104:107], a[212:215], a[176:179], a[104:107]
    ds_read_b64_tr_b16 a[224:225], v206 offset:49184
    v_mfma_f32_16x16x32_bf16 a[104:107], a[208:211], a[144:147], a[104:107]
    ds_read_b128 a[136:139], v200 offset:32768
    v_mfma_f32_16x16x32_bf16 a[108:111], a[208:211], a[148:151], a[108:111]
    s_mov_b32 m0, 106496
    v_mfma_f32_16x16x32_bf16 a[108:111], a[212:215], a[180:183], a[108:111]
    ds_read_b64_tr_b16 a[226:227], v206 offset:52768
    v_mfma_f32_16x16x32_bf16 a[76:79], a[204:207], a[180:183], a[76:79]
    ds_read_b128 a[168:171], v201 offset:32768
    v_mfma_f32_16x16x32_bf16 a[76:79], a[200:203], a[148:151], a[76:79]
    buffer_load_dwordx4 v194, s[36:39], s75 offen lds
    v_mfma_f32_16x16x32_bf16 a[80:83], a[200:203], a[152:155], a[80:83]
    ds_read_b128 a[140:143], v200 offset:34816
    v_mfma_f32_16x16x32_bf16 a[80:83], a[204:207], a[184:187], a[80:83]
    s_mov_b32 m0, 107520
    v_mfma_f32_16x16x32_bf16 a[112:115], a[212:215], a[184:187], a[112:115]
    buffer_load_dwordx4 v195, s[36:39], s75 offen lds
    v_mfma_f32_16x16x32_bf16 a[112:115], a[208:211], a[152:155], a[112:115]
    ds_read_b128 a[172:175], v201 offset:34816
    v_mfma_f32_16x16x32_bf16 a[116:119], a[208:211], a[156:159], a[116:119]
    s_add_u32 s75, s75, 229376
    v_mfma_f32_16x16x32_bf16 a[116:119], a[212:215], a[188:191], a[116:119]
    ds_read_b128 a[144:147], v200 offset:36864
    v_mfma_f32_16x16x32_bf16 a[84:87], a[204:207], a[188:191], a[84:87]
    s_mov_b32 m0, 111616
    v_mfma_f32_16x16x32_bf16 a[84:87], a[200:203], a[156:159], a[84:87]
    ds_read_b128 a[176:179], v201 offset:36864
    v_mfma_f32_16x16x32_bf16 a[88:91], a[200:203], a[160:163], a[88:91]
    buffer_load_dwordx4 v192, s[36:39], s75 offen lds
    v_mfma_f32_16x16x32_bf16 a[88:91], a[204:207], a[192:195], a[88:91]
    ds_read_b128 a[148:151], v200 offset:38912
    v_mfma_f32_16x16x32_bf16 a[120:123], a[212:215], a[192:195], a[120:123]
    s_mov_b32 m0, 112640
    v_mfma_f32_16x16x32_bf16 a[120:123], a[208:211], a[160:163], a[120:123]
    ds_read_b128 a[180:183], v201 offset:38912
    v_mfma_f32_16x16x32_bf16 a[124:127], a[208:211], a[164:167], a[124:127]
    buffer_load_dwordx4 v193, s[36:39], s75 offen lds
    v_mfma_f32_16x16x32_bf16 a[124:127], a[212:215], a[196:199], a[124:127]
    s_mov_b32 m0, 113664
    v_mfma_f32_16x16x32_bf16 a[92:95], a[204:207], a[196:199], a[92:95]
    s_cbranch_vccnz L_skh0_04
L_sbh0_04:
    v_mfma_f32_16x16x32_bf16 a[92:95], a[200:203], a[164:167], a[92:95]
    s_waitcnt lgkmcnt(4)
    v_mfma_f32_16x16x32_bf16 a[0:3], a[216:219], a[136:139], a[0:3]
    ds_read_b128 a[152:155], v200 offset:40960
    v_mfma_f32_16x16x32_bf16 a[0:3], a[220:223], a[168:171], a[0:3]
    buffer_load_dwordx4 v194, s[36:39], s75 offen lds
    v_mfma_f32_16x16x32_bf16 a[32:35], a[228:231], a[168:171], a[32:35]
    ds_read_b128 a[184:187], v201 offset:40960
    v_mfma_f32_16x16x32_bf16 a[32:35], a[224:227], a[136:139], a[32:35]
    s_mov_b32 m0, 114688
    v_mfma_f32_16x16x32_bf16 a[36:39], a[224:227], a[140:143], a[36:39]
    ds_read_b128 a[156:159], v200 offset:43008
    v_mfma_f32_16x16x32_bf16 a[36:39], a[228:231], a[172:175], a[36:39]
    buffer_load_dwordx4 v195, s[36:39], s75 offen lds
    v_mfma_f32_16x16x32_bf16 a[4:7], a[220:223], a[172:175], a[4:7]
    ds_read_b128 a[188:191], v201 offset:43008
    v_mfma_f32_16x16x32_bf16 a[4:7], a[216:219], a[140:143], a[4:7]
    s_waitcnt lgkmcnt(4)
    v_mfma_f32_16x16x32_bf16 a[8:11], a[216:219], a[144:147], a[8:11]
    s_add_u32 s75, s75, 229376
    v_mfma_f32_16x16x32_bf16 a[8:11], a[220:223], a[176:179], a[8:11]
    ds_read_b128 a[160:163], v200 offset:45056
    v_mfma_f32_16x16x32_bf16 a[40:43], a[228:231], a[176:179], a[40:43]
    ds_read_b128 a[192:195], v201 offset:45056
    v_mfma_f32_16x16x32_bf16 a[40:43], a[224:227], a[144:147], a[40:43]
    ds_read_b128 a[164:167], v200 offset:47104
    v_mfma_f32_16x16x32_bf16 a[44:47], a[224:227], a[148:151], a[44:47]
    ds_read_b128 a[196:199], v201 offset:47104
    v_mfma_f32_16x16x32_bf16 a[44:47], a[228:231], a[180:183], a[44:47]
    ds_read_b64_tr_b16 a[200:201], v204 offset:2048
    v_mfma_f32_16x16x32_bf16 a[12:15], a[220:223], a[180:183], a[12:15]
    ds_read_b64_tr_b16 a[202:203], v204 offset:3072
    v_mfma_f32_16x16x32_bf16 a[12:15], a[216:219], a[148:151], a[12:15]
    s_waitcnt lgkmcnt(6)
    v_mfma_f32_16x16x32_bf16 a[16:19], a[216:219], a[152:155], a[16:19]
    ds_read_b64_tr_b16 a[204:205], v204 offset:8192
    v_mfma_f32_16x16x32_bf16 a[16:19], a[220:223], a[184:187], a[16:19]
    ds_read_b64_tr_b16 a[206:207], v204 offset:9216
    v_mfma_f32_16x16x32_bf16 a[48:51], a[228:231], a[184:187], a[48:51]
    ds_read_b64_tr_b16 a[212:213], v205 offset:8224
    v_mfma_f32_16x16x32_bf16 a[48:51], a[224:227], a[152:155], a[48:51]
    s_cmp_lt_u32 s76, 3
    s_cselect_b32 s84, s90, 2.0
    s_bfm_b64 exec, 28, 0
    buffer_load_dword v236, v197, s[52:55], s84 offen
    s_mov_b64 exec, -1
    v_mfma_f32_16x16x32_bf16 a[52:55], a[224:227], a[156:159], a[52:55]
    ds_read_b64_tr_b16 a[214:215], v205 offset:9248
    v_mfma_f32_16x16x32_bf16 a[52:55], a[228:231], a[188:191], a[52:55]
    ds_read_b64_tr_b16 a[208:209], v205 offset:2080
    v_mfma_f32_16x16x32_bf16 a[20:23], a[220:223], a[188:191], a[20:23]
    ds_read_b64_tr_b16 a[210:211], v205 offset:3104
    v_mfma_f32_16x16x32_bf16 a[20:23], a[216:219], a[156:159], a[20:23]
    s_waitcnt lgkmcnt(8)
    v_mfma_f32_16x16x32_bf16 a[24:27], a[216:219], a[160:163], a[24:27]
    v_mfma_f32_16x16x32_bf16 a[24:27], a[220:223], a[192:195], a[24:27]
    v_mfma_f32_16x16x32_bf16 a[56:59], a[228:231], a[192:195], a[56:59]
    v_mfma_f32_16x16x32_bf16 a[56:59], a[224:227], a[160:163], a[56:59]
    v_mfma_f32_16x16x32_bf16 a[60:63], a[224:227], a[164:167], a[60:63]
    v_mfma_f32_16x16x32_bf16 a[60:63], a[228:231], a[196:199], a[60:63]
    v_mfma_f32_16x16x32_bf16 a[28:31], a[220:223], a[196:199], a[28:31]
    s_cmp_eq_u32 s76, 4
    s_cselect_b32 s93, s92, 2.0
    buffer_load_dwordx4 v[232:235], v238, s[24:27], s93 offen offset:0
    v_mfma_f32_16x16x32_bf16 a[28:31], a[216:219], a[164:167], a[28:31]
    s_waitcnt lgkmcnt(0)
    v_mfma_f32_16x16x32_bf16 v[92:95], a[200:203], a[164:167], v[92:95]
    v_mfma_f32_16x16x32_bf16 v[92:95], a[204:207], a[196:199], v[92:95]
    v_mfma_f32_16x16x32_bf16 v[124:127], a[212:215], a[196:199], v[124:127]
    buffer_load_dwordx4 v[240:243], v238, s[24:27], s93 offen offset:512
    v_mfma_f32_16x16x32_bf16 v[124:127], a[208:211], a[164:167], v[124:127]
    v_mfma_f32_16x16x32_bf16 v[120:123], a[208:211], a[160:163], v[120:123]
    v_mfma_f32_16x16x32_bf16 v[120:123], a[212:215], a[192:195], v[120:123]
    v_mfma_f32_16x16x32_bf16 v[88:91], a[204:207], a[192:195], v[88:91]
    buffer_load_dwordx4 v[244:247], v238, s[24:27], s93 offen offset:1024
    v_mfma_f32_16x16x32_bf16 v[88:91], a[200:203], a[160:163], v[88:91]
    v_mfma_f32_16x16x32_bf16 v[84:87], a[200:203], a[156:159], v[84:87]
    v_mfma_f32_16x16x32_bf16 v[84:87], a[204:207], a[188:191], v[84:87]
    v_mfma_f32_16x16x32_bf16 v[116:119], a[212:215], a[188:191], v[116:119]
    buffer_load_dwordx4 v[248:251], v238, s[24:27], s93 offen offset:1536
    v_mfma_f32_16x16x32_bf16 v[116:119], a[208:211], a[156:159], v[116:119]
    v_mfma_f32_16x16x32_bf16 v[112:115], a[208:211], a[152:155], v[112:115]
    v_mfma_f32_16x16x32_bf16 v[112:115], a[212:215], a[184:187], v[112:115]
    v_mfma_f32_16x16x32_bf16 v[80:83], a[204:207], a[184:187], v[80:83]
    v_mfma_f32_16x16x32_bf16 v[80:83], a[200:203], a[152:155], v[80:83]
    s_branch L_g1_loop0
L_tail0:
    s_waitcnt vmcnt(25)
    s_barrier
    v_mfma_f32_16x16x32_bf16 v[76:79], a[216:219], a[148:151], v[76:79]
    ds_read_b64_tr_b16 a[200:201], v204 offset:16384
    v_mfma_f32_16x16x32_bf16 v[76:79], a[220:223], a[180:183], v[76:79]
    ds_read_b64_tr_b16 a[202:203], v204 offset:17408
    v_mfma_f32_16x16x32_bf16 v[108:111], a[228:231], a[180:183], v[108:111]
    ds_read_b64_tr_b16 a[204:205], v204 offset:36864
    v_mfma_f32_16x16x32_bf16 v[108:111], a[224:227], a[148:151], v[108:111]
    ds_read_b64_tr_b16 a[206:207], v204 offset:37888
    v_mfma_f32_16x16x32_bf16 v[104:107], a[224:227], a[144:147], v[104:107]
    ds_read_b64_tr_b16 a[212:213], v205 offset:36896
    v_mfma_f32_16x16x32_bf16 v[104:107], a[228:231], a[176:179], v[104:107]
    ds_read_b64_tr_b16 a[214:215], v205 offset:37920
    v_mfma_f32_16x16x32_bf16 v[72:75], a[220:223], a[176:179], v[72:75]
    ds_read_b64_tr_b16 a[208:209], v205 offset:16416
    v_mfma_f32_16x16x32_bf16 v[72:75], a[216:219], a[144:147], v[72:75]
    ds_read_b64_tr_b16 a[210:211], v205 offset:17440
    v_mfma_f32_16x16x32_bf16 v[68:71], a[216:219], a[140:143], v[68:71]
    v_lshrrev_b32 v203, 1, v254
    v_mfma_f32_16x16x32_bf16 v[68:71], a[220:223], a[172:175], v[68:71]
    v_min_u32 v202, 624, v254
    v_mfma_f32_16x16x32_bf16 v[100:103], a[228:231], a[172:175], v[100:103]
    buffer_load_dwordx2 v[224:225], v203, s[44:47], s4 offen sc1
    v_mfma_f32_16x16x32_bf16 v[100:103], a[224:227], a[140:143], v[100:103]
    v_and_b32 v226, 0x78, v203
    v_mfma_f32_16x16x32_bf16 v[96:99], a[224:227], a[136:139], v[96:99]
    buffer_load_dwordx2 v[226:227], v226, s[44:47], s5 offen sc1
    v_mfma_f32_16x16x32_bf16 v[96:99], a[228:231], a[168:171], v[96:99]
    buffer_load_dwordx4 v[208:211], v202, s[44:47], s6 offen offset:0 sc1
    v_mfma_f32_16x16x32_bf16 v[64:67], a[220:223], a[168:171], v[64:67]
    buffer_load_dwordx4 v[192:195], v202, s[44:47], s6 offen offset:2560 sc1
    v_mfma_f32_16x16x32_bf16 v[64:67], a[216:219], a[136:139], v[64:67]
    s_waitcnt lgkmcnt(4)
    v_mfma_f32_16x16x32_bf16 v[128:131], a[136:139], a[200:203], v[128:131]
    ds_read_b64_tr_b16 a[216:217], v204 offset:12288
    v_mfma_f32_16x16x32_bf16 v[128:131], a[168:171], a[204:207], v[128:131]
    s_waitcnt lgkmcnt(1)
    v_mfma_f32_16x16x32_bf16 v[160:163], a[168:171], a[212:215], v[160:163]
    s_add_u32 s75, s6, 5120
    v_mfma_f32_16x16x32_bf16 v[160:163], a[136:139], a[208:211], v[160:163]
    ds_read_b64_tr_b16 a[218:219], v204 offset:13312
    v_mfma_f32_16x16x32_bf16 v[164:167], a[140:143], a[208:211], v[164:167]
    buffer_load_dwordx4 v[196:199], v202, s[44:47], s75 offen offset:0 sc1
    v_mfma_f32_16x16x32_bf16 v[164:167], a[172:175], a[212:215], v[164:167]
    ds_read_b64_tr_b16 a[220:221], v204 offset:32768
    v_mfma_f32_16x16x32_bf16 v[132:135], a[172:175], a[204:207], v[132:135]
    buffer_load_dwordx4 v[212:215], v202, s[44:47], s75 offen offset:2560 sc1
    v_mfma_f32_16x16x32_bf16 v[132:135], a[140:143], a[200:203], v[132:135]
    ds_read_b64_tr_b16 a[222:223], v204 offset:33792
    v_mfma_f32_16x16x32_bf16 v[136:139], a[144:147], a[200:203], v[136:139]
    s_add_u32 s75, s6, 10240
    v_mfma_f32_16x16x32_bf16 v[136:139], a[176:179], a[204:207], v[136:139]
    ds_read_b64_tr_b16 a[228:229], v205 offset:32800
    v_mfma_f32_16x16x32_bf16 v[168:171], a[176:179], a[212:215], v[168:171]
    buffer_load_dwordx4 v[216:219], v202, s[44:47], s75 offen offset:0 sc1
    v_mfma_f32_16x16x32_bf16 v[168:171], a[144:147], a[208:211], v[168:171]
    buffer_load_dwordx4 v[220:223], v202, s[44:47], s75 offen offset:2560 sc1
    v_mfma_f32_16x16x32_bf16 v[172:175], a[148:151], a[208:211], v[172:175]
    ds_read_b64_tr_b16 a[230:231], v205 offset:33824
    v_mfma_f32_16x16x32_bf16 v[172:175], a[180:183], a[212:215], v[172:175]
    s_add_u32 s75, s6, 15360
    v_mfma_f32_16x16x32_bf16 v[140:143], a[180:183], a[204:207], v[140:143]
    ds_read_b64_tr_b16 a[224:225], v205 offset:12320
    v_mfma_f32_16x16x32_bf16 v[140:143], a[148:151], a[200:203], v[140:143]
    buffer_load_dwordx4 v[228:231], v202, s[44:47], s75 offen offset:0 sc1
    v_mfma_f32_16x16x32_bf16 v[144:147], a[152:155], a[200:203], v[144:147]
    ds_read_b64_tr_b16 a[226:227], v205 offset:13344
    v_mfma_f32_16x16x32_bf16 v[144:147], a[184:187], a[204:207], v[144:147]
    s_waitcnt vmcnt(32)
    buffer_load_dwordx4 v[232:235], v202, s[44:47], s75 offen offset:2560 sc1
    v_mfma_f32_16x16x32_bf16 v[176:179], a[184:187], a[212:215], v[176:179]
    v_lshrrev_b32 v238, 2, v254
    v_mfma_f32_16x16x32_bf16 v[176:179], a[152:155], a[208:211], v[176:179]
    buffer_load_dword v238, v238, s[44:47], s77 offen offset:512 sc1
    v_mfma_f32_16x16x32_bf16 v[180:183], a[156:159], a[208:211], v[180:183]
    s_add_u32 s28, s7, 0
    v_mfma_f32_16x16x32_bf16 v[180:183], a[188:191], a[212:215], v[180:183]
    s_add_u32 s29, s7, 147456
    v_mfma_f32_16x16x32_bf16 v[148:151], a[188:191], a[204:207], v[148:151]
    s_add_u32 s30, s7, 294912
    v_mfma_f32_16x16x32_bf16 v[148:151], a[156:159], a[200:203], v[148:151]
    s_add_u32 s31, s7, 442368
    v_mfma_f32_16x16x32_bf16 v[152:155], a[160:163], a[200:203], v[152:155]
    s_add_u32 s32, s7, 589824
    v_mfma_f32_16x16x32_bf16 v[152:155], a[192:195], a[204:207], v[152:155]
    s_add_u32 s33, s7, 737280
    v_mfma_f32_16x16x32_bf16 v[184:187], a[192:195], a[212:215], v[184:187]
    s_add_u32 s34, s7, 884736
    v_mfma_f32_16x16x32_bf16 v[184:187], a[160:163], a[208:211], v[184:187]
    s_add_u32 s35, s7, 1032192
    v_mfma_f32_16x16x32_bf16 v[188:191], a[164:167], a[208:211], v[188:191]
    v_mfma_f32_16x16x32_bf16 v[188:191], a[196:199], a[212:215], v[188:191]
    s_waitcnt vmcnt(32)
    v_accvgpr_read_b32 v247, a237
    v_mfma_f32_16x16x32_bf16 v[156:159], a[196:199], a[204:207], v[156:159]
    v_mfma_f32_16x16x32_bf16 v[156:159], a[164:167], a[200:203], v[156:159]
    s_waitcnt lgkmcnt(0)
    v_mfma_f32_16x16x32_bf16 v[28:31], a[216:219], a[164:167], v[28:31]
    ds_read_b64_tr_b16 a[200:201], v206 offset:20480
    v_mfma_f32_16x16x32_bf16 v[28:31], a[220:223], a[196:199], v[28:31]
    v_accvgpr_read_b32 v244, a238
    v_mfma_f32_16x16x32_bf16 v[60:63], a[228:231], a[196:199], v[60:63]
    v_mfma_f32_16x16x32_bf16 v[60:63], a[224:227], a[164:167], v[60:63]
    ds_read_b64_tr_b16 a[202:203], v206 offset:24064
    v_mfma_f32_16x16x32_bf16 v[56:59], a[224:227], a[160:163], v[56:59]
    v_accvgpr_read_b32 v245, a239
    v_mfma_f32_16x16x32_bf16 v[56:59], a[228:231], a[192:195], v[56:59]
    ds_read_b64_tr_b16 a[204:205], v206 offset:27648
    v_mfma_f32_16x16x32_bf16 v[24:27], a[220:223], a[192:195], v[24:27]
    v_accvgpr_read_b32 v246, a240
    v_mfma_f32_16x16x32_bf16 v[24:27], a[216:219], a[160:163], v[24:27]
    ds_read_b64_tr_b16 a[206:207], v206 offset:31232
    v_mfma_f32_16x16x32_bf16 v[20:23], a[216:219], a[156:159], v[20:23]
    v_mfma_f32_16x16x32_bf16 v[20:23], a[220:223], a[188:191], v[20:23]
    ds_read_b64_tr_b16 a[212:213], v206 offset:27680
    v_mfma_f32_16x16x32_bf16 v[52:55], a[228:231], a[188:191], v[52:55]
    s_waitcnt vmcnt(31)
    v_accvgpr_read_b32 v248, a241
    v_mfma_f32_16x16x32_bf16 v[52:55], a[224:227], a[156:159], v[52:55]
    v_mfma_f32_16x16x32_bf16 v[48:51], a[224:227], a[152:155], v[48:51]
    ds_read_b64_tr_b16 a[214:215], v206 offset:31264
    v_mfma_f32_16x16x32_bf16 v[48:51], a[228:231], a[184:187], v[48:51]
    v_accvgpr_read_b32 v250, a242
    v_mfma_f32_16x16x32_bf16 v[16:19], a[220:223], a[184:187], v[16:19]
    ds_read_b64_tr_b16 a[208:209], v206 offset:20512
    v_mfma_f32_16x16x32_bf16 v[16:19], a[216:219], a[152:155], v[16:19]
    v_accvgpr_read_b32 v251, a243
    v_mfma_f32_16x16x32_bf16 v[12:15], a[216:219], a[148:151], v[12:15]
    ds_read_b64_tr_b16 a[210:211], v206 offset:24096
    v_mfma_f32_16x16x32_bf16 v[12:15], a[220:223], a[180:183], v[12:15]
    v_mfma_f32_16x16x32_bf16 v[44:47], a[228:231], a[180:183], v[44:47]
    v_accvgpr_read_b32 v240, a244
    v_mfma_f32_16x16x32_bf16 v[44:47], a[224:227], a[148:151], v[44:47]
    v_mfma_f32_16x16x32_bf16 v[40:43], a[224:227], a[144:147], v[40:43]
    v_mfma_f32_16x16x32_bf16 v[40:43], a[228:231], a[176:179], v[40:43]
    v_accvgpr_read_b32 v241, a245
    v_mfma_f32_16x16x32_bf16 v[8:11], a[220:223], a[176:179], v[8:11]
    v_mfma_f32_16x16x32_bf16 v[8:11], a[216:219], a[144:147], v[8:11]
    v_mfma_f32_16x16x32_bf16 v[4:7], a[216:219], a[140:143], v[4:7]
    v_accvgpr_read_b32 v242, a246
    v_mfma_f32_16x16x32_bf16 v[4:7], a[220:223], a[172:175], v[4:7]
    v_mfma_f32_16x16x32_bf16 v[36:39], a[228:231], a[172:175], v[36:39]
    v_mfma_f32_16x16x32_bf16 v[36:39], a[224:227], a[140:143], v[36:39]
    v_accvgpr_read_b32 v243, a247
    v_mfma_f32_16x16x32_bf16 v[32:35], a[224:227], a[136:139], v[32:35]
    v_mfma_f32_16x16x32_bf16 v[32:35], a[228:231], a[168:171], v[32:35]
    v_mfma_f32_16x16x32_bf16 v[0:3], a[220:223], a[168:171], v[0:3]
    v_mfma_f32_16x16x32_bf16 v[0:3], a[216:219], a[136:139], v[0:3]
    s_waitcnt vmcnt(21) lgkmcnt(0)
    s_barrier
    v_mfma_f32_16x16x32_bf16 a[64:67], a[200:203], a[136:139], a[64:67]
    ds_read_b64_tr_b16 a[216:217], v206 offset:49152
    v_mfma_f32_16x16x32_bf16 a[64:67], a[204:207], a[168:171], a[64:67]
    ds_read_b64_tr_b16 a[218:219], v206 offset:52736
    v_mfma_f32_16x16x32_bf16 a[96:99], a[212:215], a[168:171], a[96:99]
    ds_read_b64_tr_b16 a[220:221], v206 offset:56320
    v_mfma_f32_16x16x32_bf16 a[96:99], a[208:211], a[136:139], a[96:99]
    ds_read_b64_tr_b16 a[222:223], v206 offset:59904
    v_mfma_f32_16x16x32_bf16 a[100:103], a[208:211], a[140:143], a[100:103]
    ds_read_b64_tr_b16 a[228:229], v206 offset:56352
    v_mfma_f32_16x16x32_bf16 a[100:103], a[212:215], a[172:175], a[100:103]
    ds_read_b64_tr_b16 a[230:231], v206 offset:59936
    v_mfma_f32_16x16x32_bf16 a[68:71], a[204:207], a[172:175], a[68:71]
    ds_read_b64_tr_b16 a[224:225], v206 offset:49184
    v_mfma_f32_16x16x32_bf16 a[68:71], a[200:203], a[140:143], a[68:71]
    ds_read_b128 a[136:139], v200 offset:32768
    v_mfma_f32_16x16x32_bf16 a[72:75], a[200:203], a[144:147], a[72:75]
    ds_read_b64_tr_b16 a[226:227], v206 offset:52768
    v_mfma_f32_16x16x32_bf16 a[72:75], a[204:207], a[176:179], a[72:75]
    ds_read_b128 a[168:171], v201 offset:32768
    v_mfma_f32_16x16x32_bf16 a[104:107], a[212:215], a[176:179], a[104:107]
    ds_read_b128 a[140:143], v200 offset:34816
    v_mfma_f32_16x16x32_bf16 a[104:107], a[208:211], a[144:147], a[104:107]
    v_mfma_f32_16x16x32_bf16 a[108:111], a[208:211], a[148:151], a[108:111]
    ds_read_b128 a[172:175], v201 offset:34816
    v_mfma_f32_16x16x32_bf16 a[108:111], a[212:215], a[180:183], a[108:111]
    v_mfma_f32_16x16x32_bf16 a[76:79], a[204:207], a[180:183], a[76:79]
    ds_read_b128 a[144:147], v200 offset:36864
    v_mfma_f32_16x16x32_bf16 a[76:79], a[200:203], a[148:151], a[76:79]
    v_mfma_f32_16x16x32_bf16 a[80:83], a[200:203], a[152:155], a[80:83]
    ds_read_b128 a[176:179], v201 offset:36864
    v_mfma_f32_16x16x32_bf16 a[80:83], a[204:207], a[184:187], a[80:83]
    v_mfma_f32_16x16x32_bf16 a[112:115], a[212:215], a[184:187], a[112:115]
    ds_read_b128 a[148:151], v200 offset:38912
    v_mfma_f32_16x16x32_bf16 a[112:115], a[208:211], a[152:155], a[112:115]
    v_mfma_f32_16x16x32_bf16 a[116:119], a[208:211], a[156:159], a[116:119]
    ds_read_b128 a[180:183], v201 offset:38912
    v_mfma_f32_16x16x32_bf16 a[116:119], a[212:215], a[188:191], a[116:119]
    v_mfma_f32_16x16x32_bf16 a[84:87], a[204:207], a[188:191], a[84:87]
    ds_read_b128 a[152:155], v200 offset:40960
    v_mfma_f32_16x16x32_bf16 a[84:87], a[200:203], a[156:159], a[84:87]
    v_mfma_f32_16x16x32_bf16 a[88:91], a[200:203], a[160:163], a[88:91]
    ds_read_b128 a[184:187], v201 offset:40960
    v_mfma_f32_16x16x32_bf16 a[88:91], a[204:207], a[192:195], a[88:91]
    v_mfma_f32_16x16x32_bf16 a[120:123], a[212:215], a[192:195], a[120:123]
    ds_read_b128 a[156:159], v200 offset:43008
    v_mfma_f32_16x16x32_bf16 a[120:123], a[208:211], a[160:163], a[120:123]
    v_mfma_f32_16x16x32_bf16 a[124:127], a[208:211], a[164:167], a[124:127]
    ds_read_b128 a[188:191], v201 offset:43008
    v_mfma_f32_16x16x32_bf16 a[124:127], a[212:215], a[196:199], a[124:127]
    v_mfma_f32_16x16x32_bf16 a[92:95], a[204:207], a[196:199], a[92:95]
    ds_read_b128 a[160:163], v200 offset:45056
    v_mfma_f32_16x16x32_bf16 a[92:95], a[200:203], a[164:167], a[92:95]
    s_waitcnt lgkmcnt(9)
    v_mfma_f32_16x16x32_bf16 a[0:3], a[216:219], a[136:139], a[0:3]
    ds_read_b128 a[192:195], v201 offset:45056
    v_mfma_f32_16x16x32_bf16 a[0:3], a[220:223], a[168:171], a[0:3]
    v_mfma_f32_16x16x32_bf16 a[32:35], a[228:231], a[168:171], a[32:35]
    ds_read_b128 a[164:167], v200 offset:47104
    v_mfma_f32_16x16x32_bf16 a[32:35], a[224:227], a[136:139], a[32:35]
    v_mfma_f32_16x16x32_bf16 a[36:39], a[224:227], a[140:143], a[36:39]
    ds_read_b128 a[196:199], v201 offset:47104
    v_mfma_f32_16x16x32_bf16 a[36:39], a[228:231], a[172:175], a[36:39]
    ds_read_b64_tr_b16 a[200:201], v204 offset:2048
    v_mfma_f32_16x16x32_bf16 a[4:7], a[220:223], a[172:175], a[4:7]
    v_mfma_f32_16x16x32_bf16 a[4:7], a[216:219], a[140:143], a[4:7]
    s_waitcnt lgkmcnt(9)
    v_mfma_f32_16x16x32_bf16 a[8:11], a[216:219], a[144:147], a[8:11]
    ds_read_b64_tr_b16 a[202:203], v204 offset:3072
    v_mfma_f32_16x16x32_bf16 a[8:11], a[220:223], a[176:179], a[8:11]
    ds_read_b64_tr_b16 a[204:205], v204 offset:8192
    v_mfma_f32_16x16x32_bf16 a[40:43], a[228:231], a[176:179], a[40:43]
    s_waitcnt vmcnt(5)
    v_mfma_f32_16x16x32_bf16 a[40:43], a[224:227], a[144:147], a[40:43]
    ds_read_b64_tr_b16 a[206:207], v204 offset:9216
    v_mfma_f32_16x16x32_bf16 a[44:47], a[224:227], a[148:151], a[44:47]
    v_min3_u32 v252, v239, v225, v227
    v_mfma_f32_16x16x32_bf16 a[44:47], a[228:231], a[180:183], a[44:47]
    ds_read_b64_tr_b16 a[212:213], v205 offset:8224
    v_mfma_f32_16x16x32_bf16 a[12:15], a[220:223], a[180:183], a[12:15]
    v_max3_u32 v253, v239, v225, v227
    v_mfma_f32_16x16x32_bf16 a[12:15], a[216:219], a[148:151], a[12:15]
    s_waitcnt lgkmcnt(9)
    v_mfma_f32_16x16x32_bf16 a[16:19], a[216:219], a[152:155], a[16:19]
    ds_read_b64_tr_b16 a[214:215], v205 offset:9248
    v_mfma_f32_16x16x32_bf16 a[16:19], a[220:223], a[184:187], a[16:19]
    ds_read_b64_tr_b16 a[208:209], v205 offset:2080
    v_mfma_f32_16x16x32_bf16 a[48:51], a[228:231], a[184:187], a[48:51]
    v_min3_u32 v252, v252, v209, v211
    v_mfma_f32_16x16x32_bf16 a[48:51], a[224:227], a[152:155], a[48:51]
    ds_read_b64_tr_b16 a[210:211], v205 offset:3104
    v_mfma_f32_16x16x32_bf16 a[52:55], a[224:227], a[156:159], a[52:55]
    v_max3_u32 v253, v253, v209, v211
    v_mfma_f32_16x16x32_bf16 a[52:55], a[228:231], a[188:191], a[52:55]
    v_min3_u32 v252, v252, v193, v195
    v_mfma_f32_16x16x32_bf16 a[20:23], a[220:223], a[188:191], a[20:23]
    v_max3_u32 v253, v253, v193, v195
    v_mfma_f32_16x16x32_bf16 a[20:23], a[216:219], a[156:159], a[20:23]
    s_waitcnt lgkmcnt(8)
    v_mfma_f32_16x16x32_bf16 a[24:27], a[216:219], a[160:163], a[24:27]
    v_add_f32 v208, v208, v192
    v_mfma_f32_16x16x32_bf16 a[24:27], a[220:223], a[192:195], a[24:27]
    v_add_f32 v210, v210, v194
    v_mfma_f32_16x16x32_bf16 a[56:59], a[228:231], a[192:195], a[56:59]
    v_min3_u32 v252, v252, v197, v199
    v_mfma_f32_16x16x32_bf16 a[56:59], a[224:227], a[160:163], a[56:59]
    v_max3_u32 v253, v253, v197, v199
    v_mfma_f32_16x16x32_bf16 a[60:63], a[224:227], a[164:167], a[60:63]
    v_add_f32 v208, v208, v196
    v_mfma_f32_16x16x32_bf16 a[60:63], a[228:231], a[196:199], a[60:63]
    v_add_f32 v210, v210, v198
    v_mfma_f32_16x16x32_bf16 a[28:31], a[220:223], a[196:199], a[28:31]
    v_min3_u32 v252, v252, v213, v215
    v_mfma_f32_16x16x32_bf16 a[28:31], a[216:219], a[164:167], a[28:31]
    s_waitcnt lgkmcnt(0)
    v_mfma_f32_16x16x32_bf16 v[92:95], a[200:203], a[164:167], v[92:95]
    v_max3_u32 v253, v253, v213, v215
    v_mfma_f32_16x16x32_bf16 v[92:95], a[204:207], a[196:199], v[92:95]
    v_add_f32 v208, v208, v212
    v_mfma_f32_16x16x32_bf16 v[124:127], a[212:215], a[196:199], v[124:127]
    v_add_f32 v210, v210, v214
    v_mfma_f32_16x16x32_bf16 v[124:127], a[208:211], a[164:167], v[124:127]
    v_mfma_f32_16x16x32_bf16 v[120:123], a[208:211], a[160:163], v[120:123]
    s_waitcnt vmcnt(1)
    v_mfma_f32_16x16x32_bf16 v[120:123], a[212:215], a[192:195], v[120:123]
    v_min3_u32 v252, v252, v217, v219
    v_mfma_f32_16x16x32_bf16 v[88:91], a[204:207], a[192:195], v[88:91]
    v_mfma_f32_16x16x32_bf16 v[88:91], a[200:203], a[160:163], v[88:91]
    v_max3_u32 v253, v253, v217, v219
    v_mfma_f32_16x16x32_bf16 v[84:87], a[200:203], a[156:159], v[84:87]
    v_mfma_f32_16x16x32_bf16 v[84:87], a[204:207], a[188:191], v[84:87]
    v_mfma_f32_16x16x32_bf16 v[116:119], a[212:215], a[188:191], v[116:119]
    v_mfma_f32_16x16x32_bf16 v[116:119], a[208:211], a[156:159], v[116:119]
    v_mfma_f32_16x16x32_bf16 v[112:115], a[208:211], a[152:155], v[112:115]
    v_mfma_f32_16x16x32_bf16 v[112:115], a[212:215], a[184:187], v[112:115]
    v_mfma_f32_16x16x32_bf16 v[80:83], a[204:207], a[184:187], v[80:83]
    v_mfma_f32_16x16x32_bf16 v[80:83], a[200:203], a[152:155], v[80:83]
    s_barrier
    v_mfma_f32_16x16x32_bf16 v[76:79], a[200:203], a[148:151], v[76:79]
    ds_read_b64_tr_b16 a[216:217], v204 offset:4096
    s_mov_b64 s[52:53], s[8:9]
    s_mov_b32 s54, 2097152
    v_mfma_f32_16x16x32_bf16 v[76:79], a[204:207], a[180:183], v[76:79]
    ds_read_b64_tr_b16 a[218:219], v204 offset:5120
    v_readlane_b32 s92, v247, 0
    v_mfma_f32_16x16x32_bf16 v[108:111], a[212:215], a[180:183], v[108:111]
    ds_read_b64_tr_b16 a[220:221], v204 offset:10240
    s_add_u32 m0, s3, 98304
    v_mfma_f32_16x16x32_bf16 v[108:111], a[208:211], a[148:151], v[108:111]
    ds_read_b64_tr_b16 a[222:223], v204 offset:11264
    buffer_load_dwordx4 v244, s[48:51], s92 offen lds
    v_mfma_f32_16x16x32_bf16 v[104:107], a[208:211], a[144:147], v[104:107]
    ds_read_b64_tr_b16 a[228:229], v205 offset:10272
    v_add_f32 v208, v208, v216
    v_mfma_f32_16x16x32_bf16 v[104:107], a[212:215], a[176:179], v[104:107]
    ds_read_b64_tr_b16 a[230:231], v205 offset:11296
    v_add_f32 v210, v210, v218
    v_mfma_f32_16x16x32_bf16 v[72:75], a[204:207], a[176:179], v[72:75]
    ds_read_b64_tr_b16 a[224:225], v205 offset:4128
    v_mfma_f32_16x16x32_bf16 v[72:75], a[200:203], a[144:147], v[72:75]
    ds_read_b64_tr_b16 a[226:227], v205 offset:5152
    v_mfma_f32_16x16x32_bf16 v[68:71], a[200:203], a[140:143], v[68:71]
    v_min3_u32 v252, v252, v221, v223
    v_mfma_f32_16x16x32_bf16 v[68:71], a[204:207], a[172:175], v[68:71]
    v_max3_u32 v253, v253, v221, v223
    v_mfma_f32_16x16x32_bf16 v[100:103], a[212:215], a[172:175], v[100:103]
    v_add_f32 v208, v208, v220
    v_mfma_f32_16x16x32_bf16 v[100:103], a[208:211], a[140:143], v[100:103]
    v_add_f32 v210, v210, v222
    v_mfma_f32_16x16x32_bf16 v[96:99], a[208:211], a[136:139], v[96:99]
    v_min3_u32 v252, v252, v229, v231
    v_mfma_f32_16x16x32_bf16 v[96:99], a[212:215], a[168:171], v[96:99]
    v_max3_u32 v253, v253, v229, v231
    v_mfma_f32_16x16x32_bf16 v[64:67], a[204:207], a[168:171], v[64:67]
    v_add_f32 v208, v208, v228
    v_mfma_f32_16x16x32_bf16 v[64:67], a[200:203], a[136:139], v[64:67]
    s_waitcnt lgkmcnt(4)
    v_mfma_f32_16x16x32_bf16 v[128:131], a[136:139], a[216:219], v[128:131]
    ds_read_b64_tr_b16 a[200:201], v204 offset:0
    v_mfma_f32_16x16x32_bf16 v[128:131], a[168:171], a[220:223], v[128:131]
    s_waitcnt lgkmcnt(1)
    v_mfma_f32_16x16x32_bf16 v[160:163], a[168:171], a[228:231], v[160:163]
    v_readlane_b32 s93, v247, 1
    v_mfma_f32_16x16x32_bf16 v[160:163], a[136:139], a[224:227], v[160:163]
    ds_read_b64_tr_b16 a[202:203], v204 offset:1024
    v_mfma_f32_16x16x32_bf16 v[164:167], a[140:143], a[224:227], v[164:167]
    v_add_f32 v210, v210, v230
    v_mfma_f32_16x16x32_bf16 v[164:167], a[172:175], a[228:231], v[164:167]
    ds_read_b64_tr_b16 a[204:205], v204 offset:6144
    v_mfma_f32_16x16x32_bf16 v[132:135], a[172:175], a[220:223], v[132:135]
    v_min3_u32 v252, v252, v233, v235
    v_mfma_f32_16x16x32_bf16 v[132:135], a[140:143], a[216:219], v[132:135]
    ds_read_b64_tr_b16 a[206:207], v204 offset:7168
    v_mfma_f32_16x16x32_bf16 v[136:139], a[144:147], a[216:219], v[136:139]
    s_add_u32 m0, s3, 100352
    v_mfma_f32_16x16x32_bf16 v[136:139], a[176:179], a[220:223], v[136:139]
    ds_read_b64_tr_b16 a[212:213], v205 offset:6176
    v_mfma_f32_16x16x32_bf16 v[168:171], a[176:179], a[228:231], v[168:171]
    v_max3_u32 v253, v253, v233, v235
    v_mfma_f32_16x16x32_bf16 v[168:171], a[144:147], a[224:227], v[168:171]
    v_add_f32 v208, v208, v232
    v_mfma_f32_16x16x32_bf16 v[172:175], a[148:151], a[224:227], v[172:175]
    ds_read_b64_tr_b16 a[214:215], v205 offset:7200
    v_mfma_f32_16x16x32_bf16 v[172:175], a[180:183], a[228:231], v[172:175]
    buffer_load_dwordx4 v245, s[48:51], s92 offen lds
    v_mfma_f32_16x16x32_bf16 v[140:143], a[180:183], a[220:223], v[140:143]
    ds_read_b64_tr_b16 a[208:209], v205 offset:32
    v_mfma_f32_16x16x32_bf16 v[140:143], a[148:151], a[216:219], v[140:143]
    v_add_f32 v210, v210, v234
    v_mfma_f32_16x16x32_bf16 v[144:147], a[152:155], a[216:219], v[144:147]
    ds_read_b64_tr_b16 a[210:211], v205 offset:1056
    v_mfma_f32_16x16x32_bf16 v[144:147], a[184:187], a[220:223], v[144:147]
    v_cmp_ne_u32 vcc, v252, v253
    s_cbranch_vccnz L_gs0
L_gb0:
    v_mfma_f32_16x16x32_bf16 v[176:179], a[184:187], a[228:231], v[176:179]
    s_add_u32 m0, s3, 106496
    v_mfma_f32_16x16x32_bf16 v[176:179], a[152:155], a[224:227], v[176:179]
    v_accvgpr_read_b32 v196, a236
    v_mfma_f32_16x16x32_bf16 v[180:183], a[156:159], a[224:227], v[180:183]
    ds_write2_b32 v196, v208, v210 offset1:1
    v_mfma_f32_16x16x32_bf16 v[180:183], a[188:191], a[228:231], v[180:183]
    buffer_load_dwordx4 v244, s[48:51], s93 offen lds
    v_mfma_f32_16x16x32_bf16 v[148:151], a[188:191], a[220:223], v[148:151]
    v_and_b32 v214, 0xffff0000, v226
    v_mfma_f32_16x16x32_bf16 v[148:151], a[156:159], a[216:219], v[148:151]
    v_rcp_f32 v216, v214
    v_mfma_f32_16x16x32_bf16 v[152:155], a[160:163], a[216:219], v[152:155]
    v_readlane_b32 s94, v247, 2
    v_mfma_f32_16x16x32_bf16 v[152:155], a[192:195], a[220:223], v[152:155]
    v_lshlrev_b32 v212, 16, v226
    v_mfma_f32_16x16x32_bf16 v[184:187], a[192:195], a[228:231], v[184:187]
    v_xor_b32 v212, 0x80000000, v212
    v_mfma_f32_16x16x32_bf16 v[184:187], a[160:163], a[224:227], v[184:187]
    s_add_u32 m0, s3, 108544
    v_mfma_f32_16x16x32_bf16 v[188:191], a[164:167], a[224:227], v[188:191]
    v_accvgpr_read_b32 v195, a235
    v_mfma_f32_16x16x32_bf16 v[188:191], a[196:199], a[228:231], v[188:191]
    ds_write2st64_b32 v195, v212, v216 offset1:5
    v_mfma_f32_16x16x32_bf16 v[156:159], a[196:199], a[220:223], v[156:159]
    buffer_load_dwordx4 v245, s[48:51], s93 offen lds
    v_mfma_f32_16x16x32_bf16 v[156:159], a[164:167], a[216:219], v[156:159]
    s_waitcnt lgkmcnt(2)
    v_mfma_f32_16x16x32_bf16 v[28:31], a[200:203], a[164:167], v[28:31]
    ds_read_b64_tr_b16 a[216:217], v206 offset:0
    v_mfma_f32_16x16x32_bf16 v[28:31], a[204:207], a[196:199], v[28:31]
    v_mul_f32 v213, 3216550459, v216
    v_mfma_f32_16x16x32_bf16 v[60:63], a[212:215], a[196:199], v[60:63]
    v_mul_f32 v215, 1057048658, v216
    v_mfma_f32_16x16x32_bf16 v[60:63], a[208:211], a[164:167], v[60:63]
    ds_read_b64_tr_b16 a[218:219], v206 offset:3584
    v_mfma_f32_16x16x32_bf16 v[56:59], a[208:211], a[160:163], v[56:59]
    s_add_u32 m0, s3, 114688
    v_mfma_f32_16x16x32_bf16 v[56:59], a[212:215], a[192:195], v[56:59]
    ds_read_b64_tr_b16 a[220:221], v206 offset:7168
    v_mfma_f32_16x16x32_bf16 v[24:27], a[204:207], a[192:195], v[24:27]
    v_accvgpr_read_b32 v194, a234
    v_mfma_f32_16x16x32_bf16 v[24:27], a[200:203], a[160:163], v[24:27]
    ds_read_b64_tr_b16 a[222:223], v206 offset:10752
    v_mfma_f32_16x16x32_bf16 v[20:23], a[200:203], a[156:159], v[20:23]
    ds_write_b128 v194, v[212:215]
    v_mfma_f32_16x16x32_bf16 v[20:23], a[204:207], a[188:191], v[20:23]
    ds_read_b64_tr_b16 a[228:229], v206 offset:7200
    v_mfma_f32_16x16x32_bf16 v[52:55], a[212:215], a[188:191], v[52:55]
    v_and_b32 v230, 0xffff0000, v224
    v_mfma_f32_16x16x32_bf16 v[52:55], a[208:211], a[156:159], v[52:55]
    buffer_load_dwordx4 v244, s[48:51], s94 offen lds
    v_mfma_f32_16x16x32_bf16 v[48:51], a[208:211], a[152:155], v[48:51]
    ds_read_b64_tr_b16 a[230:231], v206 offset:10784
    v_mfma_f32_16x16x32_bf16 v[48:51], a[212:215], a[184:187], v[48:51]
    v_rcp_f32 v232, v230
    v_mfma_f32_16x16x32_bf16 v[16:19], a[204:207], a[184:187], v[16:19]
    ds_read_b64_tr_b16 a[224:225], v206 offset:32
    v_mfma_f32_16x16x32_bf16 v[16:19], a[200:203], a[152:155], v[16:19]
    v_lshlrev_b32 v228, 16, v224
    v_mfma_f32_16x16x32_bf16 v[12:15], a[200:203], a[148:151], v[12:15]
    ds_read_b64_tr_b16 a[226:227], v206 offset:3616
    v_mfma_f32_16x16x32_bf16 v[12:15], a[204:207], a[180:183], v[12:15]
    v_readlane_b32 s95, v247, 3
    v_mfma_f32_16x16x32_bf16 v[44:47], a[212:215], a[180:183], v[44:47]
    v_xor_b32 v228, 0x80000000, v228
    v_mfma_f32_16x16x32_bf16 v[44:47], a[208:211], a[148:151], v[44:47]
    v_accvgpr_read_b32 v193, a233
    v_mfma_f32_16x16x32_bf16 v[40:43], a[208:211], a[144:147], v[40:43]
    s_add_u32 m0, s3, 116736
    v_mfma_f32_16x16x32_bf16 v[40:43], a[212:215], a[176:179], v[40:43]
    ds_write2st64_b32 v193, v228, v232 offset1:5
    v_mfma_f32_16x16x32_bf16 v[8:11], a[204:207], a[176:179], v[8:11]
    v_mul_f32 v229, 3216550459, v232
    v_mfma_f32_16x16x32_bf16 v[8:11], a[200:203], a[144:147], v[8:11]
    buffer_load_dwordx4 v245, s[48:51], s94 offen lds
    v_mfma_f32_16x16x32_bf16 v[4:7], a[200:203], a[140:143], v[4:7]
    v_mul_f32 v231, 1057048658, v232
    v_mfma_f32_16x16x32_bf16 v[4:7], a[204:207], a[172:175], v[4:7]
    v_accvgpr_read_b32 v192, a232
    v_mfma_f32_16x16x32_bf16 v[36:39], a[212:215], a[172:175], v[36:39]
    s_add_u32 m0, s3, 122880
    v_mfma_f32_16x16x32_bf16 v[36:39], a[208:211], a[140:143], v[36:39]
    ds_write_b128 v192, v[228:231]
    v_mfma_f32_16x16x32_bf16 v[32:35], a[208:211], a[136:139], v[32:35]
    buffer_load_dwordx4 v244, s[52:55], s95 offen lds
    v_mfma_f32_16x16x32_bf16 v[32:35], a[212:215], a[168:171], v[32:35]
    s_getreg_b32 s72, hwreg(HW_REG_XCC_ID, 0, 4)
    s_add_u32 s72, s72, 1
    s_waitcnt vmcnt(7)
    v_subrev_u32 v238, s72, v238
    v_mfma_f32_16x16x32_bf16 v[0:3], a[204:207], a[168:171], v[0:3]
    v_cmp_eq_u32 vcc, v239, v238
    s_nop 1
    s_and_b32 s78, vcc_lo, 0xff
    s_xor_b32 s78, s78, 0xff
    v_mfma_f32_16x16x32_bf16 v[0:3], a[200:203], a[136:139], v[0:3]
    s_waitcnt lgkmcnt(2)
    v_mfma_f32_16x16x32_bf16 a[64:67], a[216:219], a[136:139], a[64:67]
    v_accvgpr_read_b32 v252, a248
    v_mfma_f32_16x16x32_bf16 a[64:67], a[220:223], a[168:171], a[64:67]
    v_readlane_b32 s92, v247, 4
    v_mfma_f32_16x16x32_bf16 a[96:99], a[228:231], a[168:171], a[96:99]
    v_accvgpr_read_b32 v253, a249
    v_mfma_f32_16x16x32_bf16 a[96:99], a[224:227], a[136:139], a[96:99]
    v_accvgpr_read_b32 v232, a250
    v_mfma_f32_16x16x32_bf16 a[100:103], a[224:227], a[140:143], a[100:103]
    v_accvgpr_read_b32 v233, a251
    v_mfma_f32_16x16x32_bf16 a[100:103], a[228:231], a[172:175], a[100:103]
    s_add_u32 m0, s3, 124928
    v_mfma_f32_16x16x32_bf16 a[68:71], a[220:223], a[172:175], a[68:71]
    v_xor_b32 v249, 0x80, v250
    v_mfma_f32_16x16x32_bf16 a[68:71], a[216:219], a[140:143], a[68:71]
    v_xor_b32 v234, 0x80, v251
    v_mfma_f32_16x16x32_bf16 a[72:75], a[216:219], a[144:147], a[72:75]
    v_xor_b32 v235, 0x80, v252
    v_mfma_f32_16x16x32_bf16 a[72:75], a[220:223], a[176:179], a[72:75]
    buffer_load_dwordx4 v245, s[52:55], s95 offen lds
    v_mfma_f32_16x16x32_bf16 a[104:107], a[228:231], a[176:179], a[104:107]
    v_xor_b32 v236, 0x80, v253
    v_mfma_f32_16x16x32_bf16 a[104:107], a[224:227], a[144:147], a[104:107]
    s_lshl_b32 s84, s69, 11
    s_add_u32 s84, s84, 154624
    v_and_b32 v237, 0xf0, v254
    v_mfma_f32_16x16x32_bf16 a[108:111], a[224:227], a[148:151], a[108:111]
    v_add_u32 v237, s84, v237
    v_mfma_f32_16x16x32_bf16 a[108:111], a[228:231], a[180:183], a[108:111]
    s_add_u32 m0, s3, 131072
    v_mfma_f32_16x16x32_bf16 a[76:79], a[220:223], a[180:183], a[76:79]
    v_lshrrev_b32 v238, 8, v254
    v_mfma_f32_16x16x32_bf16 a[76:79], a[216:219], a[148:151], a[76:79]
    v_lshlrev_b32 v238, 4, v238
    v_mfma_f32_16x16x32_bf16 a[80:83], a[216:219], a[152:155], a[80:83]
    v_add_u32 v238, 158976, v238
    v_mfma_f32_16x16x32_bf16 a[80:83], a[220:223], a[184:187], a[80:83]
    buffer_load_dwordx4 v244, s[48:51], s92 offen lds
    v_mfma_f32_16x16x32_bf16 a[112:115], a[228:231], a[184:187], a[112:115]
    s_waitcnt lgkmcnt(0)
    s_barrier
    v_mfma_f32_16x16x32_bf16 a[112:115], a[224:227], a[152:155], a[112:115]
    v_readlane_b32 s93, v247, 5
    v_mfma_f32_16x16x32_bf16 a[116:119], a[224:227], a[156:159], a[116:119]
    ds_read_b128 v[208:211], v238 offset:2752
    v_mfma_f32_16x16x32_bf16 a[116:119], a[228:231], a[188:191], a[116:119]
    s_add_u32 m0, s3, 133120
    v_mfma_f32_16x16x32_bf16 a[84:87], a[220:223], a[188:191], a[84:87]
    ds_read_b128 v[212:215], v238 offset:2816
    v_mfma_f32_16x16x32_bf16 a[84:87], a[216:219], a[156:159], a[84:87]
    buffer_load_dwordx4 v245, s[48:51], s92 offen lds
    v_mfma_f32_16x16x32_bf16 a[88:91], a[216:219], a[160:163], a[88:91]
    ds_read_b128 v[216:219], v238 offset:2880
    v_mfma_f32_16x16x32_bf16 a[88:91], a[220:223], a[192:195], a[88:91]
    s_add_u32 m0, s3, 139264
    v_mfma_f32_16x16x32_bf16 a[120:123], a[228:231], a[192:195], a[120:123]
    ds_read_b128 v[220:223], v238 offset:2944
    v_mfma_f32_16x16x32_bf16 a[120:123], a[224:227], a[160:163], a[120:123]
    buffer_load_dwordx4 v244, s[48:51], s93 offen lds
    v_mfma_f32_16x16x32_bf16 a[124:127], a[224:227], a[164:167], a[124:127]
    ds_read_b128 v[224:227], v237 offset:256
    v_mfma_f32_16x16x32_bf16 a[124:127], a[228:231], a[196:199], a[124:127]
    s_add_u32 m0, s3, 141312
    v_mfma_f32_16x16x32_bf16 a[92:95], a[220:223], a[196:199], a[92:95]
    ds_read_b128 v[228:231], v237 offset:512
    v_mfma_f32_16x16x32_bf16 a[92:95], a[216:219], a[164:167], a[92:95]
    buffer_load_dwordx4 v245, s[48:51], s93 offen lds
    s_branch L_epi0
L_w1:
    s_mov_b64 s[24:25], s[4:5]
    s_mov_b32 s60, s20
    s_mov_b32 s61, s21
    s_mov_b32 s62, 256
    s_mov_b32 s63, 0x20000
    s_mov_b64 s[0:1], s[82:83]
    v_mov_b32 v197, v213
    s_add_u32 s73, s72, 65536
    s_add_u32 s72, s72, 32896
    v_add_u32 v208, 256, v214
    v_mul_u32_u24 v209, 4682, v208
    v_lshrrev_b32 v209, 16, v209
    v_mul_u32_u24 v210, 14, v209
    v_sub_u32 v210, v208, v210
    v_lshlrev_b32 v192, 4, v210
    v_bfe_u32 v210, v209, 2, 2
    v_lshlrev_b32 v210, 3, v210
    v_lshrrev_b32 v211, 4, v209
    v_lshl_add_u32 v210, v211, 2, v210
    v_and_b32 v211, 3, v209
    v_add_u32 v210, v210, v211
    v_mul_u32_u24 v210, 7168, v210
    v_add_u32 v192, v192, v210
    v_add_u32 v208, 320, v214
    v_mul_u32_u24 v209, 4682, v208
    v_lshrrev_b32 v209, 16, v209
    v_mul_u32_u24 v210, 14, v209
    v_sub_u32 v210, v208, v210
    v_lshlrev_b32 v193, 4, v210
    v_bfe_u32 v210, v209, 2, 2
    v_lshlrev_b32 v210, 3, v210
    v_lshrrev_b32 v211, 4, v209
    v_lshl_add_u32 v210, v211, 2, v210
    v_and_b32 v211, 3, v209
    v_add_u32 v210, v210, v211
    v_mul_u32_u24 v210, 7168, v210
    v_add_u32 v193, v193, v210
    v_add_u32 v208, 384, v214
    v_mul_u32_u24 v209, 4682, v208
    v_lshrrev_b32 v209, 16, v209
    v_mul_u32_u24 v210, 14, v209
    v_sub_u32 v210, v208, v210
    v_lshlrev_b32 v194, 4, v210
    v_bfe_u32 v210, v209, 2, 2
    v_lshlrev_b32 v210, 3, v210
    v_lshrrev_b32 v211, 4, v209
    v_lshl_add_u32 v210, v211, 2, v210
    v_and_b32 v211, 3, v209
    v_add_u32 v210, v210, v211
    v_mul_u32_u24 v210, 7168, v210
    v_add_u32 v194, v194, v210
    s_mov_b32 s32, s12
    s_mov_b32 s33, s13
    s_mov_b32 s34, 7340032
    s_mov_b32 s35, 0x20000
    s_mov_b32 s36, s14
    s_mov_b32 s37, s15
    s_mov_b32 s38, 7340032
    s_mov_b32 s39, 0x20000
    s_mov_b32 m0, 122880
    s_nop 0
    buffer_load_dwordx4 v192, s[32:35], s75 offen lds
    s_mov_b32 m0, 123904
    s_nop 0
    buffer_load_dwordx4 v193, s[32:35], s75 offen lds
    s_mov_b32 m0, 124928
    s_nop 0
    buffer_load_dwordx4 v194, s[32:35], s75 offen lds
    s_add_u32 s75, s75, 229376
    s_mov_b32 m0, 130048
    s_nop 0
    buffer_load_dwordx4 v192, s[32:35], s75 offen lds
    s_mov_b32 m0, 131072
    s_nop 0
    buffer_load_dwordx4 v193, s[32:35], s75 offen lds
    s_mov_b32 m0, 132096
    s_nop 0
    buffer_load_dwordx4 v194, s[32:35], s75 offen lds
    s_sub_u32 s75, s75, 229376
    s_mov_b32 m0, 4096
    s_nop 0
    buffer_load_dwordx4 v198, s[24:27], s73 offen lds
    s_mov_b32 m0, 5120
    s_nop 0
    buffer_load_dwordx4 v199, s[24:27], s73 offen lds
    s_add_u32 s73, s73, 32768
    s_mov_b32 m0, 6144
    s_nop 0
    buffer_load_dwordx4 v198, s[24:27], s73 offen lds
    s_mov_b32 m0, 7168
    s_nop 0
    buffer_load_dwordx4 v199, s[24:27], s73 offen lds
    s_add_u32 s73, s73, 32768
    s_mov_b32 m0, 8192
    s_nop 0
    buffer_load_dwordx4 v198, s[24:27], s73 offen lds
    s_mov_b32 m0, 9216
    s_nop 0
    buffer_load_dwordx4 v199, s[24:27], s73 offen lds
    s_add_u32 s73, s73, 4294901888
    s_add_u32 s44, s22, 100663296
    s_addc_u32 s45, s23, 0
    s_mov_b32 s46, 2822144
    s_mov_b32 s47, 0x20000
    s_add_u32 s40, s22, 4194304
    s_addc_u32 s41, s23, 0
    s_mov_b32 s42, 18874368
    s_mov_b32 s43, 0x20000
    s_lshl_b32 s79, s65, 3
    s_add_u32 s79, s79, s67
    s_lshl_b32 s77, s65, 2
    s_add_u32 s77, s77, s66
    s_lshl_b32 s77, s77, 10
    v_lshrrev_b32 v208, 4, v214
    v_bfe_u32 v209, v214, 3, 1
    v_xor_b32 v209, v209, v214
    v_xor_b32 v209, v209, v208
    v_and_b32 v209, 7, v209
    v_lshlrev_b32 v209, 4, v209
    v_and_b32 v210, 15, v214
    v_lshl_add_u32 v209, v210, 7, v209
    v_add_u32 v200, 16384, v209
    v_xor_b32 v201, 64, v200
    v_bfe_u32 v209, v214, 2, 2
    v_lshl_add_u32 v209, v208, 2, v209
    v_and_b32 v210, 3, v214
    v_lshlrev_b32 v210, 3, v210
    v_mul_u32_u24 v211, 224, v209
    v_add_u32 v211, v211, v210
    v_lshlrev_b32 v204, 6, v209
    v_add_u32 v204, v204, v210
    v_add_u32 v204, 65536, v204
    v_and_b32 v208, 1, v208
    v_lshlrev_b32 v208, 5, v208
    v_sub_u32 v205, v204, v208
    v_add_u32 v204, v204, v208
    s_mul_i32 s84, s71, 160
    s_add_u32 s84, s84, 83968
    v_add_u32 v206, s84, v211
    v_mov_b32 v228, 0x3f803f80
    v_accvgpr_write_b32 a128, -1
    v_mov_b32 v229, 0x3f803f80
    v_accvgpr_write_b32 a129, -1
    v_mov_b32 v230, 0x3f803f80
    v_accvgpr_write_b32 a130, -1
    v_mov_b32 v231, 0x3f803f80
    v_accvgpr_write_b32 a131, -1
    s_lshl_b32 s88, s65, 5
    s_add_u32 s88, s88, s68
    s_lshl_b32 s88, s88, 2
    s_add_u32 s88, s88, 1
    s_lshl_b32 s92, s88, 12
    v_lshrrev_b32 v252, 5, v214
    v_and_b32 v238, 0x1f0, v254
    v_lshl_add_u32 v238, v252, 11, v238
    v_lshlrev_b32 v207, 3, v252
    v_and_b32 v252, 31, v214
    v_cmp_eq_u32 vcc, 0, v252
    s_nop 1
    v_cndmask_b32 v207, 2.0, v207, vcc
    s_lshl_b32 s88, s88, 4
    s_add_u32 s88, s88, 32768
    s_add_u32 s80, s80, 1
    s_cmp_eq_u32 s65, 0
    s_cselect_b32 s80, 0, s80
    s_sub_u32 s82, s80, 1
    s_cmp_lt_u32 s65, 4
    s_cselect_b32 s81, 63, 1
    s_mov_b32 s83, 3
    s_mov_b32 s76, 0
    s_mov_b32 m0, 108544
    s_nop 0
    buffer_load_dwordx4 v192, s[36:39], s75 offen lds
    s_mov_b32 m0, 109568
    s_nop 0
    buffer_load_dwordx4 v193, s[36:39], s75 offen lds
    s_mov_b32 m0, 110592
    s_nop 0
    buffer_load_dwordx4 v194, s[36:39], s75 offen lds
    s_add_u32 s75, s75, 229376
    s_mov_b32 m0, 115712
    s_nop 0
    buffer_load_dwordx4 v192, s[36:39], s75 offen lds
    s_mov_b32 m0, 116736
    s_nop 0
    buffer_load_dwordx4 v193, s[36:39], s75 offen lds
    s_mov_b32 m0, 117760
    s_nop 0
    buffer_load_dwordx4 v194, s[36:39], s75 offen lds
    s_add_u32 s75, s75, 229376
    s_bfm_b64 exec, 28, 28
    buffer_load_dword v236, v197, s[52:55], s90 offen
    s_mov_b64 exec, -1
    s_mov_b32 s56, s18
    s_mov_b32 s57, s19
    s_mov_b32 s58, 4194304
    s_mov_b32 s59, 0x20000
    s_mov_b32 s48, s16
    s_mov_b32 s49, s17
    s_mov_b32 s50, 7340032
    s_mov_b32 s51, 0x20000
    v_lshrrev_b32 v213, 4, v254
    v_and_b32 v211, 15, v213
    v_lshrrev_b32 v212, 4, v213
    v_subrev_u32 v208, 2, v213
    v_subrev_u32 v209, 16, v213
    v_cmp_le_u32 vcc, 18, v213
    s_nop 1
    v_cndmask_b32 v208, v208, v209, vcc
    v_cndmask_b32 v209, 0, 2, vcc
    v_lshrrev_b32 v208, 1, v208
    v_and_b32 v210, 1, v213
    v_add_u32 v209, v209, v210
    v_subrev_u32 v210, 17, v213
    v_cmp_le_u32 vcc, 18, v213
    s_nop 1
    v_cndmask_b32 v208, v208, v210, vcc
    v_cndmask_b32 v209, v209, 2, vcc
    v_cmp_le_u32 vcc, 25, v213
    s_nop 1
    v_cndmask_b32 v208, v208, v213, vcc
    v_cndmask_b32 v209, v209, 3, vcc
    v_cmp_gt_u32 vcc, 4, v213
    s_nop 1
    v_cndmask_b32 v208, v208, 0, vcc
    v_cndmask_b32 v209, v209, v213, vcc
    v_add_u32 v208, s67, v208
    v_and_b32 v208, 7, v208
    v_and_b32 v210, 1, v208
    v_lshl_add_u32 v209, v210, 2, v209
    v_lshlrev_b32 v209, 2, v209
    s_mov_b32 s84, 0x86750312
    v_lshrrev_b32 v209, v209, s84
    v_and_b32 v209, 15, v209
    v_lshrrev_b32 v208, 1, v208
    v_and_b32 v210, 3, v213
    v_cmp_le_u32 vcc, 32, v213
    s_nop 1
    v_cndmask_b32 v208, v208, v210, vcc
    v_cndmask_b32 v209, v209, 4, vcc
    s_lshl_b32 s84, s66, 2
    v_add_u32 v208, s84, v208
    v_mad_u32_u24 v246, v208, 9, v209
    v_lshlrev_b32 v246, 10, v246
    v_mul_u32_u24 v247, 224, v208
    v_lshl_add_u32 v247, v209, 5, v247
    v_subrev_u32 v247, 32, v247
    v_lshlrev_b32 v247, 11, v247
    v_lshrrev_b32 v210, 3, v209
    v_lshl_add_u32 v210, v208, 1, v210
    v_lshlrev_b32 v210, 16, v210
    v_and_b32 v209, 7, v209
    v_cmp_eq_u32 vcc, 0, v209
    s_nop 1
    v_cndmask_b32 v247, v247, v210, vcc
    s_sub_u32 s84, s69, s70
    s_mul_i32 s84, s84, 24576
    v_add_u32 v210, s84, v247
    v_cmp_le_u32 vcc, 32, v213
    s_nop 1
    v_cndmask_b32 v247, v247, v210, vcc
    v_accvgpr_write_b32 a240, v246
    v_accvgpr_write_b32 a237, v247
    s_lshl_b32 s85, s70, 2
    s_add_u32 s85, s85, s69
    s_lshl_b32 s84, s85, 2
    v_add_u32 v208, s84, v212
    v_lshrrev_b32 v209, 1, v213
    v_xor_b32 v209, v209, v208
    v_and_b32 v209, 7, v209
    v_and_b32 v210, 1, v213
    v_lshlrev_b32 v210, 4, v210
    v_lshl_add_u32 v244, v209, 5, v210
    v_lshl_add_u32 v244, v208, 11, v244
    s_lshl_b32 s84, s67, 8
    v_add_u32 v244, s84, v244
    v_add_u32 v245, 16384, v244
    v_accvgpr_write_b32 a238, v244
    v_accvgpr_write_b32 a239, v245
    s_lshl_b32 s3, s85, 10
    s_lshl_b32 s84, s69, 13
    v_add_u32 v208, s84, v254
    v_accvgpr_write_b32 a251, v208
    s_lshl_b32 s84, s65, 1
    s_add_u32 s84, s84, s69
    s_mul_i32 s84, s84, 1179648
    s_lshr_b32 s85, s67, 1
    s_mul_i32 s85, s85, 9
    s_mul_i32 s86, s66, 36
    s_add_u32 s85, s85, s86
    s_lshl_b32 s85, s85, 10
    s_add_u32 s84, s84, s85
    s_mul_i32 s86, s71, 6144
    s_add_u32 s7, s86, s84
    s_lshl_b32 s86, s71, 11
    v_add_u32 v208, s86, v254
    v_accvgpr_write_b32 a250, v208
    s_lshl_b32 s84, s65, 2
    s_add_u32 s84, s84, s64
    s_mul_i32 s84, s84, 589824
    v_add_u32 v208, s84, v254
    v_accvgpr_write_b32 a244, v208
    v_add_u32 v209, 147456, v208
    v_accvgpr_write_b32 a245, v209
    v_add_u32 v209, 294912, v208
    v_accvgpr_write_b32 a246, v209
    v_add_u32 v209, 442368, v208
    v_accvgpr_write_b32 a247, v209
    s_lshl_b32 s84, s64, 12
    v_add_u32 v208, s84, v254
    v_accvgpr_write_b32 a241, v208
    v_bfe_u32 v209, v213, 2, 2
    v_lshl_add_u32 v209, v212, 2, v209
    v_and_b32 v210, 3, v213
    v_lshlrev_b32 v210, 3, v210
    v_lshl_add_u32 v210, v209, 8, v210
    v_add_u32 v210, 81920, v210
    v_and_b32 v209, 7, v209
    v_lshl_add_u32 v210, v209, 5, v210
    s_lshl_b32 s84, s66, 6
    s_add_u32 s85, s84, 64
    s_and_b32 s85, s85, 0xc0
    v_xor_b32 v208, s84, v210
    v_accvgpr_write_b32 a242, v208
    v_xor_b32 v208, 32, v208
    v_accvgpr_write_b32 a243, v208
    v_xor_b32 v208, s85, v210
    v_accvgpr_write_b32 a248, v208
    v_xor_b32 v208, 32, v208
    v_accvgpr_write_b32 a249, v208
    s_lshl_b32 s10, s67, 2
    s_lshl_b32 s11, 15, s10
    s_add_u32 s10, s10, s64
    s_lshl_b32 s10, s10, 2
    s_add_u32 s10, s10, s77
    v_lshrrev_b32 v208, 1, v213
    v_lshlrev_b32 v208, 11, v208
    v_and_b32 v209, 1, v213
    v_lshl_add_u32 v208, v209, 7, v208
    s_lshl_b32 s84, s67, 8
    v_add_u32 v208, s84, v208
    v_accvgpr_write_b32 a252, v208
    s_and_b32 s13, s65, 3
    s_lshl_b32 s84, s64, 2
    s_add_u32 s13, s13, s84
    s_add_u32 s13, s13, 6
    v_lshrrev_b32 v208, 3, v213
    v_mul_u32_u24 v208, 147456, v208
    v_and_b32 v209, 7, v213
    v_lshl_add_u32 v208, v209, 7, v208
    v_accvgpr_write_b32 a253, v208
    s_lshl_b32 s4, s65, 2
    s_add_u32 s4, s4, s64
    s_lshl_b32 s4, s4, 9
    s_add_u32 s4, s4, 32768
    s_lshl_b32 s5, s65, 11
    s_sub_u32 s5, s5, 128
    s_max_i32 s5, s5, 0
    s_add_u32 s5, s5, 32768
    s_mul_i32 s6, s68, 20480
    s_mul_i32 s84, s64, 640
    s_add_u32 s6, s6, s84
    s_add_u32 s6, s6, 65536
    s_lshl_b32 s12, s68, 4
    s_add_u32 s12, s12, s65
    s_lshl_b32 s12, s12, 12
    s_add_u32 s12, s12, 729088
    s_lshl_b32 s84, s64, 10
    s_add_u32 s84, s84, 154880
    v_add_u32 v208, s84, v254
    v_accvgpr_write_b32 a232, v208
    s_lshl_b32 s84, s64, 8
    s_add_u32 s84, s84, 159040
    v_lshl_add_u32 v208, v213, 2, s84
    v_accvgpr_write_b32 a233, v208
    s_mov_b32 s84, 154624
    v_lshl_add_u32 v208, v211, 4, s84
    v_accvgpr_write_b32 a234, v208
    s_mov_b32 s84, 158976
    v_lshl_add_u32 v208, v211, 2, s84
    v_accvgpr_write_b32 a235, v208
    s_mul_i32 s84, s64, 320
    s_add_u32 s84, s84, 161344
    v_min_u32 v208, 39, v213
    v_lshl_add_u32 v208, v208, 3, s84
    v_accvgpr_write_b32 a236, v208
    s_cmp_eq_u32 s80, 0
    s_cselect_b64 vcc, -1, 0
    s_waitcnt vmcnt(7)
    s_barrier
    ds_read_b64_tr_b16 a[200:201], v206 offset:34816
    ds_read_b64_tr_b16 a[202:203], v206 offset:38400
    ds_read_b128 a[136:139], v200 offset:0
    ds_read_b64_tr_b16 a[204:205], v206 offset:41984
    ds_read_b64_tr_b16 a[206:207], v206 offset:45568
    ds_read_b128 a[168:171], v201 offset:0
    ds_read_b64_tr_b16 a[212:213], v206 offset:42016
    ds_read_b64_tr_b16 a[214:215], v206 offset:45600
    ds_read_b64_tr_b16 a[208:209], v206 offset:34848
    ds_read_b64_tr_b16 a[210:211], v206 offset:38432
    ds_read_b128 a[140:143], v200 offset:2048
    ds_read_b128 a[172:175], v201 offset:2048
    ds_read_b128 a[144:147], v200 offset:4096
    ds_read_b128 a[176:179], v201 offset:4096
    ds_read_b128 a[148:151], v200 offset:6144
    ds_read_b128 a[180:183], v201 offset:6144
    ds_read_b128 a[152:155], v200 offset:8192
    ds_read_b128 a[184:187], v201 offset:8192
    ds_read_b128 a[156:159], v200 offset:10240
    ds_read_b128 a[188:191], v201 offset:10240
    ds_read_b128 a[160:163], v200 offset:12288
    ds_read_b128 a[192:195], v201 offset:12288
    ds_read_b128 a[164:167], v200 offset:14336
    ds_read_b128 a[196:199], v201 offset:14336
    s_add_u32 s84, s90, 917504
    s_bfm_b64 exec, 28, 0
    buffer_load_dword v236, v197, s[52:55], s84 offen
    s_mov_b64 exec, -1
    s_waitcnt lgkmcnt(15)
    v_mfma_f32_16x16x32_bf16 a[0:3], a[200:203], a[136:139], 0
    s_mov_b32 m0, 34816
    v_mfma_f32_16x16x32_bf16 a[0:3], a[204:207], a[168:171], a[0:3]
    v_mfma_f32_16x16x32_bf16 a[32:35], a[212:215], a[168:171], 0
    buffer_load_dwordx4 v198, s[24:27], s72 offen lds
    s_waitcnt lgkmcnt(14)
    v_mfma_f32_16x16x32_bf16 a[32:35], a[208:211], a[136:139], a[32:35]
    s_waitcnt lgkmcnt(13)
    v_mfma_f32_16x16x32_bf16 a[36:39], a[208:211], a[140:143], 0
    s_mov_b32 m0, 35840
    s_waitcnt lgkmcnt(12)
    v_mfma_f32_16x16x32_bf16 a[36:39], a[212:215], a[172:175], a[36:39]
    ds_read_b64_tr_b16 a[216:217], v204 offset:14336
    v_mfma_f32_16x16x32_bf16 a[4:7], a[204:207], a[172:175], 0
    buffer_load_dwordx4 v199, s[24:27], s72 offen lds
    v_mfma_f32_16x16x32_bf16 a[4:7], a[200:203], a[140:143], a[4:7]
    s_waitcnt lgkmcnt(9)
    v_mfma_f32_16x16x32_bf16 a[8:11], a[200:203], a[144:147], 0
    s_add_u32 s72, s72, 32768
    v_mfma_f32_16x16x32_bf16 a[8:11], a[204:207], a[176:179], a[8:11]
    ds_read_b64_tr_b16 a[218:219], v204 offset:15360
    v_mfma_f32_16x16x32_bf16 a[40:43], a[212:215], a[176:179], 0
    s_mov_b32 m0, 36864
    v_mfma_f32_16x16x32_bf16 a[40:43], a[208:211], a[144:147], a[40:43]
    ds_read_b64_tr_b16 a[220:221], v204 offset:34816
    v_mfma_f32_16x16x32_bf16 a[44:47], a[208:211], a[148:151], 0
    buffer_load_dwordx4 v198, s[24:27], s72 offen lds
    v_mfma_f32_16x16x32_bf16 a[44:47], a[212:215], a[180:183], a[44:47]
    ds_read_b64_tr_b16 a[222:223], v204 offset:35840
    v_mfma_f32_16x16x32_bf16 a[12:15], a[204:207], a[180:183], 0
    s_mov_b32 m0, 37888
    v_mfma_f32_16x16x32_bf16 a[12:15], a[200:203], a[148:151], a[12:15]
    s_waitcnt lgkmcnt(8)
    v_mfma_f32_16x16x32_bf16 a[16:19], a[200:203], a[152:155], 0
    ds_read_b64_tr_b16 a[228:229], v205 offset:34848
    v_mfma_f32_16x16x32_bf16 a[16:19], a[204:207], a[184:187], a[16:19]
    buffer_load_dwordx4 v199, s[24:27], s72 offen lds
    v_mfma_f32_16x16x32_bf16 a[48:51], a[212:215], a[184:187], 0
    ds_read_b64_tr_b16 a[230:231], v205 offset:35872
    v_mfma_f32_16x16x32_bf16 a[48:51], a[208:211], a[152:155], a[48:51]
    s_add_u32 s72, s72, 4294934656
    v_mfma_f32_16x16x32_bf16 a[52:55], a[208:211], a[156:159], 0
    s_mov_b32 m0, 137216
    v_mfma_f32_16x16x32_bf16 a[52:55], a[212:215], a[188:191], a[52:55]
    ds_read_b64_tr_b16 a[224:225], v205 offset:14368
    v_mfma_f32_16x16x32_bf16 a[20:23], a[204:207], a[188:191], 0
    buffer_load_dwordx4 v192, s[32:35], s75 offen lds
    v_mfma_f32_16x16x32_bf16 a[20:23], a[200:203], a[156:159], a[20:23]
    s_waitcnt lgkmcnt(7)
    v_mfma_f32_16x16x32_bf16 a[24:27], a[200:203], a[160:163], 0
    ds_read_b64_tr_b16 a[226:227], v205 offset:15392
    v_mfma_f32_16x16x32_bf16 a[24:27], a[204:207], a[192:195], a[24:27]
    s_mov_b32 m0, 138240
    v_mfma_f32_16x16x32_bf16 a[56:59], a[212:215], a[192:195], 0
    buffer_load_dwordx4 v193, s[32:35], s75 offen lds
    v_mfma_f32_16x16x32_bf16 a[56:59], a[208:211], a[160:163], a[56:59]
    s_mov_b32 m0, 139264
    v_mfma_f32_16x16x32_bf16 a[60:63], a[208:211], a[164:167], 0
    buffer_load_dwordx4 v194, s[32:35], s75 offen lds
    v_mfma_f32_16x16x32_bf16 a[60:63], a[212:215], a[196:199], a[60:63]
    s_add_u32 s75, s75, 229376
    v_mfma_f32_16x16x32_bf16 a[28:31], a[204:207], a[196:199], 0
    s_cbranch_vccnz L_skp1_00
L_sbp1_00:
    v_mfma_f32_16x16x32_bf16 a[28:31], a[200:203], a[164:167], a[28:31]
    s_waitcnt lgkmcnt(0)
    v_mfma_f32_16x16x32_bf16 v[92:95], a[216:219], a[164:167], 0
    s_mov_b32 m0, 144384
    v_mfma_f32_16x16x32_bf16 v[92:95], a[220:223], a[196:199], v[92:95]
    buffer_load_dwordx4 v192, s[32:35], s75 offen lds
    v_mfma_f32_16x16x32_bf16 v[124:127], a[228:231], a[196:199], 0
    s_mov_b32 m0, 145408
    v_mfma_f32_16x16x32_bf16 v[124:127], a[224:227], a[164:167], v[124:127]
    buffer_load_dwordx4 v193, s[32:35], s75 offen lds
    v_mfma_f32_16x16x32_bf16 v[120:123], a[224:227], a[160:163], 0
    s_mov_b32 m0, 146432
    v_mfma_f32_16x16x32_bf16 v[120:123], a[228:231], a[192:195], v[120:123]
    buffer_load_dwordx4 v194, s[32:35], s75 offen lds
    v_mfma_f32_16x16x32_bf16 v[88:91], a[220:223], a[192:195], 0
    v_mfma_f32_16x16x32_bf16 v[88:91], a[216:219], a[160:163], v[88:91]
    s_sub_u32 s75, s75, 229376
    v_mfma_f32_16x16x32_bf16 v[84:87], a[216:219], a[156:159], 0
    v_mfma_f32_16x16x32_bf16 v[84:87], a[220:223], a[188:191], v[84:87]
    s_add_u32 s84, s90, 917504
    s_bfm_b64 exec, 28, 28
    buffer_load_dword v236, v197, s[52:55], s84 offen
    s_mov_b64 exec, -1
    v_mfma_f32_16x16x32_bf16 v[116:119], a[228:231], a[188:191], 0
    buffer_load_dword v239, off, s[60:63], 0 sc1
    v_mfma_f32_16x16x32_bf16 v[116:119], a[224:227], a[156:159], v[116:119]
    v_mfma_f32_16x16x32_bf16 v[112:115], a[224:227], a[152:155], 0
    v_mfma_f32_16x16x32_bf16 v[112:115], a[228:231], a[184:187], v[112:115]
    v_mfma_f32_16x16x32_bf16 v[80:83], a[220:223], a[184:187], 0
    v_mfma_f32_16x16x32_bf16 v[80:83], a[216:219], a[152:155], v[80:83]
    s_waitcnt vmcnt(14)
    s_barrier
    v_mfma_f32_16x16x32_bf16 v[76:79], a[216:219], a[148:151], 0
    ds_read_b64_tr_b16 a[200:201], v204 offset:16384
    v_mfma_f32_16x16x32_bf16 v[76:79], a[220:223], a[180:183], v[76:79]
    ds_read_b64_tr_b16 a[202:203], v204 offset:17408
    v_mfma_f32_16x16x32_bf16 v[108:111], a[228:231], a[180:183], 0
    ds_read_b64_tr_b16 a[204:205], v204 offset:36864
    v_mfma_f32_16x16x32_bf16 v[108:111], a[224:227], a[148:151], v[108:111]
    ds_read_b64_tr_b16 a[206:207], v204 offset:37888
    v_mfma_f32_16x16x32_bf16 v[104:107], a[224:227], a[144:147], 0
    ds_read_b64_tr_b16 a[212:213], v205 offset:36896
    v_mfma_f32_16x16x32_bf16 v[104:107], a[228:231], a[176:179], v[104:107]
    ds_read_b64_tr_b16 a[214:215], v205 offset:37920
    v_mfma_f32_16x16x32_bf16 v[72:75], a[220:223], a[176:179], 0
    ds_read_b64_tr_b16 a[208:209], v205 offset:16416
    v_mfma_f32_16x16x32_bf16 v[72:75], a[216:219], a[144:147], v[72:75]
    ds_read_b64_tr_b16 a[210:211], v205 offset:17440
    v_mfma_f32_16x16x32_bf16 v[68:71], a[216:219], a[140:143], 0
    s_mov_b32 m0, 88064
    v_mfma_f32_16x16x32_bf16 v[68:71], a[220:223], a[172:175], v[68:71]
    v_mfma_f32_16x16x32_bf16 v[100:103], a[228:231], a[172:175], 0
    buffer_load_dwordx4 v192, s[36:39], s75 offen lds
    v_mfma_f32_16x16x32_bf16 v[100:103], a[224:227], a[140:143], v[100:103]
    v_mfma_f32_16x16x32_bf16 v[96:99], a[224:227], a[136:139], 0
    s_mov_b32 m0, 89088
    v_mfma_f32_16x16x32_bf16 v[96:99], a[228:231], a[168:171], v[96:99]
    v_mfma_f32_16x16x32_bf16 v[64:67], a[220:223], a[168:171], 0
    buffer_load_dwordx4 v193, s[36:39], s75 offen lds
    v_mfma_f32_16x16x32_bf16 v[64:67], a[216:219], a[136:139], v[64:67]
    s_waitcnt lgkmcnt(4)
    v_mfma_f32_16x16x32_bf16 v[128:131], a[136:139], a[200:203], 0
    s_mov_b32 m0, 90112
    v_mfma_f32_16x16x32_bf16 v[128:131], a[168:171], a[204:207], v[128:131]
    s_waitcnt lgkmcnt(0)
    v_mfma_f32_16x16x32_bf16 v[160:163], a[168:171], a[212:215], 0
    ds_read_b64_tr_b16 a[216:217], v204 offset:12288
    v_mfma_f32_16x16x32_bf16 v[160:163], a[136:139], a[208:211], v[160:163]
    buffer_load_dwordx4 v194, s[36:39], s75 offen lds
    v_mfma_f32_16x16x32_bf16 v[164:167], a[140:143], a[208:211], 0
    ds_read_b64_tr_b16 a[218:219], v204 offset:13312
    v_mfma_f32_16x16x32_bf16 v[164:167], a[172:175], a[212:215], v[164:167]
    s_add_u32 s75, s75, 229376
    v_mfma_f32_16x16x32_bf16 v[132:135], a[172:175], a[204:207], 0
    s_mov_b32 m0, 95232
    v_mfma_f32_16x16x32_bf16 v[132:135], a[140:143], a[200:203], v[132:135]
    ds_read_b64_tr_b16 a[220:221], v204 offset:32768
    v_mfma_f32_16x16x32_bf16 v[136:139], a[144:147], a[200:203], 0
    buffer_load_dwordx4 v192, s[36:39], s75 offen lds
    v_mfma_f32_16x16x32_bf16 v[136:139], a[176:179], a[204:207], v[136:139]
    ds_read_b64_tr_b16 a[222:223], v204 offset:33792
    v_mfma_f32_16x16x32_bf16 v[168:171], a[176:179], a[212:215], 0
    s_mov_b32 m0, 96256
    v_mfma_f32_16x16x32_bf16 v[168:171], a[144:147], a[208:211], v[168:171]
    ds_read_b64_tr_b16 a[228:229], v205 offset:32800
    v_mfma_f32_16x16x32_bf16 v[172:175], a[148:151], a[208:211], 0
    buffer_load_dwordx4 v193, s[36:39], s75 offen lds
    v_mfma_f32_16x16x32_bf16 v[172:175], a[180:183], a[212:215], v[172:175]
    s_mov_b32 m0, 97280
    v_mfma_f32_16x16x32_bf16 v[140:143], a[180:183], a[204:207], 0
    ds_read_b64_tr_b16 a[230:231], v205 offset:33824
    v_mfma_f32_16x16x32_bf16 v[140:143], a[148:151], a[200:203], v[140:143]
    buffer_load_dwordx4 v194, s[36:39], s75 offen lds
    v_mfma_f32_16x16x32_bf16 v[144:147], a[152:155], a[200:203], 0
    ds_read_b64_tr_b16 a[224:225], v205 offset:12320
    v_mfma_f32_16x16x32_bf16 v[144:147], a[184:187], a[204:207], v[144:147]
    s_add_u32 s75, s75, 229376
    v_mfma_f32_16x16x32_bf16 v[176:179], a[184:187], a[212:215], 0
    ds_read_b64_tr_b16 a[226:227], v205 offset:13344
    v_mfma_f32_16x16x32_bf16 v[176:179], a[152:155], a[208:211], v[176:179]
    s_mov_b32 m0, 2048
    v_mfma_f32_16x16x32_bf16 v[180:183], a[156:159], a[208:211], 0
    buffer_load_dwordx4 v198, s[24:27], s72 offen lds
    v_mfma_f32_16x16x32_bf16 v[180:183], a[188:191], a[212:215], v[180:183]
    s_mov_b32 m0, 3072
    v_mfma_f32_16x16x32_bf16 v[148:151], a[188:191], a[204:207], 0
    buffer_load_dwordx4 v199, s[24:27], s72 offen lds
    v_mfma_f32_16x16x32_bf16 v[148:151], a[156:159], a[200:203], v[148:151]
    v_mfma_f32_16x16x32_bf16 v[152:155], a[160:163], a[200:203], 0
    s_add_u32 s72, s72, 32768
    v_mfma_f32_16x16x32_bf16 v[152:155], a[192:195], a[204:207], v[152:155]
    s_mov_b32 m0, 4096
    v_mfma_f32_16x16x32_bf16 v[184:187], a[192:195], a[212:215], 0
    v_mfma_f32_16x16x32_bf16 v[184:187], a[160:163], a[208:211], v[184:187]
    buffer_load_dwordx4 v198, s[24:27], s72 offen lds
    v_mfma_f32_16x16x32_bf16 v[188:191], a[164:167], a[208:211], 0
    v_mfma_f32_16x16x32_bf16 v[188:191], a[196:199], a[212:215], v[188:191]
    s_mov_b32 m0, 5120
    v_mfma_f32_16x16x32_bf16 v[156:159], a[196:199], a[204:207], 0
    s_cbranch_vccnz L_skp1_02
L_sbp1_02:
    v_mfma_f32_16x16x32_bf16 v[156:159], a[164:167], a[200:203], v[156:159]
    s_waitcnt lgkmcnt(0)
    v_mfma_f32_16x16x32_bf16 v[28:31], a[216:219], a[164:167], 0
    buffer_load_dwordx4 v199, s[24:27], s72 offen lds
    v_mfma_f32_16x16x32_bf16 v[28:31], a[220:223], a[196:199], v[28:31]
    s_add_u32 s72, s72, 4294934656
    v_mfma_f32_16x16x32_bf16 v[60:63], a[228:231], a[196:199], 0
    ds_read_b64_tr_b16 a[200:201], v206 offset:20480
    v_mfma_f32_16x16x32_bf16 v[60:63], a[224:227], a[164:167], v[60:63]
    s_mov_b32 m0, 122880
    v_mfma_f32_16x16x32_bf16 v[56:59], a[224:227], a[160:163], 0
    ds_read_b64_tr_b16 a[202:203], v206 offset:24064
    v_mfma_f32_16x16x32_bf16 v[56:59], a[228:231], a[192:195], v[56:59]
    buffer_load_dwordx4 v192, s[32:35], s75 offen lds
    v_mfma_f32_16x16x32_bf16 v[24:27], a[220:223], a[192:195], 0
    ds_read_b64_tr_b16 a[204:205], v206 offset:27648
    v_mfma_f32_16x16x32_bf16 v[24:27], a[216:219], a[160:163], v[24:27]
    s_mov_b32 m0, 123904
    v_mfma_f32_16x16x32_bf16 v[20:23], a[216:219], a[156:159], 0
    ds_read_b64_tr_b16 a[206:207], v206 offset:31232
    v_mfma_f32_16x16x32_bf16 v[20:23], a[220:223], a[188:191], v[20:23]
    buffer_load_dwordx4 v193, s[32:35], s75 offen lds
    v_mfma_f32_16x16x32_bf16 v[52:55], a[228:231], a[188:191], 0
    s_mov_b32 m0, 124928
    v_mfma_f32_16x16x32_bf16 v[52:55], a[224:227], a[156:159], v[52:55]
    ds_read_b64_tr_b16 a[212:213], v206 offset:27680
    v_mfma_f32_16x16x32_bf16 v[48:51], a[224:227], a[152:155], 0
    buffer_load_dwordx4 v194, s[32:35], s75 offen lds
    v_mfma_f32_16x16x32_bf16 v[48:51], a[228:231], a[184:187], v[48:51]
    ds_read_b64_tr_b16 a[214:215], v206 offset:31264
    v_mfma_f32_16x16x32_bf16 v[16:19], a[220:223], a[184:187], 0
    s_add_u32 s75, s75, 229376
    v_mfma_f32_16x16x32_bf16 v[16:19], a[216:219], a[152:155], v[16:19]
    ds_read_b64_tr_b16 a[208:209], v206 offset:20512
    v_mfma_f32_16x16x32_bf16 v[12:15], a[216:219], a[148:151], 0
    s_mov_b32 m0, 130048
    v_mfma_f32_16x16x32_bf16 v[12:15], a[220:223], a[180:183], v[12:15]
    buffer_load_dwordx4 v192, s[32:35], s75 offen lds
    v_mfma_f32_16x16x32_bf16 v[44:47], a[228:231], a[180:183], 0
    ds_read_b64_tr_b16 a[210:211], v206 offset:24096
    v_mfma_f32_16x16x32_bf16 v[44:47], a[224:227], a[148:151], v[44:47]
    s_mov_b32 m0, 131072
    v_mfma_f32_16x16x32_bf16 v[40:43], a[224:227], a[144:147], 0
    buffer_load_dwordx4 v193, s[32:35], s75 offen lds
    v_mfma_f32_16x16x32_bf16 v[40:43], a[228:231], a[176:179], v[40:43]
    s_mov_b32 m0, 132096
    v_mfma_f32_16x16x32_bf16 v[8:11], a[220:223], a[176:179], 0
    v_mfma_f32_16x16x32_bf16 v[8:11], a[216:219], a[144:147], v[8:11]
    buffer_load_dwordx4 v194, s[32:35], s75 offen lds
    v_mfma_f32_16x16x32_bf16 v[4:7], a[216:219], a[140:143], 0
    v_mfma_f32_16x16x32_bf16 v[4:7], a[220:223], a[172:175], v[4:7]
    s_sub_u32 s75, s75, 229376
    v_mfma_f32_16x16x32_bf16 v[36:39], a[228:231], a[172:175], 0
    v_mfma_f32_16x16x32_bf16 v[36:39], a[224:227], a[140:143], v[36:39]
    v_mfma_f32_16x16x32_bf16 v[32:35], a[224:227], a[136:139], 0
    v_mfma_f32_16x16x32_bf16 v[32:35], a[228:231], a[168:171], v[32:35]
    v_mfma_f32_16x16x32_bf16 v[0:3], a[220:223], a[168:171], 0
    v_mfma_f32_16x16x32_bf16 v[0:3], a[216:219], a[136:139], v[0:3]
    s_waitcnt vmcnt(18) lgkmcnt(0)
    s_barrier
    v_mfma_f32_16x16x32_bf16 a[64:67], a[200:203], a[136:139], 0
    ds_read_b64_tr_b16 a[216:217], v206 offset:49152
    v_mfma_f32_16x16x32_bf16 a[64:67], a[204:207], a[168:171], a[64:67]
    s_mov_b32 m0, 108544
    v_mfma_f32_16x16x32_bf16 a[96:99], a[212:215], a[168:171], 0
    ds_read_b64_tr_b16 a[218:219], v206 offset:52736
    v_mfma_f32_16x16x32_bf16 a[96:99], a[208:211], a[136:139], a[96:99]
    ds_read_b64_tr_b16 a[220:221], v206 offset:56320
    v_mfma_f32_16x16x32_bf16 a[100:103], a[208:211], a[140:143], 0
    buffer_load_dwordx4 v192, s[36:39], s75 offen lds
    v_mfma_f32_16x16x32_bf16 a[100:103], a[212:215], a[172:175], a[100:103]
    ds_read_b64_tr_b16 a[222:223], v206 offset:59904
    v_mfma_f32_16x16x32_bf16 a[68:71], a[204:207], a[172:175], 0
    ds_read_b64_tr_b16 a[228:229], v206 offset:56352
    v_mfma_f32_16x16x32_bf16 a[68:71], a[200:203], a[140:143], a[68:71]
    s_mov_b32 m0, 109568
    v_mfma_f32_16x16x32_bf16 a[72:75], a[200:203], a[144:147], 0
    ds_read_b64_tr_b16 a[230:231], v206 offset:59936
    v_mfma_f32_16x16x32_bf16 a[72:75], a[204:207], a[176:179], a[72:75]
    ds_read_b64_tr_b16 a[224:225], v206 offset:49184
    v_mfma_f32_16x16x32_bf16 a[104:107], a[212:215], a[176:179], 0
    ds_read_b128 a[136:139], v200 offset:32768
    v_mfma_f32_16x16x32_bf16 a[104:107], a[208:211], a[144:147], a[104:107]
    buffer_load_dwordx4 v193, s[36:39], s75 offen lds
    v_mfma_f32_16x16x32_bf16 a[108:111], a[208:211], a[148:151], 0
    ds_read_b64_tr_b16 a[226:227], v206 offset:52768
    v_mfma_f32_16x16x32_bf16 a[108:111], a[212:215], a[180:183], a[108:111]
    ds_read_b128 a[168:171], v201 offset:32768
    v_mfma_f32_16x16x32_bf16 a[76:79], a[204:207], a[180:183], 0
    s_mov_b32 m0, 110592
    v_mfma_f32_16x16x32_bf16 a[76:79], a[200:203], a[148:151], a[76:79]
    ds_read_b128 a[140:143], v200 offset:34816
    v_mfma_f32_16x16x32_bf16 a[80:83], a[200:203], a[152:155], 0
    buffer_load_dwordx4 v194, s[36:39], s75 offen lds
    v_mfma_f32_16x16x32_bf16 a[80:83], a[204:207], a[184:187], a[80:83]
    ds_read_b128 a[172:175], v201 offset:34816
    v_mfma_f32_16x16x32_bf16 a[112:115], a[212:215], a[184:187], 0
    s_add_u32 s75, s75, 229376
    v_mfma_f32_16x16x32_bf16 a[112:115], a[208:211], a[152:155], a[112:115]
    ds_read_b128 a[144:147], v200 offset:36864
    v_mfma_f32_16x16x32_bf16 a[116:119], a[208:211], a[156:159], 0
    s_mov_b32 m0, 115712
    v_mfma_f32_16x16x32_bf16 a[116:119], a[212:215], a[188:191], a[116:119]
    ds_read_b128 a[176:179], v201 offset:36864
    v_mfma_f32_16x16x32_bf16 a[84:87], a[204:207], a[188:191], 0
    buffer_load_dwordx4 v192, s[36:39], s75 offen lds
    v_mfma_f32_16x16x32_bf16 a[84:87], a[200:203], a[156:159], a[84:87]
    ds_read_b128 a[148:151], v200 offset:38912
    v_mfma_f32_16x16x32_bf16 a[88:91], a[200:203], a[160:163], 0
    s_mov_b32 m0, 116736
    v_mfma_f32_16x16x32_bf16 a[88:91], a[204:207], a[192:195], a[88:91]
    ds_read_b128 a[180:183], v201 offset:38912
    v_mfma_f32_16x16x32_bf16 a[120:123], a[212:215], a[192:195], 0
    buffer_load_dwordx4 v193, s[36:39], s75 offen lds
    v_mfma_f32_16x16x32_bf16 a[120:123], a[208:211], a[160:163], a[120:123]
    ds_read_b128 a[152:155], v200 offset:40960
    v_mfma_f32_16x16x32_bf16 a[124:127], a[208:211], a[164:167], 0
    s_mov_b32 m0, 117760
    v_mfma_f32_16x16x32_bf16 a[124:127], a[212:215], a[196:199], a[124:127]
    ds_read_b128 a[184:187], v201 offset:40960
    v_mfma_f32_16x16x32_bf16 a[92:95], a[204:207], a[196:199], 0
    s_cbranch_vccnz L_skp1_04
L_sbp1_04:
    v_mfma_f32_16x16x32_bf16 a[92:95], a[200:203], a[164:167], a[92:95]
    s_waitcnt lgkmcnt(6)
    v_mfma_f32_16x16x32_bf16 a[0:3], a[216:219], a[136:139], a[0:3]
    buffer_load_dwordx4 v194, s[36:39], s75 offen lds
    v_mfma_f32_16x16x32_bf16 a[0:3], a[220:223], a[168:171], a[0:3]
    ds_read_b128 a[156:159], v200 offset:43008
    v_mfma_f32_16x16x32_bf16 a[32:35], a[228:231], a[168:171], a[32:35]
    s_add_u32 s75, s75, 229376
    v_mfma_f32_16x16x32_bf16 a[32:35], a[224:227], a[136:139], a[32:35]
    ds_read_b128 a[188:191], v201 offset:43008
    v_mfma_f32_16x16x32_bf16 a[36:39], a[224:227], a[140:143], a[36:39]
    ds_read_b128 a[160:163], v200 offset:45056
    v_mfma_f32_16x16x32_bf16 a[36:39], a[228:231], a[172:175], a[36:39]
    ds_read_b128 a[192:195], v201 offset:45056
    v_mfma_f32_16x16x32_bf16 a[4:7], a[220:223], a[172:175], a[4:7]
    ds_read_b128 a[164:167], v200 offset:47104
    v_mfma_f32_16x16x32_bf16 a[4:7], a[216:219], a[140:143], a[4:7]
    s_waitcnt lgkmcnt(7)
    v_mfma_f32_16x16x32_bf16 a[8:11], a[216:219], a[144:147], a[8:11]
    ds_read_b128 a[196:199], v201 offset:47104
    v_mfma_f32_16x16x32_bf16 a[8:11], a[220:223], a[176:179], a[8:11]
    ds_read_b64_tr_b16 a[200:201], v204 offset:2048
    v_mfma_f32_16x16x32_bf16 a[40:43], a[228:231], a[176:179], a[40:43]
    ds_read_b64_tr_b16 a[202:203], v204 offset:3072
    v_mfma_f32_16x16x32_bf16 a[40:43], a[224:227], a[144:147], a[40:43]
    ds_read_b64_tr_b16 a[204:205], v204 offset:8192
    v_mfma_f32_16x16x32_bf16 a[44:47], a[224:227], a[148:151], a[44:47]
    ds_read_b64_tr_b16 a[206:207], v204 offset:9216
    v_mfma_f32_16x16x32_bf16 a[44:47], a[228:231], a[180:183], a[44:47]
    ds_read_b64_tr_b16 a[212:213], v205 offset:8224
    v_mfma_f32_16x16x32_bf16 a[12:15], a[220:223], a[180:183], a[12:15]
    s_cmp_lt_u32 s65, 4
    s_cselect_b32 s84, 2, 5
    s_mul_i32 s84, s84, 917504
    s_add_u32 s90, s90, s84
    v_mfma_f32_16x16x32_bf16 a[12:15], a[216:219], a[148:151], a[12:15]
    s_waitcnt lgkmcnt(9)
    v_mfma_f32_16x16x32_bf16 a[16:19], a[216:219], a[152:155], a[16:19]
    s_bfm_b64 exec, 28, 0
    buffer_load_dword v236, v197, s[52:55], s90 offen
    s_mov_b64 exec, -1
    v_mfma_f32_16x16x32_bf16 a[16:19], a[220:223], a[184:187], a[16:19]
    ds_read_b64_tr_b16 a[214:215], v205 offset:9248
    v_mfma_f32_16x16x32_bf16 a[48:51], a[228:231], a[184:187], a[48:51]
    ds_read_b64_tr_b16 a[208:209], v205 offset:2080
    v_mfma_f32_16x16x32_bf16 a[48:51], a[224:227], a[152:155], a[48:51]
    ds_read_b64_tr_b16 a[210:211], v205 offset:3104
    v_mfma_f32_16x16x32_bf16 a[52:55], a[224:227], a[156:159], a[52:55]
    v_mfma_f32_16x16x32_bf16 a[52:55], a[228:231], a[188:191], a[52:55]
    v_mfma_f32_16x16x32_bf16 a[20:23], a[220:223], a[188:191], a[20:23]
    v_mfma_f32_16x16x32_bf16 a[20:23], a[216:219], a[156:159], a[20:23]
    s_waitcnt lgkmcnt(8)
    v_mfma_f32_16x16x32_bf16 a[24:27], a[216:219], a[160:163], a[24:27]
    v_mfma_f32_16x16x32_bf16 a[24:27], a[220:223], a[192:195], a[24:27]
    v_mfma_f32_16x16x32_bf16 a[56:59], a[228:231], a[192:195], a[56:59]
    v_mfma_f32_16x16x32_bf16 a[56:59], a[224:227], a[160:163], a[56:59]
    v_mfma_f32_16x16x32_bf16 a[60:63], a[224:227], a[164:167], a[60:63]
    v_mfma_f32_16x16x32_bf16 a[60:63], a[228:231], a[196:199], a[60:63]
    v_mfma_f32_16x16x32_bf16 a[28:31], a[220:223], a[196:199], a[28:31]
    v_mfma_f32_16x16x32_bf16 a[28:31], a[216:219], a[164:167], a[28:31]
    s_waitcnt lgkmcnt(0)
    v_mfma_f32_16x16x32_bf16 v[92:95], a[200:203], a[164:167], v[92:95]
    v_mfma_f32_16x16x32_bf16 v[92:95], a[204:207], a[196:199], v[92:95]
    v_mfma_f32_16x16x32_bf16 v[124:127], a[212:215], a[196:199], v[124:127]
    v_mfma_f32_16x16x32_bf16 v[124:127], a[208:211], a[164:167], v[124:127]
    v_mfma_f32_16x16x32_bf16 v[120:123], a[208:211], a[160:163], v[120:123]
    v_mfma_f32_16x16x32_bf16 v[120:123], a[212:215], a[192:195], v[120:123]
    v_mfma_f32_16x16x32_bf16 v[88:91], a[204:207], a[192:195], v[88:91]
    v_mfma_f32_16x16x32_bf16 v[88:91], a[200:203], a[160:163], v[88:91]
    v_mfma_f32_16x16x32_bf16 v[84:87], a[200:203], a[156:159], v[84:87]
    v_mfma_f32_16x16x32_bf16 v[84:87], a[204:207], a[188:191], v[84:87]
    v_mfma_f32_16x16x32_bf16 v[116:119], a[212:215], a[188:191], v[116:119]
    v_mfma_f32_16x16x32_bf16 v[116:119], a[208:211], a[156:159], v[116:119]
    v_mfma_f32_16x16x32_bf16 v[112:115], a[208:211], a[152:155], v[112:115]
    v_mfma_f32_16x16x32_bf16 v[112:115], a[212:215], a[184:187], v[112:115]
    v_mfma_f32_16x16x32_bf16 v[80:83], a[204:207], a[184:187], v[80:83]
    v_mfma_f32_16x16x32_bf16 v[80:83], a[200:203], a[152:155], v[80:83]
L_g1_loop1:
    s_waitcnt vmcnt(17)
    s_barrier
    v_mfma_f32_16x16x32_bf16 v[76:79], a[200:203], a[148:151], v[76:79]
    ds_read_b64_tr_b16 a[216:217], v204 offset:4096
    v_mfma_f32_16x16x32_bf16 v[76:79], a[204:207], a[180:183], v[76:79]
    ds_read_b64_tr_b16 a[218:219], v204 offset:5120
    v_mfma_f32_16x16x32_bf16 v[108:111], a[212:215], a[180:183], v[108:111]
    ds_read_b64_tr_b16 a[220:221], v204 offset:10240
    v_mfma_f32_16x16x32_bf16 v[108:111], a[208:211], a[148:151], v[108:111]
    ds_read_b64_tr_b16 a[222:223], v204 offset:11264
    v_mfma_f32_16x16x32_bf16 v[104:107], a[208:211], a[144:147], v[104:107]
    ds_read_b64_tr_b16 a[228:229], v205 offset:10272
    v_mfma_f32_16x16x32_bf16 v[104:107], a[212:215], a[176:179], v[104:107]
    ds_read_b64_tr_b16 a[230:231], v205 offset:11296
    v_mfma_f32_16x16x32_bf16 v[72:75], a[204:207], a[176:179], v[72:75]
    ds_read_b64_tr_b16 a[224:225], v205 offset:4128
    v_mfma_f32_16x16x32_bf16 v[72:75], a[200:203], a[144:147], v[72:75]
    ds_read_b64_tr_b16 a[226:227], v205 offset:5152
    v_mfma_f32_16x16x32_bf16 v[68:71], a[200:203], a[140:143], v[68:71]
    s_mov_b32 m0, 34816
    v_mfma_f32_16x16x32_bf16 v[68:71], a[204:207], a[172:175], v[68:71]
    v_mfma_f32_16x16x32_bf16 v[100:103], a[212:215], a[172:175], v[100:103]
    v_mfma_f32_16x16x32_bf16 v[100:103], a[208:211], a[140:143], v[100:103]
    buffer_load_dwordx4 v198, s[24:27], s72 offen lds
    v_mfma_f32_16x16x32_bf16 v[96:99], a[208:211], a[136:139], v[96:99]
    s_cbranch_vccnz L_skh1_11
L_sbh1_11:
    v_mfma_f32_16x16x32_bf16 v[96:99], a[212:215], a[168:171], v[96:99]
    v_mfma_f32_16x16x32_bf16 v[64:67], a[204:207], a[168:171], v[64:67]
    s_mov_b32 m0, 35840
    v_mfma_f32_16x16x32_bf16 v[64:67], a[200:203], a[136:139], v[64:67]
    s_waitcnt lgkmcnt(4)
    v_mfma_f32_16x16x32_bf16 v[128:131], a[136:139], a[216:219], v[128:131]
    ds_read_b64_tr_b16 a[200:201], v204 offset:0
    v_mfma_f32_16x16x32_bf16 v[128:131], a[168:171], a[220:223], v[128:131]
    s_waitcnt lgkmcnt(1)
    v_mfma_f32_16x16x32_bf16 v[160:163], a[168:171], a[228:231], v[160:163]
    buffer_load_dwordx4 v199, s[24:27], s72 offen lds
    v_mfma_f32_16x16x32_bf16 v[160:163], a[136:139], a[224:227], v[160:163]
    ds_read_b64_tr_b16 a[202:203], v204 offset:1024
    v_mfma_f32_16x16x32_bf16 v[164:167], a[140:143], a[224:227], v[164:167]
    s_add_u32 s72, s72, 32768
    v_mfma_f32_16x16x32_bf16 v[164:167], a[172:175], a[228:231], v[164:167]
    ds_read_b64_tr_b16 a[204:205], v204 offset:6144
    v_mfma_f32_16x16x32_bf16 v[132:135], a[172:175], a[220:223], v[132:135]
    s_mov_b32 m0, 36864
    v_mfma_f32_16x16x32_bf16 v[132:135], a[140:143], a[216:219], v[132:135]
    ds_read_b64_tr_b16 a[206:207], v204 offset:7168
    v_mfma_f32_16x16x32_bf16 v[136:139], a[144:147], a[216:219], v[136:139]
    v_mfma_f32_16x16x32_bf16 v[136:139], a[176:179], a[220:223], v[136:139]
    buffer_load_dwordx4 v198, s[24:27], s72 offen lds
    v_mfma_f32_16x16x32_bf16 v[168:171], a[176:179], a[228:231], v[168:171]
    ds_read_b64_tr_b16 a[212:213], v205 offset:6176
    v_mfma_f32_16x16x32_bf16 v[168:171], a[144:147], a[224:227], v[168:171]
    v_mfma_f32_16x16x32_bf16 v[172:175], a[148:151], a[224:227], v[172:175]
    ds_read_b64_tr_b16 a[214:215], v205 offset:7200
    v_mfma_f32_16x16x32_bf16 v[172:175], a[180:183], a[228:231], v[172:175]
    s_mov_b32 m0, 37888
    v_mfma_f32_16x16x32_bf16 v[140:143], a[180:183], a[220:223], v[140:143]
    ds_read_b64_tr_b16 a[208:209], v205 offset:32
    v_mfma_f32_16x16x32_bf16 v[140:143], a[148:151], a[216:219], v[140:143]
    buffer_load_dwordx4 v199, s[24:27], s72 offen lds
    v_mfma_f32_16x16x32_bf16 v[144:147], a[152:155], a[216:219], v[144:147]
    ds_read_b64_tr_b16 a[210:211], v205 offset:1056
    v_mfma_f32_16x16x32_bf16 v[144:147], a[184:187], a[220:223], v[144:147]
    s_add_u32 s72, s72, 4294934656
    v_mfma_f32_16x16x32_bf16 v[176:179], a[184:187], a[228:231], v[176:179]
    v_mfma_f32_16x16x32_bf16 v[176:179], a[152:155], a[224:227], v[176:179]
    v_mfma_f32_16x16x32_bf16 v[180:183], a[156:159], a[224:227], v[180:183]
    s_mov_b32 m0, 137216
    v_mfma_f32_16x16x32_bf16 v[180:183], a[188:191], a[228:231], v[180:183]
    v_mfma_f32_16x16x32_bf16 v[148:151], a[188:191], a[220:223], v[148:151]
    v_mfma_f32_16x16x32_bf16 v[148:151], a[156:159], a[216:219], v[148:151]
    buffer_load_dwordx4 v192, s[32:35], s75 offen lds
    v_mfma_f32_16x16x32_bf16 v[152:155], a[160:163], a[216:219], v[152:155]
    v_mfma_f32_16x16x32_bf16 v[152:155], a[192:195], a[220:223], v[152:155]
    s_mov_b32 m0, 138240
    v_mfma_f32_16x16x32_bf16 v[184:187], a[192:195], a[228:231], v[184:187]
    v_mfma_f32_16x16x32_bf16 v[184:187], a[160:163], a[224:227], v[184:187]
    v_mfma_f32_16x16x32_bf16 v[188:191], a[164:167], a[224:227], v[188:191]
    buffer_load_dwordx4 v193, s[32:35], s75 offen lds
    v_mfma_f32_16x16x32_bf16 v[188:191], a[196:199], a[228:231], v[188:191]
    v_mfma_f32_16x16x32_bf16 v[156:159], a[196:199], a[220:223], v[156:159]
    v_mfma_f32_16x16x32_bf16 v[156:159], a[164:167], a[216:219], v[156:159]
    s_waitcnt lgkmcnt(0)
    v_mfma_f32_16x16x32_bf16 v[28:31], a[200:203], a[164:167], v[28:31]
    s_mov_b32 m0, 139264
    v_mfma_f32_16x16x32_bf16 v[28:31], a[204:207], a[196:199], v[28:31]
    ds_read_b64_tr_b16 a[216:217], v206 offset:0
    v_mfma_f32_16x16x32_bf16 v[60:63], a[212:215], a[196:199], v[60:63]
    buffer_load_dwordx4 v194, s[32:35], s75 offen lds
    v_mfma_f32_16x16x32_bf16 v[60:63], a[208:211], a[164:167], v[60:63]
    ds_read_b64_tr_b16 a[218:219], v206 offset:3584
    v_mfma_f32_16x16x32_bf16 v[56:59], a[208:211], a[160:163], v[56:59]
    s_add_u32 s75, s75, 229376
    v_mfma_f32_16x16x32_bf16 v[56:59], a[212:215], a[192:195], v[56:59]
    ds_read_b64_tr_b16 a[220:221], v206 offset:7168
    v_mfma_f32_16x16x32_bf16 v[24:27], a[204:207], a[192:195], v[24:27]
    v_mfma_f32_16x16x32_bf16 v[24:27], a[200:203], a[160:163], v[24:27]
    ds_read_b64_tr_b16 a[222:223], v206 offset:10752
    v_mfma_f32_16x16x32_bf16 v[20:23], a[200:203], a[156:159], v[20:23]
    s_mov_b32 m0, 144384
    v_mfma_f32_16x16x32_bf16 v[20:23], a[204:207], a[188:191], v[20:23]
    ds_read_b64_tr_b16 a[228:229], v206 offset:7200
    v_mfma_f32_16x16x32_bf16 v[52:55], a[212:215], a[188:191], v[52:55]
    buffer_load_dwordx4 v192, s[32:35], s75 offen lds
    v_mfma_f32_16x16x32_bf16 v[52:55], a[208:211], a[156:159], v[52:55]
    v_mfma_f32_16x16x32_bf16 v[48:51], a[208:211], a[152:155], v[48:51]
    ds_read_b64_tr_b16 a[230:231], v206 offset:10784
    v_mfma_f32_16x16x32_bf16 v[48:51], a[212:215], a[184:187], v[48:51]
    s_mov_b32 m0, 145408
    v_mfma_f32_16x16x32_bf16 v[16:19], a[204:207], a[184:187], v[16:19]
    ds_read_b64_tr_b16 a[224:225], v206 offset:32
    v_mfma_f32_16x16x32_bf16 v[16:19], a[200:203], a[152:155], v[16:19]
    buffer_load_dwordx4 v193, s[32:35], s75 offen lds
    v_mfma_f32_16x16x32_bf16 v[12:15], a[200:203], a[148:151], v[12:15]
    ds_read_b64_tr_b16 a[226:227], v206 offset:3616
    v_mfma_f32_16x16x32_bf16 v[12:15], a[204:207], a[180:183], v[12:15]
    v_mfma_f32_16x16x32_bf16 v[44:47], a[212:215], a[180:183], v[44:47]
    s_mov_b32 m0, 146432
    v_mfma_f32_16x16x32_bf16 v[44:47], a[208:211], a[148:151], v[44:47]
    v_mfma_f32_16x16x32_bf16 v[40:43], a[208:211], a[144:147], v[40:43]
    v_mfma_f32_16x16x32_bf16 v[40:43], a[212:215], a[176:179], v[40:43]
    buffer_load_dwordx4 v194, s[32:35], s75 offen lds
    v_mfma_f32_16x16x32_bf16 v[8:11], a[204:207], a[176:179], v[8:11]
    v_mfma_f32_16x16x32_bf16 v[8:11], a[200:203], a[144:147], v[8:11]
    v_mfma_f32_16x16x32_bf16 v[4:7], a[200:203], a[140:143], v[4:7]
    s_sub_u32 s75, s75, 229376
    v_mfma_f32_16x16x32_bf16 v[4:7], a[204:207], a[172:175], v[4:7]
    v_mfma_f32_16x16x32_bf16 v[36:39], a[212:215], a[172:175], v[36:39]
    global_load_dword v236, v237, s[0:1]
    v_mfma_f32_16x16x32_bf16 v[36:39], a[208:211], a[140:143], v[36:39]
    v_mfma_f32_16x16x32_bf16 v[32:35], a[208:211], a[136:139], v[32:35]
    v_mfma_f32_16x16x32_bf16 v[32:35], a[212:215], a[168:171], v[32:35]
    v_mfma_f32_16x16x32_bf16 v[0:3], a[204:207], a[168:171], v[0:3]
    s_cbranch_vccnz L_skh1_13
L_sbh1_13:
    v_mfma_f32_16x16x32_bf16 v[0:3], a[200:203], a[136:139], v[0:3]
    s_cmp_eq_u32 s76, 4
    s_cbranch_scc1 L_hs1
L_hb1:
    s_waitcnt vmcnt(18) lgkmcnt(0)
    s_barrier
    v_mfma_f32_16x16x32_bf16 a[64:67], a[216:219], a[136:139], a[64:67]
    ds_read_b64_tr_b16 a[200:201], v206 offset:34816
    v_mfma_f32_16x16x32_bf16 a[64:67], a[220:223], a[168:171], a[64:67]
    s_mov_b32 m0, 88064
    v_mfma_f32_16x16x32_bf16 a[96:99], a[228:231], a[168:171], a[96:99]
    ds_read_b64_tr_b16 a[202:203], v206 offset:38400
    v_mfma_f32_16x16x32_bf16 a[96:99], a[224:227], a[136:139], a[96:99]
    ds_read_b64_tr_b16 a[204:205], v206 offset:41984
    v_mfma_f32_16x16x32_bf16 a[100:103], a[224:227], a[140:143], a[100:103]
    buffer_load_dwordx4 v192, s[36:39], s75 offen lds
    v_mfma_f32_16x16x32_bf16 a[100:103], a[228:231], a[172:175], a[100:103]
    ds_read_b64_tr_b16 a[206:207], v206 offset:45568
    v_mfma_f32_16x16x32_bf16 a[68:71], a[220:223], a[172:175], a[68:71]
    ds_read_b64_tr_b16 a[212:213], v206 offset:42016
    v_mfma_f32_16x16x32_bf16 a[68:71], a[216:219], a[140:143], a[68:71]
    s_mov_b32 m0, 89088
    v_mfma_f32_16x16x32_bf16 a[72:75], a[216:219], a[144:147], a[72:75]
    ds_read_b64_tr_b16 a[214:215], v206 offset:45600
    v_mfma_f32_16x16x32_bf16 a[72:75], a[220:223], a[176:179], a[72:75]
    ds_read_b64_tr_b16 a[208:209], v206 offset:34848
    v_mfma_f32_16x16x32_bf16 a[104:107], a[228:231], a[176:179], a[104:107]
    ds_read_b128 a[136:139], v200 offset:0
    v_mfma_f32_16x16x32_bf16 a[104:107], a[224:227], a[144:147], a[104:107]
    buffer_load_dwordx4 v193, s[36:39], s75 offen lds
    v_mfma_f32_16x16x32_bf16 a[108:111], a[224:227], a[148:151], a[108:111]
    ds_read_b64_tr_b16 a[210:211], v206 offset:38432
    v_mfma_f32_16x16x32_bf16 a[108:111], a[228:231], a[180:183], a[108:111]
    ds_read_b128 a[168:171], v201 offset:0
    v_mfma_f32_16x16x32_bf16 a[76:79], a[220:223], a[180:183], a[76:79]
    s_mov_b32 m0, 90112
    v_mfma_f32_16x16x32_bf16 a[76:79], a[216:219], a[148:151], a[76:79]
    ds_read_b128 a[140:143], v200 offset:2048
    v_mfma_f32_16x16x32_bf16 a[80:83], a[216:219], a[152:155], a[80:83]
    buffer_load_dwordx4 v194, s[36:39], s75 offen lds
    v_mfma_f32_16x16x32_bf16 a[80:83], a[220:223], a[184:187], a[80:83]
    ds_read_b128 a[172:175], v201 offset:2048
    v_mfma_f32_16x16x32_bf16 a[112:115], a[228:231], a[184:187], a[112:115]
    s_add_u32 s75, s75, 229376
    v_mfma_f32_16x16x32_bf16 a[112:115], a[224:227], a[152:155], a[112:115]
    ds_read_b128 a[144:147], v200 offset:4096
    v_mfma_f32_16x16x32_bf16 a[116:119], a[224:227], a[156:159], a[116:119]
    s_mov_b32 m0, 95232
    v_mfma_f32_16x16x32_bf16 a[116:119], a[228:231], a[188:191], a[116:119]
    ds_read_b128 a[176:179], v201 offset:4096
    v_mfma_f32_16x16x32_bf16 a[84:87], a[220:223], a[188:191], a[84:87]
    buffer_load_dwordx4 v192, s[36:39], s75 offen lds
    v_mfma_f32_16x16x32_bf16 a[84:87], a[216:219], a[156:159], a[84:87]
    ds_read_b128 a[148:151], v200 offset:6144
    v_mfma_f32_16x16x32_bf16 a[88:91], a[216:219], a[160:163], a[88:91]
    s_mov_b32 m0, 96256
    v_mfma_f32_16x16x32_bf16 a[88:91], a[220:223], a[192:195], a[88:91]
    ds_read_b128 a[180:183], v201 offset:6144
    v_mfma_f32_16x16x32_bf16 a[120:123], a[228:231], a[192:195], a[120:123]
    buffer_load_dwordx4 v193, s[36:39], s75 offen lds
    v_mfma_f32_16x16x32_bf16 a[120:123], a[224:227], a[160:163], a[120:123]
    ds_read_b128 a[152:155], v200 offset:8192
    v_mfma_f32_16x16x32_bf16 a[124:127], a[224:227], a[164:167], a[124:127]
    s_mov_b32 m0, 97280
    v_mfma_f32_16x16x32_bf16 a[124:127], a[228:231], a[196:199], a[124:127]
    ds_read_b128 a[184:187], v201 offset:8192
    v_mfma_f32_16x16x32_bf16 a[92:95], a[220:223], a[196:199], a[92:95]
    buffer_load_dwordx4 v194, s[36:39], s75 offen lds
    v_mfma_f32_16x16x32_bf16 a[92:95], a[216:219], a[164:167], a[92:95]
    s_waitcnt lgkmcnt(6)
    v_mfma_f32_16x16x32_bf16 a[0:3], a[200:203], a[136:139], a[0:3]
    ds_read_b128 a[156:159], v200 offset:10240
    v_mfma_f32_16x16x32_bf16 a[0:3], a[204:207], a[168:171], a[0:3]
    s_add_u32 s75, s75, 229376
    v_mfma_f32_16x16x32_bf16 a[32:35], a[212:215], a[168:171], a[32:35]
    ds_read_b128 a[188:191], v201 offset:10240
    v_mfma_f32_16x16x32_bf16 a[32:35], a[208:211], a[136:139], a[32:35]
    ds_read_b128 a[160:163], v200 offset:12288
    v_mfma_f32_16x16x32_bf16 a[36:39], a[208:211], a[140:143], a[36:39]
    ds_read_b128 a[192:195], v201 offset:12288
    v_mfma_f32_16x16x32_bf16 a[36:39], a[212:215], a[172:175], a[36:39]
    ds_read_b128 a[164:167], v200 offset:14336
    v_mfma_f32_16x16x32_bf16 a[4:7], a[204:207], a[172:175], a[4:7]
    ds_read_b128 a[196:199], v201 offset:14336
    v_mfma_f32_16x16x32_bf16 a[4:7], a[200:203], a[140:143], a[4:7]
    s_waitcnt lgkmcnt(8)
    v_mfma_f32_16x16x32_bf16 a[8:11], a[200:203], a[144:147], a[8:11]
    ds_read_b64_tr_b16 a[216:217], v204 offset:14336
    v_mfma_f32_16x16x32_bf16 a[8:11], a[204:207], a[176:179], a[8:11]
    ds_read_b64_tr_b16 a[218:219], v204 offset:15360
    v_mfma_f32_16x16x32_bf16 a[40:43], a[212:215], a[176:179], a[40:43]
    ds_read_b64_tr_b16 a[220:221], v204 offset:34816
    v_mfma_f32_16x16x32_bf16 a[40:43], a[208:211], a[144:147], a[40:43]
    ds_read_b64_tr_b16 a[222:223], v204 offset:35840
    v_mfma_f32_16x16x32_bf16 a[44:47], a[208:211], a[148:151], a[44:47]
    v_mfma_f32_16x16x32_bf16 a[44:47], a[212:215], a[180:183], a[44:47]
    ds_read_b64_tr_b16 a[228:229], v205 offset:34848
    v_mfma_f32_16x16x32_bf16 a[12:15], a[204:207], a[180:183], a[12:15]
    s_cmp_lt_u32 s76, 3
    s_cselect_b32 s84, s90, 2.0
    s_bfm_b64 exec, 28, 28
    buffer_load_dword v236, v197, s[52:55], s84 offen
    s_mov_b64 exec, -1
    s_add_u32 s90, s90, 917504
    v_mfma_f32_16x16x32_bf16 a[12:15], a[200:203], a[148:151], a[12:15]
    s_waitcnt lgkmcnt(9)
    v_mfma_f32_16x16x32_bf16 a[16:19], a[200:203], a[152:155], a[16:19]
    ds_read_b64_tr_b16 a[230:231], v205 offset:35872
    v_mfma_f32_16x16x32_bf16 a[16:19], a[204:207], a[184:187], a[16:19]
    ds_read_b64_tr_b16 a[224:225], v205 offset:14368
    v_mfma_f32_16x16x32_bf16 a[48:51], a[212:215], a[184:187], a[48:51]
    v_mfma_f32_16x16x32_bf16 a[48:51], a[208:211], a[152:155], a[48:51]
    ds_read_b64_tr_b16 a[226:227], v205 offset:15392
    v_mfma_f32_16x16x32_bf16 a[52:55], a[208:211], a[156:159], a[52:55]
    v_mfma_f32_16x16x32_bf16 a[52:55], a[212:215], a[188:191], a[52:55]
    v_mfma_f32_16x16x32_bf16 a[20:23], a[204:207], a[188:191], a[20:23]
    v_mfma_f32_16x16x32_bf16 a[20:23], a[200:203], a[156:159], a[20:23]
    s_waitcnt lgkmcnt(8)
    v_mfma_f32_16x16x32_bf16 a[24:27], a[200:203], a[160:163], a[24:27]
    v_mfma_f32_16x16x32_bf16 a[24:27], a[204:207], a[192:195], a[24:27]
    v_mfma_f32_16x16x32_bf16 a[56:59], a[212:215], a[192:195], a[56:59]
    v_mfma_f32_16x16x32_bf16 a[56:59], a[208:211], a[160:163], a[56:59]
    v_mfma_f32_16x16x32_bf16 a[60:63], a[208:211], a[164:167], a[60:63]
    v_mfma_f32_16x16x32_bf16 a[60:63], a[212:215], a[196:199], a[60:63]
    s_cmp_eq_u32 s76, s82
    s_cselect_b64 vcc, -1, 0
    v_mfma_f32_16x16x32_bf16 a[28:31], a[204:207], a[196:199], a[28:31]
    s_cbranch_vccnz L_skh1_00
L_sbh1_00:
    v_mfma_f32_16x16x32_bf16 a[28:31], a[200:203], a[164:167], a[28:31]
    s_waitcnt lgkmcnt(0)
    v_mfma_f32_16x16x32_bf16 v[92:95], a[216:219], a[164:167], v[92:95]
    v_mfma_f32_16x16x32_bf16 v[92:95], a[220:223], a[196:199], v[92:95]
    v_mfma_f32_16x16x32_bf16 v[124:127], a[228:231], a[196:199], v[124:127]
    v_mfma_f32_16x16x32_bf16 v[124:127], a[224:227], a[164:167], v[124:127]
    v_mfma_f32_16x16x32_bf16 v[120:123], a[224:227], a[160:163], v[120:123]
    v_mfma_f32_16x16x32_bf16 v[120:123], a[228:231], a[192:195], v[120:123]
    v_mfma_f32_16x16x32_bf16 v[88:91], a[220:223], a[192:195], v[88:91]
    v_mfma_f32_16x16x32_bf16 v[88:91], a[216:219], a[160:163], v[88:91]
    v_mfma_f32_16x16x32_bf16 v[84:87], a[216:219], a[156:159], v[84:87]
    v_mfma_f32_16x16x32_bf16 v[84:87], a[220:223], a[188:191], v[84:87]
    v_mfma_f32_16x16x32_bf16 v[116:119], a[228:231], a[188:191], v[116:119]
    v_mfma_f32_16x16x32_bf16 v[116:119], a[224:227], a[156:159], v[116:119]
    v_mfma_f32_16x16x32_bf16 v[112:115], a[224:227], a[152:155], v[112:115]
    v_mfma_f32_16x16x32_bf16 v[112:115], a[228:231], a[184:187], v[112:115]
    v_mfma_f32_16x16x32_bf16 v[80:83], a[220:223], a[184:187], v[80:83]
    v_mfma_f32_16x16x32_bf16 v[80:83], a[216:219], a[152:155], v[80:83]
    s_add_u32 s76, s76, 1
    s_cmp_eq_u32 s76, 7
    s_cbranch_scc1 L_tail1
    s_cmp_lg_u32 s76, s81
    s_cbranch_scc1 L_nw1
    s_lshl_b32 s84, s83, 8
    s_add_u32 s72, s72, s84
    s_mul_i32 s84, s83, 917504
    s_add_u32 s75, s75, s84
    s_mov_b32 s81, 4
    s_mov_b32 s83, -6
L_nw1:
    s_waitcnt vmcnt(19)
    s_barrier
    v_mfma_f32_16x16x32_bf16 v[76:79], a[216:219], a[148:151], v[76:79]
    ds_read_b64_tr_b16 a[200:201], v204 offset:16384
    v_mfma_f32_16x16x32_bf16 v[76:79], a[220:223], a[180:183], v[76:79]
    s_cmp_eq_u32 s76, 5
    s_cselect_b32 s84, s88, 2.0
    buffer_store_dwordx2 v[238:239], v207, s[44:47], s84 offen sc1
    v_mfma_f32_16x16x32_bf16 v[108:111], a[228:231], a[180:183], v[108:111]
    ds_read_b64_tr_b16 a[202:203], v204 offset:17408
    v_mfma_f32_16x16x32_bf16 v[108:111], a[224:227], a[148:151], v[108:111]
    ds_read_b64_tr_b16 a[204:205], v204 offset:36864
    v_mfma_f32_16x16x32_bf16 v[104:107], a[224:227], a[144:147], v[104:107]
    ds_read_b64_tr_b16 a[206:207], v204 offset:37888
    v_mfma_f32_16x16x32_bf16 v[104:107], a[228:231], a[176:179], v[104:107]
    ds_read_b64_tr_b16 a[212:213], v205 offset:36896
    v_mfma_f32_16x16x32_bf16 v[72:75], a[220:223], a[176:179], v[72:75]
    ds_read_b64_tr_b16 a[214:215], v205 offset:37920
    v_mfma_f32_16x16x32_bf16 v[72:75], a[216:219], a[144:147], v[72:75]
    ds_read_b64_tr_b16 a[208:209], v205 offset:16416
    v_mfma_f32_16x16x32_bf16 v[68:71], a[216:219], a[140:143], v[68:71]
    ds_read_b64_tr_b16 a[210:211], v205 offset:17440
    v_mfma_f32_16x16x32_bf16 v[68:71], a[220:223], a[172:175], v[68:71]
    s_mov_b32 m0, 2048
    v_mfma_f32_16x16x32_bf16 v[100:103], a[228:231], a[172:175], v[100:103]
    v_mfma_f32_16x16x32_bf16 v[100:103], a[224:227], a[140:143], v[100:103]
    buffer_load_dwordx4 v198, s[24:27], s72 offen lds
    v_mfma_f32_16x16x32_bf16 v[96:99], a[224:227], a[136:139], v[96:99]
    v_mfma_f32_16x16x32_bf16 v[96:99], a[228:231], a[168:171], v[96:99]
    v_mfma_f32_16x16x32_bf16 v[64:67], a[220:223], a[168:171], v[64:67]
    s_mov_b32 m0, 3072
    v_mfma_f32_16x16x32_bf16 v[64:67], a[216:219], a[136:139], v[64:67]
    s_waitcnt lgkmcnt(4)
    v_mfma_f32_16x16x32_bf16 v[128:131], a[136:139], a[200:203], v[128:131]
    ds_read_b64_tr_b16 a[216:217], v204 offset:12288
    v_mfma_f32_16x16x32_bf16 v[128:131], a[168:171], a[204:207], v[128:131]
    s_waitcnt lgkmcnt(1)
    v_mfma_f32_16x16x32_bf16 v[160:163], a[168:171], a[212:215], v[160:163]
    buffer_load_dwordx4 v199, s[24:27], s72 offen lds
    v_mfma_f32_16x16x32_bf16 v[160:163], a[136:139], a[208:211], v[160:163]
    ds_read_b64_tr_b16 a[218:219], v204 offset:13312
    v_mfma_f32_16x16x32_bf16 v[164:167], a[140:143], a[208:211], v[164:167]
    s_add_u32 s72, s72, 32768
    v_mfma_f32_16x16x32_bf16 v[164:167], a[172:175], a[212:215], v[164:167]
    ds_read_b64_tr_b16 a[220:221], v204 offset:32768
    v_mfma_f32_16x16x32_bf16 v[132:135], a[172:175], a[204:207], v[132:135]
    s_mov_b32 m0, 4096
    v_mfma_f32_16x16x32_bf16 v[132:135], a[140:143], a[200:203], v[132:135]
    ds_read_b64_tr_b16 a[222:223], v204 offset:33792
    v_mfma_f32_16x16x32_bf16 v[136:139], a[144:147], a[200:203], v[136:139]
    v_mfma_f32_16x16x32_bf16 v[136:139], a[176:179], a[204:207], v[136:139]
    buffer_load_dwordx4 v198, s[24:27], s72 offen lds
    v_mfma_f32_16x16x32_bf16 v[168:171], a[176:179], a[212:215], v[168:171]
    ds_read_b64_tr_b16 a[228:229], v205 offset:32800
    v_mfma_f32_16x16x32_bf16 v[168:171], a[144:147], a[208:211], v[168:171]
    v_mfma_f32_16x16x32_bf16 v[172:175], a[148:151], a[208:211], v[172:175]
    ds_read_b64_tr_b16 a[230:231], v205 offset:33824
    v_mfma_f32_16x16x32_bf16 v[172:175], a[180:183], a[212:215], v[172:175]
    s_mov_b32 m0, 5120
    v_mfma_f32_16x16x32_bf16 v[140:143], a[180:183], a[204:207], v[140:143]
    ds_read_b64_tr_b16 a[224:225], v205 offset:12320
    v_mfma_f32_16x16x32_bf16 v[140:143], a[148:151], a[200:203], v[140:143]
    buffer_load_dwordx4 v199, s[24:27], s72 offen lds
    v_mfma_f32_16x16x32_bf16 v[144:147], a[152:155], a[200:203], v[144:147]
    ds_read_b64_tr_b16 a[226:227], v205 offset:13344
    v_mfma_f32_16x16x32_bf16 v[144:147], a[184:187], a[204:207], v[144:147]
    s_add_u32 s72, s72, 4294934656
    v_mfma_f32_16x16x32_bf16 v[176:179], a[184:187], a[212:215], v[176:179]
    v_mfma_f32_16x16x32_bf16 v[176:179], a[152:155], a[208:211], v[176:179]
    v_mfma_f32_16x16x32_bf16 v[180:183], a[156:159], a[208:211], v[180:183]
    s_mov_b32 m0, 122880
    v_mfma_f32_16x16x32_bf16 v[180:183], a[188:191], a[212:215], v[180:183]
    v_mfma_f32_16x16x32_bf16 v[148:151], a[188:191], a[204:207], v[148:151]
    v_mfma_f32_16x16x32_bf16 v[148:151], a[156:159], a[200:203], v[148:151]
    buffer_load_dwordx4 v192, s[32:35], s75 offen lds
    v_mfma_f32_16x16x32_bf16 v[152:155], a[160:163], a[200:203], v[152:155]
    v_mfma_f32_16x16x32_bf16 v[152:155], a[192:195], a[204:207], v[152:155]
    s_mov_b32 m0, 123904
    v_mfma_f32_16x16x32_bf16 v[184:187], a[192:195], a[212:215], v[184:187]
    v_mfma_f32_16x16x32_bf16 v[184:187], a[160:163], a[208:211], v[184:187]
    v_mfma_f32_16x16x32_bf16 v[188:191], a[164:167], a[208:211], v[188:191]
    buffer_load_dwordx4 v193, s[32:35], s75 offen lds
    v_mfma_f32_16x16x32_bf16 v[188:191], a[196:199], a[212:215], v[188:191]
    v_mfma_f32_16x16x32_bf16 v[156:159], a[196:199], a[204:207], v[156:159]
    s_cbranch_vccnz L_skh1_02
L_sbh1_02:
    v_mfma_f32_16x16x32_bf16 v[156:159], a[164:167], a[200:203], v[156:159]
    s_waitcnt lgkmcnt(0)
    v_mfma_f32_16x16x32_bf16 v[28:31], a[216:219], a[164:167], v[28:31]
    s_mov_b32 m0, 124928
    v_mfma_f32_16x16x32_bf16 v[28:31], a[220:223], a[196:199], v[28:31]
    ds_read_b64_tr_b16 a[200:201], v206 offset:20480
    v_mfma_f32_16x16x32_bf16 v[60:63], a[228:231], a[196:199], v[60:63]
    buffer_load_dwordx4 v194, s[32:35], s75 offen lds
    v_mfma_f32_16x16x32_bf16 v[60:63], a[224:227], a[164:167], v[60:63]
    ds_read_b64_tr_b16 a[202:203], v206 offset:24064
    v_mfma_f32_16x16x32_bf16 v[56:59], a[224:227], a[160:163], v[56:59]
    s_add_u32 s75, s75, 229376
    v_mfma_f32_16x16x32_bf16 v[56:59], a[228:231], a[192:195], v[56:59]
    ds_read_b64_tr_b16 a[204:205], v206 offset:27648
    v_mfma_f32_16x16x32_bf16 v[24:27], a[220:223], a[192:195], v[24:27]
    v_mfma_f32_16x16x32_bf16 v[24:27], a[216:219], a[160:163], v[24:27]
    ds_read_b64_tr_b16 a[206:207], v206 offset:31232
    v_mfma_f32_16x16x32_bf16 v[20:23], a[216:219], a[156:159], v[20:23]
    s_mov_b32 m0, 130048
    v_mfma_f32_16x16x32_bf16 v[20:23], a[220:223], a[188:191], v[20:23]
    ds_read_b64_tr_b16 a[212:213], v206 offset:27680
    v_mfma_f32_16x16x32_bf16 v[52:55], a[228:231], a[188:191], v[52:55]
    buffer_load_dwordx4 v192, s[32:35], s75 offen lds
    v_mfma_f32_16x16x32_bf16 v[52:55], a[224:227], a[156:159], v[52:55]
    v_mfma_f32_16x16x32_bf16 v[48:51], a[224:227], a[152:155], v[48:51]
    ds_read_b64_tr_b16 a[214:215], v206 offset:31264
    v_mfma_f32_16x16x32_bf16 v[48:51], a[228:231], a[184:187], v[48:51]
    s_mov_b32 m0, 131072
    v_mfma_f32_16x16x32_bf16 v[16:19], a[220:223], a[184:187], v[16:19]
    ds_read_b64_tr_b16 a[208:209], v206 offset:20512
    v_mfma_f32_16x16x32_bf16 v[16:19], a[216:219], a[152:155], v[16:19]
    buffer_load_dwordx4 v193, s[32:35], s75 offen lds
    v_mfma_f32_16x16x32_bf16 v[12:15], a[216:219], a[148:151], v[12:15]
    ds_read_b64_tr_b16 a[210:211], v206 offset:24096
    v_mfma_f32_16x16x32_bf16 v[12:15], a[220:223], a[180:183], v[12:15]
    v_mfma_f32_16x16x32_bf16 v[44:47], a[228:231], a[180:183], v[44:47]
    s_mov_b32 m0, 132096
    v_mfma_f32_16x16x32_bf16 v[44:47], a[224:227], a[148:151], v[44:47]
    v_mfma_f32_16x16x32_bf16 v[40:43], a[224:227], a[144:147], v[40:43]
    v_mfma_f32_16x16x32_bf16 v[40:43], a[228:231], a[176:179], v[40:43]
    buffer_load_dwordx4 v194, s[32:35], s75 offen lds
    v_mfma_f32_16x16x32_bf16 v[8:11], a[220:223], a[176:179], v[8:11]
    v_mfma_f32_16x16x32_bf16 v[8:11], a[216:219], a[144:147], v[8:11]
    v_mfma_f32_16x16x32_bf16 v[4:7], a[216:219], a[140:143], v[4:7]
    s_sub_u32 s75, s75, 229376
    v_mfma_f32_16x16x32_bf16 v[4:7], a[220:223], a[172:175], v[4:7]
    v_mfma_f32_16x16x32_bf16 v[36:39], a[228:231], a[172:175], v[36:39]
    v_mfma_f32_16x16x32_bf16 v[36:39], a[224:227], a[140:143], v[36:39]
    v_mfma_f32_16x16x32_bf16 v[32:35], a[224:227], a[136:139], v[32:35]
    v_mfma_f32_16x16x32_bf16 v[32:35], a[228:231], a[168:171], v[32:35]
    v_mfma_f32_16x16x32_bf16 v[0:3], a[220:223], a[168:171], v[0:3]
    v_mfma_f32_16x16x32_bf16 v[0:3], a[216:219], a[136:139], v[0:3]
    s_waitcnt vmcnt(19) lgkmcnt(0)
    s_barrier
    v_mfma_f32_16x16x32_bf16 a[64:67], a[200:203], a[136:139], a[64:67]
    ds_read_b64_tr_b16 a[216:217], v206 offset:49152
    v_mfma_f32_16x16x32_bf16 a[64:67], a[204:207], a[168:171], a[64:67]
    s_mov_b32 m0, 108544
    v_mfma_f32_16x16x32_bf16 a[96:99], a[212:215], a[168:171], a[96:99]
    ds_read_b64_tr_b16 a[218:219], v206 offset:52736
    v_mfma_f32_16x16x32_bf16 a[96:99], a[208:211], a[136:139], a[96:99]
    ds_read_b64_tr_b16 a[220:221], v206 offset:56320
    v_mfma_f32_16x16x32_bf16 a[100:103], a[208:211], a[140:143], a[100:103]
    buffer_load_dwordx4 v192, s[36:39], s75 offen lds
    v_mfma_f32_16x16x32_bf16 a[100:103], a[212:215], a[172:175], a[100:103]
    ds_read_b64_tr_b16 a[222:223], v206 offset:59904
    v_mfma_f32_16x16x32_bf16 a[68:71], a[204:207], a[172:175], a[68:71]
    ds_read_b64_tr_b16 a[228:229], v206 offset:56352
    v_mfma_f32_16x16x32_bf16 a[68:71], a[200:203], a[140:143], a[68:71]
    s_mov_b32 m0, 109568
    v_mfma_f32_16x16x32_bf16 a[72:75], a[200:203], a[144:147], a[72:75]
    ds_read_b64_tr_b16 a[230:231], v206 offset:59936
    v_mfma_f32_16x16x32_bf16 a[72:75], a[204:207], a[176:179], a[72:75]
    ds_read_b64_tr_b16 a[224:225], v206 offset:49184
    v_mfma_f32_16x16x32_bf16 a[104:107], a[212:215], a[176:179], a[104:107]
    ds_read_b128 a[136:139], v200 offset:32768
    v_mfma_f32_16x16x32_bf16 a[104:107], a[208:211], a[144:147], a[104:107]
    buffer_load_dwordx4 v193, s[36:39], s75 offen lds
    v_mfma_f32_16x16x32_bf16 a[108:111], a[208:211], a[148:151], a[108:111]
    ds_read_b64_tr_b16 a[226:227], v206 offset:52768
    v_mfma_f32_16x16x32_bf16 a[108:111], a[212:215], a[180:183], a[108:111]
    ds_read_b128 a[168:171], v201 offset:32768
    v_mfma_f32_16x16x32_bf16 a[76:79], a[204:207], a[180:183], a[76:79]
    s_mov_b32 m0, 110592
    v_mfma_f32_16x16x32_bf16 a[76:79], a[200:203], a[148:151], a[76:79]
    ds_read_b128 a[140:143], v200 offset:34816
    v_mfma_f32_16x16x32_bf16 a[80:83], a[200:203], a[152:155], a[80:83]
    buffer_load_dwordx4 v194, s[36:39], s75 offen lds
    v_mfma_f32_16x16x32_bf16 a[80:83], a[204:207], a[184:187], a[80:83]
    ds_read_b128 a[172:175], v201 offset:34816
    v_mfma_f32_16x16x32_bf16 a[112:115], a[212:215], a[184:187], a[112:115]
    s_add_u32 s75, s75, 229376
    v_mfma_f32_16x16x32_bf16 a[112:115], a[208:211], a[152:155], a[112:115]
    ds_read_b128 a[144:147], v200 offset:36864
    v_mfma_f32_16x16x32_bf16 a[116:119], a[208:211], a[156:159], a[116:119]
    s_mov_b32 m0, 115712
    v_mfma_f32_16x16x32_bf16 a[116:119], a[212:215], a[188:191], a[116:119]
    ds_read_b128 a[176:179], v201 offset:36864
    v_mfma_f32_16x16x32_bf16 a[84:87], a[204:207], a[188:191], a[84:87]
    buffer_load_dwordx4 v192, s[36:39], s75 offen lds
    v_mfma_f32_16x16x32_bf16 a[84:87], a[200:203], a[156:159], a[84:87]
    ds_read_b128 a[148:151], v200 offset:38912
    v_mfma_f32_16x16x32_bf16 a[88:91], a[200:203], a[160:163], a[88:91]
    s_mov_b32 m0, 116736
    v_mfma_f32_16x16x32_bf16 a[88:91], a[204:207], a[192:195], a[88:91]
    ds_read_b128 a[180:183], v201 offset:38912
    v_mfma_f32_16x16x32_bf16 a[120:123], a[212:215], a[192:195], a[120:123]
    buffer_load_dwordx4 v193, s[36:39], s75 offen lds
    v_mfma_f32_16x16x32_bf16 a[120:123], a[208:211], a[160:163], a[120:123]
    ds_read_b128 a[152:155], v200 offset:40960
    v_mfma_f32_16x16x32_bf16 a[124:127], a[208:211], a[164:167], a[124:127]
    s_mov_b32 m0, 117760
    v_mfma_f32_16x16x32_bf16 a[124:127], a[212:215], a[196:199], a[124:127]
    ds_read_b128 a[184:187], v201 offset:40960
    v_mfma_f32_16x16x32_bf16 a[92:95], a[204:207], a[196:199], a[92:95]
    s_cbranch_vccnz L_skh1_04
L_sbh1_04:
    v_mfma_f32_16x16x32_bf16 a[92:95], a[200:203], a[164:167], a[92:95]
    s_waitcnt lgkmcnt(6)
    v_mfma_f32_16x16x32_bf16 a[0:3], a[216:219], a[136:139], a[0:3]
    buffer_load_dwordx4 v194, s[36:39], s75 offen lds
    v_mfma_f32_16x16x32_bf16 a[0:3], a[220:223], a[168:171], a[0:3]
    ds_read_b128 a[156:159], v200 offset:43008
    v_mfma_f32_16x16x32_bf16 a[32:35], a[228:231], a[168:171], a[32:35]
    s_add_u32 s75, s75, 229376
    v_mfma_f32_16x16x32_bf16 a[32:35], a[224:227], a[136:139], a[32:35]
    ds_read_b128 a[188:191], v201 offset:43008
    v_mfma_f32_16x16x32_bf16 a[36:39], a[224:227], a[140:143], a[36:39]
    ds_read_b128 a[160:163], v200 offset:45056
    v_mfma_f32_16x16x32_bf16 a[36:39], a[228:231], a[172:175], a[36:39]
    ds_read_b128 a[192:195], v201 offset:45056
    v_mfma_f32_16x16x32_bf16 a[4:7], a[220:223], a[172:175], a[4:7]
    ds_read_b128 a[164:167], v200 offset:47104
    v_mfma_f32_16x16x32_bf16 a[4:7], a[216:219], a[140:143], a[4:7]
    s_waitcnt lgkmcnt(7)
    v_mfma_f32_16x16x32_bf16 a[8:11], a[216:219], a[144:147], a[8:11]
    ds_read_b128 a[196:199], v201 offset:47104
    v_mfma_f32_16x16x32_bf16 a[8:11], a[220:223], a[176:179], a[8:11]
    ds_read_b64_tr_b16 a[200:201], v204 offset:2048
    v_mfma_f32_16x16x32_bf16 a[40:43], a[228:231], a[176:179], a[40:43]
    ds_read_b64_tr_b16 a[202:203], v204 offset:3072
    v_mfma_f32_16x16x32_bf16 a[40:43], a[224:227], a[144:147], a[40:43]
    ds_read_b64_tr_b16 a[204:205], v204 offset:8192
    v_mfma_f32_16x16x32_bf16 a[44:47], a[224:227], a[148:151], a[44:47]
    ds_read_b64_tr_b16 a[206:207], v204 offset:9216
    v_mfma_f32_16x16x32_bf16 a[44:47], a[228:231], a[180:183], a[44:47]
    ds_read_b64_tr_b16 a[212:213], v205 offset:8224
    v_mfma_f32_16x16x32_bf16 a[12:15], a[220:223], a[180:183], a[12:15]
    s_cmp_lt_u32 s76, 3
    s_cselect_b32 s84, s90, 2.0
    s_bfm_b64 exec, 28, 0
    buffer_load_dword v236, v197, s[52:55], s84 offen
    s_mov_b64 exec, -1
    v_mfma_f32_16x16x32_bf16 a[12:15], a[216:219], a[148:151], a[12:15]
    s_waitcnt lgkmcnt(9)
    v_mfma_f32_16x16x32_bf16 a[16:19], a[216:219], a[152:155], a[16:19]
    ds_read_b64_tr_b16 a[214:215], v205 offset:9248
    v_mfma_f32_16x16x32_bf16 a[16:19], a[220:223], a[184:187], a[16:19]
    ds_read_b64_tr_b16 a[208:209], v205 offset:2080
    v_mfma_f32_16x16x32_bf16 a[48:51], a[228:231], a[184:187], a[48:51]
    v_mfma_f32_16x16x32_bf16 a[48:51], a[224:227], a[152:155], a[48:51]
    ds_read_b64_tr_b16 a[210:211], v205 offset:3104
    v_mfma_f32_16x16x32_bf16 a[52:55], a[224:227], a[156:159], a[52:55]
    v_mfma_f32_16x16x32_bf16 a[52:55], a[228:231], a[188:191], a[52:55]
    v_mfma_f32_16x16x32_bf16 a[20:23], a[220:223], a[188:191], a[20:23]
    v_mfma_f32_16x16x32_bf16 a[20:23], a[216:219], a[156:159], a[20:23]
    s_waitcnt lgkmcnt(8)
    v_mfma_f32_16x16x32_bf16 a[24:27], a[216:219], a[160:163], a[24:27]
    v_mfma_f32_16x16x32_bf16 a[24:27], a[220:223], a[192:195], a[24:27]
    v_mfma_f32_16x16x32_bf16 a[56:59], a[228:231], a[192:195], a[56:59]
    v_mfma_f32_16x16x32_bf16 a[56:59], a[224:227], a[160:163], a[56:59]
    v_mfma_f32_16x16x32_bf16 a[60:63], a[224:227], a[164:167], a[60:63]
    v_mfma_f32_16x16x32_bf16 a[60:63], a[228:231], a[196:199], a[60:63]
    v_mfma_f32_16x16x32_bf16 a[28:31], a[220:223], a[196:199], a[28:31]
    s_cmp_eq_u32 s76, 4
    s_cselect_b32 s93, s92, 2.0
    buffer_load_dwordx4 v[232:235], v238, s[24:27], s93 offen offset:0
    v_mfma_f32_16x16x32_bf16 a[28:31], a[216:219], a[164:167], a[28:31]
    s_waitcnt lgkmcnt(0)
    v_mfma_f32_16x16x32_bf16 v[92:95], a[200:203], a[164:167], v[92:95]
    v_mfma_f32_16x16x32_bf16 v[92:95], a[204:207], a[196:199], v[92:95]
    v_mfma_f32_16x16x32_bf16 v[124:127], a[212:215], a[196:199], v[124:127]
    buffer_load_dwordx4 v[240:243], v238, s[24:27], s93 offen offset:512
    v_mfma_f32_16x16x32_bf16 v[124:127], a[208:211], a[164:167], v[124:127]
    v_mfma_f32_16x16x32_bf16 v[120:123], a[208:211], a[160:163], v[120:123]
    v_mfma_f32_16x16x32_bf16 v[120:123], a[212:215], a[192:195], v[120:123]
    v_mfma_f32_16x16x32_bf16 v[88:91], a[204:207], a[192:195], v[88:91]
    buffer_load_dwordx4 v[244:247], v238, s[24:27], s93 offen offset:1024
    v_mfma_f32_16x16x32_bf16 v[88:91], a[200:203], a[160:163], v[88:91]
    v_mfma_f32_16x16x32_bf16 v[84:87], a[200:203], a[156:159], v[84:87]
    v_mfma_f32_16x16x32_bf16 v[84:87], a[204:207], a[188:191], v[84:87]
    v_mfma_f32_16x16x32_bf16 v[116:119], a[212:215], a[188:191], v[116:119]
    buffer_load_dwordx4 v[248:251], v238, s[24:27], s93 offen offset:1536
    v_mfma_f32_16x16x32_bf16 v[116:119], a[208:211], a[156:159], v[116:119]
    v_mfma_f32_16x16x32_bf16 v[112:115], a[208:211], a[152:155], v[112:115]
    v_mfma_f32_16x16x32_bf16 v[112:115], a[212:215], a[184:187], v[112:115]
    v_mfma_f32_16x16x32_bf16 v[80:83], a[204:207], a[184:187], v[80:83]
    v_mfma_f32_16x16x32_bf16 v[80:83], a[200:203], a[152:155], v[80:83]
    s_branch L_g1_loop1
L_tail1:
    s_waitcnt vmcnt(23)
    s_barrier
    v_mfma_f32_16x16x32_bf16 v[76:79], a[216:219], a[148:151], v[76:79]
    ds_read_b64_tr_b16 a[200:201], v204 offset:16384
    v_mfma_f32_16x16x32_bf16 v[76:79], a[220:223], a[180:183], v[76:79]
    ds_read_b64_tr_b16 a[202:203], v204 offset:17408
    v_mfma_f32_16x16x32_bf16 v[108:111], a[228:231], a[180:183], v[108:111]
    ds_read_b64_tr_b16 a[204:205], v204 offset:36864
    v_mfma_f32_16x16x32_bf16 v[108:111], a[224:227], a[148:151], v[108:111]
    ds_read_b64_tr_b16 a[206:207], v204 offset:37888
    v_mfma_f32_16x16x32_bf16 v[104:107], a[224:227], a[144:147], v[104:107]
    ds_read_b64_tr_b16 a[212:213], v205 offset:36896
    v_mfma_f32_16x16x32_bf16 v[104:107], a[228:231], a[176:179], v[104:107]
    ds_read_b64_tr_b16 a[214:215], v205 offset:37920
    v_mfma_f32_16x16x32_bf16 v[72:75], a[220:223], a[176:179], v[72:75]
    ds_read_b64_tr_b16 a[208:209], v205 offset:16416
    v_mfma_f32_16x16x32_bf16 v[72:75], a[216:219], a[144:147], v[72:75]
    ds_read_b64_tr_b16 a[210:211], v205 offset:17440
    v_mfma_f32_16x16x32_bf16 v[68:71], a[216:219], a[140:143], v[68:71]
    v_lshrrev_b32 v203, 1, v254
    v_mfma_f32_16x16x32_bf16 v[68:71], a[220:223], a[172:175], v[68:71]
    v_min_u32 v202, 624, v254
    v_mfma_f32_16x16x32_bf16 v[100:103], a[228:231], a[172:175], v[100:103]
    buffer_load_dwordx2 v[224:225], v203, s[44:47], s4 offen sc1
    v_mfma_f32_16x16x32_bf16 v[100:103], a[224:227], a[140:143], v[100:103]
    v_and_b32 v226, 0x78, v203
    v_mfma_f32_16x16x32_bf16 v[96:99], a[224:227], a[136:139], v[96:99]
    buffer_load_dwordx2 v[226:227], v226, s[44:47], s5 offen sc1
    v_mfma_f32_16x16x32_bf16 v[96:99], a[228:231], a[168:171], v[96:99]
    buffer_load_dwordx4 v[208:211], v202, s[44:47], s6 offen offset:0 sc1
    v_mfma_f32_16x16x32_bf16 v[64:67], a[220:223], a[168:171], v[64:67]
    buffer_load_dwordx4 v[192:195], v202, s[44:47], s6 offen offset:2560 sc1
    v_mfma_f32_16x16x32_bf16 v[64:67], a[216:219], a[136:139], v[64:67]
    s_waitcnt lgkmcnt(4)
    v_mfma_f32_16x16x32_bf16 v[128:131], a[136:139], a[200:203], v[128:131]
    ds_read_b64_tr_b16 a[216:217], v204 offset:12288
    v_mfma_f32_16x16x32_bf16 v[128:131], a[168:171], a[204:207], v[128:131]
    s_waitcnt lgkmcnt(1)
    v_mfma_f32_16x16x32_bf16 v[160:163], a[168:171], a[212:215], v[160:163]
    s_add_u32 s75, s6, 5120
    v_mfma_f32_16x16x32_bf16 v[160:163], a[136:139], a[208:211], v[160:163]
    ds_read_b64_tr_b16 a[218:219], v204 offset:13312
    v_mfma_f32_16x16x32_bf16 v[164:167], a[140:143], a[208:211], v[164:167]
    buffer_load_dwordx4 v[196:199], v202, s[44:47], s75 offen offset:0 sc1
    v_mfma_f32_16x16x32_bf16 v[164:167], a[172:175], a[212:215], v[164:167]
    ds_read_b64_tr_b16 a[220:221], v204 offset:32768
    v_mfma_f32_16x16x32_bf16 v[132:135], a[172:175], a[204:207], v[132:135]
    buffer_load_dwordx4 v[212:215], v202, s[44:47], s75 offen offset:2560 sc1
    v_mfma_f32_16x16x32_bf16 v[132:135], a[140:143], a[200:203], v[132:135]
    ds_read_b64_tr_b16 a[222:223], v204 offset:33792
    v_mfma_f32_16x16x32_bf16 v[136:139], a[144:147], a[200:203], v[136:139]
    s_add_u32 s75, s6, 10240
    v_mfma_f32_16x16x32_bf16 v[136:139], a[176:179], a[204:207], v[136:139]
    ds_read_b64_tr_b16 a[228:229], v205 offset:32800
    v_mfma_f32_16x16x32_bf16 v[168:171], a[176:179], a[212:215], v[168:171]
    buffer_load_dwordx4 v[216:219], v202, s[44:47], s75 offen offset:0 sc1
    v_mfma_f32_16x16x32_bf16 v[168:171], a[144:147], a[208:211], v[168:171]
    buffer_load_dwordx4 v[220:223], v202, s[44:47], s75 offen offset:2560 sc1
    v_mfma_f32_16x16x32_bf16 v[172:175], a[148:151], a[208:211], v[172:175]
    ds_read_b64_tr_b16 a[230:231], v205 offset:33824
    v_mfma_f32_16x16x32_bf16 v[172:175], a[180:183], a[212:215], v[172:175]
    s_add_u32 s75, s6, 15360
    v_mfma_f32_16x16x32_bf16 v[140:143], a[180:183], a[204:207], v[140:143]
    ds_read_b64_tr_b16 a[224:225], v205 offset:12320
    v_mfma_f32_16x16x32_bf16 v[140:143], a[148:151], a[200:203], v[140:143]
    buffer_load_dwordx4 v[228:231], v202, s[44:47], s75 offen offset:0 sc1
    v_mfma_f32_16x16x32_bf16 v[144:147], a[152:155], a[200:203], v[144:147]
    ds_read_b64_tr_b16 a[226:227], v205 offset:13344
    v_mfma_f32_16x16x32_bf16 v[144:147], a[184:187], a[204:207], v[144:147]
    s_waitcnt vmcnt(30)
    buffer_load_dwordx4 v[232:235], v202, s[44:47], s75 offen offset:2560 sc1
    v_mfma_f32_16x16x32_bf16 v[176:179], a[184:187], a[212:215], v[176:179]
    v_lshrrev_b32 v238, 2, v254
    v_mfma_f32_16x16x32_bf16 v[176:179], a[152:155], a[208:211], v[176:179]
    buffer_load_dword v238, v238, s[44:47], s77 offen offset:512 sc1
    v_mfma_f32_16x16x32_bf16 v[180:183], a[156:159], a[208:211], v[180:183]
    s_add_u32 s28, s7, 0
    v_mfma_f32_16x16x32_bf16 v[180:183], a[188:191], a[212:215], v[180:183]
    s_add_u32 s29, s7, 147456
    v_mfma_f32_16x16x32_bf16 v[148:151], a[188:191], a[204:207], v[148:151]
    s_add_u32 s30, s7, 294912
    v_mfma_f32_16x16x32_bf16 v[148:151], a[156:159], a[200:203], v[148:151]
    s_add_u32 s31, s7, 442368
    v_mfma_f32_16x16x32_bf16 v[152:155], a[160:163], a[200:203], v[152:155]
    s_add_u32 s32, s7, 589824
    v_mfma_f32_16x16x32_bf16 v[152:155], a[192:195], a[204:207], v[152:155]
    s_add_u32 s33, s7, 737280
    v_mfma_f32_16x16x32_bf16 v[184:187], a[192:195], a[212:215], v[184:187]
    s_add_u32 s34, s7, 884736
    v_mfma_f32_16x16x32_bf16 v[184:187], a[160:163], a[208:211], v[184:187]
    s_add_u32 s35, s7, 1032192
    v_mfma_f32_16x16x32_bf16 v[188:191], a[164:167], a[208:211], v[188:191]
    v_mfma_f32_16x16x32_bf16 v[188:191], a[196:199], a[212:215], v[188:191]
    s_waitcnt vmcnt(30)
    v_accvgpr_read_b32 v247, a237
    v_mfma_f32_16x16x32_bf16 v[156:159], a[196:199], a[204:207], v[156:159]
    v_mfma_f32_16x16x32_bf16 v[156:159], a[164:167], a[200:203], v[156:159]
    s_waitcnt lgkmcnt(0)
    v_mfma_f32_16x16x32_bf16 v[28:31], a[216:219], a[164:167], v[28:31]
    ds_read_b64_tr_b16 a[200:201], v206 offset:20480
    v_mfma_f32_16x16x32_bf16 v[28:31], a[220:223], a[196:199], v[28:31]
    v_accvgpr_read_b32 v244, a238
    v_mfma_f32_16x16x32_bf16 v[60:63], a[228:231], a[196:199], v[60:63]
    v_mfma_f32_16x16x32_bf16 v[60:63], a[224:227], a[164:167], v[60:63]
    ds_read_b64_tr_b16 a[202:203], v206 offset:24064
    v_mfma_f32_16x16x32_bf16 v[56:59], a[224:227], a[160:163], v[56:59]
    v_accvgpr_read_b32 v245, a239
    v_mfma_f32_16x16x32_bf16 v[56:59], a[228:231], a[192:195], v[56:59]
    ds_read_b64_tr_b16 a[204:205], v206 offset:27648
    v_mfma_f32_16x16x32_bf16 v[24:27], a[220:223], a[192:195], v[24:27]
    v_accvgpr_read_b32 v246, a240
    v_mfma_f32_16x16x32_bf16 v[24:27], a[216:219], a[160:163], v[24:27]
    ds_read_b64_tr_b16 a[206:207], v206 offset:31232
    v_mfma_f32_16x16x32_bf16 v[20:23], a[216:219], a[156:159], v[20:23]
    v_mfma_f32_16x16x32_bf16 v[20:23], a[220:223], a[188:191], v[20:23]
    ds_read_b64_tr_b16 a[212:213], v206 offset:27680
    v_mfma_f32_16x16x32_bf16 v[52:55], a[228:231], a[188:191], v[52:55]
    s_waitcnt vmcnt(29)
    v_accvgpr_read_b32 v248, a241
    v_mfma_f32_16x16x32_bf16 v[52:55], a[224:227], a[156:159], v[52:55]
    v_mfma_f32_16x16x32_bf16 v[48:51], a[224:227], a[152:155], v[48:51]
    ds_read_b64_tr_b16 a[214:215], v206 offset:31264
    v_mfma_f32_16x16x32_bf16 v[48:51], a[228:231], a[184:187], v[48:51]
    v_accvgpr_read_b32 v250, a242
    v_mfma_f32_16x16x32_bf16 v[16:19], a[220:223], a[184:187], v[16:19]
    ds_read_b64_tr_b16 a[208:209], v206 offset:20512
    v_mfma_f32_16x16x32_bf16 v[16:19], a[216:219], a[152:155], v[16:19]
    v_accvgpr_read_b32 v251, a243
    v_mfma_f32_16x16x32_bf16 v[12:15], a[216:219], a[148:151], v[12:15]
    ds_read_b64_tr_b16 a[210:211], v206 offset:24096
    v_mfma_f32_16x16x32_bf16 v[12:15], a[220:223], a[180:183], v[12:15]
    v_mfma_f32_16x16x32_bf16 v[44:47], a[228:231], a[180:183], v[44:47]
    v_accvgpr_read_b32 v240, a244
    v_mfma_f32_16x16x32_bf16 v[44:47], a[224:227], a[148:151], v[44:47]
    v_mfma_f32_16x16x32_bf16 v[40:43], a[224:227], a[144:147], v[40:43]
    v_mfma_f32_16x16x32_bf16 v[40:43], a[228:231], a[176:179], v[40:43]
    v_accvgpr_read_b32 v241, a245
    v_mfma_f32_16x16x32_bf16 v[8:11], a[220:223], a[176:179], v[8:11]
    v_mfma_f32_16x16x32_bf16 v[8:11], a[216:219], a[144:147], v[8:11]
    v_mfma_f32_16x16x32_bf16 v[4:7], a[216:219], a[140:143], v[4:7]
    v_accvgpr_read_b32 v242, a246
    v_mfma_f32_16x16x32_bf16 v[4:7], a[220:223], a[172:175], v[4:7]
    v_mfma_f32_16x16x32_bf16 v[36:39], a[228:231], a[172:175], v[36:39]
    v_mfma_f32_16x16x32_bf16 v[36:39], a[224:227], a[140:143], v[36:39]
    v_accvgpr_read_b32 v243, a247
    v_mfma_f32_16x16x32_bf16 v[32:35], a[224:227], a[136:139], v[32:35]
    v_mfma_f32_16x16x32_bf16 v[32:35], a[228:231], a[168:171], v[32:35]
    v_mfma_f32_16x16x32_bf16 v[0:3], a[220:223], a[168:171], v[0:3]
    v_mfma_f32_16x16x32_bf16 v[0:3], a[216:219], a[136:139], v[0:3]
    s_waitcnt vmcnt(19) lgkmcnt(0)
    s_barrier
    v_mfma_f32_16x16x32_bf16 a[64:67], a[200:203], a[136:139], a[64:67]
    ds_read_b64_tr_b16 a[216:217], v206 offset:49152
    v_mfma_f32_16x16x32_bf16 a[64:67], a[204:207], a[168:171], a[64:67]
    ds_read_b64_tr_b16 a[218:219], v206 offset:52736
    v_mfma_f32_16x16x32_bf16 a[96:99], a[212:215], a[168:171], a[96:99]
    ds_read_b64_tr_b16 a[220:221], v206 offset:56320
    v_mfma_f32_16x16x32_bf16 a[96:99], a[208:211], a[136:139], a[96:99]
    ds_read_b64_tr_b16 a[222:223], v206 offset:59904
    v_mfma_f32_16x16x32_bf16 a[100:103], a[208:211], a[140:143], a[100:103]
    ds_read_b64_tr_b16 a[228:229], v206 offset:56352
    v_mfma_f32_16x16x32_bf16 a[100:103], a[212:215], a[172:175], a[100:103]
    ds_read_b64_tr_b16 a[230:231], v206 offset:59936
    v_mfma_f32_16x16x32_bf16 a[68:71], a[204:207], a[172:175], a[68:71]
    ds_read_b64_tr_b16 a[224:225], v206 offset:49184
    v_mfma_f32_16x16x32_bf16 a[68:71], a[200:203], a[140:143], a[68:71]
    ds_read_b128 a[136:139], v200 offset:32768
    v_mfma_f32_16x16x32_bf16 a[72:75], a[200:203], a[144:147], a[72:75]
    ds_read_b64_tr_b16 a[226:227], v206 offset:52768
    v_mfma_f32_16x16x32_bf16 a[72:75], a[204:207], a[176:179], a[72:75]
    ds_read_b128 a[168:171], v201 offset:32768
    v_mfma_f32_16x16x32_bf16 a[104:107], a[212:215], a[176:179], a[104:107]
    ds_read_b128 a[140:143], v200 offset:34816
    v_mfma_f32_16x16x32_bf16 a[104:107], a[208:211], a[144:147], a[104:107]
    v_mfma_f32_16x16x32_bf16 a[108:111], a[208:211], a[148:151], a[108:111]
    ds_read_b128 a[172:175], v201 offset:34816
    v_mfma_f32_16x16x32_bf16 a[108:111], a[212:215], a[180:183], a[108:111]
    v_mfma_f32_16x16x32_bf16 a[76:79], a[204:207], a[180:183], a[76:79]
    ds_read_b128 a[144:147], v200 offset:36864
    v_mfma_f32_16x16x32_bf16 a[76:79], a[200:203], a[148:151], a[76:79]
    v_mfma_f32_16x16x32_bf16 a[80:83], a[200:203], a[152:155], a[80:83]
    ds_read_b128 a[176:179], v201 offset:36864
    v_mfma_f32_16x16x32_bf16 a[80:83], a[204:207], a[184:187], a[80:83]
    v_mfma_f32_16x16x32_bf16 a[112:115], a[212:215], a[184:187], a[112:115]
    ds_read_b128 a[148:151], v200 offset:38912
    v_mfma_f32_16x16x32_bf16 a[112:115], a[208:211], a[152:155], a[112:115]
    v_mfma_f32_16x16x32_bf16 a[116:119], a[208:211], a[156:159], a[116:119]
    ds_read_b128 a[180:183], v201 offset:38912
    v_mfma_f32_16x16x32_bf16 a[116:119], a[212:215], a[188:191], a[116:119]
    v_mfma_f32_16x16x32_bf16 a[84:87], a[204:207], a[188:191], a[84:87]
    ds_read_b128 a[152:155], v200 offset:40960
    v_mfma_f32_16x16x32_bf16 a[84:87], a[200:203], a[156:159], a[84:87]
    v_mfma_f32_16x16x32_bf16 a[88:91], a[200:203], a[160:163], a[88:91]
    ds_read_b128 a[184:187], v201 offset:40960
    v_mfma_f32_16x16x32_bf16 a[88:91], a[204:207], a[192:195], a[88:91]
    v_mfma_f32_16x16x32_bf16 a[120:123], a[212:215], a[192:195], a[120:123]
    ds_read_b128 a[156:159], v200 offset:43008
    v_mfma_f32_16x16x32_bf16 a[120:123], a[208:211], a[160:163], a[120:123]
    v_mfma_f32_16x16x32_bf16 a[124:127], a[208:211], a[164:167], a[124:127]
    ds_read_b128 a[188:191], v201 offset:43008
    v_mfma_f32_16x16x32_bf16 a[124:127], a[212:215], a[196:199], a[124:127]
    v_mfma_f32_16x16x32_bf16 a[92:95], a[204:207], a[196:199], a[92:95]
    ds_read_b128 a[160:163], v200 offset:45056
    v_mfma_f32_16x16x32_bf16 a[92:95], a[200:203], a[164:167], a[92:95]
    s_waitcnt lgkmcnt(9)
    v_mfma_f32_16x16x32_bf16 a[0:3], a[216:219], a[136:139], a[0:3]
    ds_read_b128 a[192:195], v201 offset:45056
    v_mfma_f32_16x16x32_bf16 a[0:3], a[220:223], a[168:171], a[0:3]
    v_mfma_f32_16x16x32_bf16 a[32:35], a[228:231], a[168:171], a[32:35]
    ds_read_b128 a[164:167], v200 offset:47104
    v_mfma_f32_16x16x32_bf16 a[32:35], a[224:227], a[136:139], a[32:35]
    v_mfma_f32_16x16x32_bf16 a[36:39], a[224:227], a[140:143], a[36:39]
    ds_read_b128 a[196:199], v201 offset:47104
    v_mfma_f32_16x16x32_bf16 a[36:39], a[228:231], a[172:175], a[36:39]
    ds_read_b64_tr_b16 a[200:201], v204 offset:2048
    v_mfma_f32_16x16x32_bf16 a[4:7], a[220:223], a[172:175], a[4:7]
    v_mfma_f32_16x16x32_bf16 a[4:7], a[216:219], a[140:143], a[4:7]
    s_waitcnt lgkmcnt(9)
    v_mfma_f32_16x16x32_bf16 a[8:11], a[216:219], a[144:147], a[8:11]
    ds_read_b64_tr_b16 a[202:203], v204 offset:3072
    v_mfma_f32_16x16x32_bf16 a[8:11], a[220:223], a[176:179], a[8:11]
    ds_read_b64_tr_b16 a[204:205], v204 offset:8192
    v_mfma_f32_16x16x32_bf16 a[40:43], a[228:231], a[176:179], a[40:43]
    s_waitcnt vmcnt(5)
    v_mfma_f32_16x16x32_bf16 a[40:43], a[224:227], a[144:147], a[40:43]
    ds_read_b64_tr_b16 a[206:207], v204 offset:9216
    v_mfma_f32_16x16x32_bf16 a[44:47], a[224:227], a[148:151], a[44:47]
    v_min3_u32 v252, v239, v225, v227
    v_mfma_f32_16x16x32_bf16 a[44:47], a[228:231], a[180:183], a[44:47]
    ds_read_b64_tr_b16 a[212:213], v205 offset:8224
    v_mfma_f32_16x16x32_bf16 a[12:15], a[220:223], a[180:183], a[12:15]
    v_max3_u32 v253, v239, v225, v227
    v_mfma_f32_16x16x32_bf16 a[12:15], a[216:219], a[148:151], a[12:15]
    s_waitcnt lgkmcnt(9)
    v_mfma_f32_16x16x32_bf16 a[16:19], a[216:219], a[152:155], a[16:19]
    ds_read_b64_tr_b16 a[214:215], v205 offset:9248
    v_mfma_f32_16x16x32_bf16 a[16:19], a[220:223], a[184:187], a[16:19]
    ds_read_b64_tr_b16 a[208:209], v205 offset:2080
    v_mfma_f32_16x16x32_bf16 a[48:51], a[228:231], a[184:187], a[48:51]
    v_min3_u32 v252, v252, v209, v211
    v_mfma_f32_16x16x32_bf16 a[48:51], a[224:227], a[152:155], a[48:51]
    ds_read_b64_tr_b16 a[210:211], v205 offset:3104
    v_mfma_f32_16x16x32_bf16 a[52:55], a[224:227], a[156:159], a[52:55]
    v_max3_u32 v253, v253, v209, v211
    v_mfma_f32_16x16x32_bf16 a[52:55], a[228:231], a[188:191], a[52:55]
    v_min3_u32 v252, v252, v193, v195
    v_mfma_f32_16x16x32_bf16 a[20:23], a[220:223], a[188:191], a[20:23]
    v_max3_u32 v253, v253, v193, v195
    v_mfma_f32_16x16x32_bf16 a[20:23], a[216:219], a[156:159], a[20:23]
    s_waitcnt lgkmcnt(8)
    v_mfma_f32_16x16x32_bf16 a[24:27], a[216:219], a[160:163], a[24:27]
    v_add_f32 v208, v208, v192
    v_mfma_f32_16x16x32_bf16 a[24:27], a[220:223], a[192:195], a[24:27]
    v_add_f32 v210, v210, v194
    v_mfma_f32_16x16x32_bf16 a[56:59], a[228:231], a[192:195], a[56:59]
    v_min3_u32 v252, v252, v197, v199
    v_mfma_f32_16x16x32_bf16 a[56:59], a[224:227], a[160:163], a[56:59]
    v_max3_u32 v253, v253, v197, v199
    v_mfma_f32_16x16x32_bf16 a[60:63], a[224:227], a[164:167], a[60:63]
    v_add_f32 v208, v208, v196
    v_mfma_f32_16x16x32_bf16 a[60:63], a[228:231], a[196:199], a[60:63]
    v_add_f32 v210, v210, v198
    v_mfma_f32_16x16x32_bf16 a[28:31], a[220:223], a[196:199], a[28:31]
    v_min3_u32 v252, v252, v213, v215
    v_mfma_f32_16x16x32_bf16 a[28:31], a[216:219], a[164:167], a[28:31]
    s_waitcnt lgkmcnt(0)
    v_mfma_f32_16x16x32_bf16 v[92:95], a[200:203], a[164:167], v[92:95]
    v_max3_u32 v253, v253, v213, v215
    v_mfma_f32_16x16x32_bf16 v[92:95], a[204:207], a[196:199], v[92:95]
    v_add_f32 v208, v208, v212
    v_mfma_f32_16x16x32_bf16 v[124:127], a[212:215], a[196:199], v[124:127]
    v_add_f32 v210, v210, v214
    v_mfma_f32_16x16x32_bf16 v[124:127], a[208:211], a[164:167], v[124:127]
    v_mfma_f32_16x16x32_bf16 v[120:123], a[208:211], a[160:163], v[120:123]
    s_waitcnt vmcnt(1)
    v_mfma_f32_16x16x32_bf16 v[120:123], a[212:215], a[192:195], v[120:123]
    v_min3_u32 v252, v252, v217, v219
    v_mfma_f32_16x16x32_bf16 v[88:91], a[204:207], a[192:195], v[88:91]
    v_mfma_f32_16x16x32_bf16 v[88:91], a[200:203], a[160:163], v[88:91]
    v_max3_u32 v253, v253, v217, v219
    v_mfma_f32_16x16x32_bf16 v[84:87], a[200:203], a[156:159], v[84:87]
    v_mfma_f32_16x16x32_bf16 v[84:87], a[204:207], a[188:191], v[84:87]
    v_mfma_f32_16x16x32_bf16 v[116:119], a[212:215], a[188:191], v[116:119]
    v_mfma_f32_16x16x32_bf16 v[116:119], a[208:211], a[156:159], v[116:119]
    v_mfma_f32_16x16x32_bf16 v[112:115], a[208:211], a[152:155], v[112:115]
    v_mfma_f32_16x16x32_bf16 v[112:115], a[212:215], a[184:187], v[112:115]
    v_mfma_f32_16x16x32_bf16 v[80:83], a[204:207], a[184:187], v[80:83]
    v_mfma_f32_16x16x32_bf16 v[80:83], a[200:203], a[152:155], v[80:83]
    s_barrier
    v_mfma_f32_16x16x32_bf16 v[76:79], a[200:203], a[148:151], v[76:79]
    ds_read_b64_tr_b16 a[216:217], v204 offset:4096
    s_mov_b64 s[52:53], s[8:9]
    s_mov_b32 s54, 2097152
    v_mfma_f32_16x16x32_bf16 v[76:79], a[204:207], a[180:183], v[76:79]
    ds_read_b64_tr_b16 a[218:219], v204 offset:5120
    v_readlane_b32 s92, v247, 0
    v_mfma_f32_16x16x32_bf16 v[108:111], a[212:215], a[180:183], v[108:111]
    ds_read_b64_tr_b16 a[220:221], v204 offset:10240
    s_add_u32 m0, s3, 98304
    v_mfma_f32_16x16x32_bf16 v[108:111], a[208:211], a[148:151], v[108:111]
    ds_read_b64_tr_b16 a[222:223], v204 offset:11264
    buffer_load_dwordx4 v244, s[48:51], s92 offen lds
    v_mfma_f32_16x16x32_bf16 v[104:107], a[208:211], a[144:147], v[104:107]
    ds_read_b64_tr_b16 a[228:229], v205 offset:10272
    v_add_f32 v208, v208, v216
    v_mfma_f32_16x16x32_bf16 v[104:107], a[212:215], a[176:179], v[104:107]
    ds_read_b64_tr_b16 a[230:231], v205 offset:11296
    v_add_f32 v210, v210, v218
    v_mfma_f32_16x16x32_bf16 v[72:75], a[204:207], a[176:179], v[72:75]
    ds_read_b64_tr_b16 a[224:225], v205 offset:4128
    v_min3_u32 v252, v252, v221, v223
    v_mfma_f32_16x16x32_bf16 v[72:75], a[200:203], a[144:147], v[72:75]
    ds_read_b64_tr_b16 a[226:227], v205 offset:5152
    v_max3_u32 v253, v253, v221, v223
    v_mfma_f32_16x16x32_bf16 v[68:71], a[200:203], a[140:143], v[68:71]
    v_add_f32 v208, v208, v220
    v_readlane_b32 s93, v247, 1
    v_mfma_f32_16x16x32_bf16 v[68:71], a[204:207], a[172:175], v[68:71]
    v_add_f32 v210, v210, v222
    s_add_u32 m0, s3, 100352
    v_mfma_f32_16x16x32_bf16 v[100:103], a[212:215], a[172:175], v[100:103]
    v_min3_u32 v252, v252, v229, v231
    v_mfma_f32_16x16x32_bf16 v[100:103], a[208:211], a[140:143], v[100:103]
    v_max3_u32 v253, v253, v229, v231
    v_mfma_f32_16x16x32_bf16 v[96:99], a[208:211], a[136:139], v[96:99]
    v_add_f32 v208, v208, v228
    v_mfma_f32_16x16x32_bf16 v[96:99], a[212:215], a[168:171], v[96:99]
    v_add_f32 v210, v210, v230
    v_mfma_f32_16x16x32_bf16 v[64:67], a[204:207], a[168:171], v[64:67]
    v_min3_u32 v252, v252, v233, v235
    v_mfma_f32_16x16x32_bf16 v[64:67], a[200:203], a[136:139], v[64:67]
    s_waitcnt lgkmcnt(4)
    v_mfma_f32_16x16x32_bf16 v[156:159], a[164:167], a[216:219], v[156:159]
    ds_read_b64_tr_b16 a[200:201], v204 offset:0
    v_mfma_f32_16x16x32_bf16 v[156:159], a[196:199], a[220:223], v[156:159]
    s_waitcnt lgkmcnt(1)
    v_mfma_f32_16x16x32_bf16 v[188:191], a[196:199], a[228:231], v[188:191]
    ds_read_b64_tr_b16 a[202:203], v204 offset:1024
    v_mfma_f32_16x16x32_bf16 v[188:191], a[164:167], a[224:227], v[188:191]
    v_max3_u32 v253, v253, v233, v235
    v_mfma_f32_16x16x32_bf16 v[184:187], a[160:163], a[224:227], v[184:187]
    ds_read_b64_tr_b16 a[204:205], v204 offset:6144
    v_mfma_f32_16x16x32_bf16 v[184:187], a[192:195], a[228:231], v[184:187]
    v_add_f32 v208, v208, v232
    v_mfma_f32_16x16x32_bf16 v[152:155], a[192:195], a[220:223], v[152:155]
    buffer_load_dwordx4 v245, s[48:51], s92 offen lds
    v_mfma_f32_16x16x32_bf16 v[152:155], a[160:163], a[216:219], v[152:155]
    ds_read_b64_tr_b16 a[206:207], v204 offset:7168
    v_mfma_f32_16x16x32_bf16 v[148:151], a[156:159], a[216:219], v[148:151]
    v_add_f32 v210, v210, v234
    v_mfma_f32_16x16x32_bf16 v[148:151], a[188:191], a[220:223], v[148:151]
    ds_read_b64_tr_b16 a[212:213], v205 offset:6176
    v_mfma_f32_16x16x32_bf16 v[180:183], a[188:191], a[228:231], v[180:183]
    v_cmp_ne_u32 vcc, v252, v253
    s_cbranch_vccnz L_gs1
L_gb1:
    v_mfma_f32_16x16x32_bf16 v[180:183], a[156:159], a[224:227], v[180:183]
    s_add_u32 m0, s3, 106496
    v_mfma_f32_16x16x32_bf16 v[176:179], a[152:155], a[224:227], v[176:179]
    ds_read_b64_tr_b16 a[214:215], v205 offset:7200
    v_mfma_f32_16x16x32_bf16 v[176:179], a[184:187], a[228:231], v[176:179]
    buffer_store_dwordx4 v[92:95], v254, s[44:47], s12 offen offset:0 sc1
    v_mfma_f32_16x16x32_bf16 v[144:147], a[184:187], a[220:223], v[144:147]
    ds_read_b64_tr_b16 a[208:209], v205 offset:32
    v_mfma_f32_16x16x32_bf16 v[144:147], a[152:155], a[216:219], v[144:147]
    buffer_store_dwordx4 v[124:127], v254, s[44:47], s12 offen offset:1024 sc1
    v_mfma_f32_16x16x32_bf16 v[140:143], a[148:151], a[216:219], v[140:143]
    ds_read_b64_tr_b16 a[210:211], v205 offset:1056
    v_mfma_f32_16x16x32_bf16 v[140:143], a[180:183], a[220:223], v[140:143]
    buffer_load_dwordx4 v244, s[48:51], s93 offen lds
    v_mfma_f32_16x16x32_bf16 v[172:175], a[180:183], a[228:231], v[172:175]
    buffer_store_dwordx4 v[156:159], v254, s[44:47], s12 offen offset:2048 sc1
    v_mfma_f32_16x16x32_bf16 v[172:175], a[148:151], a[224:227], v[172:175]
    buffer_store_dwordx4 v[188:191], v254, s[44:47], s12 offen offset:3072 sc1
    v_mfma_f32_16x16x32_bf16 v[168:171], a[144:147], a[224:227], v[168:171]
    v_readlane_b32 s94, v247, 2
    v_mfma_f32_16x16x32_bf16 v[168:171], a[176:179], a[228:231], v[168:171]
    v_accvgpr_read_b32 v196, a236
    v_mfma_f32_16x16x32_bf16 v[136:139], a[176:179], a[220:223], v[136:139]
    ds_write2_b32 v196, v208, v210 offset1:1
    v_mfma_f32_16x16x32_bf16 v[136:139], a[144:147], a[216:219], v[136:139]
    s_add_u32 m0, s3, 108544
    v_mfma_f32_16x16x32_bf16 v[132:135], a[140:143], a[216:219], v[132:135]
    v_and_b32 v214, 0xffff0000, v226
    v_mfma_f32_16x16x32_bf16 v[132:135], a[172:175], a[220:223], v[132:135]
    v_rcp_f32 v216, v214
    v_mfma_f32_16x16x32_bf16 v[164:167], a[172:175], a[228:231], v[164:167]
    buffer_load_dwordx4 v245, s[48:51], s93 offen lds
    v_mfma_f32_16x16x32_bf16 v[164:167], a[140:143], a[224:227], v[164:167]
    v_lshlrev_b32 v212, 16, v226
    v_mfma_f32_16x16x32_bf16 v[160:163], a[136:139], a[224:227], v[160:163]
    v_xor_b32 v212, 0x80000000, v212
    v_mfma_f32_16x16x32_bf16 v[160:163], a[168:171], a[228:231], v[160:163]
    s_add_u32 m0, s3, 114688
    v_mfma_f32_16x16x32_bf16 v[128:131], a[168:171], a[220:223], v[128:131]
    v_accvgpr_read_b32 v195, a235
    v_mfma_f32_16x16x32_bf16 v[128:131], a[136:139], a[216:219], v[128:131]
    s_waitcnt lgkmcnt(1)
    v_mfma_f32_16x16x32_bf16 v[0:3], a[200:203], a[136:139], v[0:3]
    ds_read_b64_tr_b16 a[216:217], v206 offset:0
    v_mfma_f32_16x16x32_bf16 v[0:3], a[204:207], a[168:171], v[0:3]
    ds_write2st64_b32 v195, v212, v216 offset1:5
    v_mfma_f32_16x16x32_bf16 v[32:35], a[212:215], a[168:171], v[32:35]
    v_mul_f32 v213, 3216550459, v216
    v_mfma_f32_16x16x32_bf16 v[32:35], a[208:211], a[136:139], v[32:35]
    ds_read_b64_tr_b16 a[218:219], v206 offset:3584
    v_mfma_f32_16x16x32_bf16 v[36:39], a[208:211], a[140:143], v[36:39]
    buffer_load_dwordx4 v244, s[48:51], s94 offen lds
    v_mfma_f32_16x16x32_bf16 v[36:39], a[212:215], a[172:175], v[36:39]
    ds_read_b64_tr_b16 a[220:221], v206 offset:7168
    v_mfma_f32_16x16x32_bf16 v[4:7], a[204:207], a[172:175], v[4:7]
    v_mul_f32 v215, 1057048658, v216
    v_mfma_f32_16x16x32_bf16 v[4:7], a[200:203], a[140:143], v[4:7]
    ds_read_b64_tr_b16 a[222:223], v206 offset:10752
    v_mfma_f32_16x16x32_bf16 v[8:11], a[200:203], a[144:147], v[8:11]
    v_accvgpr_read_b32 v194, a234
    v_mfma_f32_16x16x32_bf16 v[8:11], a[204:207], a[176:179], v[8:11]
    ds_read_b64_tr_b16 a[228:229], v206 offset:7200
    v_mfma_f32_16x16x32_bf16 v[40:43], a[212:215], a[176:179], v[40:43]
    v_readlane_b32 s95, v247, 3
    v_mfma_f32_16x16x32_bf16 v[40:43], a[208:211], a[144:147], v[40:43]
    ds_write_b128 v194, v[212:215]
    v_mfma_f32_16x16x32_bf16 v[44:47], a[208:211], a[148:151], v[44:47]
    ds_read_b64_tr_b16 a[230:231], v206 offset:10784
    v_mfma_f32_16x16x32_bf16 v[44:47], a[212:215], a[180:183], v[44:47]
    v_and_b32 v230, 0xffff0000, v224
    v_mfma_f32_16x16x32_bf16 v[12:15], a[204:207], a[180:183], v[12:15]
    ds_read_b64_tr_b16 a[224:225], v206 offset:32
    v_mfma_f32_16x16x32_bf16 v[12:15], a[200:203], a[148:151], v[12:15]
    s_add_u32 m0, s3, 116736
    v_mfma_f32_16x16x32_bf16 v[16:19], a[200:203], a[152:155], v[16:19]
    ds_read_b64_tr_b16 a[226:227], v206 offset:3616
    v_mfma_f32_16x16x32_bf16 v[16:19], a[204:207], a[184:187], v[16:19]
    v_rcp_f32 v232, v230
    v_mfma_f32_16x16x32_bf16 v[48:51], a[212:215], a[184:187], v[48:51]
    v_lshlrev_b32 v228, 16, v224
    v_mfma_f32_16x16x32_bf16 v[48:51], a[208:211], a[152:155], v[48:51]
    buffer_load_dwordx4 v245, s[48:51], s94 offen lds
    v_mfma_f32_16x16x32_bf16 v[52:55], a[208:211], a[156:159], v[52:55]
    v_xor_b32 v228, 0x80000000, v228
    v_mfma_f32_16x16x32_bf16 v[52:55], a[212:215], a[188:191], v[52:55]
    v_accvgpr_read_b32 v193, a233
    v_mfma_f32_16x16x32_bf16 v[20:23], a[204:207], a[188:191], v[20:23]
    s_add_u32 m0, s3, 122880
    v_mfma_f32_16x16x32_bf16 v[20:23], a[200:203], a[156:159], v[20:23]
    ds_write2st64_b32 v193, v228, v232 offset1:5
    v_mfma_f32_16x16x32_bf16 v[24:27], a[200:203], a[160:163], v[24:27]
    v_mul_f32 v229, 3216550459, v232
    v_mfma_f32_16x16x32_bf16 v[24:27], a[204:207], a[192:195], v[24:27]
    buffer_load_dwordx4 v244, s[52:55], s95 offen lds
    v_mfma_f32_16x16x32_bf16 v[56:59], a[212:215], a[192:195], v[56:59]
    v_mul_f32 v231, 1057048658, v232
    v_mfma_f32_16x16x32_bf16 v[56:59], a[208:211], a[160:163], v[56:59]
    v_accvgpr_read_b32 v192, a232
    v_mfma_f32_16x16x32_bf16 v[60:63], a[208:211], a[164:167], v[60:63]
    v_readlane_b32 s92, v247, 4
    v_mfma_f32_16x16x32_bf16 v[60:63], a[212:215], a[196:199], v[60:63]
    ds_write_b128 v192, v[228:231]
    v_mfma_f32_16x16x32_bf16 v[28:31], a[204:207], a[196:199], v[28:31]
    s_getreg_b32 s72, hwreg(HW_REG_XCC_ID, 0, 4)
    s_add_u32 s72, s72, 1
    s_waitcnt vmcnt(11)
    v_subrev_u32 v238, s72, v238
    v_mfma_f32_16x16x32_bf16 v[28:31], a[200:203], a[164:167], v[28:31]
    s_waitcnt lgkmcnt(2)
    v_mfma_f32_16x16x32_bf16 a[64:67], a[216:219], a[136:139], a[64:67]
    v_cmp_eq_u32 vcc, v239, v238
    s_nop 1
    s_and_b32 s78, vcc_lo, 0xff
    s_xor_b32 s78, s78, 0xff
    v_mfma_f32_16x16x32_bf16 a[64:67], a[220:223], a[168:171], a[64:67]
    v_accvgpr_read_b32 v252, a248
    v_mfma_f32_16x16x32_bf16 a[96:99], a[228:231], a[168:171], a[96:99]
    v_accvgpr_read_b32 v253, a249
    v_mfma_f32_16x16x32_bf16 a[96:99], a[224:227], a[136:139], a[96:99]
    v_accvgpr_read_b32 v232, a250
    v_mfma_f32_16x16x32_bf16 a[100:103], a[224:227], a[140:143], a[100:103]
    v_accvgpr_read_b32 v233, a251
    v_mfma_f32_16x16x32_bf16 a[100:103], a[228:231], a[172:175], a[100:103]
    s_add_u32 m0, s3, 124928
    v_mfma_f32_16x16x32_bf16 a[68:71], a[220:223], a[172:175], a[68:71]
    v_xor_b32 v249, 0x80, v250
    v_mfma_f32_16x16x32_bf16 a[68:71], a[216:219], a[140:143], a[68:71]
    v_xor_b32 v234, 0x80, v251
    v_mfma_f32_16x16x32_bf16 a[72:75], a[216:219], a[144:147], a[72:75]
    v_xor_b32 v235, 0x80, v252
    v_mfma_f32_16x16x32_bf16 a[72:75], a[220:223], a[176:179], a[72:75]
    buffer_load_dwordx4 v245, s[52:55], s95 offen lds
    v_mfma_f32_16x16x32_bf16 a[104:107], a[228:231], a[176:179], a[104:107]
    v_xor_b32 v236, 0x80, v253
    v_mfma_f32_16x16x32_bf16 a[104:107], a[224:227], a[144:147], a[104:107]
    s_lshl_b32 s84, s69, 11
    s_add_u32 s84, s84, 154624
    v_and_b32 v237, 0xf0, v254
    v_mfma_f32_16x16x32_bf16 a[108:111], a[224:227], a[148:151], a[108:111]
    v_add_u32 v237, s84, v237
    v_mfma_f32_16x16x32_bf16 a[108:111], a[228:231], a[180:183], a[108:111]
    s_add_u32 m0, s3, 131072
    v_mfma_f32_16x16x32_bf16 a[76:79], a[220:223], a[180:183], a[76:79]
    v_lshrrev_b32 v238, 8, v254
    v_mfma_f32_16x16x32_bf16 a[76:79], a[216:219], a[148:151], a[76:79]
    v_lshlrev_b32 v238, 4, v238
    v_mfma_f32_16x16x32_bf16 a[80:83], a[216:219], a[152:155], a[80:83]
    v_add_u32 v238, 158976, v238
    v_mfma_f32_16x16x32_bf16 a[80:83], a[220:223], a[184:187], a[80:83]
    buffer_load_dwordx4 v244, s[48:51], s92 offen lds
    v_mfma_f32_16x16x32_bf16 a[112:115], a[228:231], a[184:187], a[112:115]
    s_waitcnt lgkmcnt(0)
    s_barrier
    v_mfma_f32_16x16x32_bf16 a[112:115], a[224:227], a[152:155], a[112:115]
    v_readlane_b32 s93, v247, 5
    v_mfma_f32_16x16x32_bf16 a[116:119], a[224:227], a[156:159], a[116:119]
    ds_read_b128 v[208:211], v238 offset:2752
    v_mfma_f32_16x16x32_bf16 a[116:119], a[228:231], a[188:191], a[116:119]
    s_add_u32 m0, s3, 133120
    v_mfma_f32_16x16x32_bf16 a[84:87], a[220:223], a[188:191], a[84:87]
    ds_read_b128 v[212:215], v238 offset:2816
    v_mfma_f32_16x16x32_bf16 a[84:87], a[216:219], a[156:159], a[84:87]
    buffer_load_dwordx4 v245, s[48:51], s92 offen lds
    v_mfma_f32_16x16x32_bf16 a[88:91], a[216:219], a[160:163], a[88:91]
    ds_read_b128 v[216:219], v238 offset:2880
    v_mfma_f32_16x16x32_bf16 a[88:91], a[220:223], a[192:195], a[88:91]
    s_add_u32 m0, s3, 139264
    v_mfma_f32_16x16x32_bf16 a[120:123], a[228:231], a[192:195], a[120:123]
    ds_read_b128 v[220:223], v238 offset:2944
    v_mfma_f32_16x16x32_bf16 a[120:123], a[224:227], a[160:163], a[120:123]
    buffer_load_dwordx4 v244, s[48:51], s93 offen lds
    v_mfma_f32_16x16x32_bf16 a[124:127], a[224:227], a[164:167], a[124:127]
    ds_read_b128 v[224:227], v237 offset:256
    v_mfma_f32_16x16x32_bf16 a[124:127], a[228:231], a[196:199], a[124:127]
    s_add_u32 m0, s3, 141312
    v_mfma_f32_16x16x32_bf16 a[92:95], a[220:223], a[196:199], a[92:95]
    ds_read_b128 v[228:231], v237 offset:512
    v_mfma_f32_16x16x32_bf16 a[92:95], a[216:219], a[164:167], a[92:95]
    buffer_load_dwordx4 v245, s[48:51], s93 offen lds
L_epi0:
    v_accvgpr_read_b32 v192, a0
    v_accvgpr_read_b32 v193, a1
    v_accvgpr_read_b32 v194, a2
    v_accvgpr_read_b32 v195, a3
    v_accvgpr_read_b32 v196, a32
    v_accvgpr_read_b32 v197, a33
    v_accvgpr_read_b32 v198, a34
    v_accvgpr_read_b32 v199, a35
    s_waitcnt lgkmcnt(1)
    v_pk_fma_f32 v[192:193], v[208:209], v[224:225], v[192:193] op_sel:[0,0,0] op_sel_hi:[1,0,1]
    v_pk_fma_f32 v[194:195], v[210:211], v[224:225], v[194:195] op_sel:[0,0,0] op_sel_hi:[1,0,1]
    v_pk_fma_f32 v[196:197], v[212:213], v[224:225], v[196:197] op_sel:[0,0,0] op_sel_hi:[1,0,1]
    v_pk_fma_f32 v[198:199], v[214:215], v[224:225], v[198:199] op_sel:[0,0,0] op_sel_hi:[1,0,1]
    v_pk_mul_f32 v[192:193], v[192:193], v[224:225] op_sel:[0,1] op_sel_hi:[1,1]
    v_pk_mul_f32 v[194:195], v[194:195], v[224:225] op_sel:[0,1] op_sel_hi:[1,1]
    v_pk_mul_f32 v[196:197], v[196:197], v[224:225] op_sel:[0,1] op_sel_hi:[1,1]
    v_pk_mul_f32 v[198:199], v[198:199], v[224:225] op_sel:[0,1] op_sel_hi:[1,1]
    v_exp_f32 v192, v192
    v_exp_f32 v193, v193
    v_exp_f32 v194, v194
    v_exp_f32 v195, v195
    v_exp_f32 v196, v196
    v_exp_f32 v197, v197
    v_exp_f32 v198, v198
    v_exp_f32 v199, v199
    v_accvgpr_read_b32 v200, a64
    v_accvgpr_read_b32 v201, a65
    v_accvgpr_read_b32 v202, a66
    v_accvgpr_read_b32 v203, a67
    v_pk_fma_f32 v[192:193], v[192:193], v[226:227], v[226:227] op_sel:[0,0,0] op_sel_hi:[1,0,0]
    v_pk_fma_f32 v[194:195], v[194:195], v[226:227], v[226:227] op_sel:[0,0,0] op_sel_hi:[1,0,0]
    v_pk_fma_f32 v[196:197], v[196:197], v[226:227], v[226:227] op_sel:[0,0,0] op_sel_hi:[1,0,0]
    v_pk_fma_f32 v[198:199], v[198:199], v[226:227], v[226:227] op_sel:[0,0,0] op_sel_hi:[1,0,0]
    v_rcp_f32 v192, v192
    v_rcp_f32 v193, v193
    v_rcp_f32 v194, v194
    v_rcp_f32 v195, v195
    v_rcp_f32 v196, v196
    v_rcp_f32 v197, v197
    v_rcp_f32 v198, v198
    v_rcp_f32 v199, v199
    v_pk_fma_f32 v[200:201], v[216:217], v[224:225], v[200:201] op_sel:[0,0,0] op_sel_hi:[1,0,1]
    v_pk_fma_f32 v[202:203], v[218:219], v[224:225], v[202:203] op_sel:[0,0,0] op_sel_hi:[1,0,1]
    v_pk_mul_f32 v[192:193], v[192:193], v[200:201]
    v_pk_mul_f32 v[194:195], v[194:195], v[202:203]
    v_accvgpr_read_b32 v200, a96
    v_accvgpr_read_b32 v201, a97
    v_accvgpr_read_b32 v202, a98
    v_accvgpr_read_b32 v203, a99
    v_pk_fma_f32 v[200:201], v[220:221], v[224:225], v[200:201] op_sel:[0,0,0] op_sel_hi:[1,0,1]
    v_pk_fma_f32 v[202:203], v[222:223], v[224:225], v[202:203] op_sel:[0,0,0] op_sel_hi:[1,0,1]
    v_pk_mul_f32 v[196:197], v[196:197], v[200:201]
    v_pk_mul_f32 v[198:199], v[198:199], v[202:203]
    v_cvt_pk_bf16_f32 v192, v192, v193
    v_cvt_pk_bf16_f32 v193, v194, v195
    v_cvt_pk_bf16_f32 v194, v196, v197
    v_cvt_pk_bf16_f32 v195, v198, v199
    v_and_b32 v192, -2, v192
    v_accvgpr_read_b32 v196, a4
    v_accvgpr_read_b32 v197, a5
    v_accvgpr_read_b32 v198, a6
    v_accvgpr_read_b32 v199, a7
    v_accvgpr_read_b32 v200, a36
    v_accvgpr_read_b32 v201, a37
    v_accvgpr_read_b32 v202, a38
    v_accvgpr_read_b32 v203, a39
    s_waitcnt lgkmcnt(0)
    v_pk_fma_f32 v[196:197], v[208:209], v[228:229], v[196:197] op_sel:[0,0,0] op_sel_hi:[1,0,1]
    v_pk_fma_f32 v[198:199], v[210:211], v[228:229], v[198:199] op_sel:[0,0,0] op_sel_hi:[1,0,1]
    v_pk_fma_f32 v[200:201], v[212:213], v[228:229], v[200:201] op_sel:[0,0,0] op_sel_hi:[1,0,1]
    v_pk_fma_f32 v[202:203], v[214:215], v[228:229], v[202:203] op_sel:[0,0,0] op_sel_hi:[1,0,1]
    v_pk_mul_f32 v[196:197], v[196:197], v[228:229] op_sel:[0,1] op_sel_hi:[1,1]
    v_pk_mul_f32 v[198:199], v[198:199], v[228:229] op_sel:[0,1] op_sel_hi:[1,1]
    v_pk_mul_f32 v[200:201], v[200:201], v[228:229] op_sel:[0,1] op_sel_hi:[1,1]
    v_pk_mul_f32 v[202:203], v[202:203], v[228:229] op_sel:[0,1] op_sel_hi:[1,1]
    v_exp_f32 v196, v196
    v_exp_f32 v197, v197
    v_exp_f32 v198, v198
    v_exp_f32 v199, v199
    v_exp_f32 v200, v200
    v_exp_f32 v201, v201
    v_exp_f32 v202, v202
    v_exp_f32 v203, v203
    v_accvgpr_read_b32 v204, a68
    v_accvgpr_read_b32 v205, a69
    v_accvgpr_read_b32 v206, a70
    v_accvgpr_read_b32 v207, a71
    v_pk_fma_f32 v[196:197], v[196:197], v[230:231], v[230:231] op_sel:[0,0,0] op_sel_hi:[1,0,0]
    v_pk_fma_f32 v[198:199], v[198:199], v[230:231], v[230:231] op_sel:[0,0,0] op_sel_hi:[1,0,0]
    v_pk_fma_f32 v[200:201], v[200:201], v[230:231], v[230:231] op_sel:[0,0,0] op_sel_hi:[1,0,0]
    v_pk_fma_f32 v[202:203], v[202:203], v[230:231], v[230:231] op_sel:[0,0,0] op_sel_hi:[1,0,0]
    v_rcp_f32 v196, v196
    v_rcp_f32 v197, v197
    v_rcp_f32 v198, v198
    v_rcp_f32 v199, v199
    v_rcp_f32 v200, v200
    v_rcp_f32 v201, v201
    v_rcp_f32 v202, v202
    v_rcp_f32 v203, v203
    v_pk_fma_f32 v[204:205], v[216:217], v[228:229], v[204:205] op_sel:[0,0,0] op_sel_hi:[1,0,1]
    v_pk_fma_f32 v[206:207], v[218:219], v[228:229], v[206:207] op_sel:[0,0,0] op_sel_hi:[1,0,1]
    v_pk_mul_f32 v[196:197], v[196:197], v[204:205]
    v_pk_mul_f32 v[198:199], v[198:199], v[206:207]
    v_accvgpr_read_b32 v204, a100
    v_accvgpr_read_b32 v205, a101
    v_accvgpr_read_b32 v206, a102
    v_accvgpr_read_b32 v207, a103
    v_pk_fma_f32 v[204:205], v[220:221], v[228:229], v[204:205] op_sel:[0,0,0] op_sel_hi:[1,0,1]
    v_pk_fma_f32 v[206:207], v[222:223], v[228:229], v[206:207] op_sel:[0,0,0] op_sel_hi:[1,0,1]
    v_pk_mul_f32 v[200:201], v[200:201], v[204:205]
    v_pk_mul_f32 v[202:203], v[202:203], v[206:207]
    v_cvt_pk_bf16_f32 v196, v196, v197
    v_cvt_pk_bf16_f32 v197, v198, v199
    v_cvt_pk_bf16_f32 v198, v200, v201
    v_cvt_pk_bf16_f32 v199, v202, v203
    v_and_b32 v196, -2, v196
    ds_read_b128 v[224:227], v237 offset:768
    ds_read_b128 v[228:231], v237 offset:1024
    buffer_store_dwordx4 v[192:195], v254, s[40:43], s28 offen offset:1024 sc1
    ds_write_b128 v233, v[192:195] offset:16384
    buffer_store_dwordx4 v[196:199], v254, s[40:43], s29 offen offset:1024 sc1
    ds_write_b128 v233, v[196:199] offset:17408
    v_accvgpr_read_b32 v192, a8
    v_accvgpr_read_b32 v193, a9
    v_accvgpr_read_b32 v194, a10
    v_accvgpr_read_b32 v195, a11
    v_accvgpr_read_b32 v196, a40
    v_accvgpr_read_b32 v197, a41
    v_accvgpr_read_b32 v198, a42
    v_accvgpr_read_b32 v199, a43
    s_waitcnt lgkmcnt(3)
    v_pk_fma_f32 v[192:193], v[208:209], v[224:225], v[192:193] op_sel:[0,0,0] op_sel_hi:[1,0,1]
    v_pk_fma_f32 v[194:195], v[210:211], v[224:225], v[194:195] op_sel:[0,0,0] op_sel_hi:[1,0,1]
    v_pk_fma_f32 v[196:197], v[212:213], v[224:225], v[196:197] op_sel:[0,0,0] op_sel_hi:[1,0,1]
    v_pk_fma_f32 v[198:199], v[214:215], v[224:225], v[198:199] op_sel:[0,0,0] op_sel_hi:[1,0,1]
    v_pk_mul_f32 v[192:193], v[192:193], v[224:225] op_sel:[0,1] op_sel_hi:[1,1]
    v_pk_mul_f32 v[194:195], v[194:195], v[224:225] op_sel:[0,1] op_sel_hi:[1,1]
    v_pk_mul_f32 v[196:197], v[196:197], v[224:225] op_sel:[0,1] op_sel_hi:[1,1]
    v_pk_mul_f32 v[198:199], v[198:199], v[224:225] op_sel:[0,1] op_sel_hi:[1,1]
    v_exp_f32 v192, v192
    v_exp_f32 v193, v193
    v_exp_f32 v194, v194
    v_exp_f32 v195, v195
    v_exp_f32 v196, v196
    v_exp_f32 v197, v197
    v_exp_f32 v198, v198
    v_exp_f32 v199, v199
    v_accvgpr_read_b32 v200, a72
    v_accvgpr_read_b32 v201, a73
    v_accvgpr_read_b32 v202, a74
    v_accvgpr_read_b32 v203, a75
    v_pk_fma_f32 v[192:193], v[192:193], v[226:227], v[226:227] op_sel:[0,0,0] op_sel_hi:[1,0,0]
    v_pk_fma_f32 v[194:195], v[194:195], v[226:227], v[226:227] op_sel:[0,0,0] op_sel_hi:[1,0,0]
    v_pk_fma_f32 v[196:197], v[196:197], v[226:227], v[226:227] op_sel:[0,0,0] op_sel_hi:[1,0,0]
    v_pk_fma_f32 v[198:199], v[198:199], v[226:227], v[226:227] op_sel:[0,0,0] op_sel_hi:[1,0,0]
    v_rcp_f32 v192, v192
    v_rcp_f32 v193, v193
    v_rcp_f32 v194, v194
    v_rcp_f32 v195, v195
    v_rcp_f32 v196, v196
    v_rcp_f32 v197, v197
    v_rcp_f32 v198, v198
    v_rcp_f32 v199, v199
    v_pk_fma_f32 v[200:201], v[216:217], v[224:225], v[200:201] op_sel:[0,0,0] op_sel_hi:[1,0,1]
    v_pk_fma_f32 v[202:203], v[218:219], v[224:225], v[202:203] op_sel:[0,0,0] op_sel_hi:[1,0,1]
    v_pk_mul_f32 v[192:193], v[192:193], v[200:201]
    v_pk_mul_f32 v[194:195], v[194:195], v[202:203]
    v_accvgpr_read_b32 v200, a104
    v_accvgpr_read_b32 v201, a105
    v_accvgpr_read_b32 v202, a106
    v_accvgpr_read_b32 v203, a107
    v_pk_fma_f32 v[200:201], v[220:221], v[224:225], v[200:201] op_sel:[0,0,0] op_sel_hi:[1,0,1]
    v_pk_fma_f32 v[202:203], v[222:223], v[224:225], v[202:203] op_sel:[0,0,0] op_sel_hi:[1,0,1]
    v_pk_mul_f32 v[196:197], v[196:197], v[200:201]
    v_pk_mul_f32 v[198:199], v[198:199], v[202:203]
    v_cvt_pk_bf16_f32 v192, v192, v193
    v_cvt_pk_bf16_f32 v193, v194, v195
    v_cvt_pk_bf16_f32 v194, v196, v197
    v_cvt_pk_bf16_f32 v195, v198, v199
    v_and_b32 v192, -2, v192
    v_accvgpr_read_b32 v196, a12
    v_accvgpr_read_b32 v197, a13
    v_accvgpr_read_b32 v198, a14
    v_accvgpr_read_b32 v199, a15
    v_accvgpr_read_b32 v200, a44
    v_accvgpr_read_b32 v201, a45
    v_accvgpr_read_b32 v202, a46
    v_accvgpr_read_b32 v203, a47
    s_waitcnt lgkmcnt(2)
    v_pk_fma_f32 v[196:197], v[208:209], v[228:229], v[196:197] op_sel:[0,0,0] op_sel_hi:[1,0,1]
    v_pk_fma_f32 v[198:199], v[210:211], v[228:229], v[198:199] op_sel:[0,0,0] op_sel_hi:[1,0,1]
    v_pk_fma_f32 v[200:201], v[212:213], v[228:229], v[200:201] op_sel:[0,0,0] op_sel_hi:[1,0,1]
    v_pk_fma_f32 v[202:203], v[214:215], v[228:229], v[202:203] op_sel:[0,0,0] op_sel_hi:[1,0,1]
    v_pk_mul_f32 v[196:197], v[196:197], v[228:229] op_sel:[0,1] op_sel_hi:[1,1]
    v_pk_mul_f32 v[198:199], v[198:199], v[228:229] op_sel:[0,1] op_sel_hi:[1,1]
    v_pk_mul_f32 v[200:201], v[200:201], v[228:229] op_sel:[0,1] op_sel_hi:[1,1]
    v_pk_mul_f32 v[202:203], v[202:203], v[228:229] op_sel:[0,1] op_sel_hi:[1,1]
    v_exp_f32 v196, v196
    v_exp_f32 v197, v197
    v_exp_f32 v198, v198
    v_exp_f32 v199, v199
    v_exp_f32 v200, v200
    v_exp_f32 v201, v201
    v_exp_f32 v202, v202
    v_exp_f32 v203, v203
    v_accvgpr_read_b32 v204, a76
    v_accvgpr_read_b32 v205, a77
    v_accvgpr_read_b32 v206, a78
    v_accvgpr_read_b32 v207, a79
    v_pk_fma_f32 v[196:197], v[196:197], v[230:231], v[230:231] op_sel:[0,0,0] op_sel_hi:[1,0,0]
    v_pk_fma_f32 v[198:199], v[198:199], v[230:231], v[230:231] op_sel:[0,0,0] op_sel_hi:[1,0,0]
    v_pk_fma_f32 v[200:201], v[200:201], v[230:231], v[230:231] op_sel:[0,0,0] op_sel_hi:[1,0,0]
    v_pk_fma_f32 v[202:203], v[202:203], v[230:231], v[230:231] op_sel:[0,0,0] op_sel_hi:[1,0,0]
    v_rcp_f32 v196, v196
    v_rcp_f32 v197, v197
    v_rcp_f32 v198, v198
    v_rcp_f32 v199, v199
    v_rcp_f32 v200, v200
    v_rcp_f32 v201, v201
    v_rcp_f32 v202, v202
    v_rcp_f32 v203, v203
    v_pk_fma_f32 v[204:205], v[216:217], v[228:229], v[204:205] op_sel:[0,0,0] op_sel_hi:[1,0,1]
    v_pk_fma_f32 v[206:207], v[218:219], v[228:229], v[206:207] op_sel:[0,0,0] op_sel_hi:[1,0,1]
    v_pk_mul_f32 v[196:197], v[196:197], v[204:205]
    v_pk_mul_f32 v[198:199], v[198:199], v[206:207]
    v_accvgpr_read_b32 v204, a108
    v_accvgpr_read_b32 v205, a109
    v_accvgpr_read_b32 v206, a110
    v_accvgpr_read_b32 v207, a111
    v_pk_fma_f32 v[204:205], v[220:221], v[228:229], v[204:205] op_sel:[0,0,0] op_sel_hi:[1,0,1]
    v_pk_fma_f32 v[206:207], v[222:223], v[228:229], v[206:207] op_sel:[0,0,0] op_sel_hi:[1,0,1]
    v_pk_mul_f32 v[200:201], v[200:201], v[204:205]
    v_pk_mul_f32 v[202:203], v[202:203], v[206:207]
    v_cvt_pk_bf16_f32 v196, v196, v197
    v_cvt_pk_bf16_f32 v197, v198, v199
    v_cvt_pk_bf16_f32 v198, v200, v201
    v_cvt_pk_bf16_f32 v199, v202, v203
    v_and_b32 v196, -2, v196
    ds_read_b128 v[224:227], v237 offset:1280
    ds_read_b128 v[228:231], v237 offset:1536
    buffer_store_dwordx4 v[192:195], v254, s[40:43], s30 offen offset:1024 sc1
    ds_write_b128 v233, v[192:195] offset:18432
    buffer_store_dwordx4 v[196:199], v254, s[40:43], s31 offen offset:1024 sc1
    ds_write_b128 v233, v[196:199] offset:19456
    s_lshl_b32 s75, s68, 4
    s_add_u32 s75, s75, s65
    s_lshl_b32 s75, s75, 12
    s_add_u32 s75, s75, 724992
    s_lshl_b32 s84, s69, 11
    s_add_u32 s75, s75, s84
    s_cmp_eq_u32 s65, 0
    s_cselect_b32 s75, 2.0, s75
    buffer_load_dwordx4 a[128:131], v254, s[44:47], s75 offen offset:0 sc1
    buffer_load_dwordx4 a[132:135], v254, s[44:47], s75 offen offset:1024 sc1
    v_accvgpr_read_b32 v192, a16
    v_accvgpr_read_b32 v193, a17
    v_accvgpr_read_b32 v194, a18
    v_accvgpr_read_b32 v195, a19
    v_accvgpr_read_b32 v196, a48
    v_accvgpr_read_b32 v197, a49
    v_accvgpr_read_b32 v198, a50
    v_accvgpr_read_b32 v199, a51
    s_waitcnt lgkmcnt(3)
    v_pk_fma_f32 v[192:193], v[208:209], v[224:225], v[192:193] op_sel:[0,0,0] op_sel_hi:[1,0,1]
    v_pk_fma_f32 v[194:195], v[210:211], v[224:225], v[194:195] op_sel:[0,0,0] op_sel_hi:[1,0,1]
    v_pk_fma_f32 v[196:197], v[212:213], v[224:225], v[196:197] op_sel:[0,0,0] op_sel_hi:[1,0,1]
    v_pk_fma_f32 v[198:199], v[214:215], v[224:225], v[198:199] op_sel:[0,0,0] op_sel_hi:[1,0,1]
    v_pk_mul_f32 v[192:193], v[192:193], v[224:225] op_sel:[0,1] op_sel_hi:[1,1]
    v_pk_mul_f32 v[194:195], v[194:195], v[224:225] op_sel:[0,1] op_sel_hi:[1,1]
    v_pk_mul_f32 v[196:197], v[196:197], v[224:225] op_sel:[0,1] op_sel_hi:[1,1]
    v_pk_mul_f32 v[198:199], v[198:199], v[224:225] op_sel:[0,1] op_sel_hi:[1,1]
    v_exp_f32 v192, v192
    v_exp_f32 v193, v193
    v_exp_f32 v194, v194
    v_exp_f32 v195, v195
    v_exp_f32 v196, v196
    v_exp_f32 v197, v197
    v_exp_f32 v198, v198
    v_exp_f32 v199, v199
    v_accvgpr_read_b32 v200, a80
    v_accvgpr_read_b32 v201, a81
    v_accvgpr_read_b32 v202, a82
    v_accvgpr_read_b32 v203, a83
    v_pk_fma_f32 v[192:193], v[192:193], v[226:227], v[226:227] op_sel:[0,0,0] op_sel_hi:[1,0,0]
    v_pk_fma_f32 v[194:195], v[194:195], v[226:227], v[226:227] op_sel:[0,0,0] op_sel_hi:[1,0,0]
    v_pk_fma_f32 v[196:197], v[196:197], v[226:227], v[226:227] op_sel:[0,0,0] op_sel_hi:[1,0,0]
    v_pk_fma_f32 v[198:199], v[198:199], v[226:227], v[226:227] op_sel:[0,0,0] op_sel_hi:[1,0,0]
    v_rcp_f32 v192, v192
    v_rcp_f32 v193, v193
    v_rcp_f32 v194, v194
    v_rcp_f32 v195, v195
    v_rcp_f32 v196, v196
    v_rcp_f32 v197, v197
    v_rcp_f32 v198, v198
    v_rcp_f32 v199, v199
    v_pk_fma_f32 v[200:201], v[216:217], v[224:225], v[200:201] op_sel:[0,0,0] op_sel_hi:[1,0,1]
    v_pk_fma_f32 v[202:203], v[218:219], v[224:225], v[202:203] op_sel:[0,0,0] op_sel_hi:[1,0,1]
    v_pk_mul_f32 v[192:193], v[192:193], v[200:201]
    v_pk_mul_f32 v[194:195], v[194:195], v[202:203]
    v_accvgpr_read_b32 v200, a112
    v_accvgpr_read_b32 v201, a113
    v_accvgpr_read_b32 v202, a114
    v_accvgpr_read_b32 v203, a115
    v_pk_fma_f32 v[200:201], v[220:221], v[224:225], v[200:201] op_sel:[0,0,0] op_sel_hi:[1,0,1]
    v_pk_fma_f32 v[202:203], v[222:223], v[224:225], v[202:203] op_sel:[0,0,0] op_sel_hi:[1,0,1]
    v_pk_mul_f32 v[196:197], v[196:197], v[200:201]
    v_pk_mul_f32 v[198:199], v[198:199], v[202:203]
    v_cvt_pk_bf16_f32 v192, v192, v193
    v_cvt_pk_bf16_f32 v193, v194, v195
    v_cvt_pk_bf16_f32 v194, v196, v197
    v_cvt_pk_bf16_f32 v195, v198, v199
    v_and_b32 v192, -2, v192
    v_accvgpr_read_b32 v196, a20
    v_accvgpr_read_b32 v197, a21
    v_accvgpr_read_b32 v198, a22
    v_accvgpr_read_b32 v199, a23
    v_accvgpr_read_b32 v200, a52
    v_accvgpr_read_b32 v201, a53
    v_accvgpr_read_b32 v202, a54
    v_accvgpr_read_b32 v203, a55
    s_waitcnt lgkmcnt(2)
    v_pk_fma_f32 v[196:197], v[208:209], v[228:229], v[196:197] op_sel:[0,0,0] op_sel_hi:[1,0,1]
    v_pk_fma_f32 v[198:199], v[210:211], v[228:229], v[198:199] op_sel:[0,0,0] op_sel_hi:[1,0,1]
    v_pk_fma_f32 v[200:201], v[212:213], v[228:229], v[200:201] op_sel:[0,0,0] op_sel_hi:[1,0,1]
    v_pk_fma_f32 v[202:203], v[214:215], v[228:229], v[202:203] op_sel:[0,0,0] op_sel_hi:[1,0,1]
    v_pk_mul_f32 v[196:197], v[196:197], v[228:229] op_sel:[0,1] op_sel_hi:[1,1]
    v_pk_mul_f32 v[198:199], v[198:199], v[228:229] op_sel:[0,1] op_sel_hi:[1,1]
    v_pk_mul_f32 v[200:201], v[200:201], v[228:229] op_sel:[0,1] op_sel_hi:[1,1]
    v_pk_mul_f32 v[202:203], v[202:203], v[228:229] op_sel:[0,1] op_sel_hi:[1,1]
    v_exp_f32 v196, v196
    v_exp_f32 v197, v197
    v_exp_f32 v198, v198
    v_exp_f32 v199, v199
    v_exp_f32 v200, v200
    v_exp_f32 v201, v201
    v_exp_f32 v202, v202
    v_exp_f32 v203, v203
    v_accvgpr_read_b32 v204, a84
    v_accvgpr_read_b32 v205, a85
    v_accvgpr_read_b32 v206, a86
    v_accvgpr_read_b32 v207, a87
    v_pk_fma_f32 v[196:197], v[196:197], v[230:231], v[230:231] op_sel:[0,0,0] op_sel_hi:[1,0,0]
    v_pk_fma_f32 v[198:199], v[198:199], v[230:231], v[230:231] op_sel:[0,0,0] op_sel_hi:[1,0,0]
    v_pk_fma_f32 v[200:201], v[200:201], v[230:231], v[230:231] op_sel:[0,0,0] op_sel_hi:[1,0,0]
    v_pk_fma_f32 v[202:203], v[202:203], v[230:231], v[230:231] op_sel:[0,0,0] op_sel_hi:[1,0,0]
    v_rcp_f32 v196, v196
    v_rcp_f32 v197, v197
    v_rcp_f32 v198, v198
    v_rcp_f32 v199, v199
    v_rcp_f32 v200, v200
    v_rcp_f32 v201, v201
    v_rcp_f32 v202, v202
    v_rcp_f32 v203, v203
    v_pk_fma_f32 v[204:205], v[216:217], v[228:229], v[204:205] op_sel:[0,0,0] op_sel_hi:[1,0,1]
    v_pk_fma_f32 v[206:207], v[218:219], v[228:229], v[206:207] op_sel:[0,0,0] op_sel_hi:[1,0,1]
    v_pk_mul_f32 v[196:197], v[196:197], v[204:205]
    v_pk_mul_f32 v[198:199], v[198:199], v[206:207]
    v_accvgpr_read_b32 v204, a116
    v_accvgpr_read_b32 v205, a117
    v_accvgpr_read_b32 v206, a118
    v_accvgpr_read_b32 v207, a119
    v_pk_fma_f32 v[204:205], v[220:221], v[228:229], v[204:205] op_sel:[0,0,0] op_sel_hi:[1,0,1]
    v_pk_fma_f32 v[206:207], v[222:223], v[228:229], v[206:207] op_sel:[0,0,0] op_sel_hi:[1,0,1]
    v_pk_mul_f32 v[200:201], v[200:201], v[204:205]
    v_pk_mul_f32 v[202:203], v[202:203], v[206:207]
    v_cvt_pk_bf16_f32 v196, v196, v197
    v_cvt_pk_bf16_f32 v197, v198, v199
    v_cvt_pk_bf16_f32 v198, v200, v201
    v_cvt_pk_bf16_f32 v199, v202, v203
    v_and_b32 v196, -2, v196
    ds_read_b128 v[224:227], v237 offset:1792
    ds_read_b128 v[228:231], v237 offset:2048
    buffer_store_dwordx4 v[192:195], v254, s[40:43], s32 offen offset:1024 sc1
    ds_write_b128 v233, v[192:195] offset:20480
    buffer_store_dwordx4 v[196:199], v254, s[40:43], s33 offen offset:1024 sc1
    ds_write_b128 v233, v[196:199] offset:21504
    v_accvgpr_read_b32 v192, a24
    v_accvgpr_read_b32 v193, a25
    v_accvgpr_read_b32 v194, a26
    v_accvgpr_read_b32 v195, a27
    v_accvgpr_read_b32 v196, a56
    v_accvgpr_read_b32 v197, a57
    v_accvgpr_read_b32 v198, a58
    v_accvgpr_read_b32 v199, a59
    s_waitcnt lgkmcnt(3)
    v_pk_fma_f32 v[192:193], v[208:209], v[224:225], v[192:193] op_sel:[0,0,0] op_sel_hi:[1,0,1]
    v_pk_fma_f32 v[194:195], v[210:211], v[224:225], v[194:195] op_sel:[0,0,0] op_sel_hi:[1,0,1]
    v_pk_fma_f32 v[196:197], v[212:213], v[224:225], v[196:197] op_sel:[0,0,0] op_sel_hi:[1,0,1]
    v_pk_fma_f32 v[198:199], v[214:215], v[224:225], v[198:199] op_sel:[0,0,0] op_sel_hi:[1,0,1]
    v_pk_mul_f32 v[192:193], v[192:193], v[224:225] op_sel:[0,1] op_sel_hi:[1,1]
    v_pk_mul_f32 v[194:195], v[194:195], v[224:225] op_sel:[0,1] op_sel_hi:[1,1]
    v_pk_mul_f32 v[196:197], v[196:197], v[224:225] op_sel:[0,1] op_sel_hi:[1,1]
    v_pk_mul_f32 v[198:199], v[198:199], v[224:225] op_sel:[0,1] op_sel_hi:[1,1]
    v_exp_f32 v192, v192
    v_exp_f32 v193, v193
    v_exp_f32 v194, v194
    v_exp_f32 v195, v195
    v_exp_f32 v196, v196
    v_exp_f32 v197, v197
    v_exp_f32 v198, v198
    v_exp_f32 v199, v199
    v_accvgpr_read_b32 v200, a88
    v_accvgpr_read_b32 v201, a89
    v_accvgpr_read_b32 v202, a90
    v_accvgpr_read_b32 v203, a91
    v_pk_fma_f32 v[192:193], v[192:193], v[226:227], v[226:227] op_sel:[0,0,0] op_sel_hi:[1,0,0]
    v_pk_fma_f32 v[194:195], v[194:195], v[226:227], v[226:227] op_sel:[0,0,0] op_sel_hi:[1,0,0]
    v_pk_fma_f32 v[196:197], v[196:197], v[226:227], v[226:227] op_sel:[0,0,0] op_sel_hi:[1,0,0]
    v_pk_fma_f32 v[198:199], v[198:199], v[226:227], v[226:227] op_sel:[0,0,0] op_sel_hi:[1,0,0]
    v_rcp_f32 v192, v192
    v_rcp_f32 v193, v193
    v_rcp_f32 v194, v194
    v_rcp_f32 v195, v195
    v_rcp_f32 v196, v196
    v_rcp_f32 v197, v197
    v_rcp_f32 v198, v198
    v_rcp_f32 v199, v199
    v_pk_fma_f32 v[200:201], v[216:217], v[224:225], v[200:201] op_sel:[0,0,0] op_sel_hi:[1,0,1]
    v_pk_fma_f32 v[202:203], v[218:219], v[224:225], v[202:203] op_sel:[0,0,0] op_sel_hi:[1,0,1]
    v_pk_mul_f32 v[192:193], v[192:193], v[200:201]
    v_pk_mul_f32 v[194:195], v[194:195], v[202:203]
    v_accvgpr_read_b32 v200, a120
    v_accvgpr_read_b32 v201, a121
    v_accvgpr_read_b32 v202, a122
    v_accvgpr_read_b32 v203, a123
    v_pk_fma_f32 v[200:201], v[220:221], v[224:225], v[200:201] op_sel:[0,0,0] op_sel_hi:[1,0,1]
    v_pk_fma_f32 v[202:203], v[222:223], v[224:225], v[202:203] op_sel:[0,0,0] op_sel_hi:[1,0,1]
    v_pk_mul_f32 v[196:197], v[196:197], v[200:201]
    v_pk_mul_f32 v[198:199], v[198:199], v[202:203]
    v_cvt_pk_bf16_f32 v192, v192, v193
    v_cvt_pk_bf16_f32 v193, v194, v195
    v_cvt_pk_bf16_f32 v194, v196, v197
    v_cvt_pk_bf16_f32 v195, v198, v199
    v_and_b32 v192, -2, v192
    v_accvgpr_read_b32 v196, a28
    v_accvgpr_read_b32 v197, a29
    v_accvgpr_read_b32 v198, a30
    v_accvgpr_read_b32 v199, a31
    v_accvgpr_read_b32 v200, a60
    v_accvgpr_read_b32 v201, a61
    v_accvgpr_read_b32 v202, a62
    v_accvgpr_read_b32 v203, a63
    s_waitcnt lgkmcnt(2)
    v_pk_fma_f32 v[196:197], v[208:209], v[228:229], v[196:197] op_sel:[0,0,0] op_sel_hi:[1,0,1]
    v_pk_fma_f32 v[198:199], v[210:211], v[228:229], v[198:199] op_sel:[0,0,0] op_sel_hi:[1,0,1]
    v_pk_fma_f32 v[200:201], v[212:213], v[228:229], v[200:201] op_sel:[0,0,0] op_sel_hi:[1,0,1]
    v_pk_fma_f32 v[202:203], v[214:215], v[228:229], v[202:203] op_sel:[0,0,0] op_sel_hi:[1,0,1]
    v_pk_mul_f32 v[196:197], v[196:197], v[228:229] op_sel:[0,1] op_sel_hi:[1,1]
    v_pk_mul_f32 v[198:199], v[198:199], v[228:229] op_sel:[0,1] op_sel_hi:[1,1]
    v_pk_mul_f32 v[200:201], v[200:201], v[228:229] op_sel:[0,1] op_sel_hi:[1,1]
    v_pk_mul_f32 v[202:203], v[202:203], v[228:229] op_sel:[0,1] op_sel_hi:[1,1]
    v_exp_f32 v196, v196
    v_exp_f32 v197, v197
    v_exp_f32 v198, v198
    v_exp_f32 v199, v199
    v_exp_f32 v200, v200
    v_exp_f32 v201, v201
    v_exp_f32 v202, v202
    v_exp_f32 v203, v203
    v_accvgpr_read_b32 v204, a92
    v_accvgpr_read_b32 v205, a93
    v_accvgpr_read_b32 v206, a94
    v_accvgpr_read_b32 v207, a95
    v_pk_fma_f32 v[196:197], v[196:197], v[230:231], v[230:231] op_sel:[0,0,0] op_sel_hi:[1,0,0]
    v_pk_fma_f32 v[198:199], v[198:199], v[230:231], v[230:231] op_sel:[0,0,0] op_sel_hi:[1,0,0]
    v_pk_fma_f32 v[200:201], v[200:201], v[230:231], v[230:231] op_sel:[0,0,0] op_sel_hi:[1,0,0]
    v_pk_fma_f32 v[202:203], v[202:203], v[230:231], v[230:231] op_sel:[0,0,0] op_sel_hi:[1,0,0]
    v_rcp_f32 v196, v196
    v_rcp_f32 v197, v197
    v_rcp_f32 v198, v198
    v_rcp_f32 v199, v199
    v_rcp_f32 v200, v200
    v_rcp_f32 v201, v201
    v_rcp_f32 v202, v202
    v_rcp_f32 v203, v203
    v_pk_fma_f32 v[204:205], v[216:217], v[228:229], v[204:205] op_sel:[0,0,0] op_sel_hi:[1,0,1]
    v_pk_fma_f32 v[206:207], v[218:219], v[228:229], v[206:207] op_sel:[0,0,0] op_sel_hi:[1,0,1]
    v_pk_mul_f32 v[196:197], v[196:197], v[204:205]
    v_pk_mul_f32 v[198:199], v[198:199], v[206:207]
    v_accvgpr_read_b32 v204, a124
    v_accvgpr_read_b32 v205, a125
    v_accvgpr_read_b32 v206, a126
    v_accvgpr_read_b32 v207, a127
    v_pk_fma_f32 v[204:205], v[220:221], v[228:229], v[204:205] op_sel:[0,0,0] op_sel_hi:[1,0,1]
    v_pk_fma_f32 v[206:207], v[222:223], v[228:229], v[206:207] op_sel:[0,0,0] op_sel_hi:[1,0,1]
    v_pk_mul_f32 v[200:201], v[200:201], v[204:205]
    v_pk_mul_f32 v[202:203], v[202:203], v[206:207]
    v_cvt_pk_bf16_f32 v196, v196, v197
    v_cvt_pk_bf16_f32 v197, v198, v199
    v_cvt_pk_bf16_f32 v198, v200, v201
    v_cvt_pk_bf16_f32 v199, v202, v203
    v_and_b32 v196, -2, v196
    ds_read_b128 v[208:211], v238 offset:2496
    ds_read_b128 v[212:215], v238 offset:2560
    ds_read_b128 v[224:227], v237 offset:256
    ds_read_b128 v[216:219], v238 offset:2368
    ds_read_b128 v[220:223], v238 offset:2432
    ds_read_b128 v[228:231], v237 offset:512
    ds_read_b128 v[200:203], v237 offset:768
    ds_read_b128 v[204:207], v237 offset:1024
    buffer_store_dwordx4 v[192:195], v254, s[40:43], s34 offen offset:1024 sc1
    ds_write_b128 v233, v[192:195] offset:22528
    buffer_store_dwordx4 v[196:199], v254, s[40:43], s35 offen offset:1024 sc1
    ds_write_b128 v233, v[196:199] offset:23552
    s_waitcnt lgkmcnt(7)
    v_pk_fma_f32 v[64:65], v[208:209], v[224:225], v[64:65] op_sel:[0,0,0] op_sel_hi:[1,0,1]
    v_pk_fma_f32 v[66:67], v[210:211], v[224:225], v[66:67] op_sel:[0,0,0] op_sel_hi:[1,0,1]
    v_pk_fma_f32 v[96:97], v[212:213], v[224:225], v[96:97] op_sel:[0,0,0] op_sel_hi:[1,0,1]
    v_pk_fma_f32 v[98:99], v[214:215], v[224:225], v[98:99] op_sel:[0,0,0] op_sel_hi:[1,0,1]
    s_waitcnt lgkmcnt(6)
    v_pk_fma_f32 v[0:1], v[216:217], v[224:225], v[0:1] op_sel:[0,0,0] op_sel_hi:[1,0,1]
    v_pk_fma_f32 v[2:3], v[218:219], v[224:225], v[2:3] op_sel:[0,0,0] op_sel_hi:[1,0,1]
    s_waitcnt lgkmcnt(5)
    v_pk_fma_f32 v[32:33], v[220:221], v[224:225], v[32:33] op_sel:[0,0,0] op_sel_hi:[1,0,1]
    v_pk_fma_f32 v[34:35], v[222:223], v[224:225], v[34:35] op_sel:[0,0,0] op_sel_hi:[1,0,1]
    v_pk_mul_f32 v[64:65], v[64:65], v[226:227] op_sel:[0,1] op_sel_hi:[1,1]
    v_pk_mul_f32 v[66:67], v[66:67], v[226:227] op_sel:[0,1] op_sel_hi:[1,1]
    v_pk_mul_f32 v[96:97], v[96:97], v[226:227] op_sel:[0,1] op_sel_hi:[1,1]
    v_pk_mul_f32 v[98:99], v[98:99], v[226:227] op_sel:[0,1] op_sel_hi:[1,1]
    v_cvt_pk_bf16_f32 v0, v0, v1
    v_cvt_pk_bf16_f32 v1, v2, v3
    v_cvt_pk_bf16_f32 v2, v32, v33
    v_cvt_pk_bf16_f32 v3, v34, v35
    v_cvt_pk_bf16_f32 v64, v64, v65
    v_cvt_pk_bf16_f32 v65, v66, v67
    v_cvt_pk_bf16_f32 v66, v96, v97
    v_cvt_pk_bf16_f32 v67, v98, v99
    s_waitcnt lgkmcnt(4)
    v_pk_fma_f32 v[68:69], v[208:209], v[228:229], v[68:69] op_sel:[0,0,0] op_sel_hi:[1,0,1]
    v_pk_fma_f32 v[70:71], v[210:211], v[228:229], v[70:71] op_sel:[0,0,0] op_sel_hi:[1,0,1]
    v_pk_fma_f32 v[100:101], v[212:213], v[228:229], v[100:101] op_sel:[0,0,0] op_sel_hi:[1,0,1]
    v_pk_fma_f32 v[102:103], v[214:215], v[228:229], v[102:103] op_sel:[0,0,0] op_sel_hi:[1,0,1]
    v_pk_fma_f32 v[4:5], v[216:217], v[228:229], v[4:5] op_sel:[0,0,0] op_sel_hi:[1,0,1]
    v_pk_fma_f32 v[6:7], v[218:219], v[228:229], v[6:7] op_sel:[0,0,0] op_sel_hi:[1,0,1]
    v_pk_fma_f32 v[36:37], v[220:221], v[228:229], v[36:37] op_sel:[0,0,0] op_sel_hi:[1,0,1]
    v_pk_fma_f32 v[38:39], v[222:223], v[228:229], v[38:39] op_sel:[0,0,0] op_sel_hi:[1,0,1]
    v_pk_mul_f32 v[68:69], v[68:69], v[230:231] op_sel:[0,1] op_sel_hi:[1,1]
    v_pk_mul_f32 v[70:71], v[70:71], v[230:231] op_sel:[0,1] op_sel_hi:[1,1]
    v_pk_mul_f32 v[100:101], v[100:101], v[230:231] op_sel:[0,1] op_sel_hi:[1,1]
    v_pk_mul_f32 v[102:103], v[102:103], v[230:231] op_sel:[0,1] op_sel_hi:[1,1]
    v_cvt_pk_bf16_f32 v4, v4, v5
    v_cvt_pk_bf16_f32 v5, v6, v7
    v_cvt_pk_bf16_f32 v6, v36, v37
    v_cvt_pk_bf16_f32 v7, v38, v39
    v_cvt_pk_bf16_f32 v68, v68, v69
    v_cvt_pk_bf16_f32 v69, v70, v71
    v_cvt_pk_bf16_f32 v70, v100, v101
    v_cvt_pk_bf16_f32 v71, v102, v103
    s_lshl_b32 s84, s69, 9
    v_add_u32 v38, s84, v238
    v_bfe_u32 v39, v254, 4, 4
    v_lshlrev_b32 v39, 2, v39
    v_add_u32 v39, 161600, v39
    ds_read_b128 v[224:227], v237 offset:1280
    ds_read_b128 v[228:231], v237 offset:1536
    ds_read_b128 v[192:195], v237 offset:1792
    ds_read_b128 v[196:199], v237 offset:2048
    ds_read_b128 v[32:35], v237 offset:0
    ds_read_b128 v[96:99], v238
    ds_read_b128 v[100:103], v238 offset:1280
    ds_read2_b32 v[36:37], v39 offset1:16
    s_waitcnt lgkmcnt(11)
    v_pk_fma_f32 v[72:73], v[208:209], v[200:201], v[72:73] op_sel:[0,0,0] op_sel_hi:[1,0,1]
    v_pk_fma_f32 v[74:75], v[210:211], v[200:201], v[74:75] op_sel:[0,0,0] op_sel_hi:[1,0,1]
    v_pk_fma_f32 v[104:105], v[212:213], v[200:201], v[104:105] op_sel:[0,0,0] op_sel_hi:[1,0,1]
    v_pk_fma_f32 v[106:107], v[214:215], v[200:201], v[106:107] op_sel:[0,0,0] op_sel_hi:[1,0,1]
    v_pk_fma_f32 v[8:9], v[216:217], v[200:201], v[8:9] op_sel:[0,0,0] op_sel_hi:[1,0,1]
    v_pk_fma_f32 v[10:11], v[218:219], v[200:201], v[10:11] op_sel:[0,0,0] op_sel_hi:[1,0,1]
    v_pk_fma_f32 v[40:41], v[220:221], v[200:201], v[40:41] op_sel:[0,0,0] op_sel_hi:[1,0,1]
    v_pk_fma_f32 v[42:43], v[222:223], v[200:201], v[42:43] op_sel:[0,0,0] op_sel_hi:[1,0,1]
    v_pk_mul_f32 v[72:73], v[72:73], v[202:203] op_sel:[0,1] op_sel_hi:[1,1]
    v_pk_mul_f32 v[74:75], v[74:75], v[202:203] op_sel:[0,1] op_sel_hi:[1,1]
    v_pk_mul_f32 v[104:105], v[104:105], v[202:203] op_sel:[0,1] op_sel_hi:[1,1]
    v_pk_mul_f32 v[106:107], v[106:107], v[202:203] op_sel:[0,1] op_sel_hi:[1,1]
    v_cvt_pk_bf16_f32 v8, v8, v9
    v_cvt_pk_bf16_f32 v9, v10, v11
    v_cvt_pk_bf16_f32 v10, v40, v41
    v_cvt_pk_bf16_f32 v11, v42, v43
    v_cvt_pk_bf16_f32 v72, v72, v73
    v_cvt_pk_bf16_f32 v73, v74, v75
    v_cvt_pk_bf16_f32 v74, v104, v105
    v_cvt_pk_bf16_f32 v75, v106, v107
    s_waitcnt lgkmcnt(10)
    v_pk_fma_f32 v[76:77], v[208:209], v[204:205], v[76:77] op_sel:[0,0,0] op_sel_hi:[1,0,1]
    v_pk_fma_f32 v[78:79], v[210:211], v[204:205], v[78:79] op_sel:[0,0,0] op_sel_hi:[1,0,1]
    v_pk_fma_f32 v[108:109], v[212:213], v[204:205], v[108:109] op_sel:[0,0,0] op_sel_hi:[1,0,1]
    v_pk_fma_f32 v[110:111], v[214:215], v[204:205], v[110:111] op_sel:[0,0,0] op_sel_hi:[1,0,1]
    v_pk_fma_f32 v[12:13], v[216:217], v[204:205], v[12:13] op_sel:[0,0,0] op_sel_hi:[1,0,1]
    v_pk_fma_f32 v[14:15], v[218:219], v[204:205], v[14:15] op_sel:[0,0,0] op_sel_hi:[1,0,1]
    v_pk_fma_f32 v[44:45], v[220:221], v[204:205], v[44:45] op_sel:[0,0,0] op_sel_hi:[1,0,1]
    v_pk_fma_f32 v[46:47], v[222:223], v[204:205], v[46:47] op_sel:[0,0,0] op_sel_hi:[1,0,1]
    v_pk_mul_f32 v[76:77], v[76:77], v[206:207] op_sel:[0,1] op_sel_hi:[1,1]
    v_pk_mul_f32 v[78:79], v[78:79], v[206:207] op_sel:[0,1] op_sel_hi:[1,1]
    v_pk_mul_f32 v[108:109], v[108:109], v[206:207] op_sel:[0,1] op_sel_hi:[1,1]
    v_pk_mul_f32 v[110:111], v[110:111], v[206:207] op_sel:[0,1] op_sel_hi:[1,1]
    v_cvt_pk_bf16_f32 v12, v12, v13
    v_cvt_pk_bf16_f32 v13, v14, v15
    v_cvt_pk_bf16_f32 v14, v44, v45
    v_cvt_pk_bf16_f32 v15, v46, v47
    v_cvt_pk_bf16_f32 v76, v76, v77
    v_cvt_pk_bf16_f32 v77, v78, v79
    v_cvt_pk_bf16_f32 v78, v108, v109
    v_cvt_pk_bf16_f32 v79, v110, v111
    s_waitcnt lgkmcnt(7)
    v_pk_fma_f32 v[80:81], v[208:209], v[224:225], v[80:81] op_sel:[0,0,0] op_sel_hi:[1,0,1]
    v_pk_fma_f32 v[82:83], v[210:211], v[224:225], v[82:83] op_sel:[0,0,0] op_sel_hi:[1,0,1]
    v_pk_fma_f32 v[112:113], v[212:213], v[224:225], v[112:113] op_sel:[0,0,0] op_sel_hi:[1,0,1]
    v_pk_fma_f32 v[114:115], v[214:215], v[224:225], v[114:115] op_sel:[0,0,0] op_sel_hi:[1,0,1]
    v_pk_fma_f32 v[16:17], v[216:217], v[224:225], v[16:17] op_sel:[0,0,0] op_sel_hi:[1,0,1]
    v_pk_fma_f32 v[18:19], v[218:219], v[224:225], v[18:19] op_sel:[0,0,0] op_sel_hi:[1,0,1]
    v_pk_fma_f32 v[48:49], v[220:221], v[224:225], v[48:49] op_sel:[0,0,0] op_sel_hi:[1,0,1]
    v_pk_fma_f32 v[50:51], v[222:223], v[224:225], v[50:51] op_sel:[0,0,0] op_sel_hi:[1,0,1]
    v_pk_mul_f32 v[80:81], v[80:81], v[226:227] op_sel:[0,1] op_sel_hi:[1,1]
    v_pk_mul_f32 v[82:83], v[82:83], v[226:227] op_sel:[0,1] op_sel_hi:[1,1]
    v_pk_mul_f32 v[112:113], v[112:113], v[226:227] op_sel:[0,1] op_sel_hi:[1,1]
    v_pk_mul_f32 v[114:115], v[114:115], v[226:227] op_sel:[0,1] op_sel_hi:[1,1]
    v_cvt_pk_bf16_f32 v16, v16, v17
    v_cvt_pk_bf16_f32 v17, v18, v19
    v_cvt_pk_bf16_f32 v18, v48, v49
    v_cvt_pk_bf16_f32 v19, v50, v51
    v_cvt_pk_bf16_f32 v80, v80, v81
    v_cvt_pk_bf16_f32 v81, v82, v83
    v_cvt_pk_bf16_f32 v82, v112, v113
    v_cvt_pk_bf16_f32 v83, v114, v115
    s_waitcnt lgkmcnt(6)
    v_pk_fma_f32 v[84:85], v[208:209], v[228:229], v[84:85] op_sel:[0,0,0] op_sel_hi:[1,0,1]
    v_pk_fma_f32 v[86:87], v[210:211], v[228:229], v[86:87] op_sel:[0,0,0] op_sel_hi:[1,0,1]
    v_pk_fma_f32 v[116:117], v[212:213], v[228:229], v[116:117] op_sel:[0,0,0] op_sel_hi:[1,0,1]
    v_pk_fma_f32 v[118:119], v[214:215], v[228:229], v[118:119] op_sel:[0,0,0] op_sel_hi:[1,0,1]
    v_pk_fma_f32 v[20:21], v[216:217], v[228:229], v[20:21] op_sel:[0,0,0] op_sel_hi:[1,0,1]
    v_pk_fma_f32 v[22:23], v[218:219], v[228:229], v[22:23] op_sel:[0,0,0] op_sel_hi:[1,0,1]
    v_pk_fma_f32 v[52:53], v[220:221], v[228:229], v[52:53] op_sel:[0,0,0] op_sel_hi:[1,0,1]
    v_pk_fma_f32 v[54:55], v[222:223], v[228:229], v[54:55] op_sel:[0,0,0] op_sel_hi:[1,0,1]
    v_pk_mul_f32 v[84:85], v[84:85], v[230:231] op_sel:[0,1] op_sel_hi:[1,1]
    v_pk_mul_f32 v[86:87], v[86:87], v[230:231] op_sel:[0,1] op_sel_hi:[1,1]
    v_pk_mul_f32 v[116:117], v[116:117], v[230:231] op_sel:[0,1] op_sel_hi:[1,1]
    v_pk_mul_f32 v[118:119], v[118:119], v[230:231] op_sel:[0,1] op_sel_hi:[1,1]
    v_cvt_pk_bf16_f32 v20, v20, v21
    v_cvt_pk_bf16_f32 v21, v22, v23
    v_cvt_pk_bf16_f32 v22, v52, v53
    v_cvt_pk_bf16_f32 v23, v54, v55
    v_cvt_pk_bf16_f32 v84, v84, v85
    v_cvt_pk_bf16_f32 v85, v86, v87
    v_cvt_pk_bf16_f32 v86, v116, v117
    v_cvt_pk_bf16_f32 v87, v118, v119
    ds_read_b128 v[40:43], v38 offset:512
    ds_read_b128 v[44:47], v38 offset:1792
    ds_read_b128 v[48:51], v38 offset:64
    ds_read_b128 v[52:55], v38 offset:1344
    ds_read_b128 v[104:107], v38 offset:128
    ds_read_b128 v[108:111], v38 offset:1408
    ds_read_b128 v[112:115], v38 offset:192
    ds_read_b128 v[116:119], v38 offset:1472
    s_waitcnt lgkmcnt(13)
    v_pk_fma_f32 v[88:89], v[208:209], v[192:193], v[88:89] op_sel:[0,0,0] op_sel_hi:[1,0,1]
    v_pk_fma_f32 v[90:91], v[210:211], v[192:193], v[90:91] op_sel:[0,0,0] op_sel_hi:[1,0,1]
    v_pk_fma_f32 v[120:121], v[212:213], v[192:193], v[120:121] op_sel:[0,0,0] op_sel_hi:[1,0,1]
    v_pk_fma_f32 v[122:123], v[214:215], v[192:193], v[122:123] op_sel:[0,0,0] op_sel_hi:[1,0,1]
    v_pk_fma_f32 v[24:25], v[216:217], v[192:193], v[24:25] op_sel:[0,0,0] op_sel_hi:[1,0,1]
    v_pk_fma_f32 v[26:27], v[218:219], v[192:193], v[26:27] op_sel:[0,0,0] op_sel_hi:[1,0,1]
    v_pk_fma_f32 v[56:57], v[220:221], v[192:193], v[56:57] op_sel:[0,0,0] op_sel_hi:[1,0,1]
    v_pk_fma_f32 v[58:59], v[222:223], v[192:193], v[58:59] op_sel:[0,0,0] op_sel_hi:[1,0,1]
    v_pk_mul_f32 v[88:89], v[88:89], v[194:195] op_sel:[0,1] op_sel_hi:[1,1]
    v_pk_mul_f32 v[90:91], v[90:91], v[194:195] op_sel:[0,1] op_sel_hi:[1,1]
    v_pk_mul_f32 v[120:121], v[120:121], v[194:195] op_sel:[0,1] op_sel_hi:[1,1]
    v_pk_mul_f32 v[122:123], v[122:123], v[194:195] op_sel:[0,1] op_sel_hi:[1,1]
    v_cvt_pk_bf16_f32 v24, v24, v25
    v_cvt_pk_bf16_f32 v25, v26, v27
    v_cvt_pk_bf16_f32 v26, v56, v57
    v_cvt_pk_bf16_f32 v27, v58, v59
    v_cvt_pk_bf16_f32 v88, v88, v89
    v_cvt_pk_bf16_f32 v89, v90, v91
    v_cvt_pk_bf16_f32 v90, v120, v121
    v_cvt_pk_bf16_f32 v91, v122, v123
    s_waitcnt lgkmcnt(12)
    v_pk_fma_f32 v[92:93], v[208:209], v[196:197], v[92:93] op_sel:[0,0,0] op_sel_hi:[1,0,1]
    v_pk_fma_f32 v[94:95], v[210:211], v[196:197], v[94:95] op_sel:[0,0,0] op_sel_hi:[1,0,1]
    v_pk_fma_f32 v[124:125], v[212:213], v[196:197], v[124:125] op_sel:[0,0,0] op_sel_hi:[1,0,1]
    v_pk_fma_f32 v[126:127], v[214:215], v[196:197], v[126:127] op_sel:[0,0,0] op_sel_hi:[1,0,1]
    v_pk_fma_f32 v[28:29], v[216:217], v[196:197], v[28:29] op_sel:[0,0,0] op_sel_hi:[1,0,1]
    v_pk_fma_f32 v[30:31], v[218:219], v[196:197], v[30:31] op_sel:[0,0,0] op_sel_hi:[1,0,1]
    v_pk_fma_f32 v[60:61], v[220:221], v[196:197], v[60:61] op_sel:[0,0,0] op_sel_hi:[1,0,1]
    v_pk_fma_f32 v[62:63], v[222:223], v[196:197], v[62:63] op_sel:[0,0,0] op_sel_hi:[1,0,1]
    v_pk_mul_f32 v[92:93], v[92:93], v[198:199] op_sel:[0,1] op_sel_hi:[1,1]
    v_pk_mul_f32 v[94:95], v[94:95], v[198:199] op_sel:[0,1] op_sel_hi:[1,1]
    v_pk_mul_f32 v[124:125], v[124:125], v[198:199] op_sel:[0,1] op_sel_hi:[1,1]
    v_pk_mul_f32 v[126:127], v[126:127], v[198:199] op_sel:[0,1] op_sel_hi:[1,1]
    v_cvt_pk_bf16_f32 v28, v28, v29
    v_cvt_pk_bf16_f32 v29, v30, v31
    v_cvt_pk_bf16_f32 v30, v60, v61
    v_cvt_pk_bf16_f32 v31, v62, v63
    v_cvt_pk_bf16_f32 v92, v92, v93
    v_cvt_pk_bf16_f32 v93, v94, v95
    v_cvt_pk_bf16_f32 v94, v124, v125
    v_cvt_pk_bf16_f32 v95, v126, v127
    ds_read_b128 v[56:59], v38 offset:256
    ds_read_b128 v[60:63], v38 offset:1536
    ds_read_b128 v[120:123], v38 offset:320
    ds_read_b128 v[124:127], v38 offset:1600
    s_waitcnt vmcnt(0)
    s_cmp_eq_u32 s78, 0
    s_cbranch_scc1 L_fl_e0
    buffer_wbl2 sc1
    s_waitcnt vmcnt(0)
L_fl_e0:
    s_mov_b64 exec, 1
    buffer_store_dword v239, v254, s[44:47], s10 offen offset:0
    buffer_store_dword v239, v254, s[44:47], s10 offen offset:128 sc1
    s_mov_b64 exec, -1
    v_accvgpr_read_b32 v200, a128
    v_accvgpr_read_b32 v201, a129
    v_accvgpr_read_b32 v202, a130
    v_accvgpr_read_b32 v203, a131
    v_accvgpr_read_b32 v204, a132
    v_accvgpr_read_b32 v205, a133
    v_accvgpr_read_b32 v206, a134
    v_accvgpr_read_b32 v207, a135
    s_waitcnt lgkmcnt(12)
    v_mov_b32 v36, v36
    v_max_u32 v228, v200, v204
    v_cmp_eq_u32 vcc, -1, v228
    s_nop 1
    s_cmp_lg_u64 vcc, 0
    s_cbranch_scc1 L_hxs
L_hxb:
    s_cmp_eq_u32 s69, 1
    s_cbranch_scc1 L_h1
    v_pk_fma_f32 v[200:201], v[208:209], v[32:33], v[200:201] op_sel:[0,0,0] op_sel_hi:[1,0,1]
    v_pk_fma_f32 v[202:203], v[210:211], v[32:33], v[202:203] op_sel:[0,0,0] op_sel_hi:[1,0,1]
    v_pk_fma_f32 v[204:205], v[212:213], v[32:33], v[204:205] op_sel:[0,0,0] op_sel_hi:[1,0,1]
    v_pk_fma_f32 v[206:207], v[214:215], v[32:33], v[206:207] op_sel:[0,0,0] op_sel_hi:[1,0,1]
    v_pk_mul_f32 v[200:201], v[200:201], v[34:35] op_sel:[0,1] op_sel_hi:[1,1]
    v_pk_mul_f32 v[202:203], v[202:203], v[34:35] op_sel:[0,1] op_sel_hi:[1,1]
    v_pk_mul_f32 v[204:205], v[204:205], v[34:35] op_sel:[0,1] op_sel_hi:[1,1]
    v_pk_mul_f32 v[206:207], v[206:207], v[34:35] op_sel:[0,1] op_sel_hi:[1,1]
    s_branch L_hd
L_h1:
    v_pk_fma_f32 v[200:201], v[96:97], v[36:37], v[200:201] op_sel:[0,0,0] op_sel_hi:[1,0,1]
    v_pk_fma_f32 v[202:203], v[98:99], v[36:37], v[202:203] op_sel:[0,0,0] op_sel_hi:[1,0,1]
    v_pk_fma_f32 v[204:205], v[96:97], v[36:37], v[204:205] op_sel:[0,1,0] op_sel_hi:[1,1,1]
    v_pk_fma_f32 v[206:207], v[98:99], v[36:37], v[206:207] op_sel:[0,1,0] op_sel_hi:[1,1,1]
    v_pk_mul_f32 v[200:201], v[200:201], v[100:101]
    v_pk_mul_f32 v[202:203], v[202:203], v[102:103]
    v_pk_mul_f32 v[204:205], v[204:205], v[100:101]
    v_pk_mul_f32 v[206:207], v[206:207], v[102:103]
L_hd:
    v_cvt_pk_bf16_f32 v228, v200, v201
    v_cvt_pk_bf16_f32 v229, v202, v203
    v_cvt_pk_bf16_f32 v230, v204, v205
    v_cvt_pk_bf16_f32 v231, v206, v207
    v_add_u32 v34, 147456, v254
    s_waitcnt lgkmcnt(11)
    v_pk_fma_f32 v[156:157], v[40:41], v[36:37], v[156:157] op_sel:[0,0,0] op_sel_hi:[1,0,1]
    v_pk_fma_f32 v[158:159], v[42:43], v[36:37], v[158:159] op_sel:[0,0,0] op_sel_hi:[1,0,1]
    v_pk_fma_f32 v[188:189], v[40:41], v[36:37], v[188:189] op_sel:[0,1,0] op_sel_hi:[1,1,1]
    v_pk_fma_f32 v[190:191], v[42:43], v[36:37], v[190:191] op_sel:[0,1,0] op_sel_hi:[1,1,1]
    s_waitcnt lgkmcnt(10)
    v_pk_mul_f32 v[156:157], v[156:157], v[44:45]
    v_pk_mul_f32 v[158:159], v[158:159], v[46:47]
    v_pk_mul_f32 v[188:189], v[188:189], v[44:45]
    v_pk_mul_f32 v[190:191], v[190:191], v[46:47]
    v_cvt_pk_bf16_f32 v208, v156, v157
    v_cvt_pk_bf16_f32 v209, v158, v159
    v_cvt_pk_bf16_f32 v226, v188, v189
    v_cvt_pk_bf16_f32 v227, v190, v191
    s_waitcnt lgkmcnt(9)
    v_pk_fma_f32 v[128:129], v[48:49], v[36:37], v[128:129] op_sel:[0,0,0] op_sel_hi:[1,0,1]
    v_pk_fma_f32 v[130:131], v[50:51], v[36:37], v[130:131] op_sel:[0,0,0] op_sel_hi:[1,0,1]
    v_pk_fma_f32 v[160:161], v[48:49], v[36:37], v[160:161] op_sel:[0,1,0] op_sel_hi:[1,1,1]
    v_pk_fma_f32 v[162:163], v[50:51], v[36:37], v[162:163] op_sel:[0,1,0] op_sel_hi:[1,1,1]
    s_waitcnt lgkmcnt(8)
    v_pk_mul_f32 v[128:129], v[128:129], v[52:53]
    v_pk_mul_f32 v[130:131], v[130:131], v[54:55]
    v_pk_mul_f32 v[160:161], v[160:161], v[52:53]
    v_pk_mul_f32 v[162:163], v[162:163], v[54:55]
    v_cvt_pk_bf16_f32 v194, v128, v129
    v_cvt_pk_bf16_f32 v195, v130, v131
    v_cvt_pk_bf16_f32 v212, v160, v161
    v_cvt_pk_bf16_f32 v213, v162, v163
    s_cmp_eq_u32 s69, 1
    s_cbranch_scc1 L_ex_w1
    ds_write_b128 v34, v[92:95] offset:1024
    ds_write_b64 v34, v[208:209] offset:2048
    ds_write_b64 v34, v[226:227] offset:2056
    s_branch L_ex_wd
L_ex_w1:
    ds_write_b128 v34, v[228:231]
L_ex_wd:
    ds_read_b128 v[40:43], v38 offset:384
    ds_read_b128 v[44:47], v38 offset:1664
    ds_read_b128 v[48:51], v38 offset:448
    ds_read_b128 v[52:55], v38 offset:1728
    ds_read_b32 v97, v237 offset:524
    ds_read_b32 v98, v237 offset:780
    ds_read_b32 v99, v237 offset:1036
    ds_read_b32 v100, v237 offset:1292
    ds_read_b32 v101, v237 offset:1548
    ds_read_b32 v102, v237 offset:1804
    ds_read_b32 v103, v237 offset:2060
    ds_read_b32 v96, v237 offset:268
    s_waitcnt lgkmcnt(15)
    v_pk_fma_f32 v[132:133], v[104:105], v[36:37], v[132:133] op_sel:[0,0,0] op_sel_hi:[1,0,1]
    v_pk_fma_f32 v[134:135], v[106:107], v[36:37], v[134:135] op_sel:[0,0,0] op_sel_hi:[1,0,1]
    v_pk_fma_f32 v[164:165], v[104:105], v[36:37], v[164:165] op_sel:[0,1,0] op_sel_hi:[1,1,1]
    v_pk_fma_f32 v[166:167], v[106:107], v[36:37], v[166:167] op_sel:[0,1,0] op_sel_hi:[1,1,1]
    v_pk_mul_f32 v[132:133], v[132:133], v[108:109]
    v_pk_mul_f32 v[134:135], v[134:135], v[110:111]
    v_pk_mul_f32 v[164:165], v[164:165], v[108:109]
    v_pk_mul_f32 v[166:167], v[166:167], v[110:111]
    v_cvt_pk_bf16_f32 v196, v132, v133
    v_cvt_pk_bf16_f32 v197, v134, v135
    v_cvt_pk_bf16_f32 v214, v164, v165
    v_cvt_pk_bf16_f32 v215, v166, v167
    v_pk_fma_f32 v[136:137], v[112:113], v[36:37], v[136:137] op_sel:[0,0,0] op_sel_hi:[1,0,1]
    v_pk_fma_f32 v[138:139], v[114:115], v[36:37], v[138:139] op_sel:[0,0,0] op_sel_hi:[1,0,1]
    v_pk_fma_f32 v[168:169], v[112:113], v[36:37], v[168:169] op_sel:[0,1,0] op_sel_hi:[1,1,1]
    v_pk_fma_f32 v[170:171], v[114:115], v[36:37], v[170:171] op_sel:[0,1,0] op_sel_hi:[1,1,1]
    v_pk_mul_f32 v[136:137], v[136:137], v[116:117]
    v_pk_mul_f32 v[138:139], v[138:139], v[118:119]
    v_pk_mul_f32 v[168:169], v[168:169], v[116:117]
    v_pk_mul_f32 v[170:171], v[170:171], v[118:119]
    v_cvt_pk_bf16_f32 v198, v136, v137
    v_cvt_pk_bf16_f32 v199, v138, v139
    v_cvt_pk_bf16_f32 v216, v168, v169
    v_cvt_pk_bf16_f32 v217, v170, v171
    v_pk_fma_f32 v[140:141], v[56:57], v[36:37], v[140:141] op_sel:[0,0,0] op_sel_hi:[1,0,1]
    v_pk_fma_f32 v[142:143], v[58:59], v[36:37], v[142:143] op_sel:[0,0,0] op_sel_hi:[1,0,1]
    v_pk_fma_f32 v[172:173], v[56:57], v[36:37], v[172:173] op_sel:[0,1,0] op_sel_hi:[1,1,1]
    v_pk_fma_f32 v[174:175], v[58:59], v[36:37], v[174:175] op_sel:[0,1,0] op_sel_hi:[1,1,1]
    v_pk_mul_f32 v[140:141], v[140:141], v[60:61]
    v_pk_mul_f32 v[142:143], v[142:143], v[62:63]
    v_pk_mul_f32 v[172:173], v[172:173], v[60:61]
    v_pk_mul_f32 v[174:175], v[174:175], v[62:63]
    v_cvt_pk_bf16_f32 v200, v140, v141
    v_cvt_pk_bf16_f32 v201, v142, v143
    v_cvt_pk_bf16_f32 v218, v172, v173
    v_cvt_pk_bf16_f32 v219, v174, v175
    s_waitcnt lgkmcnt(14)
    v_pk_fma_f32 v[144:145], v[120:121], v[36:37], v[144:145] op_sel:[0,0,0] op_sel_hi:[1,0,1]
    v_pk_fma_f32 v[146:147], v[122:123], v[36:37], v[146:147] op_sel:[0,0,0] op_sel_hi:[1,0,1]
    v_pk_fma_f32 v[176:177], v[120:121], v[36:37], v[176:177] op_sel:[0,1,0] op_sel_hi:[1,1,1]
    v_pk_fma_f32 v[178:179], v[122:123], v[36:37], v[178:179] op_sel:[0,1,0] op_sel_hi:[1,1,1]
    s_waitcnt lgkmcnt(13)
    v_pk_mul_f32 v[144:145], v[144:145], v[124:125]
    v_pk_mul_f32 v[146:147], v[146:147], v[126:127]
    v_pk_mul_f32 v[176:177], v[176:177], v[124:125]
    v_pk_mul_f32 v[178:179], v[178:179], v[126:127]
    v_cvt_pk_bf16_f32 v202, v144, v145
    v_cvt_pk_bf16_f32 v203, v146, v147
    v_cvt_pk_bf16_f32 v220, v176, v177
    v_cvt_pk_bf16_f32 v221, v178, v179
    s_waitcnt lgkmcnt(11)
    v_pk_fma_f32 v[148:149], v[40:41], v[36:37], v[148:149] op_sel:[0,0,0] op_sel_hi:[1,0,1]
    v_pk_fma_f32 v[150:151], v[42:43], v[36:37], v[150:151] op_sel:[0,0,0] op_sel_hi:[1,0,1]
    v_pk_fma_f32 v[180:181], v[40:41], v[36:37], v[180:181] op_sel:[0,1,0] op_sel_hi:[1,1,1]
    v_pk_fma_f32 v[182:183], v[42:43], v[36:37], v[182:183] op_sel:[0,1,0] op_sel_hi:[1,1,1]
    s_waitcnt lgkmcnt(10)
    v_pk_mul_f32 v[148:149], v[148:149], v[44:45]
    v_pk_mul_f32 v[150:151], v[150:151], v[46:47]
    v_pk_mul_f32 v[180:181], v[180:181], v[44:45]
    v_pk_mul_f32 v[182:183], v[182:183], v[46:47]
    v_cvt_pk_bf16_f32 v204, v148, v149
    v_cvt_pk_bf16_f32 v205, v150, v151
    v_cvt_pk_bf16_f32 v222, v180, v181
    v_cvt_pk_bf16_f32 v223, v182, v183
    s_waitcnt lgkmcnt(9)
    v_pk_fma_f32 v[152:153], v[48:49], v[36:37], v[152:153] op_sel:[0,0,0] op_sel_hi:[1,0,1]
    v_pk_fma_f32 v[154:155], v[50:51], v[36:37], v[154:155] op_sel:[0,0,0] op_sel_hi:[1,0,1]
    v_pk_fma_f32 v[184:185], v[48:49], v[36:37], v[184:185] op_sel:[0,1,0] op_sel_hi:[1,1,1]
    v_pk_fma_f32 v[186:187], v[50:51], v[36:37], v[186:187] op_sel:[0,1,0] op_sel_hi:[1,1,1]
    s_waitcnt lgkmcnt(8)
    v_pk_mul_f32 v[152:153], v[152:153], v[52:53]
    v_pk_mul_f32 v[154:155], v[154:155], v[54:55]
    v_pk_mul_f32 v[184:185], v[184:185], v[52:53]
    v_pk_mul_f32 v[186:187], v[186:187], v[54:55]
    v_cvt_pk_bf16_f32 v206, v152, v153
    v_cvt_pk_bf16_f32 v207, v154, v155
    v_cvt_pk_bf16_f32 v224, v184, v185
    v_cvt_pk_bf16_f32 v225, v186, v187
    v_bfe_u32 v124, v254, 4, 4
    v_lshrrev_b32 v125, 8, v254
    v_lshlrev_b32 v125, 2, v125
    v_sub_u32 v124, v124, v125
    v_mov_b32 v33, 4048155338
    s_or_b32 s84, s65, s69
    s_cmp_eq_u32 s84, 0
    s_cselect_b64 s[86:87], 0, -1
    v_subrev_u32 v127, 0, v124
    v_and_b32 v32, 0x80000001, v127
    v_cmp_eq_u32 vcc, 0, v32
    s_nop 1
    v_cndmask_b32 v108, v33, 0, vcc
    v_cmp_eq_u32 vcc, 0x80000000, v32
    s_nop 1
    v_cndmask_b32 v104, v33, 0, vcc
    v_subrev_u32 v127, 1, v124
    v_and_b32 v32, 0x80000001, v127
    v_cmp_eq_u32 vcc, 0, v32
    s_nop 1
    v_cndmask_b32 v109, v33, 0, vcc
    v_cmp_eq_u32 vcc, 0x80000000, v32
    s_nop 1
    v_cndmask_b32 v105, v33, 0, vcc
    v_subrev_u32 v127, 2, v124
    v_and_b32 v32, 0x80000001, v127
    v_cmp_eq_u32 vcc, 0, v32
    s_nop 1
    v_cndmask_b32 v110, v33, 0, vcc
    v_cmp_eq_u32 vcc, 0x80000000, v32
    s_nop 1
    v_cndmask_b32 v106, v33, 0, vcc
    v_subrev_u32 v127, 3, v124
    v_and_b32 v32, 0x80000001, v127
    v_cmp_eq_u32 vcc, 0, v32
    s_nop 1
    v_cndmask_b32 v111, v33, 0, vcc
    v_cmp_eq_u32 vcc, 0x80000000, v32
    s_nop 1
    v_cndmask_b32 v107, v33, 0, vcc
    s_waitcnt lgkmcnt(0)
    s_barrier
    v_accvgpr_read_b32 v35, a253
    s_mul_i32 s84, s71, 3072
    s_sub_u32 s84, s28, s84
    buffer_load_dword a253, v35, s[40:43], s84 offen offset:2048
    buffer_load_dword a254, v35, s[40:43], s28 offen offset:1024
    s_cmp_eq_u32 s69, 1
    s_cbranch_scc1 L_ex_r1
    ds_read_b64 v[192:193], v34
    ds_read_b64 v[210:211], v34 offset:8
    s_branch L_ex_rd
L_ex_r1:
    ds_read_b128 v[228:231], v34 offset:1024
    ds_read_b64 v[192:193], v34 offset:2048
    ds_read_b64 v[210:211], v34 offset:2056
L_ex_rd:
    v_mfma_f32_16x16x32_bf16 v[128:131], v[64:67], v[4:7], v[104:107]
    v_subrev_u32 v127, 0, v124
    v_ashrrev_i32 v127, 31, v127
    v_mfma_f32_16x16x32_bf16 v[132:135], v[68:71], v[4:7], v[108:111]
    v_and_b32 v120, 0xffff, v127
    v_mov_b32 v116, 0x3f803f80
    v_mfma_f32_16x16x32_bf16 v[136:139], v[68:71], v[8:11], v[104:107]
    v_cndmask_b32 v112, v33, v104, s[86:87]
    v_subrev_u32 v127, 1, v124
    v_mfma_f32_16x16x32_bf16 v[140:143], v[72:75], v[8:11], v[108:111]
    v_ashrrev_i32 v127, 31, v127
    v_and_b32 v127, 0xffff0000, v127
    v_mfma_f32_16x16x32_bf16 v[144:147], v[72:75], v[12:15], v[104:107]
    v_or_b32 v120, v120, v127
    v_not_b32 v122, v120
    v_mfma_f32_16x16x32_bf16 v[148:151], v[76:79], v[12:15], v[108:111]
    v_mov_b32 v117, 0x3f803f80
    v_cndmask_b32 v113, v33, v105, s[86:87]
    v_mfma_f32_16x16x32_bf16 v[152:155], v[76:79], v[16:19], v[104:107]
    v_subrev_u32 v127, 2, v124
    v_ashrrev_i32 v127, 31, v127
    v_mfma_f32_16x16x32_bf16 v[156:159], v[80:83], v[16:19], v[108:111]
    v_and_b32 v121, 0xffff, v127
    v_mov_b32 v118, 0x3f803f80
    v_mfma_f32_16x16x32_bf16 v[160:163], v[80:83], v[20:23], v[104:107]
    v_cndmask_b32 v114, v33, v106, s[86:87]
    v_subrev_u32 v127, 3, v124
    v_mfma_f32_16x16x32_bf16 v[164:167], v[84:87], v[20:23], v[108:111]
    v_ashrrev_i32 v127, 31, v127
    v_and_b32 v127, 0xffff0000, v127
    v_mfma_f32_16x16x32_bf16 v[168:171], v[84:87], v[24:27], v[104:107]
    v_or_b32 v121, v121, v127
    v_not_b32 v123, v121
    v_mfma_f32_16x16x32_bf16 v[172:175], v[88:91], v[24:27], v[108:111]
    v_mov_b32 v119, 0x3f803f80
    v_cndmask_b32 v115, v33, v107, s[86:87]
    v_mfma_f32_16x16x32_bf16 v[176:179], v[88:91], v[28:31], v[104:107]
    v_max_f32 v128, v128, v132
    v_max_f32 v129, v129, v133
    v_mfma_f32_16x16x32_bf16 v[180:183], v[92:95], v[28:31], v[108:111]
    v_max_f32 v130, v130, v134
    v_max_f32 v131, v131, v135
    s_waitcnt lgkmcnt(0)
    v_mfma_f32_16x16x32_bf16 v[184:187], v[228:231], v[0:3], v[112:115]
    v_max3_f32 v40, v128, v129, v130
    v_max_f32 v40, v40, v131
    v_mfma_f32_16x16x32_bf16 v[188:191], v[64:67], v[0:3], v[108:111]
    v_mul_f32 v40, v40, v97
    v_max_f32 v136, v136, v140
    v_max_f32 v137, v137, v141
    v_max_f32 v138, v138, v142
    v_max_f32 v139, v139, v143
    v_max3_f32 v41, v136, v137, v138
    v_max_f32 v41, v41, v139
    v_mul_f32 v41, v41, v98
    v_max_f32 v144, v144, v148
    v_max_f32 v145, v145, v149
    v_max_f32 v146, v146, v150
    v_max_f32 v147, v147, v151
    v_max3_f32 v42, v144, v145, v146
    v_max_f32 v42, v42, v147
    v_mul_f32 v42, v42, v99
    v_max_f32 v152, v152, v156
    v_max_f32 v153, v153, v157
    v_max_f32 v154, v154, v158
    v_max_f32 v155, v155, v159
    v_max3_f32 v43, v152, v153, v154
    v_max_f32 v43, v43, v155
    v_mul_f32 v43, v43, v100
    v_max_f32 v160, v160, v164
    v_max_f32 v161, v161, v165
    v_max_f32 v162, v162, v166
    v_permlane16_swap_b32 v40, v41
    v_max_f32 v163, v163, v167
    v_max3_f32 v44, v160, v161, v162
    v_permlane16_swap_b32 v42, v43
    v_max_f32 v44, v44, v163
    v_mul_f32 v44, v44, v101
    v_max_f32 v40, v40, v41
    v_max_f32 v168, v168, v172
    v_max_f32 v169, v169, v173
    v_max_f32 v170, v170, v174
    v_max_f32 v42, v42, v43
    v_max_f32 v171, v171, v175
    v_max3_f32 v45, v168, v169, v170
    v_permlane32_swap_b32 v40, v42
    v_max_f32 v45, v45, v171
    v_mul_f32 v45, v45, v102
    v_max_f32 v40, v40, v42
    v_max_f32 v176, v176, v180
    v_max_f32 v177, v177, v181
    v_max_f32 v178, v178, v182
    v_mov_b32 v42, v40
    v_max_f32 v179, v179, v183
    v_max3_f32 v46, v176, v177, v178
    v_permlane32_swap_b32 v40, v42
    v_max_f32 v46, v46, v179
    v_mul_f32 v46, v46, v103
    v_mov_b32 v41, v40
    v_max_f32 v184, v184, v188
    v_max_f32 v185, v185, v189
    v_max_f32 v186, v186, v190
    v_mov_b32 v43, v42
    v_max_f32 v187, v187, v191
    v_max3_f32 v47, v184, v185, v186
    v_permlane16_swap_b32 v40, v41
    v_max_f32 v47, v47, v187
    v_mul_f32 v47, v47, v96
    v_permlane16_swap_b32 v42, v43
    v_fma_f32 v128, v128, v97, -v40
    v_fma_f32 v129, v129, v97, -v40
    v_fma_f32 v130, v130, v97, -v40
    v_permlane16_swap_b32 v44, v45
    v_fma_f32 v131, v131, v97, -v40
    v_exp_f32 v128, v128
    v_lshrrev_b32 v238, 2, v254
    buffer_load_dword v238, v238, s[44:47], s77 offen offset:0 sc1
    v_permlane16_swap_b32 v46, v47
    v_exp_f32 v129, v129
    v_exp_f32 v130, v130
    v_max_f32 v44, v44, v45
    v_exp_f32 v131, v131
    v_cvt_pk_bf16_f32 v128, v128, v129
    v_cvt_pk_bf16_f32 v129, v130, v131
    v_max_f32 v46, v46, v47
    v_and_b32 v132, v120, v128
    v_and_b32 v133, v121, v129
    v_permlane32_swap_b32 v44, v46
    v_and_b32 v134, v122, v128
    v_and_b32 v135, v123, v129
    v_max_f32 v44, v44, v46
    v_fma_f32 v136, v136, v98, -v41
    v_mfma_f32_16x16x32_bf16 v[68:71], v[116:119], v[132:135], 0
    v_fma_f32 v137, v137, v98, -v41
    v_fma_f32 v138, v138, v98, -v41
    v_mfma_f32_16x16x32_bf16 v[128:131], v[194:197], v[132:135], 0
    v_mov_b32 v46, v44
    v_fma_f32 v139, v139, v98, -v41
    v_mfma_f32_16x16x32_bf16 v[4:7], v[212:215], v[132:135], 0
    v_exp_f32 v136, v136
    v_permlane32_swap_b32 v44, v46
    v_exp_f32 v137, v137
    v_exp_f32 v138, v138
    v_mov_b32 v45, v44
    v_exp_f32 v139, v139
    v_cvt_pk_bf16_f32 v136, v136, v137
    v_cvt_pk_bf16_f32 v137, v138, v139
    v_mov_b32 v47, v46
    v_and_b32 v140, v120, v136
    v_and_b32 v141, v121, v137
    v_permlane16_swap_b32 v44, v45
    v_and_b32 v142, v122, v136
    v_and_b32 v143, v123, v137
    v_permlane16_swap_b32 v46, v47
    v_fma_f32 v144, v144, v99, -v42
    v_mfma_f32_16x16x32_bf16 v[72:75], v[116:119], v[140:143], 0
    v_fma_f32 v145, v145, v99, -v42
    v_fma_f32 v146, v146, v99, -v42
    v_mfma_f32_16x16x32_bf16 v[136:139], v[196:199], v[140:143], 0
    v_fma_f32 v147, v147, v99, -v42
    v_exp_f32 v144, v144
    v_mfma_f32_16x16x32_bf16 v[8:11], v[214:217], v[140:143], 0
    v_exp_f32 v145, v145
    v_exp_f32 v146, v146
    v_exp_f32 v147, v147
    v_cvt_pk_bf16_f32 v144, v144, v145
    v_cvt_pk_bf16_f32 v145, v146, v147
    v_and_b32 v148, v120, v144
    v_and_b32 v149, v121, v145
    v_and_b32 v150, v122, v144
    v_and_b32 v151, v123, v145
    v_fma_f32 v152, v152, v100, -v43
    v_fma_f32 v153, v153, v100, -v43
    v_mfma_f32_16x16x32_bf16 v[76:79], v[116:119], v[148:151], 0
    v_fma_f32 v154, v154, v100, -v43
    v_fma_f32 v155, v155, v100, -v43
    v_mfma_f32_16x16x32_bf16 v[144:147], v[198:201], v[148:151], 0
    v_exp_f32 v152, v152
    v_mfma_f32_16x16x32_bf16 v[12:15], v[216:219], v[148:151], 0
    v_exp_f32 v153, v153
    v_exp_f32 v154, v154
    v_exp_f32 v155, v155
    v_cvt_pk_bf16_f32 v152, v152, v153
    v_cvt_pk_bf16_f32 v153, v154, v155
    v_and_b32 v156, v120, v152
    v_and_b32 v157, v121, v153
    v_and_b32 v158, v122, v152
    v_and_b32 v159, v123, v153
    v_fma_f32 v160, v160, v101, -v44
    v_fma_f32 v161, v161, v101, -v44
    v_mfma_f32_16x16x32_bf16 v[80:83], v[116:119], v[156:159], 0
    v_fma_f32 v162, v162, v101, -v44
    v_fma_f32 v163, v163, v101, -v44
    v_mfma_f32_16x16x32_bf16 v[152:155], v[200:203], v[156:159], 0
    v_exp_f32 v160, v160
    v_mfma_f32_16x16x32_bf16 v[16:19], v[218:221], v[156:159], 0
    v_exp_f32 v161, v161
    v_exp_f32 v162, v162
    v_exp_f32 v163, v163
    v_cvt_pk_bf16_f32 v160, v160, v161
    v_cvt_pk_bf16_f32 v161, v162, v163
    v_and_b32 v164, v120, v160
    v_and_b32 v165, v121, v161
    v_and_b32 v166, v122, v160
    v_and_b32 v167, v123, v161
    v_fma_f32 v168, v168, v102, -v45
    v_fma_f32 v169, v169, v102, -v45
    v_mfma_f32_16x16x32_bf16 v[84:87], v[116:119], v[164:167], 0
    v_fma_f32 v170, v170, v102, -v45
    v_fma_f32 v171, v171, v102, -v45
    v_mfma_f32_16x16x32_bf16 v[160:163], v[202:205], v[164:167], 0
    v_exp_f32 v168, v168
    v_mfma_f32_16x16x32_bf16 v[20:23], v[220:223], v[164:167], 0
    v_exp_f32 v169, v169
    v_exp_f32 v170, v170
    v_exp_f32 v171, v171
    v_cvt_pk_bf16_f32 v168, v168, v169
    v_cvt_pk_bf16_f32 v169, v170, v171
    v_and_b32 v172, v120, v168
    v_and_b32 v173, v121, v169
    v_and_b32 v174, v122, v168
    v_and_b32 v175, v123, v169
    v_fma_f32 v176, v176, v103, -v46
    v_fma_f32 v177, v177, v103, -v46
    v_mfma_f32_16x16x32_bf16 v[88:91], v[116:119], v[172:175], 0
    v_fma_f32 v178, v178, v103, -v46
    v_fma_f32 v179, v179, v103, -v46
    v_mfma_f32_16x16x32_bf16 v[168:171], v[204:207], v[172:175], 0
    v_exp_f32 v176, v176
    v_mfma_f32_16x16x32_bf16 v[24:27], v[222:225], v[172:175], 0
    v_exp_f32 v177, v177
    v_exp_f32 v178, v178
    v_exp_f32 v179, v179
    v_cvt_pk_bf16_f32 v176, v176, v177
    v_cvt_pk_bf16_f32 v177, v178, v179
    v_and_b32 v180, v120, v176
    v_and_b32 v181, v121, v177
    v_and_b32 v182, v122, v176
    v_and_b32 v183, v123, v177
    v_fma_f32 v184, v184, v96, -v47
    v_fma_f32 v185, v185, v96, -v47
    v_mfma_f32_16x16x32_bf16 v[92:95], v[116:119], v[180:183], 0
    v_fma_f32 v186, v186, v96, -v47
    v_fma_f32 v187, v187, v96, -v47
    v_mfma_f32_16x16x32_bf16 v[176:179], v[206:209], v[180:183], 0
    v_exp_f32 v184, v184
    v_mfma_f32_16x16x32_bf16 v[28:31], v[224:227], v[180:183], 0
    v_exp_f32 v185, v185
    v_exp_f32 v186, v186
    v_exp_f32 v187, v187
    v_cvt_pk_bf16_f32 v184, v184, v185
    v_cvt_pk_bf16_f32 v185, v186, v187
    v_and_b32 v188, v120, v184
    v_and_b32 v189, v121, v185
    v_and_b32 v190, v122, v184
    v_and_b32 v191, v123, v185
    v_rcp_f32 v68, v68
    v_rcp_f32 v72, v72
    v_mfma_f32_16x16x32_bf16 v[64:67], v[116:119], v[188:191], 0
    v_rcp_f32 v76, v76
    v_mfma_f32_16x16x32_bf16 v[184:187], v[192:195], v[188:191], 0
    v_rcp_f32 v80, v80
    v_mfma_f32_16x16x32_bf16 v[0:3], v[210:213], v[188:191], 0
    v_rcp_f32 v84, v84
    v_rcp_f32 v88, v88
    v_rcp_f32 v92, v92
    s_nop 0
    v_rcp_f32 v64, v64
    ds_read_b64_tr_b16 a[232:233], v250 offset:16384
    ds_read_b64_tr_b16 a[234:235], v250 offset:20480
    ds_read_b128 a[136:139], v248 offset:0
    ds_read_b64_tr_b16 a[236:237], v250 offset:24576
    ds_read_b64_tr_b16 a[238:239], v250 offset:28672
    ds_read_b128 a[152:155], v248 offset:16384
    v_pk_mul_f32 v[128:129], v[128:129], v[68:69] op_sel_hi:[1,0]
    v_pk_mul_f32 v[130:131], v[130:131], v[68:69] op_sel_hi:[1,0]
    v_pk_mul_f32 v[4:5], v[4:5], v[68:69] op_sel_hi:[1,0]
    v_pk_mul_f32 v[6:7], v[6:7], v[68:69] op_sel_hi:[1,0]
    v_cvt_pk_bf16_f32 v132, v128, v129
    v_cvt_pk_bf16_f32 v133, v130, v131
    v_cvt_pk_bf16_f32 v134, v4, v5
    v_cvt_pk_bf16_f32 v135, v6, v7
    v_pk_mul_f32 v[136:137], v[136:137], v[72:73] op_sel_hi:[1,0]
    v_pk_mul_f32 v[138:139], v[138:139], v[72:73] op_sel_hi:[1,0]
    v_pk_mul_f32 v[8:9], v[8:9], v[72:73] op_sel_hi:[1,0]
    v_pk_mul_f32 v[10:11], v[10:11], v[72:73] op_sel_hi:[1,0]
    v_cvt_pk_bf16_f32 v140, v136, v137
    v_cvt_pk_bf16_f32 v141, v138, v139
    v_cvt_pk_bf16_f32 v142, v8, v9
    v_cvt_pk_bf16_f32 v143, v10, v11
    ds_write_b128 v233, v[132:135] offset:50176
    ds_write_b128 v233, v[140:143] offset:51200
    ds_read_b128 a[156:159], v248 offset:17408
    ds_read_b128 a[140:143], v248 offset:1024
    ds_read_b128 a[144:147], v248 offset:2048
    ds_read_b128 a[160:163], v248 offset:18432
    ds_read_b128 a[164:167], v248 offset:19456
    ds_read_b128 a[148:151], v248 offset:3072
    v_pk_mul_f32 v[144:145], v[144:145], v[76:77] op_sel_hi:[1,0]
    v_pk_mul_f32 v[146:147], v[146:147], v[76:77] op_sel_hi:[1,0]
    v_pk_mul_f32 v[12:13], v[12:13], v[76:77] op_sel_hi:[1,0]
    v_pk_mul_f32 v[14:15], v[14:15], v[76:77] op_sel_hi:[1,0]
    v_cvt_pk_bf16_f32 v148, v144, v145
    v_cvt_pk_bf16_f32 v149, v146, v147
    v_cvt_pk_bf16_f32 v150, v12, v13
    v_cvt_pk_bf16_f32 v151, v14, v15
    v_pk_mul_f32 v[152:153], v[152:153], v[80:81] op_sel_hi:[1,0]
    v_pk_mul_f32 v[154:155], v[154:155], v[80:81] op_sel_hi:[1,0]
    v_pk_mul_f32 v[16:17], v[16:17], v[80:81] op_sel_hi:[1,0]
    v_pk_mul_f32 v[18:19], v[18:19], v[80:81] op_sel_hi:[1,0]
    v_cvt_pk_bf16_f32 v156, v152, v153
    v_cvt_pk_bf16_f32 v157, v154, v155
    v_cvt_pk_bf16_f32 v158, v16, v17
    v_cvt_pk_bf16_f32 v159, v18, v19
    ds_write_b128 v233, v[148:151] offset:52224
    ds_write_b128 v233, v[156:159] offset:53248
    ds_read_b64_tr_b16 a[240:241], v251 offset:16384
    ds_read_b64_tr_b16 a[242:243], v251 offset:20480
    ds_read_b64_tr_b16 a[244:245], v251 offset:24576
    ds_read_b64_tr_b16 a[246:247], v251 offset:28672
    v_pk_mul_f32 v[160:161], v[160:161], v[84:85] op_sel_hi:[1,0]
    v_pk_mul_f32 v[162:163], v[162:163], v[84:85] op_sel_hi:[1,0]
    v_pk_mul_f32 v[20:21], v[20:21], v[84:85] op_sel_hi:[1,0]
    v_pk_mul_f32 v[22:23], v[22:23], v[84:85] op_sel_hi:[1,0]
    v_cvt_pk_bf16_f32 v164, v160, v161
    v_cvt_pk_bf16_f32 v165, v162, v163
    v_cvt_pk_bf16_f32 v166, v20, v21
    v_cvt_pk_bf16_f32 v167, v22, v23
    v_pk_mul_f32 v[168:169], v[168:169], v[88:89] op_sel_hi:[1,0]
    v_pk_mul_f32 v[170:171], v[170:171], v[88:89] op_sel_hi:[1,0]
    v_pk_mul_f32 v[24:25], v[24:25], v[88:89] op_sel_hi:[1,0]
    v_pk_mul_f32 v[26:27], v[26:27], v[88:89] op_sel_hi:[1,0]
    v_cvt_pk_bf16_f32 v172, v168, v169
    v_cvt_pk_bf16_f32 v173, v170, v171
    v_cvt_pk_bf16_f32 v174, v24, v25
    v_cvt_pk_bf16_f32 v175, v26, v27
    ds_write_b128 v233, v[164:167] offset:54272
    ds_write_b128 v233, v[172:175] offset:55296
    v_pk_mul_f32 v[176:177], v[176:177], v[92:93] op_sel_hi:[1,0]
    v_pk_mul_f32 v[178:179], v[178:179], v[92:93] op_sel_hi:[1,0]
    v_pk_mul_f32 v[28:29], v[28:29], v[92:93] op_sel_hi:[1,0]
    v_pk_mul_f32 v[30:31], v[30:31], v[92:93] op_sel_hi:[1,0]
    v_cvt_pk_bf16_f32 v180, v176, v177
    v_cvt_pk_bf16_f32 v181, v178, v179
    v_cvt_pk_bf16_f32 v182, v28, v29
    v_cvt_pk_bf16_f32 v183, v30, v31
    v_pk_mul_f32 v[184:185], v[184:185], v[64:65] op_sel_hi:[1,0]
    v_pk_mul_f32 v[186:187], v[186:187], v[64:65] op_sel_hi:[1,0]
    v_pk_mul_f32 v[0:1], v[0:1], v[64:65] op_sel_hi:[1,0]
    v_pk_mul_f32 v[2:3], v[2:3], v[64:65] op_sel_hi:[1,0]
    v_cvt_pk_bf16_f32 v188, v184, v185
    v_cvt_pk_bf16_f32 v189, v186, v187
    v_cvt_pk_bf16_f32 v190, v0, v1
    v_cvt_pk_bf16_f32 v191, v2, v3
    ds_write_b128 v233, v[180:183] offset:56320
    ds_write_b128 v233, v[188:191] offset:49152
    s_mov_b64 vcc, 0
    s_branch L_g2
L_w2:
    s_mov_b64 s[24:25], s[4:5]
    s_mov_b32 s60, s20
    s_mov_b32 s61, s21
    s_mov_b32 s62, 256
    s_mov_b32 s63, 0x20000
    s_mov_b64 s[0:1], s[82:83]
    v_mov_b32 v202, v213
    s_add_u32 s73, s72, 163840
    s_add_u32 s72, s72, 98432
    v_lshrrev_b32 v211, 3, v214
    v_and_b32 v211, 2, v211
    v_xor_b32 v211, v211, v214
    v_and_b32 v211, 3, v211
    v_lshrrev_b32 v209, 4, v214
    v_bfe_u32 v210, v214, 2, 2
    v_lshl_add_u32 v210, v209, 3, v210
    v_mul_u32_u24 v210, 6144, v210
    v_lshl_add_u32 v192, v211, 4, v210
    v_add_u32 v193, 24576, v192
    v_add_u32 v194, 2048, v192
    v_add_u32 v195, 26624, v192
    v_add_u32 v196, 4096, v192
    v_add_u32 v197, 28672, v192
    s_mov_b32 s28, s6
    s_mov_b32 s29, s7
    s_mov_b32 s30, 6291456
    s_mov_b32 s31, 0x20000
    s_mov_b32 m0, 79872
    s_nop 0
    buffer_load_dwordx4 v194, s[28:31], s74 offen lds
    s_mov_b32 m0, 80896
    s_nop 0
    buffer_load_dwordx4 v195, s[28:31], s74 offen lds
    s_add_u32 s74, s74, 196608
    s_mov_b32 m0, 100352
    s_nop 0
    buffer_load_dwordx4 v194, s[28:31], s74 offen lds
    s_mov_b32 m0, 101376
    s_nop 0
    buffer_load_dwordx4 v195, s[28:31], s74 offen lds
    s_sub_u32 s74, s74, 196608
    s_mov_b32 m0, 10240
    s_nop 0
    buffer_load_dwordx4 v198, s[24:27], s73 offen lds
    s_mov_b32 m0, 11264
    s_nop 0
    buffer_load_dwordx4 v199, s[24:27], s73 offen lds
    s_add_u32 s73, s73, 32768
    s_mov_b32 m0, 12288
    s_nop 0
    buffer_load_dwordx4 v198, s[24:27], s73 offen lds
    s_mov_b32 m0, 13312
    s_nop 0
    buffer_load_dwordx4 v199, s[24:27], s73 offen lds
    s_add_u32 s73, s73, 32768
    s_mov_b32 m0, 14336
    s_nop 0
    buffer_load_dwordx4 v198, s[24:27], s73 offen lds
    s_mov_b32 m0, 15360
    s_nop 0
    buffer_load_dwordx4 v199, s[24:27], s73 offen lds
    s_add_u32 s73, s73, 32768
    s_mov_b32 m0, 16384
    s_nop 0
    buffer_load_dwordx4 v198, s[24:27], s73 offen lds
    s_mov_b32 m0, 17408
    s_nop 0
    buffer_load_dwordx4 v199, s[24:27], s73 offen lds
    s_add_u32 s73, s73, 4294869120
    s_add_u32 s44, s22, 100663296
    s_addc_u32 s45, s23, 0
    s_mov_b32 s46, 2822144
    s_mov_b32 s47, 0x20000
    s_add_u32 s40, s22, 4194304
    s_addc_u32 s41, s23, 0
    s_mov_b32 s42, 18874368
    s_mov_b32 s43, 0x20000
    s_lshl_b32 s79, s65, 3
    s_add_u32 s79, s79, s67
    s_lshl_b32 s77, s65, 2
    s_add_u32 s77, s77, s66
    s_lshl_b32 s77, s77, 10
    v_lshrrev_b32 v208, 4, v214
    v_bfe_u32 v209, v214, 3, 1
    v_xor_b32 v209, v209, v214
    v_xor_b32 v209, v209, v208
    v_and_b32 v209, 7, v209
    v_lshlrev_b32 v209, 4, v209
    v_and_b32 v210, 15, v214
    v_lshl_add_u32 v209, v210, 7, v209
    v_add_u32 v200, 0, v209
    v_xor_b32 v201, 64, v200
    v_bfe_u32 v209, v214, 2, 2
    v_lshl_add_u32 v209, v208, 2, v209
    v_and_b32 v210, 3, v214
    v_lshlrev_b32 v210, 3, v210
    v_mul_u32_u24 v211, 224, v209
    v_add_u32 v211, v211, v210
    s_lshl_b32 s84, s71, 5
    s_sub_u32 s84, 84032, s84
    v_add_u32 v204, s84, v211
    s_mul_i32 s84, s71, 192
    s_sub_u32 s84, 84160, s84
    v_add_u32 v205, s84, v211
    v_mov_b32 v228, 0x3f803f80
    v_mov_b32 v229, 0x3f803f80
    v_mov_b32 v230, 0x3f803f80
    v_mov_b32 v231, 0x3f803f80
    s_lshl_b32 s88, s65, 5
    s_add_u32 s88, s88, s68
    s_lshl_b32 s88, s88, 2
    s_add_u32 s88, s88, 2
    s_lshl_b32 s92, s88, 12
    v_lshrrev_b32 v252, 5, v214
    v_and_b32 v238, 0x1f0, v254
    v_lshl_add_u32 v238, v252, 11, v238
    v_lshlrev_b32 v207, 3, v252
    v_and_b32 v252, 31, v214
    v_cmp_eq_u32 vcc, 0, v252
    s_nop 1
    v_cndmask_b32 v207, 2.0, v207, vcc
    s_lshl_b32 s88, s88, 4
    s_add_u32 s88, s88, 32768
    s_add_u32 s80, s80, 1
    s_cmp_eq_u32 s65, 0
    s_cselect_b32 s80, 0, s80
    s_sub_u32 s82, s80, 1
    s_cmp_lt_u32 s65, 4
    s_cselect_b32 s81, 63, 1
    s_mov_b32 s83, 3
    s_mov_b32 s76, 0
    s_mov_b32 m0, 81920
    s_nop 0
    buffer_load_dwordx4 v196, s[28:31], s74 offen lds
    s_mov_b32 m0, 82944
    s_nop 0
    buffer_load_dwordx4 v197, s[28:31], s74 offen lds
    s_mov_b32 m0, 77824
    s_nop 0
    buffer_load_dwordx4 v192, s[28:31], s74 offen lds
    s_mov_b32 m0, 78848
    s_nop 0
    buffer_load_dwordx4 v193, s[28:31], s74 offen lds
    s_add_u32 s74, s74, 196608
    s_mov_b32 m0, 102400
    s_nop 0
    buffer_load_dwordx4 v196, s[28:31], s74 offen lds
    s_mov_b32 m0, 103424
    s_nop 0
    buffer_load_dwordx4 v197, s[28:31], s74 offen lds
    s_mov_b32 m0, 98304
    s_nop 0
    buffer_load_dwordx4 v192, s[28:31], s74 offen lds
    s_mov_b32 m0, 99328
    s_nop 0
    buffer_load_dwordx4 v193, s[28:31], s74 offen lds
    s_add_u32 s74, s74, 196608
    s_bfm_b64 exec, 24, 24
    buffer_load_dword v236, v202, s[52:55], s90 offen
    s_mov_b64 exec, -1
    s_mov_b32 s56, s18
    s_mov_b32 s57, s19
    s_mov_b32 s58, 4194304
    s_mov_b32 s59, 0x20000
    s_mov_b32 s48, s16
    s_mov_b32 s49, s17
    s_mov_b32 s50, 7340032
    s_mov_b32 s51, 0x20000
    v_lshrrev_b32 v213, 4, v254
    v_and_b32 v211, 15, v213
    v_lshrrev_b32 v212, 4, v213
    v_subrev_u32 v208, 2, v213
    v_subrev_u32 v209, 16, v213
    v_cmp_le_u32 vcc, 18, v213
    s_nop 1
    v_cndmask_b32 v208, v208, v209, vcc
    v_cndmask_b32 v209, 0, 2, vcc
    v_lshrrev_b32 v208, 1, v208
    v_and_b32 v210, 1, v213
    v_add_u32 v209, v209, v210
    v_subrev_u32 v210, 17, v213
    v_cmp_le_u32 vcc, 18, v213
    s_nop 1
    v_cndmask_b32 v208, v208, v210, vcc
    v_cndmask_b32 v209, v209, 2, vcc
    v_cmp_le_u32 vcc, 25, v213
    s_nop 1
    v_cndmask_b32 v208, v208, v213, vcc
    v_cndmask_b32 v209, v209, 3, vcc
    v_cmp_gt_u32 vcc, 4, v213
    s_nop 1
    v_cndmask_b32 v208, v208, 0, vcc
    v_cndmask_b32 v209, v209, v213, vcc
    v_add_u32 v208, s67, v208
    v_and_b32 v208, 7, v208
    v_and_b32 v210, 1, v208
    v_lshl_add_u32 v209, v210, 2, v209
    v_lshlrev_b32 v209, 2, v209
    s_mov_b32 s84, 0x86750312
    v_lshrrev_b32 v209, v209, s84
    v_and_b32 v209, 15, v209
    v_lshrrev_b32 v208, 1, v208
    v_and_b32 v210, 3, v213
    v_cmp_le_u32 vcc, 32, v213
    s_nop 1
    v_cndmask_b32 v208, v208, v210, vcc
    v_cndmask_b32 v209, v209, 4, vcc
    s_lshl_b32 s84, s66, 2
    v_add_u32 v208, s84, v208
    v_mad_u32_u24 v246, v208, 9, v209
    v_lshlrev_b32 v246, 10, v246
    v_mul_u32_u24 v247, 224, v208
    v_lshl_add_u32 v247, v209, 5, v247
    v_subrev_u32 v247, 32, v247
    v_lshlrev_b32 v247, 11, v247
    v_lshrrev_b32 v210, 3, v209
    v_lshl_add_u32 v210, v208, 1, v210
    v_lshlrev_b32 v210, 16, v210
    v_and_b32 v209, 7, v209
    v_cmp_eq_u32 vcc, 0, v209
    s_nop 1
    v_cndmask_b32 v247, v247, v210, vcc
    s_sub_u32 s84, s69, s70
    s_mul_i32 s84, s84, 24576
    v_add_u32 v210, s84, v247
    v_cmp_le_u32 vcc, 32, v213
    s_nop 1
    v_cndmask_b32 v247, v247, v210, vcc
    v_accvgpr_write_b32 a240, v246
    v_accvgpr_write_b32 a237, v247
    s_lshl_b32 s85, s70, 2
    s_add_u32 s85, s85, s69
    s_lshl_b32 s84, s85, 2
    v_add_u32 v208, s84, v212
    v_lshrrev_b32 v209, 1, v213
    v_xor_b32 v209, v209, v208
    v_and_b32 v209, 7, v209
    v_and_b32 v210, 1, v213
    v_lshlrev_b32 v210, 4, v210
    v_lshl_add_u32 v244, v209, 5, v210
    v_lshl_add_u32 v244, v208, 11, v244
    s_lshl_b32 s84, s67, 8
    v_add_u32 v244, s84, v244
    v_add_u32 v245, 16384, v244
    v_accvgpr_write_b32 a238, v244
    v_accvgpr_write_b32 a239, v245
    s_lshl_b32 s3, s85, 10
    v_and_b32 v208, 1, v212
    v_lshrrev_b32 v209, 1, v212
    v_mul_u32_u24 v210, 147456, v208
    v_lshl_add_u32 v210, v209, 9, v210
    v_lshl_add_u32 v210, v211, 4, v210
    s_mul_i32 s85, s71, 2816
    s_sub_u32 s85, 3072, s85
    v_add_u32 v210, s85, v210
    v_accvgpr_write_b32 a250, v210
    s_lshl_b32 s84, s69, 13
    v_add_u32 v208, s84, v254
    v_accvgpr_write_b32 a251, v208
    s_lshl_b32 s84, s65, 1
    s_add_u32 s84, s84, s69
    s_mul_i32 s84, s84, 1179648
    s_lshr_b32 s85, s67, 1
    s_mul_i32 s85, s85, 9
    s_mul_i32 s86, s66, 36
    s_add_u32 s85, s85, s86
    s_lshl_b32 s85, s85, 10
    s_add_u32 s84, s84, s85
    s_mul_i32 s85, s71, 3072
    s_add_u32 s85, s85, 1024
    s_add_u32 s7, s85, s84
    s_lshl_b32 s84, s65, 2
    s_add_u32 s84, s84, s64
    s_mul_i32 s84, s84, 589824
    v_add_u32 v208, s84, v254
    v_accvgpr_write_b32 a244, v208
    v_add_u32 v209, 147456, v208
    v_accvgpr_write_b32 a245, v209
    v_add_u32 v209, 294912, v208
    v_accvgpr_write_b32 a246, v209
    v_add_u32 v209, 442368, v208
    v_accvgpr_write_b32 a247, v209
    s_lshl_b32 s84, s64, 12
    v_add_u32 v208, s84, v254
    v_accvgpr_write_b32 a241, v208
    v_bfe_u32 v209, v213, 2, 2
    v_lshl_add_u32 v209, v212, 2, v209
    v_and_b32 v210, 3, v213
    v_lshlrev_b32 v210, 3, v210
    v_lshl_add_u32 v210, v209, 8, v210
    v_add_u32 v210, 81920, v210
    v_and_b32 v209, 7, v209
    v_lshl_add_u32 v210, v209, 5, v210
    s_lshl_b32 s84, s66, 6
    s_add_u32 s85, s84, 64
    s_and_b32 s85, s85, 0xc0
    v_xor_b32 v208, s84, v210
    v_accvgpr_write_b32 a242, v208
    v_xor_b32 v208, 32, v208
    v_accvgpr_write_b32 a243, v208
    v_xor_b32 v208, s85, v210
    v_accvgpr_write_b32 a248, v208
    v_xor_b32 v208, 32, v208
    v_accvgpr_write_b32 a249, v208
    s_lshl_b32 s10, s67, 2
    s_lshl_b32 s11, 15, s10
    s_add_u32 s10, s10, s64
    s_lshl_b32 s10, s10, 2
    s_add_u32 s10, s10, s77
    v_lshrrev_b32 v208, 1, v213
    v_lshlrev_b32 v208, 11, v208
    v_and_b32 v209, 1, v213
    v_lshl_add_u32 v208, v209, 7, v208
    s_lshl_b32 s84, s67, 8
    v_add_u32 v208, s84, v208
    v_accvgpr_write_b32 a252, v208
    s_and_b32 s13, s65, 3
    s_lshl_b32 s84, s64, 2
    s_add_u32 s13, s13, s84
    s_add_u32 s13, s13, 6
    s_lshl_b32 s4, s65, 2
    s_add_u32 s4, s4, s64
    s_lshl_b32 s4, s4, 9
    s_add_u32 s4, s4, 32768
    s_lshl_b32 s5, s65, 11
    s_sub_u32 s5, s5, 128
    s_max_i32 s5, s5, 0
    s_add_u32 s5, s5, 32768
    s_mul_i32 s6, s68, 20480
    s_mul_i32 s84, s64, 640
    s_add_u32 s6, s6, s84
    s_add_u32 s6, s6, 65536
    s_lshl_b32 s12, s68, 4
    s_add_u32 s12, s12, s65
    s_lshl_b32 s12, s12, 12
    s_add_u32 s12, s12, 729088
    s_lshl_b32 s84, s64, 10
    s_add_u32 s84, s84, 154880
    v_add_u32 v208, s84, v254
    v_accvgpr_write_b32 a232, v208
    s_lshl_b32 s84, s64, 8
    s_add_u32 s84, s84, 159040
    v_lshl_add_u32 v208, v213, 2, s84
    v_accvgpr_write_b32 a233, v208
    s_mov_b32 s84, 154624
    v_lshl_add_u32 v208, v211, 4, s84
    v_accvgpr_write_b32 a234, v208
    s_mov_b32 s84, 158976
    v_lshl_add_u32 v208, v211, 2, s84
    v_accvgpr_write_b32 a235, v208
    s_mul_i32 s84, s64, 320
    s_add_u32 s84, s84, 161344
    v_min_u32 v208, 39, v213
    v_lshl_add_u32 v208, v208, 3, s84
    v_accvgpr_write_b32 a236, v208
    s_cmp_eq_u32 s80, 0
    s_cselect_b64 vcc, -1, 0
    s_waitcnt vmcnt(9)
    s_barrier
    ds_read_b64_tr_b16 a[200:201], v204 offset:34816
    ds_read_b64_tr_b16 a[202:203], v204 offset:38400
    ds_read_b128 a[136:139], v200 offset:0
    ds_read_b64_tr_b16 a[204:205], v204 offset:41984
    ds_read_b64_tr_b16 a[206:207], v204 offset:45568
    ds_read_b128 a[168:171], v201 offset:0
    ds_read_b64_tr_b16 a[212:213], v204 offset:42016
    ds_read_b64_tr_b16 a[214:215], v204 offset:45600
    ds_read_b64_tr_b16 a[208:209], v204 offset:34848
    ds_read_b64_tr_b16 a[210:211], v204 offset:38432
    ds_read_b128 a[140:143], v200 offset:2048
    ds_read_b128 a[172:175], v201 offset:2048
    ds_read_b128 a[144:147], v200 offset:4096
    ds_read_b128 a[176:179], v201 offset:4096
    ds_read_b128 a[148:151], v200 offset:6144
    ds_read_b128 a[180:183], v201 offset:6144
    ds_read_b128 a[152:155], v200 offset:8192
    ds_read_b128 a[184:187], v201 offset:8192
    ds_read_b128 a[156:159], v200 offset:10240
    ds_read_b128 a[188:191], v201 offset:10240
    ds_read_b128 a[160:163], v200 offset:12288
    ds_read_b128 a[192:195], v201 offset:12288
    ds_read_b128 a[164:167], v200 offset:14336
    ds_read_b128 a[196:199], v201 offset:14336
    s_add_u32 s84, s90, 786432
    s_bfm_b64 exec, 24, 0
    buffer_load_dword v236, v202, s[52:55], s84 offen
    s_mov_b64 exec, -1
    s_waitcnt lgkmcnt(15)
    v_mfma_f32_16x16x32_bf16 v[0:3], a[200:203], a[136:139], 0
    s_mov_b32 m0, 38912
    ds_read_b64_tr_b16 a[216:217], v204 offset:34880
    v_mfma_f32_16x16x32_bf16 v[0:3], a[204:207], a[168:171], v[0:3]
    buffer_load_dwordx4 v198, s[24:27], s72 offen lds
    ds_read_b64_tr_b16 a[218:219], v204 offset:38464
    v_mfma_f32_16x16x32_bf16 v[32:35], a[212:215], a[168:171], 0
    s_mov_b32 m0, 39936
    ds_read_b64_tr_b16 a[220:221], v204 offset:42048
    s_waitcnt lgkmcnt(15)
    v_mfma_f32_16x16x32_bf16 v[32:35], a[208:211], a[136:139], v[32:35]
    buffer_load_dwordx4 v199, s[24:27], s72 offen lds
    ds_read_b64_tr_b16 a[222:223], v204 offset:45632
    v_mfma_f32_16x16x32_bf16 v[36:39], a[208:211], a[140:143], 0
    s_add_u32 s72, s72, 32768
    ds_read_b64_tr_b16 a[228:229], v204 offset:42080
    v_mfma_f32_16x16x32_bf16 v[36:39], a[212:215], a[172:175], v[36:39]
    s_mov_b32 m0, 40960
    ds_read_b64_tr_b16 a[230:231], v204 offset:45664
    v_mfma_f32_16x16x32_bf16 v[4:7], a[204:207], a[172:175], 0
    buffer_load_dwordx4 v198, s[24:27], s72 offen lds
    v_mfma_f32_16x16x32_bf16 v[4:7], a[200:203], a[140:143], v[4:7]
    s_waitcnt lgkmcnt(14)
    v_mfma_f32_16x16x32_bf16 v[8:11], a[200:203], a[144:147], 0
    s_mov_b32 m0, 41984
    v_mfma_f32_16x16x32_bf16 v[8:11], a[204:207], a[176:179], v[8:11]
    buffer_load_dwordx4 v199, s[24:27], s72 offen lds
    v_mfma_f32_16x16x32_bf16 v[40:43], a[212:215], a[176:179], 0
    s_add_u32 s72, s72, 32768
    v_mfma_f32_16x16x32_bf16 v[40:43], a[208:211], a[144:147], v[40:43]
    s_mov_b32 m0, 43008
    v_mfma_f32_16x16x32_bf16 v[44:47], a[208:211], a[148:151], 0
    buffer_load_dwordx4 v198, s[24:27], s72 offen lds
    v_mfma_f32_16x16x32_bf16 v[44:47], a[212:215], a[180:183], v[44:47]
    s_mov_b32 m0, 44032
    v_mfma_f32_16x16x32_bf16 v[12:15], a[204:207], a[180:183], 0
    buffer_load_dwordx4 v199, s[24:27], s72 offen lds
    v_mfma_f32_16x16x32_bf16 v[12:15], a[200:203], a[148:151], v[12:15]
    s_waitcnt lgkmcnt(10)
    v_mfma_f32_16x16x32_bf16 v[16:19], a[200:203], a[152:155], 0
    s_add_u32 s72, s72, 32768
    v_mfma_f32_16x16x32_bf16 v[16:19], a[204:207], a[184:187], v[16:19]
    ds_read_b64_tr_b16 a[224:225], v204 offset:34912
    v_mfma_f32_16x16x32_bf16 v[48:51], a[212:215], a[184:187], 0
    s_mov_b32 m0, 45056
    v_mfma_f32_16x16x32_bf16 v[48:51], a[208:211], a[152:155], v[48:51]
    buffer_load_dwordx4 v198, s[24:27], s72 offen lds
    v_mfma_f32_16x16x32_bf16 v[52:55], a[208:211], a[156:159], 0
    ds_read_b64_tr_b16 a[226:227], v204 offset:38496
    v_mfma_f32_16x16x32_bf16 v[52:55], a[212:215], a[188:191], v[52:55]
    s_mov_b32 m0, 46080
    v_mfma_f32_16x16x32_bf16 v[20:23], a[204:207], a[188:191], 0
    buffer_load_dwordx4 v199, s[24:27], s72 offen lds
    v_mfma_f32_16x16x32_bf16 v[20:23], a[200:203], a[156:159], v[20:23]
    s_waitcnt lgkmcnt(8)
    v_mfma_f32_16x16x32_bf16 v[24:27], a[200:203], a[160:163], 0
    s_add_u32 s72, s72, 32768
    v_mfma_f32_16x16x32_bf16 v[24:27], a[204:207], a[192:195], v[24:27]
    s_mov_b32 m0, 47104
    v_mfma_f32_16x16x32_bf16 v[56:59], a[212:215], a[192:195], 0
    buffer_load_dwordx4 v198, s[24:27], s72 offen lds
    v_mfma_f32_16x16x32_bf16 v[56:59], a[208:211], a[160:163], v[56:59]
    s_mov_b32 m0, 48128
    v_mfma_f32_16x16x32_bf16 v[60:63], a[208:211], a[164:167], 0
    buffer_load_dwordx4 v199, s[24:27], s72 offen lds
    v_mfma_f32_16x16x32_bf16 v[60:63], a[212:215], a[196:199], v[60:63]
    s_add_u32 s72, s72, 4294836352
    v_mfma_f32_16x16x32_bf16 v[28:31], a[204:207], a[196:199], 0
    s_cbranch_vccnz L_skp2_00
L_sbp2_00:
    v_mfma_f32_16x16x32_bf16 v[28:31], a[200:203], a[164:167], v[28:31]
    s_waitcnt lgkmcnt(0)
    v_mfma_f32_16x16x32_bf16 v[92:95], a[216:219], a[164:167], 0
    s_mov_b32 m0, 67584
    v_mfma_f32_16x16x32_bf16 v[92:95], a[220:223], a[196:199], v[92:95]
    buffer_load_dwordx4 v194, s[28:31], s74 offen lds
    v_mfma_f32_16x16x32_bf16 v[124:127], a[228:231], a[196:199], 0
    s_mov_b32 m0, 68608
    v_mfma_f32_16x16x32_bf16 v[124:127], a[224:227], a[164:167], v[124:127]
    ds_read_b64_tr_b16 a[200:201], v205 offset:34816
    v_mfma_f32_16x16x32_bf16 v[120:123], a[224:227], a[160:163], 0
    buffer_load_dwordx4 v195, s[28:31], s74 offen lds
    v_mfma_f32_16x16x32_bf16 v[120:123], a[228:231], a[192:195], v[120:123]
    ds_read_b64_tr_b16 a[202:203], v205 offset:38400
    v_mfma_f32_16x16x32_bf16 v[88:91], a[220:223], a[192:195], 0
    s_add_u32 s74, s74, 196608
    v_mfma_f32_16x16x32_bf16 v[88:91], a[216:219], a[160:163], v[88:91]
    s_mov_b32 m0, 73728
    v_mfma_f32_16x16x32_bf16 v[84:87], a[216:219], a[156:159], 0
    ds_read_b64_tr_b16 a[204:205], v205 offset:41984
    v_mfma_f32_16x16x32_bf16 v[84:87], a[220:223], a[188:191], v[84:87]
    buffer_load_dwordx4 v194, s[28:31], s74 offen lds
    v_mfma_f32_16x16x32_bf16 v[116:119], a[228:231], a[188:191], 0
    ds_read_b64_tr_b16 a[206:207], v205 offset:45568
    v_mfma_f32_16x16x32_bf16 v[116:119], a[224:227], a[156:159], v[116:119]
    s_mov_b32 m0, 74752
    v_mfma_f32_16x16x32_bf16 v[112:115], a[224:227], a[152:155], 0
    buffer_load_dwordx4 v195, s[28:31], s74 offen lds
    v_mfma_f32_16x16x32_bf16 v[112:115], a[228:231], a[184:187], v[112:115]
    s_sub_u32 s74, s74, 196608
    v_mfma_f32_16x16x32_bf16 v[80:83], a[220:223], a[184:187], 0
    s_add_u32 s84, s90, 786432
    s_bfm_b64 exec, 24, 24
    buffer_load_dword v236, v202, s[52:55], s84 offen
    s_mov_b64 exec, -1
    v_mfma_f32_16x16x32_bf16 v[80:83], a[216:219], a[152:155], v[80:83]
    buffer_load_dword v239, off, s[60:63], 0 sc1
    s_waitcnt vmcnt(18) lgkmcnt(0)
    s_barrier
    v_mfma_f32_16x16x32_bf16 v[76:79], a[216:219], a[148:151], 0
    ds_read_b64_tr_b16 a[212:213], v204 offset:27648
    v_mfma_f32_16x16x32_bf16 v[76:79], a[220:223], a[180:183], v[76:79]
    v_mfma_f32_16x16x32_bf16 v[108:111], a[228:231], a[180:183], 0
    ds_read_b64_tr_b16 a[214:215], v204 offset:31232
    v_mfma_f32_16x16x32_bf16 v[108:111], a[224:227], a[148:151], v[108:111]
    ds_read_b64_tr_b16 a[208:209], v204 offset:20480
    v_mfma_f32_16x16x32_bf16 v[104:107], a[224:227], a[144:147], 0
    ds_read_b64_tr_b16 a[210:211], v204 offset:24064
    v_mfma_f32_16x16x32_bf16 v[104:107], a[228:231], a[176:179], v[104:107]
    v_mfma_f32_16x16x32_bf16 v[72:75], a[220:223], a[176:179], 0
    v_mfma_f32_16x16x32_bf16 v[72:75], a[216:219], a[144:147], v[72:75]
    s_mov_b32 m0, 69632
    v_mfma_f32_16x16x32_bf16 v[68:71], a[216:219], a[140:143], 0
    buffer_load_dwordx4 v196, s[28:31], s74 offen lds
    v_mfma_f32_16x16x32_bf16 v[68:71], a[220:223], a[172:175], v[68:71]
    s_mov_b32 m0, 70656
    v_mfma_f32_16x16x32_bf16 v[100:103], a[228:231], a[172:175], 0
    buffer_load_dwordx4 v197, s[28:31], s74 offen lds
    v_mfma_f32_16x16x32_bf16 v[100:103], a[224:227], a[140:143], v[100:103]
    s_mov_b32 m0, 65536
    v_mfma_f32_16x16x32_bf16 v[96:99], a[224:227], a[136:139], 0
    buffer_load_dwordx4 v192, s[28:31], s74 offen lds
    v_mfma_f32_16x16x32_bf16 v[96:99], a[228:231], a[168:171], v[96:99]
    s_mov_b32 m0, 66560
    v_mfma_f32_16x16x32_bf16 v[64:67], a[220:223], a[168:171], 0
    buffer_load_dwordx4 v193, s[28:31], s74 offen lds
    v_mfma_f32_16x16x32_bf16 v[64:67], a[216:219], a[136:139], v[64:67]
    v_mfma_f32_16x16x32_bf16 v[128:131], a[200:203], a[136:139], 0
    ds_read_b64_tr_b16 a[216:217], v204 offset:20512
    v_mfma_f32_16x16x32_bf16 v[128:131], a[204:207], a[168:171], v[128:131]
    s_waitcnt lgkmcnt(1)
    v_mfma_f32_16x16x32_bf16 v[160:163], a[212:215], a[168:171], 0
    s_add_u32 s74, s74, 196608
    v_mfma_f32_16x16x32_bf16 v[160:163], a[208:211], a[136:139], v[160:163]
    ds_read_b64_tr_b16 a[218:219], v204 offset:24096
    v_mfma_f32_16x16x32_bf16 v[164:167], a[208:211], a[140:143], 0
    s_mov_b32 m0, 75776
    v_mfma_f32_16x16x32_bf16 v[164:167], a[212:215], a[172:175], v[164:167]
    buffer_load_dwordx4 v196, s[28:31], s74 offen lds
    v_mfma_f32_16x16x32_bf16 v[132:135], a[204:207], a[172:175], 0
    ds_read_b64_tr_b16 a[220:221], v204 offset:27680
    v_mfma_f32_16x16x32_bf16 v[132:135], a[200:203], a[140:143], v[132:135]
    s_mov_b32 m0, 76800
    v_mfma_f32_16x16x32_bf16 v[136:139], a[200:203], a[144:147], 0
    ds_read_b64_tr_b16 a[222:223], v204 offset:31264
    v_mfma_f32_16x16x32_bf16 v[136:139], a[204:207], a[176:179], v[136:139]
    buffer_load_dwordx4 v197, s[28:31], s74 offen lds
    v_mfma_f32_16x16x32_bf16 v[168:171], a[212:215], a[176:179], 0
    s_mov_b32 m0, 71680
    v_mfma_f32_16x16x32_bf16 v[168:171], a[208:211], a[144:147], v[168:171]
    ds_read_b64_tr_b16 a[228:229], v204 offset:27712
    v_mfma_f32_16x16x32_bf16 v[172:175], a[208:211], a[148:151], 0
    buffer_load_dwordx4 v192, s[28:31], s74 offen lds
    v_mfma_f32_16x16x32_bf16 v[172:175], a[212:215], a[180:183], v[172:175]
    s_mov_b32 m0, 72704
    v_mfma_f32_16x16x32_bf16 v[140:143], a[204:207], a[180:183], 0
    ds_read_b64_tr_b16 a[230:231], v204 offset:31296
    v_mfma_f32_16x16x32_bf16 v[140:143], a[200:203], a[148:151], v[140:143]
    buffer_load_dwordx4 v193, s[28:31], s74 offen lds
    v_mfma_f32_16x16x32_bf16 v[144:147], a[200:203], a[152:155], 0
    s_add_u32 s74, s74, 196608
    v_mfma_f32_16x16x32_bf16 v[144:147], a[204:207], a[184:187], v[144:147]
    ds_read_b64_tr_b16 a[224:225], v204 offset:20544
    v_mfma_f32_16x16x32_bf16 v[176:179], a[212:215], a[184:187], 0
    s_mov_b32 m0, 6144
    v_mfma_f32_16x16x32_bf16 v[176:179], a[208:211], a[152:155], v[176:179]
    buffer_load_dwordx4 v198, s[24:27], s72 offen lds
    v_mfma_f32_16x16x32_bf16 v[180:183], a[208:211], a[156:159], 0
    ds_read_b64_tr_b16 a[226:227], v204 offset:24128
    v_mfma_f32_16x16x32_bf16 v[180:183], a[212:215], a[188:191], v[180:183]
    s_mov_b32 m0, 7168
    v_mfma_f32_16x16x32_bf16 v[148:151], a[204:207], a[188:191], 0
    buffer_load_dwordx4 v199, s[24:27], s72 offen lds
    v_mfma_f32_16x16x32_bf16 v[148:151], a[200:203], a[156:159], v[148:151]
    s_add_u32 s72, s72, 32768
    v_mfma_f32_16x16x32_bf16 v[152:155], a[200:203], a[160:163], 0
    s_mov_b32 m0, 8192
    v_mfma_f32_16x16x32_bf16 v[152:155], a[204:207], a[192:195], v[152:155]
    buffer_load_dwordx4 v198, s[24:27], s72 offen lds
    v_mfma_f32_16x16x32_bf16 v[184:187], a[212:215], a[192:195], 0
    s_mov_b32 m0, 9216
    v_mfma_f32_16x16x32_bf16 v[184:187], a[208:211], a[160:163], v[184:187]
    buffer_load_dwordx4 v199, s[24:27], s72 offen lds
    v_mfma_f32_16x16x32_bf16 v[188:191], a[208:211], a[164:167], 0
    s_add_u32 s72, s72, 32768
    v_mfma_f32_16x16x32_bf16 v[188:191], a[212:215], a[196:199], v[188:191]
    s_mov_b32 m0, 10240
    v_mfma_f32_16x16x32_bf16 v[156:159], a[204:207], a[196:199], 0
    s_cbranch_vccnz L_skp2_02
L_sbp2_02:
    v_mfma_f32_16x16x32_bf16 v[156:159], a[200:203], a[164:167], v[156:159]
    s_waitcnt lgkmcnt(0)
    v_mfma_f32_16x16x32_bf16 a[28:31], a[216:219], a[164:167], 0
    buffer_load_dwordx4 v198, s[24:27], s72 offen lds
    v_mfma_f32_16x16x32_bf16 a[28:31], a[220:223], a[196:199], a[28:31]
    s_mov_b32 m0, 11264
    v_mfma_f32_16x16x32_bf16 a[60:63], a[228:231], a[196:199], 0
    buffer_load_dwordx4 v199, s[24:27], s72 offen lds
    v_mfma_f32_16x16x32_bf16 a[60:63], a[224:227], a[164:167], a[60:63]
    s_add_u32 s72, s72, 32768
    v_mfma_f32_16x16x32_bf16 a[56:59], a[224:227], a[160:163], 0
    ds_read_b64_tr_b16 a[200:201], v204 offset:20576
    v_mfma_f32_16x16x32_bf16 a[56:59], a[228:231], a[192:195], a[56:59]
    s_mov_b32 m0, 12288
    v_mfma_f32_16x16x32_bf16 a[24:27], a[220:223], a[192:195], 0
    ds_read_b64_tr_b16 a[202:203], v204 offset:24160
    v_mfma_f32_16x16x32_bf16 a[24:27], a[216:219], a[160:163], a[24:27]
    buffer_load_dwordx4 v198, s[24:27], s72 offen lds
    v_mfma_f32_16x16x32_bf16 a[20:23], a[216:219], a[156:159], 0
    s_mov_b32 m0, 13312
    v_mfma_f32_16x16x32_bf16 a[20:23], a[220:223], a[188:191], a[20:23]
    ds_read_b64_tr_b16 a[204:205], v204 offset:27744
    v_mfma_f32_16x16x32_bf16 a[52:55], a[228:231], a[188:191], 0
    buffer_load_dwordx4 v199, s[24:27], s72 offen lds
    v_mfma_f32_16x16x32_bf16 a[52:55], a[224:227], a[156:159], a[52:55]
    s_add_u32 s72, s72, 32768
    v_mfma_f32_16x16x32_bf16 a[48:51], a[224:227], a[152:155], 0
    ds_read_b64_tr_b16 a[206:207], v204 offset:31328
    v_mfma_f32_16x16x32_bf16 a[48:51], a[228:231], a[184:187], a[48:51]
    s_mov_b32 m0, 14336
    v_mfma_f32_16x16x32_bf16 a[16:19], a[220:223], a[184:187], 0
    buffer_load_dwordx4 v198, s[24:27], s72 offen lds
    v_mfma_f32_16x16x32_bf16 a[16:19], a[216:219], a[152:155], a[16:19]
    ds_read_b64_tr_b16 a[212:213], v205 offset:27648
    v_mfma_f32_16x16x32_bf16 a[12:15], a[216:219], a[148:151], 0
    s_mov_b32 m0, 15360
    v_mfma_f32_16x16x32_bf16 a[12:15], a[220:223], a[180:183], a[12:15]
    buffer_load_dwordx4 v199, s[24:27], s72 offen lds
    v_mfma_f32_16x16x32_bf16 a[44:47], a[228:231], a[180:183], 0
    ds_read_b64_tr_b16 a[214:215], v205 offset:31232
    v_mfma_f32_16x16x32_bf16 a[44:47], a[224:227], a[148:151], a[44:47]
    s_add_u32 s72, s72, 4294836352
    v_mfma_f32_16x16x32_bf16 a[40:43], a[224:227], a[144:147], 0
    ds_read_b64_tr_b16 a[208:209], v205 offset:20480
    v_mfma_f32_16x16x32_bf16 a[40:43], a[228:231], a[176:179], a[40:43]
    s_mov_b32 m0, 79872
    v_mfma_f32_16x16x32_bf16 a[8:11], a[220:223], a[176:179], 0
    buffer_load_dwordx4 v194, s[28:31], s74 offen lds
    v_mfma_f32_16x16x32_bf16 a[8:11], a[216:219], a[144:147], a[8:11]
    ds_read_b64_tr_b16 a[210:211], v205 offset:24064
    v_mfma_f32_16x16x32_bf16 a[4:7], a[216:219], a[140:143], 0
    s_mov_b32 m0, 80896
    v_mfma_f32_16x16x32_bf16 a[4:7], a[220:223], a[172:175], a[4:7]
    buffer_load_dwordx4 v195, s[28:31], s74 offen lds
    v_mfma_f32_16x16x32_bf16 a[36:39], a[228:231], a[172:175], 0
    s_add_u32 s74, s74, 196608
    v_mfma_f32_16x16x32_bf16 a[36:39], a[224:227], a[140:143], a[36:39]
    s_mov_b32 m0, 100352
    v_mfma_f32_16x16x32_bf16 a[32:35], a[224:227], a[136:139], 0
    buffer_load_dwordx4 v194, s[28:31], s74 offen lds
    v_mfma_f32_16x16x32_bf16 a[32:35], a[228:231], a[168:171], a[32:35]
    s_mov_b32 m0, 101376
    v_mfma_f32_16x16x32_bf16 a[0:3], a[220:223], a[168:171], 0
    buffer_load_dwordx4 v195, s[28:31], s74 offen lds
    v_mfma_f32_16x16x32_bf16 a[0:3], a[216:219], a[136:139], a[0:3]
    s_sub_u32 s74, s74, 196608
    s_waitcnt vmcnt(24) lgkmcnt(0)
    s_barrier
    v_mfma_f32_16x16x32_bf16 a[64:67], a[200:203], a[136:139], 0
    ds_read_b64_tr_b16 a[216:217], v204 offset:49152
    v_mfma_f32_16x16x32_bf16 a[64:67], a[204:207], a[168:171], a[64:67]
    s_mov_b32 m0, 81920
    v_mfma_f32_16x16x32_bf16 a[96:99], a[212:215], a[168:171], 0
    ds_read_b64_tr_b16 a[218:219], v204 offset:52736
    v_mfma_f32_16x16x32_bf16 a[96:99], a[208:211], a[136:139], a[96:99]
    buffer_load_dwordx4 v196, s[28:31], s74 offen lds
    v_mfma_f32_16x16x32_bf16 a[100:103], a[208:211], a[140:143], 0
    ds_read_b64_tr_b16 a[220:221], v204 offset:56320
    v_mfma_f32_16x16x32_bf16 a[100:103], a[212:215], a[172:175], a[100:103]
    ds_read_b64_tr_b16 a[222:223], v204 offset:59904
    v_mfma_f32_16x16x32_bf16 a[68:71], a[204:207], a[172:175], 0
    s_mov_b32 m0, 82944
    v_mfma_f32_16x16x32_bf16 a[68:71], a[200:203], a[140:143], a[68:71]
    ds_read_b64_tr_b16 a[228:229], v204 offset:56352
    v_mfma_f32_16x16x32_bf16 a[72:75], a[200:203], a[144:147], 0
    ds_read_b64_tr_b16 a[230:231], v204 offset:59936
    v_mfma_f32_16x16x32_bf16 a[72:75], a[204:207], a[176:179], a[72:75]
    buffer_load_dwordx4 v197, s[28:31], s74 offen lds
    v_mfma_f32_16x16x32_bf16 a[104:107], a[212:215], a[176:179], 0
    ds_read_b64_tr_b16 a[224:225], v204 offset:49184
    v_mfma_f32_16x16x32_bf16 a[104:107], a[208:211], a[144:147], a[104:107]
    ds_read_b128 a[136:139], v200 offset:32768
    v_mfma_f32_16x16x32_bf16 a[108:111], a[208:211], a[148:151], 0
    s_mov_b32 m0, 77824
    v_mfma_f32_16x16x32_bf16 a[108:111], a[212:215], a[180:183], a[108:111]
    ds_read_b64_tr_b16 a[226:227], v204 offset:52768
    v_mfma_f32_16x16x32_bf16 a[76:79], a[204:207], a[180:183], 0
    ds_read_b128 a[168:171], v201 offset:32768
    v_mfma_f32_16x16x32_bf16 a[76:79], a[200:203], a[148:151], a[76:79]
    buffer_load_dwordx4 v192, s[28:31], s74 offen lds
    v_mfma_f32_16x16x32_bf16 a[80:83], a[200:203], a[152:155], 0
    ds_read_b128 a[140:143], v200 offset:34816
    v_mfma_f32_16x16x32_bf16 a[80:83], a[204:207], a[184:187], a[80:83]
    s_mov_b32 m0, 78848
    v_mfma_f32_16x16x32_bf16 a[112:115], a[212:215], a[184:187], 0
    buffer_load_dwordx4 v193, s[28:31], s74 offen lds
    v_mfma_f32_16x16x32_bf16 a[112:115], a[208:211], a[152:155], a[112:115]
    ds_read_b128 a[172:175], v201 offset:34816
    v_mfma_f32_16x16x32_bf16 a[116:119], a[208:211], a[156:159], 0
    s_add_u32 s74, s74, 196608
    v_mfma_f32_16x16x32_bf16 a[116:119], a[212:215], a[188:191], a[116:119]
    ds_read_b128 a[144:147], v200 offset:36864
    v_mfma_f32_16x16x32_bf16 a[84:87], a[204:207], a[188:191], 0
    s_mov_b32 m0, 102400
    v_mfma_f32_16x16x32_bf16 a[84:87], a[200:203], a[156:159], a[84:87]
    ds_read_b128 a[176:179], v201 offset:36864
    v_mfma_f32_16x16x32_bf16 a[88:91], a[200:203], a[160:163], 0
    buffer_load_dwordx4 v196, s[28:31], s74 offen lds
    v_mfma_f32_16x16x32_bf16 a[88:91], a[204:207], a[192:195], a[88:91]
    ds_read_b128 a[148:151], v200 offset:38912
    v_mfma_f32_16x16x32_bf16 a[120:123], a[212:215], a[192:195], 0
    s_mov_b32 m0, 103424
    v_mfma_f32_16x16x32_bf16 a[120:123], a[208:211], a[160:163], a[120:123]
    ds_read_b128 a[180:183], v201 offset:38912
    v_mfma_f32_16x16x32_bf16 a[124:127], a[208:211], a[164:167], 0
    buffer_load_dwordx4 v197, s[28:31], s74 offen lds
    v_mfma_f32_16x16x32_bf16 a[124:127], a[212:215], a[196:199], a[124:127]
    s_mov_b32 m0, 98304
    v_mfma_f32_16x16x32_bf16 a[92:95], a[204:207], a[196:199], 0
    s_cbranch_vccnz L_skp2_04
L_sbp2_04:
    v_mfma_f32_16x16x32_bf16 a[92:95], a[200:203], a[164:167], a[92:95]
    s_waitcnt lgkmcnt(4)
    v_mfma_f32_16x16x32_bf16 v[0:3], a[216:219], a[136:139], v[0:3]
    ds_read_b128 a[152:155], v200 offset:40960
    v_mfma_f32_16x16x32_bf16 v[0:3], a[220:223], a[168:171], v[0:3]
    buffer_load_dwordx4 v192, s[28:31], s74 offen lds
    v_mfma_f32_16x16x32_bf16 v[32:35], a[228:231], a[168:171], v[32:35]
    ds_read_b128 a[184:187], v201 offset:40960
    v_mfma_f32_16x16x32_bf16 v[32:35], a[224:227], a[136:139], v[32:35]
    s_mov_b32 m0, 99328
    v_mfma_f32_16x16x32_bf16 v[36:39], a[224:227], a[140:143], v[36:39]
    ds_read_b128 a[156:159], v200 offset:43008
    v_mfma_f32_16x16x32_bf16 v[36:39], a[228:231], a[172:175], v[36:39]
    buffer_load_dwordx4 v193, s[28:31], s74 offen lds
    v_mfma_f32_16x16x32_bf16 v[4:7], a[220:223], a[172:175], v[4:7]
    ds_read_b128 a[188:191], v201 offset:43008
    v_mfma_f32_16x16x32_bf16 v[4:7], a[216:219], a[140:143], v[4:7]
    s_waitcnt lgkmcnt(4)
    v_mfma_f32_16x16x32_bf16 v[8:11], a[216:219], a[144:147], v[8:11]
    s_add_u32 s74, s74, 196608
    v_mfma_f32_16x16x32_bf16 v[8:11], a[220:223], a[176:179], v[8:11]
    ds_read_b128 a[160:163], v200 offset:45056
    v_mfma_f32_16x16x32_bf16 v[40:43], a[228:231], a[176:179], v[40:43]
    ds_read_b128 a[192:195], v201 offset:45056
    v_mfma_f32_16x16x32_bf16 v[40:43], a[224:227], a[144:147], v[40:43]
    ds_read_b128 a[164:167], v200 offset:47104
    v_mfma_f32_16x16x32_bf16 v[44:47], a[224:227], a[148:151], v[44:47]
    ds_read_b128 a[196:199], v201 offset:47104
    v_mfma_f32_16x16x32_bf16 v[44:47], a[228:231], a[180:183], v[44:47]
    ds_read_b64_tr_b16 a[200:201], v204 offset:49216
    v_mfma_f32_16x16x32_bf16 v[12:15], a[220:223], a[180:183], v[12:15]
    ds_read_b64_tr_b16 a[202:203], v204 offset:52800
    v_mfma_f32_16x16x32_bf16 v[12:15], a[216:219], a[148:151], v[12:15]
    s_waitcnt lgkmcnt(6)
    v_mfma_f32_16x16x32_bf16 v[16:19], a[216:219], a[152:155], v[16:19]
    ds_read_b64_tr_b16 a[204:205], v204 offset:56384
    v_mfma_f32_16x16x32_bf16 v[16:19], a[220:223], a[184:187], v[16:19]
    ds_read_b64_tr_b16 a[206:207], v204 offset:59968
    v_mfma_f32_16x16x32_bf16 v[48:51], a[228:231], a[184:187], v[48:51]
    ds_read_b64_tr_b16 a[212:213], v204 offset:56416
    v_mfma_f32_16x16x32_bf16 v[48:51], a[224:227], a[152:155], v[48:51]
    s_cmp_lt_u32 s65, 4
    s_cselect_b32 s84, 2, 5
    s_mul_i32 s84, s84, 786432
    s_add_u32 s90, s90, s84
    v_mfma_f32_16x16x32_bf16 v[52:55], a[224:227], a[156:159], v[52:55]
    s_bfm_b64 exec, 24, 0
    buffer_load_dword v236, v202, s[52:55], s90 offen
    s_mov_b64 exec, -1
    v_mfma_f32_16x16x32_bf16 v[52:55], a[228:231], a[188:191], v[52:55]
    ds_read_b64_tr_b16 a[214:215], v204 offset:60000
    v_mfma_f32_16x16x32_bf16 v[20:23], a[220:223], a[188:191], v[20:23]
    ds_read_b64_tr_b16 a[208:209], v204 offset:49248
    v_mfma_f32_16x16x32_bf16 v[20:23], a[216:219], a[156:159], v[20:23]
    s_waitcnt lgkmcnt(7)
    v_mfma_f32_16x16x32_bf16 v[24:27], a[216:219], a[160:163], v[24:27]
    ds_read_b64_tr_b16 a[210:211], v204 offset:52832
    v_mfma_f32_16x16x32_bf16 v[24:27], a[220:223], a[192:195], v[24:27]
    v_mfma_f32_16x16x32_bf16 v[56:59], a[228:231], a[192:195], v[56:59]
    v_mfma_f32_16x16x32_bf16 v[56:59], a[224:227], a[160:163], v[56:59]
    v_mfma_f32_16x16x32_bf16 v[60:63], a[224:227], a[164:167], v[60:63]
    v_mfma_f32_16x16x32_bf16 v[60:63], a[228:231], a[196:199], v[60:63]
    v_mfma_f32_16x16x32_bf16 v[28:31], a[220:223], a[196:199], v[28:31]
    v_mfma_f32_16x16x32_bf16 v[28:31], a[216:219], a[164:167], v[28:31]
    s_waitcnt lgkmcnt(0)
    v_mfma_f32_16x16x32_bf16 v[92:95], a[200:203], a[164:167], v[92:95]
    ds_read_b64_tr_b16 a[216:217], v205 offset:49152
    v_mfma_f32_16x16x32_bf16 v[92:95], a[204:207], a[196:199], v[92:95]
    v_mfma_f32_16x16x32_bf16 v[124:127], a[212:215], a[196:199], v[124:127]
    ds_read_b64_tr_b16 a[218:219], v205 offset:52736
    v_mfma_f32_16x16x32_bf16 v[124:127], a[208:211], a[164:167], v[124:127]
    v_mfma_f32_16x16x32_bf16 v[120:123], a[208:211], a[160:163], v[120:123]
    ds_read_b64_tr_b16 a[220:221], v205 offset:56320
    v_mfma_f32_16x16x32_bf16 v[120:123], a[212:215], a[192:195], v[120:123]
    v_mfma_f32_16x16x32_bf16 v[88:91], a[204:207], a[192:195], v[88:91]
    ds_read_b64_tr_b16 a[222:223], v205 offset:59904
    v_mfma_f32_16x16x32_bf16 v[88:91], a[200:203], a[160:163], v[88:91]
    v_mfma_f32_16x16x32_bf16 v[84:87], a[200:203], a[156:159], v[84:87]
    v_mfma_f32_16x16x32_bf16 v[84:87], a[204:207], a[188:191], v[84:87]
    v_mfma_f32_16x16x32_bf16 v[116:119], a[212:215], a[188:191], v[116:119]
    v_mfma_f32_16x16x32_bf16 v[116:119], a[208:211], a[156:159], v[116:119]
    v_mfma_f32_16x16x32_bf16 v[112:115], a[208:211], a[152:155], v[112:115]
    v_mfma_f32_16x16x32_bf16 v[112:115], a[212:215], a[184:187], v[112:115]
    v_mfma_f32_16x16x32_bf16 v[80:83], a[204:207], a[184:187], v[80:83]
    v_mfma_f32_16x16x32_bf16 v[80:83], a[200:203], a[152:155], v[80:83]
L_g1_loop2:
    s_waitcnt vmcnt(23) lgkmcnt(0)
    s_barrier
    v_mfma_f32_16x16x32_bf16 v[76:79], a[200:203], a[148:151], v[76:79]
    ds_read_b64_tr_b16 a[228:229], v204 offset:7168
    v_mfma_f32_16x16x32_bf16 v[76:79], a[204:207], a[180:183], v[76:79]
    v_mfma_f32_16x16x32_bf16 v[108:111], a[212:215], a[180:183], v[108:111]
    ds_read_b64_tr_b16 a[230:231], v204 offset:10752
    v_mfma_f32_16x16x32_bf16 v[108:111], a[208:211], a[148:151], v[108:111]
    ds_read_b64_tr_b16 a[224:225], v204 offset:0
    v_mfma_f32_16x16x32_bf16 v[104:107], a[208:211], a[144:147], v[104:107]
    ds_read_b64_tr_b16 a[226:227], v204 offset:3584
    v_mfma_f32_16x16x32_bf16 v[104:107], a[212:215], a[176:179], v[104:107]
    v_mfma_f32_16x16x32_bf16 v[72:75], a[204:207], a[176:179], v[72:75]
    v_mfma_f32_16x16x32_bf16 v[72:75], a[200:203], a[144:147], v[72:75]
    v_mfma_f32_16x16x32_bf16 v[68:71], a[200:203], a[140:143], v[68:71]
    s_mov_b32 m0, 38912
    v_mfma_f32_16x16x32_bf16 v[68:71], a[204:207], a[172:175], v[68:71]
    v_mfma_f32_16x16x32_bf16 v[100:103], a[212:215], a[172:175], v[100:103]
    buffer_load_dwordx4 v198, s[24:27], s72 offen lds
    v_mfma_f32_16x16x32_bf16 v[100:103], a[208:211], a[140:143], v[100:103]
    v_mfma_f32_16x16x32_bf16 v[96:99], a[208:211], a[136:139], v[96:99]
    s_cbranch_vccnz L_skh2_11
L_sbh2_11:
    v_mfma_f32_16x16x32_bf16 v[96:99], a[212:215], a[168:171], v[96:99]
    s_mov_b32 m0, 39936
    v_mfma_f32_16x16x32_bf16 v[64:67], a[204:207], a[168:171], v[64:67]
    buffer_load_dwordx4 v199, s[24:27], s72 offen lds
    v_mfma_f32_16x16x32_bf16 v[64:67], a[200:203], a[136:139], v[64:67]
    v_mfma_f32_16x16x32_bf16 v[128:131], a[216:219], a[136:139], v[128:131]
    s_add_u32 s72, s72, 32768
    v_mfma_f32_16x16x32_bf16 v[128:131], a[220:223], a[168:171], v[128:131]
    s_waitcnt lgkmcnt(0)
    v_mfma_f32_16x16x32_bf16 v[160:163], a[228:231], a[168:171], v[160:163]
    ds_read_b64_tr_b16 a[200:201], v204 offset:32
    v_mfma_f32_16x16x32_bf16 v[160:163], a[224:227], a[136:139], v[160:163]
    s_mov_b32 m0, 40960
    v_mfma_f32_16x16x32_bf16 v[164:167], a[224:227], a[140:143], v[164:167]
    ds_read_b64_tr_b16 a[202:203], v204 offset:3616
    v_mfma_f32_16x16x32_bf16 v[164:167], a[228:231], a[172:175], v[164:167]
    buffer_load_dwordx4 v198, s[24:27], s72 offen lds
    v_mfma_f32_16x16x32_bf16 v[132:135], a[220:223], a[172:175], v[132:135]
    ds_read_b64_tr_b16 a[204:205], v204 offset:7200
    v_mfma_f32_16x16x32_bf16 v[132:135], a[216:219], a[140:143], v[132:135]
    s_mov_b32 m0, 41984
    v_mfma_f32_16x16x32_bf16 v[136:139], a[216:219], a[144:147], v[136:139]
    ds_read_b64_tr_b16 a[206:207], v204 offset:10784
    v_mfma_f32_16x16x32_bf16 v[136:139], a[220:223], a[176:179], v[136:139]
    buffer_load_dwordx4 v199, s[24:27], s72 offen lds
    v_mfma_f32_16x16x32_bf16 v[168:171], a[228:231], a[176:179], v[168:171]
    s_add_u32 s72, s72, 32768
    v_mfma_f32_16x16x32_bf16 v[168:171], a[224:227], a[144:147], v[168:171]
    ds_read_b64_tr_b16 a[212:213], v204 offset:7232
    v_mfma_f32_16x16x32_bf16 v[172:175], a[224:227], a[148:151], v[172:175]
    s_mov_b32 m0, 43008
    v_mfma_f32_16x16x32_bf16 v[172:175], a[228:231], a[180:183], v[172:175]
    ds_read_b64_tr_b16 a[214:215], v204 offset:10816
    v_mfma_f32_16x16x32_bf16 v[140:143], a[220:223], a[180:183], v[140:143]
    buffer_load_dwordx4 v198, s[24:27], s72 offen lds
    v_mfma_f32_16x16x32_bf16 v[140:143], a[216:219], a[148:151], v[140:143]
    ds_read_b64_tr_b16 a[208:209], v204 offset:64
    v_mfma_f32_16x16x32_bf16 v[144:147], a[216:219], a[152:155], v[144:147]
    s_mov_b32 m0, 44032
    v_mfma_f32_16x16x32_bf16 v[144:147], a[220:223], a[184:187], v[144:147]
    ds_read_b64_tr_b16 a[210:211], v204 offset:3648
    v_mfma_f32_16x16x32_bf16 v[176:179], a[228:231], a[184:187], v[176:179]
    buffer_load_dwordx4 v199, s[24:27], s72 offen lds
    v_mfma_f32_16x16x32_bf16 v[176:179], a[224:227], a[152:155], v[176:179]
    s_add_u32 s72, s72, 32768
    v_mfma_f32_16x16x32_bf16 v[180:183], a[224:227], a[156:159], v[180:183]
    v_mfma_f32_16x16x32_bf16 v[180:183], a[228:231], a[188:191], v[180:183]
    s_mov_b32 m0, 45056
    v_mfma_f32_16x16x32_bf16 v[148:151], a[220:223], a[188:191], v[148:151]
    v_mfma_f32_16x16x32_bf16 v[148:151], a[216:219], a[156:159], v[148:151]
    buffer_load_dwordx4 v198, s[24:27], s72 offen lds
    v_mfma_f32_16x16x32_bf16 v[152:155], a[216:219], a[160:163], v[152:155]
    v_mfma_f32_16x16x32_bf16 v[152:155], a[220:223], a[192:195], v[152:155]
    s_mov_b32 m0, 46080
    v_mfma_f32_16x16x32_bf16 v[184:187], a[228:231], a[192:195], v[184:187]
    buffer_load_dwordx4 v199, s[24:27], s72 offen lds
    v_mfma_f32_16x16x32_bf16 v[184:187], a[224:227], a[160:163], v[184:187]
    v_mfma_f32_16x16x32_bf16 v[188:191], a[224:227], a[164:167], v[188:191]
    s_add_u32 s72, s72, 32768
    v_mfma_f32_16x16x32_bf16 v[188:191], a[228:231], a[196:199], v[188:191]
    v_mfma_f32_16x16x32_bf16 v[156:159], a[220:223], a[196:199], v[156:159]
    s_mov_b32 m0, 47104
    v_mfma_f32_16x16x32_bf16 v[156:159], a[216:219], a[164:167], v[156:159]
    s_waitcnt lgkmcnt(0)
    v_mfma_f32_16x16x32_bf16 a[28:31], a[200:203], a[164:167], a[28:31]
    buffer_load_dwordx4 v198, s[24:27], s72 offen lds
    v_mfma_f32_16x16x32_bf16 a[28:31], a[204:207], a[196:199], a[28:31]
    ds_read_b64_tr_b16 a[216:217], v204 offset:96
    v_mfma_f32_16x16x32_bf16 a[60:63], a[212:215], a[196:199], a[60:63]
    s_mov_b32 m0, 48128
    v_mfma_f32_16x16x32_bf16 a[60:63], a[208:211], a[164:167], a[60:63]
    ds_read_b64_tr_b16 a[218:219], v204 offset:3680
    v_mfma_f32_16x16x32_bf16 a[56:59], a[208:211], a[160:163], a[56:59]
    buffer_load_dwordx4 v199, s[24:27], s72 offen lds
    v_mfma_f32_16x16x32_bf16 a[56:59], a[212:215], a[192:195], a[56:59]
    ds_read_b64_tr_b16 a[220:221], v204 offset:7264
    v_mfma_f32_16x16x32_bf16 a[24:27], a[204:207], a[192:195], a[24:27]
    s_add_u32 s72, s72, 4294836352
    v_mfma_f32_16x16x32_bf16 a[24:27], a[200:203], a[160:163], a[24:27]
    ds_read_b64_tr_b16 a[222:223], v204 offset:10848
    v_mfma_f32_16x16x32_bf16 a[20:23], a[200:203], a[156:159], a[20:23]
    s_mov_b32 m0, 67584
    v_mfma_f32_16x16x32_bf16 a[20:23], a[204:207], a[188:191], a[20:23]
    ds_read_b64_tr_b16 a[228:229], v205 offset:7168
    v_mfma_f32_16x16x32_bf16 a[52:55], a[212:215], a[188:191], a[52:55]
    buffer_load_dwordx4 v194, s[28:31], s74 offen lds
    v_mfma_f32_16x16x32_bf16 a[52:55], a[208:211], a[156:159], a[52:55]
    s_mov_b32 m0, 68608
    v_mfma_f32_16x16x32_bf16 a[48:51], a[208:211], a[152:155], a[48:51]
    ds_read_b64_tr_b16 a[230:231], v205 offset:10752
    v_mfma_f32_16x16x32_bf16 a[48:51], a[212:215], a[184:187], a[48:51]
    buffer_load_dwordx4 v195, s[28:31], s74 offen lds
    v_mfma_f32_16x16x32_bf16 a[16:19], a[204:207], a[184:187], a[16:19]
    ds_read_b64_tr_b16 a[224:225], v205 offset:0
    v_mfma_f32_16x16x32_bf16 a[16:19], a[200:203], a[152:155], a[16:19]
    s_add_u32 s74, s74, 196608
    v_mfma_f32_16x16x32_bf16 a[12:15], a[200:203], a[148:151], a[12:15]
    ds_read_b64_tr_b16 a[226:227], v205 offset:3584
    v_mfma_f32_16x16x32_bf16 a[12:15], a[204:207], a[180:183], a[12:15]
    s_mov_b32 m0, 73728
    v_mfma_f32_16x16x32_bf16 a[44:47], a[212:215], a[180:183], a[44:47]
    v_mfma_f32_16x16x32_bf16 a[44:47], a[208:211], a[148:151], a[44:47]
    buffer_load_dwordx4 v194, s[28:31], s74 offen lds
    v_mfma_f32_16x16x32_bf16 a[40:43], a[208:211], a[144:147], a[40:43]
    v_mfma_f32_16x16x32_bf16 a[40:43], a[212:215], a[176:179], a[40:43]
    s_mov_b32 m0, 74752
    v_mfma_f32_16x16x32_bf16 a[8:11], a[204:207], a[176:179], a[8:11]
    v_mfma_f32_16x16x32_bf16 a[8:11], a[200:203], a[144:147], a[8:11]
    buffer_load_dwordx4 v195, s[28:31], s74 offen lds
    v_mfma_f32_16x16x32_bf16 a[4:7], a[200:203], a[140:143], a[4:7]
    v_mfma_f32_16x16x32_bf16 a[4:7], a[204:207], a[172:175], a[4:7]
    s_sub_u32 s74, s74, 196608
    v_mfma_f32_16x16x32_bf16 a[36:39], a[212:215], a[172:175], a[36:39]
    global_load_dword v236, v237, s[0:1]
    v_mfma_f32_16x16x32_bf16 a[36:39], a[208:211], a[140:143], a[36:39]
    v_mfma_f32_16x16x32_bf16 a[32:35], a[208:211], a[136:139], a[32:35]
    v_mfma_f32_16x16x32_bf16 a[32:35], a[212:215], a[168:171], a[32:35]
    v_mfma_f32_16x16x32_bf16 a[0:3], a[204:207], a[168:171], a[0:3]
    s_cbranch_vccnz L_skh2_13
L_sbh2_13:
    v_mfma_f32_16x16x32_bf16 a[0:3], a[200:203], a[136:139], a[0:3]
    s_cmp_eq_u32 s76, 4
    s_cbranch_scc1 L_hs2
L_hb2:
    s_waitcnt vmcnt(24) lgkmcnt(0)
    s_barrier
    v_mfma_f32_16x16x32_bf16 a[64:67], a[216:219], a[136:139], a[64:67]
    ds_read_b64_tr_b16 a[200:201], v204 offset:34816
    v_mfma_f32_16x16x32_bf16 a[64:67], a[220:223], a[168:171], a[64:67]
    s_mov_b32 m0, 69632
    v_mfma_f32_16x16x32_bf16 a[96:99], a[228:231], a[168:171], a[96:99]
    ds_read_b64_tr_b16 a[202:203], v204 offset:38400
    v_mfma_f32_16x16x32_bf16 a[96:99], a[224:227], a[136:139], a[96:99]
    buffer_load_dwordx4 v196, s[28:31], s74 offen lds
    v_mfma_f32_16x16x32_bf16 a[100:103], a[224:227], a[140:143], a[100:103]
    ds_read_b64_tr_b16 a[204:205], v204 offset:41984
    v_mfma_f32_16x16x32_bf16 a[100:103], a[228:231], a[172:175], a[100:103]
    ds_read_b64_tr_b16 a[206:207], v204 offset:45568
    v_mfma_f32_16x16x32_bf16 a[68:71], a[220:223], a[172:175], a[68:71]
    s_mov_b32 m0, 70656
    v_mfma_f32_16x16x32_bf16 a[68:71], a[216:219], a[140:143], a[68:71]
    ds_read_b64_tr_b16 a[212:213], v204 offset:42016
    v_mfma_f32_16x16x32_bf16 a[72:75], a[216:219], a[144:147], a[72:75]
    ds_read_b64_tr_b16 a[214:215], v204 offset:45600
    v_mfma_f32_16x16x32_bf16 a[72:75], a[220:223], a[176:179], a[72:75]
    buffer_load_dwordx4 v197, s[28:31], s74 offen lds
    v_mfma_f32_16x16x32_bf16 a[104:107], a[228:231], a[176:179], a[104:107]
    ds_read_b64_tr_b16 a[208:209], v204 offset:34848
    v_mfma_f32_16x16x32_bf16 a[104:107], a[224:227], a[144:147], a[104:107]
    ds_read_b128 a[136:139], v200 offset:0
    v_mfma_f32_16x16x32_bf16 a[108:111], a[224:227], a[148:151], a[108:111]
    s_mov_b32 m0, 65536
    v_mfma_f32_16x16x32_bf16 a[108:111], a[228:231], a[180:183], a[108:111]
    ds_read_b64_tr_b16 a[210:211], v204 offset:38432
    v_mfma_f32_16x16x32_bf16 a[76:79], a[220:223], a[180:183], a[76:79]
    ds_read_b128 a[168:171], v201 offset:0
    v_mfma_f32_16x16x32_bf16 a[76:79], a[216:219], a[148:151], a[76:79]
    buffer_load_dwordx4 v192, s[28:31], s74 offen lds
    v_mfma_f32_16x16x32_bf16 a[80:83], a[216:219], a[152:155], a[80:83]
    ds_read_b128 a[140:143], v200 offset:2048
    v_mfma_f32_16x16x32_bf16 a[80:83], a[220:223], a[184:187], a[80:83]
    s_mov_b32 m0, 66560
    v_mfma_f32_16x16x32_bf16 a[112:115], a[228:231], a[184:187], a[112:115]
    buffer_load_dwordx4 v193, s[28:31], s74 offen lds
    v_mfma_f32_16x16x32_bf16 a[112:115], a[224:227], a[152:155], a[112:115]
    ds_read_b128 a[172:175], v201 offset:2048
    v_mfma_f32_16x16x32_bf16 a[116:119], a[224:227], a[156:159], a[116:119]
    s_add_u32 s74, s74, 196608
    v_mfma_f32_16x16x32_bf16 a[116:119], a[228:231], a[188:191], a[116:119]
    ds_read_b128 a[144:147], v200 offset:4096
    v_mfma_f32_16x16x32_bf16 a[84:87], a[220:223], a[188:191], a[84:87]
    s_mov_b32 m0, 75776
    v_mfma_f32_16x16x32_bf16 a[84:87], a[216:219], a[156:159], a[84:87]
    ds_read_b128 a[176:179], v201 offset:4096
    v_mfma_f32_16x16x32_bf16 a[88:91], a[216:219], a[160:163], a[88:91]
    buffer_load_dwordx4 v196, s[28:31], s74 offen lds
    v_mfma_f32_16x16x32_bf16 a[88:91], a[220:223], a[192:195], a[88:91]
    ds_read_b128 a[148:151], v200 offset:6144
    v_mfma_f32_16x16x32_bf16 a[120:123], a[228:231], a[192:195], a[120:123]
    s_mov_b32 m0, 76800
    v_mfma_f32_16x16x32_bf16 a[120:123], a[224:227], a[160:163], a[120:123]
    ds_read_b128 a[180:183], v201 offset:6144
    v_mfma_f32_16x16x32_bf16 a[124:127], a[224:227], a[164:167], a[124:127]
    buffer_load_dwordx4 v197, s[28:31], s74 offen lds
    v_mfma_f32_16x16x32_bf16 a[124:127], a[228:231], a[196:199], a[124:127]
    s_mov_b32 m0, 71680
    v_mfma_f32_16x16x32_bf16 a[92:95], a[220:223], a[196:199], a[92:95]
    ds_read_b128 a[152:155], v200 offset:8192
    v_mfma_f32_16x16x32_bf16 a[92:95], a[216:219], a[164:167], a[92:95]
    s_waitcnt lgkmcnt(5)
    v_mfma_f32_16x16x32_bf16 v[0:3], a[200:203], a[136:139], v[0:3]
    buffer_load_dwordx4 v192, s[28:31], s74 offen lds
    v_mfma_f32_16x16x32_bf16 v[0:3], a[204:207], a[168:171], v[0:3]
    ds_read_b128 a[184:187], v201 offset:8192
    v_mfma_f32_16x16x32_bf16 v[32:35], a[212:215], a[168:171], v[32:35]
    s_mov_b32 m0, 72704
    v_mfma_f32_16x16x32_bf16 v[32:35], a[208:211], a[136:139], v[32:35]
    ds_read_b128 a[156:159], v200 offset:10240
    v_mfma_f32_16x16x32_bf16 v[36:39], a[208:211], a[140:143], v[36:39]
    buffer_load_dwordx4 v193, s[28:31], s74 offen lds
    v_mfma_f32_16x16x32_bf16 v[36:39], a[212:215], a[172:175], v[36:39]
    ds_read_b128 a[188:191], v201 offset:10240
    v_mfma_f32_16x16x32_bf16 v[4:7], a[204:207], a[172:175], v[4:7]
    s_add_u32 s74, s74, 196608
    v_mfma_f32_16x16x32_bf16 v[4:7], a[200:203], a[140:143], v[4:7]
    s_waitcnt lgkmcnt(4)
    v_mfma_f32_16x16x32_bf16 v[8:11], a[200:203], a[144:147], v[8:11]
    ds_read_b128 a[160:163], v200 offset:12288
    v_mfma_f32_16x16x32_bf16 v[8:11], a[204:207], a[176:179], v[8:11]
    ds_read_b128 a[192:195], v201 offset:12288
    v_mfma_f32_16x16x32_bf16 v[40:43], a[212:215], a[176:179], v[40:43]
    ds_read_b128 a[164:167], v200 offset:14336
    v_mfma_f32_16x16x32_bf16 v[40:43], a[208:211], a[144:147], v[40:43]
    ds_read_b128 a[196:199], v201 offset:14336
    v_mfma_f32_16x16x32_bf16 v[44:47], a[208:211], a[148:151], v[44:47]
    ds_read_b64_tr_b16 a[216:217], v204 offset:34880
    v_mfma_f32_16x16x32_bf16 v[44:47], a[212:215], a[180:183], v[44:47]
    ds_read_b64_tr_b16 a[218:219], v204 offset:38464
    v_mfma_f32_16x16x32_bf16 v[12:15], a[204:207], a[180:183], v[12:15]
    ds_read_b64_tr_b16 a[220:221], v204 offset:42048
    v_mfma_f32_16x16x32_bf16 v[12:15], a[200:203], a[148:151], v[12:15]
    s_waitcnt lgkmcnt(7)
    v_mfma_f32_16x16x32_bf16 v[16:19], a[200:203], a[152:155], v[16:19]
    ds_read_b64_tr_b16 a[222:223], v204 offset:45632
    v_mfma_f32_16x16x32_bf16 v[16:19], a[204:207], a[184:187], v[16:19]
    ds_read_b64_tr_b16 a[228:229], v204 offset:42080
    v_mfma_f32_16x16x32_bf16 v[48:51], a[212:215], a[184:187], v[48:51]
    s_cmp_lt_u32 s76, 3
    s_cselect_b32 s84, s90, 2.0
    s_bfm_b64 exec, 24, 24
    buffer_load_dword v236, v202, s[52:55], s84 offen
    s_mov_b64 exec, -1
    s_add_u32 s90, s90, 786432
    v_mfma_f32_16x16x32_bf16 v[48:51], a[208:211], a[152:155], v[48:51]
    ds_read_b64_tr_b16 a[230:231], v204 offset:45664
    v_mfma_f32_16x16x32_bf16 v[52:55], a[208:211], a[156:159], v[52:55]
    ds_read_b64_tr_b16 a[224:225], v204 offset:34912
    v_mfma_f32_16x16x32_bf16 v[52:55], a[212:215], a[188:191], v[52:55]
    ds_read_b64_tr_b16 a[226:227], v204 offset:38496
    v_mfma_f32_16x16x32_bf16 v[20:23], a[204:207], a[188:191], v[20:23]
    v_mfma_f32_16x16x32_bf16 v[20:23], a[200:203], a[156:159], v[20:23]
    s_waitcnt lgkmcnt(8)
    v_mfma_f32_16x16x32_bf16 v[24:27], a[200:203], a[160:163], v[24:27]
    v_mfma_f32_16x16x32_bf16 v[24:27], a[204:207], a[192:195], v[24:27]
    v_mfma_f32_16x16x32_bf16 v[56:59], a[212:215], a[192:195], v[56:59]
    v_mfma_f32_16x16x32_bf16 v[56:59], a[208:211], a[160:163], v[56:59]
    v_mfma_f32_16x16x32_bf16 v[60:63], a[208:211], a[164:167], v[60:63]
    v_mfma_f32_16x16x32_bf16 v[60:63], a[212:215], a[196:199], v[60:63]
    s_cmp_eq_u32 s76, s82
    s_cselect_b64 vcc, -1, 0
    v_mfma_f32_16x16x32_bf16 v[28:31], a[204:207], a[196:199], v[28:31]
    s_cbranch_vccnz L_skh2_00
L_sbh2_00:
    v_mfma_f32_16x16x32_bf16 v[28:31], a[200:203], a[164:167], v[28:31]
    s_waitcnt lgkmcnt(0)
    v_mfma_f32_16x16x32_bf16 v[92:95], a[216:219], a[164:167], v[92:95]
    ds_read_b64_tr_b16 a[200:201], v205 offset:34816
    v_mfma_f32_16x16x32_bf16 v[92:95], a[220:223], a[196:199], v[92:95]
    v_mfma_f32_16x16x32_bf16 v[124:127], a[228:231], a[196:199], v[124:127]
    ds_read_b64_tr_b16 a[202:203], v205 offset:38400
    v_mfma_f32_16x16x32_bf16 v[124:127], a[224:227], a[164:167], v[124:127]
    v_mfma_f32_16x16x32_bf16 v[120:123], a[224:227], a[160:163], v[120:123]
    ds_read_b64_tr_b16 a[204:205], v205 offset:41984
    v_mfma_f32_16x16x32_bf16 v[120:123], a[228:231], a[192:195], v[120:123]
    v_mfma_f32_16x16x32_bf16 v[88:91], a[220:223], a[192:195], v[88:91]
    ds_read_b64_tr_b16 a[206:207], v205 offset:45568
    v_mfma_f32_16x16x32_bf16 v[88:91], a[216:219], a[160:163], v[88:91]
    v_mfma_f32_16x16x32_bf16 v[84:87], a[216:219], a[156:159], v[84:87]
    v_mfma_f32_16x16x32_bf16 v[84:87], a[220:223], a[188:191], v[84:87]
    v_mfma_f32_16x16x32_bf16 v[116:119], a[228:231], a[188:191], v[116:119]
    v_mfma_f32_16x16x32_bf16 v[116:119], a[224:227], a[156:159], v[116:119]
    v_mfma_f32_16x16x32_bf16 v[112:115], a[224:227], a[152:155], v[112:115]
    v_mfma_f32_16x16x32_bf16 v[112:115], a[228:231], a[184:187], v[112:115]
    v_mfma_f32_16x16x32_bf16 v[80:83], a[220:223], a[184:187], v[80:83]
    v_mfma_f32_16x16x32_bf16 v[80:83], a[216:219], a[152:155], v[80:83]
    s_add_u32 s76, s76, 1
    s_cmp_eq_u32 s76, 7
    s_cbranch_scc1 L_tail2
    s_cmp_lg_u32 s76, s81
    s_cbranch_scc1 L_nw2
    s_lshl_b32 s84, s83, 8
    s_add_u32 s72, s72, s84
    s_mul_i32 s84, s83, 786432
    s_add_u32 s74, s74, s84
    s_mov_b32 s81, 4
    s_mov_b32 s83, -6
L_nw2:
    s_waitcnt vmcnt(25) lgkmcnt(0)
    s_barrier
    v_mfma_f32_16x16x32_bf16 v[76:79], a[216:219], a[148:151], v[76:79]
    ds_read_b64_tr_b16 a[212:213], v204 offset:27648
    v_mfma_f32_16x16x32_bf16 v[76:79], a[220:223], a[180:183], v[76:79]
    s_cmp_eq_u32 s76, 5
    s_cselect_b32 s84, s88, 2.0
    buffer_store_dwordx2 v[238:239], v207, s[44:47], s84 offen sc1
    v_mfma_f32_16x16x32_bf16 v[108:111], a[228:231], a[180:183], v[108:111]
    ds_read_b64_tr_b16 a[214:215], v204 offset:31232
    v_mfma_f32_16x16x32_bf16 v[108:111], a[224:227], a[148:151], v[108:111]
    ds_read_b64_tr_b16 a[208:209], v204 offset:20480
    v_mfma_f32_16x16x32_bf16 v[104:107], a[224:227], a[144:147], v[104:107]
    ds_read_b64_tr_b16 a[210:211], v204 offset:24064
    v_mfma_f32_16x16x32_bf16 v[104:107], a[228:231], a[176:179], v[104:107]
    v_mfma_f32_16x16x32_bf16 v[72:75], a[220:223], a[176:179], v[72:75]
    v_mfma_f32_16x16x32_bf16 v[72:75], a[216:219], a[144:147], v[72:75]
    v_mfma_f32_16x16x32_bf16 v[68:71], a[216:219], a[140:143], v[68:71]
    s_mov_b32 m0, 6144
    v_mfma_f32_16x16x32_bf16 v[68:71], a[220:223], a[172:175], v[68:71]
    v_mfma_f32_16x16x32_bf16 v[100:103], a[228:231], a[172:175], v[100:103]
    buffer_load_dwordx4 v198, s[24:27], s72 offen lds
    v_mfma_f32_16x16x32_bf16 v[100:103], a[224:227], a[140:143], v[100:103]
    v_mfma_f32_16x16x32_bf16 v[96:99], a[224:227], a[136:139], v[96:99]
    s_mov_b32 m0, 7168
    v_mfma_f32_16x16x32_bf16 v[96:99], a[228:231], a[168:171], v[96:99]
    v_mfma_f32_16x16x32_bf16 v[64:67], a[220:223], a[168:171], v[64:67]
    buffer_load_dwordx4 v199, s[24:27], s72 offen lds
    v_mfma_f32_16x16x32_bf16 v[64:67], a[216:219], a[136:139], v[64:67]
    v_mfma_f32_16x16x32_bf16 v[128:131], a[200:203], a[136:139], v[128:131]
    s_add_u32 s72, s72, 32768
    v_mfma_f32_16x16x32_bf16 v[128:131], a[204:207], a[168:171], v[128:131]
    s_waitcnt lgkmcnt(0)
    v_mfma_f32_16x16x32_bf16 v[160:163], a[212:215], a[168:171], v[160:163]
    ds_read_b64_tr_b16 a[216:217], v204 offset:20512
    v_mfma_f32_16x16x32_bf16 v[160:163], a[208:211], a[136:139], v[160:163]
    s_mov_b32 m0, 8192
    v_mfma_f32_16x16x32_bf16 v[164:167], a[208:211], a[140:143], v[164:167]
    ds_read_b64_tr_b16 a[218:219], v204 offset:24096
    v_mfma_f32_16x16x32_bf16 v[164:167], a[212:215], a[172:175], v[164:167]
    buffer_load_dwordx4 v198, s[24:27], s72 offen lds
    v_mfma_f32_16x16x32_bf16 v[132:135], a[204:207], a[172:175], v[132:135]
    ds_read_b64_tr_b16 a[220:221], v204 offset:27680
    v_mfma_f32_16x16x32_bf16 v[132:135], a[200:203], a[140:143], v[132:135]
    s_mov_b32 m0, 9216
    v_mfma_f32_16x16x32_bf16 v[136:139], a[200:203], a[144:147], v[136:139]
    ds_read_b64_tr_b16 a[222:223], v204 offset:31264
    v_mfma_f32_16x16x32_bf16 v[136:139], a[204:207], a[176:179], v[136:139]
    buffer_load_dwordx4 v199, s[24:27], s72 offen lds
    v_mfma_f32_16x16x32_bf16 v[168:171], a[212:215], a[176:179], v[168:171]
    s_add_u32 s72, s72, 32768
    v_mfma_f32_16x16x32_bf16 v[168:171], a[208:211], a[144:147], v[168:171]
    ds_read_b64_tr_b16 a[228:229], v204 offset:27712
    v_mfma_f32_16x16x32_bf16 v[172:175], a[208:211], a[148:151], v[172:175]
    s_mov_b32 m0, 10240
    v_mfma_f32_16x16x32_bf16 v[172:175], a[212:215], a[180:183], v[172:175]
    ds_read_b64_tr_b16 a[230:231], v204 offset:31296
    v_mfma_f32_16x16x32_bf16 v[140:143], a[204:207], a[180:183], v[140:143]
    buffer_load_dwordx4 v198, s[24:27], s72 offen lds
    v_mfma_f32_16x16x32_bf16 v[140:143], a[200:203], a[148:151], v[140:143]
    ds_read_b64_tr_b16 a[224:225], v204 offset:20544
    v_mfma_f32_16x16x32_bf16 v[144:147], a[200:203], a[152:155], v[144:147]
    s_mov_b32 m0, 11264
    v_mfma_f32_16x16x32_bf16 v[144:147], a[204:207], a[184:187], v[144:147]
    ds_read_b64_tr_b16 a[226:227], v204 offset:24128
    v_mfma_f32_16x16x32_bf16 v[176:179], a[212:215], a[184:187], v[176:179]
    buffer_load_dwordx4 v199, s[24:27], s72 offen lds
    v_mfma_f32_16x16x32_bf16 v[176:179], a[208:211], a[152:155], v[176:179]
    s_add_u32 s72, s72, 32768
    v_mfma_f32_16x16x32_bf16 v[180:183], a[208:211], a[156:159], v[180:183]
    v_mfma_f32_16x16x32_bf16 v[180:183], a[212:215], a[188:191], v[180:183]
    s_mov_b32 m0, 12288
    v_mfma_f32_16x16x32_bf16 v[148:151], a[204:207], a[188:191], v[148:151]
    v_mfma_f32_16x16x32_bf16 v[148:151], a[200:203], a[156:159], v[148:151]
    buffer_load_dwordx4 v198, s[24:27], s72 offen lds
    v_mfma_f32_16x16x32_bf16 v[152:155], a[200:203], a[160:163], v[152:155]
    v_mfma_f32_16x16x32_bf16 v[152:155], a[204:207], a[192:195], v[152:155]
    s_mov_b32 m0, 13312
    v_mfma_f32_16x16x32_bf16 v[184:187], a[212:215], a[192:195], v[184:187]
    buffer_load_dwordx4 v199, s[24:27], s72 offen lds
    v_mfma_f32_16x16x32_bf16 v[184:187], a[208:211], a[160:163], v[184:187]
    v_mfma_f32_16x16x32_bf16 v[188:191], a[208:211], a[164:167], v[188:191]
    s_add_u32 s72, s72, 32768
    v_mfma_f32_16x16x32_bf16 v[188:191], a[212:215], a[196:199], v[188:191]
    v_mfma_f32_16x16x32_bf16 v[156:159], a[204:207], a[196:199], v[156:159]
    s_cbranch_vccnz L_skh2_02
L_sbh2_02:
    v_mfma_f32_16x16x32_bf16 v[156:159], a[200:203], a[164:167], v[156:159]
    s_waitcnt lgkmcnt(0)
    v_mfma_f32_16x16x32_bf16 a[28:31], a[216:219], a[164:167], a[28:31]
    s_mov_b32 m0, 14336
    v_mfma_f32_16x16x32_bf16 a[28:31], a[220:223], a[196:199], a[28:31]
    buffer_load_dwordx4 v198, s[24:27], s72 offen lds
    v_mfma_f32_16x16x32_bf16 a[60:63], a[228:231], a[196:199], a[60:63]
    ds_read_b64_tr_b16 a[200:201], v204 offset:20576
    v_mfma_f32_16x16x32_bf16 a[60:63], a[224:227], a[164:167], a[60:63]
    s_mov_b32 m0, 15360
    v_mfma_f32_16x16x32_bf16 a[56:59], a[224:227], a[160:163], a[56:59]
    ds_read_b64_tr_b16 a[202:203], v204 offset:24160
    v_mfma_f32_16x16x32_bf16 a[56:59], a[228:231], a[192:195], a[56:59]
    buffer_load_dwordx4 v199, s[24:27], s72 offen lds
    v_mfma_f32_16x16x32_bf16 a[24:27], a[220:223], a[192:195], a[24:27]
    ds_read_b64_tr_b16 a[204:205], v204 offset:27744
    v_mfma_f32_16x16x32_bf16 a[24:27], a[216:219], a[160:163], a[24:27]
    s_add_u32 s72, s72, 4294836352
    v_mfma_f32_16x16x32_bf16 a[20:23], a[216:219], a[156:159], a[20:23]
    ds_read_b64_tr_b16 a[206:207], v204 offset:31328
    v_mfma_f32_16x16x32_bf16 a[20:23], a[220:223], a[188:191], a[20:23]
    s_mov_b32 m0, 79872
    v_mfma_f32_16x16x32_bf16 a[52:55], a[228:231], a[188:191], a[52:55]
    ds_read_b64_tr_b16 a[212:213], v205 offset:27648
    v_mfma_f32_16x16x32_bf16 a[52:55], a[224:227], a[156:159], a[52:55]
    buffer_load_dwordx4 v194, s[28:31], s74 offen lds
    v_mfma_f32_16x16x32_bf16 a[48:51], a[224:227], a[152:155], a[48:51]
    s_mov_b32 m0, 80896
    v_mfma_f32_16x16x32_bf16 a[48:51], a[228:231], a[184:187], a[48:51]
    ds_read_b64_tr_b16 a[214:215], v205 offset:31232
    v_mfma_f32_16x16x32_bf16 a[16:19], a[220:223], a[184:187], a[16:19]
    buffer_load_dwordx4 v195, s[28:31], s74 offen lds
    v_mfma_f32_16x16x32_bf16 a[16:19], a[216:219], a[152:155], a[16:19]
    ds_read_b64_tr_b16 a[208:209], v205 offset:20480
    v_mfma_f32_16x16x32_bf16 a[12:15], a[216:219], a[148:151], a[12:15]
    s_add_u32 s74, s74, 196608
    v_mfma_f32_16x16x32_bf16 a[12:15], a[220:223], a[180:183], a[12:15]
    ds_read_b64_tr_b16 a[210:211], v205 offset:24064
    v_mfma_f32_16x16x32_bf16 a[44:47], a[228:231], a[180:183], a[44:47]
    s_mov_b32 m0, 100352
    v_mfma_f32_16x16x32_bf16 a[44:47], a[224:227], a[148:151], a[44:47]
    buffer_load_dwordx4 v194, s[28:31], s74 offen lds
    v_mfma_f32_16x16x32_bf16 a[40:43], a[224:227], a[144:147], a[40:43]
    v_mfma_f32_16x16x32_bf16 a[40:43], a[228:231], a[176:179], a[40:43]
    s_mov_b32 m0, 101376
    v_mfma_f32_16x16x32_bf16 a[8:11], a[220:223], a[176:179], a[8:11]
    v_mfma_f32_16x16x32_bf16 a[8:11], a[216:219], a[144:147], a[8:11]
    buffer_load_dwordx4 v195, s[28:31], s74 offen lds
    v_mfma_f32_16x16x32_bf16 a[4:7], a[216:219], a[140:143], a[4:7]
    v_mfma_f32_16x16x32_bf16 a[4:7], a[220:223], a[172:175], a[4:7]
    s_sub_u32 s74, s74, 196608
    v_mfma_f32_16x16x32_bf16 a[36:39], a[228:231], a[172:175], a[36:39]
    v_mfma_f32_16x16x32_bf16 a[36:39], a[224:227], a[140:143], a[36:39]
    v_mfma_f32_16x16x32_bf16 a[32:35], a[224:227], a[136:139], a[32:35]
    v_mfma_f32_16x16x32_bf16 a[32:35], a[228:231], a[168:171], a[32:35]
    v_mfma_f32_16x16x32_bf16 a[0:3], a[220:223], a[168:171], a[0:3]
    v_mfma_f32_16x16x32_bf16 a[0:3], a[216:219], a[136:139], a[0:3]
    s_waitcnt vmcnt(25) lgkmcnt(0)
    s_barrier
    v_mfma_f32_16x16x32_bf16 a[64:67], a[200:203], a[136:139], a[64:67]
    ds_read_b64_tr_b16 a[216:217], v204 offset:49152
    v_mfma_f32_16x16x32_bf16 a[64:67], a[204:207], a[168:171], a[64:67]
    s_mov_b32 m0, 81920
    v_mfma_f32_16x16x32_bf16 a[96:99], a[212:215], a[168:171], a[96:99]
    ds_read_b64_tr_b16 a[218:219], v204 offset:52736
    v_mfma_f32_16x16x32_bf16 a[96:99], a[208:211], a[136:139], a[96:99]
    buffer_load_dwordx4 v196, s[28:31], s74 offen lds
    v_mfma_f32_16x16x32_bf16 a[100:103], a[208:211], a[140:143], a[100:103]
    ds_read_b64_tr_b16 a[220:221], v204 offset:56320
    v_mfma_f32_16x16x32_bf16 a[100:103], a[212:215], a[172:175], a[100:103]
    ds_read_b64_tr_b16 a[222:223], v204 offset:59904
    v_mfma_f32_16x16x32_bf16 a[68:71], a[204:207], a[172:175], a[68:71]
    s_mov_b32 m0, 82944
    v_mfma_f32_16x16x32_bf16 a[68:71], a[200:203], a[140:143], a[68:71]
    ds_read_b64_tr_b16 a[228:229], v204 offset:56352
    v_mfma_f32_16x16x32_bf16 a[72:75], a[200:203], a[144:147], a[72:75]
    ds_read_b64_tr_b16 a[230:231], v204 offset:59936
    v_mfma_f32_16x16x32_bf16 a[72:75], a[204:207], a[176:179], a[72:75]
    buffer_load_dwordx4 v197, s[28:31], s74 offen lds
    v_mfma_f32_16x16x32_bf16 a[104:107], a[212:215], a[176:179], a[104:107]
    ds_read_b64_tr_b16 a[224:225], v204 offset:49184
    v_mfma_f32_16x16x32_bf16 a[104:107], a[208:211], a[144:147], a[104:107]
    ds_read_b128 a[136:139], v200 offset:32768
    v_mfma_f32_16x16x32_bf16 a[108:111], a[208:211], a[148:151], a[108:111]
    s_mov_b32 m0, 77824
    v_mfma_f32_16x16x32_bf16 a[108:111], a[212:215], a[180:183], a[108:111]
    ds_read_b64_tr_b16 a[226:227], v204 offset:52768
    v_mfma_f32_16x16x32_bf16 a[76:79], a[204:207], a[180:183], a[76:79]
    ds_read_b128 a[168:171], v201 offset:32768
    v_mfma_f32_16x16x32_bf16 a[76:79], a[200:203], a[148:151], a[76:79]
    buffer_load_dwordx4 v192, s[28:31], s74 offen lds
    v_mfma_f32_16x16x32_bf16 a[80:83], a[200:203], a[152:155], a[80:83]
    ds_read_b128 a[140:143], v200 offset:34816
    v_mfma_f32_16x16x32_bf16 a[80:83], a[204:207], a[184:187], a[80:83]
    s_mov_b32 m0, 78848
    v_mfma_f32_16x16x32_bf16 a[112:115], a[212:215], a[184:187], a[112:115]
    buffer_load_dwordx4 v193, s[28:31], s74 offen lds
    v_mfma_f32_16x16x32_bf16 a[112:115], a[208:211], a[152:155], a[112:115]
    ds_read_b128 a[172:175], v201 offset:34816
    v_mfma_f32_16x16x32_bf16 a[116:119], a[208:211], a[156:159], a[116:119]
    s_add_u32 s74, s74, 196608
    v_mfma_f32_16x16x32_bf16 a[116:119], a[212:215], a[188:191], a[116:119]
    ds_read_b128 a[144:147], v200 offset:36864
    v_mfma_f32_16x16x32_bf16 a[84:87], a[204:207], a[188:191], a[84:87]
    s_mov_b32 m0, 102400
    v_mfma_f32_16x16x32_bf16 a[84:87], a[200:203], a[156:159], a[84:87]
    ds_read_b128 a[176:179], v201 offset:36864
    v_mfma_f32_16x16x32_bf16 a[88:91], a[200:203], a[160:163], a[88:91]
    buffer_load_dwordx4 v196, s[28:31], s74 offen lds
    v_mfma_f32_16x16x32_bf16 a[88:91], a[204:207], a[192:195], a[88:91]
    ds_read_b128 a[148:151], v200 offset:38912
    v_mfma_f32_16x16x32_bf16 a[120:123], a[212:215], a[192:195], a[120:123]
    s_mov_b32 m0, 103424
    v_mfma_f32_16x16x32_bf16 a[120:123], a[208:211], a[160:163], a[120:123]
    ds_read_b128 a[180:183], v201 offset:38912
    v_mfma_f32_16x16x32_bf16 a[124:127], a[208:211], a[164:167], a[124:127]
    buffer_load_dwordx4 v197, s[28:31], s74 offen lds
    v_mfma_f32_16x16x32_bf16 a[124:127], a[212:215], a[196:199], a[124:127]
    s_mov_b32 m0, 98304
    v_mfma_f32_16x16x32_bf16 a[92:95], a[204:207], a[196:199], a[92:95]
    s_cbranch_vccnz L_skh2_04
L_sbh2_04:
    v_mfma_f32_16x16x32_bf16 a[92:95], a[200:203], a[164:167], a[92:95]
    s_waitcnt lgkmcnt(4)
    v_mfma_f32_16x16x32_bf16 v[0:3], a[216:219], a[136:139], v[0:3]
    ds_read_b128 a[152:155], v200 offset:40960
    v_mfma_f32_16x16x32_bf16 v[0:3], a[220:223], a[168:171], v[0:3]
    buffer_load_dwordx4 v192, s[28:31], s74 offen lds
    v_mfma_f32_16x16x32_bf16 v[32:35], a[228:231], a[168:171], v[32:35]
    ds_read_b128 a[184:187], v201 offset:40960
    v_mfma_f32_16x16x32_bf16 v[32:35], a[224:227], a[136:139], v[32:35]
    s_mov_b32 m0, 99328
    v_mfma_f32_16x16x32_bf16 v[36:39], a[224:227], a[140:143], v[36:39]
    ds_read_b128 a[156:159], v200 offset:43008
    v_mfma_f32_16x16x32_bf16 v[36:39], a[228:231], a[172:175], v[36:39]
    buffer_load_dwordx4 v193, s[28:31], s74 offen lds
    v_mfma_f32_16x16x32_bf16 v[4:7], a[220:223], a[172:175], v[4:7]
    ds_read_b128 a[188:191], v201 offset:43008
    v_mfma_f32_16x16x32_bf16 v[4:7], a[216:219], a[140:143], v[4:7]
    s_waitcnt lgkmcnt(4)
    v_mfma_f32_16x16x32_bf16 v[8:11], a[216:219], a[144:147], v[8:11]
    s_add_u32 s74, s74, 196608
    v_mfma_f32_16x16x32_bf16 v[8:11], a[220:223], a[176:179], v[8:11]
    ds_read_b128 a[160:163], v200 offset:45056
    v_mfma_f32_16x16x32_bf16 v[40:43], a[228:231], a[176:179], v[40:43]
    ds_read_b128 a[192:195], v201 offset:45056
    v_mfma_f32_16x16x32_bf16 v[40:43], a[224:227], a[144:147], v[40:43]
    ds_read_b128 a[164:167], v200 offset:47104
    v_mfma_f32_16x16x32_bf16 v[44:47], a[224:227], a[148:151], v[44:47]
    ds_read_b128 a[196:199], v201 offset:47104
    v_mfma_f32_16x16x32_bf16 v[44:47], a[228:231], a[180:183], v[44:47]
    ds_read_b64_tr_b16 a[200:201], v204 offset:49216
    v_mfma_f32_16x16x32_bf16 v[12:15], a[220:223], a[180:183], v[12:15]
    ds_read_b64_tr_b16 a[202:203], v204 offset:52800
    v_mfma_f32_16x16x32_bf16 v[12:15], a[216:219], a[148:151], v[12:15]
    s_waitcnt lgkmcnt(6)
    v_mfma_f32_16x16x32_bf16 v[16:19], a[216:219], a[152:155], v[16:19]
    ds_read_b64_tr_b16 a[204:205], v204 offset:56384
    v_mfma_f32_16x16x32_bf16 v[16:19], a[220:223], a[184:187], v[16:19]
    ds_read_b64_tr_b16 a[206:207], v204 offset:59968
    v_mfma_f32_16x16x32_bf16 v[48:51], a[228:231], a[184:187], v[48:51]
    ds_read_b64_tr_b16 a[212:213], v204 offset:56416
    v_mfma_f32_16x16x32_bf16 v[48:51], a[224:227], a[152:155], v[48:51]
    s_cmp_lt_u32 s76, 3
    s_cselect_b32 s84, s90, 2.0
    s_bfm_b64 exec, 24, 0
    buffer_load_dword v236, v202, s[52:55], s84 offen
    s_mov_b64 exec, -1
    v_mfma_f32_16x16x32_bf16 v[52:55], a[224:227], a[156:159], v[52:55]
    ds_read_b64_tr_b16 a[214:215], v204 offset:60000
    v_mfma_f32_16x16x32_bf16 v[52:55], a[228:231], a[188:191], v[52:55]
    ds_read_b64_tr_b16 a[208:209], v204 offset:49248
    v_mfma_f32_16x16x32_bf16 v[20:23], a[220:223], a[188:191], v[20:23]
    ds_read_b64_tr_b16 a[210:211], v204 offset:52832
    v_mfma_f32_16x16x32_bf16 v[20:23], a[216:219], a[156:159], v[20:23]
    s_waitcnt lgkmcnt(8)
    v_mfma_f32_16x16x32_bf16 v[24:27], a[216:219], a[160:163], v[24:27]
    v_mfma_f32_16x16x32_bf16 v[24:27], a[220:223], a[192:195], v[24:27]
    v_mfma_f32_16x16x32_bf16 v[56:59], a[228:231], a[192:195], v[56:59]
    v_mfma_f32_16x16x32_bf16 v[56:59], a[224:227], a[160:163], v[56:59]
    v_mfma_f32_16x16x32_bf16 v[60:63], a[224:227], a[164:167], v[60:63]
    v_mfma_f32_16x16x32_bf16 v[60:63], a[228:231], a[196:199], v[60:63]
    v_mfma_f32_16x16x32_bf16 v[28:31], a[220:223], a[196:199], v[28:31]
    s_cmp_eq_u32 s76, 4
    s_cselect_b32 s93, s92, 2.0
    buffer_load_dwordx4 v[232:235], v238, s[24:27], s93 offen offset:0
    v_mfma_f32_16x16x32_bf16 v[28:31], a[216:219], a[164:167], v[28:31]
    s_waitcnt lgkmcnt(0)
    v_mfma_f32_16x16x32_bf16 v[92:95], a[200:203], a[164:167], v[92:95]
    ds_read_b64_tr_b16 a[216:217], v205 offset:49152
    v_mfma_f32_16x16x32_bf16 v[92:95], a[204:207], a[196:199], v[92:95]
    v_mfma_f32_16x16x32_bf16 v[124:127], a[212:215], a[196:199], v[124:127]
    ds_read_b64_tr_b16 a[218:219], v205 offset:52736
    v_mfma_f32_16x16x32_bf16 v[124:127], a[208:211], a[164:167], v[124:127]
    buffer_load_dwordx4 v[240:243], v238, s[24:27], s93 offen offset:512
    v_mfma_f32_16x16x32_bf16 v[120:123], a[208:211], a[160:163], v[120:123]
    ds_read_b64_tr_b16 a[220:221], v205 offset:56320
    v_mfma_f32_16x16x32_bf16 v[120:123], a[212:215], a[192:195], v[120:123]
    v_mfma_f32_16x16x32_bf16 v[88:91], a[204:207], a[192:195], v[88:91]
    ds_read_b64_tr_b16 a[222:223], v205 offset:59904
    v_mfma_f32_16x16x32_bf16 v[88:91], a[200:203], a[160:163], v[88:91]
    buffer_load_dwordx4 v[244:247], v238, s[24:27], s93 offen offset:1024
    v_mfma_f32_16x16x32_bf16 v[84:87], a[200:203], a[156:159], v[84:87]
    v_mfma_f32_16x16x32_bf16 v[84:87], a[204:207], a[188:191], v[84:87]
    v_mfma_f32_16x16x32_bf16 v[116:119], a[212:215], a[188:191], v[116:119]
    buffer_load_dwordx4 v[248:251], v238, s[24:27], s93 offen offset:1536
    v_mfma_f32_16x16x32_bf16 v[116:119], a[208:211], a[156:159], v[116:119]
    v_mfma_f32_16x16x32_bf16 v[112:115], a[208:211], a[152:155], v[112:115]
    v_mfma_f32_16x16x32_bf16 v[112:115], a[212:215], a[184:187], v[112:115]
    v_mfma_f32_16x16x32_bf16 v[80:83], a[204:207], a[184:187], v[80:83]
    v_mfma_f32_16x16x32_bf16 v[80:83], a[200:203], a[152:155], v[80:83]
    s_branch L_g1_loop2
L_w3:
    s_mov_b64 s[24:25], s[4:5]
    s_mov_b32 s60, s20
    s_mov_b32 s61, s21
    s_mov_b32 s62, 256
    s_mov_b32 s63, 0x20000
    s_cmp_lg_u32 s2, 0
    s_cbranch_scc1 L_nonon
    s_or_b32 s96, s96, 1
    v_mov_b32 v208, s96
    s_mov_b64 exec, 1
    buffer_store_dword v208, off, s[60:63], 0 sc1
    s_mov_b64 exec, -1
L_nonon:
    s_mov_b64 s[0:1], s[82:83]
    v_mov_b32 v202, v213
    s_add_u32 s73, s72, 294912
    s_add_u32 s72, s72, 262272
    s_mov_b32 m0, 18432
    s_nop 0
    buffer_load_dwordx4 v198, s[24:27], s73 offen lds
    s_mov_b32 m0, 19456
    s_nop 0
    buffer_load_dwordx4 v199, s[24:27], s73 offen lds
    s_add_u32 s73, s73, 32768
    s_mov_b32 m0, 20480
    s_nop 0
    buffer_load_dwordx4 v198, s[24:27], s73 offen lds
    s_mov_b32 m0, 21504
    s_nop 0
    buffer_load_dwordx4 v199, s[24:27], s73 offen lds
    s_add_u32 s73, s73, 32768
    s_mov_b32 m0, 22528
    s_nop 0
    buffer_load_dwordx4 v198, s[24:27], s73 offen lds
    s_mov_b32 m0, 23552
    s_nop 0
    buffer_load_dwordx4 v199, s[24:27], s73 offen lds
    s_add_u32 s73, s73, 32768
    s_mov_b32 m0, 24576
    s_nop 0
    buffer_load_dwordx4 v198, s[24:27], s73 offen lds
    s_mov_b32 m0, 25600
    s_nop 0
    buffer_load_dwordx4 v199, s[24:27], s73 offen lds
    s_add_u32 s73, s73, 32768
    s_mov_b32 m0, 26624
    s_nop 0
    buffer_load_dwordx4 v198, s[24:27], s73 offen lds
    s_mov_b32 m0, 27648
    s_nop 0
    buffer_load_dwordx4 v199, s[24:27], s73 offen lds
    s_add_u32 s73, s73, 32768
    s_mov_b32 m0, 28672
    s_nop 0
    buffer_load_dwordx4 v198, s[24:27], s73 offen lds
    s_mov_b32 m0, 29696
    s_nop 0
    buffer_load_dwordx4 v199, s[24:27], s73 offen lds
    s_add_u32 s73, s73, 32768
    s_mov_b32 m0, 30720
    s_nop 0
    buffer_load_dwordx4 v198, s[24:27], s73 offen lds
    s_mov_b32 m0, 31744
    s_nop 0
    buffer_load_dwordx4 v199, s[24:27], s73 offen lds
    s_add_u32 s73, s73, 4294770816
    s_add_u32 s44, s22, 100663296
    s_addc_u32 s45, s23, 0
    s_mov_b32 s46, 2822144
    s_mov_b32 s47, 0x20000
    s_add_u32 s40, s22, 4194304
    s_addc_u32 s41, s23, 0
    s_mov_b32 s42, 18874368
    s_mov_b32 s43, 0x20000
    s_lshl_b32 s79, s65, 3
    s_add_u32 s79, s79, s67
    s_lshl_b32 s77, s65, 2
    s_add_u32 s77, s77, s66
    s_lshl_b32 s77, s77, 10
    v_lshlrev_b32 v192, 7, v214
    s_mov_b32 s73, 2.0
    s_lshl_b32 s74, s2, 13
    s_mov_b32 s75, 7340032
    s_mul_i32 s94, s2, 28672
    s_sub_u32 s94, s94, 14336
    v_lshrrev_b32 v208, 4, v214
    v_bfe_u32 v209, v214, 3, 1
    v_xor_b32 v209, v209, v214
    v_xor_b32 v209, v209, v208
    v_and_b32 v209, 7, v209
    v_lshlrev_b32 v209, 4, v209
    v_and_b32 v210, 15, v214
    v_lshl_add_u32 v209, v210, 7, v209
    v_add_u32 v200, 16384, v209
    v_xor_b32 v201, 64, v200
    v_bfe_u32 v209, v214, 2, 2
    v_lshl_add_u32 v209, v208, 2, v209
    v_and_b32 v210, 3, v214
    v_lshlrev_b32 v210, 3, v210
    v_mul_u32_u24 v211, 224, v209
    v_add_u32 v211, v211, v210
    s_lshl_b32 s84, s71, 5
    s_sub_u32 s84, 84032, s84
    v_add_u32 v204, s84, v211
    s_mul_i32 s84, s71, 192
    s_sub_u32 s84, 84160, s84
    v_add_u32 v205, s84, v211
    v_mov_b32 v228, 0x3f803f80
    v_mov_b32 v229, 0x3f803f80
    v_mov_b32 v230, 0x3f803f80
    v_mov_b32 v231, 0x3f803f80
    s_lshl_b32 s88, s65, 5
    s_add_u32 s88, s88, s68
    s_lshl_b32 s88, s88, 2
    s_add_u32 s88, s88, 3
    s_lshl_b32 s92, s88, 12
    v_lshrrev_b32 v252, 5, v214
    v_and_b32 v238, 0x1f0, v254
    v_lshl_add_u32 v238, v252, 11, v238
    v_lshlrev_b32 v207, 3, v252
    v_and_b32 v252, 31, v214
    v_cmp_eq_u32 vcc, 0, v252
    s_nop 1
    v_cndmask_b32 v207, 2.0, v207, vcc
    s_lshl_b32 s88, s88, 4
    s_add_u32 s88, s88, 32768
    s_add_u32 s80, s80, 1
    s_cmp_eq_u32 s65, 0
    s_cselect_b32 s80, 0, s80
    s_sub_u32 s82, s80, 1
    s_cmp_lt_u32 s65, 4
    s_cselect_b32 s81, 63, 1
    s_mov_b32 s83, 3
    s_mov_b32 s76, 0
    s_mov_b32 s56, s18
    s_mov_b32 s57, s19
    s_mov_b32 s58, 4194304
    s_mov_b32 s59, 0x20000
    s_mov_b32 s48, s16
    s_mov_b32 s49, s17
    s_mov_b32 s50, 7340032
    s_mov_b32 s51, 0x20000
    v_lshrrev_b32 v213, 4, v254
    v_and_b32 v211, 15, v213
    v_lshrrev_b32 v212, 4, v213
    v_subrev_u32 v208, 2, v213
    v_subrev_u32 v209, 16, v213
    v_cmp_le_u32 vcc, 18, v213
    s_nop 1
    v_cndmask_b32 v208, v208, v209, vcc
    v_cndmask_b32 v209, 0, 2, vcc
    v_lshrrev_b32 v208, 1, v208
    v_and_b32 v210, 1, v213
    v_add_u32 v209, v209, v210
    v_subrev_u32 v210, 17, v213
    v_cmp_le_u32 vcc, 18, v213
    s_nop 1
    v_cndmask_b32 v208, v208, v210, vcc
    v_cndmask_b32 v209, v209, 2, vcc
    v_cmp_le_u32 vcc, 25, v213
    s_nop 1
    v_cndmask_b32 v208, v208, v213, vcc
    v_cndmask_b32 v209, v209, 3, vcc
    v_cmp_gt_u32 vcc, 4, v213
    s_nop 1
    v_cndmask_b32 v208, v208, 0, vcc
    v_cndmask_b32 v209, v209, v213, vcc
    v_add_u32 v208, s67, v208
    v_and_b32 v208, 7, v208
    v_and_b32 v210, 1, v208
    v_lshl_add_u32 v209, v210, 2, v209
    v_lshlrev_b32 v209, 2, v209
    s_mov_b32 s84, 0x86750312
    v_lshrrev_b32 v209, v209, s84
    v_and_b32 v209, 15, v209
    v_lshrrev_b32 v208, 1, v208
    v_and_b32 v210, 3, v213
    v_cmp_le_u32 vcc, 32, v213
    s_nop 1
    v_cndmask_b32 v208, v208, v210, vcc
    v_cndmask_b32 v209, v209, 4, vcc
    s_lshl_b32 s84, s66, 2
    v_add_u32 v208, s84, v208
    v_mad_u32_u24 v246, v208, 9, v209
    v_lshlrev_b32 v246, 10, v246
    v_mul_u32_u24 v247, 224, v208
    v_lshl_add_u32 v247, v209, 5, v247
    v_subrev_u32 v247, 32, v247
    v_lshlrev_b32 v247, 11, v247
    v_lshrrev_b32 v210, 3, v209
    v_lshl_add_u32 v210, v208, 1, v210
    v_lshlrev_b32 v210, 16, v210
    v_and_b32 v209, 7, v209
    v_cmp_eq_u32 vcc, 0, v209
    s_nop 1
    v_cndmask_b32 v247, v247, v210, vcc
    s_sub_u32 s84, s69, s70
    s_mul_i32 s84, s84, 24576
    v_add_u32 v210, s84, v247
    v_cmp_le_u32 vcc, 32, v213
    s_nop 1
    v_cndmask_b32 v247, v247, v210, vcc
    v_accvgpr_write_b32 a240, v246
    v_accvgpr_write_b32 a237, v247
    s_lshl_b32 s85, s70, 2
    s_add_u32 s85, s85, s69
    s_lshl_b32 s84, s85, 2
    v_add_u32 v208, s84, v212
    v_lshrrev_b32 v209, 1, v213
    v_xor_b32 v209, v209, v208
    v_and_b32 v209, 7, v209
    v_and_b32 v210, 1, v213
    v_lshlrev_b32 v210, 4, v210
    v_lshl_add_u32 v244, v209, 5, v210
    v_lshl_add_u32 v244, v208, 11, v244
    s_lshl_b32 s84, s67, 8
    v_add_u32 v244, s84, v244
    v_add_u32 v245, 16384, v244
    v_accvgpr_write_b32 a238, v244
    v_accvgpr_write_b32 a239, v245
    s_lshl_b32 s3, s85, 10
    v_and_b32 v208, 1, v212
    v_lshrrev_b32 v209, 1, v212
    v_mul_u32_u24 v210, 147456, v208
    v_lshl_add_u32 v210, v209, 9, v210
    v_lshl_add_u32 v210, v211, 4, v210
    s_mul_i32 s85, s71, 2816
    s_sub_u32 s85, 3072, s85
    v_add_u32 v210, s85, v210
    v_accvgpr_write_b32 a250, v210
    s_lshl_b32 s84, s69, 13
    v_add_u32 v208, s84, v254
    v_accvgpr_write_b32 a251, v208
    s_lshl_b32 s84, s65, 1
    s_add_u32 s84, s84, s69
    s_mul_i32 s84, s84, 1179648
    s_lshr_b32 s85, s67, 1
    s_mul_i32 s85, s85, 9
    s_mul_i32 s86, s66, 36
    s_add_u32 s85, s85, s86
    s_lshl_b32 s85, s85, 10
    s_add_u32 s84, s84, s85
    s_mul_i32 s85, s71, 3072
    s_add_u32 s85, s85, 1024
    s_add_u32 s7, s85, s84
    s_lshl_b32 s84, s65, 2
    s_add_u32 s84, s84, s64
    s_mul_i32 s84, s84, 589824
    v_add_u32 v208, s84, v254
    v_accvgpr_write_b32 a244, v208
    v_add_u32 v209, 147456, v208
    v_accvgpr_write_b32 a245, v209
    v_add_u32 v209, 294912, v208
    v_accvgpr_write_b32 a246, v209
    v_add_u32 v209, 442368, v208
    v_accvgpr_write_b32 a247, v209
    s_lshl_b32 s84, s64, 12
    v_add_u32 v208, s84, v254
    v_accvgpr_write_b32 a241, v208
    v_bfe_u32 v209, v213, 2, 2
    v_lshl_add_u32 v209, v212, 2, v209
    v_and_b32 v210, 3, v213
    v_lshlrev_b32 v210, 3, v210
    v_lshl_add_u32 v210, v209, 8, v210
    v_add_u32 v210, 81920, v210
    v_and_b32 v209, 7, v209
    v_lshl_add_u32 v210, v209, 5, v210
    s_lshl_b32 s84, s66, 6
    s_add_u32 s85, s84, 64
    s_and_b32 s85, s85, 0xc0
    v_xor_b32 v208, s84, v210
    v_accvgpr_write_b32 a242, v208
    v_xor_b32 v208, 32, v208
    v_accvgpr_write_b32 a243, v208
    v_xor_b32 v208, s85, v210
    v_accvgpr_write_b32 a248, v208
    v_xor_b32 v208, 32, v208
    v_accvgpr_write_b32 a249, v208
    s_lshl_b32 s10, s67, 2
    s_lshl_b32 s11, 15, s10
    s_add_u32 s10, s10, s64
    s_lshl_b32 s10, s10, 2
    s_add_u32 s10, s10, s77
    v_lshrrev_b32 v208, 1, v213
    v_lshlrev_b32 v208, 11, v208
    v_and_b32 v209, 1, v213
    v_lshl_add_u32 v208, v209, 7, v208
    s_lshl_b32 s84, s67, 8
    v_add_u32 v208, s84, v208
    v_accvgpr_write_b32 a252, v208
    s_and_b32 s13, s65, 3
    s_lshl_b32 s84, s64, 2
    s_add_u32 s13, s13, s84
    s_add_u32 s13, s13, 6
    s_lshl_b32 s4, s65, 2
    s_add_u32 s4, s4, s64
    s_lshl_b32 s4, s4, 9
    s_add_u32 s4, s4, 32768
    s_lshl_b32 s5, s65, 11
    s_sub_u32 s5, s5, 128
    s_max_i32 s5, s5, 0
    s_add_u32 s5, s5, 32768
    s_mul_i32 s6, s68, 20480
    s_mul_i32 s84, s64, 640
    s_add_u32 s6, s6, s84
    s_add_u32 s6, s6, 65536
    s_lshl_b32 s12, s68, 4
    s_add_u32 s12, s12, s65
    s_lshl_b32 s12, s12, 12
    s_add_u32 s12, s12, 729088
    s_lshl_b32 s84, s64, 10
    s_add_u32 s84, s84, 154880
    v_add_u32 v208, s84, v254
    v_accvgpr_write_b32 a232, v208
    s_lshl_b32 s84, s64, 8
    s_add_u32 s84, s84, 159040
    v_lshl_add_u32 v208, v213, 2, s84
    v_accvgpr_write_b32 a233, v208
    s_mov_b32 s84, 154624
    v_lshl_add_u32 v208, v211, 4, s84
    v_accvgpr_write_b32 a234, v208
    s_mov_b32 s84, 158976
    v_lshl_add_u32 v208, v211, 2, s84
    v_accvgpr_write_b32 a235, v208
    s_mul_i32 s84, s64, 320
    s_add_u32 s84, s84, 161344
    v_min_u32 v208, 39, v213
    v_lshl_add_u32 v208, v208, 3, s84
    v_accvgpr_write_b32 a236, v208
    s_cmp_eq_u32 s80, 0
    s_cselect_b64 vcc, -1, 0
    s_waitcnt vmcnt(0)
    s_barrier
    ds_read_b64_tr_b16 a[200:201], v204 offset:34816
    ds_read_b64_tr_b16 a[202:203], v204 offset:38400
    ds_read_b128 a[136:139], v200 offset:0
    ds_read_b64_tr_b16 a[204:205], v204 offset:41984
    ds_read_b64_tr_b16 a[206:207], v204 offset:45568
    ds_read_b128 a[168:171], v201 offset:0
    ds_read_b64_tr_b16 a[212:213], v204 offset:42016
    ds_read_b64_tr_b16 a[214:215], v204 offset:45600
    ds_read_b64_tr_b16 a[208:209], v204 offset:34848
    ds_read_b64_tr_b16 a[210:211], v204 offset:38432
    ds_read_b128 a[140:143], v200 offset:2048
    ds_read_b128 a[172:175], v201 offset:2048
    ds_read_b128 a[144:147], v200 offset:4096
    ds_read_b128 a[176:179], v201 offset:4096
    ds_read_b128 a[148:151], v200 offset:6144
    ds_read_b128 a[180:183], v201 offset:6144
    ds_read_b128 a[152:155], v200 offset:8192
    ds_read_b128 a[184:187], v201 offset:8192
    ds_read_b128 a[156:159], v200 offset:10240
    ds_read_b128 a[188:191], v201 offset:10240
    ds_read_b128 a[160:163], v200 offset:12288
    ds_read_b128 a[192:195], v201 offset:12288
    ds_read_b128 a[164:167], v200 offset:14336
    ds_read_b128 a[196:199], v201 offset:14336
    s_add_u32 s84, s90, 256
    buffer_load_dword v236, v202, s[52:55], s84 offen
    s_waitcnt lgkmcnt(15)
    v_mfma_f32_16x16x32_bf16 v[0:3], a[200:203], a[136:139], 0
    s_mov_b32 m0, 49152
    ds_read_b64_tr_b16 a[216:217], v204 offset:34880
    v_mfma_f32_16x16x32_bf16 v[0:3], a[204:207], a[168:171], v[0:3]
    buffer_load_dwordx4 v198, s[24:27], s72 offen lds
    ds_read_b64_tr_b16 a[218:219], v204 offset:38464
    v_mfma_f32_16x16x32_bf16 v[32:35], a[212:215], a[168:171], 0
    s_mov_b32 m0, 50176
    ds_read_b64_tr_b16 a[220:221], v204 offset:42048
    s_waitcnt lgkmcnt(15)
    v_mfma_f32_16x16x32_bf16 v[32:35], a[208:211], a[136:139], v[32:35]
    buffer_load_dwordx4 v199, s[24:27], s72 offen lds
    ds_read_b64_tr_b16 a[222:223], v204 offset:45632
    v_mfma_f32_16x16x32_bf16 v[36:39], a[208:211], a[140:143], 0
    s_add_u32 s72, s72, 32768
    ds_read_b64_tr_b16 a[228:229], v204 offset:42080
    v_mfma_f32_16x16x32_bf16 v[36:39], a[212:215], a[172:175], v[36:39]
    s_mov_b32 m0, 51200
    ds_read_b64_tr_b16 a[230:231], v204 offset:45664
    v_mfma_f32_16x16x32_bf16 v[4:7], a[204:207], a[172:175], 0
    buffer_load_dwordx4 v198, s[24:27], s72 offen lds
    ds_read_b64_tr_b16 a[224:225], v204 offset:34912
    v_mfma_f32_16x16x32_bf16 v[4:7], a[200:203], a[140:143], v[4:7]
    s_waitcnt lgkmcnt(15)
    v_mfma_f32_16x16x32_bf16 v[8:11], a[200:203], a[144:147], 0
    s_mov_b32 m0, 52224
    ds_read_b64_tr_b16 a[226:227], v204 offset:38496
    v_mfma_f32_16x16x32_bf16 v[8:11], a[204:207], a[176:179], v[8:11]
    buffer_load_dwordx4 v199, s[24:27], s72 offen lds
    v_mfma_f32_16x16x32_bf16 v[40:43], a[212:215], a[176:179], 0
    s_add_u32 s72, s72, 32768
    v_mfma_f32_16x16x32_bf16 v[40:43], a[208:211], a[144:147], v[40:43]
    s_mov_b32 m0, 53248
    v_mfma_f32_16x16x32_bf16 v[44:47], a[208:211], a[148:151], 0
    buffer_load_dwordx4 v198, s[24:27], s72 offen lds
    v_mfma_f32_16x16x32_bf16 v[44:47], a[212:215], a[180:183], v[44:47]
    s_mov_b32 m0, 54272
    v_mfma_f32_16x16x32_bf16 v[12:15], a[204:207], a[180:183], 0
    buffer_load_dwordx4 v199, s[24:27], s72 offen lds
    v_mfma_f32_16x16x32_bf16 v[12:15], a[200:203], a[148:151], v[12:15]
    s_waitcnt lgkmcnt(12)
    v_mfma_f32_16x16x32_bf16 v[16:19], a[200:203], a[152:155], 0
    s_add_u32 s72, s72, 32768
    v_mfma_f32_16x16x32_bf16 v[16:19], a[204:207], a[184:187], v[16:19]
    s_mov_b32 m0, 55296
    v_mfma_f32_16x16x32_bf16 v[48:51], a[212:215], a[184:187], 0
    buffer_load_dwordx4 v198, s[24:27], s72 offen lds
    v_mfma_f32_16x16x32_bf16 v[48:51], a[208:211], a[152:155], v[48:51]
    s_mov_b32 m0, 56320
    v_mfma_f32_16x16x32_bf16 v[52:55], a[208:211], a[156:159], 0
    buffer_load_dwordx4 v199, s[24:27], s72 offen lds
    v_mfma_f32_16x16x32_bf16 v[52:55], a[212:215], a[188:191], v[52:55]
    s_add_u32 s72, s72, 32768
    v_mfma_f32_16x16x32_bf16 v[20:23], a[204:207], a[188:191], 0
    s_mov_b32 m0, 57344
    v_mfma_f32_16x16x32_bf16 v[20:23], a[200:203], a[156:159], v[20:23]
    s_waitcnt lgkmcnt(8)
    v_mfma_f32_16x16x32_bf16 v[24:27], a[200:203], a[160:163], 0
    buffer_load_dwordx4 v198, s[24:27], s72 offen lds
    v_mfma_f32_16x16x32_bf16 v[24:27], a[204:207], a[192:195], v[24:27]
    s_mov_b32 m0, 58368
    v_mfma_f32_16x16x32_bf16 v[56:59], a[212:215], a[192:195], 0
    buffer_load_dwordx4 v199, s[24:27], s72 offen lds
    v_mfma_f32_16x16x32_bf16 v[56:59], a[208:211], a[160:163], v[56:59]
    s_add_u32 s72, s72, 32768
    v_mfma_f32_16x16x32_bf16 v[60:63], a[208:211], a[164:167], 0
    s_mov_b32 m0, 59392
    v_mfma_f32_16x16x32_bf16 v[60:63], a[212:215], a[196:199], v[60:63]
    buffer_load_dwordx4 v198, s[24:27], s72 offen lds
    v_mfma_f32_16x16x32_bf16 v[28:31], a[204:207], a[196:199], 0
    s_cbranch_vccnz L_skp3_00
L_sbp3_00:
    v_mfma_f32_16x16x32_bf16 v[28:31], a[200:203], a[164:167], v[28:31]
    s_waitcnt lgkmcnt(0)
    v_mfma_f32_16x16x32_bf16 v[92:95], a[216:219], a[164:167], 0
    s_mov_b32 m0, 60416
    ds_read_b64_tr_b16 a[200:201], v205 offset:34816
    v_mfma_f32_16x16x32_bf16 v[92:95], a[220:223], a[196:199], v[92:95]
    buffer_load_dwordx4 v199, s[24:27], s72 offen lds
    ds_read_b64_tr_b16 a[202:203], v205 offset:38400
    v_mfma_f32_16x16x32_bf16 v[124:127], a[228:231], a[196:199], 0
    s_add_u32 s72, s72, 32768
    v_mfma_f32_16x16x32_bf16 v[124:127], a[224:227], a[164:167], v[124:127]
    s_mov_b32 m0, 61440
    v_mfma_f32_16x16x32_bf16 v[120:123], a[224:227], a[160:163], 0
    buffer_load_dwordx4 v198, s[24:27], s72 offen lds
    v_mfma_f32_16x16x32_bf16 v[120:123], a[228:231], a[192:195], v[120:123]
    s_mov_b32 m0, 62464
    v_mfma_f32_16x16x32_bf16 v[88:91], a[220:223], a[192:195], 0
    buffer_load_dwordx4 v199, s[24:27], s72 offen lds
    v_mfma_f32_16x16x32_bf16 v[88:91], a[216:219], a[160:163], v[88:91]
    ds_read_b64_tr_b16 a[204:205], v205 offset:41984
    v_mfma_f32_16x16x32_bf16 v[84:87], a[216:219], a[156:159], 0
    s_add_u32 s72, s72, 32768
    v_mfma_f32_16x16x32_bf16 v[84:87], a[220:223], a[188:191], v[84:87]
    s_mov_b32 m0, 63488
    v_mfma_f32_16x16x32_bf16 v[116:119], a[228:231], a[188:191], 0
    ds_read_b64_tr_b16 a[206:207], v205 offset:45568
    v_mfma_f32_16x16x32_bf16 v[116:119], a[224:227], a[156:159], v[116:119]
    buffer_load_dwordx4 v198, s[24:27], s72 offen lds
    v_mfma_f32_16x16x32_bf16 v[112:115], a[224:227], a[152:155], 0
    s_mov_b32 m0, 64512
    v_mfma_f32_16x16x32_bf16 v[112:115], a[228:231], a[184:187], v[112:115]
    buffer_load_dwordx4 v199, s[24:27], s72 offen lds
    v_mfma_f32_16x16x32_bf16 v[80:83], a[220:223], a[184:187], 0
    s_add_u32 s72, s72, 4294738048
    v_mfma_f32_16x16x32_bf16 v[80:83], a[216:219], a[152:155], v[80:83]
    buffer_load_dword v239, off, s[60:63], 0 sc1
    s_waitcnt lgkmcnt(0)
    s_barrier
    v_mfma_f32_16x16x32_bf16 v[76:79], a[216:219], a[148:151], 0
    ds_read_b64_tr_b16 a[212:213], v204 offset:27648
    v_mfma_f32_16x16x32_bf16 v[76:79], a[220:223], a[180:183], v[76:79]
    v_mfma_f32_16x16x32_bf16 v[108:111], a[228:231], a[180:183], 0
    ds_read_b64_tr_b16 a[214:215], v204 offset:31232
    v_mfma_f32_16x16x32_bf16 v[108:111], a[224:227], a[148:151], v[108:111]
    ds_read_b64_tr_b16 a[208:209], v204 offset:20480
    v_mfma_f32_16x16x32_bf16 v[104:107], a[224:227], a[144:147], 0
    ds_read_b64_tr_b16 a[210:211], v204 offset:24064
    v_mfma_f32_16x16x32_bf16 v[104:107], a[228:231], a[176:179], v[104:107]
    v_mfma_f32_16x16x32_bf16 v[72:75], a[220:223], a[176:179], 0
    v_mfma_f32_16x16x32_bf16 v[72:75], a[216:219], a[144:147], v[72:75]
    v_mfma_f32_16x16x32_bf16 v[68:71], a[216:219], a[140:143], 0
    s_mov_b32 m0, 16384
    v_mfma_f32_16x16x32_bf16 v[68:71], a[220:223], a[172:175], v[68:71]
    v_mfma_f32_16x16x32_bf16 v[100:103], a[228:231], a[172:175], 0
    v_mfma_f32_16x16x32_bf16 v[100:103], a[224:227], a[140:143], v[100:103]
    v_mfma_f32_16x16x32_bf16 v[96:99], a[224:227], a[136:139], 0
    buffer_load_dwordx4 v198, s[24:27], s72 offen lds
    v_mfma_f32_16x16x32_bf16 v[96:99], a[228:231], a[168:171], v[96:99]
    v_mfma_f32_16x16x32_bf16 v[64:67], a[220:223], a[168:171], 0
    v_mfma_f32_16x16x32_bf16 v[64:67], a[216:219], a[136:139], v[64:67]
    v_mfma_f32_16x16x32_bf16 v[128:131], a[200:203], a[136:139], 0
    s_mov_b32 m0, 17408
    v_mfma_f32_16x16x32_bf16 v[128:131], a[204:207], a[168:171], v[128:131]
    s_waitcnt lgkmcnt(0)
    v_mfma_f32_16x16x32_bf16 v[160:163], a[212:215], a[168:171], 0
    ds_read_b64_tr_b16 a[216:217], v204 offset:20512
    v_mfma_f32_16x16x32_bf16 v[160:163], a[208:211], a[136:139], v[160:163]
    buffer_load_dwordx4 v199, s[24:27], s72 offen lds
    v_mfma_f32_16x16x32_bf16 v[164:167], a[208:211], a[140:143], 0
    ds_read_b64_tr_b16 a[218:219], v204 offset:24096
    v_mfma_f32_16x16x32_bf16 v[164:167], a[212:215], a[172:175], v[164:167]
    ds_read_b64_tr_b16 a[220:221], v204 offset:27680
    v_mfma_f32_16x16x32_bf16 v[132:135], a[204:207], a[172:175], 0
    s_add_u32 s72, s72, 32768
    v_mfma_f32_16x16x32_bf16 v[132:135], a[200:203], a[140:143], v[132:135]
    ds_read_b64_tr_b16 a[222:223], v204 offset:31264
    v_mfma_f32_16x16x32_bf16 v[136:139], a[200:203], a[144:147], 0
    v_mfma_f32_16x16x32_bf16 v[136:139], a[204:207], a[176:179], v[136:139]
    s_mov_b32 m0, 18432
    v_mfma_f32_16x16x32_bf16 v[168:171], a[212:215], a[176:179], 0
    ds_read_b64_tr_b16 a[228:229], v204 offset:27712
    v_mfma_f32_16x16x32_bf16 v[168:171], a[208:211], a[144:147], v[168:171]
    v_mfma_f32_16x16x32_bf16 v[172:175], a[208:211], a[148:151], 0
    ds_read_b64_tr_b16 a[230:231], v204 offset:31296
    v_mfma_f32_16x16x32_bf16 v[172:175], a[212:215], a[180:183], v[172:175]
    buffer_load_dwordx4 v198, s[24:27], s72 offen lds
    v_mfma_f32_16x16x32_bf16 v[140:143], a[204:207], a[180:183], 0
    ds_read_b64_tr_b16 a[224:225], v204 offset:20544
    v_mfma_f32_16x16x32_bf16 v[140:143], a[200:203], a[148:151], v[140:143]
    v_mfma_f32_16x16x32_bf16 v[144:147], a[200:203], a[152:155], 0
    s_mov_b32 m0, 19456
    v_mfma_f32_16x16x32_bf16 v[144:147], a[204:207], a[184:187], v[144:147]
    ds_read_b64_tr_b16 a[226:227], v204 offset:24128
    v_mfma_f32_16x16x32_bf16 v[176:179], a[212:215], a[184:187], 0
    v_mfma_f32_16x16x32_bf16 v[176:179], a[208:211], a[152:155], v[176:179]
    buffer_load_dwordx4 v199, s[24:27], s72 offen lds
    v_mfma_f32_16x16x32_bf16 v[180:183], a[208:211], a[156:159], 0
    v_mfma_f32_16x16x32_bf16 v[180:183], a[212:215], a[188:191], v[180:183]
    v_mfma_f32_16x16x32_bf16 v[148:151], a[204:207], a[188:191], 0
    s_add_u32 s72, s72, 32768
    v_mfma_f32_16x16x32_bf16 v[148:151], a[200:203], a[156:159], v[148:151]
    v_mfma_f32_16x16x32_bf16 v[152:155], a[200:203], a[160:163], 0
    v_mfma_f32_16x16x32_bf16 v[152:155], a[204:207], a[192:195], v[152:155]
    s_mov_b32 m0, 20480
    v_mfma_f32_16x16x32_bf16 v[184:187], a[212:215], a[192:195], 0
    v_mfma_f32_16x16x32_bf16 v[184:187], a[208:211], a[160:163], v[184:187]
    v_mfma_f32_16x16x32_bf16 v[188:191], a[208:211], a[164:167], 0
    v_mfma_f32_16x16x32_bf16 v[188:191], a[212:215], a[196:199], v[188:191]
    buffer_load_dwordx4 v198, s[24:27], s72 offen lds
    v_mfma_f32_16x16x32_bf16 v[156:159], a[204:207], a[196:199], 0
    s_cbranch_vccnz L_skp3_02
L_sbp3_02:
    v_mfma_f32_16x16x32_bf16 v[156:159], a[200:203], a[164:167], v[156:159]
    s_waitcnt lgkmcnt(0)
    v_mfma_f32_16x16x32_bf16 a[28:31], a[216:219], a[164:167], 0
    s_mov_b32 m0, 21504
    v_mfma_f32_16x16x32_bf16 a[28:31], a[220:223], a[196:199], a[28:31]
    ds_read_b64_tr_b16 a[200:201], v204 offset:20576
    v_mfma_f32_16x16x32_bf16 a[60:63], a[228:231], a[196:199], 0
    v_mfma_f32_16x16x32_bf16 a[60:63], a[224:227], a[164:167], a[60:63]
    ds_read_b64_tr_b16 a[202:203], v204 offset:24160
    v_mfma_f32_16x16x32_bf16 a[56:59], a[224:227], a[160:163], 0
    buffer_load_dwordx4 v199, s[24:27], s72 offen lds
    v_mfma_f32_16x16x32_bf16 a[56:59], a[228:231], a[192:195], a[56:59]
    ds_read_b64_tr_b16 a[204:205], v204 offset:27744
    v_mfma_f32_16x16x32_bf16 a[24:27], a[220:223], a[192:195], 0
    v_mfma_f32_16x16x32_bf16 a[24:27], a[216:219], a[160:163], a[24:27]
    s_add_u32 s72, s72, 32768
    v_mfma_f32_16x16x32_bf16 a[20:23], a[216:219], a[156:159], 0
    ds_read_b64_tr_b16 a[206:207], v204 offset:31328
    v_mfma_f32_16x16x32_bf16 a[20:23], a[220:223], a[188:191], a[20:23]
    ds_read_b64_tr_b16 a[212:213], v205 offset:27648
    v_mfma_f32_16x16x32_bf16 a[52:55], a[228:231], a[188:191], 0
    s_mov_b32 m0, 22528
    v_mfma_f32_16x16x32_bf16 a[52:55], a[224:227], a[156:159], a[52:55]
    v_mfma_f32_16x16x32_bf16 a[48:51], a[224:227], a[152:155], 0
    ds_read_b64_tr_b16 a[214:215], v205 offset:31232
    v_mfma_f32_16x16x32_bf16 a[48:51], a[228:231], a[184:187], a[48:51]
    buffer_load_dwordx4 v198, s[24:27], s72 offen lds
    v_mfma_f32_16x16x32_bf16 a[16:19], a[220:223], a[184:187], 0
    ds_read_b64_tr_b16 a[208:209], v205 offset:20480
    v_mfma_f32_16x16x32_bf16 a[16:19], a[216:219], a[152:155], a[16:19]
    v_mfma_f32_16x16x32_bf16 a[12:15], a[216:219], a[148:151], 0
    ds_read_b64_tr_b16 a[210:211], v205 offset:24064
    v_mfma_f32_16x16x32_bf16 a[12:15], a[220:223], a[180:183], a[12:15]
    s_mov_b32 m0, 23552
    v_mfma_f32_16x16x32_bf16 a[44:47], a[228:231], a[180:183], 0
    v_mfma_f32_16x16x32_bf16 a[44:47], a[224:227], a[148:151], a[44:47]
    v_mfma_f32_16x16x32_bf16 a[40:43], a[224:227], a[144:147], 0
    buffer_load_dwordx4 v199, s[24:27], s72 offen lds
    v_mfma_f32_16x16x32_bf16 a[40:43], a[228:231], a[176:179], a[40:43]
    v_mfma_f32_16x16x32_bf16 a[8:11], a[220:223], a[176:179], 0
    v_mfma_f32_16x16x32_bf16 a[8:11], a[216:219], a[144:147], a[8:11]
    s_add_u32 s72, s72, 32768
    v_mfma_f32_16x16x32_bf16 a[4:7], a[216:219], a[140:143], 0
    v_mfma_f32_16x16x32_bf16 a[4:7], a[220:223], a[172:175], a[4:7]
    v_mfma_f32_16x16x32_bf16 a[36:39], a[228:231], a[172:175], 0
    v_mfma_f32_16x16x32_bf16 a[36:39], a[224:227], a[140:143], a[36:39]
    v_mfma_f32_16x16x32_bf16 a[32:35], a[224:227], a[136:139], 0
    v_mfma_f32_16x16x32_bf16 a[32:35], a[228:231], a[168:171], a[32:35]
    v_mfma_f32_16x16x32_bf16 a[0:3], a[220:223], a[168:171], 0
    v_mfma_f32_16x16x32_bf16 a[0:3], a[216:219], a[136:139], a[0:3]
    s_waitcnt vmcnt(9) lgkmcnt(0)
    s_barrier
    v_mfma_f32_16x16x32_bf16 a[64:67], a[200:203], a[136:139], 0
    ds_read_b64_tr_b16 a[216:217], v204 offset:49152
    v_mfma_f32_16x16x32_bf16 a[64:67], a[204:207], a[168:171], a[64:67]
    s_mov_b32 m0, 24576
    v_mfma_f32_16x16x32_bf16 a[96:99], a[212:215], a[168:171], 0
    ds_read_b64_tr_b16 a[218:219], v204 offset:52736
    v_mfma_f32_16x16x32_bf16 a[96:99], a[208:211], a[136:139], a[96:99]
    buffer_load_dwordx4 v198, s[24:27], s72 offen lds
    v_mfma_f32_16x16x32_bf16 a[100:103], a[208:211], a[140:143], 0
    ds_read_b64_tr_b16 a[220:221], v204 offset:56320
    v_mfma_f32_16x16x32_bf16 a[100:103], a[212:215], a[172:175], a[100:103]
    ds_read_b64_tr_b16 a[222:223], v204 offset:59904
    v_mfma_f32_16x16x32_bf16 a[68:71], a[204:207], a[172:175], 0
    s_mov_b32 m0, 25600
    v_mfma_f32_16x16x32_bf16 a[68:71], a[200:203], a[140:143], a[68:71]
    ds_read_b64_tr_b16 a[228:229], v204 offset:56352
    v_mfma_f32_16x16x32_bf16 a[72:75], a[200:203], a[144:147], 0
    buffer_load_dwordx4 v199, s[24:27], s72 offen lds
    v_mfma_f32_16x16x32_bf16 a[72:75], a[204:207], a[176:179], a[72:75]
    ds_read_b64_tr_b16 a[230:231], v204 offset:59936
    v_mfma_f32_16x16x32_bf16 a[104:107], a[212:215], a[176:179], 0
    ds_read_b64_tr_b16 a[224:225], v204 offset:49184
    v_mfma_f32_16x16x32_bf16 a[104:107], a[208:211], a[144:147], a[104:107]
    ds_read_b128 a[136:139], v200 offset:32768
    v_mfma_f32_16x16x32_bf16 a[108:111], a[208:211], a[148:151], 0
    s_add_u32 s72, s72, 32768
    v_mfma_f32_16x16x32_bf16 a[108:111], a[212:215], a[180:183], a[108:111]
    ds_read_b64_tr_b16 a[226:227], v204 offset:52768
    v_mfma_f32_16x16x32_bf16 a[76:79], a[204:207], a[180:183], 0
    s_mov_b32 m0, 26624
    v_mfma_f32_16x16x32_bf16 a[76:79], a[200:203], a[148:151], a[76:79]
    ds_read_b128 a[168:171], v201 offset:32768
    v_mfma_f32_16x16x32_bf16 a[80:83], a[200:203], a[152:155], 0
    buffer_load_dwordx4 v198, s[24:27], s72 offen lds
    v_mfma_f32_16x16x32_bf16 a[80:83], a[204:207], a[184:187], a[80:83]
    ds_read_b128 a[140:143], v200 offset:34816
    v_mfma_f32_16x16x32_bf16 a[112:115], a[212:215], a[184:187], 0
    s_mov_b32 m0, 27648
    v_mfma_f32_16x16x32_bf16 a[112:115], a[208:211], a[152:155], a[112:115]
    ds_read_b128 a[172:175], v201 offset:34816
    v_mfma_f32_16x16x32_bf16 a[116:119], a[208:211], a[156:159], 0
    buffer_load_dwordx4 v199, s[24:27], s72 offen lds
    v_mfma_f32_16x16x32_bf16 a[116:119], a[212:215], a[188:191], a[116:119]
    s_add_u32 s72, s72, 32768
    v_mfma_f32_16x16x32_bf16 a[84:87], a[204:207], a[188:191], 0
    ds_read_b128 a[144:147], v200 offset:36864
    v_mfma_f32_16x16x32_bf16 a[84:87], a[200:203], a[156:159], a[84:87]
    s_mov_b32 m0, 28672
    v_mfma_f32_16x16x32_bf16 a[88:91], a[200:203], a[160:163], 0
    ds_read_b128 a[176:179], v201 offset:36864
    v_mfma_f32_16x16x32_bf16 a[88:91], a[204:207], a[192:195], a[88:91]
    buffer_load_dwordx4 v198, s[24:27], s72 offen lds
    v_mfma_f32_16x16x32_bf16 a[120:123], a[212:215], a[192:195], 0
    ds_read_b128 a[148:151], v200 offset:38912
    v_mfma_f32_16x16x32_bf16 a[120:123], a[208:211], a[160:163], a[120:123]
    s_mov_b32 m0, 29696
    v_mfma_f32_16x16x32_bf16 a[124:127], a[208:211], a[164:167], 0
    buffer_load_dwordx4 v199, s[24:27], s72 offen lds
    v_mfma_f32_16x16x32_bf16 a[124:127], a[212:215], a[196:199], a[124:127]
    ds_read_b128 a[180:183], v201 offset:38912
    v_mfma_f32_16x16x32_bf16 a[92:95], a[204:207], a[196:199], 0
    s_cbranch_vccnz L_skp3_04
L_sbp3_04:
    v_mfma_f32_16x16x32_bf16 a[92:95], a[200:203], a[164:167], a[92:95]
    s_waitcnt lgkmcnt(4)
    v_mfma_f32_16x16x32_bf16 v[0:3], a[216:219], a[136:139], v[0:3]
    s_add_u32 s72, s72, 32768
    v_mfma_f32_16x16x32_bf16 v[0:3], a[220:223], a[168:171], v[0:3]
    ds_read_b128 a[152:155], v200 offset:40960
    v_mfma_f32_16x16x32_bf16 v[32:35], a[228:231], a[168:171], v[32:35]
    s_mov_b32 m0, 30720
    v_mfma_f32_16x16x32_bf16 v[32:35], a[224:227], a[136:139], v[32:35]
    ds_read_b128 a[184:187], v201 offset:40960
    v_mfma_f32_16x16x32_bf16 v[36:39], a[224:227], a[140:143], v[36:39]
    buffer_load_dwordx4 v198, s[24:27], s72 offen lds
    v_mfma_f32_16x16x32_bf16 v[36:39], a[228:231], a[172:175], v[36:39]
    s_mov_b32 m0, 31744
    v_mfma_f32_16x16x32_bf16 v[4:7], a[220:223], a[172:175], v[4:7]
    ds_read_b128 a[156:159], v200 offset:43008
    v_mfma_f32_16x16x32_bf16 v[4:7], a[216:219], a[140:143], v[4:7]
    s_waitcnt lgkmcnt(3)
    v_mfma_f32_16x16x32_bf16 v[8:11], a[216:219], a[144:147], v[8:11]
    buffer_load_dwordx4 v199, s[24:27], s72 offen lds
    v_mfma_f32_16x16x32_bf16 v[8:11], a[220:223], a[176:179], v[8:11]
    ds_read_b128 a[188:191], v201 offset:43008
    v_mfma_f32_16x16x32_bf16 v[40:43], a[228:231], a[176:179], v[40:43]
    s_add_u32 s72, s72, 4294738048
    v_mfma_f32_16x16x32_bf16 v[40:43], a[224:227], a[144:147], v[40:43]
    ds_read_b128 a[160:163], v200 offset:45056
    v_mfma_f32_16x16x32_bf16 v[44:47], a[224:227], a[148:151], v[44:47]
    ds_read_b128 a[192:195], v201 offset:45056
    v_mfma_f32_16x16x32_bf16 v[44:47], a[228:231], a[180:183], v[44:47]
    ds_read_b128 a[164:167], v200 offset:47104
    v_mfma_f32_16x16x32_bf16 v[12:15], a[220:223], a[180:183], v[12:15]
    ds_read_b128 a[196:199], v201 offset:47104
    v_mfma_f32_16x16x32_bf16 v[12:15], a[216:219], a[148:151], v[12:15]
    s_waitcnt lgkmcnt(4)
    v_mfma_f32_16x16x32_bf16 v[16:19], a[216:219], a[152:155], v[16:19]
    ds_read_b64_tr_b16 a[200:201], v204 offset:49216
    v_mfma_f32_16x16x32_bf16 v[16:19], a[220:223], a[184:187], v[16:19]
    ds_read_b64_tr_b16 a[202:203], v204 offset:52800
    v_mfma_f32_16x16x32_bf16 v[48:51], a[228:231], a[184:187], v[48:51]
    ds_read_b64_tr_b16 a[204:205], v204 offset:56384
    v_mfma_f32_16x16x32_bf16 v[48:51], a[224:227], a[152:155], v[48:51]
    ds_read_b64_tr_b16 a[206:207], v204 offset:59968
    v_mfma_f32_16x16x32_bf16 v[52:55], a[224:227], a[156:159], v[52:55]
    ds_read_b64_tr_b16 a[212:213], v204 offset:56416
    v_mfma_f32_16x16x32_bf16 v[52:55], a[228:231], a[188:191], v[52:55]
    s_cmp_lt_u32 s65, 4
    s_cselect_b32 s84, 2, 5
    s_mul_i32 s84, s84, 256
    s_add_u32 s90, s90, s84
    v_mfma_f32_16x16x32_bf16 v[20:23], a[220:223], a[188:191], v[20:23]
    buffer_load_dword v236, v202, s[52:55], s90 offen
    s_add_u32 s90, s90, 256
    v_mfma_f32_16x16x32_bf16 v[20:23], a[216:219], a[156:159], v[20:23]
    s_waitcnt lgkmcnt(5)
    v_mfma_f32_16x16x32_bf16 v[24:27], a[216:219], a[160:163], v[24:27]
    ds_read_b64_tr_b16 a[214:215], v204 offset:60000
    v_mfma_f32_16x16x32_bf16 v[24:27], a[220:223], a[192:195], v[24:27]
    ds_read_b64_tr_b16 a[208:209], v204 offset:49248
    v_mfma_f32_16x16x32_bf16 v[56:59], a[228:231], a[192:195], v[56:59]
    ds_read_b64_tr_b16 a[210:211], v204 offset:52832
    v_mfma_f32_16x16x32_bf16 v[56:59], a[224:227], a[160:163], v[56:59]
    v_mfma_f32_16x16x32_bf16 v[60:63], a[224:227], a[164:167], v[60:63]
    v_mfma_f32_16x16x32_bf16 v[60:63], a[228:231], a[196:199], v[60:63]
    v_mfma_f32_16x16x32_bf16 v[28:31], a[220:223], a[196:199], v[28:31]
    v_mfma_f32_16x16x32_bf16 v[28:31], a[216:219], a[164:167], v[28:31]
    s_waitcnt lgkmcnt(0)
    v_mfma_f32_16x16x32_bf16 v[92:95], a[200:203], a[164:167], v[92:95]
    ds_read_b64_tr_b16 a[216:217], v205 offset:49152
    v_mfma_f32_16x16x32_bf16 v[92:95], a[204:207], a[196:199], v[92:95]
    v_mfma_f32_16x16x32_bf16 v[124:127], a[212:215], a[196:199], v[124:127]
    ds_read_b64_tr_b16 a[218:219], v205 offset:52736
    v_mfma_f32_16x16x32_bf16 v[124:127], a[208:211], a[164:167], v[124:127]
    v_mfma_f32_16x16x32_bf16 v[120:123], a[208:211], a[160:163], v[120:123]
    ds_read_b64_tr_b16 a[220:221], v205 offset:56320
    v_mfma_f32_16x16x32_bf16 v[120:123], a[212:215], a[192:195], v[120:123]
    v_mfma_f32_16x16x32_bf16 v[88:91], a[204:207], a[192:195], v[88:91]
    ds_read_b64_tr_b16 a[222:223], v205 offset:59904
    v_mfma_f32_16x16x32_bf16 v[88:91], a[200:203], a[160:163], v[88:91]
    v_mfma_f32_16x16x32_bf16 v[84:87], a[200:203], a[156:159], v[84:87]
    v_mfma_f32_16x16x32_bf16 v[84:87], a[204:207], a[188:191], v[84:87]
    v_mfma_f32_16x16x32_bf16 v[116:119], a[212:215], a[188:191], v[116:119]
    v_mfma_f32_16x16x32_bf16 v[116:119], a[208:211], a[156:159], v[116:119]
    v_mfma_f32_16x16x32_bf16 v[112:115], a[208:211], a[152:155], v[112:115]
    v_mfma_f32_16x16x32_bf16 v[112:115], a[212:215], a[184:187], v[112:115]
    v_mfma_f32_16x16x32_bf16 v[80:83], a[204:207], a[184:187], v[80:83]
    v_mfma_f32_16x16x32_bf16 v[80:83], a[200:203], a[152:155], v[80:83]
L_g1_loop3:
    s_waitcnt lgkmcnt(0)
    s_barrier
    v_mfma_f32_16x16x32_bf16 v[76:79], a[200:203], a[148:151], v[76:79]
    ds_read_b64_tr_b16 a[228:229], v204 offset:7168
    v_mfma_f32_16x16x32_bf16 v[76:79], a[204:207], a[180:183], v[76:79]
    v_mfma_f32_16x16x32_bf16 v[108:111], a[212:215], a[180:183], v[108:111]
    ds_read_b64_tr_b16 a[230:231], v204 offset:10752
    v_mfma_f32_16x16x32_bf16 v[108:111], a[208:211], a[148:151], v[108:111]
    ds_read_b64_tr_b16 a[224:225], v204 offset:0
    v_mfma_f32_16x16x32_bf16 v[104:107], a[208:211], a[144:147], v[104:107]
    ds_read_b64_tr_b16 a[226:227], v204 offset:3584
    v_mfma_f32_16x16x32_bf16 v[104:107], a[212:215], a[176:179], v[104:107]
    v_mfma_f32_16x16x32_bf16 v[72:75], a[204:207], a[176:179], v[72:75]
    v_mfma_f32_16x16x32_bf16 v[72:75], a[200:203], a[144:147], v[72:75]
    v_mfma_f32_16x16x32_bf16 v[68:71], a[200:203], a[140:143], v[68:71]
    s_mov_b32 m0, 49152
    v_mfma_f32_16x16x32_bf16 v[68:71], a[204:207], a[172:175], v[68:71]
    v_mfma_f32_16x16x32_bf16 v[100:103], a[212:215], a[172:175], v[100:103]
    v_mfma_f32_16x16x32_bf16 v[100:103], a[208:211], a[140:143], v[100:103]
    v_mfma_f32_16x16x32_bf16 v[96:99], a[208:211], a[136:139], v[96:99]
    s_cbranch_vccnz L_skh3_11
L_sbh3_11:
    v_mfma_f32_16x16x32_bf16 v[96:99], a[212:215], a[168:171], v[96:99]
    buffer_load_dwordx4 v198, s[24:27], s72 offen lds
    v_mfma_f32_16x16x32_bf16 v[64:67], a[204:207], a[168:171], v[64:67]
    v_mfma_f32_16x16x32_bf16 v[64:67], a[200:203], a[136:139], v[64:67]
    v_mfma_f32_16x16x32_bf16 v[128:131], a[216:219], a[136:139], v[128:131]
    s_mov_b32 m0, 50176
    v_mfma_f32_16x16x32_bf16 v[128:131], a[220:223], a[168:171], v[128:131]
    s_waitcnt lgkmcnt(0)
    v_mfma_f32_16x16x32_bf16 v[160:163], a[228:231], a[168:171], v[160:163]
    ds_read_b64_tr_b16 a[200:201], v204 offset:32
    v_mfma_f32_16x16x32_bf16 v[160:163], a[224:227], a[136:139], v[160:163]
    buffer_load_dwordx4 v199, s[24:27], s72 offen lds
    v_mfma_f32_16x16x32_bf16 v[164:167], a[224:227], a[140:143], v[164:167]
    ds_read_b64_tr_b16 a[202:203], v204 offset:3616
    v_mfma_f32_16x16x32_bf16 v[164:167], a[228:231], a[172:175], v[164:167]
    ds_read_b64_tr_b16 a[204:205], v204 offset:7200
    v_mfma_f32_16x16x32_bf16 v[132:135], a[220:223], a[172:175], v[132:135]
    s_add_u32 s72, s72, 32768
    v_mfma_f32_16x16x32_bf16 v[132:135], a[216:219], a[140:143], v[132:135]
    ds_read_b64_tr_b16 a[206:207], v204 offset:10784
    v_mfma_f32_16x16x32_bf16 v[136:139], a[216:219], a[144:147], v[136:139]
    v_mfma_f32_16x16x32_bf16 v[136:139], a[220:223], a[176:179], v[136:139]
    s_mov_b32 m0, 51200
    v_mfma_f32_16x16x32_bf16 v[168:171], a[228:231], a[176:179], v[168:171]
    ds_read_b64_tr_b16 a[212:213], v204 offset:7232
    v_mfma_f32_16x16x32_bf16 v[168:171], a[224:227], a[144:147], v[168:171]
    v_mfma_f32_16x16x32_bf16 v[172:175], a[224:227], a[148:151], v[172:175]
    ds_read_b64_tr_b16 a[214:215], v204 offset:10816
    v_mfma_f32_16x16x32_bf16 v[172:175], a[228:231], a[180:183], v[172:175]
    buffer_load_dwordx4 v198, s[24:27], s72 offen lds
    v_mfma_f32_16x16x32_bf16 v[140:143], a[220:223], a[180:183], v[140:143]
    ds_read_b64_tr_b16 a[208:209], v204 offset:64
    v_mfma_f32_16x16x32_bf16 v[140:143], a[216:219], a[148:151], v[140:143]
    v_mfma_f32_16x16x32_bf16 v[144:147], a[216:219], a[152:155], v[144:147]
    s_mov_b32 m0, 52224
    v_mfma_f32_16x16x32_bf16 v[144:147], a[220:223], a[184:187], v[144:147]
    ds_read_b64_tr_b16 a[210:211], v204 offset:3648
    v_mfma_f32_16x16x32_bf16 v[176:179], a[228:231], a[184:187], v[176:179]
    v_mfma_f32_16x16x32_bf16 v[176:179], a[224:227], a[152:155], v[176:179]
    buffer_load_dwordx4 v199, s[24:27], s72 offen lds
    v_mfma_f32_16x16x32_bf16 v[180:183], a[224:227], a[156:159], v[180:183]
    v_mfma_f32_16x16x32_bf16 v[180:183], a[228:231], a[188:191], v[180:183]
    v_mfma_f32_16x16x32_bf16 v[148:151], a[220:223], a[188:191], v[148:151]
    s_add_u32 s72, s72, 32768
    v_mfma_f32_16x16x32_bf16 v[148:151], a[216:219], a[156:159], v[148:151]
    v_mfma_f32_16x16x32_bf16 v[152:155], a[216:219], a[160:163], v[152:155]
    v_mfma_f32_16x16x32_bf16 v[152:155], a[220:223], a[192:195], v[152:155]
    s_mov_b32 m0, 53248
    v_mfma_f32_16x16x32_bf16 v[184:187], a[228:231], a[192:195], v[184:187]
    v_mfma_f32_16x16x32_bf16 v[184:187], a[224:227], a[160:163], v[184:187]
    v_mfma_f32_16x16x32_bf16 v[188:191], a[224:227], a[164:167], v[188:191]
    v_mfma_f32_16x16x32_bf16 v[188:191], a[228:231], a[196:199], v[188:191]
    buffer_load_dwordx4 v198, s[24:27], s72 offen lds
    v_mfma_f32_16x16x32_bf16 v[156:159], a[220:223], a[196:199], v[156:159]
    v_mfma_f32_16x16x32_bf16 v[156:159], a[216:219], a[164:167], v[156:159]
    s_waitcnt lgkmcnt(0)
    v_mfma_f32_16x16x32_bf16 a[28:31], a[200:203], a[164:167], a[28:31]
    s_mov_b32 m0, 54272
    v_mfma_f32_16x16x32_bf16 a[28:31], a[204:207], a[196:199], a[28:31]
    ds_read_b64_tr_b16 a[216:217], v204 offset:96
    v_mfma_f32_16x16x32_bf16 a[60:63], a[212:215], a[196:199], a[60:63]
    v_mfma_f32_16x16x32_bf16 a[60:63], a[208:211], a[164:167], a[60:63]
    ds_read_b64_tr_b16 a[218:219], v204 offset:3680
    v_mfma_f32_16x16x32_bf16 a[56:59], a[208:211], a[160:163], a[56:59]
    buffer_load_dwordx4 v199, s[24:27], s72 offen lds
    v_mfma_f32_16x16x32_bf16 a[56:59], a[212:215], a[192:195], a[56:59]
    ds_read_b64_tr_b16 a[220:221], v204 offset:7264
    v_mfma_f32_16x16x32_bf16 a[24:27], a[204:207], a[192:195], a[24:27]
    v_mfma_f32_16x16x32_bf16 a[24:27], a[200:203], a[160:163], a[24:27]
    s_add_u32 s72, s72, 32768
    v_mfma_f32_16x16x32_bf16 a[20:23], a[200:203], a[156:159], a[20:23]
    ds_read_b64_tr_b16 a[222:223], v204 offset:10848
    v_mfma_f32_16x16x32_bf16 a[20:23], a[204:207], a[188:191], a[20:23]
    ds_read_b64_tr_b16 a[228:229], v205 offset:7168
    v_mfma_f32_16x16x32_bf16 a[52:55], a[212:215], a[188:191], a[52:55]
    s_mov_b32 m0, 55296
    v_mfma_f32_16x16x32_bf16 a[52:55], a[208:211], a[156:159], a[52:55]
    v_mfma_f32_16x16x32_bf16 a[48:51], a[208:211], a[152:155], a[48:51]
    ds_read_b64_tr_b16 a[230:231], v205 offset:10752
    v_mfma_f32_16x16x32_bf16 a[48:51], a[212:215], a[184:187], a[48:51]
    buffer_load_dwordx4 v198, s[24:27], s72 offen lds
    v_mfma_f32_16x16x32_bf16 a[16:19], a[204:207], a[184:187], a[16:19]
    ds_read_b64_tr_b16 a[224:225], v205 offset:0
    v_mfma_f32_16x16x32_bf16 a[16:19], a[200:203], a[152:155], a[16:19]
    v_mfma_f32_16x16x32_bf16 a[12:15], a[200:203], a[148:151], a[12:15]
    ds_read_b64_tr_b16 a[226:227], v205 offset:3584
    v_mfma_f32_16x16x32_bf16 a[12:15], a[204:207], a[180:183], a[12:15]
    s_mov_b32 m0, 56320
    v_mfma_f32_16x16x32_bf16 a[44:47], a[212:215], a[180:183], a[44:47]
    v_mfma_f32_16x16x32_bf16 a[44:47], a[208:211], a[148:151], a[44:47]
    v_mfma_f32_16x16x32_bf16 a[40:43], a[208:211], a[144:147], a[40:43]
    buffer_load_dwordx4 v199, s[24:27], s72 offen lds
    v_mfma_f32_16x16x32_bf16 a[40:43], a[212:215], a[176:179], a[40:43]
    v_mfma_f32_16x16x32_bf16 a[8:11], a[204:207], a[176:179], a[8:11]
    v_mfma_f32_16x16x32_bf16 a[8:11], a[200:203], a[144:147], a[8:11]
    s_add_u32 s72, s72, 32768
    v_mfma_f32_16x16x32_bf16 a[4:7], a[200:203], a[140:143], a[4:7]
    v_mfma_f32_16x16x32_bf16 a[4:7], a[204:207], a[172:175], a[4:7]
    v_mfma_f32_16x16x32_bf16 a[36:39], a[212:215], a[172:175], a[36:39]
    global_load_dword v236, v237, s[0:1]
    v_mfma_f32_16x16x32_bf16 a[36:39], a[208:211], a[140:143], a[36:39]
    v_mfma_f32_16x16x32_bf16 a[32:35], a[208:211], a[136:139], a[32:35]
    v_mfma_f32_16x16x32_bf16 a[32:35], a[212:215], a[168:171], a[32:35]
    v_mfma_f32_16x16x32_bf16 a[0:3], a[204:207], a[168:171], a[0:3]
    s_cbranch_vccnz L_skh3_13
L_sbh3_13:
    v_mfma_f32_16x16x32_bf16 a[0:3], a[200:203], a[136:139], a[0:3]
    s_cmp_eq_u32 s76, 4
    s_cbranch_scc1 L_hs3
L_hb3:
    s_waitcnt vmcnt(10) lgkmcnt(0)
    s_barrier
    v_mfma_f32_16x16x32_bf16 a[64:67], a[216:219], a[136:139], a[64:67]
    ds_read_b64_tr_b16 a[200:201], v204 offset:34816
    v_mfma_f32_16x16x32_bf16 a[64:67], a[220:223], a[168:171], a[64:67]
    s_mov_b32 m0, 57344
    v_mfma_f32_16x16x32_bf16 a[96:99], a[228:231], a[168:171], a[96:99]
    ds_read_b64_tr_b16 a[202:203], v204 offset:38400
    v_mfma_f32_16x16x32_bf16 a[96:99], a[224:227], a[136:139], a[96:99]
    buffer_load_dwordx4 v198, s[24:27], s72 offen lds
    v_mfma_f32_16x16x32_bf16 a[100:103], a[224:227], a[140:143], a[100:103]
    ds_read_b64_tr_b16 a[204:205], v204 offset:41984
    v_mfma_f32_16x16x32_bf16 a[100:103], a[228:231], a[172:175], a[100:103]
    ds_read_b64_tr_b16 a[206:207], v204 offset:45568
    v_mfma_f32_16x16x32_bf16 a[68:71], a[220:223], a[172:175], a[68:71]
    s_mov_b32 m0, 58368
    v_mfma_f32_16x16x32_bf16 a[68:71], a[216:219], a[140:143], a[68:71]
    ds_read_b64_tr_b16 a[212:213], v204 offset:42016
    v_mfma_f32_16x16x32_bf16 a[72:75], a[216:219], a[144:147], a[72:75]
    buffer_load_dwordx4 v199, s[24:27], s72 offen lds
    v_mfma_f32_16x16x32_bf16 a[72:75], a[220:223], a[176:179], a[72:75]
    ds_read_b64_tr_b16 a[214:215], v204 offset:45600
    v_mfma_f32_16x16x32_bf16 a[104:107], a[228:231], a[176:179], a[104:107]
    ds_read_b64_tr_b16 a[208:209], v204 offset:34848
    v_mfma_f32_16x16x32_bf16 a[104:107], a[224:227], a[144:147], a[104:107]
    ds_read_b128 a[136:139], v200 offset:0
    v_mfma_f32_16x16x32_bf16 a[108:111], a[224:227], a[148:151], a[108:111]
    s_add_u32 s72, s72, 32768
    v_mfma_f32_16x16x32_bf16 a[108:111], a[228:231], a[180:183], a[108:111]
    ds_read_b64_tr_b16 a[210:211], v204 offset:38432
    v_mfma_f32_16x16x32_bf16 a[76:79], a[220:223], a[180:183], a[76:79]
    s_mov_b32 m0, 59392
    v_mfma_f32_16x16x32_bf16 a[76:79], a[216:219], a[148:151], a[76:79]
    ds_read_b128 a[168:171], v201 offset:0
    v_mfma_f32_16x16x32_bf16 a[80:83], a[216:219], a[152:155], a[80:83]
    buffer_load_dwordx4 v198, s[24:27], s72 offen lds
    v_mfma_f32_16x16x32_bf16 a[80:83], a[220:223], a[184:187], a[80:83]
    ds_read_b128 a[140:143], v200 offset:2048
    v_mfma_f32_16x16x32_bf16 a[112:115], a[228:231], a[184:187], a[112:115]
    s_mov_b32 m0, 60416
    v_mfma_f32_16x16x32_bf16 a[112:115], a[224:227], a[152:155], a[112:115]
    ds_read_b128 a[172:175], v201 offset:2048
    v_mfma_f32_16x16x32_bf16 a[116:119], a[224:227], a[156:159], a[116:119]
    buffer_load_dwordx4 v199, s[24:27], s72 offen lds
    v_mfma_f32_16x16x32_bf16 a[116:119], a[228:231], a[188:191], a[116:119]
    s_add_u32 s72, s72, 32768
    v_mfma_f32_16x16x32_bf16 a[84:87], a[220:223], a[188:191], a[84:87]
    ds_read_b128 a[144:147], v200 offset:4096
    v_mfma_f32_16x16x32_bf16 a[84:87], a[216:219], a[156:159], a[84:87]
    s_mov_b32 m0, 61440
    v_mfma_f32_16x16x32_bf16 a[88:91], a[216:219], a[160:163], a[88:91]
    ds_read_b128 a[176:179], v201 offset:4096
    v_mfma_f32_16x16x32_bf16 a[88:91], a[220:223], a[192:195], a[88:91]
    buffer_load_dwordx4 v198, s[24:27], s72 offen lds
    v_mfma_f32_16x16x32_bf16 a[120:123], a[228:231], a[192:195], a[120:123]
    ds_read_b128 a[148:151], v200 offset:6144
    v_mfma_f32_16x16x32_bf16 a[120:123], a[224:227], a[160:163], a[120:123]
    s_mov_b32 m0, 62464
    v_mfma_f32_16x16x32_bf16 a[124:127], a[224:227], a[164:167], a[124:127]
    buffer_load_dwordx4 v199, s[24:27], s72 offen lds
    v_mfma_f32_16x16x32_bf16 a[124:127], a[228:231], a[196:199], a[124:127]
    ds_read_b128 a[180:183], v201 offset:6144
    v_mfma_f32_16x16x32_bf16 a[92:95], a[220:223], a[196:199], a[92:95]
    s_add_u32 s72, s72, 32768
    v_mfma_f32_16x16x32_bf16 a[92:95], a[216:219], a[164:167], a[92:95]
    s_waitcnt lgkmcnt(4)
    v_mfma_f32_16x16x32_bf16 v[0:3], a[200:203], a[136:139], v[0:3]
    ds_read_b128 a[152:155], v200 offset:8192
    v_mfma_f32_16x16x32_bf16 v[0:3], a[204:207], a[168:171], v[0:3]
    s_mov_b32 m0, 63488
    v_mfma_f32_16x16x32_bf16 v[32:35], a[212:215], a[168:171], v[32:35]
    ds_read_b128 a[184:187], v201 offset:8192
    v_mfma_f32_16x16x32_bf16 v[32:35], a[208:211], a[136:139], v[32:35]
    buffer_load_dwordx4 v198, s[24:27], s72 offen lds
    v_mfma_f32_16x16x32_bf16 v[36:39], a[208:211], a[140:143], v[36:39]
    s_mov_b32 m0, 64512
    v_mfma_f32_16x16x32_bf16 v[36:39], a[212:215], a[172:175], v[36:39]
    ds_read_b128 a[156:159], v200 offset:10240
    v_mfma_f32_16x16x32_bf16 v[4:7], a[204:207], a[172:175], v[4:7]
    buffer_load_dwordx4 v199, s[24:27], s72 offen lds
    v_mfma_f32_16x16x32_bf16 v[4:7], a[200:203], a[140:143], v[4:7]
    s_waitcnt lgkmcnt(3)
    v_mfma_f32_16x16x32_bf16 v[8:11], a[200:203], a[144:147], v[8:11]
    ds_read_b128 a[188:191], v201 offset:10240
    v_mfma_f32_16x16x32_bf16 v[8:11], a[204:207], a[176:179], v[8:11]
    s_add_u32 s72, s72, 4294738048
    v_mfma_f32_16x16x32_bf16 v[40:43], a[212:215], a[176:179], v[40:43]
    ds_read_b128 a[160:163], v200 offset:12288
    v_mfma_f32_16x16x32_bf16 v[40:43], a[208:211], a[144:147], v[40:43]
    ds_read_b128 a[192:195], v201 offset:12288
    v_mfma_f32_16x16x32_bf16 v[44:47], a[208:211], a[148:151], v[44:47]
    ds_read_b128 a[164:167], v200 offset:14336
    v_mfma_f32_16x16x32_bf16 v[44:47], a[212:215], a[180:183], v[44:47]
    ds_read_b128 a[196:199], v201 offset:14336
    v_mfma_f32_16x16x32_bf16 v[12:15], a[204:207], a[180:183], v[12:15]
    ds_read_b64_tr_b16 a[216:217], v204 offset:34880
    v_mfma_f32_16x16x32_bf16 v[12:15], a[200:203], a[148:151], v[12:15]
    s_waitcnt lgkmcnt(5)
    v_mfma_f32_16x16x32_bf16 v[16:19], a[200:203], a[152:155], v[16:19]
    ds_read_b64_tr_b16 a[218:219], v204 offset:38464
    v_mfma_f32_16x16x32_bf16 v[16:19], a[204:207], a[184:187], v[16:19]
    ds_read_b64_tr_b16 a[220:221], v204 offset:42048
    v_mfma_f32_16x16x32_bf16 v[48:51], a[212:215], a[184:187], v[48:51]
    ds_read_b64_tr_b16 a[222:223], v204 offset:45632
    v_mfma_f32_16x16x32_bf16 v[48:51], a[208:211], a[152:155], v[48:51]
    ds_read_b64_tr_b16 a[228:229], v204 offset:42080
    v_mfma_f32_16x16x32_bf16 v[52:55], a[208:211], a[156:159], v[52:55]
    s_cmp_lt_u32 s76, 3
    s_cselect_b32 s84, s90, 2.0
    buffer_load_dword v236, v202, s[52:55], s84 offen
    s_add_u32 s90, s90, 256
    s_bitcmp1_b32 s90, 11
    s_cselect_b32 s84, 1536, 0
    s_sub_u32 s90, s90, s84
    v_mfma_f32_16x16x32_bf16 v[52:55], a[212:215], a[188:191], v[52:55]
    ds_read_b64_tr_b16 a[230:231], v204 offset:45664
    v_mfma_f32_16x16x32_bf16 v[20:23], a[204:207], a[188:191], v[20:23]
    ds_read_b64_tr_b16 a[224:225], v204 offset:34912
    v_mfma_f32_16x16x32_bf16 v[20:23], a[200:203], a[156:159], v[20:23]
    s_waitcnt lgkmcnt(7)
    v_mfma_f32_16x16x32_bf16 v[24:27], a[200:203], a[160:163], v[24:27]
    ds_read_b64_tr_b16 a[226:227], v204 offset:38496
    v_mfma_f32_16x16x32_bf16 v[24:27], a[204:207], a[192:195], v[24:27]
    v_mfma_f32_16x16x32_bf16 v[56:59], a[212:215], a[192:195], v[56:59]
    v_mfma_f32_16x16x32_bf16 v[56:59], a[208:211], a[160:163], v[56:59]
    v_mfma_f32_16x16x32_bf16 v[60:63], a[208:211], a[164:167], v[60:63]
    v_mfma_f32_16x16x32_bf16 v[60:63], a[212:215], a[196:199], v[60:63]
    s_cmp_eq_u32 s76, s82
    s_cselect_b64 vcc, -1, 0
    v_mfma_f32_16x16x32_bf16 v[28:31], a[204:207], a[196:199], v[28:31]
    s_cbranch_vccnz L_skh3_00
L_sbh3_00:
    v_mfma_f32_16x16x32_bf16 v[28:31], a[200:203], a[164:167], v[28:31]
    s_waitcnt lgkmcnt(0)
    v_mfma_f32_16x16x32_bf16 v[92:95], a[216:219], a[164:167], v[92:95]
    ds_read_b64_tr_b16 a[200:201], v205 offset:34816
    v_mfma_f32_16x16x32_bf16 v[92:95], a[220:223], a[196:199], v[92:95]
    v_mfma_f32_16x16x32_bf16 v[124:127], a[228:231], a[196:199], v[124:127]
    ds_read_b64_tr_b16 a[202:203], v205 offset:38400
    v_mfma_f32_16x16x32_bf16 v[124:127], a[224:227], a[164:167], v[124:127]
    v_mfma_f32_16x16x32_bf16 v[120:123], a[224:227], a[160:163], v[120:123]
    ds_read_b64_tr_b16 a[204:205], v205 offset:41984
    v_mfma_f32_16x16x32_bf16 v[120:123], a[228:231], a[192:195], v[120:123]
    v_mfma_f32_16x16x32_bf16 v[88:91], a[220:223], a[192:195], v[88:91]
    ds_read_b64_tr_b16 a[206:207], v205 offset:45568
    v_mfma_f32_16x16x32_bf16 v[88:91], a[216:219], a[160:163], v[88:91]
    v_mfma_f32_16x16x32_bf16 v[84:87], a[216:219], a[156:159], v[84:87]
    v_mfma_f32_16x16x32_bf16 v[84:87], a[220:223], a[188:191], v[84:87]
    buffer_load_dword v236, v192, s[60:63], s73 offen
    v_mfma_f32_16x16x32_bf16 v[116:119], a[228:231], a[188:191], v[116:119]
    v_mfma_f32_16x16x32_bf16 v[116:119], a[224:227], a[156:159], v[116:119]
    v_mfma_f32_16x16x32_bf16 v[112:115], a[224:227], a[152:155], v[112:115]
    s_cmp_eq_u32 s76, 1
    s_cselect_b32 s60, s8, s16
    s_cselect_b32 s61, s9, s17
    s_cselect_b32 s62, 2097152, s75
    s_cselect_b32 s73, s74, s94
    s_add_u32 s94, s94, 7168
    s_cmp_eq_u32 s76, 0
    s_cselect_b32 s73, 2.0, s73
    v_mfma_f32_16x16x32_bf16 v[112:115], a[228:231], a[184:187], v[112:115]
    v_mfma_f32_16x16x32_bf16 v[80:83], a[220:223], a[184:187], v[80:83]
    v_mfma_f32_16x16x32_bf16 v[80:83], a[216:219], a[152:155], v[80:83]
    s_add_u32 s76, s76, 1
    s_cmp_eq_u32 s76, 7
    s_cbranch_scc1 L_tail2
    s_cmp_lg_u32 s76, s81
    s_cbranch_scc1 L_nw3
    s_lshl_b32 s84, s83, 8
    s_add_u32 s72, s72, s84
    s_mov_b32 s81, 4
    s_mov_b32 s83, -6
L_nw3:
    s_waitcnt lgkmcnt(0)
    s_barrier
    v_mfma_f32_16x16x32_bf16 v[76:79], a[216:219], a[148:151], v[76:79]
    ds_read_b64_tr_b16 a[212:213], v204 offset:27648
    v_mfma_f32_16x16x32_bf16 v[76:79], a[220:223], a[180:183], v[76:79]
    s_cmp_eq_u32 s76, 5
    s_cselect_b32 s84, s88, 2.0
    buffer_store_dwordx2 v[238:239], v207, s[44:47], s84 offen sc1
    v_mfma_f32_16x16x32_bf16 v[108:111], a[228:231], a[180:183], v[108:111]
    ds_read_b64_tr_b16 a[214:215], v204 offset:31232
    v_mfma_f32_16x16x32_bf16 v[108:111], a[224:227], a[148:151], v[108:111]
    ds_read_b64_tr_b16 a[208:209], v204 offset:20480
    v_mfma_f32_16x16x32_bf16 v[104:107], a[224:227], a[144:147], v[104:107]
    ds_read_b64_tr_b16 a[210:211], v204 offset:24064
    v_mfma_f32_16x16x32_bf16 v[104:107], a[228:231], a[176:179], v[104:107]
    v_mfma_f32_16x16x32_bf16 v[72:75], a[220:223], a[176:179], v[72:75]
    v_mfma_f32_16x16x32_bf16 v[72:75], a[216:219], a[144:147], v[72:75]
    v_mfma_f32_16x16x32_bf16 v[68:71], a[216:219], a[140:143], v[68:71]
    s_mov_b32 m0, 16384
    v_mfma_f32_16x16x32_bf16 v[68:71], a[220:223], a[172:175], v[68:71]
    v_mfma_f32_16x16x32_bf16 v[100:103], a[228:231], a[172:175], v[100:103]
    v_mfma_f32_16x16x32_bf16 v[100:103], a[224:227], a[140:143], v[100:103]
    v_mfma_f32_16x16x32_bf16 v[96:99], a[224:227], a[136:139], v[96:99]
    buffer_load_dwordx4 v198, s[24:27], s72 offen lds
    v_mfma_f32_16x16x32_bf16 v[96:99], a[228:231], a[168:171], v[96:99]
    v_mfma_f32_16x16x32_bf16 v[64:67], a[220:223], a[168:171], v[64:67]
    v_mfma_f32_16x16x32_bf16 v[64:67], a[216:219], a[136:139], v[64:67]
    v_mfma_f32_16x16x32_bf16 v[128:131], a[200:203], a[136:139], v[128:131]
    s_mov_b32 m0, 17408
    v_mfma_f32_16x16x32_bf16 v[128:131], a[204:207], a[168:171], v[128:131]
    s_waitcnt lgkmcnt(0)
    v_mfma_f32_16x16x32_bf16 v[160:163], a[212:215], a[168:171], v[160:163]
    ds_read_b64_tr_b16 a[216:217], v204 offset:20512
    v_mfma_f32_16x16x32_bf16 v[160:163], a[208:211], a[136:139], v[160:163]
    buffer_load_dwordx4 v199, s[24:27], s72 offen lds
    v_mfma_f32_16x16x32_bf16 v[164:167], a[208:211], a[140:143], v[164:167]
    ds_read_b64_tr_b16 a[218:219], v204 offset:24096
    v_mfma_f32_16x16x32_bf16 v[164:167], a[212:215], a[172:175], v[164:167]
    ds_read_b64_tr_b16 a[220:221], v204 offset:27680
    v_mfma_f32_16x16x32_bf16 v[132:135], a[204:207], a[172:175], v[132:135]
    s_add_u32 s72, s72, 32768
    v_mfma_f32_16x16x32_bf16 v[132:135], a[200:203], a[140:143], v[132:135]
    ds_read_b64_tr_b16 a[222:223], v204 offset:31264
    v_mfma_f32_16x16x32_bf16 v[136:139], a[200:203], a[144:147], v[136:139]
    v_mfma_f32_16x16x32_bf16 v[136:139], a[204:207], a[176:179], v[136:139]
    s_mov_b32 m0, 18432
    v_mfma_f32_16x16x32_bf16 v[168:171], a[212:215], a[176:179], v[168:171]
    ds_read_b64_tr_b16 a[228:229], v204 offset:27712
    v_mfma_f32_16x16x32_bf16 v[168:171], a[208:211], a[144:147], v[168:171]
    v_mfma_f32_16x16x32_bf16 v[172:175], a[208:211], a[148:151], v[172:175]
    ds_read_b64_tr_b16 a[230:231], v204 offset:31296
    v_mfma_f32_16x16x32_bf16 v[172:175], a[212:215], a[180:183], v[172:175]
    buffer_load_dwordx4 v198, s[24:27], s72 offen lds
    v_mfma_f32_16x16x32_bf16 v[140:143], a[204:207], a[180:183], v[140:143]
    ds_read_b64_tr_b16 a[224:225], v204 offset:20544
    v_mfma_f32_16x16x32_bf16 v[140:143], a[200:203], a[148:151], v[140:143]
    v_mfma_f32_16x16x32_bf16 v[144:147], a[200:203], a[152:155], v[144:147]
    s_mov_b32 m0, 19456
    v_mfma_f32_16x16x32_bf16 v[144:147], a[204:207], a[184:187], v[144:147]
    ds_read_b64_tr_b16 a[226:227], v204 offset:24128
    v_mfma_f32_16x16x32_bf16 v[176:179], a[212:215], a[184:187], v[176:179]
    v_mfma_f32_16x16x32_bf16 v[176:179], a[208:211], a[152:155], v[176:179]
    buffer_load_dwordx4 v199, s[24:27], s72 offen lds
    v_mfma_f32_16x16x32_bf16 v[180:183], a[208:211], a[156:159], v[180:183]
    v_mfma_f32_16x16x32_bf16 v[180:183], a[212:215], a[188:191], v[180:183]
    v_mfma_f32_16x16x32_bf16 v[148:151], a[204:207], a[188:191], v[148:151]
    s_add_u32 s72, s72, 32768
    v_mfma_f32_16x16x32_bf16 v[148:151], a[200:203], a[156:159], v[148:151]
    v_mfma_f32_16x16x32_bf16 v[152:155], a[200:203], a[160:163], v[152:155]
    v_mfma_f32_16x16x32_bf16 v[152:155], a[204:207], a[192:195], v[152:155]
    s_mov_b32 m0, 20480
    v_mfma_f32_16x16x32_bf16 v[184:187], a[212:215], a[192:195], v[184:187]
    v_mfma_f32_16x16x32_bf16 v[184:187], a[208:211], a[160:163], v[184:187]
    v_mfma_f32_16x16x32_bf16 v[188:191], a[208:211], a[164:167], v[188:191]
    v_mfma_f32_16x16x32_bf16 v[188:191], a[212:215], a[196:199], v[188:191]
    buffer_load_dwordx4 v198, s[24:27], s72 offen lds
    v_mfma_f32_16x16x32_bf16 v[156:159], a[204:207], a[196:199], v[156:159]
    s_cbranch_vccnz L_skh3_02
L_sbh3_02:
    v_mfma_f32_16x16x32_bf16 v[156:159], a[200:203], a[164:167], v[156:159]
    s_waitcnt lgkmcnt(0)
    v_mfma_f32_16x16x32_bf16 a[28:31], a[216:219], a[164:167], a[28:31]
    s_mov_b32 m0, 21504
    v_mfma_f32_16x16x32_bf16 a[28:31], a[220:223], a[196:199], a[28:31]
    ds_read_b64_tr_b16 a[200:201], v204 offset:20576
    v_mfma_f32_16x16x32_bf16 a[60:63], a[228:231], a[196:199], a[60:63]
    v_mfma_f32_16x16x32_bf16 a[60:63], a[224:227], a[164:167], a[60:63]
    ds_read_b64_tr_b16 a[202:203], v204 offset:24160
    v_mfma_f32_16x16x32_bf16 a[56:59], a[224:227], a[160:163], a[56:59]
    buffer_load_dwordx4 v199, s[24:27], s72 offen lds
    v_mfma_f32_16x16x32_bf16 a[56:59], a[228:231], a[192:195], a[56:59]
    ds_read_b64_tr_b16 a[204:205], v204 offset:27744
    v_mfma_f32_16x16x32_bf16 a[24:27], a[220:223], a[192:195], a[24:27]
    v_mfma_f32_16x16x32_bf16 a[24:27], a[216:219], a[160:163], a[24:27]
    s_add_u32 s72, s72, 32768
    v_mfma_f32_16x16x32_bf16 a[20:23], a[216:219], a[156:159], a[20:23]
    ds_read_b64_tr_b16 a[206:207], v204 offset:31328
    v_mfma_f32_16x16x32_bf16 a[20:23], a[220:223], a[188:191], a[20:23]
    ds_read_b64_tr_b16 a[212:213], v205 offset:27648
    v_mfma_f32_16x16x32_bf16 a[52:55], a[228:231], a[188:191], a[52:55]
    s_mov_b32 m0, 22528
    v_mfma_f32_16x16x32_bf16 a[52:55], a[224:227], a[156:159], a[52:55]
    v_mfma_f32_16x16x32_bf16 a[48:51], a[224:227], a[152:155], a[48:51]
    ds_read_b64_tr_b16 a[214:215], v205 offset:31232
    v_mfma_f32_16x16x32_bf16 a[48:51], a[228:231], a[184:187], a[48:51]
    buffer_load_dwordx4 v198, s[24:27], s72 offen lds
    v_mfma_f32_16x16x32_bf16 a[16:19], a[220:223], a[184:187], a[16:19]
    ds_read_b64_tr_b16 a[208:209], v205 offset:20480
    v_mfma_f32_16x16x32_bf16 a[16:19], a[216:219], a[152:155], a[16:19]
    v_mfma_f32_16x16x32_bf16 a[12:15], a[216:219], a[148:151], a[12:15]
    ds_read_b64_tr_b16 a[210:211], v205 offset:24064
    v_mfma_f32_16x16x32_bf16 a[12:15], a[220:223], a[180:183], a[12:15]
    s_mov_b32 m0, 23552
    v_mfma_f32_16x16x32_bf16 a[44:47], a[228:231], a[180:183], a[44:47]
    v_mfma_f32_16x16x32_bf16 a[44:47], a[224:227], a[148:151], a[44:47]
    v_mfma_f32_16x16x32_bf16 a[40:43], a[224:227], a[144:147], a[40:43]
    buffer_load_dwordx4 v199, s[24:27], s72 offen lds
    v_mfma_f32_16x16x32_bf16 a[40:43], a[228:231], a[176:179], a[40:43]
    v_mfma_f32_16x16x32_bf16 a[8:11], a[220:223], a[176:179], a[8:11]
    v_mfma_f32_16x16x32_bf16 a[8:11], a[216:219], a[144:147], a[8:11]
    s_add_u32 s72, s72, 32768
    v_mfma_f32_16x16x32_bf16 a[4:7], a[216:219], a[140:143], a[4:7]
    v_mfma_f32_16x16x32_bf16 a[4:7], a[220:223], a[172:175], a[4:7]
    v_mfma_f32_16x16x32_bf16 a[36:39], a[228:231], a[172:175], a[36:39]
    v_mfma_f32_16x16x32_bf16 a[36:39], a[224:227], a[140:143], a[36:39]
    v_mfma_f32_16x16x32_bf16 a[32:35], a[224:227], a[136:139], a[32:35]
    v_mfma_f32_16x16x32_bf16 a[32:35], a[228:231], a[168:171], a[32:35]
    v_mfma_f32_16x16x32_bf16 a[0:3], a[220:223], a[168:171], a[0:3]
    v_mfma_f32_16x16x32_bf16 a[0:3], a[216:219], a[136:139], a[0:3]
    s_waitcnt vmcnt(11) lgkmcnt(0)
    s_barrier
    v_mfma_f32_16x16x32_bf16 a[64:67], a[200:203], a[136:139], a[64:67]
    ds_read_b64_tr_b16 a[216:217], v204 offset:49152
    v_mfma_f32_16x16x32_bf16 a[64:67], a[204:207], a[168:171], a[64:67]
    s_mov_b32 m0, 24576
    v_mfma_f32_16x16x32_bf16 a[96:99], a[212:215], a[168:171], a[96:99]
    ds_read_b64_tr_b16 a[218:219], v204 offset:52736
    v_mfma_f32_16x16x32_bf16 a[96:99], a[208:211], a[136:139], a[96:99]
    buffer_load_dwordx4 v198, s[24:27], s72 offen lds
    v_mfma_f32_16x16x32_bf16 a[100:103], a[208:211], a[140:143], a[100:103]
    ds_read_b64_tr_b16 a[220:221], v204 offset:56320
    v_mfma_f32_16x16x32_bf16 a[100:103], a[212:215], a[172:175], a[100:103]
    ds_read_b64_tr_b16 a[222:223], v204 offset:59904
    v_mfma_f32_16x16x32_bf16 a[68:71], a[204:207], a[172:175], a[68:71]
    s_mov_b32 m0, 25600
    v_mfma_f32_16x16x32_bf16 a[68:71], a[200:203], a[140:143], a[68:71]
    ds_read_b64_tr_b16 a[228:229], v204 offset:56352
    v_mfma_f32_16x16x32_bf16 a[72:75], a[200:203], a[144:147], a[72:75]
    buffer_load_dwordx4 v199, s[24:27], s72 offen lds
    v_mfma_f32_16x16x32_bf16 a[72:75], a[204:207], a[176:179], a[72:75]
    ds_read_b64_tr_b16 a[230:231], v204 offset:59936
    v_mfma_f32_16x16x32_bf16 a[104:107], a[212:215], a[176:179], a[104:107]
    ds_read_b64_tr_b16 a[224:225], v204 offset:49184
    v_mfma_f32_16x16x32_bf16 a[104:107], a[208:211], a[144:147], a[104:107]
    ds_read_b128 a[136:139], v200 offset:32768
    v_mfma_f32_16x16x32_bf16 a[108:111], a[208:211], a[148:151], a[108:111]
    s_add_u32 s72, s72, 32768
    v_mfma_f32_16x16x32_bf16 a[108:111], a[212:215], a[180:183], a[108:111]
    ds_read_b64_tr_b16 a[226:227], v204 offset:52768
    v_mfma_f32_16x16x32_bf16 a[76:79], a[204:207], a[180:183], a[76:79]
    s_mov_b32 m0, 26624
    v_mfma_f32_16x16x32_bf16 a[76:79], a[200:203], a[148:151], a[76:79]
    ds_read_b128 a[168:171], v201 offset:32768
    v_mfma_f32_16x16x32_bf16 a[80:83], a[200:203], a[152:155], a[80:83]
    buffer_load_dwordx4 v198, s[24:27], s72 offen lds
    v_mfma_f32_16x16x32_bf16 a[80:83], a[204:207], a[184:187], a[80:83]
    ds_read_b128 a[140:143], v200 offset:34816
    v_mfma_f32_16x16x32_bf16 a[112:115], a[212:215], a[184:187], a[112:115]
    s_mov_b32 m0, 27648
    v_mfma_f32_16x16x32_bf16 a[112:115], a[208:211], a[152:155], a[112:115]
    ds_read_b128 a[172:175], v201 offset:34816
    v_mfma_f32_16x16x32_bf16 a[116:119], a[208:211], a[156:159], a[116:119]
    buffer_load_dwordx4 v199, s[24:27], s72 offen lds
    v_mfma_f32_16x16x32_bf16 a[116:119], a[212:215], a[188:191], a[116:119]
    s_add_u32 s72, s72, 32768
    v_mfma_f32_16x16x32_bf16 a[84:87], a[204:207], a[188:191], a[84:87]
    ds_read_b128 a[144:147], v200 offset:36864
    v_mfma_f32_16x16x32_bf16 a[84:87], a[200:203], a[156:159], a[84:87]
    s_mov_b32 m0, 28672
    v_mfma_f32_16x16x32_bf16 a[88:91], a[200:203], a[160:163], a[88:91]
    ds_read_b128 a[176:179], v201 offset:36864
    v_mfma_f32_16x16x32_bf16 a[88:91], a[204:207], a[192:195], a[88:91]
    buffer_load_dwordx4 v198, s[24:27], s72 offen lds
    v_mfma_f32_16x16x32_bf16 a[120:123], a[212:215], a[192:195], a[120:123]
    ds_read_b128 a[148:151], v200 offset:38912
    v_mfma_f32_16x16x32_bf16 a[120:123], a[208:211], a[160:163], a[120:123]
    s_mov_b32 m0, 29696
    v_mfma_f32_16x16x32_bf16 a[124:127], a[208:211], a[164:167], a[124:127]
    buffer_load_dwordx4 v199, s[24:27], s72 offen lds
    v_mfma_f32_16x16x32_bf16 a[124:127], a[212:215], a[196:199], a[124:127]
    ds_read_b128 a[180:183], v201 offset:38912
    v_mfma_f32_16x16x32_bf16 a[92:95], a[204:207], a[196:199], a[92:95]
    s_cbranch_vccnz L_skh3_04
L_sbh3_04:
    v_mfma_f32_16x16x32_bf16 a[92:95], a[200:203], a[164:167], a[92:95]
    s_waitcnt lgkmcnt(4)
    v_mfma_f32_16x16x32_bf16 v[0:3], a[216:219], a[136:139], v[0:3]
    s_add_u32 s72, s72, 32768
    v_mfma_f32_16x16x32_bf16 v[0:3], a[220:223], a[168:171], v[0:3]
    ds_read_b128 a[152:155], v200 offset:40960
    v_mfma_f32_16x16x32_bf16 v[32:35], a[228:231], a[168:171], v[32:35]
    s_mov_b32 m0, 30720
    v_mfma_f32_16x16x32_bf16 v[32:35], a[224:227], a[136:139], v[32:35]
    ds_read_b128 a[184:187], v201 offset:40960
    v_mfma_f32_16x16x32_bf16 v[36:39], a[224:227], a[140:143], v[36:39]
    buffer_load_dwordx4 v198, s[24:27], s72 offen lds
    v_mfma_f32_16x16x32_bf16 v[36:39], a[228:231], a[172:175], v[36:39]
    s_mov_b32 m0, 31744
    v_mfma_f32_16x16x32_bf16 v[4:7], a[220:223], a[172:175], v[4:7]
    ds_read_b128 a[156:159], v200 offset:43008
    v_mfma_f32_16x16x32_bf16 v[4:7], a[216:219], a[140:143], v[4:7]
    s_waitcnt lgkmcnt(3)
    v_mfma_f32_16x16x32_bf16 v[8:11], a[216:219], a[144:147], v[8:11]
    buffer_load_dwordx4 v199, s[24:27], s72 offen lds
    v_mfma_f32_16x16x32_bf16 v[8:11], a[220:223], a[176:179], v[8:11]
    ds_read_b128 a[188:191], v201 offset:43008
    v_mfma_f32_16x16x32_bf16 v[40:43], a[228:231], a[176:179], v[40:43]
    s_add_u32 s72, s72, 4294738048
    v_mfma_f32_16x16x32_bf16 v[40:43], a[224:227], a[144:147], v[40:43]
    ds_read_b128 a[160:163], v200 offset:45056
    v_mfma_f32_16x16x32_bf16 v[44:47], a[224:227], a[148:151], v[44:47]
    ds_read_b128 a[192:195], v201 offset:45056
    v_mfma_f32_16x16x32_bf16 v[44:47], a[228:231], a[180:183], v[44:47]
    ds_read_b128 a[164:167], v200 offset:47104
    v_mfma_f32_16x16x32_bf16 v[12:15], a[220:223], a[180:183], v[12:15]
    ds_read_b128 a[196:199], v201 offset:47104
    v_mfma_f32_16x16x32_bf16 v[12:15], a[216:219], a[148:151], v[12:15]
    s_waitcnt lgkmcnt(4)
    v_mfma_f32_16x16x32_bf16 v[16:19], a[216:219], a[152:155], v[16:19]
    ds_read_b64_tr_b16 a[200:201], v204 offset:49216
    v_mfma_f32_16x16x32_bf16 v[16:19], a[220:223], a[184:187], v[16:19]
    ds_read_b64_tr_b16 a[202:203], v204 offset:52800
    v_mfma_f32_16x16x32_bf16 v[48:51], a[228:231], a[184:187], v[48:51]
    ds_read_b64_tr_b16 a[204:205], v204 offset:56384
    v_mfma_f32_16x16x32_bf16 v[48:51], a[224:227], a[152:155], v[48:51]
    ds_read_b64_tr_b16 a[206:207], v204 offset:59968
    v_mfma_f32_16x16x32_bf16 v[52:55], a[224:227], a[156:159], v[52:55]
    ds_read_b64_tr_b16 a[212:213], v204 offset:56416
    v_mfma_f32_16x16x32_bf16 v[52:55], a[228:231], a[188:191], v[52:55]
    s_cmp_lt_u32 s76, 3
    s_cselect_b32 s84, s90, 2.0
    buffer_load_dword v236, v202, s[52:55], s84 offen
    s_add_u32 s90, s90, 256
    s_bitcmp1_b32 s90, 11
    s_cselect_b32 s84, 1536, 0
    s_sub_u32 s90, s90, s84
    v_mfma_f32_16x16x32_bf16 v[20:23], a[220:223], a[188:191], v[20:23]
    ds_read_b64_tr_b16 a[214:215], v204 offset:60000
    v_mfma_f32_16x16x32_bf16 v[20:23], a[216:219], a[156:159], v[20:23]
    s_waitcnt lgkmcnt(6)
    v_mfma_f32_16x16x32_bf16 v[24:27], a[216:219], a[160:163], v[24:27]
    ds_read_b64_tr_b16 a[208:209], v204 offset:49248
    v_mfma_f32_16x16x32_bf16 v[24:27], a[220:223], a[192:195], v[24:27]
    ds_read_b64_tr_b16 a[210:211], v204 offset:52832
    v_mfma_f32_16x16x32_bf16 v[56:59], a[228:231], a[192:195], v[56:59]
    v_mfma_f32_16x16x32_bf16 v[56:59], a[224:227], a[160:163], v[56:59]
    v_mfma_f32_16x16x32_bf16 v[60:63], a[224:227], a[164:167], v[60:63]
    v_mfma_f32_16x16x32_bf16 v[60:63], a[228:231], a[196:199], v[60:63]
    v_mfma_f32_16x16x32_bf16 v[28:31], a[220:223], a[196:199], v[28:31]
    s_cmp_eq_u32 s76, 4
    s_cselect_b32 s93, s92, 2.0
    buffer_load_dwordx4 v[232:235], v238, s[24:27], s93 offen offset:0
    v_mfma_f32_16x16x32_bf16 v[28:31], a[216:219], a[164:167], v[28:31]
    s_waitcnt lgkmcnt(0)
    v_mfma_f32_16x16x32_bf16 v[92:95], a[200:203], a[164:167], v[92:95]
    ds_read_b64_tr_b16 a[216:217], v205 offset:49152
    v_mfma_f32_16x16x32_bf16 v[92:95], a[204:207], a[196:199], v[92:95]
    v_mfma_f32_16x16x32_bf16 v[124:127], a[212:215], a[196:199], v[124:127]
    ds_read_b64_tr_b16 a[218:219], v205 offset:52736
    v_mfma_f32_16x16x32_bf16 v[124:127], a[208:211], a[164:167], v[124:127]
    buffer_load_dwordx4 v[240:243], v238, s[24:27], s93 offen offset:512
    v_mfma_f32_16x16x32_bf16 v[120:123], a[208:211], a[160:163], v[120:123]
    ds_read_b64_tr_b16 a[220:221], v205 offset:56320
    v_mfma_f32_16x16x32_bf16 v[120:123], a[212:215], a[192:195], v[120:123]
    v_mfma_f32_16x16x32_bf16 v[88:91], a[204:207], a[192:195], v[88:91]
    ds_read_b64_tr_b16 a[222:223], v205 offset:59904
    v_mfma_f32_16x16x32_bf16 v[88:91], a[200:203], a[160:163], v[88:91]
    buffer_load_dwordx4 v[244:247], v238, s[24:27], s93 offen offset:1024
    v_mfma_f32_16x16x32_bf16 v[84:87], a[200:203], a[156:159], v[84:87]
    v_mfma_f32_16x16x32_bf16 v[84:87], a[204:207], a[188:191], v[84:87]
    v_mfma_f32_16x16x32_bf16 v[116:119], a[212:215], a[188:191], v[116:119]
    buffer_load_dwordx4 v[248:251], v238, s[24:27], s93 offen offset:1536
    v_mfma_f32_16x16x32_bf16 v[116:119], a[208:211], a[156:159], v[116:119]
    v_mfma_f32_16x16x32_bf16 v[112:115], a[208:211], a[152:155], v[112:115]
    v_mfma_f32_16x16x32_bf16 v[112:115], a[212:215], a[184:187], v[112:115]
    v_mfma_f32_16x16x32_bf16 v[80:83], a[204:207], a[184:187], v[80:83]
    v_mfma_f32_16x16x32_bf16 v[80:83], a[200:203], a[152:155], v[80:83]
    s_branch L_g1_loop3
L_tail2:
    s_waitcnt vmcnt(29) lgkmcnt(0)
    s_barrier
    v_mfma_f32_16x16x32_bf16 v[76:79], a[216:219], a[148:151], v[76:79]
    ds_read_b64_tr_b16 a[212:213], v204 offset:27648
    v_mfma_f32_16x16x32_bf16 v[76:79], a[220:223], a[180:183], v[76:79]
    v_lshrrev_b32 v203, 1, v254
    v_mfma_f32_16x16x32_bf16 v[108:111], a[228:231], a[180:183], v[108:111]
    ds_read_b64_tr_b16 a[214:215], v204 offset:31232
    v_mfma_f32_16x16x32_bf16 v[108:111], a[224:227], a[148:151], v[108:111]
    ds_read_b64_tr_b16 a[208:209], v204 offset:20480
    v_mfma_f32_16x16x32_bf16 v[104:107], a[224:227], a[144:147], v[104:107]
    ds_read_b64_tr_b16 a[210:211], v204 offset:24064
    v_mfma_f32_16x16x32_bf16 v[104:107], a[228:231], a[176:179], v[104:107]
    v_min_u32 v202, 624, v254
    v_mfma_f32_16x16x32_bf16 v[72:75], a[220:223], a[176:179], v[72:75]
    buffer_load_dwordx2 v[224:225], v203, s[44:47], s4 offen sc1
    v_mfma_f32_16x16x32_bf16 v[72:75], a[216:219], a[144:147], v[72:75]
    v_and_b32 v226, 0x78, v203
    v_mfma_f32_16x16x32_bf16 v[68:71], a[216:219], a[140:143], v[68:71]
    buffer_load_dwordx2 v[226:227], v226, s[44:47], s5 offen sc1
    v_mfma_f32_16x16x32_bf16 v[68:71], a[220:223], a[172:175], v[68:71]
    buffer_load_dwordx4 v[208:211], v202, s[44:47], s6 offen offset:0 sc1
    v_mfma_f32_16x16x32_bf16 v[100:103], a[228:231], a[172:175], v[100:103]
    buffer_load_dwordx4 v[192:195], v202, s[44:47], s6 offen offset:2560 sc1
    v_mfma_f32_16x16x32_bf16 v[100:103], a[224:227], a[140:143], v[100:103]
    s_add_u32 s75, s6, 5120
    v_mfma_f32_16x16x32_bf16 v[96:99], a[224:227], a[136:139], v[96:99]
    buffer_load_dwordx4 v[196:199], v202, s[44:47], s75 offen offset:0 sc1
    v_mfma_f32_16x16x32_bf16 v[96:99], a[228:231], a[168:171], v[96:99]
    buffer_load_dwordx4 v[212:215], v202, s[44:47], s75 offen offset:2560 sc1
    v_mfma_f32_16x16x32_bf16 v[64:67], a[220:223], a[168:171], v[64:67]
    s_add_u32 s75, s6, 10240
    v_mfma_f32_16x16x32_bf16 v[64:67], a[216:219], a[136:139], v[64:67]
    v_mfma_f32_16x16x32_bf16 v[128:131], a[200:203], a[136:139], v[128:131]
    ds_read_b64_tr_b16 a[216:217], v204 offset:20512
    v_mfma_f32_16x16x32_bf16 v[128:131], a[204:207], a[168:171], v[128:131]
    s_waitcnt lgkmcnt(1)
    v_mfma_f32_16x16x32_bf16 v[160:163], a[212:215], a[168:171], v[160:163]
    buffer_load_dwordx4 v[216:219], v202, s[44:47], s75 offen offset:0 sc1
    v_mfma_f32_16x16x32_bf16 v[160:163], a[208:211], a[136:139], v[160:163]
    ds_read_b64_tr_b16 a[218:219], v204 offset:24096
    v_mfma_f32_16x16x32_bf16 v[164:167], a[208:211], a[140:143], v[164:167]
    buffer_load_dwordx4 v[220:223], v202, s[44:47], s75 offen offset:2560 sc1
    v_mfma_f32_16x16x32_bf16 v[164:167], a[212:215], a[172:175], v[164:167]
    ds_read_b64_tr_b16 a[220:221], v204 offset:27680
    v_mfma_f32_16x16x32_bf16 v[132:135], a[204:207], a[172:175], v[132:135]
    s_add_u32 s75, s6, 15360
    v_mfma_f32_16x16x32_bf16 v[132:135], a[200:203], a[140:143], v[132:135]
    ds_read_b64_tr_b16 a[222:223], v204 offset:31264
    v_mfma_f32_16x16x32_bf16 v[136:139], a[200:203], a[144:147], v[136:139]
    buffer_load_dwordx4 v[228:231], v202, s[44:47], s75 offen offset:0 sc1
    v_mfma_f32_16x16x32_bf16 v[136:139], a[204:207], a[176:179], v[136:139]
    ds_read_b64_tr_b16 a[228:229], v204 offset:27712
    v_mfma_f32_16x16x32_bf16 v[168:171], a[212:215], a[176:179], v[168:171]
    s_waitcnt vmcnt(36)
    buffer_load_dwordx4 v[232:235], v202, s[44:47], s75 offen offset:2560 sc1
    v_mfma_f32_16x16x32_bf16 v[168:171], a[208:211], a[144:147], v[168:171]
    v_lshrrev_b32 v238, 2, v254
    v_mfma_f32_16x16x32_bf16 v[172:175], a[208:211], a[148:151], v[172:175]
    ds_read_b64_tr_b16 a[230:231], v204 offset:31296
    v_mfma_f32_16x16x32_bf16 v[172:175], a[212:215], a[180:183], v[172:175]
    buffer_load_dword v238, v238, s[44:47], s77 offen offset:512 sc1
    v_mfma_f32_16x16x32_bf16 v[140:143], a[204:207], a[180:183], v[140:143]
    ds_read_b64_tr_b16 a[224:225], v204 offset:20544
    v_mfma_f32_16x16x32_bf16 v[140:143], a[200:203], a[148:151], v[140:143]
    s_add_u32 s28, s7, 0
    v_mfma_f32_16x16x32_bf16 v[144:147], a[200:203], a[152:155], v[144:147]
    ds_read_b64_tr_b16 a[226:227], v204 offset:24128
    v_mfma_f32_16x16x32_bf16 v[144:147], a[204:207], a[184:187], v[144:147]
    s_add_u32 s29, s7, 147456
    v_mfma_f32_16x16x32_bf16 v[176:179], a[212:215], a[184:187], v[176:179]
    s_add_u32 s30, s7, 294912
    v_mfma_f32_16x16x32_bf16 v[176:179], a[208:211], a[152:155], v[176:179]
    s_add_u32 s31, s7, 442368
    v_mfma_f32_16x16x32_bf16 v[180:183], a[208:211], a[156:159], v[180:183]
    s_add_u32 s32, s7, 589824
    v_mfma_f32_16x16x32_bf16 v[180:183], a[212:215], a[188:191], v[180:183]
    s_add_u32 s33, s7, 737280
    v_mfma_f32_16x16x32_bf16 v[148:151], a[204:207], a[188:191], v[148:151]
    v_mfma_f32_16x16x32_bf16 v[148:151], a[200:203], a[156:159], v[148:151]
    s_add_u32 s34, s7, 884736
    v_mfma_f32_16x16x32_bf16 v[152:155], a[200:203], a[160:163], v[152:155]
    v_mfma_f32_16x16x32_bf16 v[152:155], a[204:207], a[192:195], v[152:155]
    v_mfma_f32_16x16x32_bf16 v[184:187], a[212:215], a[192:195], v[184:187]
    s_add_u32 s35, s7, 1032192
    v_mfma_f32_16x16x32_bf16 v[184:187], a[208:211], a[160:163], v[184:187]
    v_mfma_f32_16x16x32_bf16 v[188:191], a[208:211], a[164:167], v[188:191]
    v_mfma_f32_16x16x32_bf16 v[188:191], a[212:215], a[196:199], v[188:191]
    s_waitcnt vmcnt(36)
    v_accvgpr_read_b32 v247, a237
    v_mfma_f32_16x16x32_bf16 v[156:159], a[204:207], a[196:199], v[156:159]
    v_mfma_f32_16x16x32_bf16 v[156:159], a[200:203], a[164:167], v[156:159]
    s_waitcnt lgkmcnt(0)
    v_mfma_f32_16x16x32_bf16 a[28:31], a[216:219], a[164:167], a[28:31]
    ds_read_b64_tr_b16 a[200:201], v204 offset:20576
    v_mfma_f32_16x16x32_bf16 a[28:31], a[220:223], a[196:199], a[28:31]
    v_accvgpr_read_b32 v244, a238
    v_mfma_f32_16x16x32_bf16 a[60:63], a[228:231], a[196:199], a[60:63]
    v_mfma_f32_16x16x32_bf16 a[60:63], a[224:227], a[164:167], a[60:63]
    ds_read_b64_tr_b16 a[202:203], v204 offset:24160
    v_mfma_f32_16x16x32_bf16 a[56:59], a[224:227], a[160:163], a[56:59]
    v_accvgpr_read_b32 v245, a239
    v_mfma_f32_16x16x32_bf16 a[56:59], a[228:231], a[192:195], a[56:59]
    ds_read_b64_tr_b16 a[204:205], v204 offset:27744
    v_mfma_f32_16x16x32_bf16 a[24:27], a[220:223], a[192:195], a[24:27]
    v_accvgpr_read_b32 v246, a240
    v_mfma_f32_16x16x32_bf16 a[24:27], a[216:219], a[160:163], a[24:27]
    ds_read_b64_tr_b16 a[206:207], v204 offset:31328
    v_mfma_f32_16x16x32_bf16 a[20:23], a[216:219], a[156:159], a[20:23]
    v_mfma_f32_16x16x32_bf16 a[20:23], a[220:223], a[188:191], a[20:23]
    ds_read_b64_tr_b16 a[212:213], v205 offset:27648
    v_mfma_f32_16x16x32_bf16 a[52:55], a[228:231], a[188:191], a[52:55]
    s_waitcnt vmcnt(30)
    v_accvgpr_read_b32 v248, a241
    v_mfma_f32_16x16x32_bf16 a[52:55], a[224:227], a[156:159], a[52:55]
    v_mfma_f32_16x16x32_bf16 a[48:51], a[224:227], a[152:155], a[48:51]
    ds_read_b64_tr_b16 a[214:215], v205 offset:31232
    v_mfma_f32_16x16x32_bf16 a[48:51], a[228:231], a[184:187], a[48:51]
    v_accvgpr_read_b32 v250, a242
    v_mfma_f32_16x16x32_bf16 a[16:19], a[220:223], a[184:187], a[16:19]
    ds_read_b64_tr_b16 a[208:209], v205 offset:20480
    v_mfma_f32_16x16x32_bf16 a[16:19], a[216:219], a[152:155], a[16:19]
    v_accvgpr_read_b32 v251, a243
    v_mfma_f32_16x16x32_bf16 a[12:15], a[216:219], a[148:151], a[12:15]
    ds_read_b64_tr_b16 a[210:211], v205 offset:24064
    v_mfma_f32_16x16x32_bf16 a[12:15], a[220:223], a[180:183], a[12:15]
    v_mfma_f32_16x16x32_bf16 a[44:47], a[228:231], a[180:183], a[44:47]
    v_accvgpr_read_b32 v240, a244
    v_mfma_f32_16x16x32_bf16 a[44:47], a[224:227], a[148:151], a[44:47]
    v_mfma_f32_16x16x32_bf16 a[40:43], a[224:227], a[144:147], a[40:43]
    v_mfma_f32_16x16x32_bf16 a[40:43], a[228:231], a[176:179], a[40:43]
    v_accvgpr_read_b32 v241, a245
    v_mfma_f32_16x16x32_bf16 a[8:11], a[220:223], a[176:179], a[8:11]
    v_mfma_f32_16x16x32_bf16 a[8:11], a[216:219], a[144:147], a[8:11]
    v_mfma_f32_16x16x32_bf16 a[4:7], a[216:219], a[140:143], a[4:7]
    v_accvgpr_read_b32 v242, a246
    v_mfma_f32_16x16x32_bf16 a[4:7], a[220:223], a[172:175], a[4:7]
    v_mfma_f32_16x16x32_bf16 a[36:39], a[228:231], a[172:175], a[36:39]
    v_mfma_f32_16x16x32_bf16 a[36:39], a[224:227], a[140:143], a[36:39]
    v_accvgpr_read_b32 v243, a247
    v_mfma_f32_16x16x32_bf16 a[32:35], a[224:227], a[136:139], a[32:35]
    v_mfma_f32_16x16x32_bf16 a[32:35], a[228:231], a[168:171], a[32:35]
    v_mfma_f32_16x16x32_bf16 a[0:3], a[220:223], a[168:171], a[0:3]
    v_mfma_f32_16x16x32_bf16 a[0:3], a[216:219], a[136:139], a[0:3]
    s_waitcnt vmcnt(13) lgkmcnt(0)
    s_barrier
    v_mfma_f32_16x16x32_bf16 a[64:67], a[200:203], a[136:139], a[64:67]
    ds_read_b64_tr_b16 a[216:217], v204 offset:49152
    v_mfma_f32_16x16x32_bf16 a[64:67], a[204:207], a[168:171], a[64:67]
    ds_read_b64_tr_b16 a[218:219], v204 offset:52736
    v_mfma_f32_16x16x32_bf16 a[96:99], a[212:215], a[168:171], a[96:99]
    ds_read_b64_tr_b16 a[220:221], v204 offset:56320
    v_mfma_f32_16x16x32_bf16 a[96:99], a[208:211], a[136:139], a[96:99]
    ds_read_b64_tr_b16 a[222:223], v204 offset:59904
    v_mfma_f32_16x16x32_bf16 a[100:103], a[208:211], a[140:143], a[100:103]
    ds_read_b64_tr_b16 a[228:229], v204 offset:56352
    v_mfma_f32_16x16x32_bf16 a[100:103], a[212:215], a[172:175], a[100:103]
    ds_read_b64_tr_b16 a[230:231], v204 offset:59936
    v_mfma_f32_16x16x32_bf16 a[68:71], a[204:207], a[172:175], a[68:71]
    ds_read_b64_tr_b16 a[224:225], v204 offset:49184
    v_mfma_f32_16x16x32_bf16 a[68:71], a[200:203], a[140:143], a[68:71]
    ds_read_b128 a[136:139], v200 offset:32768
    v_mfma_f32_16x16x32_bf16 a[72:75], a[200:203], a[144:147], a[72:75]
    ds_read_b64_tr_b16 a[226:227], v204 offset:52768
    v_mfma_f32_16x16x32_bf16 a[72:75], a[204:207], a[176:179], a[72:75]
    ds_read_b128 a[168:171], v201 offset:32768
    v_mfma_f32_16x16x32_bf16 a[104:107], a[212:215], a[176:179], a[104:107]
    ds_read_b128 a[140:143], v200 offset:34816
    v_mfma_f32_16x16x32_bf16 a[104:107], a[208:211], a[144:147], a[104:107]
    v_mfma_f32_16x16x32_bf16 a[108:111], a[208:211], a[148:151], a[108:111]
    ds_read_b128 a[172:175], v201 offset:34816
    v_mfma_f32_16x16x32_bf16 a[108:111], a[212:215], a[180:183], a[108:111]
    v_mfma_f32_16x16x32_bf16 a[76:79], a[204:207], a[180:183], a[76:79]
    ds_read_b128 a[144:147], v200 offset:36864
    v_mfma_f32_16x16x32_bf16 a[76:79], a[200:203], a[148:151], a[76:79]
    v_mfma_f32_16x16x32_bf16 a[80:83], a[200:203], a[152:155], a[80:83]
    ds_read_b128 a[176:179], v201 offset:36864
    v_mfma_f32_16x16x32_bf16 a[80:83], a[204:207], a[184:187], a[80:83]
    v_mfma_f32_16x16x32_bf16 a[112:115], a[212:215], a[184:187], a[112:115]
    ds_read_b128 a[148:151], v200 offset:38912
    v_mfma_f32_16x16x32_bf16 a[112:115], a[208:211], a[152:155], a[112:115]
    v_mfma_f32_16x16x32_bf16 a[116:119], a[208:211], a[156:159], a[116:119]
    ds_read_b128 a[180:183], v201 offset:38912
    v_mfma_f32_16x16x32_bf16 a[116:119], a[212:215], a[188:191], a[116:119]
    v_mfma_f32_16x16x32_bf16 a[84:87], a[204:207], a[188:191], a[84:87]
    ds_read_b128 a[152:155], v200 offset:40960
    v_mfma_f32_16x16x32_bf16 a[84:87], a[200:203], a[156:159], a[84:87]
    v_mfma_f32_16x16x32_bf16 a[88:91], a[200:203], a[160:163], a[88:91]
    ds_read_b128 a[184:187], v201 offset:40960
    v_mfma_f32_16x16x32_bf16 a[88:91], a[204:207], a[192:195], a[88:91]
    v_mfma_f32_16x16x32_bf16 a[120:123], a[212:215], a[192:195], a[120:123]
    ds_read_b128 a[156:159], v200 offset:43008
    v_mfma_f32_16x16x32_bf16 a[120:123], a[208:211], a[160:163], a[120:123]
    v_mfma_f32_16x16x32_bf16 a[124:127], a[208:211], a[164:167], a[124:127]
    ds_read_b128 a[188:191], v201 offset:43008
    v_mfma_f32_16x16x32_bf16 a[124:127], a[212:215], a[196:199], a[124:127]
    v_mfma_f32_16x16x32_bf16 a[92:95], a[204:207], a[196:199], a[92:95]
    ds_read_b128 a[160:163], v200 offset:45056
    v_mfma_f32_16x16x32_bf16 a[92:95], a[200:203], a[164:167], a[92:95]
    s_waitcnt lgkmcnt(9)
    v_mfma_f32_16x16x32_bf16 v[0:3], a[216:219], a[136:139], v[0:3]
    ds_read_b128 a[192:195], v201 offset:45056
    v_mfma_f32_16x16x32_bf16 v[0:3], a[220:223], a[168:171], v[0:3]
    v_mfma_f32_16x16x32_bf16 v[32:35], a[228:231], a[168:171], v[32:35]
    ds_read_b128 a[164:167], v200 offset:47104
    v_mfma_f32_16x16x32_bf16 v[32:35], a[224:227], a[136:139], v[32:35]
    v_mfma_f32_16x16x32_bf16 v[36:39], a[224:227], a[140:143], v[36:39]
    ds_read_b128 a[196:199], v201 offset:47104
    v_mfma_f32_16x16x32_bf16 v[36:39], a[228:231], a[172:175], v[36:39]
    ds_read_b64_tr_b16 a[200:201], v204 offset:49216
    v_mfma_f32_16x16x32_bf16 v[4:7], a[220:223], a[172:175], v[4:7]
    v_mfma_f32_16x16x32_bf16 v[4:7], a[216:219], a[140:143], v[4:7]
    s_waitcnt lgkmcnt(9)
    v_mfma_f32_16x16x32_bf16 v[8:11], a[216:219], a[144:147], v[8:11]
    ds_read_b64_tr_b16 a[202:203], v204 offset:52800
    v_mfma_f32_16x16x32_bf16 v[8:11], a[220:223], a[176:179], v[8:11]
    ds_read_b64_tr_b16 a[204:205], v204 offset:56384
    v_mfma_f32_16x16x32_bf16 v[40:43], a[228:231], a[176:179], v[40:43]
    s_waitcnt vmcnt(5)
    v_mfma_f32_16x16x32_bf16 v[40:43], a[224:227], a[144:147], v[40:43]
    ds_read_b64_tr_b16 a[206:207], v204 offset:59968
    v_mfma_f32_16x16x32_bf16 v[44:47], a[224:227], a[148:151], v[44:47]
    v_min3_u32 v252, v239, v225, v227
    v_mfma_f32_16x16x32_bf16 v[44:47], a[228:231], a[180:183], v[44:47]
    ds_read_b64_tr_b16 a[212:213], v204 offset:56416
    v_mfma_f32_16x16x32_bf16 v[12:15], a[220:223], a[180:183], v[12:15]
    v_max3_u32 v253, v239, v225, v227
    v_mfma_f32_16x16x32_bf16 v[12:15], a[216:219], a[148:151], v[12:15]
    s_waitcnt lgkmcnt(9)
    v_mfma_f32_16x16x32_bf16 v[16:19], a[216:219], a[152:155], v[16:19]
    ds_read_b64_tr_b16 a[214:215], v204 offset:60000
    v_mfma_f32_16x16x32_bf16 v[16:19], a[220:223], a[184:187], v[16:19]
    ds_read_b64_tr_b16 a[208:209], v204 offset:49248
    v_mfma_f32_16x16x32_bf16 v[48:51], a[228:231], a[184:187], v[48:51]
    v_min3_u32 v252, v252, v209, v211
    v_mfma_f32_16x16x32_bf16 v[48:51], a[224:227], a[152:155], v[48:51]
    ds_read_b64_tr_b16 a[210:211], v204 offset:52832
    v_mfma_f32_16x16x32_bf16 v[52:55], a[224:227], a[156:159], v[52:55]
    v_max3_u32 v253, v253, v209, v211
    v_mfma_f32_16x16x32_bf16 v[52:55], a[228:231], a[188:191], v[52:55]
    v_min3_u32 v252, v252, v193, v195
    v_mfma_f32_16x16x32_bf16 v[20:23], a[220:223], a[188:191], v[20:23]
    v_max3_u32 v253, v253, v193, v195
    v_mfma_f32_16x16x32_bf16 v[20:23], a[216:219], a[156:159], v[20:23]
    s_waitcnt lgkmcnt(8)
    v_mfma_f32_16x16x32_bf16 v[24:27], a[216:219], a[160:163], v[24:27]
    v_add_f32 v208, v208, v192
    v_mfma_f32_16x16x32_bf16 v[24:27], a[220:223], a[192:195], v[24:27]
    v_add_f32 v210, v210, v194
    v_mfma_f32_16x16x32_bf16 v[56:59], a[228:231], a[192:195], v[56:59]
    v_min3_u32 v252, v252, v197, v199
    v_mfma_f32_16x16x32_bf16 v[56:59], a[224:227], a[160:163], v[56:59]
    v_max3_u32 v253, v253, v197, v199
    v_mfma_f32_16x16x32_bf16 v[60:63], a[224:227], a[164:167], v[60:63]
    v_add_f32 v208, v208, v196
    v_mfma_f32_16x16x32_bf16 v[60:63], a[228:231], a[196:199], v[60:63]
    v_add_f32 v210, v210, v198
    v_mfma_f32_16x16x32_bf16 v[28:31], a[220:223], a[196:199], v[28:31]
    v_min3_u32 v252, v252, v213, v215
    v_mfma_f32_16x16x32_bf16 v[28:31], a[216:219], a[164:167], v[28:31]
    s_waitcnt lgkmcnt(0)
    v_mfma_f32_16x16x32_bf16 v[92:95], a[200:203], a[164:167], v[92:95]
    ds_read_b64_tr_b16 a[216:217], v205 offset:49152
    v_mfma_f32_16x16x32_bf16 v[92:95], a[204:207], a[196:199], v[92:95]
    v_max3_u32 v253, v253, v213, v215
    v_mfma_f32_16x16x32_bf16 v[124:127], a[212:215], a[196:199], v[124:127]
    ds_read_b64_tr_b16 a[218:219], v205 offset:52736
    v_mfma_f32_16x16x32_bf16 v[124:127], a[208:211], a[164:167], v[124:127]
    v_add_f32 v208, v208, v212
    v_mfma_f32_16x16x32_bf16 v[120:123], a[208:211], a[160:163], v[120:123]
    ds_read_b64_tr_b16 a[220:221], v205 offset:56320
    v_mfma_f32_16x16x32_bf16 v[120:123], a[212:215], a[192:195], v[120:123]
    v_add_f32 v210, v210, v214
    v_mfma_f32_16x16x32_bf16 v[88:91], a[204:207], a[192:195], v[88:91]
    ds_read_b64_tr_b16 a[222:223], v205 offset:59904
    v_mfma_f32_16x16x32_bf16 v[88:91], a[200:203], a[160:163], v[88:91]
    s_waitcnt vmcnt(1)
    v_mfma_f32_16x16x32_bf16 v[84:87], a[200:203], a[156:159], v[84:87]
    v_min3_u32 v252, v252, v217, v219
    v_mfma_f32_16x16x32_bf16 v[84:87], a[204:207], a[188:191], v[84:87]
    v_max3_u32 v253, v253, v217, v219
    v_mfma_f32_16x16x32_bf16 v[116:119], a[212:215], a[188:191], v[116:119]
    v_mfma_f32_16x16x32_bf16 v[116:119], a[208:211], a[156:159], v[116:119]
    v_mfma_f32_16x16x32_bf16 v[112:115], a[208:211], a[152:155], v[112:115]
    v_mfma_f32_16x16x32_bf16 v[112:115], a[212:215], a[184:187], v[112:115]
    v_mfma_f32_16x16x32_bf16 v[80:83], a[204:207], a[184:187], v[80:83]
    v_mfma_f32_16x16x32_bf16 v[80:83], a[200:203], a[152:155], v[80:83]
    s_waitcnt lgkmcnt(0)
    s_barrier
    v_mfma_f32_16x16x32_bf16 v[76:79], a[200:203], a[148:151], v[76:79]
    ds_read_b64_tr_b16 a[228:229], v204 offset:7168
    s_mov_b64 s[52:53], s[8:9]
    s_mov_b32 s54, 2097152
    v_mfma_f32_16x16x32_bf16 v[76:79], a[204:207], a[180:183], v[76:79]
    ds_read_b64_tr_b16 a[230:231], v204 offset:10752
    v_readlane_b32 s92, v247, 0
    v_mfma_f32_16x16x32_bf16 v[108:111], a[212:215], a[180:183], v[108:111]
    ds_read_b64_tr_b16 a[224:225], v204 offset:0
    s_add_u32 m0, s3, 98304
    v_mfma_f32_16x16x32_bf16 v[108:111], a[208:211], a[148:151], v[108:111]
    ds_read_b64_tr_b16 a[226:227], v204 offset:3584
    buffer_load_dwordx4 v244, s[48:51], s92 offen lds
    v_mfma_f32_16x16x32_bf16 v[104:107], a[208:211], a[144:147], v[104:107]
    v_add_f32 v208, v208, v216
    v_mfma_f32_16x16x32_bf16 v[104:107], a[212:215], a[176:179], v[104:107]
    v_add_f32 v210, v210, v218
    v_mfma_f32_16x16x32_bf16 v[72:75], a[204:207], a[176:179], v[72:75]
    v_min3_u32 v252, v252, v221, v223
    v_mfma_f32_16x16x32_bf16 v[72:75], a[200:203], a[144:147], v[72:75]
    v_max3_u32 v253, v253, v221, v223
    v_mfma_f32_16x16x32_bf16 v[68:71], a[200:203], a[140:143], v[68:71]
    v_add_f32 v208, v208, v220
    v_mfma_f32_16x16x32_bf16 v[68:71], a[204:207], a[172:175], v[68:71]
    v_add_f32 v210, v210, v222
    v_mfma_f32_16x16x32_bf16 v[100:103], a[212:215], a[172:175], v[100:103]
    v_min3_u32 v252, v252, v229, v231
    v_mfma_f32_16x16x32_bf16 v[100:103], a[208:211], a[140:143], v[100:103]
    v_max3_u32 v253, v253, v229, v231
    v_mfma_f32_16x16x32_bf16 v[96:99], a[208:211], a[136:139], v[96:99]
    v_add_f32 v208, v208, v228
    v_mfma_f32_16x16x32_bf16 v[96:99], a[212:215], a[168:171], v[96:99]
    v_readlane_b32 s93, v247, 1
    v_mfma_f32_16x16x32_bf16 v[64:67], a[204:207], a[168:171], v[64:67]
    v_add_f32 v210, v210, v230
    v_mfma_f32_16x16x32_bf16 v[64:67], a[200:203], a[136:139], v[64:67]
    v_mfma_f32_16x16x32_bf16 v[128:131], a[216:219], a[136:139], v[128:131]
    ds_read_b64_tr_b16 a[200:201], v204 offset:32
    v_mfma_f32_16x16x32_bf16 v[128:131], a[220:223], a[168:171], v[128:131]
    s_waitcnt lgkmcnt(1)
    v_mfma_f32_16x16x32_bf16 v[160:163], a[228:231], a[168:171], v[160:163]
    ds_read_b64_tr_b16 a[202:203], v204 offset:3616
    v_mfma_f32_16x16x32_bf16 v[160:163], a[224:227], a[136:139], v[160:163]
    v_min3_u32 v252, v252, v233, v235
    v_mfma_f32_16x16x32_bf16 v[164:167], a[224:227], a[140:143], v[164:167]
    s_add_u32 m0, s3, 100352
    v_mfma_f32_16x16x32_bf16 v[164:167], a[228:231], a[172:175], v[164:167]
    ds_read_b64_tr_b16 a[204:205], v204 offset:7200
    v_mfma_f32_16x16x32_bf16 v[132:135], a[220:223], a[172:175], v[132:135]
    v_max3_u32 v253, v253, v233, v235
    v_mfma_f32_16x16x32_bf16 v[132:135], a[216:219], a[140:143], v[132:135]
    ds_read_b64_tr_b16 a[206:207], v204 offset:10784
    v_mfma_f32_16x16x32_bf16 v[136:139], a[216:219], a[144:147], v[136:139]
    v_add_f32 v208, v208, v232
    v_mfma_f32_16x16x32_bf16 v[136:139], a[220:223], a[176:179], v[136:139]
    ds_read_b64_tr_b16 a[212:213], v204 offset:7232
    v_mfma_f32_16x16x32_bf16 v[168:171], a[228:231], a[176:179], v[168:171]
    buffer_load_dwordx4 v245, s[48:51], s92 offen lds
    v_mfma_f32_16x16x32_bf16 v[168:171], a[224:227], a[144:147], v[168:171]
    v_add_f32 v210, v210, v234
    v_mfma_f32_16x16x32_bf16 v[172:175], a[224:227], a[148:151], v[172:175]
    ds_read_b64_tr_b16 a[214:215], v204 offset:10816
    v_mfma_f32_16x16x32_bf16 v[172:175], a[228:231], a[180:183], v[172:175]
    v_cmp_ne_u32 vcc, v252, v253
    s_cbranch_vccnz L_gs2
L_gb2:
    v_mfma_f32_16x16x32_bf16 v[140:143], a[220:223], a[180:183], v[140:143]
    ds_read_b64_tr_b16 a[208:209], v204 offset:64
    v_mfma_f32_16x16x32_bf16 v[140:143], a[216:219], a[148:151], v[140:143]
    s_add_u32 m0, s3, 106496
    v_mfma_f32_16x16x32_bf16 v[144:147], a[216:219], a[152:155], v[144:147]
    ds_read_b64_tr_b16 a[210:211], v204 offset:3648
    v_mfma_f32_16x16x32_bf16 v[144:147], a[220:223], a[184:187], v[144:147]
    v_accvgpr_read_b32 v196, a236
    v_mfma_f32_16x16x32_bf16 v[176:179], a[228:231], a[184:187], v[176:179]
    ds_write2_b32 v196, v208, v210 offset1:1
    v_mfma_f32_16x16x32_bf16 v[176:179], a[224:227], a[152:155], v[176:179]
    buffer_load_dwordx4 v244, s[48:51], s93 offen lds
    v_mfma_f32_16x16x32_bf16 v[180:183], a[224:227], a[156:159], v[180:183]
    v_and_b32 v214, 0xffff0000, v226
    v_mfma_f32_16x16x32_bf16 v[180:183], a[228:231], a[188:191], v[180:183]
    v_rcp_f32 v216, v214
    v_mfma_f32_16x16x32_bf16 v[148:151], a[220:223], a[188:191], v[148:151]
    v_readlane_b32 s94, v247, 2
    v_mfma_f32_16x16x32_bf16 v[148:151], a[216:219], a[156:159], v[148:151]
    v_lshlrev_b32 v212, 16, v226
    v_mfma_f32_16x16x32_bf16 v[152:155], a[216:219], a[160:163], v[152:155]
    v_xor_b32 v212, 0x80000000, v212
    v_mfma_f32_16x16x32_bf16 v[152:155], a[220:223], a[192:195], v[152:155]
    s_add_u32 m0, s3, 108544
    v_mfma_f32_16x16x32_bf16 v[184:187], a[228:231], a[192:195], v[184:187]
    v_accvgpr_read_b32 v195, a235
    v_mfma_f32_16x16x32_bf16 v[184:187], a[224:227], a[160:163], v[184:187]
    ds_write2st64_b32 v195, v212, v216 offset1:5
    v_mfma_f32_16x16x32_bf16 v[188:191], a[224:227], a[164:167], v[188:191]
    buffer_load_dwordx4 v245, s[48:51], s93 offen lds
    v_mfma_f32_16x16x32_bf16 v[188:191], a[228:231], a[196:199], v[188:191]
    v_mul_f32 v213, 3216550459, v216
    v_mfma_f32_16x16x32_bf16 v[156:159], a[220:223], a[196:199], v[156:159]
    v_mul_f32 v215, 1057048658, v216
    v_mfma_f32_16x16x32_bf16 v[156:159], a[216:219], a[164:167], v[156:159]
    s_waitcnt lgkmcnt(2)
    v_mfma_f32_16x16x32_bf16 a[28:31], a[200:203], a[164:167], a[28:31]
    ds_read_b64_tr_b16 a[216:217], v204 offset:96
    v_mfma_f32_16x16x32_bf16 a[28:31], a[204:207], a[196:199], a[28:31]
    s_add_u32 m0, s3, 114688
    v_mfma_f32_16x16x32_bf16 a[60:63], a[212:215], a[196:199], a[60:63]
    v_accvgpr_read_b32 v194, a234
    v_mfma_f32_16x16x32_bf16 a[60:63], a[208:211], a[164:167], a[60:63]
    ds_read_b64_tr_b16 a[218:219], v204 offset:3680
    v_mfma_f32_16x16x32_bf16 a[56:59], a[208:211], a[160:163], a[56:59]
    ds_write_b128 v194, v[212:215]
    v_mfma_f32_16x16x32_bf16 a[56:59], a[212:215], a[192:195], a[56:59]
    ds_read_b64_tr_b16 a[220:221], v204 offset:7264
    v_mfma_f32_16x16x32_bf16 a[24:27], a[204:207], a[192:195], a[24:27]
    v_and_b32 v230, 0xffff0000, v224
    v_mfma_f32_16x16x32_bf16 a[24:27], a[200:203], a[160:163], a[24:27]
    ds_read_b64_tr_b16 a[222:223], v204 offset:10848
    v_mfma_f32_16x16x32_bf16 a[20:23], a[200:203], a[156:159], a[20:23]
    buffer_load_dwordx4 v244, s[48:51], s94 offen lds
    v_mfma_f32_16x16x32_bf16 a[20:23], a[204:207], a[188:191], a[20:23]
    ds_read_b64_tr_b16 a[228:229], v205 offset:7168
    v_mfma_f32_16x16x32_bf16 a[52:55], a[212:215], a[188:191], a[52:55]
    v_rcp_f32 v232, v230
    v_mfma_f32_16x16x32_bf16 a[52:55], a[208:211], a[156:159], a[52:55]
    v_lshlrev_b32 v228, 16, v224
    v_mfma_f32_16x16x32_bf16 a[48:51], a[208:211], a[152:155], a[48:51]
    ds_read_b64_tr_b16 a[230:231], v205 offset:10752
    v_mfma_f32_16x16x32_bf16 a[48:51], a[212:215], a[184:187], a[48:51]
    v_readlane_b32 s95, v247, 3
    v_mfma_f32_16x16x32_bf16 a[16:19], a[204:207], a[184:187], a[16:19]
    ds_read_b64_tr_b16 a[224:225], v205 offset:0
    v_mfma_f32_16x16x32_bf16 a[16:19], a[200:203], a[152:155], a[16:19]
    v_xor_b32 v228, 0x80000000, v228
    v_mfma_f32_16x16x32_bf16 a[12:15], a[200:203], a[148:151], a[12:15]
    ds_read_b64_tr_b16 a[226:227], v205 offset:3584
    v_mfma_f32_16x16x32_bf16 a[12:15], a[204:207], a[180:183], a[12:15]
    v_accvgpr_read_b32 v193, a233
    v_mfma_f32_16x16x32_bf16 a[44:47], a[212:215], a[180:183], a[44:47]
    s_add_u32 m0, s3, 116736
    v_mfma_f32_16x16x32_bf16 a[44:47], a[208:211], a[148:151], a[44:47]
    ds_write2st64_b32 v193, v228, v232 offset1:5
    v_mfma_f32_16x16x32_bf16 a[40:43], a[208:211], a[144:147], a[40:43]
    v_mul_f32 v229, 3216550459, v232
    v_mfma_f32_16x16x32_bf16 a[40:43], a[212:215], a[176:179], a[40:43]
    buffer_load_dwordx4 v245, s[48:51], s94 offen lds
    v_mfma_f32_16x16x32_bf16 a[8:11], a[204:207], a[176:179], a[8:11]
    v_mul_f32 v231, 1057048658, v232
    v_mfma_f32_16x16x32_bf16 a[8:11], a[200:203], a[144:147], a[8:11]
    v_accvgpr_read_b32 v192, a232
    v_mfma_f32_16x16x32_bf16 a[4:7], a[200:203], a[140:143], a[4:7]
    s_add_u32 m0, s3, 122880
    v_mfma_f32_16x16x32_bf16 a[4:7], a[204:207], a[172:175], a[4:7]
    ds_write_b128 v192, v[228:231]
    v_mfma_f32_16x16x32_bf16 a[36:39], a[212:215], a[172:175], a[36:39]
    buffer_load_dwordx4 v244, s[52:55], s95 offen lds
    v_mfma_f32_16x16x32_bf16 a[36:39], a[208:211], a[140:143], a[36:39]
    s_getreg_b32 s72, hwreg(HW_REG_XCC_ID, 0, 4)
    s_add_u32 s72, s72, 1
    s_waitcnt vmcnt(7)
    v_subrev_u32 v238, s72, v238
    v_mfma_f32_16x16x32_bf16 a[32:35], a[208:211], a[136:139], a[32:35]
    v_cmp_eq_u32 vcc, v239, v238
    s_nop 1
    s_and_b32 s78, vcc_lo, 0xff
    s_xor_b32 s78, s78, 0xff
    v_mfma_f32_16x16x32_bf16 a[32:35], a[212:215], a[168:171], a[32:35]
    v_accvgpr_read_b32 v252, a248
    v_mfma_f32_16x16x32_bf16 a[0:3], a[204:207], a[168:171], a[0:3]
    v_readlane_b32 s92, v247, 4
    v_mfma_f32_16x16x32_bf16 a[0:3], a[200:203], a[136:139], a[0:3]
    s_waitcnt lgkmcnt(2)
    v_mfma_f32_16x16x32_bf16 a[64:67], a[216:219], a[136:139], a[64:67]
    v_accvgpr_read_b32 v253, a249
    v_mfma_f32_16x16x32_bf16 a[64:67], a[220:223], a[168:171], a[64:67]
    v_accvgpr_read_b32 v237, a250
    v_mfma_f32_16x16x32_bf16 a[96:99], a[228:231], a[168:171], a[96:99]
    v_accvgpr_read_b32 v233, a251
    v_mfma_f32_16x16x32_bf16 a[96:99], a[224:227], a[136:139], a[96:99]
    s_add_u32 m0, s3, 124928
    v_mfma_f32_16x16x32_bf16 a[100:103], a[224:227], a[140:143], a[100:103]
    v_xor_b32 v249, 0x80, v250
    v_mfma_f32_16x16x32_bf16 a[100:103], a[228:231], a[172:175], a[100:103]
    v_xor_b32 v234, 0x80, v251
    v_mfma_f32_16x16x32_bf16 a[68:71], a[220:223], a[172:175], a[68:71]
    v_xor_b32 v235, 0x80, v252
    v_mfma_f32_16x16x32_bf16 a[68:71], a[216:219], a[140:143], a[68:71]
    buffer_load_dwordx4 v245, s[52:55], s95 offen lds
    v_mfma_f32_16x16x32_bf16 a[72:75], a[216:219], a[144:147], a[72:75]
    v_xor_b32 v236, 0x80, v253
    v_mfma_f32_16x16x32_bf16 a[72:75], a[220:223], a[176:179], a[72:75]
    s_lshl_b32 s84, s69, 11
    s_add_u32 s84, s84, 154624
    v_and_b32 v232, 0xf0, v254
    v_mfma_f32_16x16x32_bf16 a[104:107], a[228:231], a[176:179], a[104:107]
    v_add_u32 v232, s84, v232
    v_mfma_f32_16x16x32_bf16 a[104:107], a[224:227], a[144:147], a[104:107]
    s_add_u32 m0, s3, 131072
    v_mfma_f32_16x16x32_bf16 a[108:111], a[224:227], a[148:151], a[108:111]
    v_lshrrev_b32 v238, 8, v254
    v_mfma_f32_16x16x32_bf16 a[108:111], a[228:231], a[180:183], a[108:111]
    v_lshlrev_b32 v238, 4, v238
    v_mfma_f32_16x16x32_bf16 a[76:79], a[220:223], a[180:183], a[76:79]
    v_add_u32 v238, 161984, v238
    v_mfma_f32_16x16x32_bf16 a[76:79], a[216:219], a[148:151], a[76:79]
    buffer_load_dwordx4 v244, s[48:51], s92 offen lds
    v_mfma_f32_16x16x32_bf16 a[80:83], a[216:219], a[152:155], a[80:83]
    s_waitcnt lgkmcnt(0)
    s_barrier
    v_mfma_f32_16x16x32_bf16 a[80:83], a[220:223], a[184:187], a[80:83]
    v_readlane_b32 s93, v247, 5
    v_mfma_f32_16x16x32_bf16 a[112:115], a[228:231], a[184:187], a[112:115]
    ds_read_b128 v[208:211], v238 offset:0
    v_mfma_f32_16x16x32_bf16 a[112:115], a[224:227], a[152:155], a[112:115]
    s_add_u32 m0, s3, 133120
    v_mfma_f32_16x16x32_bf16 a[116:119], a[224:227], a[156:159], a[116:119]
    ds_read_b128 v[212:215], v238 offset:64
    v_mfma_f32_16x16x32_bf16 a[116:119], a[228:231], a[188:191], a[116:119]
    buffer_load_dwordx4 v245, s[48:51], s92 offen lds
    v_mfma_f32_16x16x32_bf16 a[84:87], a[220:223], a[188:191], a[84:87]
    ds_read_b128 v[216:219], v238 offset:320
    v_mfma_f32_16x16x32_bf16 a[84:87], a[216:219], a[156:159], a[84:87]
    ds_read_b128 v[220:223], v238 offset:384
    v_mfma_f32_16x16x32_bf16 a[88:91], a[216:219], a[160:163], a[88:91]
    s_add_u32 m0, s3, 139264
    v_mfma_f32_16x16x32_bf16 a[88:91], a[220:223], a[192:195], a[88:91]
    ds_read_b128 v[224:227], v232 offset:256
    v_mfma_f32_16x16x32_bf16 a[120:123], a[228:231], a[192:195], a[120:123]
    buffer_load_dwordx4 v244, s[48:51], s93 offen lds
    v_mfma_f32_16x16x32_bf16 a[120:123], a[224:227], a[160:163], a[120:123]
    ds_read_b128 v[228:231], v232 offset:512
    v_mfma_f32_16x16x32_bf16 a[124:127], a[224:227], a[164:167], a[124:127]
    s_add_u32 m0, s3, 141312
    v_mfma_f32_16x16x32_bf16 a[124:127], a[228:231], a[196:199], a[124:127]
    ds_read_b128 v[192:195], v232 offset:768
    v_mfma_f32_16x16x32_bf16 a[92:95], a[220:223], a[196:199], a[92:95]
    buffer_load_dwordx4 v245, s[48:51], s93 offen lds
    v_mfma_f32_16x16x32_bf16 a[92:95], a[216:219], a[164:167], a[92:95]
    ds_read_b128 v[196:199], v232 offset:1024
L_epi1:
    s_waitcnt lgkmcnt(3)
    v_pk_fma_f32 v[0:1], v[208:209], v[224:225], v[0:1] op_sel:[0,0,0] op_sel_hi:[1,0,1]
    v_pk_fma_f32 v[2:3], v[210:211], v[224:225], v[2:3] op_sel:[0,0,0] op_sel_hi:[1,0,1]
    v_pk_fma_f32 v[32:33], v[212:213], v[224:225], v[32:33] op_sel:[0,0,0] op_sel_hi:[1,0,1]
    v_pk_fma_f32 v[34:35], v[214:215], v[224:225], v[34:35] op_sel:[0,0,0] op_sel_hi:[1,0,1]
    v_pk_mul_f32 v[0:1], v[0:1], v[224:225] op_sel:[0,1] op_sel_hi:[1,1]
    v_pk_mul_f32 v[2:3], v[2:3], v[224:225] op_sel:[0,1] op_sel_hi:[1,1]
    v_pk_mul_f32 v[32:33], v[32:33], v[224:225] op_sel:[0,1] op_sel_hi:[1,1]
    v_pk_mul_f32 v[34:35], v[34:35], v[224:225] op_sel:[0,1] op_sel_hi:[1,1]
    v_exp_f32 v0, v0
    v_exp_f32 v1, v1
    v_exp_f32 v2, v2
    v_exp_f32 v3, v3
    v_exp_f32 v32, v32
    v_exp_f32 v33, v33
    v_exp_f32 v34, v34
    v_exp_f32 v35, v35
    v_accvgpr_read_b32 v200, a0
    v_accvgpr_read_b32 v201, a1
    v_accvgpr_read_b32 v202, a2
    v_accvgpr_read_b32 v203, a3
    v_pk_fma_f32 v[0:1], v[0:1], v[226:227], v[226:227] op_sel:[0,0,0] op_sel_hi:[1,0,0]
    v_pk_fma_f32 v[2:3], v[2:3], v[226:227], v[226:227] op_sel:[0,0,0] op_sel_hi:[1,0,0]
    v_pk_fma_f32 v[32:33], v[32:33], v[226:227], v[226:227] op_sel:[0,0,0] op_sel_hi:[1,0,0]
    v_pk_fma_f32 v[34:35], v[34:35], v[226:227], v[226:227] op_sel:[0,0,0] op_sel_hi:[1,0,0]
    v_rcp_f32 v0, v0
    v_rcp_f32 v1, v1
    v_rcp_f32 v2, v2
    v_rcp_f32 v3, v3
    v_rcp_f32 v32, v32
    v_rcp_f32 v33, v33
    v_rcp_f32 v34, v34
    v_rcp_f32 v35, v35
    v_pk_fma_f32 v[160:161], v[216:217], v[224:225], v[160:161] op_sel:[0,0,0] op_sel_hi:[1,0,1]
    v_pk_fma_f32 v[162:163], v[218:219], v[224:225], v[162:163] op_sel:[0,0,0] op_sel_hi:[1,0,1]
    v_pk_fma_f32 v[200:201], v[220:221], v[224:225], v[200:201] op_sel:[0,0,0] op_sel_hi:[1,0,1]
    v_pk_fma_f32 v[202:203], v[222:223], v[224:225], v[202:203] op_sel:[0,0,0] op_sel_hi:[1,0,1]
    v_pk_mul_f32 v[0:1], v[0:1], v[160:161]
    v_pk_mul_f32 v[2:3], v[2:3], v[162:163]
    v_pk_mul_f32 v[32:33], v[32:33], v[200:201]
    v_pk_mul_f32 v[34:35], v[34:35], v[202:203]
    v_cvt_pk_bf16_f32 v0, v0, v1
    v_cvt_pk_bf16_f32 v1, v2, v3
    v_cvt_pk_bf16_f32 v2, v32, v33
    v_cvt_pk_bf16_f32 v3, v34, v35
    v_and_b32 v0, -2, v0
    s_waitcnt lgkmcnt(2)
    v_pk_fma_f32 v[4:5], v[208:209], v[228:229], v[4:5] op_sel:[0,0,0] op_sel_hi:[1,0,1]
    v_pk_fma_f32 v[6:7], v[210:211], v[228:229], v[6:7] op_sel:[0,0,0] op_sel_hi:[1,0,1]
    v_pk_fma_f32 v[36:37], v[212:213], v[228:229], v[36:37] op_sel:[0,0,0] op_sel_hi:[1,0,1]
    v_pk_fma_f32 v[38:39], v[214:215], v[228:229], v[38:39] op_sel:[0,0,0] op_sel_hi:[1,0,1]
    v_pk_mul_f32 v[4:5], v[4:5], v[228:229] op_sel:[0,1] op_sel_hi:[1,1]
    v_pk_mul_f32 v[6:7], v[6:7], v[228:229] op_sel:[0,1] op_sel_hi:[1,1]
    v_pk_mul_f32 v[36:37], v[36:37], v[228:229] op_sel:[0,1] op_sel_hi:[1,1]
    v_pk_mul_f32 v[38:39], v[38:39], v[228:229] op_sel:[0,1] op_sel_hi:[1,1]
    v_exp_f32 v4, v4
    v_exp_f32 v5, v5
    v_exp_f32 v6, v6
    v_exp_f32 v7, v7
    v_exp_f32 v36, v36
    v_exp_f32 v37, v37
    v_exp_f32 v38, v38
    v_exp_f32 v39, v39
    v_accvgpr_read_b32 v204, a4
    v_accvgpr_read_b32 v205, a5
    v_accvgpr_read_b32 v206, a6
    v_accvgpr_read_b32 v207, a7
    v_pk_fma_f32 v[4:5], v[4:5], v[230:231], v[230:231] op_sel:[0,0,0] op_sel_hi:[1,0,0]
    v_pk_fma_f32 v[6:7], v[6:7], v[230:231], v[230:231] op_sel:[0,0,0] op_sel_hi:[1,0,0]
    v_pk_fma_f32 v[36:37], v[36:37], v[230:231], v[230:231] op_sel:[0,0,0] op_sel_hi:[1,0,0]
    v_pk_fma_f32 v[38:39], v[38:39], v[230:231], v[230:231] op_sel:[0,0,0] op_sel_hi:[1,0,0]
    v_rcp_f32 v4, v4
    v_rcp_f32 v5, v5
    v_rcp_f32 v6, v6
    v_rcp_f32 v7, v7
    v_rcp_f32 v36, v36
    v_rcp_f32 v37, v37
    v_rcp_f32 v38, v38
    v_rcp_f32 v39, v39
    v_pk_fma_f32 v[164:165], v[216:217], v[228:229], v[164:165] op_sel:[0,0,0] op_sel_hi:[1,0,1]
    v_pk_fma_f32 v[166:167], v[218:219], v[228:229], v[166:167] op_sel:[0,0,0] op_sel_hi:[1,0,1]
    v_pk_fma_f32 v[204:205], v[220:221], v[228:229], v[204:205] op_sel:[0,0,0] op_sel_hi:[1,0,1]
    v_pk_fma_f32 v[206:207], v[222:223], v[228:229], v[206:207] op_sel:[0,0,0] op_sel_hi:[1,0,1]
    v_pk_mul_f32 v[4:5], v[4:5], v[164:165]
    v_pk_mul_f32 v[6:7], v[6:7], v[166:167]
    v_pk_mul_f32 v[36:37], v[36:37], v[204:205]
    v_pk_mul_f32 v[38:39], v[38:39], v[206:207]
    v_cvt_pk_bf16_f32 v4, v4, v5
    v_cvt_pk_bf16_f32 v5, v6, v7
    v_cvt_pk_bf16_f32 v6, v36, v37
    v_cvt_pk_bf16_f32 v7, v38, v39
    v_and_b32 v4, -2, v4
    ds_read_b128 v[32:35], v232 offset:1280
    ds_read_b128 v[36:39], v232 offset:1536
    ds_read_b128 v[160:163], v232 offset:1792
    ds_read_b128 v[164:167], v232 offset:2048
    buffer_store_dwordx4 v[0:3], v254, s[40:43], s28 offen offset:1024 sc1
    ds_write_b128 v233, v[0:3] offset:0
    buffer_store_dwordx4 v[4:7], v254, s[40:43], s29 offen offset:1024 sc1
    ds_write_b128 v233, v[4:7] offset:1024
    s_waitcnt lgkmcnt(7)
    v_pk_fma_f32 v[8:9], v[208:209], v[192:193], v[8:9] op_sel:[0,0,0] op_sel_hi:[1,0,1]
    v_pk_fma_f32 v[10:11], v[210:211], v[192:193], v[10:11] op_sel:[0,0,0] op_sel_hi:[1,0,1]
    v_pk_fma_f32 v[40:41], v[212:213], v[192:193], v[40:41] op_sel:[0,0,0] op_sel_hi:[1,0,1]
    v_pk_fma_f32 v[42:43], v[214:215], v[192:193], v[42:43] op_sel:[0,0,0] op_sel_hi:[1,0,1]
    v_pk_mul_f32 v[8:9], v[8:9], v[192:193] op_sel:[0,1] op_sel_hi:[1,1]
    v_pk_mul_f32 v[10:11], v[10:11], v[192:193] op_sel:[0,1] op_sel_hi:[1,1]
    v_pk_mul_f32 v[40:41], v[40:41], v[192:193] op_sel:[0,1] op_sel_hi:[1,1]
    v_pk_mul_f32 v[42:43], v[42:43], v[192:193] op_sel:[0,1] op_sel_hi:[1,1]
    v_exp_f32 v8, v8
    v_exp_f32 v9, v9
    v_exp_f32 v10, v10
    v_exp_f32 v11, v11
    v_exp_f32 v40, v40
    v_exp_f32 v41, v41
    v_exp_f32 v42, v42
    v_exp_f32 v43, v43
    v_accvgpr_read_b32 v200, a8
    v_accvgpr_read_b32 v201, a9
    v_accvgpr_read_b32 v202, a10
    v_accvgpr_read_b32 v203, a11
    v_pk_fma_f32 v[8:9], v[8:9], v[194:195], v[194:195] op_sel:[0,0,0] op_sel_hi:[1,0,0]
    v_pk_fma_f32 v[10:11], v[10:11], v[194:195], v[194:195] op_sel:[0,0,0] op_sel_hi:[1,0,0]
    v_pk_fma_f32 v[40:41], v[40:41], v[194:195], v[194:195] op_sel:[0,0,0] op_sel_hi:[1,0,0]
    v_pk_fma_f32 v[42:43], v[42:43], v[194:195], v[194:195] op_sel:[0,0,0] op_sel_hi:[1,0,0]
    v_rcp_f32 v8, v8
    v_rcp_f32 v9, v9
    v_rcp_f32 v10, v10
    v_rcp_f32 v11, v11
    v_rcp_f32 v40, v40
    v_rcp_f32 v41, v41
    v_rcp_f32 v42, v42
    v_rcp_f32 v43, v43
    v_pk_fma_f32 v[168:169], v[216:217], v[192:193], v[168:169] op_sel:[0,0,0] op_sel_hi:[1,0,1]
    v_pk_fma_f32 v[170:171], v[218:219], v[192:193], v[170:171] op_sel:[0,0,0] op_sel_hi:[1,0,1]
    v_pk_fma_f32 v[200:201], v[220:221], v[192:193], v[200:201] op_sel:[0,0,0] op_sel_hi:[1,0,1]
    v_pk_fma_f32 v[202:203], v[222:223], v[192:193], v[202:203] op_sel:[0,0,0] op_sel_hi:[1,0,1]
    v_pk_mul_f32 v[8:9], v[8:9], v[168:169]
    v_pk_mul_f32 v[10:11], v[10:11], v[170:171]
    v_pk_mul_f32 v[40:41], v[40:41], v[200:201]
    v_pk_mul_f32 v[42:43], v[42:43], v[202:203]
    v_cvt_pk_bf16_f32 v8, v8, v9
    v_cvt_pk_bf16_f32 v9, v10, v11
    v_cvt_pk_bf16_f32 v10, v40, v41
    v_cvt_pk_bf16_f32 v11, v42, v43
    v_and_b32 v8, -2, v8
    s_waitcnt lgkmcnt(6)
    v_pk_fma_f32 v[12:13], v[208:209], v[196:197], v[12:13] op_sel:[0,0,0] op_sel_hi:[1,0,1]
    v_pk_fma_f32 v[14:15], v[210:211], v[196:197], v[14:15] op_sel:[0,0,0] op_sel_hi:[1,0,1]
    v_pk_fma_f32 v[44:45], v[212:213], v[196:197], v[44:45] op_sel:[0,0,0] op_sel_hi:[1,0,1]
    v_pk_fma_f32 v[46:47], v[214:215], v[196:197], v[46:47] op_sel:[0,0,0] op_sel_hi:[1,0,1]
    v_pk_mul_f32 v[12:13], v[12:13], v[196:197] op_sel:[0,1] op_sel_hi:[1,1]
    v_pk_mul_f32 v[14:15], v[14:15], v[196:197] op_sel:[0,1] op_sel_hi:[1,1]
    v_pk_mul_f32 v[44:45], v[44:45], v[196:197] op_sel:[0,1] op_sel_hi:[1,1]
    v_pk_mul_f32 v[46:47], v[46:47], v[196:197] op_sel:[0,1] op_sel_hi:[1,1]
    v_exp_f32 v12, v12
    v_exp_f32 v13, v13
    v_exp_f32 v14, v14
    v_exp_f32 v15, v15
    v_exp_f32 v44, v44
    v_exp_f32 v45, v45
    v_exp_f32 v46, v46
    v_exp_f32 v47, v47
    v_accvgpr_read_b32 v204, a12
    v_accvgpr_read_b32 v205, a13
    v_accvgpr_read_b32 v206, a14
    v_accvgpr_read_b32 v207, a15
    v_pk_fma_f32 v[12:13], v[12:13], v[198:199], v[198:199] op_sel:[0,0,0] op_sel_hi:[1,0,0]
    v_pk_fma_f32 v[14:15], v[14:15], v[198:199], v[198:199] op_sel:[0,0,0] op_sel_hi:[1,0,0]
    v_pk_fma_f32 v[44:45], v[44:45], v[198:199], v[198:199] op_sel:[0,0,0] op_sel_hi:[1,0,0]
    v_pk_fma_f32 v[46:47], v[46:47], v[198:199], v[198:199] op_sel:[0,0,0] op_sel_hi:[1,0,0]
    v_rcp_f32 v12, v12
    v_rcp_f32 v13, v13
    v_rcp_f32 v14, v14
    v_rcp_f32 v15, v15
    v_rcp_f32 v44, v44
    v_rcp_f32 v45, v45
    v_rcp_f32 v46, v46
    v_rcp_f32 v47, v47
    v_pk_fma_f32 v[172:173], v[216:217], v[196:197], v[172:173] op_sel:[0,0,0] op_sel_hi:[1,0,1]
    v_pk_fma_f32 v[174:175], v[218:219], v[196:197], v[174:175] op_sel:[0,0,0] op_sel_hi:[1,0,1]
    v_pk_fma_f32 v[204:205], v[220:221], v[196:197], v[204:205] op_sel:[0,0,0] op_sel_hi:[1,0,1]
    v_pk_fma_f32 v[206:207], v[222:223], v[196:197], v[206:207] op_sel:[0,0,0] op_sel_hi:[1,0,1]
    v_pk_mul_f32 v[12:13], v[12:13], v[172:173]
    v_pk_mul_f32 v[14:15], v[14:15], v[174:175]
    v_pk_mul_f32 v[44:45], v[44:45], v[204:205]
    v_pk_mul_f32 v[46:47], v[46:47], v[206:207]
    v_cvt_pk_bf16_f32 v12, v12, v13
    v_cvt_pk_bf16_f32 v13, v14, v15
    v_cvt_pk_bf16_f32 v14, v44, v45
    v_cvt_pk_bf16_f32 v15, v46, v47
    v_and_b32 v12, -2, v12
    ds_read_b128 v[40:43], v238 offset:128
    ds_read_b128 v[44:47], v238 offset:192
    ds_read_b128 v[168:171], v238 offset:448
    ds_read_b128 v[172:175], v238 offset:512
    buffer_store_dwordx4 v[8:11], v254, s[40:43], s30 offen offset:1024 sc1
    ds_write_b128 v233, v[8:11] offset:2048
    buffer_store_dwordx4 v[12:15], v254, s[40:43], s31 offen offset:1024 sc1
    ds_write_b128 v233, v[12:15] offset:3072
    s_waitcnt lgkmcnt(11)
    v_pk_fma_f32 v[16:17], v[208:209], v[32:33], v[16:17] op_sel:[0,0,0] op_sel_hi:[1,0,1]
    v_pk_fma_f32 v[18:19], v[210:211], v[32:33], v[18:19] op_sel:[0,0,0] op_sel_hi:[1,0,1]
    v_pk_fma_f32 v[48:49], v[212:213], v[32:33], v[48:49] op_sel:[0,0,0] op_sel_hi:[1,0,1]
    v_pk_fma_f32 v[50:51], v[214:215], v[32:33], v[50:51] op_sel:[0,0,0] op_sel_hi:[1,0,1]
    v_pk_mul_f32 v[16:17], v[16:17], v[32:33] op_sel:[0,1] op_sel_hi:[1,1]
    v_pk_mul_f32 v[18:19], v[18:19], v[32:33] op_sel:[0,1] op_sel_hi:[1,1]
    v_pk_mul_f32 v[48:49], v[48:49], v[32:33] op_sel:[0,1] op_sel_hi:[1,1]
    v_pk_mul_f32 v[50:51], v[50:51], v[32:33] op_sel:[0,1] op_sel_hi:[1,1]
    v_exp_f32 v16, v16
    v_exp_f32 v17, v17
    v_exp_f32 v18, v18
    v_exp_f32 v19, v19
    v_exp_f32 v48, v48
    v_exp_f32 v49, v49
    v_exp_f32 v50, v50
    v_exp_f32 v51, v51
    v_accvgpr_read_b32 v200, a16
    v_accvgpr_read_b32 v201, a17
    v_accvgpr_read_b32 v202, a18
    v_accvgpr_read_b32 v203, a19
    v_pk_fma_f32 v[16:17], v[16:17], v[34:35], v[34:35] op_sel:[0,0,0] op_sel_hi:[1,0,0]
    v_pk_fma_f32 v[18:19], v[18:19], v[34:35], v[34:35] op_sel:[0,0,0] op_sel_hi:[1,0,0]
    v_pk_fma_f32 v[48:49], v[48:49], v[34:35], v[34:35] op_sel:[0,0,0] op_sel_hi:[1,0,0]
    v_pk_fma_f32 v[50:51], v[50:51], v[34:35], v[34:35] op_sel:[0,0,0] op_sel_hi:[1,0,0]
    v_rcp_f32 v16, v16
    v_rcp_f32 v17, v17
    v_rcp_f32 v18, v18
    v_rcp_f32 v19, v19
    v_rcp_f32 v48, v48
    v_rcp_f32 v49, v49
    v_rcp_f32 v50, v50
    v_rcp_f32 v51, v51
    v_pk_fma_f32 v[176:177], v[216:217], v[32:33], v[176:177] op_sel:[0,0,0] op_sel_hi:[1,0,1]
    v_pk_fma_f32 v[178:179], v[218:219], v[32:33], v[178:179] op_sel:[0,0,0] op_sel_hi:[1,0,1]
    v_pk_fma_f32 v[200:201], v[220:221], v[32:33], v[200:201] op_sel:[0,0,0] op_sel_hi:[1,0,1]
    v_pk_fma_f32 v[202:203], v[222:223], v[32:33], v[202:203] op_sel:[0,0,0] op_sel_hi:[1,0,1]
    v_pk_mul_f32 v[16:17], v[16:17], v[176:177]
    v_pk_mul_f32 v[18:19], v[18:19], v[178:179]
    v_pk_mul_f32 v[48:49], v[48:49], v[200:201]
    v_pk_mul_f32 v[50:51], v[50:51], v[202:203]
    v_cvt_pk_bf16_f32 v16, v16, v17
    v_cvt_pk_bf16_f32 v17, v18, v19
    v_cvt_pk_bf16_f32 v18, v48, v49
    v_cvt_pk_bf16_f32 v19, v50, v51
    v_and_b32 v16, -2, v16
    s_waitcnt lgkmcnt(10)
    v_pk_fma_f32 v[20:21], v[208:209], v[36:37], v[20:21] op_sel:[0,0,0] op_sel_hi:[1,0,1]
    v_pk_fma_f32 v[22:23], v[210:211], v[36:37], v[22:23] op_sel:[0,0,0] op_sel_hi:[1,0,1]
    v_pk_fma_f32 v[52:53], v[212:213], v[36:37], v[52:53] op_sel:[0,0,0] op_sel_hi:[1,0,1]
    v_pk_fma_f32 v[54:55], v[214:215], v[36:37], v[54:55] op_sel:[0,0,0] op_sel_hi:[1,0,1]
    v_pk_mul_f32 v[20:21], v[20:21], v[36:37] op_sel:[0,1] op_sel_hi:[1,1]
    v_pk_mul_f32 v[22:23], v[22:23], v[36:37] op_sel:[0,1] op_sel_hi:[1,1]
    v_pk_mul_f32 v[52:53], v[52:53], v[36:37] op_sel:[0,1] op_sel_hi:[1,1]
    v_pk_mul_f32 v[54:55], v[54:55], v[36:37] op_sel:[0,1] op_sel_hi:[1,1]
    v_exp_f32 v20, v20
    v_exp_f32 v21, v21
    v_exp_f32 v22, v22
    v_exp_f32 v23, v23
    v_exp_f32 v52, v52
    v_exp_f32 v53, v53
    v_exp_f32 v54, v54
    v_exp_f32 v55, v55
    v_accvgpr_read_b32 v204, a20
    v_accvgpr_read_b32 v205, a21
    v_accvgpr_read_b32 v206, a22
    v_accvgpr_read_b32 v207, a23
    v_pk_fma_f32 v[20:21], v[20:21], v[38:39], v[38:39] op_sel:[0,0,0] op_sel_hi:[1,0,0]
    v_pk_fma_f32 v[22:23], v[22:23], v[38:39], v[38:39] op_sel:[0,0,0] op_sel_hi:[1,0,0]
    v_pk_fma_f32 v[52:53], v[52:53], v[38:39], v[38:39] op_sel:[0,0,0] op_sel_hi:[1,0,0]
    v_pk_fma_f32 v[54:55], v[54:55], v[38:39], v[38:39] op_sel:[0,0,0] op_sel_hi:[1,0,0]
    v_rcp_f32 v20, v20
    v_rcp_f32 v21, v21
    v_rcp_f32 v22, v22
    v_rcp_f32 v23, v23
    v_rcp_f32 v52, v52
    v_rcp_f32 v53, v53
    v_rcp_f32 v54, v54
    v_rcp_f32 v55, v55
    v_pk_fma_f32 v[180:181], v[216:217], v[36:37], v[180:181] op_sel:[0,0,0] op_sel_hi:[1,0,1]
    v_pk_fma_f32 v[182:183], v[218:219], v[36:37], v[182:183] op_sel:[0,0,0] op_sel_hi:[1,0,1]
    v_pk_fma_f32 v[204:205], v[220:221], v[36:37], v[204:205] op_sel:[0,0,0] op_sel_hi:[1,0,1]
    v_pk_fma_f32 v[206:207], v[222:223], v[36:37], v[206:207] op_sel:[0,0,0] op_sel_hi:[1,0,1]
    v_pk_mul_f32 v[20:21], v[20:21], v[180:181]
    v_pk_mul_f32 v[22:23], v[22:23], v[182:183]
    v_pk_mul_f32 v[52:53], v[52:53], v[204:205]
    v_pk_mul_f32 v[54:55], v[54:55], v[206:207]
    v_cvt_pk_bf16_f32 v20, v20, v21
    v_cvt_pk_bf16_f32 v21, v22, v23
    v_cvt_pk_bf16_f32 v22, v52, v53
    v_cvt_pk_bf16_f32 v23, v54, v55
    v_and_b32 v20, -2, v20
    ds_read_b128 v[48:51], v238 offset:256
    ds_read_b128 v[52:55], v238 offset:576
    buffer_store_dwordx4 v[16:19], v254, s[40:43], s32 offen offset:1024 sc1
    ds_write_b128 v233, v[16:19] offset:4096
    buffer_store_dwordx4 v[20:23], v254, s[40:43], s33 offen offset:1024 sc1
    ds_write_b128 v233, v[20:23] offset:5120
    s_waitcnt lgkmcnt(13)
    v_pk_fma_f32 v[24:25], v[208:209], v[160:161], v[24:25] op_sel:[0,0,0] op_sel_hi:[1,0,1]
    v_pk_fma_f32 v[26:27], v[210:211], v[160:161], v[26:27] op_sel:[0,0,0] op_sel_hi:[1,0,1]
    v_pk_fma_f32 v[56:57], v[212:213], v[160:161], v[56:57] op_sel:[0,0,0] op_sel_hi:[1,0,1]
    v_pk_fma_f32 v[58:59], v[214:215], v[160:161], v[58:59] op_sel:[0,0,0] op_sel_hi:[1,0,1]
    v_pk_mul_f32 v[24:25], v[24:25], v[160:161] op_sel:[0,1] op_sel_hi:[1,1]
    v_pk_mul_f32 v[26:27], v[26:27], v[160:161] op_sel:[0,1] op_sel_hi:[1,1]
    v_pk_mul_f32 v[56:57], v[56:57], v[160:161] op_sel:[0,1] op_sel_hi:[1,1]
    v_pk_mul_f32 v[58:59], v[58:59], v[160:161] op_sel:[0,1] op_sel_hi:[1,1]
    v_exp_f32 v24, v24
    v_exp_f32 v25, v25
    v_exp_f32 v26, v26
    v_exp_f32 v27, v27
    v_exp_f32 v56, v56
    v_exp_f32 v57, v57
    v_exp_f32 v58, v58
    v_exp_f32 v59, v59
    v_accvgpr_read_b32 v200, a24
    v_accvgpr_read_b32 v201, a25
    v_accvgpr_read_b32 v202, a26
    v_accvgpr_read_b32 v203, a27
    v_pk_fma_f32 v[24:25], v[24:25], v[162:163], v[162:163] op_sel:[0,0,0] op_sel_hi:[1,0,0]
    v_pk_fma_f32 v[26:27], v[26:27], v[162:163], v[162:163] op_sel:[0,0,0] op_sel_hi:[1,0,0]
    v_pk_fma_f32 v[56:57], v[56:57], v[162:163], v[162:163] op_sel:[0,0,0] op_sel_hi:[1,0,0]
    v_pk_fma_f32 v[58:59], v[58:59], v[162:163], v[162:163] op_sel:[0,0,0] op_sel_hi:[1,0,0]
    v_rcp_f32 v24, v24
    v_rcp_f32 v25, v25
    v_rcp_f32 v26, v26
    v_rcp_f32 v27, v27
    v_rcp_f32 v56, v56
    v_rcp_f32 v57, v57
    v_rcp_f32 v58, v58
    v_rcp_f32 v59, v59
    v_pk_fma_f32 v[184:185], v[216:217], v[160:161], v[184:185] op_sel:[0,0,0] op_sel_hi:[1,0,1]
    v_pk_fma_f32 v[186:187], v[218:219], v[160:161], v[186:187] op_sel:[0,0,0] op_sel_hi:[1,0,1]
    v_pk_fma_f32 v[200:201], v[220:221], v[160:161], v[200:201] op_sel:[0,0,0] op_sel_hi:[1,0,1]
    v_pk_fma_f32 v[202:203], v[222:223], v[160:161], v[202:203] op_sel:[0,0,0] op_sel_hi:[1,0,1]
    v_pk_mul_f32 v[24:25], v[24:25], v[184:185]
    v_pk_mul_f32 v[26:27], v[26:27], v[186:187]
    v_pk_mul_f32 v[56:57], v[56:57], v[200:201]
    v_pk_mul_f32 v[58:59], v[58:59], v[202:203]
    v_cvt_pk_bf16_f32 v24, v24, v25
    v_cvt_pk_bf16_f32 v25, v26, v27
    v_cvt_pk_bf16_f32 v26, v56, v57
    v_cvt_pk_bf16_f32 v27, v58, v59
    v_and_b32 v24, -2, v24
    s_waitcnt lgkmcnt(12)
    v_pk_fma_f32 v[28:29], v[208:209], v[164:165], v[28:29] op_sel:[0,0,0] op_sel_hi:[1,0,1]
    v_pk_fma_f32 v[30:31], v[210:211], v[164:165], v[30:31] op_sel:[0,0,0] op_sel_hi:[1,0,1]
    v_pk_fma_f32 v[60:61], v[212:213], v[164:165], v[60:61] op_sel:[0,0,0] op_sel_hi:[1,0,1]
    v_pk_fma_f32 v[62:63], v[214:215], v[164:165], v[62:63] op_sel:[0,0,0] op_sel_hi:[1,0,1]
    v_pk_mul_f32 v[28:29], v[28:29], v[164:165] op_sel:[0,1] op_sel_hi:[1,1]
    v_pk_mul_f32 v[30:31], v[30:31], v[164:165] op_sel:[0,1] op_sel_hi:[1,1]
    v_pk_mul_f32 v[60:61], v[60:61], v[164:165] op_sel:[0,1] op_sel_hi:[1,1]
    v_pk_mul_f32 v[62:63], v[62:63], v[164:165] op_sel:[0,1] op_sel_hi:[1,1]
    v_exp_f32 v28, v28
    v_exp_f32 v29, v29
    v_exp_f32 v30, v30
    v_exp_f32 v31, v31
    v_exp_f32 v60, v60
    v_exp_f32 v61, v61
    v_exp_f32 v62, v62
    v_exp_f32 v63, v63
    v_accvgpr_read_b32 v204, a28
    v_accvgpr_read_b32 v205, a29
    v_accvgpr_read_b32 v206, a30
    v_accvgpr_read_b32 v207, a31
    v_pk_fma_f32 v[28:29], v[28:29], v[166:167], v[166:167] op_sel:[0,0,0] op_sel_hi:[1,0,0]
    v_pk_fma_f32 v[30:31], v[30:31], v[166:167], v[166:167] op_sel:[0,0,0] op_sel_hi:[1,0,0]
    v_pk_fma_f32 v[60:61], v[60:61], v[166:167], v[166:167] op_sel:[0,0,0] op_sel_hi:[1,0,0]
    v_pk_fma_f32 v[62:63], v[62:63], v[166:167], v[166:167] op_sel:[0,0,0] op_sel_hi:[1,0,0]
    v_rcp_f32 v28, v28
    v_rcp_f32 v29, v29
    v_rcp_f32 v30, v30
    v_rcp_f32 v31, v31
    v_rcp_f32 v60, v60
    v_rcp_f32 v61, v61
    v_rcp_f32 v62, v62
    v_rcp_f32 v63, v63
    v_pk_fma_f32 v[188:189], v[216:217], v[164:165], v[188:189] op_sel:[0,0,0] op_sel_hi:[1,0,1]
    v_pk_fma_f32 v[190:191], v[218:219], v[164:165], v[190:191] op_sel:[0,0,0] op_sel_hi:[1,0,1]
    v_pk_fma_f32 v[204:205], v[220:221], v[164:165], v[204:205] op_sel:[0,0,0] op_sel_hi:[1,0,1]
    v_pk_fma_f32 v[206:207], v[222:223], v[164:165], v[206:207] op_sel:[0,0,0] op_sel_hi:[1,0,1]
    v_pk_mul_f32 v[28:29], v[28:29], v[188:189]
    v_pk_mul_f32 v[30:31], v[30:31], v[190:191]
    v_pk_mul_f32 v[60:61], v[60:61], v[204:205]
    v_pk_mul_f32 v[62:63], v[62:63], v[206:207]
    v_cvt_pk_bf16_f32 v28, v28, v29
    v_cvt_pk_bf16_f32 v29, v30, v31
    v_cvt_pk_bf16_f32 v30, v60, v61
    v_cvt_pk_bf16_f32 v31, v62, v63
    v_and_b32 v28, -2, v28
    buffer_store_dwordx4 v[24:27], v254, s[40:43], s34 offen offset:1024 sc1
    ds_write_b128 v233, v[24:27] offset:6144
    buffer_store_dwordx4 v[28:31], v254, s[40:43], s35 offen offset:1024 sc1
    ds_write_b128 v233, v[28:31] offset:7168
    s_waitcnt lgkmcnt(11)
    v_pk_fma_f32 v[64:65], v[40:41], v[224:225], v[64:65] op_sel:[0,0,0] op_sel_hi:[1,0,1]
    v_pk_fma_f32 v[66:67], v[42:43], v[224:225], v[66:67] op_sel:[0,0,0] op_sel_hi:[1,0,1]
    s_waitcnt lgkmcnt(10)
    v_pk_fma_f32 v[96:97], v[44:45], v[224:225], v[96:97] op_sel:[0,0,0] op_sel_hi:[1,0,1]
    v_pk_fma_f32 v[98:99], v[46:47], v[224:225], v[98:99] op_sel:[0,0,0] op_sel_hi:[1,0,1]
    v_pk_mul_f32 v[64:65], v[64:65], v[224:225] op_sel:[0,1] op_sel_hi:[1,1]
    v_pk_mul_f32 v[66:67], v[66:67], v[224:225] op_sel:[0,1] op_sel_hi:[1,1]
    v_pk_mul_f32 v[96:97], v[96:97], v[224:225] op_sel:[0,1] op_sel_hi:[1,1]
    v_pk_mul_f32 v[98:99], v[98:99], v[224:225] op_sel:[0,1] op_sel_hi:[1,1]
    v_exp_f32 v64, v64
    v_exp_f32 v65, v65
    v_exp_f32 v66, v66
    v_exp_f32 v67, v67
    v_exp_f32 v96, v96
    v_exp_f32 v97, v97
    v_exp_f32 v98, v98
    v_exp_f32 v99, v99
    v_accvgpr_read_b32 v200, a32
    v_accvgpr_read_b32 v201, a33
    v_accvgpr_read_b32 v202, a34
    v_accvgpr_read_b32 v203, a35
    v_accvgpr_read_b32 v204, a64
    v_accvgpr_read_b32 v205, a65
    v_accvgpr_read_b32 v206, a66
    v_accvgpr_read_b32 v207, a67
    v_pk_fma_f32 v[64:65], v[64:65], v[226:227], v[226:227] op_sel:[0,0,0] op_sel_hi:[1,0,0]
    v_pk_fma_f32 v[66:67], v[66:67], v[226:227], v[226:227] op_sel:[0,0,0] op_sel_hi:[1,0,0]
    v_pk_fma_f32 v[96:97], v[96:97], v[226:227], v[226:227] op_sel:[0,0,0] op_sel_hi:[1,0,0]
    v_pk_fma_f32 v[98:99], v[98:99], v[226:227], v[226:227] op_sel:[0,0,0] op_sel_hi:[1,0,0]
    v_rcp_f32 v64, v64
    v_rcp_f32 v65, v65
    v_rcp_f32 v66, v66
    v_rcp_f32 v67, v67
    v_rcp_f32 v96, v96
    v_rcp_f32 v97, v97
    v_rcp_f32 v98, v98
    v_rcp_f32 v99, v99
    s_waitcnt lgkmcnt(9)
    v_pk_fma_f32 v[200:201], v[168:169], v[224:225], v[200:201] op_sel:[0,0,0] op_sel_hi:[1,0,1]
    v_pk_fma_f32 v[202:203], v[170:171], v[224:225], v[202:203] op_sel:[0,0,0] op_sel_hi:[1,0,1]
    s_waitcnt lgkmcnt(8)
    v_pk_fma_f32 v[204:205], v[172:173], v[224:225], v[204:205] op_sel:[0,0,0] op_sel_hi:[1,0,1]
    v_pk_fma_f32 v[206:207], v[174:175], v[224:225], v[206:207] op_sel:[0,0,0] op_sel_hi:[1,0,1]
    v_pk_mul_f32 v[64:65], v[64:65], v[200:201]
    v_pk_mul_f32 v[66:67], v[66:67], v[202:203]
    v_pk_mul_f32 v[96:97], v[96:97], v[204:205]
    v_pk_mul_f32 v[98:99], v[98:99], v[206:207]
    v_cvt_pk_bf16_f32 v64, v64, v65
    v_cvt_pk_bf16_f32 v65, v66, v67
    v_cvt_pk_bf16_f32 v66, v96, v97
    v_cvt_pk_bf16_f32 v67, v98, v99
    v_and_b32 v64, -2, v64
    v_pk_fma_f32 v[68:69], v[40:41], v[228:229], v[68:69] op_sel:[0,0,0] op_sel_hi:[1,0,1]
    v_pk_fma_f32 v[70:71], v[42:43], v[228:229], v[70:71] op_sel:[0,0,0] op_sel_hi:[1,0,1]
    v_pk_fma_f32 v[100:101], v[44:45], v[228:229], v[100:101] op_sel:[0,0,0] op_sel_hi:[1,0,1]
    v_pk_fma_f32 v[102:103], v[46:47], v[228:229], v[102:103] op_sel:[0,0,0] op_sel_hi:[1,0,1]
    v_pk_mul_f32 v[68:69], v[68:69], v[228:229] op_sel:[0,1] op_sel_hi:[1,1]
    v_pk_mul_f32 v[70:71], v[70:71], v[228:229] op_sel:[0,1] op_sel_hi:[1,1]
    v_pk_mul_f32 v[100:101], v[100:101], v[228:229] op_sel:[0,1] op_sel_hi:[1,1]
    v_pk_mul_f32 v[102:103], v[102:103], v[228:229] op_sel:[0,1] op_sel_hi:[1,1]
    v_exp_f32 v68, v68
    v_exp_f32 v69, v69
    v_exp_f32 v70, v70
    v_exp_f32 v71, v71
    v_exp_f32 v100, v100
    v_exp_f32 v101, v101
    v_exp_f32 v102, v102
    v_exp_f32 v103, v103
    v_accvgpr_read_b32 v176, a36
    v_accvgpr_read_b32 v177, a37
    v_accvgpr_read_b32 v178, a38
    v_accvgpr_read_b32 v179, a39
    v_accvgpr_read_b32 v180, a68
    v_accvgpr_read_b32 v181, a69
    v_accvgpr_read_b32 v182, a70
    v_accvgpr_read_b32 v183, a71
    v_pk_fma_f32 v[68:69], v[68:69], v[230:231], v[230:231] op_sel:[0,0,0] op_sel_hi:[1,0,0]
    v_pk_fma_f32 v[70:71], v[70:71], v[230:231], v[230:231] op_sel:[0,0,0] op_sel_hi:[1,0,0]
    v_pk_fma_f32 v[100:101], v[100:101], v[230:231], v[230:231] op_sel:[0,0,0] op_sel_hi:[1,0,0]
    v_pk_fma_f32 v[102:103], v[102:103], v[230:231], v[230:231] op_sel:[0,0,0] op_sel_hi:[1,0,0]
    v_rcp_f32 v68, v68
    v_rcp_f32 v69, v69
    v_rcp_f32 v70, v70
    v_rcp_f32 v71, v71
    v_rcp_f32 v100, v100
    v_rcp_f32 v101, v101
    v_rcp_f32 v102, v102
    v_rcp_f32 v103, v103
    v_pk_fma_f32 v[176:177], v[168:169], v[228:229], v[176:177] op_sel:[0,0,0] op_sel_hi:[1,0,1]
    v_pk_fma_f32 v[178:179], v[170:171], v[228:229], v[178:179] op_sel:[0,0,0] op_sel_hi:[1,0,1]
    v_pk_fma_f32 v[180:181], v[172:173], v[228:229], v[180:181] op_sel:[0,0,0] op_sel_hi:[1,0,1]
    v_pk_fma_f32 v[182:183], v[174:175], v[228:229], v[182:183] op_sel:[0,0,0] op_sel_hi:[1,0,1]
    v_pk_mul_f32 v[68:69], v[68:69], v[176:177]
    v_pk_mul_f32 v[70:71], v[70:71], v[178:179]
    v_pk_mul_f32 v[100:101], v[100:101], v[180:181]
    v_pk_mul_f32 v[102:103], v[102:103], v[182:183]
    v_cvt_pk_bf16_f32 v68, v68, v69
    v_cvt_pk_bf16_f32 v69, v70, v71
    v_cvt_pk_bf16_f32 v70, v100, v101
    v_cvt_pk_bf16_f32 v71, v102, v103
    v_and_b32 v68, -2, v68
    buffer_store_dwordx4 v[64:67], v254, s[40:43], s28 offen offset:2048 sc1
    ds_write_b128 v233, v[64:67] offset:32768
    buffer_store_dwordx4 v[68:71], v254, s[40:43], s29 offen offset:2048 sc1
    ds_write_b128 v233, v[68:71] offset:33792
    s_waitcnt vmcnt(2)
    s_cmp_eq_u32 s78, 0
    s_cbranch_scc1 L_fl_e1
    buffer_wbl2 sc1
    s_waitcnt vmcnt(0)
L_fl_e1:
    s_mov_b64 exec, 1
    buffer_store_dword v239, v254, s[44:47], s10 offen offset:0
    buffer_store_dword v239, v254, s[44:47], s10 offen offset:128 sc1
    s_mov_b64 exec, -1
    v_pk_fma_f32 v[72:73], v[40:41], v[192:193], v[72:73] op_sel:[0,0,0] op_sel_hi:[1,0,1]
    v_pk_fma_f32 v[74:75], v[42:43], v[192:193], v[74:75] op_sel:[0,0,0] op_sel_hi:[1,0,1]
    v_pk_fma_f32 v[104:105], v[44:45], v[192:193], v[104:105] op_sel:[0,0,0] op_sel_hi:[1,0,1]
    v_pk_fma_f32 v[106:107], v[46:47], v[192:193], v[106:107] op_sel:[0,0,0] op_sel_hi:[1,0,1]
    v_pk_mul_f32 v[72:73], v[72:73], v[192:193] op_sel:[0,1] op_sel_hi:[1,1]
    v_pk_mul_f32 v[74:75], v[74:75], v[192:193] op_sel:[0,1] op_sel_hi:[1,1]
    v_pk_mul_f32 v[104:105], v[104:105], v[192:193] op_sel:[0,1] op_sel_hi:[1,1]
    v_pk_mul_f32 v[106:107], v[106:107], v[192:193] op_sel:[0,1] op_sel_hi:[1,1]
    v_exp_f32 v72, v72
    v_exp_f32 v73, v73
    v_exp_f32 v74, v74
    v_exp_f32 v75, v75
    v_exp_f32 v104, v104
    v_exp_f32 v105, v105
    v_exp_f32 v106, v106
    v_exp_f32 v107, v107
    v_accvgpr_read_b32 v200, a40
    v_accvgpr_read_b32 v201, a41
    v_accvgpr_read_b32 v202, a42
    v_accvgpr_read_b32 v203, a43
    v_accvgpr_read_b32 v204, a72
    v_accvgpr_read_b32 v205, a73
    v_accvgpr_read_b32 v206, a74
    v_accvgpr_read_b32 v207, a75
    v_pk_fma_f32 v[72:73], v[72:73], v[194:195], v[194:195] op_sel:[0,0,0] op_sel_hi:[1,0,0]
    v_pk_fma_f32 v[74:75], v[74:75], v[194:195], v[194:195] op_sel:[0,0,0] op_sel_hi:[1,0,0]
    v_pk_fma_f32 v[104:105], v[104:105], v[194:195], v[194:195] op_sel:[0,0,0] op_sel_hi:[1,0,0]
    v_pk_fma_f32 v[106:107], v[106:107], v[194:195], v[194:195] op_sel:[0,0,0] op_sel_hi:[1,0,0]
    v_rcp_f32 v72, v72
    v_rcp_f32 v73, v73
    v_rcp_f32 v74, v74
    v_rcp_f32 v75, v75
    v_rcp_f32 v104, v104
    v_rcp_f32 v105, v105
    v_rcp_f32 v106, v106
    v_rcp_f32 v107, v107
    v_pk_fma_f32 v[200:201], v[168:169], v[192:193], v[200:201] op_sel:[0,0,0] op_sel_hi:[1,0,1]
    v_pk_fma_f32 v[202:203], v[170:171], v[192:193], v[202:203] op_sel:[0,0,0] op_sel_hi:[1,0,1]
    v_pk_fma_f32 v[204:205], v[172:173], v[192:193], v[204:205] op_sel:[0,0,0] op_sel_hi:[1,0,1]
    v_pk_fma_f32 v[206:207], v[174:175], v[192:193], v[206:207] op_sel:[0,0,0] op_sel_hi:[1,0,1]
    v_pk_mul_f32 v[72:73], v[72:73], v[200:201]
    v_pk_mul_f32 v[74:75], v[74:75], v[202:203]
    v_pk_mul_f32 v[104:105], v[104:105], v[204:205]
    v_pk_mul_f32 v[106:107], v[106:107], v[206:207]
    v_cvt_pk_bf16_f32 v72, v72, v73
    v_cvt_pk_bf16_f32 v73, v74, v75
    v_cvt_pk_bf16_f32 v74, v104, v105
    v_cvt_pk_bf16_f32 v75, v106, v107
    v_and_b32 v72, -2, v72
    v_pk_fma_f32 v[76:77], v[40:41], v[196:197], v[76:77] op_sel:[0,0,0] op_sel_hi:[1,0,1]
    v_pk_fma_f32 v[78:79], v[42:43], v[196:197], v[78:79] op_sel:[0,0,0] op_sel_hi:[1,0,1]
    v_pk_fma_f32 v[108:109], v[44:45], v[196:197], v[108:109] op_sel:[0,0,0] op_sel_hi:[1,0,1]
    v_pk_fma_f32 v[110:111], v[46:47], v[196:197], v[110:111] op_sel:[0,0,0] op_sel_hi:[1,0,1]
    v_pk_mul_f32 v[76:77], v[76:77], v[196:197] op_sel:[0,1] op_sel_hi:[1,1]
    v_pk_mul_f32 v[78:79], v[78:79], v[196:197] op_sel:[0,1] op_sel_hi:[1,1]
    v_pk_mul_f32 v[108:109], v[108:109], v[196:197] op_sel:[0,1] op_sel_hi:[1,1]
    v_pk_mul_f32 v[110:111], v[110:111], v[196:197] op_sel:[0,1] op_sel_hi:[1,1]
    v_exp_f32 v76, v76
    v_exp_f32 v77, v77
    v_exp_f32 v78, v78
    v_exp_f32 v79, v79
    v_exp_f32 v108, v108
    v_exp_f32 v109, v109
    v_exp_f32 v110, v110
    v_exp_f32 v111, v111
    v_accvgpr_read_b32 v176, a44
    v_accvgpr_read_b32 v177, a45
    v_accvgpr_read_b32 v178, a46
    v_accvgpr_read_b32 v179, a47
    v_accvgpr_read_b32 v180, a76
    v_accvgpr_read_b32 v181, a77
    v_accvgpr_read_b32 v182, a78
    v_accvgpr_read_b32 v183, a79
    v_pk_fma_f32 v[76:77], v[76:77], v[198:199], v[198:199] op_sel:[0,0,0] op_sel_hi:[1,0,0]
    v_pk_fma_f32 v[78:79], v[78:79], v[198:199], v[198:199] op_sel:[0,0,0] op_sel_hi:[1,0,0]
    v_pk_fma_f32 v[108:109], v[108:109], v[198:199], v[198:199] op_sel:[0,0,0] op_sel_hi:[1,0,0]
    v_pk_fma_f32 v[110:111], v[110:111], v[198:199], v[198:199] op_sel:[0,0,0] op_sel_hi:[1,0,0]
    v_rcp_f32 v76, v76
    v_rcp_f32 v77, v77
    v_rcp_f32 v78, v78
    v_rcp_f32 v79, v79
    v_rcp_f32 v108, v108
    v_rcp_f32 v109, v109
    v_rcp_f32 v110, v110
    v_rcp_f32 v111, v111
    v_pk_fma_f32 v[176:177], v[168:169], v[196:197], v[176:177] op_sel:[0,0,0] op_sel_hi:[1,0,1]
    v_pk_fma_f32 v[178:179], v[170:171], v[196:197], v[178:179] op_sel:[0,0,0] op_sel_hi:[1,0,1]
    v_pk_fma_f32 v[180:181], v[172:173], v[196:197], v[180:181] op_sel:[0,0,0] op_sel_hi:[1,0,1]
    v_pk_fma_f32 v[182:183], v[174:175], v[196:197], v[182:183] op_sel:[0,0,0] op_sel_hi:[1,0,1]
    v_pk_mul_f32 v[76:77], v[76:77], v[176:177]
    v_pk_mul_f32 v[78:79], v[78:79], v[178:179]
    v_pk_mul_f32 v[108:109], v[108:109], v[180:181]
    v_pk_mul_f32 v[110:111], v[110:111], v[182:183]
    v_cvt_pk_bf16_f32 v76, v76, v77
    v_cvt_pk_bf16_f32 v77, v78, v79
    v_cvt_pk_bf16_f32 v78, v108, v109
    v_cvt_pk_bf16_f32 v79, v110, v111
    v_and_b32 v76, -2, v76
    buffer_store_dwordx4 v[72:75], v254, s[40:43], s30 offen offset:2048 sc1
    ds_write_b128 v233, v[72:75] offset:34816
    buffer_store_dwordx4 v[76:79], v254, s[40:43], s31 offen offset:2048 sc1
    ds_write_b128 v233, v[76:79] offset:35840
    v_pk_fma_f32 v[80:81], v[40:41], v[32:33], v[80:81] op_sel:[0,0,0] op_sel_hi:[1,0,1]
    v_pk_fma_f32 v[82:83], v[42:43], v[32:33], v[82:83] op_sel:[0,0,0] op_sel_hi:[1,0,1]
    v_pk_fma_f32 v[112:113], v[44:45], v[32:33], v[112:113] op_sel:[0,0,0] op_sel_hi:[1,0,1]
    v_pk_fma_f32 v[114:115], v[46:47], v[32:33], v[114:115] op_sel:[0,0,0] op_sel_hi:[1,0,1]
    v_pk_mul_f32 v[80:81], v[80:81], v[32:33] op_sel:[0,1] op_sel_hi:[1,1]
    v_pk_mul_f32 v[82:83], v[82:83], v[32:33] op_sel:[0,1] op_sel_hi:[1,1]
    v_pk_mul_f32 v[112:113], v[112:113], v[32:33] op_sel:[0,1] op_sel_hi:[1,1]
    v_pk_mul_f32 v[114:115], v[114:115], v[32:33] op_sel:[0,1] op_sel_hi:[1,1]
    v_exp_f32 v80, v80
    v_exp_f32 v81, v81
    v_exp_f32 v82, v82
    v_exp_f32 v83, v83
    v_exp_f32 v112, v112
    v_exp_f32 v113, v113
    v_exp_f32 v114, v114
    v_exp_f32 v115, v115
    v_accvgpr_read_b32 v200, a48
    v_accvgpr_read_b32 v201, a49
    v_accvgpr_read_b32 v202, a50
    v_accvgpr_read_b32 v203, a51
    v_accvgpr_read_b32 v204, a80
    v_accvgpr_read_b32 v205, a81
    v_accvgpr_read_b32 v206, a82
    v_accvgpr_read_b32 v207, a83
    v_pk_fma_f32 v[80:81], v[80:81], v[34:35], v[34:35] op_sel:[0,0,0] op_sel_hi:[1,0,0]
    v_pk_fma_f32 v[82:83], v[82:83], v[34:35], v[34:35] op_sel:[0,0,0] op_sel_hi:[1,0,0]
    v_pk_fma_f32 v[112:113], v[112:113], v[34:35], v[34:35] op_sel:[0,0,0] op_sel_hi:[1,0,0]
    v_pk_fma_f32 v[114:115], v[114:115], v[34:35], v[34:35] op_sel:[0,0,0] op_sel_hi:[1,0,0]
    v_rcp_f32 v80, v80
    v_rcp_f32 v81, v81
    v_rcp_f32 v82, v82
    v_rcp_f32 v83, v83
    v_rcp_f32 v112, v112
    v_rcp_f32 v113, v113
    v_rcp_f32 v114, v114
    v_rcp_f32 v115, v115
    v_pk_fma_f32 v[200:201], v[168:169], v[32:33], v[200:201] op_sel:[0,0,0] op_sel_hi:[1,0,1]
    v_pk_fma_f32 v[202:203], v[170:171], v[32:33], v[202:203] op_sel:[0,0,0] op_sel_hi:[1,0,1]
    v_pk_fma_f32 v[204:205], v[172:173], v[32:33], v[204:205] op_sel:[0,0,0] op_sel_hi:[1,0,1]
    v_pk_fma_f32 v[206:207], v[174:175], v[32:33], v[206:207] op_sel:[0,0,0] op_sel_hi:[1,0,1]
    v_pk_mul_f32 v[80:81], v[80:81], v[200:201]
    v_pk_mul_f32 v[82:83], v[82:83], v[202:203]
    v_pk_mul_f32 v[112:113], v[112:113], v[204:205]
    v_pk_mul_f32 v[114:115], v[114:115], v[206:207]
    v_cvt_pk_bf16_f32 v80, v80, v81
    v_cvt_pk_bf16_f32 v81, v82, v83
    v_cvt_pk_bf16_f32 v82, v112, v113
    v_cvt_pk_bf16_f32 v83, v114, v115
    v_and_b32 v80, -2, v80
    v_pk_fma_f32 v[84:85], v[40:41], v[36:37], v[84:85] op_sel:[0,0,0] op_sel_hi:[1,0,1]
    v_pk_fma_f32 v[86:87], v[42:43], v[36:37], v[86:87] op_sel:[0,0,0] op_sel_hi:[1,0,1]
    v_pk_fma_f32 v[116:117], v[44:45], v[36:37], v[116:117] op_sel:[0,0,0] op_sel_hi:[1,0,1]
    v_pk_fma_f32 v[118:119], v[46:47], v[36:37], v[118:119] op_sel:[0,0,0] op_sel_hi:[1,0,1]
    v_pk_mul_f32 v[84:85], v[84:85], v[36:37] op_sel:[0,1] op_sel_hi:[1,1]
    v_pk_mul_f32 v[86:87], v[86:87], v[36:37] op_sel:[0,1] op_sel_hi:[1,1]
    v_pk_mul_f32 v[116:117], v[116:117], v[36:37] op_sel:[0,1] op_sel_hi:[1,1]
    v_pk_mul_f32 v[118:119], v[118:119], v[36:37] op_sel:[0,1] op_sel_hi:[1,1]
    v_exp_f32 v84, v84
    v_exp_f32 v85, v85
    v_exp_f32 v86, v86
    v_exp_f32 v87, v87
    v_exp_f32 v116, v116
    v_exp_f32 v117, v117
    v_exp_f32 v118, v118
    v_exp_f32 v119, v119
    v_accvgpr_read_b32 v176, a52
    v_accvgpr_read_b32 v177, a53
    v_accvgpr_read_b32 v178, a54
    v_accvgpr_read_b32 v179, a55
    v_accvgpr_read_b32 v180, a84
    v_accvgpr_read_b32 v181, a85
    v_accvgpr_read_b32 v182, a86
    v_accvgpr_read_b32 v183, a87
    v_pk_fma_f32 v[84:85], v[84:85], v[38:39], v[38:39] op_sel:[0,0,0] op_sel_hi:[1,0,0]
    v_pk_fma_f32 v[86:87], v[86:87], v[38:39], v[38:39] op_sel:[0,0,0] op_sel_hi:[1,0,0]
    v_pk_fma_f32 v[116:117], v[116:117], v[38:39], v[38:39] op_sel:[0,0,0] op_sel_hi:[1,0,0]
    v_pk_fma_f32 v[118:119], v[118:119], v[38:39], v[38:39] op_sel:[0,0,0] op_sel_hi:[1,0,0]
    v_rcp_f32 v84, v84
    v_rcp_f32 v85, v85
    v_rcp_f32 v86, v86
    v_rcp_f32 v87, v87
    v_rcp_f32 v116, v116
    v_rcp_f32 v117, v117
    v_rcp_f32 v118, v118
    v_rcp_f32 v119, v119
    v_pk_fma_f32 v[176:177], v[168:169], v[36:37], v[176:177] op_sel:[0,0,0] op_sel_hi:[1,0,1]
    v_pk_fma_f32 v[178:179], v[170:171], v[36:37], v[178:179] op_sel:[0,0,0] op_sel_hi:[1,0,1]
    v_pk_fma_f32 v[180:181], v[172:173], v[36:37], v[180:181] op_sel:[0,0,0] op_sel_hi:[1,0,1]
    v_pk_fma_f32 v[182:183], v[174:175], v[36:37], v[182:183] op_sel:[0,0,0] op_sel_hi:[1,0,1]
    v_pk_mul_f32 v[84:85], v[84:85], v[176:177]
    v_pk_mul_f32 v[86:87], v[86:87], v[178:179]
    v_pk_mul_f32 v[116:117], v[116:117], v[180:181]
    v_pk_mul_f32 v[118:119], v[118:119], v[182:183]
    v_cvt_pk_bf16_f32 v84, v84, v85
    v_cvt_pk_bf16_f32 v85, v86, v87
    v_cvt_pk_bf16_f32 v86, v116, v117
    v_cvt_pk_bf16_f32 v87, v118, v119
    v_and_b32 v84, -2, v84
    buffer_store_dwordx4 v[80:83], v254, s[40:43], s32 offen offset:2048 sc1
    ds_write_b128 v233, v[80:83] offset:36864
    buffer_store_dwordx4 v[84:87], v254, s[40:43], s33 offen offset:2048 sc1
    ds_write_b128 v233, v[84:87] offset:37888
    v_pk_fma_f32 v[88:89], v[40:41], v[160:161], v[88:89] op_sel:[0,0,0] op_sel_hi:[1,0,1]
    v_pk_fma_f32 v[90:91], v[42:43], v[160:161], v[90:91] op_sel:[0,0,0] op_sel_hi:[1,0,1]
    v_pk_fma_f32 v[120:121], v[44:45], v[160:161], v[120:121] op_sel:[0,0,0] op_sel_hi:[1,0,1]
    v_pk_fma_f32 v[122:123], v[46:47], v[160:161], v[122:123] op_sel:[0,0,0] op_sel_hi:[1,0,1]
    v_pk_mul_f32 v[88:89], v[88:89], v[160:161] op_sel:[0,1] op_sel_hi:[1,1]
    v_pk_mul_f32 v[90:91], v[90:91], v[160:161] op_sel:[0,1] op_sel_hi:[1,1]
    v_pk_mul_f32 v[120:121], v[120:121], v[160:161] op_sel:[0,1] op_sel_hi:[1,1]
    v_pk_mul_f32 v[122:123], v[122:123], v[160:161] op_sel:[0,1] op_sel_hi:[1,1]
    v_exp_f32 v88, v88
    v_exp_f32 v89, v89
    v_exp_f32 v90, v90
    v_exp_f32 v91, v91
    v_exp_f32 v120, v120
    v_exp_f32 v121, v121
    v_exp_f32 v122, v122
    v_exp_f32 v123, v123
    v_accvgpr_read_b32 v200, a56
    v_accvgpr_read_b32 v201, a57
    v_accvgpr_read_b32 v202, a58
    v_accvgpr_read_b32 v203, a59
    v_accvgpr_read_b32 v204, a88
    v_accvgpr_read_b32 v205, a89
    v_accvgpr_read_b32 v206, a90
    v_accvgpr_read_b32 v207, a91
    v_pk_fma_f32 v[88:89], v[88:89], v[162:163], v[162:163] op_sel:[0,0,0] op_sel_hi:[1,0,0]
    v_pk_fma_f32 v[90:91], v[90:91], v[162:163], v[162:163] op_sel:[0,0,0] op_sel_hi:[1,0,0]
    v_pk_fma_f32 v[120:121], v[120:121], v[162:163], v[162:163] op_sel:[0,0,0] op_sel_hi:[1,0,0]
    v_pk_fma_f32 v[122:123], v[122:123], v[162:163], v[162:163] op_sel:[0,0,0] op_sel_hi:[1,0,0]
    v_rcp_f32 v88, v88
    v_rcp_f32 v89, v89
    v_rcp_f32 v90, v90
    v_rcp_f32 v91, v91
    v_rcp_f32 v120, v120
    v_rcp_f32 v121, v121
    v_rcp_f32 v122, v122
    v_rcp_f32 v123, v123
    v_pk_fma_f32 v[200:201], v[168:169], v[160:161], v[200:201] op_sel:[0,0,0] op_sel_hi:[1,0,1]
    v_pk_fma_f32 v[202:203], v[170:171], v[160:161], v[202:203] op_sel:[0,0,0] op_sel_hi:[1,0,1]
    v_pk_fma_f32 v[204:205], v[172:173], v[160:161], v[204:205] op_sel:[0,0,0] op_sel_hi:[1,0,1]
    v_pk_fma_f32 v[206:207], v[174:175], v[160:161], v[206:207] op_sel:[0,0,0] op_sel_hi:[1,0,1]
    v_pk_mul_f32 v[88:89], v[88:89], v[200:201]
    v_pk_mul_f32 v[90:91], v[90:91], v[202:203]
    v_pk_mul_f32 v[120:121], v[120:121], v[204:205]
    v_pk_mul_f32 v[122:123], v[122:123], v[206:207]
    v_cvt_pk_bf16_f32 v88, v88, v89
    v_cvt_pk_bf16_f32 v89, v90, v91
    v_cvt_pk_bf16_f32 v90, v120, v121
    v_cvt_pk_bf16_f32 v91, v122, v123
    v_and_b32 v88, -2, v88
    v_pk_fma_f32 v[92:93], v[40:41], v[164:165], v[92:93] op_sel:[0,0,0] op_sel_hi:[1,0,1]
    v_pk_fma_f32 v[94:95], v[42:43], v[164:165], v[94:95] op_sel:[0,0,0] op_sel_hi:[1,0,1]
    v_pk_fma_f32 v[124:125], v[44:45], v[164:165], v[124:125] op_sel:[0,0,0] op_sel_hi:[1,0,1]
    v_pk_fma_f32 v[126:127], v[46:47], v[164:165], v[126:127] op_sel:[0,0,0] op_sel_hi:[1,0,1]
    v_pk_mul_f32 v[92:93], v[92:93], v[164:165] op_sel:[0,1] op_sel_hi:[1,1]
    v_pk_mul_f32 v[94:95], v[94:95], v[164:165] op_sel:[0,1] op_sel_hi:[1,1]
    v_pk_mul_f32 v[124:125], v[124:125], v[164:165] op_sel:[0,1] op_sel_hi:[1,1]
    v_pk_mul_f32 v[126:127], v[126:127], v[164:165] op_sel:[0,1] op_sel_hi:[1,1]
    v_exp_f32 v92, v92
    v_exp_f32 v93, v93
    v_exp_f32 v94, v94
    v_exp_f32 v95, v95
    v_exp_f32 v124, v124
    v_exp_f32 v125, v125
    v_exp_f32 v126, v126
    v_exp_f32 v127, v127
    v_accvgpr_read_b32 v176, a60
    v_accvgpr_read_b32 v177, a61
    v_accvgpr_read_b32 v178, a62
    v_accvgpr_read_b32 v179, a63
    v_accvgpr_read_b32 v180, a92
    v_accvgpr_read_b32 v181, a93
    v_accvgpr_read_b32 v182, a94
    v_accvgpr_read_b32 v183, a95
    v_pk_fma_f32 v[92:93], v[92:93], v[166:167], v[166:167] op_sel:[0,0,0] op_sel_hi:[1,0,0]
    v_pk_fma_f32 v[94:95], v[94:95], v[166:167], v[166:167] op_sel:[0,0,0] op_sel_hi:[1,0,0]
    v_pk_fma_f32 v[124:125], v[124:125], v[166:167], v[166:167] op_sel:[0,0,0] op_sel_hi:[1,0,0]
    v_pk_fma_f32 v[126:127], v[126:127], v[166:167], v[166:167] op_sel:[0,0,0] op_sel_hi:[1,0,0]
    v_rcp_f32 v92, v92
    v_rcp_f32 v93, v93
    v_rcp_f32 v94, v94
    v_rcp_f32 v95, v95
    v_rcp_f32 v124, v124
    v_rcp_f32 v125, v125
    v_rcp_f32 v126, v126
    v_rcp_f32 v127, v127
    v_pk_fma_f32 v[176:177], v[168:169], v[164:165], v[176:177] op_sel:[0,0,0] op_sel_hi:[1,0,1]
    v_pk_fma_f32 v[178:179], v[170:171], v[164:165], v[178:179] op_sel:[0,0,0] op_sel_hi:[1,0,1]
    v_pk_fma_f32 v[180:181], v[172:173], v[164:165], v[180:181] op_sel:[0,0,0] op_sel_hi:[1,0,1]
    v_pk_fma_f32 v[182:183], v[174:175], v[164:165], v[182:183] op_sel:[0,0,0] op_sel_hi:[1,0,1]
    v_pk_mul_f32 v[92:93], v[92:93], v[176:177]
    v_pk_mul_f32 v[94:95], v[94:95], v[178:179]
    v_pk_mul_f32 v[124:125], v[124:125], v[180:181]
    v_pk_mul_f32 v[126:127], v[126:127], v[182:183]
    v_cvt_pk_bf16_f32 v92, v92, v93
    v_cvt_pk_bf16_f32 v93, v94, v95
    v_cvt_pk_bf16_f32 v94, v124, v125
    v_cvt_pk_bf16_f32 v95, v126, v127
    v_and_b32 v92, -2, v92
    buffer_store_dwordx4 v[88:91], v254, s[40:43], s34 offen offset:2048 sc1
    ds_write_b128 v233, v[88:91] offset:38912
    buffer_store_dwordx4 v[92:95], v254, s[40:43], s35 offen offset:2048 sc1
    ds_write_b128 v233, v[92:95] offset:39936
    s_waitcnt lgkmcnt(8)
    s_barrier
    v_pk_fma_f32 v[128:129], v[48:49], v[224:225], v[128:129] op_sel:[0,0,0] op_sel_hi:[1,0,1]
    v_pk_fma_f32 v[130:131], v[50:51], v[224:225], v[130:131] op_sel:[0,0,0] op_sel_hi:[1,0,1]
    v_pk_fma_f32 v[132:133], v[48:49], v[228:229], v[132:133] op_sel:[0,0,0] op_sel_hi:[1,0,1]
    v_pk_fma_f32 v[134:135], v[50:51], v[228:229], v[134:135] op_sel:[0,0,0] op_sel_hi:[1,0,1]
    v_pk_mul_f32 v[128:129], v[128:129], v[224:225] op_sel:[0,1] op_sel_hi:[1,1]
    v_pk_mul_f32 v[130:131], v[130:131], v[224:225] op_sel:[0,1] op_sel_hi:[1,1]
    v_pk_mul_f32 v[132:133], v[132:133], v[228:229] op_sel:[0,1] op_sel_hi:[1,1]
    v_pk_mul_f32 v[134:135], v[134:135], v[228:229] op_sel:[0,1] op_sel_hi:[1,1]
    v_exp_f32 v128, v128
    v_exp_f32 v129, v129
    v_exp_f32 v130, v130
    v_exp_f32 v131, v131
    v_exp_f32 v132, v132
    v_exp_f32 v133, v133
    v_exp_f32 v134, v134
    v_exp_f32 v135, v135
    v_accvgpr_read_b32 v200, a96
    v_accvgpr_read_b32 v201, a97
    v_accvgpr_read_b32 v202, a98
    v_accvgpr_read_b32 v203, a99
    v_accvgpr_read_b32 v204, a100
    v_accvgpr_read_b32 v205, a101
    v_accvgpr_read_b32 v206, a102
    v_accvgpr_read_b32 v207, a103
    v_pk_fma_f32 v[128:129], v[128:129], v[226:227], v[226:227] op_sel:[0,0,0] op_sel_hi:[1,0,0]
    v_pk_fma_f32 v[130:131], v[130:131], v[226:227], v[226:227] op_sel:[0,0,0] op_sel_hi:[1,0,0]
    v_pk_fma_f32 v[132:133], v[132:133], v[230:231], v[230:231] op_sel:[0,0,0] op_sel_hi:[1,0,0]
    v_pk_fma_f32 v[134:135], v[134:135], v[230:231], v[230:231] op_sel:[0,0,0] op_sel_hi:[1,0,0]
    v_rcp_f32 v128, v128
    v_rcp_f32 v129, v129
    v_rcp_f32 v130, v130
    v_rcp_f32 v131, v131
    v_rcp_f32 v132, v132
    v_rcp_f32 v133, v133
    v_rcp_f32 v134, v134
    v_rcp_f32 v135, v135
    v_pk_fma_f32 v[200:201], v[52:53], v[224:225], v[200:201] op_sel:[0,0,0] op_sel_hi:[1,0,1]
    v_pk_fma_f32 v[202:203], v[54:55], v[224:225], v[202:203] op_sel:[0,0,0] op_sel_hi:[1,0,1]
    v_pk_fma_f32 v[204:205], v[52:53], v[228:229], v[204:205] op_sel:[0,0,0] op_sel_hi:[1,0,1]
    v_pk_fma_f32 v[206:207], v[54:55], v[228:229], v[206:207] op_sel:[0,0,0] op_sel_hi:[1,0,1]
    v_pk_mul_f32 v[128:129], v[128:129], v[200:201]
    v_pk_mul_f32 v[130:131], v[130:131], v[202:203]
    v_pk_mul_f32 v[132:133], v[132:133], v[204:205]
    v_pk_mul_f32 v[134:135], v[134:135], v[206:207]
    v_cvt_pk_bf16_f32 v128, v128, v129
    v_cvt_pk_bf16_f32 v129, v130, v131
    v_cvt_pk_bf16_f32 v130, v132, v133
    v_cvt_pk_bf16_f32 v131, v134, v135
    s_nop 0
    v_permlane16_swap_b32 v128, v130
    v_permlane16_swap_b32 v129, v131
    buffer_store_dwordx4 v[128:131], v237, s[40:43], s28 offen sc1
    ds_read_b64_tr_b16 a[232:233], v250 offset:16384
    ds_read_b64_tr_b16 a[234:235], v250 offset:20480
    ds_read_b128 a[136:139], v248 offset:0
    ds_read_b64_tr_b16 a[236:237], v250 offset:24576
    v_pk_fma_f32 v[136:137], v[48:49], v[192:193], v[136:137] op_sel:[0,0,0] op_sel_hi:[1,0,1]
    v_pk_fma_f32 v[138:139], v[50:51], v[192:193], v[138:139] op_sel:[0,0,0] op_sel_hi:[1,0,1]
    v_pk_fma_f32 v[140:141], v[48:49], v[196:197], v[140:141] op_sel:[0,0,0] op_sel_hi:[1,0,1]
    v_pk_fma_f32 v[142:143], v[50:51], v[196:197], v[142:143] op_sel:[0,0,0] op_sel_hi:[1,0,1]
    v_pk_mul_f32 v[136:137], v[136:137], v[192:193] op_sel:[0,1] op_sel_hi:[1,1]
    v_pk_mul_f32 v[138:139], v[138:139], v[192:193] op_sel:[0,1] op_sel_hi:[1,1]
    v_pk_mul_f32 v[140:141], v[140:141], v[196:197] op_sel:[0,1] op_sel_hi:[1,1]
    v_pk_mul_f32 v[142:143], v[142:143], v[196:197] op_sel:[0,1] op_sel_hi:[1,1]
    v_exp_f32 v136, v136
    v_exp_f32 v137, v137
    v_exp_f32 v138, v138
    v_exp_f32 v139, v139
    v_exp_f32 v140, v140
    v_exp_f32 v141, v141
    v_exp_f32 v142, v142
    v_exp_f32 v143, v143
    v_accvgpr_read_b32 v176, a104
    v_accvgpr_read_b32 v177, a105
    v_accvgpr_read_b32 v178, a106
    v_accvgpr_read_b32 v179, a107
    v_accvgpr_read_b32 v180, a108
    v_accvgpr_read_b32 v181, a109
    v_accvgpr_read_b32 v182, a110
    v_accvgpr_read_b32 v183, a111
    v_pk_fma_f32 v[136:137], v[136:137], v[194:195], v[194:195] op_sel:[0,0,0] op_sel_hi:[1,0,0]
    v_pk_fma_f32 v[138:139], v[138:139], v[194:195], v[194:195] op_sel:[0,0,0] op_sel_hi:[1,0,0]
    v_pk_fma_f32 v[140:141], v[140:141], v[198:199], v[198:199] op_sel:[0,0,0] op_sel_hi:[1,0,0]
    v_pk_fma_f32 v[142:143], v[142:143], v[198:199], v[198:199] op_sel:[0,0,0] op_sel_hi:[1,0,0]
    v_rcp_f32 v136, v136
    v_rcp_f32 v137, v137
    v_rcp_f32 v138, v138
    v_rcp_f32 v139, v139
    v_rcp_f32 v140, v140
    v_rcp_f32 v141, v141
    v_rcp_f32 v142, v142
    v_rcp_f32 v143, v143
    v_pk_fma_f32 v[176:177], v[52:53], v[192:193], v[176:177] op_sel:[0,0,0] op_sel_hi:[1,0,1]
    v_pk_fma_f32 v[178:179], v[54:55], v[192:193], v[178:179] op_sel:[0,0,0] op_sel_hi:[1,0,1]
    v_pk_fma_f32 v[180:181], v[52:53], v[196:197], v[180:181] op_sel:[0,0,0] op_sel_hi:[1,0,1]
    v_pk_fma_f32 v[182:183], v[54:55], v[196:197], v[182:183] op_sel:[0,0,0] op_sel_hi:[1,0,1]
    v_pk_mul_f32 v[136:137], v[136:137], v[176:177]
    v_pk_mul_f32 v[138:139], v[138:139], v[178:179]
    v_pk_mul_f32 v[140:141], v[140:141], v[180:181]
    v_pk_mul_f32 v[142:143], v[142:143], v[182:183]
    v_cvt_pk_bf16_f32 v136, v136, v137
    v_cvt_pk_bf16_f32 v137, v138, v139
    v_cvt_pk_bf16_f32 v138, v140, v141
    v_cvt_pk_bf16_f32 v139, v142, v143
    s_nop 0
    v_permlane16_swap_b32 v136, v138
    v_permlane16_swap_b32 v137, v139
    buffer_store_dwordx4 v[136:139], v237, s[40:43], s30 offen sc1
    ds_read_b64_tr_b16 a[238:239], v250 offset:28672
    ds_read_b128 a[152:155], v248 offset:16384
    ds_read_b128 a[156:159], v248 offset:17408
    ds_read_b128 a[140:143], v248 offset:1024
    v_pk_fma_f32 v[144:145], v[48:49], v[32:33], v[144:145] op_sel:[0,0,0] op_sel_hi:[1,0,1]
    v_pk_fma_f32 v[146:147], v[50:51], v[32:33], v[146:147] op_sel:[0,0,0] op_sel_hi:[1,0,1]
    v_pk_fma_f32 v[148:149], v[48:49], v[36:37], v[148:149] op_sel:[0,0,0] op_sel_hi:[1,0,1]
    v_pk_fma_f32 v[150:151], v[50:51], v[36:37], v[150:151] op_sel:[0,0,0] op_sel_hi:[1,0,1]
    v_pk_mul_f32 v[144:145], v[144:145], v[32:33] op_sel:[0,1] op_sel_hi:[1,1]
    v_pk_mul_f32 v[146:147], v[146:147], v[32:33] op_sel:[0,1] op_sel_hi:[1,1]
    v_pk_mul_f32 v[148:149], v[148:149], v[36:37] op_sel:[0,1] op_sel_hi:[1,1]
    v_pk_mul_f32 v[150:151], v[150:151], v[36:37] op_sel:[0,1] op_sel_hi:[1,1]
    v_exp_f32 v144, v144
    v_exp_f32 v145, v145
    v_exp_f32 v146, v146
    v_exp_f32 v147, v147
    v_exp_f32 v148, v148
    v_exp_f32 v149, v149
    v_exp_f32 v150, v150
    v_exp_f32 v151, v151
    v_accvgpr_read_b32 v200, a112
    v_accvgpr_read_b32 v201, a113
    v_accvgpr_read_b32 v202, a114
    v_accvgpr_read_b32 v203, a115
    v_accvgpr_read_b32 v204, a116
    v_accvgpr_read_b32 v205, a117
    v_accvgpr_read_b32 v206, a118
    v_accvgpr_read_b32 v207, a119
    v_pk_fma_f32 v[144:145], v[144:145], v[34:35], v[34:35] op_sel:[0,0,0] op_sel_hi:[1,0,0]
    v_pk_fma_f32 v[146:147], v[146:147], v[34:35], v[34:35] op_sel:[0,0,0] op_sel_hi:[1,0,0]
    v_pk_fma_f32 v[148:149], v[148:149], v[38:39], v[38:39] op_sel:[0,0,0] op_sel_hi:[1,0,0]
    v_pk_fma_f32 v[150:151], v[150:151], v[38:39], v[38:39] op_sel:[0,0,0] op_sel_hi:[1,0,0]
    v_rcp_f32 v144, v144
    v_rcp_f32 v145, v145
    v_rcp_f32 v146, v146
    v_rcp_f32 v147, v147
    v_rcp_f32 v148, v148
    v_rcp_f32 v149, v149
    v_rcp_f32 v150, v150
    v_rcp_f32 v151, v151
    v_pk_fma_f32 v[200:201], v[52:53], v[32:33], v[200:201] op_sel:[0,0,0] op_sel_hi:[1,0,1]
    v_pk_fma_f32 v[202:203], v[54:55], v[32:33], v[202:203] op_sel:[0,0,0] op_sel_hi:[1,0,1]
    v_pk_fma_f32 v[204:205], v[52:53], v[36:37], v[204:205] op_sel:[0,0,0] op_sel_hi:[1,0,1]
    v_pk_fma_f32 v[206:207], v[54:55], v[36:37], v[206:207] op_sel:[0,0,0] op_sel_hi:[1,0,1]
    v_pk_mul_f32 v[144:145], v[144:145], v[200:201]
    v_pk_mul_f32 v[146:147], v[146:147], v[202:203]
    v_pk_mul_f32 v[148:149], v[148:149], v[204:205]
    v_pk_mul_f32 v[150:151], v[150:151], v[206:207]
    v_cvt_pk_bf16_f32 v144, v144, v145
    v_cvt_pk_bf16_f32 v145, v146, v147
    v_cvt_pk_bf16_f32 v146, v148, v149
    v_cvt_pk_bf16_f32 v147, v150, v151
    s_nop 0
    v_permlane16_swap_b32 v144, v146
    v_permlane16_swap_b32 v145, v147
    buffer_store_dwordx4 v[144:147], v237, s[40:43], s32 offen sc1
    ds_read_b128 a[144:147], v248 offset:2048
    ds_read_b128 a[160:163], v248 offset:18432
    ds_read_b128 a[164:167], v248 offset:19456
    ds_read_b128 a[148:151], v248 offset:3072
    v_pk_fma_f32 v[152:153], v[48:49], v[160:161], v[152:153] op_sel:[0,0,0] op_sel_hi:[1,0,1]
    v_pk_fma_f32 v[154:155], v[50:51], v[160:161], v[154:155] op_sel:[0,0,0] op_sel_hi:[1,0,1]
    v_pk_fma_f32 v[156:157], v[48:49], v[164:165], v[156:157] op_sel:[0,0,0] op_sel_hi:[1,0,1]
    v_pk_fma_f32 v[158:159], v[50:51], v[164:165], v[158:159] op_sel:[0,0,0] op_sel_hi:[1,0,1]
    v_pk_mul_f32 v[152:153], v[152:153], v[160:161] op_sel:[0,1] op_sel_hi:[1,1]
    v_pk_mul_f32 v[154:155], v[154:155], v[160:161] op_sel:[0,1] op_sel_hi:[1,1]
    v_pk_mul_f32 v[156:157], v[156:157], v[164:165] op_sel:[0,1] op_sel_hi:[1,1]
    v_pk_mul_f32 v[158:159], v[158:159], v[164:165] op_sel:[0,1] op_sel_hi:[1,1]
    v_exp_f32 v152, v152
    v_exp_f32 v153, v153
    v_exp_f32 v154, v154
    v_exp_f32 v155, v155
    v_exp_f32 v156, v156
    v_exp_f32 v157, v157
    v_exp_f32 v158, v158
    v_exp_f32 v159, v159
    v_accvgpr_read_b32 v176, a120
    v_accvgpr_read_b32 v177, a121
    v_accvgpr_read_b32 v178, a122
    v_accvgpr_read_b32 v179, a123
    v_accvgpr_read_b32 v180, a124
    v_accvgpr_read_b32 v181, a125
    v_accvgpr_read_b32 v182, a126
    v_accvgpr_read_b32 v183, a127
    v_pk_fma_f32 v[152:153], v[152:153], v[162:163], v[162:163] op_sel:[0,0,0] op_sel_hi:[1,0,0]
    v_pk_fma_f32 v[154:155], v[154:155], v[162:163], v[162:163] op_sel:[0,0,0] op_sel_hi:[1,0,0]
    v_pk_fma_f32 v[156:157], v[156:157], v[166:167], v[166:167] op_sel:[0,0,0] op_sel_hi:[1,0,0]
    v_pk_fma_f32 v[158:159], v[158:159], v[166:167], v[166:167] op_sel:[0,0,0] op_sel_hi:[1,0,0]
    v_rcp_f32 v152, v152
    v_rcp_f32 v153, v153
    v_rcp_f32 v154, v154
    v_rcp_f32 v155, v155
    v_rcp_f32 v156, v156
    v_rcp_f32 v157, v157
    v_rcp_f32 v158, v158
    v_rcp_f32 v159, v159
    v_pk_fma_f32 v[176:177], v[52:53], v[160:161], v[176:177] op_sel:[0,0,0] op_sel_hi:[1,0,1]
    v_pk_fma_f32 v[178:179], v[54:55], v[160:161], v[178:179] op_sel:[0,0,0] op_sel_hi:[1,0,1]
    v_pk_fma_f32 v[180:181], v[52:53], v[164:165], v[180:181] op_sel:[0,0,0] op_sel_hi:[1,0,1]
    v_pk_fma_f32 v[182:183], v[54:55], v[164:165], v[182:183] op_sel:[0,0,0] op_sel_hi:[1,0,1]
    v_pk_mul_f32 v[152:153], v[152:153], v[176:177]
    v_pk_mul_f32 v[154:155], v[154:155], v[178:179]
    v_pk_mul_f32 v[156:157], v[156:157], v[180:181]
    v_pk_mul_f32 v[158:159], v[158:159], v[182:183]
    v_cvt_pk_bf16_f32 v152, v152, v153
    v_cvt_pk_bf16_f32 v153, v154, v155
    v_cvt_pk_bf16_f32 v154, v156, v157
    v_cvt_pk_bf16_f32 v155, v158, v159
    s_nop 0
    v_permlane16_swap_b32 v152, v154
    v_permlane16_swap_b32 v153, v155
    buffer_store_dwordx4 v[152:155], v237, s[40:43], s34 offen sc1
    ds_read_b64_tr_b16 a[240:241], v251 offset:16384
    ds_read_b64_tr_b16 a[242:243], v251 offset:20480
    ds_read_b64_tr_b16 a[244:245], v251 offset:24576
    ds_read_b64_tr_b16 a[246:247], v251 offset:28672
    v_subrev_u32 v0, 32768, v244
    v_subrev_u32 v1, 32768, v245
    v_readlane_b32 s92, v247, 6
    v_readlane_b32 s93, v247, 7
    v_readlane_b32 s94, v247, 8
    v_readlane_b32 s95, v247, 9
    s_add_u32 m0, s3, 81920
    s_nop 0
    buffer_load_dwordx4 v244, s[48:51], s92 offen lds
    s_add_u32 m0, s3, 83968
    s_nop 0
    buffer_load_dwordx4 v245, s[48:51], s92 offen lds
    s_add_u32 m0, s3, 77824
    s_nop 0
    buffer_load_dwordx4 v0, s[48:51], s92 offen lds
    s_add_u32 m0, s3, 79872
    s_nop 0
    buffer_load_dwordx4 v1, s[48:51], s92 offen lds
    s_add_u32 m0, s3, 90112
    s_nop 0
    buffer_load_dwordx4 v244, s[48:51], s93 offen lds
    s_add_u32 m0, s3, 92160
    s_nop 0
    buffer_load_dwordx4 v245, s[48:51], s93 offen lds
    s_add_u32 m0, s3, 86016
    s_nop 0
    buffer_load_dwordx4 v0, s[48:51], s93 offen lds
    s_add_u32 m0, s3, 88064
    s_nop 0
    buffer_load_dwordx4 v1, s[48:51], s93 offen lds
    s_add_u32 m0, s3, 65536
    s_nop 0
    buffer_load_dwordx4 v244, s[48:51], s94 offen lds
    s_add_u32 m0, s3, 67584
    s_nop 0
    buffer_load_dwordx4 v245, s[48:51], s94 offen lds
    s_add_u32 m0, s3, 61440
    s_nop 0
    buffer_load_dwordx4 v0, s[48:51], s94 offen lds
    s_add_u32 m0, s3, 63488
    s_nop 0
    buffer_load_dwordx4 v1, s[48:51], s94 offen lds
    s_add_u32 m0, s3, 73728
    s_nop 0
    buffer_load_dwordx4 v244, s[48:51], s95 offen lds
    s_add_u32 m0, s3, 75776
    s_nop 0
    buffer_load_dwordx4 v245, s[48:51], s95 offen lds
    s_add_u32 m0, s3, 69632
    s_nop 0
    buffer_load_dwordx4 v0, s[48:51], s95 offen lds
    s_add_u32 m0, s3, 71680
    s_nop 0
    buffer_load_dwordx4 v1, s[48:51], s95 offen lds
    s_mov_b64 vcc, -1
L_g2:
    s_waitcnt lgkmcnt(10)
    v_mfma_f32_16x16x32_bf16 v[0:3], a[232:235], a[136:139], 0
    ds_read_b64_tr_b16 v[128:129], v252 offset:16384
    v_mfma_f32_16x16x32_bf16 v[0:3], a[236:239], a[152:155], v[0:3]
    ds_read_b64_tr_b16 v[130:131], v252 offset:20480
    s_waitcnt lgkmcnt(11)
    v_mfma_f32_16x16x32_bf16 v[8:11], a[236:239], a[156:159], 0
    ds_read_b64_tr_b16 v[132:133], v252 offset:24576
    s_waitcnt lgkmcnt(11)
    v_mfma_f32_16x16x32_bf16 v[8:11], a[232:235], a[140:143], v[8:11]
    ds_read_b64_tr_b16 v[134:135], v252 offset:28672
    s_waitcnt lgkmcnt(11)
    v_mfma_f32_16x16x32_bf16 v[16:19], a[232:235], a[144:147], 0
    ds_read_b64_tr_b16 v[136:137], v253 offset:16384
    s_waitcnt lgkmcnt(11)
    v_mfma_f32_16x16x32_bf16 v[16:19], a[236:239], a[160:163], v[16:19]
    ds_read_b64_tr_b16 v[138:139], v253 offset:20480
    s_waitcnt lgkmcnt(11)
    v_mfma_f32_16x16x32_bf16 v[24:27], a[236:239], a[164:167], 0
    ds_read_b64_tr_b16 v[140:141], v253 offset:24576
    s_waitcnt lgkmcnt(11)
    v_mfma_f32_16x16x32_bf16 v[24:27], a[232:235], a[148:151], v[24:27]
    ds_read_b64_tr_b16 v[142:143], v253 offset:28672
    s_waitcnt lgkmcnt(10)
    v_mfma_f32_16x16x32_bf16 v[28:31], a[240:243], a[148:151], 0
    ds_read_b64_tr_b16 v[144:145], v249 offset:16384
    s_waitcnt lgkmcnt(9)
    v_mfma_f32_16x16x32_bf16 v[28:31], a[244:247], a[164:167], v[28:31]
    v_mfma_f32_16x16x32_bf16 v[20:23], a[244:247], a[160:163], 0
    ds_read_b64_tr_b16 v[146:147], v249 offset:20480
    v_mfma_f32_16x16x32_bf16 v[20:23], a[240:243], a[144:147], v[20:23]
    v_mfma_f32_16x16x32_bf16 v[12:15], a[240:243], a[140:143], 0
    ds_read_b64_tr_b16 v[148:149], v249 offset:24576
    v_mfma_f32_16x16x32_bf16 v[12:15], a[244:247], a[156:159], v[12:15]
    v_mfma_f32_16x16x32_bf16 v[4:7], a[244:247], a[152:155], 0
    ds_read_b64_tr_b16 v[150:151], v249 offset:28672
    v_mfma_f32_16x16x32_bf16 v[4:7], a[240:243], a[136:139], v[4:7]
    s_waitcnt lgkmcnt(4)
    v_mfma_f32_16x16x32_bf16 v[32:35], v[128:131], a[136:139], 0
    ds_read_b64_tr_b16 v[152:153], v234 offset:16384
    v_mfma_f32_16x16x32_bf16 v[32:35], v[132:135], a[152:155], v[32:35]
    s_mov_b64 s[4:5], -1
    s_cbranch_vccnz L_p1s
    s_waitcnt vmcnt(0)
    v_cmp_eq_u32 s[4:5], v239, v238
L_p1s:
    v_mfma_f32_16x16x32_bf16 v[40:43], v[132:135], a[156:159], 0
    ds_read_b64_tr_b16 v[154:155], v234 offset:20480
    v_mfma_f32_16x16x32_bf16 v[40:43], v[128:131], a[140:143], v[40:43]
    s_or_b32 s4, s4, s5
    s_or_b32 s4, s4, s11
    s_cmp_eq_u32 s4, -1
    s_cbranch_scc0 L_slow_p1
L_back_p1:
    s_barrier
    v_mfma_f32_16x16x32_bf16 v[48:51], v[128:131], a[144:147], 0
    ds_read_b64_tr_b16 v[156:157], v234 offset:24576
    v_mfma_f32_16x16x32_bf16 v[48:51], v[132:135], a[160:163], v[48:51]
    ds_read_b128 a[168:171], v248 offset:32768
    v_mfma_f32_16x16x32_bf16 v[56:59], v[132:135], a[164:167], 0
    ds_read_b128 a[184:187], v248 offset:49152
    v_mfma_f32_16x16x32_bf16 v[56:59], v[128:131], a[148:151], v[56:59]
    ds_read_b64_tr_b16 v[158:159], v234 offset:28672
    v_mfma_f32_16x16x32_bf16 v[60:63], v[136:139], a[148:151], 0
    ds_read_b128 a[188:191], v248 offset:50176
    v_mfma_f32_16x16x32_bf16 v[60:63], v[140:143], a[164:167], v[60:63]
    ds_read_b64_tr_b16 a[232:233], v235 offset:16384
    v_mfma_f32_16x16x32_bf16 v[52:55], v[140:143], a[160:163], 0
    ds_read_b128 a[172:175], v248 offset:33792
    v_mfma_f32_16x16x32_bf16 v[52:55], v[136:139], a[144:147], v[52:55]
    ds_read_b64_tr_b16 a[234:235], v235 offset:20480
    v_mfma_f32_16x16x32_bf16 v[44:47], v[136:139], a[140:143], 0
    ds_read_b128 a[176:179], v248 offset:34816
    v_mfma_f32_16x16x32_bf16 v[44:47], v[140:143], a[156:159], v[44:47]
    ds_read_b128 a[192:195], v248 offset:51200
    v_mfma_f32_16x16x32_bf16 v[36:39], v[140:143], a[152:155], 0
    ds_read_b64_tr_b16 a[236:237], v235 offset:24576
    v_mfma_f32_16x16x32_bf16 v[36:39], v[136:139], a[136:139], v[36:39]
    s_waitcnt lgkmcnt(7)
    v_mfma_f32_16x16x32_bf16 v[64:67], v[144:147], a[136:139], 0
    ds_read_b128 a[196:199], v248 offset:52224
    v_mfma_f32_16x16x32_bf16 v[64:67], v[148:151], a[152:155], v[64:67]
    ds_read_b64_tr_b16 a[238:239], v235 offset:28672
    v_mfma_f32_16x16x32_bf16 v[72:75], v[148:151], a[156:159], 0
    ds_read_b128 a[180:183], v248 offset:35840
    v_mfma_f32_16x16x32_bf16 v[72:75], v[144:147], a[140:143], v[72:75]
    ds_read_b64_tr_b16 a[240:241], v236 offset:16384
    v_mfma_f32_16x16x32_bf16 v[80:83], v[144:147], a[144:147], 0
    ds_read_b64_tr_b16 a[242:243], v236 offset:20480
    v_mfma_f32_16x16x32_bf16 v[80:83], v[148:151], a[160:163], v[80:83]
    ds_read_b64_tr_b16 a[244:245], v236 offset:24576
    v_mfma_f32_16x16x32_bf16 v[88:91], v[148:151], a[164:167], 0
    ds_read_b64_tr_b16 a[246:247], v236 offset:28672
    v_mfma_f32_16x16x32_bf16 v[88:91], v[144:147], a[148:151], v[88:91]
    v_readlane_b32 s94, v246, 4
    v_mfma_f32_16x16x32_bf16 v[92:95], v[152:155], a[148:151], 0
    ds_read_b64_tr_b16 v[128:129], v250 offset:32768
    v_mfma_f32_16x16x32_bf16 v[92:95], v[156:159], a[164:167], v[92:95]
    v_mfma_f32_16x16x32_bf16 v[84:87], v[156:159], a[160:163], 0
    ds_read_b64_tr_b16 v[130:131], v250 offset:36864
    v_mfma_f32_16x16x32_bf16 v[84:87], v[152:155], a[144:147], v[84:87]
    buffer_load_dwordx4 a[200:203], v240, s[40:43], s94 offen sc1
    v_mfma_f32_16x16x32_bf16 v[76:79], v[152:155], a[140:143], 0
    ds_read_b64_tr_b16 v[132:133], v250 offset:40960
    v_mfma_f32_16x16x32_bf16 v[76:79], v[156:159], a[156:159], v[76:79]
    buffer_load_dwordx4 a[204:207], v241, s[40:43], s94 offen sc1
    v_mfma_f32_16x16x32_bf16 v[68:71], v[156:159], a[152:155], 0
    ds_read_b64_tr_b16 v[134:135], v250 offset:45056
    v_mfma_f32_16x16x32_bf16 v[68:71], v[152:155], a[136:139], v[68:71]
    s_waitcnt lgkmcnt(4)
    v_mfma_f32_16x16x32_bf16 v[96:99], a[232:235], a[136:139], 0
    ds_read_b64_tr_b16 v[136:137], v251 offset:32768
    v_mfma_f32_16x16x32_bf16 v[96:99], a[236:239], a[152:155], v[96:99]
    buffer_load_dwordx4 a[208:211], v242, s[40:43], s94 offen sc1
    v_mfma_f32_16x16x32_bf16 v[104:107], a[236:239], a[156:159], 0
    ds_read_b64_tr_b16 v[138:139], v251 offset:36864
    v_mfma_f32_16x16x32_bf16 v[104:107], a[232:235], a[140:143], v[104:107]
    buffer_load_dwordx4 a[212:215], v243, s[40:43], s94 offen sc1
    v_mfma_f32_16x16x32_bf16 v[112:115], a[232:235], a[144:147], 0
    ds_read_b64_tr_b16 v[140:141], v251 offset:40960
    v_mfma_f32_16x16x32_bf16 v[112:115], a[236:239], a[160:163], v[112:115]
    v_readlane_b32 s95, v246, 5
    v_mfma_f32_16x16x32_bf16 v[120:123], a[236:239], a[164:167], 0
    ds_read_b64_tr_b16 v[142:143], v251 offset:45056
    v_mfma_f32_16x16x32_bf16 v[120:123], a[232:235], a[148:151], v[120:123]
    v_mfma_f32_16x16x32_bf16 v[124:127], a[240:243], a[148:151], 0
    ds_read_b64_tr_b16 v[144:145], v252 offset:32768
    v_mfma_f32_16x16x32_bf16 v[124:127], a[244:247], a[164:167], v[124:127]
    buffer_load_dwordx4 a[216:219], v240, s[40:43], s95 offen sc1
    v_mfma_f32_16x16x32_bf16 v[116:119], a[244:247], a[160:163], 0
    ds_read_b64_tr_b16 v[146:147], v252 offset:36864
    v_mfma_f32_16x16x32_bf16 v[116:119], a[240:243], a[144:147], v[116:119]
    buffer_load_dwordx4 a[220:223], v241, s[40:43], s95 offen sc1
    v_mfma_f32_16x16x32_bf16 v[108:111], a[240:243], a[140:143], 0
    ds_read_b64_tr_b16 v[148:149], v252 offset:40960
    v_mfma_f32_16x16x32_bf16 v[108:111], a[244:247], a[156:159], v[108:111]
    buffer_load_dwordx4 a[224:227], v242, s[40:43], s95 offen sc1
    v_mfma_f32_16x16x32_bf16 v[100:103], a[244:247], a[152:155], 0
    ds_read_b64_tr_b16 v[150:151], v252 offset:45056
    v_mfma_f32_16x16x32_bf16 v[100:103], a[240:243], a[136:139], v[100:103]
    s_waitcnt lgkmcnt(4)
    v_mfma_f32_16x16x32_bf16 v[0:3], v[128:131], a[168:171], v[0:3]
    ds_read_b64_tr_b16 v[152:153], v253 offset:32768
    v_mfma_f32_16x16x32_bf16 v[0:3], v[132:135], a[184:187], v[0:3]
    buffer_load_dwordx4 a[228:231], v243, s[40:43], s95 offen sc1
    v_mfma_f32_16x16x32_bf16 v[8:11], v[132:135], a[188:191], v[8:11]
    ds_read_b64_tr_b16 v[154:155], v253 offset:36864
    v_mfma_f32_16x16x32_bf16 v[8:11], v[128:131], a[172:175], v[8:11]
    v_readlane_b32 s92, v246, 6
    v_mfma_f32_16x16x32_bf16 v[16:19], v[128:131], a[176:179], v[16:19]
    ds_read_b64_tr_b16 v[156:157], v253 offset:40960
    v_mfma_f32_16x16x32_bf16 v[16:19], v[132:135], a[192:195], v[16:19]
    ds_read_b64_tr_b16 v[158:159], v253 offset:45056
    v_mfma_f32_16x16x32_bf16 v[24:27], v[132:135], a[196:199], v[24:27]
    buffer_load_dwordx4 a[0:3], v240, s[40:43], s92 offen sc1
    v_mfma_f32_16x16x32_bf16 v[24:27], v[128:131], a[180:183], v[24:27]
    buffer_load_dwordx4 a[4:7], v241, s[40:43], s92 offen sc1
    v_mfma_f32_16x16x32_bf16 v[28:31], v[136:139], a[180:183], v[28:31]
    ds_read_b64_tr_b16 a[232:233], v249 offset:32768
    v_mfma_f32_16x16x32_bf16 v[28:31], v[140:143], a[196:199], v[28:31]
    buffer_load_dwordx4 a[8:11], v242, s[40:43], s92 offen sc1
    v_mfma_f32_16x16x32_bf16 v[20:23], v[140:143], a[192:195], v[20:23]
    ds_read_b64_tr_b16 a[234:235], v249 offset:36864
    v_mfma_f32_16x16x32_bf16 v[20:23], v[136:139], a[176:179], v[20:23]
    buffer_load_dwordx4 a[12:15], v243, s[40:43], s92 offen sc1
    v_mfma_f32_16x16x32_bf16 v[12:15], v[136:139], a[172:175], v[12:15]
    ds_read_b64_tr_b16 a[236:237], v249 offset:40960
    v_mfma_f32_16x16x32_bf16 v[12:15], v[140:143], a[188:191], v[12:15]
    v_readlane_b32 s74, v246, 3
    v_mfma_f32_16x16x32_bf16 v[4:7], v[140:143], a[184:187], v[4:7]
    ds_read_b64_tr_b16 a[238:239], v249 offset:45056
    v_mfma_f32_16x16x32_bf16 v[4:7], v[136:139], a[168:171], v[4:7]
    s_waitcnt lgkmcnt(4)
    v_mfma_f32_16x16x32_bf16 v[32:35], v[144:147], a[168:171], v[32:35]
    ds_read_b64_tr_b16 a[240:241], v234 offset:32768
    v_mfma_f32_16x16x32_bf16 v[32:35], v[148:151], a[184:187], v[32:35]
    buffer_store_dwordx4 a[184:187], v240, s[40:43], s74 offen sc1
    v_mfma_f32_16x16x32_bf16 v[40:43], v[148:151], a[188:191], v[40:43]
    ds_read_b64_tr_b16 a[242:243], v234 offset:36864
    v_mfma_f32_16x16x32_bf16 v[40:43], v[144:147], a[172:175], v[40:43]
    buffer_store_dwordx4 a[188:191], v241, s[40:43], s74 offen sc1
    v_mfma_f32_16x16x32_bf16 v[48:51], v[144:147], a[176:179], v[48:51]
    ds_read_b64_tr_b16 a[244:245], v234 offset:40960
    v_mfma_f32_16x16x32_bf16 v[48:51], v[148:151], a[192:195], v[48:51]
    buffer_store_dwordx4 a[192:195], v242, s[40:43], s74 offen sc1
    v_mfma_f32_16x16x32_bf16 v[56:59], v[148:151], a[196:199], v[56:59]
    ds_read_b64_tr_b16 a[246:247], v234 offset:45056
    v_mfma_f32_16x16x32_bf16 v[56:59], v[144:147], a[180:183], v[56:59]
    buffer_store_dwordx4 a[196:199], v243, s[40:43], s74 offen sc1
    v_mfma_f32_16x16x32_bf16 v[60:63], v[152:155], a[180:183], v[60:63]
    ds_read_b64_tr_b16 v[128:129], v235 offset:32768
    v_mfma_f32_16x16x32_bf16 v[60:63], v[156:159], a[196:199], v[60:63]
    ds_read_b64_tr_b16 v[130:131], v235 offset:36864
    v_mfma_f32_16x16x32_bf16 v[52:55], v[156:159], a[192:195], v[52:55]
    ds_read_b64_tr_b16 v[132:133], v235 offset:40960
    v_mfma_f32_16x16x32_bf16 v[52:55], v[152:155], a[176:179], v[52:55]
    ds_read_b64_tr_b16 v[134:135], v235 offset:45056
    v_mfma_f32_16x16x32_bf16 v[44:47], v[152:155], a[172:175], v[44:47]
    ds_read_b64_tr_b16 v[136:137], v236 offset:32768
    v_mfma_f32_16x16x32_bf16 v[44:47], v[156:159], a[188:191], v[44:47]
    ds_read_b64_tr_b16 v[138:139], v236 offset:36864
    v_mfma_f32_16x16x32_bf16 v[36:39], v[156:159], a[184:187], v[36:39]
    ds_read_b64_tr_b16 v[140:141], v236 offset:40960
    v_mfma_f32_16x16x32_bf16 v[36:39], v[152:155], a[168:171], v[36:39]
    s_waitcnt lgkmcnt(7)
    v_mfma_f32_16x16x32_bf16 v[64:67], a[232:235], a[168:171], v[64:67]
    ds_read_b64_tr_b16 v[142:143], v236 offset:45056
    v_mfma_f32_16x16x32_bf16 v[64:67], a[236:239], a[184:187], v[64:67]
    s_memrealtime s[36:37]
    v_mfma_f32_16x16x32_bf16 v[72:75], a[236:239], a[188:191], v[72:75]
    v_readlane_b32 s94, v246, 7
    v_mfma_f32_16x16x32_bf16 v[72:75], a[232:235], a[172:175], v[72:75]
    v_mfma_f32_16x16x32_bf16 v[80:83], a[232:235], a[176:179], v[80:83]
    s_nop 2
    buffer_load_dwordx4 a[16:19], v240, s[40:43], s94 offen sc1
    v_mfma_f32_16x16x32_bf16 v[80:83], a[236:239], a[192:195], v[80:83]
    buffer_load_dwordx4 a[20:23], v241, s[40:43], s94 offen sc1
    v_mfma_f32_16x16x32_bf16 v[88:91], a[236:239], a[196:199], v[88:91]
    buffer_load_dwordx4 a[24:27], v242, s[40:43], s94 offen sc1
    v_mfma_f32_16x16x32_bf16 v[88:91], a[232:235], a[180:183], v[88:91]
    buffer_load_dwordx4 a[28:31], v243, s[40:43], s94 offen sc1
    v_readlane_b32 s95, v246, 8
    s_waitcnt vmcnt(40)
    s_waitcnt lgkmcnt(0)
    s_barrier
    v_mfma_f32_16x16x32_bf16 v[92:95], a[240:243], a[180:183], v[92:95]
    ds_read_b64_tr_b16 v[144:145], v250 offset:49152
    v_readfirstlane_b32 s34, v239
    v_mfma_f32_16x16x32_bf16 v[92:95], a[244:247], a[196:199], v[92:95]
    buffer_load_dwordx4 a[32:35], v240, s[40:43], s95 offen sc1
    ds_read_b64_tr_b16 v[146:147], v250 offset:53248
    v_mfma_f32_16x16x32_bf16 v[84:87], a[244:247], a[192:195], v[84:87]
    s_lshl_b32 s28, s79, 6
    s_add_u32 s28, s28, 720896
    buffer_load_dwordx4 a[36:39], v241, s[40:43], s95 offen sc1
    v_mfma_f32_16x16x32_bf16 v[84:87], a[240:243], a[176:179], v[84:87]
    ds_read_b64_tr_b16 v[148:149], v250 offset:57344
    v_mfma_f32_16x16x32_bf16 v[76:79], a[240:243], a[172:175], v[76:79]
    s_lshl_b32 s33, s66, 3
    s_add_u32 s33, s33, s28
    ds_read_b64_tr_b16 v[150:151], v250 offset:61440
    v_mfma_f32_16x16x32_bf16 v[76:79], a[244:247], a[188:191], v[76:79]
    buffer_load_dwordx4 a[40:43], v242, s[40:43], s95 offen sc1
    v_mfma_f32_16x16x32_bf16 v[68:71], a[244:247], a[184:187], v[68:71]
    s_sub_u32 s36, s36, s34
    s_lshl_b32 s36, s36, 2
    s_or_b32 s36, s36, s66
    v_mov_b32 v238, s36
    v_mfma_f32_16x16x32_bf16 v[68:71], a[240:243], a[168:171], v[68:71]
    v_mfma_f32_16x16x32_bf16 v[96:99], v[128:131], a[168:171], v[96:99]
    ds_read_b64_tr_b16 v[152:153], v251 offset:49152
    v_mfma_f32_16x16x32_bf16 v[96:99], v[132:135], a[184:187], v[96:99]
    s_cmp_eq_u32 s64, 0
    s_cselect_b32 s33, s33, 2.0
    s_mov_b64 exec, 1
    buffer_store_dwordx2 v[238:239], v254, s[44:47], s33 offen sc1
    s_mov_b64 exec, -1
    v_mfma_f32_16x16x32_bf16 v[104:107], v[132:135], a[188:191], v[104:107]
    ds_read_b64_tr_b16 v[154:155], v251 offset:53248
    v_mfma_f32_16x16x32_bf16 v[104:107], v[128:131], a[172:175], v[104:107]
    buffer_load_dwordx4 a[44:47], v243, s[40:43], s95 offen sc1
    v_mfma_f32_16x16x32_bf16 v[112:115], v[128:131], a[176:179], v[112:115]
    ds_read_b64_tr_b16 v[156:157], v251 offset:57344
    v_mfma_f32_16x16x32_bf16 v[112:115], v[132:135], a[192:195], v[112:115]
    v_readlane_b32 s92, v246, 9
    v_mfma_f32_16x16x32_bf16 v[120:123], v[132:135], a[196:199], v[120:123]
    ds_read_b64_tr_b16 v[158:159], v251 offset:61440
    v_mfma_f32_16x16x32_bf16 v[120:123], v[128:131], a[180:183], v[120:123]
    ds_read_b64_tr_b16 a[232:233], v252 offset:49152
    v_mfma_f32_16x16x32_bf16 v[124:127], v[136:139], a[180:183], v[124:127]
    buffer_load_dwordx4 a[48:51], v240, s[40:43], s92 offen sc1
    v_mfma_f32_16x16x32_bf16 v[124:127], v[140:143], a[196:199], v[124:127]
    v_subrev_u32 v160, 65536, v250
    v_mfma_f32_16x16x32_bf16 v[116:119], v[140:143], a[192:195], v[116:119]
    ds_read_b64_tr_b16 a[234:235], v252 offset:53248
    v_mfma_f32_16x16x32_bf16 v[116:119], v[136:139], a[176:179], v[116:119]
    buffer_load_dwordx4 a[52:55], v241, s[40:43], s92 offen sc1
    v_mfma_f32_16x16x32_bf16 v[108:111], v[136:139], a[172:175], v[108:111]
    ds_read_b64_tr_b16 a[236:237], v252 offset:57344
    v_mfma_f32_16x16x32_bf16 v[108:111], v[140:143], a[188:191], v[108:111]
    ds_read_b64_tr_b16 a[238:239], v252 offset:61440
    v_mfma_f32_16x16x32_bf16 v[100:103], v[140:143], a[184:187], v[100:103]
    buffer_load_dwordx4 a[56:59], v242, s[40:43], s92 offen sc1
    v_mfma_f32_16x16x32_bf16 v[100:103], v[136:139], a[168:171], v[100:103]
    s_waitcnt vmcnt(20) lgkmcnt(4)
    v_mfma_f32_16x16x32_bf16 v[0:3], v[144:147], a[200:203], v[0:3]
    ds_read_b64_tr_b16 a[240:241], v253 offset:49152
    v_mfma_f32_16x16x32_bf16 v[0:3], v[148:151], a[216:219], v[0:3]
    v_subrev_u32 v161, 65536, v251
    v_mfma_f32_16x16x32_bf16 v[8:11], v[148:151], a[220:223], v[8:11]
    ds_read_b64_tr_b16 a[242:243], v253 offset:53248
    v_mfma_f32_16x16x32_bf16 v[8:11], v[144:147], a[204:207], v[8:11]
    buffer_load_dwordx4 a[60:63], v243, s[40:43], s92 offen sc1
    v_mfma_f32_16x16x32_bf16 v[16:19], v[144:147], a[208:211], v[16:19]
    ds_read_b64_tr_b16 a[244:245], v253 offset:57344
    v_mfma_f32_16x16x32_bf16 v[16:19], v[148:151], a[224:227], v[16:19]
    v_readlane_b32 s93, v247, 10
    v_mfma_f32_16x16x32_bf16 v[24:27], v[148:151], a[228:231], v[24:27]
    ds_read_b64_tr_b16 a[246:247], v253 offset:61440
    s_add_u32 m0, s3, 16384
    v_mfma_f32_16x16x32_bf16 v[24:27], v[144:147], a[212:215], v[24:27]
    ds_read_b64_tr_b16 v[128:129], v249 offset:49152
    v_mfma_f32_16x16x32_bf16 v[28:31], v[152:155], a[212:215], v[28:31]
    buffer_load_dwordx4 v244, s[48:51], s93 offen lds
    v_mfma_f32_16x16x32_bf16 v[28:31], v[156:159], a[228:231], v[28:31]
    ds_read_b64_tr_b16 v[130:131], v249 offset:53248
    v_mfma_f32_16x16x32_bf16 v[20:23], v[156:159], a[224:227], v[20:23]
    s_add_u32 m0, s3, 18432
    v_subrev_u32 v162, 65536, v252
    v_mfma_f32_16x16x32_bf16 v[20:23], v[152:155], a[208:211], v[20:23]
    buffer_load_dwordx4 v245, s[48:51], s93 offen lds
    v_mfma_f32_16x16x32_bf16 v[12:15], v[152:155], a[204:207], v[12:15]
    ds_read_b64_tr_b16 v[132:133], v249 offset:57344
    v_mfma_f32_16x16x32_bf16 v[12:15], v[156:159], a[220:223], v[12:15]
    v_readlane_b32 s94, v247, 11
    v_mfma_f32_16x16x32_bf16 v[4:7], v[156:159], a[216:219], v[4:7]
    ds_read_b64_tr_b16 v[134:135], v249 offset:61440
    s_add_u32 m0, s3, 24576
    v_mfma_f32_16x16x32_bf16 v[4:7], v[152:155], a[200:203], v[4:7]
    s_waitcnt lgkmcnt(4)
    v_mfma_f32_16x16x32_bf16 v[32:35], a[232:235], a[200:203], v[32:35]
    ds_read_b64_tr_b16 v[136:137], v234 offset:49152
    v_mfma_f32_16x16x32_bf16 v[32:35], a[236:239], a[216:219], v[32:35]
    buffer_load_dwordx4 v244, s[48:51], s94 offen lds
    v_mfma_f32_16x16x32_bf16 v[40:43], a[236:239], a[220:223], v[40:43]
    ds_read_b64_tr_b16 v[138:139], v234 offset:53248
    s_add_u32 m0, s3, 26624
    v_mfma_f32_16x16x32_bf16 v[40:43], a[232:235], a[204:207], v[40:43]
    buffer_load_dwordx4 v245, s[48:51], s94 offen lds
    v_mfma_f32_16x16x32_bf16 v[48:51], a[232:235], a[208:211], v[48:51]
    ds_read_b64_tr_b16 v[140:141], v234 offset:57344
    v_mfma_f32_16x16x32_bf16 v[48:51], a[236:239], a[224:227], v[48:51]
    v_readlane_b32 s95, v246, 10
    v_mfma_f32_16x16x32_bf16 v[56:59], a[236:239], a[228:231], v[56:59]
    ds_read_b64_tr_b16 v[142:143], v234 offset:61440
    v_mfma_f32_16x16x32_bf16 v[56:59], a[232:235], a[212:215], v[56:59]
    v_subrev_u32 v163, 65536, v253
    v_mfma_f32_16x16x32_bf16 v[60:63], a[240:243], a[212:215], v[60:63]
    ds_read_b64_tr_b16 v[144:145], v235 offset:49152
    v_mfma_f32_16x16x32_bf16 v[60:63], a[244:247], a[228:231], v[60:63]
    buffer_load_dwordx4 a[64:67], v240, s[40:43], s95 offen sc1
    v_mfma_f32_16x16x32_bf16 v[52:55], a[244:247], a[224:227], v[52:55]
    ds_read_b64_tr_b16 v[146:147], v235 offset:53248
    v_mfma_f32_16x16x32_bf16 v[52:55], a[240:243], a[208:211], v[52:55]
    buffer_load_dwordx4 a[68:71], v241, s[40:43], s95 offen sc1
    v_mfma_f32_16x16x32_bf16 v[44:47], a[240:243], a[204:207], v[44:47]
    ds_read_b64_tr_b16 v[148:149], v235 offset:57344
    v_mfma_f32_16x16x32_bf16 v[44:47], a[244:247], a[220:223], v[44:47]
    v_subrev_u32 v164, 65536, v249
    v_mfma_f32_16x16x32_bf16 v[36:39], a[244:247], a[216:219], v[36:39]
    ds_read_b64_tr_b16 v[150:151], v235 offset:61440
    v_mfma_f32_16x16x32_bf16 v[36:39], a[240:243], a[200:203], v[36:39]
    s_waitcnt lgkmcnt(4)
    v_mfma_f32_16x16x32_bf16 v[64:67], v[128:131], a[200:203], v[64:67]
    ds_read_b64_tr_b16 v[152:153], v236 offset:49152
    v_mfma_f32_16x16x32_bf16 v[64:67], v[132:135], a[216:219], v[64:67]
    buffer_load_dwordx4 a[72:75], v242, s[40:43], s95 offen sc1
    v_mfma_f32_16x16x32_bf16 v[72:75], v[132:135], a[220:223], v[72:75]
    ds_read_b64_tr_b16 v[154:155], v236 offset:53248
    v_mfma_f32_16x16x32_bf16 v[72:75], v[128:131], a[204:207], v[72:75]
    buffer_load_dwordx4 a[76:79], v243, s[40:43], s95 offen sc1
    v_mfma_f32_16x16x32_bf16 v[80:83], v[128:131], a[208:211], v[80:83]
    ds_read_b64_tr_b16 v[156:157], v236 offset:57344
    v_mfma_f32_16x16x32_bf16 v[80:83], v[132:135], a[224:227], v[80:83]
    v_readlane_b32 s92, v246, 11
    v_mfma_f32_16x16x32_bf16 v[88:91], v[132:135], a[228:231], v[88:91]
    ds_read_b64_tr_b16 v[158:159], v236 offset:61440
    v_mfma_f32_16x16x32_bf16 v[88:91], v[128:131], a[212:215], v[88:91]
    v_subrev_u32 v165, 65536, v234
    s_barrier
    v_mfma_f32_16x16x32_bf16 v[92:95], v[136:139], a[212:215], v[92:95]
    ds_read_b64_tr_b16 a[232:233], v250 offset:0
    v_mfma_f32_16x16x32_bf16 v[92:95], v[140:143], a[228:231], v[92:95]
    buffer_load_dwordx4 a[80:83], v240, s[40:43], s92 offen sc1
    v_mfma_f32_16x16x32_bf16 v[84:87], v[140:143], a[224:227], v[84:87]
    ds_read_b64_tr_b16 a[234:235], v250 offset:4096
    v_mfma_f32_16x16x32_bf16 v[84:87], v[136:139], a[208:211], v[84:87]
    buffer_load_dwordx4 a[84:87], v241, s[40:43], s92 offen sc1
    v_mfma_f32_16x16x32_bf16 v[76:79], v[136:139], a[204:207], v[76:79]
    ds_read_b64_tr_b16 a[236:237], v250 offset:8192
    v_mfma_f32_16x16x32_bf16 v[76:79], v[140:143], a[220:223], v[76:79]
    v_mfma_f32_16x16x32_bf16 v[68:71], v[140:143], a[216:219], v[68:71]
    ds_read_b64_tr_b16 a[238:239], v250 offset:12288
    v_mfma_f32_16x16x32_bf16 v[68:71], v[136:139], a[200:203], v[68:71]
    s_waitcnt lgkmcnt(4)
    v_mfma_f32_16x16x32_bf16 v[96:99], v[144:147], a[200:203], v[96:99]
    ds_read_b64_tr_b16 a[240:241], v251 offset:0
    v_mfma_f32_16x16x32_bf16 v[96:99], v[148:151], a[216:219], v[96:99]
    buffer_load_dwordx4 a[88:91], v242, s[40:43], s92 offen sc1
    v_mfma_f32_16x16x32_bf16 v[104:107], v[148:151], a[220:223], v[104:107]
    ds_read_b64_tr_b16 a[242:243], v251 offset:4096
    v_mfma_f32_16x16x32_bf16 v[104:107], v[144:147], a[204:207], v[104:107]
    v_subrev_u32 v166, 65536, v235
    v_mfma_f32_16x16x32_bf16 v[112:115], v[144:147], a[208:211], v[112:115]
    ds_read_b64_tr_b16 a[244:245], v251 offset:8192
    v_mfma_f32_16x16x32_bf16 v[112:115], v[148:151], a[224:227], v[112:115]
    buffer_load_dwordx4 a[92:95], v243, s[40:43], s92 offen sc1
    v_mfma_f32_16x16x32_bf16 v[120:123], v[148:151], a[228:231], v[120:123]
    ds_read_b64_tr_b16 a[246:247], v251 offset:12288
    v_mfma_f32_16x16x32_bf16 v[120:123], v[144:147], a[212:215], v[120:123]
    v_readlane_b32 s93, v247, 12
    v_mfma_f32_16x16x32_bf16 v[124:127], v[152:155], a[212:215], v[124:127]
    ds_read_b64_tr_b16 v[128:129], v252 offset:0
    s_add_u32 m0, s3, 32768
    v_mfma_f32_16x16x32_bf16 v[124:127], v[156:159], a[228:231], v[124:127]
    v_subrev_u32 v167, 65536, v236
    v_mfma_f32_16x16x32_bf16 v[116:119], v[156:159], a[224:227], v[116:119]
    ds_read_b64_tr_b16 v[130:131], v252 offset:4096
    v_mfma_f32_16x16x32_bf16 v[116:119], v[152:155], a[208:211], v[116:119]
    buffer_load_dwordx4 v244, s[48:51], s93 offen lds
    v_mfma_f32_16x16x32_bf16 v[108:111], v[152:155], a[204:207], v[108:111]
    ds_read_b64_tr_b16 v[132:133], v252 offset:8192
    s_add_u32 m0, s3, 34816
    v_mfma_f32_16x16x32_bf16 v[108:111], v[156:159], a[220:223], v[108:111]
    buffer_load_dwordx4 v245, s[48:51], s93 offen lds
    v_mfma_f32_16x16x32_bf16 v[100:103], v[156:159], a[216:219], v[100:103]
    ds_read_b64_tr_b16 v[134:135], v252 offset:12288
    v_mfma_f32_16x16x32_bf16 v[100:103], v[152:155], a[200:203], v[100:103]
    s_waitcnt vmcnt(23) lgkmcnt(4)
    v_mfma_f32_16x16x32_bf16 v[0:3], a[232:235], a[0:3], v[0:3]
    ds_read_b64_tr_b16 v[136:137], v253 offset:0
    v_mfma_f32_16x16x32_bf16 v[0:3], a[236:239], a[16:19], v[0:3]
    v_readlane_b32 s94, v247, 13
    v_mfma_f32_16x16x32_bf16 v[8:11], a[236:239], a[20:23], v[8:11]
    ds_read_b64_tr_b16 v[138:139], v253 offset:4096
    s_add_u32 m0, s3, 40960
    v_mfma_f32_16x16x32_bf16 v[8:11], a[232:235], a[4:7], v[8:11]
    v_mfma_f32_16x16x32_bf16 v[16:19], a[232:235], a[8:11], v[16:19]
    ds_read_b64_tr_b16 v[140:141], v253 offset:8192
    v_mfma_f32_16x16x32_bf16 v[16:19], a[236:239], a[24:27], v[16:19]
    buffer_load_dwordx4 v244, s[48:51], s94 offen lds
    v_mfma_f32_16x16x32_bf16 v[24:27], a[236:239], a[28:31], v[24:27]
    ds_read_b64_tr_b16 v[142:143], v253 offset:12288
    s_add_u32 m0, s3, 43008
    v_mfma_f32_16x16x32_bf16 v[24:27], a[232:235], a[12:15], v[24:27]
    buffer_load_dwordx4 v245, s[48:51], s94 offen lds
    v_mfma_f32_16x16x32_bf16 v[28:31], a[240:243], a[12:15], v[28:31]
    ds_read_b64_tr_b16 v[144:145], v249 offset:0
    v_mfma_f32_16x16x32_bf16 v[28:31], a[244:247], a[28:31], v[28:31]
    v_readlane_b32 s95, v246, 12
    v_mfma_f32_16x16x32_bf16 v[20:23], a[244:247], a[24:27], v[20:23]
    ds_read_b64_tr_b16 v[146:147], v249 offset:4096
    v_mfma_f32_16x16x32_bf16 v[20:23], a[240:243], a[8:11], v[20:23]
    s_cmp_lg_u32 s78, 0
    s_cbranch_scc1 L_fw_g2
L_fl_g2:
    s_mov_b64 exec, 1
    buffer_store_dword v239, v254, s[44:47], s10 offen offset:256
    buffer_store_dword v239, v254, s[44:47], s10 offen offset:384 sc1
    s_mov_b64 exec, -1
    v_mfma_f32_16x16x32_bf16 v[12:15], a[240:243], a[4:7], v[12:15]
    ds_read_b64_tr_b16 v[148:149], v249 offset:8192
    v_mfma_f32_16x16x32_bf16 v[12:15], a[244:247], a[20:23], v[12:15]
    buffer_load_dwordx4 a[96:99], v240, s[40:43], s95 offen sc1
    v_mfma_f32_16x16x32_bf16 v[4:7], a[244:247], a[16:19], v[4:7]
    ds_read_b64_tr_b16 v[150:151], v249 offset:12288
    v_mfma_f32_16x16x32_bf16 v[4:7], a[240:243], a[0:3], v[4:7]
    s_waitcnt lgkmcnt(4)
    v_mfma_f32_16x16x32_bf16 v[32:35], v[128:131], a[0:3], v[32:35]
    ds_read_b64_tr_b16 v[152:153], v234 offset:0
    v_mfma_f32_16x16x32_bf16 v[32:35], v[132:135], a[16:19], v[32:35]
    v_lshrrev_b32 v230, 2, v254
    v_mfma_f32_16x16x32_bf16 v[40:43], v[132:135], a[20:23], v[40:43]
    ds_read_b64_tr_b16 v[154:155], v234 offset:4096
    v_mfma_f32_16x16x32_bf16 v[40:43], v[128:131], a[4:7], v[40:43]
    buffer_load_dwordx4 a[100:103], v241, s[40:43], s95 offen sc1
    v_mfma_f32_16x16x32_bf16 v[48:51], v[128:131], a[8:11], v[48:51]
    ds_read_b64_tr_b16 v[156:157], v234 offset:8192
    v_mfma_f32_16x16x32_bf16 v[48:51], v[132:135], a[24:27], v[48:51]
    buffer_load_dwordx4 a[104:107], v242, s[40:43], s95 offen sc1
    v_mfma_f32_16x16x32_bf16 v[56:59], v[132:135], a[28:31], v[56:59]
    ds_read_b64_tr_b16 v[158:159], v234 offset:12288
    v_mfma_f32_16x16x32_bf16 v[56:59], v[128:131], a[12:15], v[56:59]
    buffer_load_dwordx4 a[108:111], v243, s[40:43], s95 offen sc1
    v_mfma_f32_16x16x32_bf16 v[60:63], v[136:139], a[12:15], v[60:63]
    ds_read_b64_tr_b16 a[232:233], v235 offset:0
    v_mfma_f32_16x16x32_bf16 v[60:63], v[140:143], a[28:31], v[60:63]
    v_readlane_b32 s92, v246, 13
    v_mfma_f32_16x16x32_bf16 v[52:55], v[140:143], a[24:27], v[52:55]
    ds_read_b64_tr_b16 a[234:235], v235 offset:4096
    v_mfma_f32_16x16x32_bf16 v[52:55], v[136:139], a[8:11], v[52:55]
    v_mfma_f32_16x16x32_bf16 v[44:47], v[136:139], a[4:7], v[44:47]
    ds_read_b64_tr_b16 a[236:237], v235 offset:8192
    v_mfma_f32_16x16x32_bf16 v[44:47], v[140:143], a[20:23], v[44:47]
    buffer_load_dwordx4 a[112:115], v240, s[40:43], s92 offen sc1
    v_mfma_f32_16x16x32_bf16 v[36:39], v[140:143], a[16:19], v[36:39]
    ds_read_b64_tr_b16 a[238:239], v235 offset:12288
    v_mfma_f32_16x16x32_bf16 v[36:39], v[136:139], a[0:3], v[36:39]
    s_waitcnt lgkmcnt(4)
    v_mfma_f32_16x16x32_bf16 v[64:67], v[144:147], a[0:3], v[64:67]
    ds_read_b64_tr_b16 a[240:241], v236 offset:0
    v_mfma_f32_16x16x32_bf16 v[64:67], v[148:151], a[16:19], v[64:67]
    buffer_load_dwordx4 a[116:119], v241, s[40:43], s92 offen sc1
    v_mfma_f32_16x16x32_bf16 v[72:75], v[148:151], a[20:23], v[72:75]
    ds_read_b64_tr_b16 a[242:243], v236 offset:4096
    v_mfma_f32_16x16x32_bf16 v[72:75], v[144:147], a[4:7], v[72:75]
    buffer_load_dwordx4 a[120:123], v242, s[40:43], s92 offen sc1
    v_mfma_f32_16x16x32_bf16 v[80:83], v[144:147], a[8:11], v[80:83]
    ds_read_b64_tr_b16 a[244:245], v236 offset:8192
    v_mfma_f32_16x16x32_bf16 v[80:83], v[148:151], a[24:27], v[80:83]
    buffer_load_dwordx4 a[124:127], v243, s[40:43], s92 offen sc1
    v_mfma_f32_16x16x32_bf16 v[88:91], v[148:151], a[28:31], v[88:91]
    ds_read_b64_tr_b16 a[246:247], v236 offset:12288
    v_mfma_f32_16x16x32_bf16 v[88:91], v[144:147], a[12:15], v[88:91]
    v_readlane_b32 s93, v247, 14
    s_add_u32 m0, s3, 49152
    s_barrier
    v_mfma_f32_16x16x32_bf16 v[92:95], v[152:155], a[12:15], v[92:95]
    ds_read_b64_tr_b16 v[128:129], v160 offset:49152
    s_nop 0
    buffer_load_dwordx4 v244, s[48:51], s93 offen lds
    v_mfma_f32_16x16x32_bf16 v[92:95], v[156:159], a[28:31], v[92:95]
    ds_read_b64_tr_b16 v[130:131], v160 offset:53248
    s_add_u32 m0, s3, 51200
    v_mfma_f32_16x16x32_bf16 v[84:87], v[156:159], a[24:27], v[84:87]
    buffer_load_dwordx4 v245, s[48:51], s93 offen lds
    ds_read_b64_tr_b16 v[132:133], v160 offset:57344
    v_mfma_f32_16x16x32_bf16 v[84:87], v[152:155], a[8:11], v[84:87]
    v_readlane_b32 s94, v247, 15
    ds_read_b64_tr_b16 v[134:135], v160 offset:61440
    v_mfma_f32_16x16x32_bf16 v[76:79], v[152:155], a[4:7], v[76:79]
    s_add_u32 m0, s3, 57344
    ds_read_b64_tr_b16 v[136:137], v161 offset:49152
    v_mfma_f32_16x16x32_bf16 v[76:79], v[156:159], a[20:23], v[76:79]
    buffer_load_dwordx4 v244, s[48:51], s94 offen lds
    ds_read_b64_tr_b16 v[138:139], v161 offset:53248
    v_mfma_f32_16x16x32_bf16 v[68:71], v[156:159], a[16:19], v[68:71]
    s_add_u32 m0, s3, 59392
    ds_read_b64_tr_b16 v[140:141], v161 offset:57344
    v_mfma_f32_16x16x32_bf16 v[68:71], v[152:155], a[0:3], v[68:71]
    s_waitcnt lgkmcnt(7)
    v_mfma_f32_16x16x32_bf16 v[96:99], a[232:235], a[0:3], v[96:99]
    v_bfe_u32 v227, v254, 4, 4
    buffer_load_dwordx4 v245, s[48:51], s94 offen lds
    v_mfma_f32_16x16x32_bf16 v[96:99], a[236:239], a[16:19], v[96:99]
    v_lshlrev_b32 v227, 11, v227
    v_mfma_f32_16x16x32_bf16 v[104:107], a[236:239], a[20:23], v[104:107]
    v_readlane_b32 s95, v246, 14
    v_mfma_f32_16x16x32_bf16 v[104:107], a[232:235], a[4:7], v[104:107]
    ds_read_b64_tr_b16 v[142:143], v161 offset:61440
    v_mfma_f32_16x16x32_bf16 v[112:115], a[232:235], a[8:11], v[112:115]
    v_lshrrev_b32 v229, 8, v254
    v_mfma_f32_16x16x32_bf16 v[112:115], a[236:239], a[24:27], v[112:115]
    buffer_load_dwordx4 a[136:139], v240, s[40:43], s95 offen sc1
    v_mfma_f32_16x16x32_bf16 v[120:123], a[236:239], a[28:31], v[120:123]
    ds_read_b64_tr_b16 v[144:145], v162 offset:49152
    v_mfma_f32_16x16x32_bf16 v[120:123], a[232:235], a[12:15], v[120:123]
    v_lshl_add_u32 v228, v229, 3, v227
    v_mfma_f32_16x16x32_bf16 v[124:127], a[240:243], a[12:15], v[124:127]
    ds_read_b64_tr_b16 v[146:147], v162 offset:53248
    v_mfma_f32_16x16x32_bf16 v[124:127], a[244:247], a[28:31], v[124:127]
    buffer_load_dwordx4 a[140:143], v241, s[40:43], s95 offen sc1
    v_mfma_f32_16x16x32_bf16 v[116:119], a[244:247], a[24:27], v[116:119]
    ds_read_b64_tr_b16 v[148:149], v162 offset:57344
    v_mfma_f32_16x16x32_bf16 v[116:119], a[240:243], a[8:11], v[116:119]
    v_lshrrev_b32 v229, 9, v254
    v_mfma_f32_16x16x32_bf16 v[108:111], a[240:243], a[4:7], v[108:111]
    ds_read_b64_tr_b16 v[150:151], v162 offset:61440
    v_mfma_f32_16x16x32_bf16 v[108:111], a[244:247], a[20:23], v[108:111]
    buffer_load_dwordx4 a[144:147], v242, s[40:43], s95 offen sc1
    v_mfma_f32_16x16x32_bf16 v[100:103], a[244:247], a[16:19], v[100:103]
    v_lshl_add_u32 v227, v229, 4, v227
    v_mfma_f32_16x16x32_bf16 v[100:103], a[240:243], a[0:3], v[100:103]
    s_waitcnt vmcnt(33) lgkmcnt(4)
    v_mfma_f32_16x16x32_bf16 v[0:3], v[128:131], a[32:35], v[0:3]
    ds_read_b64_tr_b16 v[152:153], v163 offset:49152
    v_mfma_f32_16x16x32_bf16 v[0:3], v[132:135], a[48:51], v[0:3]
    ds_read_b64_tr_b16 v[154:155], v163 offset:53248
    v_mfma_f32_16x16x32_bf16 v[8:11], v[132:135], a[52:55], v[8:11]
    v_bfe_u32 v229, v254, 8, 1
    v_mfma_f32_16x16x32_bf16 v[8:11], v[128:131], a[36:39], v[8:11]
    buffer_load_dwordx4 a[148:151], v243, s[40:43], s95 offen sc1
    v_mfma_f32_16x16x32_bf16 v[16:19], v[128:131], a[40:43], v[16:19]
    ds_read_b64_tr_b16 v[156:157], v163 offset:57344
    v_mfma_f32_16x16x32_bf16 v[16:19], v[132:135], a[56:59], v[16:19]
    v_readlane_b32 s92, v246, 15
    v_mfma_f32_16x16x32_bf16 v[24:27], v[132:135], a[60:63], v[24:27]
    ds_read_b64_tr_b16 v[158:159], v163 offset:61440
    v_mfma_f32_16x16x32_bf16 v[24:27], v[128:131], a[44:47], v[24:27]
    v_lshl_add_u32 v229, v229, 5, v227
    v_mfma_f32_16x16x32_bf16 v[28:31], v[136:139], a[44:47], v[28:31]
    ds_read_b64_tr_b16 a[232:233], v164 offset:49152
    v_mfma_f32_16x16x32_bf16 v[28:31], v[140:143], a[60:63], v[28:31]
    buffer_load_dwordx4 a[152:155], v240, s[40:43], s92 offen sc1
    s_lshl_b32 s88, s65, 2
    s_add_u32 s88, s88, s64
    v_mfma_f32_16x16x32_bf16 v[20:23], v[140:143], a[56:59], v[20:23]
    ds_read_b64_tr_b16 a[234:235], v164 offset:53248
    v_mfma_f32_16x16x32_bf16 v[20:23], v[136:139], a[40:43], v[20:23]
    buffer_load_dwordx4 a[156:159], v241, s[40:43], s92 offen sc1
    v_mfma_f32_16x16x32_bf16 v[12:15], v[136:139], a[36:39], v[12:15]
    ds_read_b64_tr_b16 a[236:237], v164 offset:57344
    s_lshl_b32 s88, s88, 17
    s_lshl_b32 s89, s67, 2
    v_mfma_f32_16x16x32_bf16 v[12:15], v[140:143], a[52:55], v[12:15]
    ds_read_b64_tr_b16 a[238:239], v164 offset:61440
    v_mfma_f32_16x16x32_bf16 v[4:7], v[140:143], a[48:51], v[4:7]
    s_add_u32 s89, s89, s66
    s_lshl_b32 s89, s89, 6
    buffer_load_dwordx4 a[160:163], v242, s[40:43], s92 offen sc1
    v_mfma_f32_16x16x32_bf16 v[4:7], v[136:139], a[32:35], v[4:7]
    s_waitcnt lgkmcnt(4)
    v_mfma_f32_16x16x32_bf16 v[32:35], v[144:147], a[32:35], v[32:35]
    ds_read_b64_tr_b16 a[240:241], v165 offset:49152
    v_mfma_f32_16x16x32_bf16 v[32:35], v[148:151], a[48:51], v[32:35]
    s_add_u32 s88, s88, s89
    s_add_u32 s89, s88, 32768
    ds_read_b64_tr_b16 a[242:243], v165 offset:53248
    v_mfma_f32_16x16x32_bf16 v[40:43], v[148:151], a[52:55], v[40:43]
    buffer_load_dwordx4 a[164:167], v243, s[40:43], s92 offen sc1
    v_mfma_f32_16x16x32_bf16 v[40:43], v[144:147], a[36:39], v[40:43]
    v_readlane_b32 s93, v247, 16
    v_mfma_f32_16x16x32_bf16 v[48:51], v[144:147], a[40:43], v[48:51]
    ds_read_b64_tr_b16 a[244:245], v165 offset:57344
    v_mfma_f32_16x16x32_bf16 v[48:51], v[148:151], a[56:59], v[48:51]
    s_add_u32 s90, s88, 65536
    s_add_u32 s91, s88, 98304
    ds_read_b64_tr_b16 a[246:247], v165 offset:61440
    v_mfma_f32_16x16x32_bf16 v[56:59], v[148:151], a[60:63], v[56:59]
    s_add_u32 m0, s3, 98304
    ds_read_b64_tr_b16 v[128:129], v166 offset:49152
    v_mfma_f32_16x16x32_bf16 v[56:59], v[144:147], a[44:47], v[56:59]
    buffer_load_dwordx4 v244, s[48:51], s93 offen lds
    v_mfma_f32_16x16x32_bf16 v[60:63], v[152:155], a[44:47], v[60:63]
    s_mov_b32 s72, 0x3f80
    s_mov_b32 s73, 0x3f800000
    ds_read_b64_tr_b16 v[130:131], v166 offset:53248
    v_mfma_f32_16x16x32_bf16 v[60:63], v[156:159], a[60:63], v[60:63]
    s_add_u32 m0, s3, 100352
    v_readlane_b32 s13, v246, 0
    v_mfma_f32_16x16x32_bf16 v[52:55], v[156:159], a[56:59], v[52:55]
    buffer_load_dwordx4 v245, s[48:51], s93 offen lds
    v_mfma_f32_16x16x32_bf16 v[52:55], v[152:155], a[40:43], v[52:55]
    v_readlane_b32 s94, v247, 17
    v_mfma_f32_16x16x32_bf16 v[44:47], v[152:155], a[36:39], v[44:47]
    ds_read_b64_tr_b16 v[132:133], v166 offset:57344
    v_mfma_f32_16x16x32_bf16 v[44:47], v[156:159], a[52:55], v[44:47]
    ds_read_b64_tr_b16 v[134:135], v166 offset:61440
    v_mfma_f32_16x16x32_bf16 v[36:39], v[156:159], a[48:51], v[36:39]
    s_add_u32 m0, s3, 106496
    v_readlane_b32 s14, v246, 1
    v_mfma_f32_16x16x32_bf16 v[36:39], v[152:155], a[32:35], v[36:39]
    s_waitcnt lgkmcnt(4)
    v_mfma_f32_16x16x32_bf16 v[64:67], a[232:235], a[32:35], v[64:67]
    ds_read_b64_tr_b16 v[136:137], v167 offset:49152
    v_mfma_f32_16x16x32_bf16 v[64:67], a[236:239], a[48:51], v[64:67]
    buffer_load_dwordx4 v244, s[48:51], s94 offen lds
    v_mfma_f32_16x16x32_bf16 v[72:75], a[236:239], a[52:55], v[72:75]
    ds_read_b64_tr_b16 v[138:139], v167 offset:53248
    s_add_u32 m0, s3, 108544
    v_mfma_f32_16x16x32_bf16 v[72:75], a[232:235], a[36:39], v[72:75]
    v_readlane_b32 s15, v246, 2
    v_mfma_f32_16x16x32_bf16 v[80:83], a[232:235], a[40:43], v[80:83]
    ds_read_b64_tr_b16 v[140:141], v167 offset:57344
    v_mfma_f32_16x16x32_bf16 v[80:83], a[236:239], a[56:59], v[80:83]
    buffer_load_dwordx4 v245, s[48:51], s94 offen lds
    s_add_u32 s80, s66, 1
    s_and_b32 s80, s80, 3
    v_mfma_f32_16x16x32_bf16 v[88:91], a[236:239], a[60:63], v[88:91]
    ds_read_b64_tr_b16 v[142:143], v167 offset:61440
    v_mfma_f32_16x16x32_bf16 v[88:91], a[232:235], a[44:47], v[88:91]
    v_readlane_b32 s95, v246, 16
    s_sub_u32 s80, s80, s66
    s_mul_i32 s80, s80, 36864
    s_waitcnt vmcnt(38)
    s_barrier
    v_mfma_f32_16x16x32_bf16 v[92:95], a[240:243], a[44:47], v[92:95]
    ds_read_b64_tr_b16 v[144:145], v160 offset:0
    v_mfma_f32_16x16x32_bf16 v[92:95], a[244:247], a[60:63], v[92:95]
    buffer_load_dwordx4 a[168:171], v240, s[40:43], s95 offen sc1
    v_mfma_f32_16x16x32_bf16 v[84:87], a[244:247], a[56:59], v[84:87]
    ds_read_b64_tr_b16 v[146:147], v160 offset:4096
    v_mfma_f32_16x16x32_bf16 v[84:87], a[240:243], a[40:43], v[84:87]
    s_add_u32 s80, s80, s15
    buffer_load_dwordx4 a[172:175], v241, s[40:43], s95 offen sc1
    v_mfma_f32_16x16x32_bf16 v[76:79], a[240:243], a[36:39], v[76:79]
    ds_read_b64_tr_b16 v[148:149], v160 offset:8192
    v_mfma_f32_16x16x32_bf16 v[76:79], a[244:247], a[52:55], v[76:79]
    v_mfma_f32_16x16x32_bf16 v[68:71], a[244:247], a[48:51], v[68:71]
    ds_read_b64_tr_b16 v[150:151], v160 offset:12288
    s_add_u32 s81, s66, 2
    s_and_b32 s81, s81, 3
    v_mfma_f32_16x16x32_bf16 v[68:71], a[240:243], a[32:35], v[68:71]
    s_waitcnt lgkmcnt(4)
    v_mfma_f32_16x16x32_bf16 v[96:99], v[128:131], a[32:35], v[96:99]
    ds_read_b64_tr_b16 v[152:153], v161 offset:0
    v_mfma_f32_16x16x32_bf16 v[96:99], v[132:135], a[48:51], v[96:99]
    buffer_load_dwordx4 a[176:179], v242, s[40:43], s95 offen sc1
    s_sub_u32 s81, s81, s66
    s_mul_i32 s81, s81, 36864
    v_mfma_f32_16x16x32_bf16 v[104:107], v[132:135], a[52:55], v[104:107]
    ds_read_b64_tr_b16 v[154:155], v161 offset:4096
    v_mfma_f32_16x16x32_bf16 v[104:107], v[128:131], a[36:39], v[104:107]
    buffer_load_dwordx4 a[180:183], v243, s[40:43], s95 offen sc1
    v_mfma_f32_16x16x32_bf16 v[112:115], v[128:131], a[40:43], v[112:115]
    ds_read_b64_tr_b16 v[156:157], v161 offset:8192
    s_add_u32 s81, s81, s14
    v_mfma_f32_16x16x32_bf16 v[112:115], v[132:135], a[56:59], v[112:115]
    v_readlane_b32 s92, v246, 17
    v_mfma_f32_16x16x32_bf16 v[120:123], v[132:135], a[60:63], v[120:123]
    ds_read_b64_tr_b16 v[158:159], v161 offset:12288
    v_mfma_f32_16x16x32_bf16 v[120:123], v[128:131], a[44:47], v[120:123]
    s_add_u32 s82, s66, 3
    s_and_b32 s82, s82, 3
    buffer_load_dwordx4 a[184:187], v240, s[40:43], s92 offen sc1
    v_mfma_f32_16x16x32_bf16 v[124:127], v[136:139], a[44:47], v[124:127]
    ds_read_b64_tr_b16 a[232:233], v162 offset:0
    v_mfma_f32_16x16x32_bf16 v[124:127], v[140:143], a[60:63], v[124:127]
    v_mfma_f32_16x16x32_bf16 v[116:119], v[140:143], a[56:59], v[116:119]
    ds_read_b64_tr_b16 a[234:235], v162 offset:4096
    s_sub_u32 s82, s82, s66
    s_mul_i32 s82, s82, 36864
    v_mfma_f32_16x16x32_bf16 v[116:119], v[136:139], a[40:43], v[116:119]
    buffer_load_dwordx4 a[188:191], v241, s[40:43], s92 offen sc1
    v_mfma_f32_16x16x32_bf16 v[108:111], v[136:139], a[36:39], v[108:111]
    ds_read_b64_tr_b16 a[236:237], v162 offset:8192
    v_mfma_f32_16x16x32_bf16 v[108:111], v[140:143], a[52:55], v[108:111]
    s_add_u32 s82, s82, s13
    v_mfma_f32_16x16x32_bf16 v[100:103], v[140:143], a[48:51], v[100:103]
    ds_read_b64_tr_b16 a[238:239], v162 offset:12288
    v_mfma_f32_16x16x32_bf16 v[100:103], v[136:139], a[32:35], v[100:103]
    s_waitcnt vmcnt(36) lgkmcnt(4)
    v_mfma_f32_16x16x32_bf16 v[0:3], v[144:147], a[64:67], v[0:3]
    ds_read_b64_tr_b16 a[240:241], v163 offset:0
    v_mfma_f32_16x16x32_bf16 v[0:3], v[148:151], a[80:83], v[0:3]
    buffer_load_dwordx4 a[192:195], v242, s[40:43], s92 offen sc1
    v_mfma_f32_16x16x32_bf16 v[8:11], v[148:151], a[84:87], v[8:11]
    ds_read_b64_tr_b16 a[242:243], v163 offset:4096
    v_mfma_f32_16x16x32_bf16 v[8:11], v[144:147], a[68:71], v[8:11]
    buffer_load_dwordx4 a[196:199], v243, s[40:43], s92 offen sc1
    v_mfma_f32_16x16x32_bf16 v[16:19], v[144:147], a[72:75], v[16:19]
    ds_read_b64_tr_b16 a[244:245], v163 offset:8192
    v_mfma_f32_16x16x32_bf16 v[16:19], v[148:151], a[88:91], v[16:19]
    v_readlane_b32 s93, v247, 18
    v_mfma_f32_16x16x32_bf16 v[24:27], v[148:151], a[92:95], v[24:27]
    ds_read_b64_tr_b16 a[246:247], v163 offset:12288
    s_add_u32 m0, s3, 114688
    v_mfma_f32_16x16x32_bf16 v[24:27], v[144:147], a[76:79], v[24:27]
    v_mfma_f32_16x16x32_bf16 v[28:31], v[152:155], a[76:79], v[28:31]
    ds_read_b64_tr_b16 v[128:129], v164 offset:0
    v_mfma_f32_16x16x32_bf16 v[28:31], v[156:159], a[92:95], v[28:31]
    buffer_load_dwordx4 v244, s[48:51], s93 offen lds
    v_mfma_f32_16x16x32_bf16 v[20:23], v[156:159], a[88:91], v[20:23]
    ds_read_b64_tr_b16 v[130:131], v164 offset:4096
    s_add_u32 m0, s3, 116736
    v_mfma_f32_16x16x32_bf16 v[20:23], v[152:155], a[72:75], v[20:23]
    buffer_load_dword v168, v230, s[44:47], s77 offen offset:256 sc1
    v_mfma_f32_16x16x32_bf16 v[12:15], v[152:155], a[68:71], v[12:15]
    ds_read_b64_tr_b16 v[132:133], v164 offset:8192
    v_mfma_f32_16x16x32_bf16 v[12:15], v[156:159], a[84:87], v[12:15]
    buffer_load_dwordx4 v245, s[48:51], s93 offen lds
    v_mfma_f32_16x16x32_bf16 v[4:7], v[156:159], a[80:83], v[4:7]
    ds_read_b64_tr_b16 v[134:135], v164 offset:12288
    v_mfma_f32_16x16x32_bf16 v[4:7], v[152:155], a[64:67], v[4:7]
    s_waitcnt lgkmcnt(4)
    v_mfma_f32_16x16x32_bf16 v[32:35], a[232:235], a[64:67], v[32:35]
    ds_read_b64_tr_b16 v[136:137], v165 offset:0
    v_mfma_f32_16x16x32_bf16 v[32:35], a[236:239], a[80:83], v[32:35]
    v_readlane_b32 s94, v247, 19
    v_mfma_f32_16x16x32_bf16 v[40:43], a[236:239], a[84:87], v[40:43]
    ds_read_b64_tr_b16 v[138:139], v165 offset:4096
    s_add_u32 m0, s3, 122880
    v_mfma_f32_16x16x32_bf16 v[40:43], a[232:235], a[68:71], v[40:43]
    v_mfma_f32_16x16x32_bf16 v[48:51], a[232:235], a[72:75], v[48:51]
    ds_read_b64_tr_b16 v[140:141], v165 offset:8192
    v_mfma_f32_16x16x32_bf16 v[48:51], a[236:239], a[88:91], v[48:51]
    buffer_load_dwordx4 v244, s[48:51], s94 offen lds
    v_mfma_f32_16x16x32_bf16 v[56:59], a[236:239], a[92:95], v[56:59]
    ds_read_b64_tr_b16 v[142:143], v165 offset:12288
    s_add_u32 m0, s3, 124928
    v_mfma_f32_16x16x32_bf16 v[56:59], a[232:235], a[76:79], v[56:59]
    buffer_load_dwordx4 v245, s[48:51], s94 offen lds
    v_mfma_f32_16x16x32_bf16 v[60:63], a[240:243], a[76:79], v[60:63]
    ds_read_b64_tr_b16 v[144:145], v166 offset:0
    v_mfma_f32_16x16x32_bf16 v[60:63], a[244:247], a[92:95], v[60:63]
    v_readlane_b32 s95, v247, 20
    v_mfma_f32_16x16x32_bf16 v[52:55], a[244:247], a[88:91], v[52:55]
    ds_read_b64_tr_b16 v[146:147], v166 offset:4096
    s_add_u32 m0, s3, 131072
    v_mfma_f32_16x16x32_bf16 v[52:55], a[240:243], a[72:75], v[52:55]
    ds_read_b64_tr_b16 v[148:149], v166 offset:8192
    v_mfma_f32_16x16x32_bf16 v[44:47], a[240:243], a[68:71], v[44:47]
    buffer_load_dwordx4 v244, s[48:51], s95 offen lds
    v_mfma_f32_16x16x32_bf16 v[44:47], a[244:247], a[84:87], v[44:47]
    s_add_u32 m0, s3, 133120
    ds_read_b64_tr_b16 v[150:151], v166 offset:12288
    v_mfma_f32_16x16x32_bf16 v[36:39], a[244:247], a[80:83], v[36:39]
    buffer_load_dwordx4 v245, s[48:51], s95 offen lds
    v_mfma_f32_16x16x32_bf16 v[36:39], a[240:243], a[64:67], v[36:39]
    s_waitcnt lgkmcnt(4)
    v_mfma_f32_16x16x32_bf16 v[64:67], v[128:131], a[64:67], v[64:67]
    ds_read_b64_tr_b16 v[152:153], v167 offset:0
    v_mfma_f32_16x16x32_bf16 v[64:67], v[132:135], a[80:83], v[64:67]
    v_readlane_b32 s92, v247, 21
    v_mfma_f32_16x16x32_bf16 v[72:75], v[132:135], a[84:87], v[72:75]
    ds_read_b64_tr_b16 v[154:155], v167 offset:4096
    s_add_u32 m0, s3, 139264
    v_mfma_f32_16x16x32_bf16 v[72:75], v[128:131], a[68:71], v[72:75]
    ds_read_b64_tr_b16 v[156:157], v167 offset:8192
    v_mfma_f32_16x16x32_bf16 v[80:83], v[128:131], a[72:75], v[80:83]
    buffer_load_dwordx4 v244, s[48:51], s92 offen lds
    ds_read_b64_tr_b16 v[158:159], v167 offset:12288
    v_mfma_f32_16x16x32_bf16 v[80:83], v[132:135], a[88:91], v[80:83]
    s_add_u32 m0, s3, 141312
    v_mfma_f32_16x16x32_bf16 v[88:91], v[132:135], a[92:95], v[88:91]
    buffer_load_dwordx4 v245, s[48:51], s92 offen lds
    v_mfma_f32_16x16x32_bf16 v[88:91], v[128:131], a[76:79], v[88:91]
    v_readlane_b32 s93, v247, 22
    s_add_u32 m0, s3, 81920
    s_waitcnt vmcnt(43)
    s_barrier
    v_mfma_f32_16x16x32_bf16 v[92:95], v[136:139], a[76:79], v[92:95]
    ds_read_b64_tr_b16 a[232:233], v160 offset:16384
    v_mfma_f32_16x16x32_bf16 v[92:95], v[140:143], a[92:95], v[92:95]
    buffer_load_dwordx4 v244, s[48:51], s93 offen lds
    v_mfma_f32_16x16x32_bf16 v[84:87], v[140:143], a[88:91], v[84:87]
    ds_read_b64_tr_b16 a[234:235], v160 offset:20480
    s_add_u32 m0, s3, 83968
    v_mfma_f32_16x16x32_bf16 v[84:87], v[136:139], a[72:75], v[84:87]
    buffer_load_dwordx4 v245, s[48:51], s93 offen lds
    v_mfma_f32_16x16x32_bf16 v[76:79], v[136:139], a[68:71], v[76:79]
    ds_read_b64_tr_b16 a[236:237], v160 offset:24576
    v_mfma_f32_16x16x32_bf16 v[76:79], v[140:143], a[84:87], v[76:79]
    v_readlane_b32 s94, v247, 23
    v_mfma_f32_16x16x32_bf16 v[68:71], v[140:143], a[80:83], v[68:71]
    ds_read_b64_tr_b16 a[238:239], v160 offset:28672
    s_add_u32 m0, s3, 90112
    v_mfma_f32_16x16x32_bf16 v[68:71], v[136:139], a[64:67], v[68:71]
    s_waitcnt lgkmcnt(4)
    v_mfma_f32_16x16x32_bf16 v[96:99], v[144:147], a[64:67], v[96:99]
    ds_read_b64_tr_b16 a[240:241], v161 offset:16384
    v_mfma_f32_16x16x32_bf16 v[96:99], v[148:151], a[80:83], v[96:99]
    buffer_load_dwordx4 v244, s[48:51], s94 offen lds
    v_mfma_f32_16x16x32_bf16 v[104:107], v[148:151], a[84:87], v[104:107]
    ds_read_b64_tr_b16 a[242:243], v161 offset:20480
    s_add_u32 m0, s3, 92160
    v_mfma_f32_16x16x32_bf16 v[104:107], v[144:147], a[68:71], v[104:107]
    buffer_load_dwordx4 v245, s[48:51], s94 offen lds
    v_mfma_f32_16x16x32_bf16 v[112:115], v[144:147], a[72:75], v[112:115]
    ds_read_b64_tr_b16 a[244:245], v161 offset:24576
    v_mfma_f32_16x16x32_bf16 v[112:115], v[148:151], a[88:91], v[112:115]
    v_readlane_b32 s95, v247, 24
    v_mfma_f32_16x16x32_bf16 v[120:123], v[148:151], a[92:95], v[120:123]
    ds_read_b64_tr_b16 a[246:247], v161 offset:28672
    s_add_u32 m0, s3, 65536
    v_mfma_f32_16x16x32_bf16 v[120:123], v[144:147], a[76:79], v[120:123]
    v_mfma_f32_16x16x32_bf16 v[124:127], v[152:155], a[76:79], v[124:127]
    ds_read_b64_tr_b16 v[128:129], v162 offset:16384
    v_mfma_f32_16x16x32_bf16 v[124:127], v[156:159], a[92:95], v[124:127]
    buffer_load_dwordx4 v244, s[48:51], s95 offen lds
    v_mfma_f32_16x16x32_bf16 v[116:119], v[156:159], a[88:91], v[116:119]
    ds_read_b64_tr_b16 v[130:131], v162 offset:20480
    s_add_u32 m0, s3, 67584
    v_mfma_f32_16x16x32_bf16 v[116:119], v[152:155], a[72:75], v[116:119]
    buffer_load_dwordx4 v245, s[48:51], s95 offen lds
    v_mfma_f32_16x16x32_bf16 v[108:111], v[152:155], a[68:71], v[108:111]
    ds_read_b64_tr_b16 v[132:133], v162 offset:24576
    v_mfma_f32_16x16x32_bf16 v[108:111], v[156:159], a[84:87], v[108:111]
    v_readlane_b32 s92, v247, 25
    v_mfma_f32_16x16x32_bf16 v[100:103], v[156:159], a[80:83], v[100:103]
    ds_read_b64_tr_b16 v[134:135], v162 offset:28672
    s_add_u32 m0, s3, 73728
    v_mfma_f32_16x16x32_bf16 v[100:103], v[152:155], a[64:67], v[100:103]
    s_waitcnt vmcnt(39) lgkmcnt(4)
    v_mfma_f32_16x16x32_bf16 v[0:3], a[232:235], a[96:99], v[0:3]
    ds_read_b64_tr_b16 v[136:137], v163 offset:16384
    v_mfma_f32_16x16x32_bf16 v[0:3], a[236:239], a[112:115], v[0:3]
    buffer_load_dwordx4 v244, s[52:55], s92 offen lds
    v_mfma_f32_16x16x32_bf16 v[8:11], a[236:239], a[116:119], v[8:11]
    ds_read_b64_tr_b16 v[138:139], v163 offset:20480
    s_add_u32 m0, s3, 75776
    v_mfma_f32_16x16x32_bf16 v[8:11], a[232:235], a[100:103], v[8:11]
    buffer_load_dwordx4 v245, s[52:55], s92 offen lds
    v_mfma_f32_16x16x32_bf16 v[16:19], a[232:235], a[104:107], v[16:19]
    ds_read_b64_tr_b16 v[140:141], v163 offset:24576
    v_mfma_f32_16x16x32_bf16 v[16:19], a[236:239], a[120:123], v[16:19]
    v_mfma_f32_16x16x32_bf16 v[24:27], a[236:239], a[124:127], v[24:27]
    ds_read_b64_tr_b16 v[142:143], v163 offset:28672
    v_mfma_f32_16x16x32_bf16 v[24:27], a[232:235], a[108:111], v[24:27]
    v_mfma_f32_16x16x32_bf16 v[28:31], a[240:243], a[108:111], v[28:31]
    ds_read_b64_tr_b16 v[144:145], v164 offset:16384
    v_mfma_f32_16x16x32_bf16 v[28:31], a[244:247], a[124:127], v[28:31]
    v_mfma_f32_16x16x32_bf16 v[20:23], a[244:247], a[120:123], v[20:23]
    ds_read_b64_tr_b16 v[146:147], v164 offset:20480
    v_mfma_f32_16x16x32_bf16 v[20:23], a[240:243], a[104:107], v[20:23]
    v_mfma_f32_16x16x32_bf16 v[12:15], a[240:243], a[100:103], v[12:15]
    ds_read_b64_tr_b16 v[148:149], v164 offset:24576
    v_mfma_f32_16x16x32_bf16 v[12:15], a[244:247], a[116:119], v[12:15]
    ds_read_b64_tr_b16 v[150:151], v164 offset:28672
    v_mfma_f32_16x16x32_bf16 v[4:7], a[244:247], a[112:115], v[4:7]
    v_readlane_b32 s93, v246, 18
    v_mfma_f32_16x16x32_bf16 v[4:7], a[240:243], a[96:99], v[4:7]
    s_waitcnt lgkmcnt(4)
    v_mfma_f32_16x16x32_bf16 v[32:35], v[128:131], a[96:99], v[32:35]
    ds_read_b64_tr_b16 v[152:153], v165 offset:16384
    v_mfma_f32_16x16x32_bf16 v[32:35], v[132:135], a[112:115], v[32:35]
    v_lshrrev_b32 v226, 1, v254
    v_mfma_f32_16x16x32_bf16 v[40:43], v[132:135], a[116:119], v[40:43]
    ds_read_b64_tr_b16 v[154:155], v165 offset:20480
    v_mfma_f32_16x16x32_bf16 v[40:43], v[128:131], a[100:103], v[40:43]
    s_waitcnt vmcnt(15)
    v_cmp_eq_u32 s[4:5], v239, v168
    v_mfma_f32_16x16x32_bf16 v[48:51], v[128:131], a[104:107], v[48:51]
    ds_read_b64_tr_b16 v[156:157], v165 offset:24576
    v_mfma_f32_16x16x32_bf16 v[48:51], v[132:135], a[120:123], v[48:51]
    v_and_b32 v226, 24, v226
    v_mfma_f32_16x16x32_bf16 v[56:59], v[132:135], a[124:127], v[56:59]
    ds_read_b64_tr_b16 v[158:159], v165 offset:28672
    v_mfma_f32_16x16x32_bf16 v[56:59], v[128:131], a[108:111], v[56:59]
    s_or_b32 s4, s4, s5
    s_cmp_eq_u32 s4, -1
    s_cbranch_scc0 L_slow_p2
L_back_p2:
    v_mfma_f32_16x16x32_bf16 v[60:63], v[136:139], a[108:111], v[60:63]
    ds_read_b64_tr_b16 a[232:233], v166 offset:16384
    v_mfma_f32_16x16x32_bf16 v[60:63], v[140:143], a[124:127], v[60:63]
    buffer_load_dwordx4 a[200:203], v240, s[40:43], s93 offen sc1
    v_mfma_f32_16x16x32_bf16 v[52:55], v[140:143], a[120:123], v[52:55]
    ds_read_b64_tr_b16 a[234:235], v166 offset:20480
    v_mfma_f32_16x16x32_bf16 v[52:55], v[136:139], a[104:107], v[52:55]
    buffer_load_dwordx2 v[224:225], v226, s[44:47], s28 offen sc1
    v_mfma_f32_16x16x32_bf16 v[44:47], v[136:139], a[100:103], v[44:47]
    ds_read_b64_tr_b16 a[236:237], v166 offset:24576
    v_mfma_f32_16x16x32_bf16 v[44:47], v[140:143], a[116:119], v[44:47]
    buffer_load_dwordx4 a[204:207], v241, s[40:43], s93 offen sc1
    v_mfma_f32_16x16x32_bf16 v[36:39], v[140:143], a[112:115], v[36:39]
    ds_read_b64_tr_b16 a[238:239], v166 offset:28672
    v_mfma_f32_16x16x32_bf16 v[36:39], v[136:139], a[96:99], v[36:39]
    s_waitcnt lgkmcnt(4)
    v_mfma_f32_16x16x32_bf16 v[64:67], v[144:147], a[96:99], v[64:67]
    ds_read_b64_tr_b16 a[240:241], v167 offset:16384
    v_mfma_f32_16x16x32_bf16 v[64:67], v[148:151], a[112:115], v[64:67]
    buffer_load_dwordx4 a[208:211], v242, s[40:43], s93 offen sc1
    v_mfma_f32_16x16x32_bf16 v[72:75], v[148:151], a[116:119], v[72:75]
    ds_read_b64_tr_b16 a[242:243], v167 offset:20480
    v_mfma_f32_16x16x32_bf16 v[72:75], v[144:147], a[100:103], v[72:75]
    buffer_load_dwordx4 a[212:215], v243, s[40:43], s93 offen sc1
    v_mfma_f32_16x16x32_bf16 v[80:83], v[144:147], a[104:107], v[80:83]
    ds_read_b64_tr_b16 a[244:245], v167 offset:24576
    v_mfma_f32_16x16x32_bf16 v[80:83], v[148:151], a[120:123], v[80:83]
    v_readlane_b32 s94, v246, 19
    v_mfma_f32_16x16x32_bf16 v[88:91], v[148:151], a[124:127], v[88:91]
    ds_read_b64_tr_b16 a[246:247], v167 offset:28672
    v_mfma_f32_16x16x32_bf16 v[88:91], v[144:147], a[108:111], v[88:91]
    s_nop 1
    buffer_load_dwordx4 a[216:219], v240, s[40:43], s94 offen sc1
    s_barrier
    v_mfma_f32_16x16x32_bf16 v[92:95], v[152:155], a[108:111], v[92:95]
    ds_read_b64_tr_b16 v[128:129], v160 offset:32768
    v_mfma_f32_16x16x32_bf16 v[92:95], v[156:159], a[124:127], v[92:95]
    buffer_load_dwordx4 a[220:223], v241, s[40:43], s94 offen sc1
    v_mfma_f32_16x16x32_bf16 v[84:87], v[156:159], a[120:123], v[84:87]
    ds_read_b64_tr_b16 v[130:131], v160 offset:36864
    v_mfma_f32_16x16x32_bf16 v[84:87], v[152:155], a[104:107], v[84:87]
    buffer_load_dwordx4 a[224:227], v242, s[40:43], s94 offen sc1
    v_mfma_f32_16x16x32_bf16 v[76:79], v[152:155], a[100:103], v[76:79]
    ds_read_b64_tr_b16 v[132:133], v160 offset:40960
    v_mfma_f32_16x16x32_bf16 v[76:79], v[156:159], a[116:119], v[76:79]
    v_mfma_f32_16x16x32_bf16 v[68:71], v[156:159], a[112:115], v[68:71]
    ds_read_b64_tr_b16 v[134:135], v160 offset:45056
    v_mfma_f32_16x16x32_bf16 v[68:71], v[152:155], a[96:99], v[68:71]
    s_waitcnt lgkmcnt(4)
    v_mfma_f32_16x16x32_bf16 v[96:99], a[232:235], a[96:99], v[96:99]
    ds_read_b64_tr_b16 v[136:137], v161 offset:32768
    v_mfma_f32_16x16x32_bf16 v[96:99], a[236:239], a[112:115], v[96:99]
    buffer_load_dwordx4 a[228:231], v243, s[40:43], s94 offen sc1
    v_mfma_f32_16x16x32_bf16 v[104:107], a[236:239], a[116:119], v[104:107]
    ds_read_b64_tr_b16 v[138:139], v161 offset:36864
    v_mfma_f32_16x16x32_bf16 v[104:107], a[232:235], a[100:103], v[104:107]
    v_readlane_b32 s95, v246, 20
    v_mfma_f32_16x16x32_bf16 v[112:115], a[232:235], a[104:107], v[112:115]
    ds_read_b64_tr_b16 v[140:141], v161 offset:40960
    v_mfma_f32_16x16x32_bf16 v[112:115], a[236:239], a[120:123], v[112:115]
    v_mfma_f32_16x16x32_bf16 v[120:123], a[236:239], a[124:127], v[120:123]
    ds_read_b64_tr_b16 v[142:143], v161 offset:45056
    v_mfma_f32_16x16x32_bf16 v[120:123], a[232:235], a[108:111], v[120:123]
    buffer_load_dwordx4 a[0:3], v240, s[40:43], s95 offen sc1
    v_mfma_f32_16x16x32_bf16 v[124:127], a[240:243], a[108:111], v[124:127]
    ds_read_b64_tr_b16 v[144:145], v162 offset:32768
    v_mfma_f32_16x16x32_bf16 v[124:127], a[244:247], a[124:127], v[124:127]
    buffer_load_dwordx4 a[4:7], v241, s[40:43], s95 offen sc1
    v_mfma_f32_16x16x32_bf16 v[116:119], a[244:247], a[120:123], v[116:119]
    ds_read_b64_tr_b16 v[146:147], v162 offset:36864
    v_mfma_f32_16x16x32_bf16 v[116:119], a[240:243], a[104:107], v[116:119]
    buffer_load_dwordx4 a[8:11], v242, s[40:43], s95 offen sc1
    v_mfma_f32_16x16x32_bf16 v[108:111], a[240:243], a[100:103], v[108:111]
    ds_read_b64_tr_b16 v[148:149], v162 offset:40960
    v_mfma_f32_16x16x32_bf16 v[108:111], a[244:247], a[116:119], v[108:111]
    v_mfma_f32_16x16x32_bf16 v[100:103], a[244:247], a[112:115], v[100:103]
    ds_read_b64_tr_b16 v[150:151], v162 offset:45056
    v_mfma_f32_16x16x32_bf16 v[100:103], a[240:243], a[96:99], v[100:103]
    s_waitcnt lgkmcnt(4)
    v_mfma_f32_16x16x32_bf16 v[0:3], v[128:131], a[136:139], v[0:3]
    ds_read_b64_tr_b16 v[152:153], v163 offset:32768
    v_mfma_f32_16x16x32_bf16 v[0:3], v[132:135], a[152:155], v[0:3]
    buffer_load_dwordx4 a[12:15], v243, s[40:43], s95 offen sc1
    v_mfma_f32_16x16x32_bf16 v[8:11], v[132:135], a[156:159], v[8:11]
    ds_read_b64_tr_b16 v[154:155], v163 offset:36864
    v_mfma_f32_16x16x32_bf16 v[8:11], v[128:131], a[140:143], v[8:11]
    v_readlane_b32 s92, v246, 21
    v_mfma_f32_16x16x32_bf16 v[16:19], v[128:131], a[144:147], v[16:19]
    ds_read_b64_tr_b16 v[156:157], v163 offset:40960
    v_mfma_f32_16x16x32_bf16 v[16:19], v[132:135], a[160:163], v[16:19]
    v_mfma_f32_16x16x32_bf16 v[24:27], v[132:135], a[164:167], v[24:27]
    ds_read_b64_tr_b16 v[158:159], v163 offset:45056
    v_mfma_f32_16x16x32_bf16 v[24:27], v[128:131], a[148:151], v[24:27]
    buffer_load_dwordx4 a[16:19], v240, s[40:43], s92 offen sc1
    v_mfma_f32_16x16x32_bf16 v[28:31], v[136:139], a[148:151], v[28:31]
    ds_read_b64_tr_b16 a[232:233], v164 offset:32768
    v_mfma_f32_16x16x32_bf16 v[28:31], v[140:143], a[164:167], v[28:31]
    buffer_load_dwordx4 a[20:23], v241, s[40:43], s92 offen sc1
    v_mfma_f32_16x16x32_bf16 v[20:23], v[140:143], a[160:163], v[20:23]
    ds_read_b64_tr_b16 a[234:235], v164 offset:36864
    v_mfma_f32_16x16x32_bf16 v[20:23], v[136:139], a[144:147], v[20:23]
    buffer_load_dwordx4 a[24:27], v242, s[40:43], s92 offen sc1
    v_mfma_f32_16x16x32_bf16 v[12:15], v[136:139], a[140:143], v[12:15]
    ds_read_b64_tr_b16 a[236:237], v164 offset:40960
    v_mfma_f32_16x16x32_bf16 v[12:15], v[140:143], a[156:159], v[12:15]
    v_mfma_f32_16x16x32_bf16 v[4:7], v[140:143], a[152:155], v[4:7]
    ds_read_b64_tr_b16 a[238:239], v164 offset:45056
    v_mfma_f32_16x16x32_bf16 v[4:7], v[136:139], a[136:139], v[4:7]
    s_waitcnt lgkmcnt(4)
    v_mfma_f32_16x16x32_bf16 v[32:35], v[144:147], a[136:139], v[32:35]
    ds_read_b64_tr_b16 a[240:241], v165 offset:32768
    v_mfma_f32_16x16x32_bf16 v[32:35], v[148:151], a[152:155], v[32:35]
    buffer_load_dwordx4 a[28:31], v243, s[40:43], s92 offen sc1
    v_mfma_f32_16x16x32_bf16 v[40:43], v[148:151], a[156:159], v[40:43]
    ds_read_b64_tr_b16 a[242:243], v165 offset:36864
    v_mfma_f32_16x16x32_bf16 v[40:43], v[144:147], a[140:143], v[40:43]
    v_readlane_b32 s93, v246, 22
    v_mfma_f32_16x16x32_bf16 v[48:51], v[144:147], a[144:147], v[48:51]
    ds_read_b64_tr_b16 a[244:245], v165 offset:40960
    v_mfma_f32_16x16x32_bf16 v[48:51], v[148:151], a[160:163], v[48:51]
    v_mfma_f32_16x16x32_bf16 v[56:59], v[148:151], a[164:167], v[56:59]
    ds_read_b64_tr_b16 a[246:247], v165 offset:45056
    v_mfma_f32_16x16x32_bf16 v[56:59], v[144:147], a[148:151], v[56:59]
    buffer_load_dwordx4 a[32:35], v240, s[40:43], s93 offen sc1
    v_mfma_f32_16x16x32_bf16 v[60:63], v[152:155], a[148:151], v[60:63]
    ds_read_b64_tr_b16 v[128:129], v166 offset:32768
    v_mfma_f32_16x16x32_bf16 v[60:63], v[156:159], a[164:167], v[60:63]
    buffer_load_dwordx4 a[36:39], v241, s[40:43], s93 offen sc1
    v_mfma_f32_16x16x32_bf16 v[52:55], v[156:159], a[160:163], v[52:55]
    ds_read_b64_tr_b16 v[130:131], v166 offset:36864
    v_mfma_f32_16x16x32_bf16 v[52:55], v[152:155], a[144:147], v[52:55]
    buffer_load_dwordx4 a[40:43], v242, s[40:43], s93 offen sc1
    v_mfma_f32_16x16x32_bf16 v[44:47], v[152:155], a[140:143], v[44:47]
    ds_read_b64_tr_b16 v[132:133], v166 offset:40960
    v_mfma_f32_16x16x32_bf16 v[44:47], v[156:159], a[156:159], v[44:47]
    v_mfma_f32_16x16x32_bf16 v[36:39], v[156:159], a[152:155], v[36:39]
    ds_read_b64_tr_b16 v[134:135], v166 offset:45056
    v_mfma_f32_16x16x32_bf16 v[36:39], v[152:155], a[136:139], v[36:39]
    s_waitcnt lgkmcnt(4)
    v_mfma_f32_16x16x32_bf16 v[64:67], a[232:235], a[136:139], v[64:67]
    ds_read_b64_tr_b16 v[136:137], v167 offset:32768
    v_mfma_f32_16x16x32_bf16 v[64:67], a[236:239], a[152:155], v[64:67]
    buffer_load_dwordx4 a[44:47], v243, s[40:43], s93 offen sc1
    v_mfma_f32_16x16x32_bf16 v[72:75], a[236:239], a[156:159], v[72:75]
    ds_read_b64_tr_b16 v[138:139], v167 offset:36864
    v_mfma_f32_16x16x32_bf16 v[72:75], a[232:235], a[140:143], v[72:75]
    v_readlane_b32 s94, v246, 23
    v_mfma_f32_16x16x32_bf16 v[80:83], a[232:235], a[144:147], v[80:83]
    ds_read_b64_tr_b16 v[140:141], v167 offset:40960
    v_mfma_f32_16x16x32_bf16 v[80:83], a[236:239], a[160:163], v[80:83]
    v_mfma_f32_16x16x32_bf16 v[88:91], a[236:239], a[164:167], v[88:91]
    ds_read_b64_tr_b16 v[142:143], v167 offset:45056
    v_mfma_f32_16x16x32_bf16 v[88:91], a[232:235], a[148:151], v[88:91]
    buffer_load_dwordx4 a[48:51], v240, s[40:43], s94 offen sc1
    s_barrier
    v_mfma_f32_16x16x32_bf16 v[92:95], a[240:243], a[148:151], v[92:95]
    ds_read_b64_tr_b16 v[144:145], v250 offset:16384
    v_mfma_f32_16x16x32_bf16 v[92:95], a[244:247], a[164:167], v[92:95]
    buffer_load_dwordx4 a[52:55], v241, s[40:43], s94 offen sc1
    v_mfma_f32_16x16x32_bf16 v[84:87], a[244:247], a[160:163], v[84:87]
    ds_read_b64_tr_b16 v[146:147], v250 offset:20480
    v_mfma_f32_16x16x32_bf16 v[84:87], a[240:243], a[144:147], v[84:87]
    s_waitcnt vmcnt(21)
    v_cmp_ne_u32 vcc, v239, v225
    s_nop 1
    s_cmp_lg_u64 vcc, 0
    s_cbranch_scc1 L_ds
L_db:
    v_mfma_f32_16x16x32_bf16 v[76:79], a[240:243], a[140:143], v[76:79]
    ds_read_b64_tr_b16 v[148:149], v250 offset:24576
    v_mfma_f32_16x16x32_bf16 v[76:79], a[244:247], a[156:159], v[76:79]
    buffer_load_dwordx4 a[56:59], v242, s[40:43], s94 offen sc1
    v_mfma_f32_16x16x32_bf16 v[68:71], a[244:247], a[152:155], v[68:71]
    ds_read_b64_tr_b16 v[150:151], v250 offset:28672
    v_mfma_f32_16x16x32_bf16 v[68:71], a[240:243], a[136:139], v[68:71]
    s_waitcnt lgkmcnt(4)
    v_mfma_f32_16x16x32_bf16 v[96:99], v[128:131], a[136:139], v[96:99]
    ds_read_b64_tr_b16 v[152:153], v251 offset:16384
    v_mfma_f32_16x16x32_bf16 v[96:99], v[132:135], a[152:155], v[96:99]
    v_readlane_b32 s31, v224, 0
    v_mfma_f32_16x16x32_bf16 v[104:107], v[132:135], a[156:159], v[104:107]
    ds_read_b64_tr_b16 v[154:155], v251 offset:20480
    v_mfma_f32_16x16x32_bf16 v[104:107], v[128:131], a[140:143], v[104:107]
    buffer_load_dwordx4 a[60:63], v243, s[40:43], s94 offen sc1
    v_mfma_f32_16x16x32_bf16 v[112:115], v[128:131], a[144:147], v[112:115]
    ds_read_b64_tr_b16 v[156:157], v251 offset:24576
    v_mfma_f32_16x16x32_bf16 v[112:115], v[132:135], a[160:163], v[112:115]
    v_readlane_b32 s95, v246, 24
    v_mfma_f32_16x16x32_bf16 v[120:123], v[132:135], a[164:167], v[120:123]
    ds_read_b64_tr_b16 v[158:159], v251 offset:28672
    v_mfma_f32_16x16x32_bf16 v[120:123], v[128:131], a[148:151], v[120:123]
    v_readlane_b32 s32, v224, 1
    v_mfma_f32_16x16x32_bf16 v[124:127], v[136:139], a[148:151], v[124:127]
    ds_read_b64_tr_b16 a[232:233], v252 offset:16384
    v_mfma_f32_16x16x32_bf16 v[124:127], v[140:143], a[164:167], v[124:127]
    v_readlane_b32 s33, v224, 2
    v_mfma_f32_16x16x32_bf16 v[116:119], v[140:143], a[160:163], v[116:119]
    ds_read_b64_tr_b16 a[234:235], v252 offset:20480
    v_mfma_f32_16x16x32_bf16 v[116:119], v[136:139], a[144:147], v[116:119]
    buffer_load_dwordx4 a[64:67], v240, s[40:43], s95 offen sc1
    v_mfma_f32_16x16x32_bf16 v[108:111], v[136:139], a[140:143], v[108:111]
    ds_read_b64_tr_b16 a[236:237], v252 offset:24576
    v_mfma_f32_16x16x32_bf16 v[108:111], v[140:143], a[156:159], v[108:111]
    v_readlane_b32 s34, v224, 3
    v_mfma_f32_16x16x32_bf16 v[100:103], v[140:143], a[152:155], v[100:103]
    ds_read_b64_tr_b16 a[238:239], v252 offset:28672
    v_mfma_f32_16x16x32_bf16 v[100:103], v[136:139], a[136:139], v[100:103]
    s_waitcnt lgkmcnt(4)
    v_mfma_f32_16x16x32_bf16 v[0:3], v[144:147], a[168:171], v[0:3]
    ds_read_b64_tr_b16 a[240:241], v253 offset:16384
    v_mfma_f32_16x16x32_bf16 v[0:3], v[148:151], a[184:187], v[0:3]
    buffer_load_dwordx4 a[68:71], v241, s[40:43], s95 offen sc1
    v_mfma_f32_16x16x32_bf16 v[8:11], v[148:151], a[188:191], v[8:11]
    ds_read_b64_tr_b16 a[242:243], v253 offset:20480
    v_mfma_f32_16x16x32_bf16 v[8:11], v[144:147], a[172:175], v[8:11]
    v_readlane_b32 s37, v224, s66
    v_mfma_f32_16x16x32_bf16 v[16:19], v[144:147], a[176:179], v[16:19]
    ds_read_b64_tr_b16 a[244:245], v253 offset:24576
    s_min_u32 s35, s31, s32
    s_min_u32 s36, s33, s34
    v_mfma_f32_16x16x32_bf16 v[16:19], v[148:151], a[192:195], v[16:19]
    buffer_load_dwordx4 a[72:75], v242, s[40:43], s95 offen sc1
    s_min_u32 s35, s35, s36
    v_mfma_f32_16x16x32_bf16 v[24:27], v[148:151], a[196:199], v[24:27]
    ds_read_b64_tr_b16 a[246:247], v253 offset:28672
    s_max_u32 s36, s31, s32
    s_max_u32 s38, s33, s34
    v_mfma_f32_16x16x32_bf16 v[24:27], v[144:147], a[180:183], v[24:27]
    buffer_load_dwordx4 a[76:79], v243, s[40:43], s95 offen sc1
    s_max_u32 s36, s36, s38
    v_mfma_f32_16x16x32_bf16 v[28:31], v[152:155], a[180:183], v[28:31]
    ds_read_b64_tr_b16 v[128:129], v249 offset:16384
    s_add_u32 s31, s31, s32
    s_add_u32 s33, s33, s34
    v_mfma_f32_16x16x32_bf16 v[28:31], v[156:159], a[196:199], v[28:31]
    v_readlane_b32 s92, v246, 25
    v_mfma_f32_16x16x32_bf16 v[20:23], v[156:159], a[192:195], v[20:23]
    ds_read_b64_tr_b16 v[130:131], v249 offset:20480
    v_mfma_f32_16x16x32_bf16 v[20:23], v[152:155], a[176:179], v[20:23]
    s_add_u32 s31, s31, s33
    v_mfma_f32_16x16x32_bf16 v[12:15], v[152:155], a[172:175], v[12:15]
    ds_read_b64_tr_b16 v[132:133], v249 offset:24576
    v_mfma_f32_16x16x32_bf16 v[12:15], v[156:159], a[188:191], v[12:15]
    buffer_load_dwordx4 a[80:83], v240, s[40:43], s92 offen sc1
    v_mfma_f32_16x16x32_bf16 v[4:7], v[156:159], a[184:187], v[4:7]
    ds_read_b64_tr_b16 v[134:135], v249 offset:28672
    s_add_u32 s32, s35, s36
    s_sub_u32 s31, s31, s32
    v_mfma_f32_16x16x32_bf16 v[4:7], v[152:155], a[168:171], v[4:7]
    s_waitcnt lgkmcnt(4)
    v_mfma_f32_16x16x32_bf16 v[32:35], a[232:235], a[168:171], v[32:35]
    ds_read_b64_tr_b16 v[136:137], v234 offset:16384
    v_mfma_f32_16x16x32_bf16 v[32:35], a[236:239], a[184:187], v[32:35]
    buffer_load_dwordx4 a[84:87], v241, s[40:43], s92 offen sc1
    s_cmp_eq_u32 s37, s35
    s_cselect_b32 s31, s32, s31
    v_mfma_f32_16x16x32_bf16 v[40:43], a[236:239], a[188:191], v[40:43]
    ds_read_b64_tr_b16 v[138:139], v234 offset:20480
    v_mfma_f32_16x16x32_bf16 v[40:43], a[232:235], a[172:175], v[40:43]
    buffer_load_dwordx4 a[88:91], v242, s[40:43], s92 offen sc1
    v_mfma_f32_16x16x32_bf16 v[48:51], a[232:235], a[176:179], v[48:51]
    ds_read_b64_tr_b16 v[140:141], v234 offset:24576
    s_cmp_eq_u32 s37, s36
    s_cselect_b32 s31, s32, s31
    v_mfma_f32_16x16x32_bf16 v[48:51], a[236:239], a[192:195], v[48:51]
    buffer_load_dwordx4 a[92:95], v243, s[40:43], s92 offen sc1
    v_mfma_f32_16x16x32_bf16 v[56:59], a[236:239], a[196:199], v[56:59]
    ds_read_b64_tr_b16 v[142:143], v234 offset:28672
    v_mfma_f32_16x16x32_bf16 v[56:59], a[232:235], a[180:183], v[56:59]
    v_readlane_b32 s93, v247, 26
    s_sub_u32 s38, s31, s37
    s_sub_i32 s31, s38, s37
    v_mfma_f32_16x16x32_bf16 v[60:63], a[240:243], a[180:183], v[60:63]
    ds_read_b64_tr_b16 v[144:145], v235 offset:16384
    s_add_u32 m0, s3, 16384
    v_mfma_f32_16x16x32_bf16 v[60:63], a[244:247], a[196:199], v[60:63]
    buffer_load_dwordx4 v244, s[52:55], s93 offen lds
    v_mfma_f32_16x16x32_bf16 v[52:55], a[244:247], a[192:195], v[52:55]
    ds_read_b64_tr_b16 v[146:147], v235 offset:20480
    s_add_u32 m0, s3, 18432
    s_abs_i32 s32, s31
    v_mfma_f32_16x16x32_bf16 v[52:55], a[240:243], a[176:179], v[52:55]
    buffer_load_dwordx4 v245, s[52:55], s93 offen lds
    v_mfma_f32_16x16x32_bf16 v[44:47], a[240:243], a[172:175], v[44:47]
    ds_read_b64_tr_b16 v[148:149], v235 offset:24576
    v_mfma_f32_16x16x32_bf16 v[44:47], a[244:247], a[188:191], v[44:47]
    v_readlane_b32 s94, v247, 27
    s_cmp_gt_u32 s32, 240
    s_cselect_b32 s39, 2, 0
    v_mfma_f32_16x16x32_bf16 v[36:39], a[244:247], a[184:187], v[36:39]
    ds_read_b64_tr_b16 v[150:151], v235 offset:28672
    s_add_u32 m0, s3, 24576
    v_mfma_f32_16x16x32_bf16 v[36:39], a[240:243], a[168:171], v[36:39]
    s_waitcnt lgkmcnt(4)
    v_mfma_f32_16x16x32_bf16 v[64:67], v[128:131], a[168:171], v[64:67]
    ds_read_b64_tr_b16 v[152:153], v236 offset:16384
    s_cmp_gt_u32 s32, 680
    s_cselect_b32 s39, 4, s39
    v_mfma_f32_16x16x32_bf16 v[64:67], v[132:135], a[184:187], v[64:67]
    buffer_load_dwordx4 v244, s[52:55], s94 offen lds
    v_mfma_f32_16x16x32_bf16 v[72:75], v[132:135], a[188:191], v[72:75]
    ds_read_b64_tr_b16 v[154:155], v236 offset:20480
    s_add_u32 m0, s3, 26624
    v_mfma_f32_16x16x32_bf16 v[72:75], v[128:131], a[172:175], v[72:75]
    buffer_load_dwordx4 v245, s[52:55], s94 offen lds
    s_and_b32 s38, s38, 3
    s_sub_u32 s38, s38, s66
    v_mfma_f32_16x16x32_bf16 v[80:83], v[128:131], a[176:179], v[80:83]
    ds_read_b64_tr_b16 v[156:157], v236 offset:24576
    v_mfma_f32_16x16x32_bf16 v[80:83], v[132:135], a[192:195], v[80:83]
    v_readlane_b32 s95, v246, 26
    v_mfma_f32_16x16x32_bf16 v[88:91], v[132:135], a[196:199], v[88:91]
    ds_read_b64_tr_b16 v[158:159], v236 offset:28672
    s_sub_u32 s29, 30, s39
    v_mfma_f32_16x16x32_bf16 v[88:91], v[128:131], a[180:183], v[88:91]
    s_nop 0
    buffer_load_dwordx4 a[96:99], v240, s[40:43], s95 offen sc1
    s_barrier
    v_mfma_f32_16x16x32_bf16 v[92:95], v[136:139], a[180:183], v[92:95]
    ds_read_b64_tr_b16 a[232:233], v250 offset:32768
    buffer_load_dwordx4 a[100:103], v241, s[40:43], s95 offen sc1
    s_cmp_gt_i32 s31, 0
    s_cselect_b32 s39, s39, 0
    v_mfma_f32_16x16x32_bf16 v[92:95], v[140:143], a[196:199], v[92:95]
    ds_read_b64_tr_b16 a[234:235], v250 offset:36864
    buffer_load_dwordx4 a[104:107], v242, s[40:43], s95 offen sc1
    s_lshl_b32 s32, s39, 1
    s_add_u32 s29, s29, s32
    v_mfma_f32_16x16x32_bf16 v[84:87], v[140:143], a[192:195], v[84:87]
    ds_read_b64_tr_b16 a[236:237], v250 offset:40960
    s_cmp_eq_u32 s39, 0
    s_cselect_b32 s38, 0, s38
    buffer_load_dwordx4 a[108:111], v243, s[40:43], s95 offen sc1
    v_mfma_f32_16x16x32_bf16 v[84:87], v[136:139], a[176:179], v[84:87]
    ds_read_b64_tr_b16 a[238:239], v250 offset:45056
    v_readlane_b32 s92, v246, 27
    s_lshl_b32 s30, s38, 10
    s_add_u32 s30, s30, s77
    v_mfma_f32_16x16x32_bf16 v[76:79], v[136:139], a[172:175], v[76:79]
    ds_read_b64_tr_b16 a[240:241], v251 offset:32768
    buffer_load_dword v169, v230, s[44:47], s30 offen offset:256 sc1
    v_mfma_f32_16x16x32_bf16 v[76:79], v[140:143], a[188:191], v[76:79]
    ds_read_b64_tr_b16 a[242:243], v251 offset:36864
    v_mfma_f32_16x16x32_bf16 v[68:71], v[140:143], a[184:187], v[68:71]
    buffer_load_dwordx4 a[112:115], v240, s[40:43], s92 offen sc1
    v_mfma_f32_16x16x32_bf16 v[68:71], v[136:139], a[168:171], v[68:71]
    s_waitcnt lgkmcnt(6)
    v_mfma_f32_16x16x32_bf16 v[96:99], v[144:147], a[168:171], v[96:99]
    ds_read_b64_tr_b16 a[244:245], v251 offset:40960
    v_mfma_f32_16x16x32_bf16 v[96:99], v[148:151], a[184:187], v[96:99]
    ds_read_b64_tr_b16 a[246:247], v251 offset:45056
    v_mfma_f32_16x16x32_bf16 v[104:107], v[148:151], a[188:191], v[104:107]
    buffer_load_dwordx4 a[116:119], v241, s[40:43], s92 offen sc1
    v_mfma_f32_16x16x32_bf16 v[104:107], v[144:147], a[172:175], v[104:107]
    v_lshrrev_b32 v226, 4, v254
    v_mfma_f32_16x16x32_bf16 v[112:115], v[144:147], a[176:179], v[112:115]
    ds_read_b64_tr_b16 v[128:129], v252 offset:32768
    v_mfma_f32_16x16x32_bf16 v[112:115], v[148:151], a[192:195], v[112:115]
    ds_read_b64_tr_b16 v[130:131], v252 offset:36864
    v_mfma_f32_16x16x32_bf16 v[120:123], v[148:151], a[196:199], v[120:123]
    s_add_u32 s31, s39, 32
    v_subrev_u32 v224, s31, v226
    v_mfma_f32_16x16x32_bf16 v[120:123], v[144:147], a[180:183], v[120:123]
    buffer_load_dwordx4 a[120:123], v242, s[40:43], s92 offen sc1
    v_mfma_f32_16x16x32_bf16 v[124:127], v[152:155], a[180:183], v[124:127]
    ds_read_b64_tr_b16 v[132:133], v252 offset:40960
    v_mfma_f32_16x16x32_bf16 v[124:127], v[156:159], a[196:199], v[124:127]
    s_lshl_b32 s32, s38, 2
    s_add_u32 s32, s32, 4
    v_add_u32 v225, s32, v224
    v_mfma_f32_16x16x32_bf16 v[116:119], v[156:159], a[192:195], v[116:119]
    ds_read_b64_tr_b16 v[134:135], v252 offset:45056
    v_mfma_f32_16x16x32_bf16 v[116:119], v[152:155], a[176:179], v[116:119]
    buffer_load_dwordx4 a[124:127], v243, s[40:43], s92 offen sc1
    v_mfma_f32_16x16x32_bf16 v[108:111], v[152:155], a[172:175], v[108:111]
    v_readlane_b32 s93, v247, 28
    v_mfma_f32_16x16x32_bf16 v[108:111], v[156:159], a[188:191], v[108:111]
    ds_read_b64_tr_b16 v[136:137], v253 offset:32768
    v_mfma_f32_16x16x32_bf16 v[100:103], v[156:159], a[184:187], v[100:103]
    v_cmp_gt_i32 vcc, 0, v224
    s_nop 1
    v_cndmask_b32 v224, v224, v225, vcc
    v_mfma_f32_16x16x32_bf16 v[100:103], v[152:155], a[168:171], v[100:103]
    s_waitcnt vmcnt(37) lgkmcnt(5)
    v_mfma_f32_16x16x32_bf16 v[0:3], a[232:235], a[200:203], v[0:3]
    ds_read_b64_tr_b16 v[138:139], v253 offset:36864
    v_mfma_f32_16x16x32_bf16 v[0:3], a[236:239], a[216:219], v[0:3]
    s_add_u32 m0, s3, 32768
    v_readlane_b32 s31, v246, 32
    v_mfma_f32_16x16x32_bf16 v[8:11], a[236:239], a[220:223], v[8:11]
    buffer_load_dwordx4 v244, s[52:55], s93 offen lds
    v_mfma_f32_16x16x32_bf16 v[8:11], a[232:235], a[204:207], v[8:11]
    ds_read_b64_tr_b16 v[140:141], v253 offset:40960
    v_mfma_f32_16x16x32_bf16 v[16:19], a[232:235], a[208:211], v[16:19]
    ds_read_b64_tr_b16 v[142:143], v253 offset:45056
    v_mfma_f32_16x16x32_bf16 v[16:19], a[236:239], a[224:227], v[16:19]
    s_add_u32 m0, s3, 34816
    v_readlane_b32 s32, v247, 32
    v_mfma_f32_16x16x32_bf16 v[24:27], a[236:239], a[228:231], v[24:27]
    buffer_load_dwordx4 v245, s[52:55], s93 offen lds
    v_mfma_f32_16x16x32_bf16 v[24:27], a[232:235], a[212:215], v[24:27]
    v_readlane_b32 s94, v247, 29
    v_mfma_f32_16x16x32_bf16 v[28:31], a[240:243], a[212:215], v[28:31]
    ds_read_b64_tr_b16 v[144:145], v249 offset:32768
    v_mfma_f32_16x16x32_bf16 v[28:31], a[244:247], a[228:231], v[28:31]
    v_mul_i32_i24 v225, 9216, v224
    v_mfma_f32_16x16x32_bf16 v[20:23], a[244:247], a[224:227], v[20:23]
    ds_read_b64_tr_b16 v[146:147], v249 offset:36864
    s_add_u32 m0, s3, 40960
    v_mfma_f32_16x16x32_bf16 v[20:23], a[240:243], a[208:211], v[20:23]
    buffer_load_dwordx4 v244, s[52:55], s94 offen lds
    v_mfma_f32_16x16x32_bf16 v[12:15], a[240:243], a[204:207], v[12:15]
    ds_read_b64_tr_b16 v[148:149], v249 offset:40960
    v_mfma_f32_16x16x32_bf16 v[12:15], a[244:247], a[220:223], v[12:15]
    v_mul_i32_i24 v224, 458752, v224
    v_mfma_f32_16x16x32_bf16 v[4:7], a[244:247], a[216:219], v[4:7]
    ds_read_b64_tr_b16 v[150:151], v249 offset:45056
    s_add_u32 m0, s3, 43008
    v_mfma_f32_16x16x32_bf16 v[4:7], a[240:243], a[200:203], v[4:7]
    s_waitcnt lgkmcnt(4)
    v_mfma_f32_16x16x32_bf16 v[32:35], v[128:131], a[200:203], v[32:35]
    ds_read_b64_tr_b16 v[152:153], v234 offset:32768
    v_mfma_f32_16x16x32_bf16 v[32:35], v[132:135], a[216:219], v[32:35]
    buffer_load_dwordx4 v245, s[52:55], s94 offen lds
    v_mfma_f32_16x16x32_bf16 v[40:43], v[132:135], a[220:223], v[40:43]
    ds_read_b64_tr_b16 v[154:155], v234 offset:36864
    v_mfma_f32_16x16x32_bf16 v[40:43], v[128:131], a[204:207], v[40:43]
    v_add_u32 v225, s31, v225
    v_mfma_f32_16x16x32_bf16 v[48:51], v[128:131], a[208:211], v[48:51]
    ds_read_b64_tr_b16 v[156:157], v234 offset:40960
    v_mfma_f32_16x16x32_bf16 v[48:51], v[132:135], a[224:227], v[48:51]
    v_readlane_b32 s95, v246, 28
    v_mfma_f32_16x16x32_bf16 v[56:59], v[132:135], a[228:231], v[56:59]
    ds_read_b64_tr_b16 v[158:159], v234 offset:45056
    v_mfma_f32_16x16x32_bf16 v[56:59], v[128:131], a[212:215], v[56:59]
    v_add_u32 v224, s32, v224
    v_mfma_f32_16x16x32_bf16 v[60:63], v[136:139], a[212:215], v[60:63]
    ds_read_b64_tr_b16 a[232:233], v235 offset:32768
    v_mfma_f32_16x16x32_bf16 v[60:63], v[140:143], a[228:231], v[60:63]
    buffer_load_dwordx4 a[136:139], v240, s[40:43], s95 offen sc1
    v_mfma_f32_16x16x32_bf16 v[52:55], v[140:143], a[224:227], v[52:55]
    ds_read_b64_tr_b16 a[234:235], v235 offset:36864
    v_mfma_f32_16x16x32_bf16 v[52:55], v[136:139], a[208:211], v[52:55]
    v_cmp_le_u32 vcc, 32, v226
    s_nop 1
    v_cndmask_b32 v246, v246, v225, vcc
    v_cndmask_b32 v247, v247, v224, vcc
    v_mfma_f32_16x16x32_bf16 v[44:47], v[136:139], a[204:207], v[44:47]
    ds_read_b64_tr_b16 a[236:237], v235 offset:40960
    v_mfma_f32_16x16x32_bf16 v[44:47], v[140:143], a[220:223], v[44:47]
    buffer_load_dwordx4 a[140:143], v241, s[40:43], s95 offen sc1
    v_mfma_f32_16x16x32_bf16 v[36:39], v[140:143], a[216:219], v[36:39]
    ds_read_b64_tr_b16 a[238:239], v235 offset:45056
    v_mfma_f32_16x16x32_bf16 v[36:39], v[136:139], a[200:203], v[36:39]
    s_waitcnt lgkmcnt(4)
    v_mfma_f32_16x16x32_bf16 v[64:67], v[144:147], a[200:203], v[64:67]
    ds_read_b64_tr_b16 a[240:241], v236 offset:32768
    v_mfma_f32_16x16x32_bf16 v[64:67], v[148:151], a[216:219], v[64:67]
    buffer_load_dwordx4 a[144:147], v242, s[40:43], s95 offen sc1
    v_mfma_f32_16x16x32_bf16 v[72:75], v[148:151], a[220:223], v[72:75]
    ds_read_b64_tr_b16 a[242:243], v236 offset:36864
    v_mfma_f32_16x16x32_bf16 v[72:75], v[144:147], a[204:207], v[72:75]
    buffer_load_dwordx4 a[148:151], v243, s[40:43], s95 offen sc1
    v_mfma_f32_16x16x32_bf16 v[80:83], v[144:147], a[208:211], v[80:83]
    ds_read_b64_tr_b16 a[244:245], v236 offset:40960
    v_mfma_f32_16x16x32_bf16 v[80:83], v[148:151], a[224:227], v[80:83]
    v_readlane_b32 s92, v246, 29
    v_mfma_f32_16x16x32_bf16 v[88:91], v[148:151], a[228:231], v[88:91]
    ds_read_b64_tr_b16 a[246:247], v236 offset:45056
    v_mfma_f32_16x16x32_bf16 v[88:91], v[144:147], a[212:215], v[88:91]
    s_nop 1
    buffer_load_dwordx4 a[152:155], v240, s[40:43], s92 offen sc1
    s_cmp_eq_u32 s29, 26
    s_cbranch_scc1 L_eg10
    s_barrier
    v_mfma_f32_16x16x32_bf16 v[92:95], v[152:155], a[212:215], v[92:95]
    ds_read_b64_tr_b16 v[128:129], v250 offset:49152
    v_mfma_f32_16x16x32_bf16 v[92:95], v[156:159], a[228:231], v[92:95]
    buffer_load_dwordx4 a[156:159], v241, s[40:43], s92 offen sc1
    v_mfma_f32_16x16x32_bf16 v[84:87], v[156:159], a[224:227], v[84:87]
    ds_read_b64_tr_b16 v[130:131], v250 offset:53248
    v_mfma_f32_16x16x32_bf16 v[84:87], v[152:155], a[208:211], v[84:87]
    buffer_load_dwordx4 a[160:163], v242, s[40:43], s92 offen sc1
    v_mfma_f32_16x16x32_bf16 v[76:79], v[152:155], a[204:207], v[76:79]
    ds_read_b64_tr_b16 v[132:133], v250 offset:57344
    v_mfma_f32_16x16x32_bf16 v[76:79], v[156:159], a[220:223], v[76:79]
    v_mfma_f32_16x16x32_bf16 v[68:71], v[156:159], a[216:219], v[68:71]
    ds_read_b64_tr_b16 v[134:135], v250 offset:61440
    v_mfma_f32_16x16x32_bf16 v[68:71], v[152:155], a[200:203], v[68:71]
    s_waitcnt lgkmcnt(4)
    v_mfma_f32_16x16x32_bf16 v[96:99], a[232:235], a[200:203], v[96:99]
    ds_read_b64_tr_b16 v[136:137], v251 offset:49152
    v_mfma_f32_16x16x32_bf16 v[96:99], a[236:239], a[216:219], v[96:99]
    buffer_load_dwordx4 a[164:167], v243, s[40:43], s92 offen sc1
    v_mfma_f32_16x16x32_bf16 v[104:107], a[236:239], a[220:223], v[104:107]
    ds_read_b64_tr_b16 v[138:139], v251 offset:53248
    v_mfma_f32_16x16x32_bf16 v[104:107], a[232:235], a[204:207], v[104:107]
    v_readlane_b32 s93, v247, 30
    v_mfma_f32_16x16x32_bf16 v[112:115], a[232:235], a[208:211], v[112:115]
    ds_read_b64_tr_b16 v[140:141], v251 offset:57344
    s_add_u32 m0, s3, 49152
    v_mfma_f32_16x16x32_bf16 v[112:115], a[236:239], a[224:227], v[112:115]
    v_mfma_f32_16x16x32_bf16 v[120:123], a[236:239], a[228:231], v[120:123]
    ds_read_b64_tr_b16 v[142:143], v251 offset:61440
    v_mfma_f32_16x16x32_bf16 v[120:123], a[232:235], a[212:215], v[120:123]
    buffer_load_dwordx4 v244, s[52:55], s93 offen lds
    v_mfma_f32_16x16x32_bf16 v[124:127], a[240:243], a[212:215], v[124:127]
    ds_read_b64_tr_b16 v[144:145], v252 offset:49152
    s_add_u32 m0, s3, 51200
    v_mfma_f32_16x16x32_bf16 v[124:127], a[244:247], a[228:231], v[124:127]
    buffer_load_dwordx4 v245, s[52:55], s93 offen lds
    v_mfma_f32_16x16x32_bf16 v[116:119], a[244:247], a[224:227], v[116:119]
    ds_read_b64_tr_b16 v[146:147], v252 offset:53248
    v_mfma_f32_16x16x32_bf16 v[116:119], a[240:243], a[208:211], v[116:119]
    v_readlane_b32 s94, v247, 31
    v_mfma_f32_16x16x32_bf16 v[108:111], a[240:243], a[204:207], v[108:111]
    ds_read_b64_tr_b16 v[148:149], v252 offset:57344
    s_add_u32 m0, s3, 57344
    v_mfma_f32_16x16x32_bf16 v[108:111], a[244:247], a[220:223], v[108:111]
    v_mfma_f32_16x16x32_bf16 v[100:103], a[244:247], a[216:219], v[100:103]
    ds_read_b64_tr_b16 v[150:151], v252 offset:61440
    v_mfma_f32_16x16x32_bf16 v[100:103], a[240:243], a[200:203], v[100:103]
    s_waitcnt vmcnt(43) lgkmcnt(4)
    v_mfma_f32_16x16x32_bf16 v[0:3], v[128:131], a[0:3], v[0:3]
    ds_read_b64_tr_b16 v[152:153], v253 offset:49152
    v_mfma_f32_16x16x32_bf16 v[0:3], v[132:135], a[16:19], v[0:3]
    buffer_load_dwordx4 v244, s[52:55], s94 offen lds
    v_mfma_f32_16x16x32_bf16 v[8:11], v[132:135], a[20:23], v[8:11]
    ds_read_b64_tr_b16 v[154:155], v253 offset:53248
    s_add_u32 m0, s3, 59392
    v_mfma_f32_16x16x32_bf16 v[8:11], v[128:131], a[4:7], v[8:11]
    buffer_load_dwordx4 v245, s[52:55], s94 offen lds
    v_mfma_f32_16x16x32_bf16 v[16:19], v[128:131], a[8:11], v[16:19]
    ds_read_b64_tr_b16 v[156:157], v253 offset:57344
    v_mfma_f32_16x16x32_bf16 v[16:19], v[132:135], a[24:27], v[16:19]
    v_readlane_b32 s95, v246, 30
    v_mfma_f32_16x16x32_bf16 v[24:27], v[132:135], a[28:31], v[24:27]
    ds_read_b64_tr_b16 v[158:159], v253 offset:61440
    v_mfma_f32_16x16x32_bf16 v[24:27], v[128:131], a[12:15], v[24:27]
    v_mfma_f32_16x16x32_bf16 v[28:31], v[136:139], a[12:15], v[28:31]
    ds_read_b64_tr_b16 a[232:233], v249 offset:49152
    v_mfma_f32_16x16x32_bf16 v[28:31], v[140:143], a[28:31], v[28:31]
    buffer_load_dwordx4 a[168:171], v240, s[40:43], s95 offen sc1
    v_mfma_f32_16x16x32_bf16 v[20:23], v[140:143], a[24:27], v[20:23]
    ds_read_b64_tr_b16 a[234:235], v249 offset:53248
    v_mfma_f32_16x16x32_bf16 v[20:23], v[136:139], a[8:11], v[20:23]
    buffer_load_dwordx4 a[172:175], v241, s[40:43], s95 offen sc1
    v_mfma_f32_16x16x32_bf16 v[12:15], v[136:139], a[4:7], v[12:15]
    ds_read_b64_tr_b16 a[236:237], v249 offset:57344
    v_mfma_f32_16x16x32_bf16 v[12:15], v[140:143], a[20:23], v[12:15]
    buffer_load_dwordx4 a[176:179], v242, s[40:43], s95 offen sc1
    v_mfma_f32_16x16x32_bf16 v[4:7], v[140:143], a[16:19], v[4:7]
    ds_read_b64_tr_b16 a[238:239], v249 offset:61440
    v_mfma_f32_16x16x32_bf16 v[4:7], v[136:139], a[0:3], v[4:7]
    s_waitcnt lgkmcnt(4)
    v_mfma_f32_16x16x32_bf16 v[32:35], v[144:147], a[0:3], v[32:35]
    ds_read_b64_tr_b16 a[240:241], v234 offset:49152
    v_mfma_f32_16x16x32_bf16 v[32:35], v[148:151], a[16:19], v[32:35]
    buffer_load_dwordx4 a[180:183], v243, s[40:43], s95 offen sc1
    v_mfma_f32_16x16x32_bf16 v[40:43], v[148:151], a[20:23], v[40:43]
    ds_read_b64_tr_b16 a[242:243], v234 offset:53248
    v_mfma_f32_16x16x32_bf16 v[40:43], v[144:147], a[4:7], v[40:43]
    v_readlane_b32 s92, v246, 31
    v_mfma_f32_16x16x32_bf16 v[48:51], v[144:147], a[8:11], v[48:51]
    ds_read_b64_tr_b16 a[244:245], v234 offset:57344
    v_mfma_f32_16x16x32_bf16 v[48:51], v[148:151], a[24:27], v[48:51]
    v_mfma_f32_16x16x32_bf16 v[56:59], v[148:151], a[28:31], v[56:59]
    ds_read_b64_tr_b16 a[246:247], v234 offset:61440
    v_mfma_f32_16x16x32_bf16 v[56:59], v[144:147], a[12:15], v[56:59]
    buffer_load_dwordx4 a[184:187], v240, s[40:43], s92 offen sc1
    v_mfma_f32_16x16x32_bf16 v[60:63], v[152:155], a[12:15], v[60:63]
    ds_read_b64_tr_b16 v[128:129], v235 offset:49152
    v_mfma_f32_16x16x32_bf16 v[60:63], v[156:159], a[28:31], v[60:63]
    buffer_load_dwordx4 a[188:191], v241, s[40:43], s92 offen sc1
    v_mfma_f32_16x16x32_bf16 v[52:55], v[156:159], a[24:27], v[52:55]
    ds_read_b64_tr_b16 v[130:131], v235 offset:53248
    v_mfma_f32_16x16x32_bf16 v[52:55], v[152:155], a[8:11], v[52:55]
    buffer_load_dwordx4 a[192:195], v242, s[40:43], s92 offen sc1
    v_mfma_f32_16x16x32_bf16 v[44:47], v[152:155], a[4:7], v[44:47]
    ds_read_b64_tr_b16 v[132:133], v235 offset:57344
    v_mfma_f32_16x16x32_bf16 v[44:47], v[156:159], a[20:23], v[44:47]
    v_mfma_f32_16x16x32_bf16 v[36:39], v[156:159], a[16:19], v[36:39]
    ds_read_b64_tr_b16 v[134:135], v235 offset:61440
    v_mfma_f32_16x16x32_bf16 v[36:39], v[152:155], a[0:3], v[36:39]
    s_waitcnt lgkmcnt(4)
    v_mfma_f32_16x16x32_bf16 v[64:67], a[232:235], a[0:3], v[64:67]
    ds_read_b64_tr_b16 v[136:137], v236 offset:49152
    v_mfma_f32_16x16x32_bf16 v[64:67], a[236:239], a[16:19], v[64:67]
    buffer_load_dwordx4 a[196:199], v243, s[40:43], s92 offen sc1
    v_mfma_f32_16x16x32_bf16 v[72:75], a[236:239], a[20:23], v[72:75]
    ds_read_b64_tr_b16 v[138:139], v236 offset:53248
    v_mfma_f32_16x16x32_bf16 v[72:75], a[232:235], a[4:7], v[72:75]
    v_readlane_b32 s93, v247, 32
    v_mfma_f32_16x16x32_bf16 v[80:83], a[232:235], a[8:11], v[80:83]
    ds_read_b64_tr_b16 v[140:141], v236 offset:57344
    s_add_u32 m0, s3, 98304
    v_mfma_f32_16x16x32_bf16 v[80:83], a[236:239], a[24:27], v[80:83]
    v_mfma_f32_16x16x32_bf16 v[88:91], a[236:239], a[28:31], v[88:91]
    ds_read_b64_tr_b16 v[142:143], v236 offset:61440
    v_mfma_f32_16x16x32_bf16 v[88:91], a[232:235], a[12:15], v[88:91]
    buffer_load_dwordx4 v244, s[48:51], s93 offen lds
    s_add_u32 m0, s3, 100352
    s_cmp_eq_u32 s29, 28
    s_cbranch_scc1 L_eg11
    s_barrier
    v_mfma_f32_16x16x32_bf16 v[92:95], a[240:243], a[12:15], v[92:95]
    ds_read_b64_tr_b16 v[144:145], v250 offset:0
    v_mfma_f32_16x16x32_bf16 v[92:95], a[244:247], a[28:31], v[92:95]
    buffer_load_dwordx4 v245, s[48:51], s93 offen lds
    v_mfma_f32_16x16x32_bf16 v[84:87], a[244:247], a[24:27], v[84:87]
    ds_read_b64_tr_b16 v[146:147], v250 offset:4096
    v_mfma_f32_16x16x32_bf16 v[84:87], a[240:243], a[8:11], v[84:87]
    v_readlane_b32 s94, v247, 33
    v_mfma_f32_16x16x32_bf16 v[76:79], a[240:243], a[4:7], v[76:79]
    ds_read_b64_tr_b16 v[148:149], v250 offset:8192
    s_add_u32 m0, s3, 106496
    v_mfma_f32_16x16x32_bf16 v[76:79], a[244:247], a[20:23], v[76:79]
    v_mfma_f32_16x16x32_bf16 v[68:71], a[244:247], a[16:19], v[68:71]
    ds_read_b64_tr_b16 v[150:151], v250 offset:12288
    v_mfma_f32_16x16x32_bf16 v[68:71], a[240:243], a[0:3], v[68:71]
    s_waitcnt lgkmcnt(4)
    v_mfma_f32_16x16x32_bf16 v[96:99], v[128:131], a[0:3], v[96:99]
    ds_read_b64_tr_b16 v[152:153], v251 offset:0
    v_mfma_f32_16x16x32_bf16 v[96:99], v[132:135], a[16:19], v[96:99]
    buffer_load_dwordx4 v244, s[48:51], s94 offen lds
    v_mfma_f32_16x16x32_bf16 v[104:107], v[132:135], a[20:23], v[104:107]
    ds_read_b64_tr_b16 v[154:155], v251 offset:4096
    s_add_u32 m0, s3, 108544
    v_mfma_f32_16x16x32_bf16 v[104:107], v[128:131], a[4:7], v[104:107]
    buffer_load_dwordx4 v245, s[48:51], s94 offen lds
    v_mfma_f32_16x16x32_bf16 v[112:115], v[128:131], a[8:11], v[112:115]
    ds_read_b64_tr_b16 v[156:157], v251 offset:8192
    v_mfma_f32_16x16x32_bf16 v[112:115], v[132:135], a[24:27], v[112:115]
    v_readlane_b32 s95, v246, 32
    v_mfma_f32_16x16x32_bf16 v[120:123], v[132:135], a[28:31], v[120:123]
    ds_read_b64_tr_b16 v[158:159], v251 offset:12288
    v_mfma_f32_16x16x32_bf16 v[120:123], v[128:131], a[12:15], v[120:123]
    s_waitcnt vmcnt(32)
    v_cmp_eq_u32 s[4:5], v239, v169
    v_mfma_f32_16x16x32_bf16 v[124:127], v[136:139], a[12:15], v[124:127]
    ds_read_b64_tr_b16 a[232:233], v252 offset:0
    v_mfma_f32_16x16x32_bf16 v[124:127], v[140:143], a[28:31], v[124:127]
    s_mov_b64 exec, 1
    buffer_store_dword v239, v254, s[44:47], s10 offen offset:768
    buffer_store_dword v239, v254, s[44:47], s10 offen offset:896 sc1
    s_mov_b64 exec, -1
    v_mfma_f32_16x16x32_bf16 v[116:119], v[140:143], a[24:27], v[116:119]
    ds_read_b64_tr_b16 a[234:235], v252 offset:4096
    v_mfma_f32_16x16x32_bf16 v[116:119], v[136:139], a[8:11], v[116:119]
    s_or_b32 s4, s5, s5
    s_cmp_eq_u32 s4, -1
    s_cbranch_scc0 L_slow_p3c
L_back_p3c:
    v_mfma_f32_16x16x32_bf16 v[108:111], v[136:139], a[4:7], v[108:111]
    ds_read_b64_tr_b16 a[236:237], v252 offset:8192
    v_mfma_f32_16x16x32_bf16 v[108:111], v[140:143], a[20:23], v[108:111]
    buffer_load_dwordx4 a[200:203], v240, s[40:43], s95 offen sc1
    v_mfma_f32_16x16x32_bf16 v[100:103], v[140:143], a[16:19], v[100:103]
    ds_read_b64_tr_b16 a[238:239], v252 offset:12288
    v_mfma_f32_16x16x32_bf16 v[100:103], v[136:139], a[0:3], v[100:103]
    s_waitcnt lgkmcnt(4)
    v_mfma_f32_16x16x32_bf16 v[0:3], v[144:147], a[32:35], v[0:3]
    ds_read_b64_tr_b16 a[240:241], v253 offset:0
    v_mfma_f32_16x16x32_bf16 v[0:3], v[148:151], a[48:51], v[0:3]
    buffer_load_dwordx4 a[204:207], v241, s[40:43], s95 offen sc1
    v_mfma_f32_16x16x32_bf16 v[8:11], v[148:151], a[52:55], v[8:11]
    ds_read_b64_tr_b16 a[242:243], v253 offset:4096
    v_mfma_f32_16x16x32_bf16 v[8:11], v[144:147], a[36:39], v[8:11]
    buffer_load_dwordx4 a[208:211], v242, s[40:43], s95 offen sc1
    v_mfma_f32_16x16x32_bf16 v[16:19], v[144:147], a[40:43], v[16:19]
    ds_read_b64_tr_b16 a[244:245], v253 offset:8192
    v_mfma_f32_16x16x32_bf16 v[16:19], v[148:151], a[56:59], v[16:19]
    buffer_load_dwordx4 a[212:215], v243, s[40:43], s95 offen sc1
    v_mfma_f32_16x16x32_bf16 v[24:27], v[148:151], a[60:63], v[24:27]
    ds_read_b64_tr_b16 a[246:247], v253 offset:12288
    v_mfma_f32_16x16x32_bf16 v[24:27], v[144:147], a[44:47], v[24:27]
    v_readlane_b32 s92, v246, 33
    v_mfma_f32_16x16x32_bf16 v[28:31], v[152:155], a[44:47], v[28:31]
    ds_read_b64_tr_b16 v[128:129], v249 offset:0
    v_mfma_f32_16x16x32_bf16 v[28:31], v[156:159], a[60:63], v[28:31]
    v_mfma_f32_16x16x32_bf16 v[20:23], v[156:159], a[56:59], v[20:23]
    ds_read_b64_tr_b16 v[130:131], v249 offset:4096
    v_mfma_f32_16x16x32_bf16 v[20:23], v[152:155], a[40:43], v[20:23]
    buffer_load_dwordx4 a[216:219], v240, s[40:43], s92 offen sc1
    v_mfma_f32_16x16x32_bf16 v[12:15], v[152:155], a[36:39], v[12:15]
    ds_read_b64_tr_b16 v[132:133], v249 offset:8192
    v_mfma_f32_16x16x32_bf16 v[12:15], v[156:159], a[52:55], v[12:15]
    buffer_load_dwordx4 a[220:223], v241, s[40:43], s92 offen sc1
    v_mfma_f32_16x16x32_bf16 v[4:7], v[156:159], a[48:51], v[4:7]
    ds_read_b64_tr_b16 v[134:135], v249 offset:12288
    v_mfma_f32_16x16x32_bf16 v[4:7], v[152:155], a[32:35], v[4:7]
    s_waitcnt lgkmcnt(4)
    v_mfma_f32_16x16x32_bf16 v[32:35], a[232:235], a[32:35], v[32:35]
    ds_read_b64_tr_b16 v[136:137], v234 offset:0
    v_mfma_f32_16x16x32_bf16 v[32:35], a[236:239], a[48:51], v[32:35]
    buffer_load_dwordx4 a[224:227], v242, s[40:43], s92 offen sc1
    v_mfma_f32_16x16x32_bf16 v[40:43], a[236:239], a[52:55], v[40:43]
    ds_read_b64_tr_b16 v[138:139], v234 offset:4096
    v_mfma_f32_16x16x32_bf16 v[40:43], a[232:235], a[36:39], v[40:43]
    buffer_load_dwordx4 a[228:231], v243, s[40:43], s92 offen sc1
    v_mfma_f32_16x16x32_bf16 v[48:51], a[232:235], a[40:43], v[48:51]
    ds_read_b64_tr_b16 v[140:141], v234 offset:8192
    v_mfma_f32_16x16x32_bf16 v[48:51], a[236:239], a[56:59], v[48:51]
    v_readlane_b32 s93, v247, 34
    v_mfma_f32_16x16x32_bf16 v[56:59], a[236:239], a[60:63], v[56:59]
    ds_read_b64_tr_b16 v[142:143], v234 offset:12288
    s_add_u32 m0, s3, 114688
    v_mfma_f32_16x16x32_bf16 v[56:59], a[232:235], a[44:47], v[56:59]
    v_mfma_f32_16x16x32_bf16 v[60:63], a[240:243], a[44:47], v[60:63]
    ds_read_b64_tr_b16 v[144:145], v235 offset:0
    v_mfma_f32_16x16x32_bf16 v[60:63], a[244:247], a[60:63], v[60:63]
    buffer_load_dwordx4 v244, s[48:51], s93 offen lds
    v_mfma_f32_16x16x32_bf16 v[52:55], a[244:247], a[56:59], v[52:55]
    ds_read_b64_tr_b16 v[146:147], v235 offset:4096
    s_add_u32 m0, s3, 116736
    v_mfma_f32_16x16x32_bf16 v[52:55], a[240:243], a[40:43], v[52:55]
    buffer_load_dwordx4 v245, s[48:51], s93 offen lds
    v_mfma_f32_16x16x32_bf16 v[44:47], a[240:243], a[36:39], v[44:47]
    ds_read_b64_tr_b16 v[148:149], v235 offset:8192
    v_mfma_f32_16x16x32_bf16 v[44:47], a[244:247], a[52:55], v[44:47]
    v_readlane_b32 s94, v247, 35
    v_mfma_f32_16x16x32_bf16 v[36:39], a[244:247], a[48:51], v[36:39]
    ds_read_b64_tr_b16 v[150:151], v235 offset:12288
    s_add_u32 m0, s3, 122880
    v_mfma_f32_16x16x32_bf16 v[36:39], a[240:243], a[32:35], v[36:39]
    s_waitcnt lgkmcnt(4)
    v_mfma_f32_16x16x32_bf16 v[64:67], v[128:131], a[32:35], v[64:67]
    ds_read_b64_tr_b16 v[152:153], v236 offset:0
    v_mfma_f32_16x16x32_bf16 v[64:67], v[132:135], a[48:51], v[64:67]
    buffer_load_dwordx4 v244, s[48:51], s94 offen lds
    v_mfma_f32_16x16x32_bf16 v[72:75], v[132:135], a[52:55], v[72:75]
    ds_read_b64_tr_b16 v[154:155], v236 offset:4096
    s_add_u32 m0, s3, 124928
    v_mfma_f32_16x16x32_bf16 v[72:75], v[128:131], a[36:39], v[72:75]
    buffer_load_dwordx4 v245, s[48:51], s94 offen lds
    v_mfma_f32_16x16x32_bf16 v[80:83], v[128:131], a[40:43], v[80:83]
    ds_read_b64_tr_b16 v[156:157], v236 offset:8192
    v_mfma_f32_16x16x32_bf16 v[80:83], v[132:135], a[56:59], v[80:83]
    v_readlane_b32 s95, v246, 34
    v_mfma_f32_16x16x32_bf16 v[88:91], v[132:135], a[60:63], v[88:91]
    ds_read_b64_tr_b16 v[158:159], v236 offset:12288
    v_mfma_f32_16x16x32_bf16 v[88:91], v[128:131], a[44:47], v[88:91]
    s_nop 1
    buffer_load_dwordx4 a[0:3], v240, s[40:43], s95 offen sc1
    s_cmp_eq_u32 s29, 30
    s_cbranch_scc1 L_eg12
    s_barrier
    v_mfma_f32_16x16x32_bf16 v[92:95], v[136:139], a[44:47], v[92:95]
    ds_read_b64_tr_b16 a[232:233], v160 offset:49152
    v_mfma_f32_16x16x32_bf16 v[92:95], v[140:143], a[60:63], v[92:95]
    buffer_load_dwordx4 a[4:7], v241, s[40:43], s95 offen sc1
    v_mfma_f32_16x16x32_bf16 v[84:87], v[140:143], a[56:59], v[84:87]
    ds_read_b64_tr_b16 a[234:235], v160 offset:53248
    v_mfma_f32_16x16x32_bf16 v[84:87], v[136:139], a[40:43], v[84:87]
    buffer_load_dwordx4 a[8:11], v242, s[40:43], s95 offen sc1
    v_mfma_f32_16x16x32_bf16 v[76:79], v[136:139], a[36:39], v[76:79]
    ds_read_b64_tr_b16 a[236:237], v160 offset:57344
    v_mfma_f32_16x16x32_bf16 v[76:79], v[140:143], a[52:55], v[76:79]
    v_mfma_f32_16x16x32_bf16 v[68:71], v[140:143], a[48:51], v[68:71]
    ds_read_b64_tr_b16 a[238:239], v160 offset:61440
    v_mfma_f32_16x16x32_bf16 v[68:71], v[136:139], a[32:35], v[68:71]
    s_waitcnt lgkmcnt(4)
    v_mfma_f32_16x16x32_bf16 v[96:99], v[144:147], a[32:35], v[96:99]
    ds_read_b64_tr_b16 a[240:241], v161 offset:49152
    v_mfma_f32_16x16x32_bf16 v[96:99], v[148:151], a[48:51], v[96:99]
    buffer_load_dwordx4 a[12:15], v243, s[40:43], s95 offen sc1
    v_mfma_f32_16x16x32_bf16 v[104:107], v[148:151], a[52:55], v[104:107]
    ds_read_b64_tr_b16 a[242:243], v161 offset:53248
    v_mfma_f32_16x16x32_bf16 v[104:107], v[144:147], a[36:39], v[104:107]
    v_readlane_b32 s92, v246, 35
    v_mfma_f32_16x16x32_bf16 v[112:115], v[144:147], a[40:43], v[112:115]
    ds_read_b64_tr_b16 a[244:245], v161 offset:57344
    v_mfma_f32_16x16x32_bf16 v[112:115], v[148:151], a[56:59], v[112:115]
    v_mfma_f32_16x16x32_bf16 v[120:123], v[148:151], a[60:63], v[120:123]
    ds_read_b64_tr_b16 a[246:247], v161 offset:61440
    v_mfma_f32_16x16x32_bf16 v[120:123], v[144:147], a[44:47], v[120:123]
    buffer_load_dwordx4 a[16:19], v240, s[40:43], s92 offen sc1
    v_mfma_f32_16x16x32_bf16 v[124:127], v[152:155], a[44:47], v[124:127]
    ds_read_b64_tr_b16 v[128:129], v162 offset:49152
    v_mfma_f32_16x16x32_bf16 v[124:127], v[156:159], a[60:63], v[124:127]
    buffer_load_dwordx4 a[20:23], v241, s[40:43], s92 offen sc1
    v_mfma_f32_16x16x32_bf16 v[116:119], v[156:159], a[56:59], v[116:119]
    ds_read_b64_tr_b16 v[130:131], v162 offset:53248
    v_mfma_f32_16x16x32_bf16 v[116:119], v[152:155], a[40:43], v[116:119]
    buffer_load_dwordx4 a[24:27], v242, s[40:43], s92 offen sc1
    v_mfma_f32_16x16x32_bf16 v[108:111], v[152:155], a[36:39], v[108:111]
    ds_read_b64_tr_b16 v[132:133], v162 offset:57344
    v_mfma_f32_16x16x32_bf16 v[108:111], v[156:159], a[52:55], v[108:111]
    v_mfma_f32_16x16x32_bf16 v[100:103], v[156:159], a[48:51], v[100:103]
    ds_read_b64_tr_b16 v[134:135], v162 offset:61440
    v_mfma_f32_16x16x32_bf16 v[100:103], v[152:155], a[32:35], v[100:103]
    s_waitcnt lgkmcnt(4)
    v_mfma_f32_16x16x32_bf16 v[0:3], a[232:235], a[64:67], v[0:3]
    ds_read_b64_tr_b16 v[136:137], v163 offset:49152
    v_mfma_f32_16x16x32_bf16 v[0:3], a[236:239], a[80:83], v[0:3]
    buffer_load_dwordx4 a[28:31], v243, s[40:43], s92 offen sc1
    v_mfma_f32_16x16x32_bf16 v[8:11], a[236:239], a[84:87], v[8:11]
    ds_read_b64_tr_b16 v[138:139], v163 offset:53248
    v_mfma_f32_16x16x32_bf16 v[8:11], a[232:235], a[68:71], v[8:11]
    v_readlane_b32 s93, v247, 36
    v_mfma_f32_16x16x32_bf16 v[16:19], a[232:235], a[72:75], v[16:19]
    ds_read_b64_tr_b16 v[140:141], v163 offset:57344
    s_add_u32 m0, s3, 131072
    v_mfma_f32_16x16x32_bf16 v[16:19], a[236:239], a[88:91], v[16:19]
    v_mfma_f32_16x16x32_bf16 v[24:27], a[236:239], a[92:95], v[24:27]
    ds_read_b64_tr_b16 v[142:143], v163 offset:61440
    v_mfma_f32_16x16x32_bf16 v[24:27], a[232:235], a[76:79], v[24:27]
    buffer_load_dwordx4 v244, s[48:51], s93 offen lds
    v_mfma_f32_16x16x32_bf16 v[28:31], a[240:243], a[76:79], v[28:31]
    ds_read_b64_tr_b16 v[144:145], v164 offset:49152
    s_add_u32 m0, s3, 133120
    v_mfma_f32_16x16x32_bf16 v[28:31], a[244:247], a[92:95], v[28:31]
    buffer_load_dwordx4 v245, s[48:51], s93 offen lds
    v_mfma_f32_16x16x32_bf16 v[20:23], a[244:247], a[88:91], v[20:23]
    ds_read_b64_tr_b16 v[146:147], v164 offset:53248
    v_mfma_f32_16x16x32_bf16 v[20:23], a[240:243], a[72:75], v[20:23]
    v_readlane_b32 s94, v247, 37
    v_mfma_f32_16x16x32_bf16 v[12:15], a[240:243], a[68:71], v[12:15]
    ds_read_b64_tr_b16 v[148:149], v164 offset:57344
    s_add_u32 m0, s3, 139264
    v_mfma_f32_16x16x32_bf16 v[12:15], a[244:247], a[84:87], v[12:15]
    v_mfma_f32_16x16x32_bf16 v[4:7], a[244:247], a[80:83], v[4:7]
    ds_read_b64_tr_b16 v[150:151], v164 offset:61440
    v_mfma_f32_16x16x32_bf16 v[4:7], a[240:243], a[64:67], v[4:7]
    s_waitcnt lgkmcnt(4)
    v_mfma_f32_16x16x32_bf16 v[32:35], v[128:131], a[64:67], v[32:35]
    ds_read_b64_tr_b16 v[152:153], v165 offset:49152
    v_mfma_f32_16x16x32_bf16 v[32:35], v[132:135], a[80:83], v[32:35]
    buffer_load_dwordx4 v244, s[48:51], s94 offen lds
    v_mfma_f32_16x16x32_bf16 v[40:43], v[132:135], a[84:87], v[40:43]
    ds_read_b64_tr_b16 v[154:155], v165 offset:53248
    s_add_u32 m0, s3, 141312
    v_mfma_f32_16x16x32_bf16 v[40:43], v[128:131], a[68:71], v[40:43]
    buffer_load_dwordx4 v245, s[48:51], s94 offen lds
    v_mfma_f32_16x16x32_bf16 v[48:51], v[128:131], a[72:75], v[48:51]
    ds_read_b64_tr_b16 v[156:157], v165 offset:57344
    v_mfma_f32_16x16x32_bf16 v[48:51], v[132:135], a[88:91], v[48:51]
    v_readlane_b32 s95, v246, 36
    v_mfma_f32_16x16x32_bf16 v[56:59], v[132:135], a[92:95], v[56:59]
    ds_read_b64_tr_b16 v[158:159], v165 offset:61440
    v_mfma_f32_16x16x32_bf16 v[56:59], v[128:131], a[76:79], v[56:59]
    v_mfma_f32_16x16x32_bf16 v[60:63], v[136:139], a[76:79], v[60:63]
    ds_read_b64_tr_b16 a[232:233], v166 offset:49152
    v_mfma_f32_16x16x32_bf16 v[60:63], v[140:143], a[92:95], v[60:63]
    buffer_load_dwordx4 a[32:35], v240, s[40:43], s95 offen sc1
    v_mfma_f32_16x16x32_bf16 v[52:55], v[140:143], a[88:91], v[52:55]
    ds_read_b64_tr_b16 a[234:235], v166 offset:53248
    v_mfma_f32_16x16x32_bf16 v[52:55], v[136:139], a[72:75], v[52:55]
    buffer_load_dwordx4 a[36:39], v241, s[40:43], s95 offen sc1
    v_mfma_f32_16x16x32_bf16 v[44:47], v[136:139], a[68:71], v[44:47]
    ds_read_b64_tr_b16 a[236:237], v166 offset:57344
    v_mfma_f32_16x16x32_bf16 v[44:47], v[140:143], a[84:87], v[44:47]
    buffer_load_dwordx4 a[40:43], v242, s[40:43], s95 offen sc1
    v_mfma_f32_16x16x32_bf16 v[36:39], v[140:143], a[80:83], v[36:39]
    ds_read_b64_tr_b16 a[238:239], v166 offset:61440
    v_mfma_f32_16x16x32_bf16 v[36:39], v[136:139], a[64:67], v[36:39]
    s_waitcnt lgkmcnt(4)
    v_mfma_f32_16x16x32_bf16 v[64:67], v[144:147], a[64:67], v[64:67]
    ds_read_b64_tr_b16 a[240:241], v167 offset:49152
    v_mfma_f32_16x16x32_bf16 v[64:67], v[148:151], a[80:83], v[64:67]
    buffer_load_dwordx4 a[44:47], v243, s[40:43], s95 offen sc1
    v_mfma_f32_16x16x32_bf16 v[72:75], v[148:151], a[84:87], v[72:75]
    ds_read_b64_tr_b16 a[242:243], v167 offset:53248
    v_mfma_f32_16x16x32_bf16 v[72:75], v[144:147], a[68:71], v[72:75]
    v_readlane_b32 s92, v246, 37
    v_mfma_f32_16x16x32_bf16 v[80:83], v[144:147], a[72:75], v[80:83]
    ds_read_b64_tr_b16 a[244:245], v167 offset:57344
    v_mfma_f32_16x16x32_bf16 v[80:83], v[148:151], a[88:91], v[80:83]
    v_mfma_f32_16x16x32_bf16 v[88:91], v[148:151], a[92:95], v[88:91]
    ds_read_b64_tr_b16 a[246:247], v167 offset:61440
    v_mfma_f32_16x16x32_bf16 v[88:91], v[144:147], a[76:79], v[88:91]
    buffer_load_dwordx4 a[48:51], v240, s[40:43], s92 offen sc1
    s_cmp_eq_u32 s29, 32
    s_cbranch_scc1 L_eg13
    s_barrier
    v_mfma_f32_16x16x32_bf16 v[92:95], v[152:155], a[76:79], v[92:95]
    ds_read_b64_tr_b16 v[128:129], v160 offset:0
    v_mfma_f32_16x16x32_bf16 v[92:95], v[156:159], a[92:95], v[92:95]
    buffer_load_dwordx4 a[52:55], v241, s[40:43], s92 offen sc1
    v_mfma_f32_16x16x32_bf16 v[84:87], v[156:159], a[88:91], v[84:87]
    ds_read_b64_tr_b16 v[130:131], v160 offset:4096
    v_mfma_f32_16x16x32_bf16 v[84:87], v[152:155], a[72:75], v[84:87]
    buffer_load_dwordx4 a[56:59], v242, s[40:43], s92 offen sc1
    v_mfma_f32_16x16x32_bf16 v[76:79], v[152:155], a[68:71], v[76:79]
    ds_read_b64_tr_b16 v[132:133], v160 offset:8192
    v_mfma_f32_16x16x32_bf16 v[76:79], v[156:159], a[84:87], v[76:79]
    v_mfma_f32_16x16x32_bf16 v[68:71], v[156:159], a[80:83], v[68:71]
    ds_read_b64_tr_b16 v[134:135], v160 offset:12288
    v_mfma_f32_16x16x32_bf16 v[68:71], v[152:155], a[64:67], v[68:71]
    s_waitcnt lgkmcnt(4)
    v_mfma_f32_16x16x32_bf16 v[96:99], a[232:235], a[64:67], v[96:99]
    ds_read_b64_tr_b16 v[136:137], v161 offset:0
    v_mfma_f32_16x16x32_bf16 v[96:99], a[236:239], a[80:83], v[96:99]
    buffer_load_dwordx4 a[60:63], v243, s[40:43], s92 offen sc1
    v_mfma_f32_16x16x32_bf16 v[104:107], a[236:239], a[84:87], v[104:107]
    ds_read_b64_tr_b16 v[138:139], v161 offset:4096
    v_mfma_f32_16x16x32_bf16 v[104:107], a[232:235], a[68:71], v[104:107]
    v_readlane_b32 s93, v247, 38
    v_mfma_f32_16x16x32_bf16 v[112:115], a[232:235], a[72:75], v[112:115]
    ds_read_b64_tr_b16 v[140:141], v161 offset:8192
    s_add_u32 m0, s3, 81920
    v_mfma_f32_16x16x32_bf16 v[112:115], a[236:239], a[88:91], v[112:115]
    v_mfma_f32_16x16x32_bf16 v[120:123], a[236:239], a[92:95], v[120:123]
    ds_read_b64_tr_b16 v[142:143], v161 offset:12288
    v_mfma_f32_16x16x32_bf16 v[120:123], a[232:235], a[76:79], v[120:123]
    buffer_load_dwordx4 v244, s[48:51], s93 offen lds
    v_mfma_f32_16x16x32_bf16 v[124:127], a[240:243], a[76:79], v[124:127]
    ds_read_b64_tr_b16 v[144:145], v162 offset:0
    s_add_u32 m0, s3, 83968
    v_mfma_f32_16x16x32_bf16 v[124:127], a[244:247], a[92:95], v[124:127]
    buffer_load_dwordx4 v245, s[48:51], s93 offen lds
    v_mfma_f32_16x16x32_bf16 v[116:119], a[244:247], a[88:91], v[116:119]
    ds_read_b64_tr_b16 v[146:147], v162 offset:4096
    v_mfma_f32_16x16x32_bf16 v[116:119], a[240:243], a[72:75], v[116:119]
    v_readlane_b32 s94, v247, 39
    v_mfma_f32_16x16x32_bf16 v[108:111], a[240:243], a[68:71], v[108:111]
    ds_read_b64_tr_b16 v[148:149], v162 offset:8192
    s_add_u32 m0, s3, 90112
    v_mfma_f32_16x16x32_bf16 v[108:111], a[244:247], a[84:87], v[108:111]
    v_mfma_f32_16x16x32_bf16 v[100:103], a[244:247], a[80:83], v[100:103]
    ds_read_b64_tr_b16 v[150:151], v162 offset:12288
    v_mfma_f32_16x16x32_bf16 v[100:103], a[240:243], a[64:67], v[100:103]
    s_waitcnt vmcnt(63) lgkmcnt(4)
    v_mfma_f32_16x16x32_bf16 v[0:3], v[128:131], a[96:99], v[0:3]
    ds_read_b64_tr_b16 v[152:153], v163 offset:0
    v_mfma_f32_16x16x32_bf16 v[0:3], v[132:135], a[112:115], v[0:3]
    buffer_load_dwordx4 v244, s[48:51], s94 offen lds
    v_mfma_f32_16x16x32_bf16 v[8:11], v[132:135], a[116:119], v[8:11]
    ds_read_b64_tr_b16 v[154:155], v163 offset:4096
    s_add_u32 m0, s3, 92160
    v_mfma_f32_16x16x32_bf16 v[8:11], v[128:131], a[100:103], v[8:11]
    buffer_load_dwordx4 v245, s[48:51], s94 offen lds
    v_mfma_f32_16x16x32_bf16 v[16:19], v[128:131], a[104:107], v[16:19]
    ds_read_b64_tr_b16 v[156:157], v163 offset:8192
    v_mfma_f32_16x16x32_bf16 v[16:19], v[132:135], a[120:123], v[16:19]
    v_readlane_b32 s95, v246, 38
    v_mfma_f32_16x16x32_bf16 v[24:27], v[132:135], a[124:127], v[24:27]
    ds_read_b64_tr_b16 v[158:159], v163 offset:12288
    v_mfma_f32_16x16x32_bf16 v[24:27], v[128:131], a[108:111], v[24:27]
    v_mfma_f32_16x16x32_bf16 v[28:31], v[136:139], a[108:111], v[28:31]
    ds_read_b64_tr_b16 a[232:233], v164 offset:0
    v_mfma_f32_16x16x32_bf16 v[28:31], v[140:143], a[124:127], v[28:31]
    buffer_load_dwordx4 a[64:67], v240, s[40:43], s95 offen sc1
    v_mfma_f32_16x16x32_bf16 v[20:23], v[140:143], a[120:123], v[20:23]
    ds_read_b64_tr_b16 a[234:235], v164 offset:4096
    v_mfma_f32_16x16x32_bf16 v[20:23], v[136:139], a[104:107], v[20:23]
    buffer_load_dwordx4 a[68:71], v241, s[40:43], s95 offen sc1
    v_mfma_f32_16x16x32_bf16 v[12:15], v[136:139], a[100:103], v[12:15]
    ds_read_b64_tr_b16 a[236:237], v164 offset:8192
    v_mfma_f32_16x16x32_bf16 v[12:15], v[140:143], a[116:119], v[12:15]
    buffer_load_dwordx4 a[72:75], v242, s[40:43], s95 offen sc1
    v_mfma_f32_16x16x32_bf16 v[4:7], v[140:143], a[112:115], v[4:7]
    ds_read_b64_tr_b16 a[238:239], v164 offset:12288
    v_mfma_f32_16x16x32_bf16 v[4:7], v[136:139], a[96:99], v[4:7]
    s_waitcnt lgkmcnt(4)
    v_mfma_f32_16x16x32_bf16 v[32:35], v[144:147], a[96:99], v[32:35]
    ds_read_b64_tr_b16 a[240:241], v165 offset:0
    v_mfma_f32_16x16x32_bf16 v[32:35], v[148:151], a[112:115], v[32:35]
    buffer_load_dwordx4 a[76:79], v243, s[40:43], s95 offen sc1
    v_mfma_f32_16x16x32_bf16 v[40:43], v[148:151], a[116:119], v[40:43]
    ds_read_b64_tr_b16 a[242:243], v165 offset:4096
    v_mfma_f32_16x16x32_bf16 v[40:43], v[144:147], a[100:103], v[40:43]
    v_readlane_b32 s92, v246, 39
    v_mfma_f32_16x16x32_bf16 v[48:51], v[144:147], a[104:107], v[48:51]
    ds_read_b64_tr_b16 a[244:245], v165 offset:8192
    v_mfma_f32_16x16x32_bf16 v[48:51], v[148:151], a[120:123], v[48:51]
    v_mfma_f32_16x16x32_bf16 v[56:59], v[148:151], a[124:127], v[56:59]
    ds_read_b64_tr_b16 a[246:247], v165 offset:12288
    v_mfma_f32_16x16x32_bf16 v[56:59], v[144:147], a[108:111], v[56:59]
    buffer_load_dwordx4 a[80:83], v240, s[40:43], s92 offen sc1
    v_mfma_f32_16x16x32_bf16 v[60:63], v[152:155], a[108:111], v[60:63]
    ds_read_b64_tr_b16 v[128:129], v166 offset:0
    v_mfma_f32_16x16x32_bf16 v[60:63], v[156:159], a[124:127], v[60:63]
    buffer_load_dwordx4 a[84:87], v241, s[40:43], s92 offen sc1
    v_mfma_f32_16x16x32_bf16 v[52:55], v[156:159], a[120:123], v[52:55]
    ds_read_b64_tr_b16 v[130:131], v166 offset:4096
    v_mfma_f32_16x16x32_bf16 v[52:55], v[152:155], a[104:107], v[52:55]
    buffer_load_dwordx4 a[88:91], v242, s[40:43], s92 offen sc1
    v_mfma_f32_16x16x32_bf16 v[44:47], v[152:155], a[100:103], v[44:47]
    ds_read_b64_tr_b16 v[132:133], v166 offset:8192
    v_mfma_f32_16x16x32_bf16 v[44:47], v[156:159], a[116:119], v[44:47]
    v_mfma_f32_16x16x32_bf16 v[36:39], v[156:159], a[112:115], v[36:39]
    ds_read_b64_tr_b16 v[134:135], v166 offset:12288
    v_mfma_f32_16x16x32_bf16 v[36:39], v[152:155], a[96:99], v[36:39]
    s_waitcnt lgkmcnt(4)
    v_mfma_f32_16x16x32_bf16 v[64:67], a[232:235], a[96:99], v[64:67]
    ds_read_b64_tr_b16 v[136:137], v167 offset:0
    v_mfma_f32_16x16x32_bf16 v[64:67], a[236:239], a[112:115], v[64:67]
    buffer_load_dwordx4 a[92:95], v243, s[40:43], s92 offen sc1
    v_mfma_f32_16x16x32_bf16 v[72:75], a[236:239], a[116:119], v[72:75]
    ds_read_b64_tr_b16 v[138:139], v167 offset:4096
    v_mfma_f32_16x16x32_bf16 v[72:75], a[232:235], a[100:103], v[72:75]
    v_mfma_f32_16x16x32_bf16 v[80:83], a[232:235], a[104:107], v[80:83]
    ds_read_b64_tr_b16 v[140:141], v167 offset:8192
    v_mfma_f32_16x16x32_bf16 v[80:83], a[236:239], a[120:123], v[80:83]
    v_mfma_f32_16x16x32_bf16 v[88:91], a[236:239], a[124:127], v[88:91]
    ds_read_b64_tr_b16 v[142:143], v167 offset:12288
    v_mfma_f32_16x16x32_bf16 v[88:91], a[232:235], a[108:111], v[88:91]
    s_waitcnt vmcnt(32)
    s_barrier
    v_mfma_f32_16x16x32_bf16 v[92:95], a[240:243], a[108:111], v[92:95]
    ds_read_b64_tr_b16 v[144:145], v162 offset:16384
    v_mfma_f32_16x16x32_bf16 v[92:95], a[244:247], a[124:127], v[92:95]
    v_mfma_f32_16x16x32_bf16 v[84:87], a[244:247], a[120:123], v[84:87]
    ds_read_b64_tr_b16 v[146:147], v162 offset:20480
    v_mfma_f32_16x16x32_bf16 v[84:87], a[240:243], a[104:107], v[84:87]
    v_mfma_f32_16x16x32_bf16 v[76:79], a[240:243], a[100:103], v[76:79]
    ds_read_b64_tr_b16 v[148:149], v162 offset:24576
    v_mfma_f32_16x16x32_bf16 v[76:79], a[244:247], a[116:119], v[76:79]
    v_mfma_f32_16x16x32_bf16 v[68:71], a[244:247], a[112:115], v[68:71]
    ds_read_b64_tr_b16 v[150:151], v162 offset:28672
    v_mfma_f32_16x16x32_bf16 v[68:71], a[240:243], a[96:99], v[68:71]
    s_waitcnt lgkmcnt(4)
    v_mfma_f32_16x16x32_bf16 v[96:99], v[128:131], a[96:99], v[96:99]
    ds_read_b64_tr_b16 v[152:153], v163 offset:16384
    v_mfma_f32_16x16x32_bf16 v[96:99], v[132:135], a[112:115], v[96:99]
    v_mfma_f32_16x16x32_bf16 v[104:107], v[132:135], a[116:119], v[104:107]
    ds_read_b64_tr_b16 v[154:155], v163 offset:20480
    v_mfma_f32_16x16x32_bf16 v[104:107], v[128:131], a[100:103], v[104:107]
    v_mfma_f32_16x16x32_bf16 v[112:115], v[128:131], a[104:107], v[112:115]
    ds_read_b64_tr_b16 v[156:157], v163 offset:24576
    v_mfma_f32_16x16x32_bf16 v[112:115], v[132:135], a[120:123], v[112:115]
    v_mfma_f32_16x16x32_bf16 v[120:123], v[132:135], a[124:127], v[120:123]
    ds_read_b64_tr_b16 v[158:159], v163 offset:28672
    v_mfma_f32_16x16x32_bf16 v[120:123], v[128:131], a[108:111], v[120:123]
    v_mfma_f32_16x16x32_bf16 v[124:127], v[136:139], a[108:111], v[124:127]
    ds_read_b64_tr_b16 a[232:233], v162 offset:32768
    v_mfma_f32_16x16x32_bf16 v[124:127], v[140:143], a[124:127], v[124:127]
    v_mfma_f32_16x16x32_bf16 v[116:119], v[140:143], a[120:123], v[116:119]
    ds_read_b64_tr_b16 a[234:235], v162 offset:36864
    v_mfma_f32_16x16x32_bf16 v[116:119], v[136:139], a[104:107], v[116:119]
    v_mfma_f32_16x16x32_bf16 v[108:111], v[136:139], a[100:103], v[108:111]
    ds_read_b64_tr_b16 a[236:237], v162 offset:40960
    v_mfma_f32_16x16x32_bf16 v[108:111], v[140:143], a[116:119], v[108:111]
    v_mfma_f32_16x16x32_bf16 v[100:103], v[140:143], a[112:115], v[100:103]
    ds_read_b64_tr_b16 a[238:239], v162 offset:45056
    v_mfma_f32_16x16x32_bf16 v[100:103], v[136:139], a[96:99], v[100:103]
    s_waitcnt lgkmcnt(4)
    v_mfma_f32_16x16x32_bf16 v[32:35], v[144:147], a[136:139], v[32:35]
    ds_read_b64_tr_b16 a[240:241], v163 offset:32768
    v_mfma_f32_16x16x32_bf16 v[32:35], v[148:151], a[152:155], v[32:35]
    v_mfma_f32_16x16x32_bf16 v[40:43], v[148:151], a[156:159], v[40:43]
    ds_read_b64_tr_b16 a[242:243], v163 offset:36864
    v_mfma_f32_16x16x32_bf16 v[40:43], v[144:147], a[140:143], v[40:43]
    v_mfma_f32_16x16x32_bf16 v[48:51], v[144:147], a[144:147], v[48:51]
    ds_read_b64_tr_b16 a[244:245], v163 offset:40960
    v_mfma_f32_16x16x32_bf16 v[48:51], v[148:151], a[160:163], v[48:51]
    v_mfma_f32_16x16x32_bf16 v[56:59], v[148:151], a[164:167], v[56:59]
    ds_read_b64_tr_b16 a[246:247], v163 offset:45056
    v_mfma_f32_16x16x32_bf16 v[56:59], v[144:147], a[148:151], v[56:59]
    v_mfma_f32_16x16x32_bf16 v[60:63], v[152:155], a[148:151], v[60:63]
    ds_read_b64_tr_b16 v[128:129], v252 offset:16384
    v_mfma_f32_16x16x32_bf16 v[60:63], v[156:159], a[164:167], v[60:63]
    v_mfma_f32_16x16x32_bf16 v[52:55], v[156:159], a[160:163], v[52:55]
    ds_read_b64_tr_b16 v[130:131], v252 offset:20480
    v_mfma_f32_16x16x32_bf16 v[52:55], v[152:155], a[144:147], v[52:55]
    v_mfma_f32_16x16x32_bf16 v[44:47], v[152:155], a[140:143], v[44:47]
    ds_read_b64_tr_b16 v[132:133], v252 offset:24576
    v_mfma_f32_16x16x32_bf16 v[44:47], v[156:159], a[156:159], v[44:47]
    v_mfma_f32_16x16x32_bf16 v[36:39], v[156:159], a[152:155], v[36:39]
    ds_read_b64_tr_b16 v[134:135], v252 offset:28672
    v_mfma_f32_16x16x32_bf16 v[36:39], v[152:155], a[136:139], v[36:39]
    s_waitcnt lgkmcnt(4)
    v_mfma_f32_16x16x32_bf16 v[32:35], a[232:235], a[168:171], v[32:35]
    ds_read_b64_tr_b16 v[136:137], v253 offset:16384
    v_mfma_f32_16x16x32_bf16 v[32:35], a[236:239], a[184:187], v[32:35]
    v_mfma_f32_16x16x32_bf16 v[40:43], a[236:239], a[188:191], v[40:43]
    ds_read_b64_tr_b16 v[138:139], v253 offset:20480
    v_mfma_f32_16x16x32_bf16 v[40:43], a[232:235], a[172:175], v[40:43]
    v_mfma_f32_16x16x32_bf16 v[48:51], a[232:235], a[176:179], v[48:51]
    ds_read_b64_tr_b16 v[140:141], v253 offset:24576
    v_mfma_f32_16x16x32_bf16 v[48:51], a[236:239], a[192:195], v[48:51]
    v_mfma_f32_16x16x32_bf16 v[56:59], a[236:239], a[196:199], v[56:59]
    ds_read_b64_tr_b16 v[142:143], v253 offset:28672
    v_mfma_f32_16x16x32_bf16 v[56:59], a[232:235], a[180:183], v[56:59]
    v_mfma_f32_16x16x32_bf16 v[60:63], a[240:243], a[180:183], v[60:63]
    ds_read_b64_tr_b16 v[144:145], v252 offset:32768
    v_mfma_f32_16x16x32_bf16 v[60:63], a[244:247], a[196:199], v[60:63]
    v_mfma_f32_16x16x32_bf16 v[52:55], a[244:247], a[192:195], v[52:55]
    ds_read_b64_tr_b16 v[146:147], v252 offset:36864
    v_mfma_f32_16x16x32_bf16 v[52:55], a[240:243], a[176:179], v[52:55]
    v_mfma_f32_16x16x32_bf16 v[44:47], a[240:243], a[172:175], v[44:47]
    ds_read_b64_tr_b16 v[148:149], v252 offset:40960
    v_mfma_f32_16x16x32_bf16 v[44:47], a[244:247], a[188:191], v[44:47]
    v_mfma_f32_16x16x32_bf16 v[36:39], a[244:247], a[184:187], v[36:39]
    ds_read_b64_tr_b16 v[150:151], v252 offset:45056
    v_mfma_f32_16x16x32_bf16 v[36:39], a[240:243], a[168:171], v[36:39]
    s_waitcnt lgkmcnt(4)
    v_mfma_f32_16x16x32_bf16 v[32:35], v[128:131], a[200:203], v[32:35]
    ds_read_b64_tr_b16 v[152:153], v253 offset:32768
    v_mfma_f32_16x16x32_bf16 v[32:35], v[132:135], a[216:219], v[32:35]
    v_mfma_f32_16x16x32_bf16 v[40:43], v[132:135], a[220:223], v[40:43]
    ds_read_b64_tr_b16 v[154:155], v253 offset:36864
    v_mfma_f32_16x16x32_bf16 v[40:43], v[128:131], a[204:207], v[40:43]
    v_mfma_f32_16x16x32_bf16 v[48:51], v[128:131], a[208:211], v[48:51]
    ds_read_b64_tr_b16 v[156:157], v253 offset:40960
    v_mfma_f32_16x16x32_bf16 v[48:51], v[132:135], a[224:227], v[48:51]
    buffer_load_dwordx2 v[176:177], v228, s[24:27], s88 offen offset:0
    v_mfma_f32_16x16x32_bf16 v[56:59], v[132:135], a[228:231], v[56:59]
    ds_read_b64_tr_b16 v[158:159], v253 offset:45056
    v_mfma_f32_16x16x32_bf16 v[56:59], v[128:131], a[212:215], v[56:59]
    s_waitcnt vmcnt(21)
    s_barrier
    v_mfma_f32_16x16x32_bf16 v[60:63], v[136:139], a[212:215], v[60:63]
    ds_read_b64_tr_b16 a[232:233], v252 offset:49152
    v_mfma_f32_16x16x32_bf16 v[60:63], v[140:143], a[228:231], v[60:63]
    v_mfma_f32_16x16x32_bf16 v[52:55], v[140:143], a[224:227], v[52:55]
    ds_read_b64_tr_b16 a[234:235], v252 offset:53248
    v_mfma_f32_16x16x32_bf16 v[52:55], v[136:139], a[208:211], v[52:55]
    buffer_load_dword v170, v230, s[44:47], s77 offen offset:768 sc1
    v_mfma_f32_16x16x32_bf16 v[44:47], v[136:139], a[204:207], v[44:47]
    ds_read_b64_tr_b16 a[236:237], v252 offset:57344
    v_mfma_f32_16x16x32_bf16 v[44:47], v[140:143], a[220:223], v[44:47]
    buffer_load_dwordx2 v[178:179], v228, s[24:27], s88 offen offset:32
    v_mfma_f32_16x16x32_bf16 v[36:39], v[140:143], a[216:219], v[36:39]
    ds_read_b64_tr_b16 a[238:239], v252 offset:61440
    v_mfma_f32_16x16x32_bf16 v[36:39], v[136:139], a[200:203], v[36:39]
    s_waitcnt lgkmcnt(4)
    v_mfma_f32_16x16x32_bf16 v[32:35], v[144:147], a[0:3], v[32:35]
    ds_read_b64_tr_b16 a[240:241], v253 offset:49152
    v_mfma_f32_16x16x32_bf16 v[32:35], v[148:151], a[16:19], v[32:35]
    v_mfma_f32_16x16x32_bf16 v[40:43], v[148:151], a[20:23], v[40:43]
    ds_read_b64_tr_b16 a[242:243], v253 offset:53248
    v_mfma_f32_16x16x32_bf16 v[40:43], v[144:147], a[4:7], v[40:43]
    buffer_load_dwordx2 v[180:181], v228, s[24:27], s89 offen offset:0
    v_mfma_f32_16x16x32_bf16 v[48:51], v[144:147], a[8:11], v[48:51]
    ds_read_b64_tr_b16 a[244:245], v253 offset:57344
    v_mfma_f32_16x16x32_bf16 v[48:51], v[148:151], a[24:27], v[48:51]
    v_mfma_f32_16x16x32_bf16 v[56:59], v[148:151], a[28:31], v[56:59]
    ds_read_b64_tr_b16 a[246:247], v253 offset:61440
    v_mfma_f32_16x16x32_bf16 v[56:59], v[144:147], a[12:15], v[56:59]
    v_mfma_f32_16x16x32_bf16 v[60:63], v[152:155], a[12:15], v[60:63]
    ds_read_b64_tr_b16 v[128:129], v164 offset:16384
    v_mfma_f32_16x16x32_bf16 v[60:63], v[156:159], a[28:31], v[60:63]
    v_mfma_f32_16x16x32_bf16 v[52:55], v[156:159], a[24:27], v[52:55]
    ds_read_b64_tr_b16 v[130:131], v164 offset:20480
    v_mfma_f32_16x16x32_bf16 v[52:55], v[152:155], a[8:11], v[52:55]
    buffer_load_dwordx2 v[182:183], v228, s[24:27], s89 offen offset:32
    v_mfma_f32_16x16x32_bf16 v[44:47], v[152:155], a[4:7], v[44:47]
    ds_read_b64_tr_b16 v[132:133], v164 offset:24576
    v_mfma_f32_16x16x32_bf16 v[44:47], v[156:159], a[20:23], v[44:47]
    v_mfma_f32_16x16x32_bf16 v[36:39], v[156:159], a[16:19], v[36:39]
    ds_read_b64_tr_b16 v[134:135], v164 offset:28672
    v_mfma_f32_16x16x32_bf16 v[36:39], v[152:155], a[0:3], v[36:39]
    s_waitcnt vmcnt(17) lgkmcnt(4)
    v_mfma_f32_16x16x32_bf16 v[32:35], a[232:235], a[32:35], v[32:35]
    ds_read_b64_tr_b16 v[136:137], v165 offset:16384
    v_mfma_f32_16x16x32_bf16 v[32:35], a[236:239], a[48:51], v[32:35]
    v_mfma_f32_16x16x32_bf16 v[40:43], a[236:239], a[52:55], v[40:43]
    ds_read_b64_tr_b16 v[138:139], v165 offset:20480
    v_mfma_f32_16x16x32_bf16 v[40:43], a[232:235], a[36:39], v[40:43]
    buffer_load_dwordx2 v[184:185], v228, s[24:27], s90 offen offset:0
    v_mfma_f32_16x16x32_bf16 v[48:51], a[232:235], a[40:43], v[48:51]
    ds_read_b64_tr_b16 v[140:141], v165 offset:24576
    v_mfma_f32_16x16x32_bf16 v[48:51], a[236:239], a[56:59], v[48:51]
    v_mfma_f32_16x16x32_bf16 v[56:59], a[236:239], a[60:63], v[56:59]
    ds_read_b64_tr_b16 v[142:143], v165 offset:28672
    v_mfma_f32_16x16x32_bf16 v[56:59], a[232:235], a[44:47], v[56:59]
    s_waitcnt vmcnt(14)
    s_barrier
    v_mfma_f32_16x16x32_bf16 v[60:63], a[240:243], a[44:47], v[60:63]
    ds_read_b64_tr_b16 v[144:145], v252 offset:0
    v_mfma_f32_16x16x32_bf16 v[60:63], a[244:247], a[60:63], v[60:63]
    v_mfma_f32_16x16x32_bf16 v[52:55], a[244:247], a[56:59], v[52:55]
    ds_read_b64_tr_b16 v[146:147], v252 offset:4096
    v_mfma_f32_16x16x32_bf16 v[52:55], a[240:243], a[40:43], v[52:55]
    buffer_load_dwordx2 v[186:187], v228, s[24:27], s90 offen offset:32
    v_mfma_f32_16x16x32_bf16 v[44:47], a[240:243], a[36:39], v[44:47]
    ds_read_b64_tr_b16 v[148:149], v252 offset:8192
    v_mfma_f32_16x16x32_bf16 v[44:47], a[244:247], a[52:55], v[44:47]
    v_mfma_f32_16x16x32_bf16 v[36:39], a[244:247], a[48:51], v[36:39]
    ds_read_b64_tr_b16 v[150:151], v252 offset:12288
    v_mfma_f32_16x16x32_bf16 v[36:39], a[240:243], a[32:35], v[36:39]
    s_waitcnt lgkmcnt(4)
    v_mfma_f32_16x16x32_bf16 v[64:67], v[128:131], a[136:139], v[64:67]
    ds_read_b64_tr_b16 v[152:153], v253 offset:0
    v_mfma_f32_16x16x32_bf16 v[64:67], v[132:135], a[152:155], v[64:67]
    buffer_load_dwordx2 v[188:189], v228, s[24:27], s91 offen offset:0
    v_mfma_f32_16x16x32_bf16 v[72:75], v[132:135], a[156:159], v[72:75]
    ds_read_b64_tr_b16 v[154:155], v253 offset:4096
    v_mfma_f32_16x16x32_bf16 v[72:75], v[128:131], a[140:143], v[72:75]
    v_mfma_f32_16x16x32_bf16 v[80:83], v[128:131], a[144:147], v[80:83]
    ds_read_b64_tr_b16 v[156:157], v253 offset:8192
    v_mfma_f32_16x16x32_bf16 v[80:83], v[132:135], a[160:163], v[80:83]
    v_mfma_f32_16x16x32_bf16 v[88:91], v[132:135], a[164:167], v[88:91]
    ds_read_b64_tr_b16 v[158:159], v253 offset:12288
    v_mfma_f32_16x16x32_bf16 v[88:91], v[128:131], a[148:151], v[88:91]
    v_mfma_f32_16x16x32_bf16 v[92:95], v[136:139], a[148:151], v[92:95]
    ds_read_b64_tr_b16 a[232:233], v164 offset:32768
    v_mfma_f32_16x16x32_bf16 v[92:95], v[140:143], a[164:167], v[92:95]
    buffer_load_dwordx2 v[190:191], v228, s[24:27], s91 offen offset:32
    v_mfma_f32_16x16x32_bf16 v[84:87], v[140:143], a[160:163], v[84:87]
    ds_read_b64_tr_b16 a[234:235], v164 offset:36864
    v_mfma_f32_16x16x32_bf16 v[84:87], v[136:139], a[144:147], v[84:87]
    v_mfma_f32_16x16x32_bf16 v[76:79], v[136:139], a[140:143], v[76:79]
    ds_read_b64_tr_b16 a[236:237], v164 offset:40960
    v_mfma_f32_16x16x32_bf16 v[76:79], v[140:143], a[156:159], v[76:79]
    v_mfma_f32_16x16x32_bf16 v[68:71], v[140:143], a[152:155], v[68:71]
    ds_read_b64_tr_b16 a[238:239], v164 offset:45056
    v_mfma_f32_16x16x32_bf16 v[68:71], v[136:139], a[136:139], v[68:71]
    s_waitcnt vmcnt(9) lgkmcnt(4)
    v_mfma_f32_16x16x32_bf16 v[32:35], v[144:147], a[64:67], v[32:35]
    ds_read_b64_tr_b16 a[240:241], v165 offset:32768
    v_mfma_f32_16x16x32_bf16 v[32:35], v[148:151], a[80:83], v[32:35]
    v_mfma_f32_16x16x32_bf16 v[36:39], v[156:159], a[80:83], v[36:39]
    ds_read_b64_tr_b16 a[242:243], v165 offset:36864
    v_mfma_f32_16x16x32_bf16 v[36:39], v[152:155], a[64:67], v[36:39]
    v_mfma_f32_16x16x32_bf16 v[44:47], v[152:155], a[68:71], v[44:47]
    ds_read_b64_tr_b16 a[244:245], v165 offset:40960
    v_mfma_f32_16x16x32_bf16 v[44:47], v[156:159], a[84:87], v[44:47]
    v_mfma_f32_16x16x32_bf16 v[40:43], v[148:151], a[84:87], v[40:43]
    ds_read_b64_tr_b16 a[246:247], v165 offset:45056
    v_mfma_f32_16x16x32_bf16 v[40:43], v[144:147], a[68:71], v[40:43]
    s_waitcnt vmcnt(7)
    v_cmp_eq_u32 s[4:5], v239, v170
    v_mfma_f32_16x16x32_bf16 v[48:51], v[144:147], a[72:75], v[48:51]
    ds_read_b64_tr_b16 v[128:129], v249 offset:16384
    v_mfma_f32_16x16x32_bf16 v[48:51], v[148:151], a[88:91], v[48:51]
    s_or_b32 s4, s4, s5
    s_cmp_eq_u32 s4, -1
    s_cbranch_scc0 L_slow_p414
L_back_p414:
    v_mfma_f32_16x16x32_bf16 v[52:55], v[156:159], a[88:91], v[52:55]
    ds_read_b64_tr_b16 v[130:131], v249 offset:20480
    v_mfma_f32_16x16x32_bf16 v[52:55], v[152:155], a[72:75], v[52:55]
    v_cvt_pk_bf16_f32 v32, v32, v33
    v_cvt_pk_bf16_f32 v33, v34, v35
    v_mfma_f32_16x16x32_bf16 v[60:63], v[152:155], a[76:79], v[60:63]
    ds_read_b64_tr_b16 v[132:133], v249 offset:24576
    v_mfma_f32_16x16x32_bf16 v[60:63], v[156:159], a[92:95], v[60:63]
    v_cvt_pk_bf16_f32 v34, v36, v37
    v_cvt_pk_bf16_f32 v35, v38, v39
    v_or_b32 v32, 1, v32
    v_mfma_f32_16x16x32_bf16 v[56:59], v[148:151], a[92:95], v[56:59]
    ds_read_b64_tr_b16 v[134:135], v249 offset:28672
    v_mfma_f32_16x16x32_bf16 v[56:59], v[144:147], a[76:79], v[56:59]
    s_waitcnt lgkmcnt(4)
    v_mfma_f32_16x16x32_bf16 v[64:67], a[232:235], a[168:171], v[64:67]
    ds_read_b64_tr_b16 v[136:137], v234 offset:16384
    v_mfma_f32_16x16x32_bf16 v[64:67], a[236:239], a[184:187], v[64:67]
    buffer_store_dwordx4 v[32:35], v240, s[40:43], s13 offen sc1
    v_mfma_f32_16x16x32_bf16 v[72:75], a[236:239], a[188:191], v[72:75]
    ds_read_b64_tr_b16 v[138:139], v234 offset:20480
    v_mfma_f32_16x16x32_bf16 v[72:75], a[232:235], a[172:175], v[72:75]
    v_cvt_pk_bf16_f32 v40, v40, v41
    v_cvt_pk_bf16_f32 v41, v42, v43
    v_mfma_f32_16x16x32_bf16 v[80:83], a[232:235], a[176:179], v[80:83]
    ds_read_b64_tr_b16 v[140:141], v234 offset:24576
    v_mfma_f32_16x16x32_bf16 v[80:83], a[236:239], a[192:195], v[80:83]
    v_cvt_pk_bf16_f32 v42, v44, v45
    v_cvt_pk_bf16_f32 v43, v46, v47
    v_or_b32 v40, 1, v40
    v_mfma_f32_16x16x32_bf16 v[88:91], a[236:239], a[196:199], v[88:91]
    ds_read_b64_tr_b16 v[142:143], v234 offset:28672
    v_mfma_f32_16x16x32_bf16 v[88:91], a[232:235], a[180:183], v[88:91]
    buffer_store_dwordx4 v[40:43], v241, s[40:43], s13 offen sc1
    v_mfma_f32_16x16x32_bf16 v[92:95], a[240:243], a[180:183], v[92:95]
    ds_read_b64_tr_b16 v[144:145], v249 offset:32768
    v_mfma_f32_16x16x32_bf16 v[92:95], a[244:247], a[196:199], v[92:95]
    v_cvt_pk_bf16_f32 v48, v48, v49
    v_cvt_pk_bf16_f32 v49, v50, v51
    v_mfma_f32_16x16x32_bf16 v[84:87], a[244:247], a[192:195], v[84:87]
    ds_read_b64_tr_b16 v[146:147], v249 offset:36864
    v_mfma_f32_16x16x32_bf16 v[84:87], a[240:243], a[176:179], v[84:87]
    v_cvt_pk_bf16_f32 v50, v52, v53
    v_cvt_pk_bf16_f32 v51, v54, v55
    v_or_b32 v48, 1, v48
    v_mfma_f32_16x16x32_bf16 v[76:79], a[240:243], a[172:175], v[76:79]
    ds_read_b64_tr_b16 v[148:149], v249 offset:40960
    v_mfma_f32_16x16x32_bf16 v[76:79], a[244:247], a[188:191], v[76:79]
    buffer_store_dwordx4 v[48:51], v242, s[40:43], s13 offen sc1
    v_mfma_f32_16x16x32_bf16 v[68:71], a[244:247], a[184:187], v[68:71]
    ds_read_b64_tr_b16 v[150:151], v249 offset:45056
    v_mfma_f32_16x16x32_bf16 v[68:71], a[240:243], a[168:171], v[68:71]
    s_waitcnt lgkmcnt(4)
    v_mfma_f32_16x16x32_bf16 v[64:67], v[128:131], a[200:203], v[64:67]
    ds_read_b64_tr_b16 v[152:153], v234 offset:32768
    v_mfma_f32_16x16x32_bf16 v[64:67], v[132:135], a[216:219], v[64:67]
    v_cvt_pk_bf16_f32 v56, v56, v57
    v_cvt_pk_bf16_f32 v57, v58, v59
    v_mfma_f32_16x16x32_bf16 v[72:75], v[132:135], a[220:223], v[72:75]
    ds_read_b64_tr_b16 v[154:155], v234 offset:36864
    v_mfma_f32_16x16x32_bf16 v[72:75], v[128:131], a[204:207], v[72:75]
    v_cvt_pk_bf16_f32 v58, v60, v61
    v_cvt_pk_bf16_f32 v59, v62, v63
    v_or_b32 v56, 1, v56
    v_mfma_f32_16x16x32_bf16 v[80:83], v[128:131], a[208:211], v[80:83]
    ds_read_b64_tr_b16 v[156:157], v234 offset:40960
    v_mfma_f32_16x16x32_bf16 v[80:83], v[132:135], a[224:227], v[80:83]
    buffer_store_dwordx4 v[56:59], v243, s[40:43], s13 offen sc1
    v_mfma_f32_16x16x32_bf16 v[88:91], v[132:135], a[228:231], v[88:91]
    ds_read_b64_tr_b16 v[158:159], v234 offset:45056
    v_mfma_f32_16x16x32_bf16 v[88:91], v[128:131], a[212:215], v[88:91]
    v_mfma_f32_16x16x32_bf16 v[92:95], v[136:139], a[212:215], v[92:95]
    ds_read_b64_tr_b16 a[232:233], v249 offset:49152
    v_mfma_f32_16x16x32_bf16 v[92:95], v[140:143], a[228:231], v[92:95]
    v_mfma_f32_16x16x32_bf16 v[84:87], v[140:143], a[224:227], v[84:87]
    ds_read_b64_tr_b16 a[234:235], v249 offset:53248
    v_mfma_f32_16x16x32_bf16 v[84:87], v[136:139], a[208:211], v[84:87]
    v_mfma_f32_16x16x32_bf16 v[76:79], v[136:139], a[204:207], v[76:79]
    ds_read_b64_tr_b16 a[236:237], v249 offset:57344
    v_mfma_f32_16x16x32_bf16 v[76:79], v[140:143], a[220:223], v[76:79]
    v_mfma_f32_16x16x32_bf16 v[68:71], v[140:143], a[216:219], v[68:71]
    ds_read_b64_tr_b16 a[238:239], v249 offset:61440
    v_mfma_f32_16x16x32_bf16 v[68:71], v[136:139], a[200:203], v[68:71]
    s_waitcnt lgkmcnt(4)
    v_mfma_f32_16x16x32_bf16 v[64:67], v[144:147], a[0:3], v[64:67]
    ds_read_b64_tr_b16 a[240:241], v234 offset:49152
    v_mfma_f32_16x16x32_bf16 v[64:67], v[148:151], a[16:19], v[64:67]
    v_mfma_f32_16x16x32_bf16 v[72:75], v[148:151], a[20:23], v[72:75]
    ds_read_b64_tr_b16 a[242:243], v234 offset:53248
    v_mfma_f32_16x16x32_bf16 v[72:75], v[144:147], a[4:7], v[72:75]
    v_mfma_f32_16x16x32_bf16 v[80:83], v[144:147], a[8:11], v[80:83]
    ds_read_b64_tr_b16 a[244:245], v234 offset:57344
    v_mfma_f32_16x16x32_bf16 v[80:83], v[148:151], a[24:27], v[80:83]
    v_mfma_f32_16x16x32_bf16 v[88:91], v[148:151], a[28:31], v[88:91]
    ds_read_b64_tr_b16 a[246:247], v234 offset:61440
    v_mfma_f32_16x16x32_bf16 v[88:91], v[144:147], a[12:15], v[88:91]
    v_mfma_f32_16x16x32_bf16 v[92:95], v[152:155], a[12:15], v[92:95]
    ds_read_b64_tr_b16 v[128:129], v249 offset:0
    v_mfma_f32_16x16x32_bf16 v[92:95], v[156:159], a[28:31], v[92:95]
    v_mfma_f32_16x16x32_bf16 v[84:87], v[156:159], a[24:27], v[84:87]
    ds_read_b64_tr_b16 v[130:131], v249 offset:4096
    v_mfma_f32_16x16x32_bf16 v[84:87], v[152:155], a[8:11], v[84:87]
    v_mfma_f32_16x16x32_bf16 v[76:79], v[152:155], a[4:7], v[76:79]
    ds_read_b64_tr_b16 v[132:133], v249 offset:8192
    v_mfma_f32_16x16x32_bf16 v[76:79], v[156:159], a[20:23], v[76:79]
    v_mfma_f32_16x16x32_bf16 v[68:71], v[156:159], a[16:19], v[68:71]
    ds_read_b64_tr_b16 v[134:135], v249 offset:12288
    v_mfma_f32_16x16x32_bf16 v[68:71], v[152:155], a[0:3], v[68:71]
    s_waitcnt lgkmcnt(4)
    v_mfma_f32_16x16x32_bf16 v[64:67], a[232:235], a[32:35], v[64:67]
    ds_read_b64_tr_b16 v[136:137], v234 offset:0
    v_mfma_f32_16x16x32_bf16 v[64:67], a[236:239], a[48:51], v[64:67]
    v_mfma_f32_16x16x32_bf16 v[72:75], a[236:239], a[52:55], v[72:75]
    ds_read_b64_tr_b16 v[138:139], v234 offset:4096
    v_mfma_f32_16x16x32_bf16 v[72:75], a[232:235], a[36:39], v[72:75]
    v_mfma_f32_16x16x32_bf16 v[80:83], a[232:235], a[40:43], v[80:83]
    ds_read_b64_tr_b16 v[140:141], v234 offset:8192
    v_mfma_f32_16x16x32_bf16 v[80:83], a[236:239], a[56:59], v[80:83]
    v_mfma_f32_16x16x32_bf16 v[88:91], a[236:239], a[60:63], v[88:91]
    ds_read_b64_tr_b16 v[142:143], v234 offset:12288
    v_mfma_f32_16x16x32_bf16 v[88:91], a[232:235], a[44:47], v[88:91]
    v_mfma_f32_16x16x32_bf16 v[92:95], a[240:243], a[44:47], v[92:95]
    ds_read_b64_tr_b16 v[144:145], v166 offset:16384
    v_mfma_f32_16x16x32_bf16 v[92:95], a[244:247], a[60:63], v[92:95]
    v_mfma_f32_16x16x32_bf16 v[84:87], a[244:247], a[56:59], v[84:87]
    ds_read_b64_tr_b16 v[146:147], v166 offset:20480
    v_mfma_f32_16x16x32_bf16 v[84:87], a[240:243], a[40:43], v[84:87]
    v_mfma_f32_16x16x32_bf16 v[76:79], a[240:243], a[36:39], v[76:79]
    ds_read_b64_tr_b16 v[148:149], v166 offset:24576
    v_mfma_f32_16x16x32_bf16 v[76:79], a[244:247], a[52:55], v[76:79]
    v_mfma_f32_16x16x32_bf16 v[68:71], a[244:247], a[48:51], v[68:71]
    ds_read_b64_tr_b16 v[150:151], v166 offset:28672
    v_mfma_f32_16x16x32_bf16 v[68:71], a[240:243], a[32:35], v[68:71]
    s_waitcnt lgkmcnt(4)
    v_mfma_f32_16x16x32_bf16 v[64:67], v[128:131], a[64:67], v[64:67]
    ds_read_b64_tr_b16 v[152:153], v167 offset:16384
    v_mfma_f32_16x16x32_bf16 v[64:67], v[132:135], a[80:83], v[64:67]
    ds_read_b64_tr_b16 v[154:155], v167 offset:20480
    v_mfma_f32_16x16x32_bf16 v[68:71], v[140:143], a[80:83], v[68:71]
    ds_read_b64_tr_b16 v[156:157], v167 offset:24576
    v_mfma_f32_16x16x32_bf16 v[68:71], v[136:139], a[64:67], v[68:71]
    ds_read_b64_tr_b16 v[158:159], v167 offset:28672
    v_mfma_f32_16x16x32_bf16 v[76:79], v[136:139], a[68:71], v[76:79]
    ds_read_b64_tr_b16 a[232:233], v166 offset:32768
    v_mfma_f32_16x16x32_bf16 v[76:79], v[140:143], a[84:87], v[76:79]
    ds_read_b64_tr_b16 a[234:235], v166 offset:36864
    v_mfma_f32_16x16x32_bf16 v[72:75], v[132:135], a[84:87], v[72:75]
    v_cvt_pk_bf16_f32 v64, v64, v65
    v_cvt_pk_bf16_f32 v65, v66, v67
    v_mfma_f32_16x16x32_bf16 v[72:75], v[128:131], a[68:71], v[72:75]
    v_cvt_pk_bf16_f32 v66, v68, v69
    v_cvt_pk_bf16_f32 v67, v70, v71
    v_or_b32 v64, 1, v64
    v_mfma_f32_16x16x32_bf16 v[80:83], v[128:131], a[72:75], v[80:83]
    buffer_store_dwordx4 v[64:67], v240, s[40:43], s14 offen sc1
    v_mfma_f32_16x16x32_bf16 v[80:83], v[132:135], a[88:91], v[80:83]
    ds_read_b64_tr_b16 a[236:237], v166 offset:40960
    v_mfma_f32_16x16x32_bf16 v[84:87], v[140:143], a[88:91], v[84:87]
    v_cvt_pk_bf16_f32 v72, v72, v73
    v_cvt_pk_bf16_f32 v73, v74, v75
    v_mfma_f32_16x16x32_bf16 v[84:87], v[136:139], a[72:75], v[84:87]
    v_cvt_pk_bf16_f32 v74, v76, v77
    v_cvt_pk_bf16_f32 v75, v78, v79
    v_or_b32 v72, 1, v72
    v_mfma_f32_16x16x32_bf16 v[92:95], v[136:139], a[76:79], v[92:95]
    ds_read_b64_tr_b16 a[238:239], v166 offset:45056
    v_mfma_f32_16x16x32_bf16 v[92:95], v[140:143], a[92:95], v[92:95]
    buffer_store_dwordx4 v[72:75], v241, s[40:43], s14 offen sc1
    v_mfma_f32_16x16x32_bf16 v[88:91], v[132:135], a[92:95], v[88:91]
    v_cvt_pk_bf16_f32 v80, v80, v81
    v_cvt_pk_bf16_f32 v81, v82, v83
    v_mfma_f32_16x16x32_bf16 v[88:91], v[128:131], a[76:79], v[88:91]
    s_waitcnt lgkmcnt(4)
    v_mfma_f32_16x16x32_bf16 v[96:99], v[144:147], a[136:139], v[96:99]
    ds_read_b64_tr_b16 a[240:241], v167 offset:32768
    v_mfma_f32_16x16x32_bf16 v[96:99], v[148:151], a[152:155], v[96:99]
    v_cvt_pk_bf16_f32 v82, v84, v85
    v_cvt_pk_bf16_f32 v83, v86, v87
    v_or_b32 v80, 1, v80
    v_mfma_f32_16x16x32_bf16 v[104:107], v[148:151], a[156:159], v[104:107]
    ds_read_b64_tr_b16 a[242:243], v167 offset:36864
    v_mfma_f32_16x16x32_bf16 v[104:107], v[144:147], a[140:143], v[104:107]
    v_mfma_f32_16x16x32_bf16 v[112:115], v[144:147], a[144:147], v[112:115]
    ds_read_b64_tr_b16 a[244:245], v167 offset:40960
    v_mfma_f32_16x16x32_bf16 v[112:115], v[148:151], a[160:163], v[112:115]
    buffer_store_dwordx4 v[80:83], v242, s[40:43], s14 offen sc1
    v_mfma_f32_16x16x32_bf16 v[120:123], v[148:151], a[164:167], v[120:123]
    ds_read_b64_tr_b16 a[246:247], v167 offset:45056
    v_mfma_f32_16x16x32_bf16 v[120:123], v[144:147], a[148:151], v[120:123]
    v_cvt_pk_bf16_f32 v88, v88, v89
    v_cvt_pk_bf16_f32 v89, v90, v91
    v_mfma_f32_16x16x32_bf16 v[124:127], v[152:155], a[148:151], v[124:127]
    ds_read_b64_tr_b16 v[128:129], v235 offset:16384
    v_mfma_f32_16x16x32_bf16 v[124:127], v[156:159], a[164:167], v[124:127]
    v_cvt_pk_bf16_f32 v90, v92, v93
    v_cvt_pk_bf16_f32 v91, v94, v95
    v_or_b32 v88, 1, v88
    v_mfma_f32_16x16x32_bf16 v[116:119], v[156:159], a[160:163], v[116:119]
    ds_read_b64_tr_b16 v[130:131], v235 offset:20480
    v_mfma_f32_16x16x32_bf16 v[116:119], v[152:155], a[144:147], v[116:119]
    buffer_store_dwordx4 v[88:91], v243, s[40:43], s14 offen sc1
    v_mfma_f32_16x16x32_bf16 v[108:111], v[152:155], a[140:143], v[108:111]
    ds_read_b64_tr_b16 v[132:133], v235 offset:24576
    v_mfma_f32_16x16x32_bf16 v[108:111], v[156:159], a[156:159], v[108:111]
    v_mfma_f32_16x16x32_bf16 v[100:103], v[156:159], a[152:155], v[100:103]
    ds_read_b64_tr_b16 v[134:135], v235 offset:28672
    v_mfma_f32_16x16x32_bf16 v[100:103], v[152:155], a[136:139], v[100:103]
    s_waitcnt lgkmcnt(4)
    v_mfma_f32_16x16x32_bf16 v[96:99], a[232:235], a[168:171], v[96:99]
    ds_read_b64_tr_b16 v[136:137], v236 offset:16384
    v_mfma_f32_16x16x32_bf16 v[96:99], a[236:239], a[184:187], v[96:99]
    v_mfma_f32_16x16x32_bf16 v[104:107], a[236:239], a[188:191], v[104:107]
    ds_read_b64_tr_b16 v[138:139], v236 offset:20480
    v_mfma_f32_16x16x32_bf16 v[104:107], a[232:235], a[172:175], v[104:107]
    v_mfma_f32_16x16x32_bf16 v[112:115], a[232:235], a[176:179], v[112:115]
    ds_read_b64_tr_b16 v[140:141], v236 offset:24576
    v_mfma_f32_16x16x32_bf16 v[112:115], a[236:239], a[192:195], v[112:115]
    v_mfma_f32_16x16x32_bf16 v[120:123], a[236:239], a[196:199], v[120:123]
    ds_read_b64_tr_b16 v[142:143], v236 offset:28672
    v_mfma_f32_16x16x32_bf16 v[120:123], a[232:235], a[180:183], v[120:123]
    v_mfma_f32_16x16x32_bf16 v[124:127], a[240:243], a[180:183], v[124:127]
    ds_read_b64_tr_b16 v[144:145], v235 offset:32768
    v_mfma_f32_16x16x32_bf16 v[124:127], a[244:247], a[196:199], v[124:127]
    v_mfma_f32_16x16x32_bf16 v[116:119], a[244:247], a[192:195], v[116:119]
    ds_read_b64_tr_b16 v[146:147], v235 offset:36864
    v_mfma_f32_16x16x32_bf16 v[116:119], a[240:243], a[176:179], v[116:119]
    v_mfma_f32_16x16x32_bf16 v[108:111], a[240:243], a[172:175], v[108:111]
    ds_read_b64_tr_b16 v[148:149], v235 offset:40960
    v_mfma_f32_16x16x32_bf16 v[108:111], a[244:247], a[188:191], v[108:111]
    v_mfma_f32_16x16x32_bf16 v[100:103], a[244:247], a[184:187], v[100:103]
    ds_read_b64_tr_b16 v[150:151], v235 offset:45056
    v_mfma_f32_16x16x32_bf16 v[100:103], a[240:243], a[168:171], v[100:103]
    s_waitcnt lgkmcnt(4)
    v_mfma_f32_16x16x32_bf16 v[96:99], v[128:131], a[200:203], v[96:99]
    ds_read_b64_tr_b16 v[152:153], v236 offset:32768
    v_mfma_f32_16x16x32_bf16 v[96:99], v[132:135], a[216:219], v[96:99]
    v_mfma_f32_16x16x32_bf16 v[104:107], v[132:135], a[220:223], v[104:107]
    ds_read_b64_tr_b16 v[154:155], v236 offset:36864
    v_mfma_f32_16x16x32_bf16 v[104:107], v[128:131], a[204:207], v[104:107]
    v_mfma_f32_16x16x32_bf16 v[112:115], v[128:131], a[208:211], v[112:115]
    ds_read_b64_tr_b16 v[156:157], v236 offset:40960
    v_mfma_f32_16x16x32_bf16 v[112:115], v[132:135], a[224:227], v[112:115]
    v_mfma_f32_16x16x32_bf16 v[120:123], v[132:135], a[228:231], v[120:123]
    ds_read_b64_tr_b16 v[158:159], v236 offset:45056
    v_mfma_f32_16x16x32_bf16 v[120:123], v[128:131], a[212:215], v[120:123]
    v_mfma_f32_16x16x32_bf16 v[124:127], v[136:139], a[212:215], v[124:127]
    ds_read_b64_tr_b16 a[232:233], v235 offset:49152
    v_mfma_f32_16x16x32_bf16 v[124:127], v[140:143], a[228:231], v[124:127]
    v_mfma_f32_16x16x32_bf16 v[116:119], v[140:143], a[224:227], v[116:119]
    ds_read_b64_tr_b16 a[234:235], v235 offset:53248
    v_mfma_f32_16x16x32_bf16 v[116:119], v[136:139], a[208:211], v[116:119]
    v_mfma_f32_16x16x32_bf16 v[108:111], v[136:139], a[204:207], v[108:111]
    ds_read_b64_tr_b16 a[236:237], v235 offset:57344
    v_mfma_f32_16x16x32_bf16 v[108:111], v[140:143], a[220:223], v[108:111]
    v_mfma_f32_16x16x32_bf16 v[100:103], v[140:143], a[216:219], v[100:103]
    ds_read_b64_tr_b16 a[238:239], v235 offset:61440
    v_mfma_f32_16x16x32_bf16 v[100:103], v[136:139], a[200:203], v[100:103]
    s_waitcnt lgkmcnt(4)
    v_mfma_f32_16x16x32_bf16 v[96:99], v[144:147], a[0:3], v[96:99]
    ds_read_b64_tr_b16 a[240:241], v236 offset:49152
    v_mfma_f32_16x16x32_bf16 v[96:99], v[148:151], a[16:19], v[96:99]
    v_mfma_f32_16x16x32_bf16 v[104:107], v[148:151], a[20:23], v[104:107]
    ds_read_b64_tr_b16 a[242:243], v236 offset:53248
    v_mfma_f32_16x16x32_bf16 v[104:107], v[144:147], a[4:7], v[104:107]
    v_mfma_f32_16x16x32_bf16 v[112:115], v[144:147], a[8:11], v[112:115]
    ds_read_b64_tr_b16 a[244:245], v236 offset:57344
    v_mfma_f32_16x16x32_bf16 v[112:115], v[148:151], a[24:27], v[112:115]
    v_mfma_f32_16x16x32_bf16 v[120:123], v[148:151], a[28:31], v[120:123]
    ds_read_b64_tr_b16 a[246:247], v236 offset:61440
    v_mfma_f32_16x16x32_bf16 v[120:123], v[144:147], a[12:15], v[120:123]
    v_mfma_f32_16x16x32_bf16 v[124:127], v[152:155], a[12:15], v[124:127]
    ds_read_b64_tr_b16 v[128:129], v235 offset:0
    v_mfma_f32_16x16x32_bf16 v[124:127], v[156:159], a[28:31], v[124:127]
    v_mfma_f32_16x16x32_bf16 v[116:119], v[156:159], a[24:27], v[116:119]
    ds_read_b64_tr_b16 v[130:131], v235 offset:4096
    v_mfma_f32_16x16x32_bf16 v[116:119], v[152:155], a[8:11], v[116:119]
    v_mfma_f32_16x16x32_bf16 v[108:111], v[152:155], a[4:7], v[108:111]
    ds_read_b64_tr_b16 v[132:133], v235 offset:8192
    v_mfma_f32_16x16x32_bf16 v[108:111], v[156:159], a[20:23], v[108:111]
    v_mfma_f32_16x16x32_bf16 v[100:103], v[156:159], a[16:19], v[100:103]
    ds_read_b64_tr_b16 v[134:135], v235 offset:12288
    v_mfma_f32_16x16x32_bf16 v[100:103], v[152:155], a[0:3], v[100:103]
    s_waitcnt lgkmcnt(4)
    v_mfma_f32_16x16x32_bf16 v[96:99], a[232:235], a[32:35], v[96:99]
    ds_read_b64_tr_b16 v[136:137], v236 offset:0
    v_mfma_f32_16x16x32_bf16 v[96:99], a[236:239], a[48:51], v[96:99]
    v_mfma_f32_16x16x32_bf16 v[104:107], a[236:239], a[52:55], v[104:107]
    ds_read_b64_tr_b16 v[138:139], v236 offset:4096
    v_mfma_f32_16x16x32_bf16 v[104:107], a[232:235], a[36:39], v[104:107]
    v_mfma_f32_16x16x32_bf16 v[112:115], a[232:235], a[40:43], v[112:115]
    ds_read_b64_tr_b16 v[140:141], v236 offset:8192
    v_mfma_f32_16x16x32_bf16 v[112:115], a[236:239], a[56:59], v[112:115]
    v_mfma_f32_16x16x32_bf16 v[120:123], a[236:239], a[60:63], v[120:123]
    ds_read_b64_tr_b16 v[142:143], v236 offset:12288
    v_mfma_f32_16x16x32_bf16 v[120:123], a[232:235], a[44:47], v[120:123]
    v_mfma_f32_16x16x32_bf16 v[124:127], a[240:243], a[44:47], v[124:127]
    ds_read_b64_tr_b16 v[144:145], v160 offset:16384
    v_mfma_f32_16x16x32_bf16 v[124:127], a[244:247], a[60:63], v[124:127]
    v_mfma_f32_16x16x32_bf16 v[116:119], a[244:247], a[56:59], v[116:119]
    ds_read_b64_tr_b16 v[146:147], v160 offset:20480
    v_mfma_f32_16x16x32_bf16 v[116:119], a[240:243], a[40:43], v[116:119]
    v_mfma_f32_16x16x32_bf16 v[108:111], a[240:243], a[36:39], v[108:111]
    ds_read_b64_tr_b16 v[148:149], v160 offset:24576
    v_mfma_f32_16x16x32_bf16 v[108:111], a[244:247], a[52:55], v[108:111]
    v_mfma_f32_16x16x32_bf16 v[100:103], a[244:247], a[48:51], v[100:103]
    ds_read_b64_tr_b16 v[150:151], v160 offset:28672
    v_mfma_f32_16x16x32_bf16 v[100:103], a[240:243], a[32:35], v[100:103]
    s_waitcnt lgkmcnt(4)
    v_mfma_f32_16x16x32_bf16 v[96:99], v[128:131], a[64:67], v[96:99]
    ds_read_b64_tr_b16 v[152:153], v161 offset:16384
    v_mfma_f32_16x16x32_bf16 v[96:99], v[132:135], a[80:83], v[96:99]
    v_mfma_f32_16x16x32_bf16 v[100:103], v[140:143], a[80:83], v[100:103]
    ds_read_b64_tr_b16 v[154:155], v161 offset:20480
    v_mfma_f32_16x16x32_bf16 v[100:103], v[136:139], a[64:67], v[100:103]
    v_mfma_f32_16x16x32_bf16 v[108:111], v[136:139], a[68:71], v[108:111]
    ds_read_b64_tr_b16 v[156:157], v161 offset:24576
    v_mfma_f32_16x16x32_bf16 v[108:111], v[140:143], a[84:87], v[108:111]
    v_mfma_f32_16x16x32_bf16 v[104:107], v[132:135], a[84:87], v[104:107]
    ds_read_b64_tr_b16 v[158:159], v161 offset:28672
    v_mfma_f32_16x16x32_bf16 v[104:107], v[128:131], a[68:71], v[104:107]
    v_cvt_pk_bf16_f32 v96, v96, v97
    v_cvt_pk_bf16_f32 v97, v98, v99
    v_mfma_f32_16x16x32_bf16 v[112:115], v[128:131], a[72:75], v[112:115]
    v_cvt_pk_bf16_f32 v98, v100, v101
    v_cvt_pk_bf16_f32 v99, v102, v103
    v_or_b32 v96, 1, v96
    v_mfma_f32_16x16x32_bf16 v[112:115], v[132:135], a[88:91], v[112:115]
    ds_read_b64_tr_b16 a[232:233], v160 offset:32768
    v_mfma_f32_16x16x32_bf16 v[116:119], v[140:143], a[88:91], v[116:119]
    buffer_store_dwordx4 v[96:99], v240, s[40:43], s15 offen sc1
    v_mfma_f32_16x16x32_bf16 v[116:119], v[136:139], a[72:75], v[116:119]
    ds_read_b64_tr_b16 a[234:235], v160 offset:36864
    v_mfma_f32_16x16x32_bf16 v[124:127], v[136:139], a[76:79], v[124:127]
    v_cvt_pk_bf16_f32 v104, v104, v105
    v_cvt_pk_bf16_f32 v105, v106, v107
    v_mfma_f32_16x16x32_bf16 v[124:127], v[140:143], a[92:95], v[124:127]
    v_cvt_pk_bf16_f32 v106, v108, v109
    v_cvt_pk_bf16_f32 v107, v110, v111
    v_or_b32 v104, 1, v104
    v_mfma_f32_16x16x32_bf16 v[120:123], v[132:135], a[92:95], v[120:123]
    ds_read_b64_tr_b16 a[236:237], v160 offset:40960
    v_mfma_f32_16x16x32_bf16 v[120:123], v[128:131], a[76:79], v[120:123]
    s_waitcnt lgkmcnt(3)
    v_mfma_f32_16x16x32_bf16 v[0:3], v[144:147], a[136:139], v[0:3]
    buffer_store_dwordx4 v[104:107], v241, s[40:43], s15 offen sc1
    v_mfma_f32_16x16x32_bf16 v[0:3], v[148:151], a[152:155], v[0:3]
    ds_read_b64_tr_b16 a[238:239], v160 offset:45056
    v_mfma_f32_16x16x32_bf16 v[8:11], v[148:151], a[156:159], v[8:11]
    v_cvt_pk_bf16_f32 v112, v112, v113
    v_cvt_pk_bf16_f32 v113, v114, v115
    v_mfma_f32_16x16x32_bf16 v[8:11], v[144:147], a[140:143], v[8:11]
    v_cvt_pk_bf16_f32 v114, v116, v117
    v_cvt_pk_bf16_f32 v115, v118, v119
    v_or_b32 v112, 1, v112
    v_mfma_f32_16x16x32_bf16 v[16:19], v[144:147], a[144:147], v[16:19]
    ds_read_b64_tr_b16 a[240:241], v161 offset:32768
    v_mfma_f32_16x16x32_bf16 v[16:19], v[148:151], a[160:163], v[16:19]
    buffer_store_dwordx4 v[112:115], v242, s[40:43], s15 offen sc1
    v_mfma_f32_16x16x32_bf16 v[24:27], v[148:151], a[164:167], v[24:27]
    ds_read_b64_tr_b16 a[242:243], v161 offset:36864
    v_mfma_f32_16x16x32_bf16 v[24:27], v[144:147], a[148:151], v[24:27]
    v_cvt_pk_bf16_f32 v120, v120, v121
    v_cvt_pk_bf16_f32 v121, v122, v123
    v_mfma_f32_16x16x32_bf16 v[28:31], v[152:155], a[148:151], v[28:31]
    v_cvt_pk_bf16_f32 v122, v124, v125
    v_cvt_pk_bf16_f32 v123, v126, v127
    v_or_b32 v120, 1, v120
    v_mfma_f32_16x16x32_bf16 v[28:31], v[156:159], a[164:167], v[28:31]
    ds_read_b64_tr_b16 a[244:245], v161 offset:40960
    v_mfma_f32_16x16x32_bf16 v[20:23], v[156:159], a[160:163], v[20:23]
    buffer_store_dwordx4 v[120:123], v243, s[40:43], s15 offen sc1
    v_mfma_f32_16x16x32_bf16 v[20:23], v[152:155], a[144:147], v[20:23]
    ds_read_b64_tr_b16 a[246:247], v161 offset:45056
    v_mfma_f32_16x16x32_bf16 v[12:15], v[152:155], a[140:143], v[12:15]
    ds_read_b64_tr_b16 v[128:129], v250 offset:16384
    v_mfma_f32_16x16x32_bf16 v[12:15], v[156:159], a[156:159], v[12:15]
    ds_read_b64_tr_b16 v[130:131], v250 offset:20480
    v_mfma_f32_16x16x32_bf16 v[4:7], v[156:159], a[152:155], v[4:7]
    ds_read_b64_tr_b16 v[132:133], v250 offset:24576
    v_mfma_f32_16x16x32_bf16 v[4:7], v[152:155], a[136:139], v[4:7]
    s_waitcnt lgkmcnt(3)
    v_mfma_f32_16x16x32_bf16 v[0:3], a[232:235], a[168:171], v[0:3]
    ds_read_b64_tr_b16 v[134:135], v250 offset:28672
    v_mfma_f32_16x16x32_bf16 v[0:3], a[236:239], a[184:187], v[0:3]
    ds_read_b64_tr_b16 v[136:137], v251 offset:16384
    v_mfma_f32_16x16x32_bf16 v[8:11], a[236:239], a[188:191], v[8:11]
    ds_read_b64_tr_b16 v[138:139], v251 offset:20480
    v_mfma_f32_16x16x32_bf16 v[8:11], a[232:235], a[172:175], v[8:11]
    v_mfma_f32_16x16x32_bf16 v[16:19], a[232:235], a[176:179], v[16:19]
    ds_read_b64_tr_b16 v[140:141], v251 offset:24576
    v_mfma_f32_16x16x32_bf16 v[16:19], a[236:239], a[192:195], v[16:19]
    v_mfma_f32_16x16x32_bf16 v[24:27], a[236:239], a[196:199], v[24:27]
    ds_read_b64_tr_b16 v[142:143], v251 offset:28672
    v_mfma_f32_16x16x32_bf16 v[24:27], a[232:235], a[180:183], v[24:27]
    v_mfma_f32_16x16x32_bf16 v[28:31], a[240:243], a[180:183], v[28:31]
    ds_read_b64_tr_b16 v[144:145], v250 offset:32768
    v_mfma_f32_16x16x32_bf16 v[28:31], a[244:247], a[196:199], v[28:31]
    v_mfma_f32_16x16x32_bf16 v[20:23], a[244:247], a[192:195], v[20:23]
    ds_read_b64_tr_b16 v[146:147], v250 offset:36864
    v_mfma_f32_16x16x32_bf16 v[20:23], a[240:243], a[176:179], v[20:23]
    v_mfma_f32_16x16x32_bf16 v[12:15], a[240:243], a[172:175], v[12:15]
    ds_read_b64_tr_b16 v[148:149], v250 offset:40960
    v_mfma_f32_16x16x32_bf16 v[12:15], a[244:247], a[188:191], v[12:15]
    v_mfma_f32_16x16x32_bf16 v[4:7], a[244:247], a[184:187], v[4:7]
    ds_read_b64_tr_b16 v[150:151], v250 offset:45056
    v_mfma_f32_16x16x32_bf16 v[4:7], a[240:243], a[168:171], v[4:7]
    s_waitcnt lgkmcnt(4)
    v_mfma_f32_16x16x32_bf16 v[0:3], v[128:131], a[200:203], v[0:3]
    ds_read_b64_tr_b16 v[152:153], v251 offset:32768
    v_mfma_f32_16x16x32_bf16 v[0:3], v[132:135], a[216:219], v[0:3]
    v_mfma_f32_16x16x32_bf16 v[8:11], v[132:135], a[220:223], v[8:11]
    ds_read_b64_tr_b16 v[154:155], v251 offset:36864
    v_mfma_f32_16x16x32_bf16 v[8:11], v[128:131], a[204:207], v[8:11]
    v_mfma_f32_16x16x32_bf16 v[16:19], v[128:131], a[208:211], v[16:19]
    ds_read_b64_tr_b16 v[156:157], v251 offset:40960
    v_mfma_f32_16x16x32_bf16 v[16:19], v[132:135], a[224:227], v[16:19]
    v_mfma_f32_16x16x32_bf16 v[24:27], v[132:135], a[228:231], v[24:27]
    ds_read_b64_tr_b16 v[158:159], v251 offset:45056
    v_mfma_f32_16x16x32_bf16 v[24:27], v[128:131], a[212:215], v[24:27]
    v_mfma_f32_16x16x32_bf16 v[28:31], v[136:139], a[212:215], v[28:31]
    ds_read_b64_tr_b16 a[232:233], v250 offset:49152
    v_mfma_f32_16x16x32_bf16 v[28:31], v[140:143], a[228:231], v[28:31]
    v_mfma_f32_16x16x32_bf16 v[20:23], v[140:143], a[224:227], v[20:23]
    ds_read_b64_tr_b16 a[234:235], v250 offset:53248
    v_mfma_f32_16x16x32_bf16 v[20:23], v[136:139], a[208:211], v[20:23]
    v_mfma_f32_16x16x32_bf16 v[12:15], v[136:139], a[204:207], v[12:15]
    ds_read_b64_tr_b16 a[236:237], v250 offset:57344
    v_mfma_f32_16x16x32_bf16 v[12:15], v[140:143], a[220:223], v[12:15]
    v_mfma_f32_16x16x32_bf16 v[4:7], v[140:143], a[216:219], v[4:7]
    ds_read_b64_tr_b16 a[238:239], v250 offset:61440
    v_mfma_f32_16x16x32_bf16 v[4:7], v[136:139], a[200:203], v[4:7]
    s_waitcnt lgkmcnt(4)
    v_mfma_f32_16x16x32_bf16 v[0:3], v[144:147], a[0:3], v[0:3]
    ds_read_b64_tr_b16 a[240:241], v251 offset:49152
    v_mfma_f32_16x16x32_bf16 v[0:3], v[148:151], a[16:19], v[0:3]
    v_mfma_f32_16x16x32_bf16 v[8:11], v[148:151], a[20:23], v[8:11]
    ds_read_b64_tr_b16 a[242:243], v251 offset:53248
    v_mfma_f32_16x16x32_bf16 v[8:11], v[144:147], a[4:7], v[8:11]
    v_mfma_f32_16x16x32_bf16 v[16:19], v[144:147], a[8:11], v[16:19]
    ds_read_b64_tr_b16 a[244:245], v251 offset:57344
    v_mfma_f32_16x16x32_bf16 v[16:19], v[148:151], a[24:27], v[16:19]
    v_mfma_f32_16x16x32_bf16 v[24:27], v[148:151], a[28:31], v[24:27]
    ds_read_b64_tr_b16 a[246:247], v251 offset:61440
    v_mfma_f32_16x16x32_bf16 v[24:27], v[144:147], a[12:15], v[24:27]
    v_mfma_f32_16x16x32_bf16 v[28:31], v[152:155], a[12:15], v[28:31]
    ds_read_b64_tr_b16 v[128:129], v250 offset:0
    v_mfma_f32_16x16x32_bf16 v[28:31], v[156:159], a[28:31], v[28:31]
    v_mfma_f32_16x16x32_bf16 v[20:23], v[156:159], a[24:27], v[20:23]
    ds_read_b64_tr_b16 v[130:131], v250 offset:4096
    v_mfma_f32_16x16x32_bf16 v[20:23], v[152:155], a[8:11], v[20:23]
    v_mfma_f32_16x16x32_bf16 v[12:15], v[152:155], a[4:7], v[12:15]
    ds_read_b64_tr_b16 v[132:133], v250 offset:8192
    v_mfma_f32_16x16x32_bf16 v[12:15], v[156:159], a[20:23], v[12:15]
    v_mfma_f32_16x16x32_bf16 v[4:7], v[156:159], a[16:19], v[4:7]
    ds_read_b64_tr_b16 v[134:135], v250 offset:12288
    v_mfma_f32_16x16x32_bf16 v[4:7], v[152:155], a[0:3], v[4:7]
    s_waitcnt lgkmcnt(4)
    v_mfma_f32_16x16x32_bf16 v[0:3], a[232:235], a[32:35], v[0:3]
    ds_read_b64_tr_b16 v[136:137], v251 offset:0
    v_mfma_f32_16x16x32_bf16 v[0:3], a[236:239], a[48:51], v[0:3]
    v_mfma_f32_16x16x32_bf16 v[8:11], a[236:239], a[52:55], v[8:11]
    ds_read_b64_tr_b16 v[138:139], v251 offset:4096
    v_mfma_f32_16x16x32_bf16 v[8:11], a[232:235], a[36:39], v[8:11]
    v_mfma_f32_16x16x32_bf16 v[16:19], a[232:235], a[40:43], v[16:19]
    ds_read_b64_tr_b16 v[140:141], v251 offset:8192
    v_mfma_f32_16x16x32_bf16 v[16:19], a[236:239], a[56:59], v[16:19]
    v_mfma_f32_16x16x32_bf16 v[24:27], a[236:239], a[60:63], v[24:27]
    ds_read_b64_tr_b16 v[142:143], v251 offset:12288
    v_mfma_f32_16x16x32_bf16 v[24:27], a[232:235], a[44:47], v[24:27]
    v_mfma_f32_16x16x32_bf16 v[28:31], a[240:243], a[44:47], v[28:31]
    v_mfma_f32_16x16x32_bf16 v[28:31], a[244:247], a[60:63], v[28:31]
    v_mfma_f32_16x16x32_bf16 v[20:23], a[244:247], a[56:59], v[20:23]
    v_mfma_f32_16x16x32_bf16 v[20:23], a[240:243], a[40:43], v[20:23]
    v_mfma_f32_16x16x32_bf16 v[12:15], a[240:243], a[36:39], v[12:15]
    v_mfma_f32_16x16x32_bf16 v[12:15], a[244:247], a[52:55], v[12:15]
    v_mfma_f32_16x16x32_bf16 v[4:7], a[244:247], a[48:51], v[4:7]
    v_mfma_f32_16x16x32_bf16 v[4:7], a[240:243], a[32:35], v[4:7]
    s_waitcnt lgkmcnt(0)
    v_mfma_f32_16x16x32_bf16 v[0:3], v[128:131], a[64:67], v[0:3]
    buffer_load_dwordx4 v[192:195], v240, s[40:43], s82 offen sc1
    v_mfma_f32_16x16x32_bf16 v[0:3], v[132:135], a[80:83], v[0:3]
    v_mfma_f32_16x16x32_bf16 v[4:7], v[140:143], a[80:83], v[4:7]
    buffer_load_dwordx4 v[196:199], v241, s[40:43], s82 offen sc1
    v_mfma_f32_16x16x32_bf16 v[4:7], v[136:139], a[64:67], v[4:7]
    v_mfma_f32_16x16x32_bf16 v[12:15], v[136:139], a[68:71], v[12:15]
    buffer_load_dwordx4 v[200:203], v242, s[40:43], s82 offen sc1
    v_mfma_f32_16x16x32_bf16 v[12:15], v[140:143], a[84:87], v[12:15]
    v_mfma_f32_16x16x32_bf16 v[8:11], v[132:135], a[84:87], v[8:11]
    buffer_load_dwordx4 v[204:207], v243, s[40:43], s82 offen sc1
    v_mfma_f32_16x16x32_bf16 v[8:11], v[128:131], a[68:71], v[8:11]
    v_mfma_f32_16x16x32_bf16 v[16:19], v[128:131], a[72:75], v[16:19]
    v_mfma_f32_16x16x32_bf16 v[16:19], v[132:135], a[88:91], v[16:19]
    v_mfma_f32_16x16x32_bf16 v[20:23], v[140:143], a[88:91], v[20:23]
    v_mfma_f32_16x16x32_bf16 v[20:23], v[136:139], a[72:75], v[20:23]
    v_mfma_f32_16x16x32_bf16 v[28:31], v[136:139], a[76:79], v[28:31]
    v_mfma_f32_16x16x32_bf16 v[28:31], v[140:143], a[92:95], v[28:31]
    v_mfma_f32_16x16x32_bf16 v[24:27], v[132:135], a[92:95], v[24:27]
    v_mfma_f32_16x16x32_bf16 v[24:27], v[128:131], a[76:79], v[24:27]
    s_branch L_g2_fin
L_eg10:
    s_barrier
    v_mfma_f32_16x16x32_bf16 v[92:95], v[152:155], a[212:215], v[92:95]
    ds_read_b64_tr_b16 v[128:129], v252 offset:49152
    v_mfma_f32_16x16x32_bf16 v[92:95], v[156:159], a[228:231], v[92:95]
    buffer_load_dwordx4 a[156:159], v241, s[40:43], s92 offen sc1
    v_mfma_f32_16x16x32_bf16 v[84:87], v[156:159], a[224:227], v[84:87]
    ds_read_b64_tr_b16 v[130:131], v252 offset:53248
    v_mfma_f32_16x16x32_bf16 v[84:87], v[152:155], a[208:211], v[84:87]
    buffer_load_dwordx4 a[160:163], v242, s[40:43], s92 offen sc1
    v_mfma_f32_16x16x32_bf16 v[76:79], v[152:155], a[204:207], v[76:79]
    ds_read_b64_tr_b16 v[132:133], v252 offset:57344
    v_mfma_f32_16x16x32_bf16 v[76:79], v[156:159], a[220:223], v[76:79]
    v_mfma_f32_16x16x32_bf16 v[68:71], v[156:159], a[216:219], v[68:71]
    ds_read_b64_tr_b16 v[134:135], v252 offset:61440
    v_mfma_f32_16x16x32_bf16 v[68:71], v[152:155], a[200:203], v[68:71]
    s_waitcnt lgkmcnt(4)
    v_mfma_f32_16x16x32_bf16 v[96:99], a[232:235], a[200:203], v[96:99]
    ds_read_b64_tr_b16 v[136:137], v253 offset:49152
    v_mfma_f32_16x16x32_bf16 v[96:99], a[236:239], a[216:219], v[96:99]
    buffer_load_dwordx4 a[164:167], v243, s[40:43], s92 offen sc1
    v_mfma_f32_16x16x32_bf16 v[104:107], a[236:239], a[220:223], v[104:107]
    ds_read_b64_tr_b16 v[138:139], v253 offset:53248
    v_mfma_f32_16x16x32_bf16 v[104:107], a[232:235], a[204:207], v[104:107]
    v_readlane_b32 s93, v247, 30
    v_mfma_f32_16x16x32_bf16 v[112:115], a[232:235], a[208:211], v[112:115]
    ds_read_b64_tr_b16 v[140:141], v253 offset:57344
    s_add_u32 m0, s3, 49152
    v_mfma_f32_16x16x32_bf16 v[112:115], a[236:239], a[224:227], v[112:115]
    v_mfma_f32_16x16x32_bf16 v[120:123], a[236:239], a[228:231], v[120:123]
    ds_read_b64_tr_b16 v[142:143], v253 offset:61440
    v_mfma_f32_16x16x32_bf16 v[120:123], a[232:235], a[212:215], v[120:123]
    buffer_load_dwordx4 v244, s[52:55], s93 offen lds
    v_mfma_f32_16x16x32_bf16 v[124:127], a[240:243], a[212:215], v[124:127]
    ds_read_b64_tr_b16 v[144:145], v252 offset:0
    s_add_u32 m0, s3, 51200
    v_mfma_f32_16x16x32_bf16 v[124:127], a[244:247], a[228:231], v[124:127]
    buffer_load_dwordx4 v245, s[52:55], s93 offen lds
    v_mfma_f32_16x16x32_bf16 v[116:119], a[244:247], a[224:227], v[116:119]
    ds_read_b64_tr_b16 v[146:147], v252 offset:4096
    v_mfma_f32_16x16x32_bf16 v[116:119], a[240:243], a[208:211], v[116:119]
    v_readlane_b32 s94, v247, 31
    v_mfma_f32_16x16x32_bf16 v[108:111], a[240:243], a[204:207], v[108:111]
    ds_read_b64_tr_b16 v[148:149], v252 offset:8192
    s_add_u32 m0, s3, 57344
    v_mfma_f32_16x16x32_bf16 v[108:111], a[244:247], a[220:223], v[108:111]
    v_mfma_f32_16x16x32_bf16 v[100:103], a[244:247], a[216:219], v[100:103]
    ds_read_b64_tr_b16 v[150:151], v252 offset:12288
    v_mfma_f32_16x16x32_bf16 v[100:103], a[240:243], a[200:203], v[100:103]
    s_waitcnt vmcnt(43) lgkmcnt(4)
    v_mfma_f32_16x16x32_bf16 v[32:35], v[128:131], a[0:3], v[32:35]
    ds_read_b64_tr_b16 v[152:153], v253 offset:0
    v_mfma_f32_16x16x32_bf16 v[32:35], v[132:135], a[16:19], v[32:35]
    buffer_load_dwordx4 v244, s[52:55], s94 offen lds
    v_mfma_f32_16x16x32_bf16 v[40:43], v[132:135], a[20:23], v[40:43]
    ds_read_b64_tr_b16 v[154:155], v253 offset:4096
    s_add_u32 m0, s3, 59392
    v_mfma_f32_16x16x32_bf16 v[40:43], v[128:131], a[4:7], v[40:43]
    buffer_load_dwordx4 v245, s[52:55], s94 offen lds
    v_mfma_f32_16x16x32_bf16 v[48:51], v[128:131], a[8:11], v[48:51]
    ds_read_b64_tr_b16 v[156:157], v253 offset:8192
    v_mfma_f32_16x16x32_bf16 v[48:51], v[132:135], a[24:27], v[48:51]
    v_readlane_b32 s95, v246, 30
    v_mfma_f32_16x16x32_bf16 v[56:59], v[132:135], a[28:31], v[56:59]
    ds_read_b64_tr_b16 v[158:159], v253 offset:12288
    v_mfma_f32_16x16x32_bf16 v[56:59], v[128:131], a[12:15], v[56:59]
    v_mfma_f32_16x16x32_bf16 v[60:63], v[136:139], a[12:15], v[60:63]
    ds_read_b64_tr_b16 a[232:233], v162 offset:49152
    v_mfma_f32_16x16x32_bf16 v[60:63], v[140:143], a[28:31], v[60:63]
    buffer_load_dwordx4 a[168:171], v240, s[40:43], s95 offen sc1
    v_mfma_f32_16x16x32_bf16 v[52:55], v[140:143], a[24:27], v[52:55]
    ds_read_b64_tr_b16 a[234:235], v162 offset:53248
    v_mfma_f32_16x16x32_bf16 v[52:55], v[136:139], a[8:11], v[52:55]
    buffer_load_dwordx4 a[172:175], v241, s[40:43], s95 offen sc1
    v_mfma_f32_16x16x32_bf16 v[44:47], v[136:139], a[4:7], v[44:47]
    ds_read_b64_tr_b16 a[236:237], v162 offset:57344
    v_mfma_f32_16x16x32_bf16 v[44:47], v[140:143], a[20:23], v[44:47]
    buffer_load_dwordx4 a[176:179], v242, s[40:43], s95 offen sc1
    v_mfma_f32_16x16x32_bf16 v[36:39], v[140:143], a[16:19], v[36:39]
    ds_read_b64_tr_b16 a[238:239], v162 offset:61440
    v_mfma_f32_16x16x32_bf16 v[36:39], v[136:139], a[0:3], v[36:39]
    s_waitcnt vmcnt(40) lgkmcnt(4)
    v_mfma_f32_16x16x32_bf16 v[32:35], v[144:147], a[32:35], v[32:35]
    ds_read_b64_tr_b16 a[240:241], v163 offset:49152
    v_mfma_f32_16x16x32_bf16 v[32:35], v[148:151], a[48:51], v[32:35]
    buffer_load_dwordx4 a[180:183], v243, s[40:43], s95 offen sc1
    v_mfma_f32_16x16x32_bf16 v[40:43], v[148:151], a[52:55], v[40:43]
    ds_read_b64_tr_b16 a[242:243], v163 offset:53248
    v_mfma_f32_16x16x32_bf16 v[40:43], v[144:147], a[36:39], v[40:43]
    v_readlane_b32 s92, v246, 31
    v_mfma_f32_16x16x32_bf16 v[48:51], v[144:147], a[40:43], v[48:51]
    ds_read_b64_tr_b16 a[244:245], v163 offset:57344
    v_mfma_f32_16x16x32_bf16 v[48:51], v[148:151], a[56:59], v[48:51]
    v_mfma_f32_16x16x32_bf16 v[56:59], v[148:151], a[60:63], v[56:59]
    ds_read_b64_tr_b16 a[246:247], v163 offset:61440
    v_mfma_f32_16x16x32_bf16 v[56:59], v[144:147], a[44:47], v[56:59]
    buffer_load_dwordx4 a[184:187], v240, s[40:43], s92 offen sc1
    v_mfma_f32_16x16x32_bf16 v[60:63], v[152:155], a[44:47], v[60:63]
    ds_read_b64_tr_b16 v[128:129], v249 offset:49152
    v_mfma_f32_16x16x32_bf16 v[60:63], v[156:159], a[60:63], v[60:63]
    buffer_load_dwordx4 a[188:191], v241, s[40:43], s92 offen sc1
    v_mfma_f32_16x16x32_bf16 v[52:55], v[156:159], a[56:59], v[52:55]
    ds_read_b64_tr_b16 v[130:131], v249 offset:53248
    v_mfma_f32_16x16x32_bf16 v[52:55], v[152:155], a[40:43], v[52:55]
    buffer_load_dwordx4 a[192:195], v242, s[40:43], s92 offen sc1
    v_mfma_f32_16x16x32_bf16 v[44:47], v[152:155], a[36:39], v[44:47]
    ds_read_b64_tr_b16 v[132:133], v249 offset:57344
    v_mfma_f32_16x16x32_bf16 v[44:47], v[156:159], a[52:55], v[44:47]
    v_mfma_f32_16x16x32_bf16 v[36:39], v[156:159], a[48:51], v[36:39]
    ds_read_b64_tr_b16 v[134:135], v249 offset:61440
    v_mfma_f32_16x16x32_bf16 v[36:39], v[152:155], a[32:35], v[36:39]
    s_waitcnt vmcnt(36) lgkmcnt(4)
    v_mfma_f32_16x16x32_bf16 v[32:35], a[232:235], a[64:67], v[32:35]
    ds_read_b64_tr_b16 v[136:137], v234 offset:49152
    v_mfma_f32_16x16x32_bf16 v[32:35], a[236:239], a[80:83], v[32:35]
    buffer_load_dwordx4 a[196:199], v243, s[40:43], s92 offen sc1
    v_mfma_f32_16x16x32_bf16 v[40:43], a[236:239], a[84:87], v[40:43]
    ds_read_b64_tr_b16 v[138:139], v234 offset:53248
    v_mfma_f32_16x16x32_bf16 v[40:43], a[232:235], a[68:71], v[40:43]
    v_mfma_f32_16x16x32_bf16 v[48:51], a[232:235], a[72:75], v[48:51]
    ds_read_b64_tr_b16 v[140:141], v234 offset:57344
    v_mfma_f32_16x16x32_bf16 v[48:51], a[236:239], a[88:91], v[48:51]
    buffer_load_dwordx2 v[176:177], v228, s[24:27], s88 offen offset:0
    v_mfma_f32_16x16x32_bf16 v[56:59], a[236:239], a[92:95], v[56:59]
    ds_read_b64_tr_b16 v[142:143], v234 offset:61440
    v_mfma_f32_16x16x32_bf16 v[56:59], a[232:235], a[76:79], v[56:59]
    s_waitcnt vmcnt(34)
    s_barrier
    v_mfma_f32_16x16x32_bf16 v[60:63], a[240:243], a[76:79], v[60:63]
    ds_read_b64_tr_b16 v[144:145], v162 offset:0
    v_mfma_f32_16x16x32_bf16 v[60:63], a[244:247], a[92:95], v[60:63]
    v_mfma_f32_16x16x32_bf16 v[52:55], a[244:247], a[88:91], v[52:55]
    ds_read_b64_tr_b16 v[146:147], v162 offset:4096
    v_mfma_f32_16x16x32_bf16 v[52:55], a[240:243], a[72:75], v[52:55]
    v_mfma_f32_16x16x32_bf16 v[44:47], a[240:243], a[68:71], v[44:47]
    ds_read_b64_tr_b16 v[148:149], v162 offset:8192
    v_mfma_f32_16x16x32_bf16 v[44:47], a[244:247], a[84:87], v[44:47]
    buffer_load_dwordx2 v[178:179], v228, s[24:27], s88 offen offset:32
    v_mfma_f32_16x16x32_bf16 v[36:39], a[244:247], a[80:83], v[36:39]
    ds_read_b64_tr_b16 v[150:151], v162 offset:12288
    v_mfma_f32_16x16x32_bf16 v[36:39], a[240:243], a[64:67], v[36:39]
    s_waitcnt lgkmcnt(4)
    v_mfma_f32_16x16x32_bf16 v[64:67], v[128:131], a[0:3], v[64:67]
    ds_read_b64_tr_b16 v[152:153], v163 offset:0
    v_mfma_f32_16x16x32_bf16 v[64:67], v[132:135], a[16:19], v[64:67]
    v_mfma_f32_16x16x32_bf16 v[72:75], v[132:135], a[20:23], v[72:75]
    ds_read_b64_tr_b16 v[154:155], v163 offset:4096
    v_mfma_f32_16x16x32_bf16 v[72:75], v[128:131], a[4:7], v[72:75]
    s_mov_b64 exec, 1
    buffer_store_dword v239, v254, s[44:47], s10 offen offset:768
    buffer_store_dword v239, v254, s[44:47], s10 offen offset:896 sc1
    s_mov_b64 exec, -1
    v_mfma_f32_16x16x32_bf16 v[80:83], v[128:131], a[8:11], v[80:83]
    ds_read_b64_tr_b16 v[156:157], v163 offset:8192
    v_mfma_f32_16x16x32_bf16 v[80:83], v[132:135], a[24:27], v[80:83]
    buffer_load_dwordx2 v[180:181], v228, s[24:27], s89 offen offset:0
    v_mfma_f32_16x16x32_bf16 v[88:91], v[132:135], a[28:31], v[88:91]
    ds_read_b64_tr_b16 v[158:159], v163 offset:12288
    v_mfma_f32_16x16x32_bf16 v[88:91], v[128:131], a[12:15], v[88:91]
    v_mfma_f32_16x16x32_bf16 v[92:95], v[136:139], a[12:15], v[92:95]
    ds_read_b64_tr_b16 a[232:233], v249 offset:0
    v_mfma_f32_16x16x32_bf16 v[92:95], v[140:143], a[28:31], v[92:95]
    v_mfma_f32_16x16x32_bf16 v[84:87], v[140:143], a[24:27], v[84:87]
    ds_read_b64_tr_b16 a[234:235], v249 offset:4096
    v_mfma_f32_16x16x32_bf16 v[84:87], v[136:139], a[8:11], v[84:87]
    buffer_load_dwordx2 v[182:183], v228, s[24:27], s89 offen offset:32
    v_mfma_f32_16x16x32_bf16 v[76:79], v[136:139], a[4:7], v[76:79]
    ds_read_b64_tr_b16 a[236:237], v249 offset:8192
    v_mfma_f32_16x16x32_bf16 v[76:79], v[140:143], a[20:23], v[76:79]
    v_mfma_f32_16x16x32_bf16 v[68:71], v[140:143], a[16:19], v[68:71]
    ds_read_b64_tr_b16 a[238:239], v249 offset:12288
    v_mfma_f32_16x16x32_bf16 v[68:71], v[136:139], a[0:3], v[68:71]
    s_waitcnt vmcnt(30) lgkmcnt(4)
    v_mfma_f32_16x16x32_bf16 v[32:35], v[144:147], a[96:99], v[32:35]
    ds_read_b64_tr_b16 a[240:241], v234 offset:0
    v_mfma_f32_16x16x32_bf16 v[32:35], v[148:151], a[112:115], v[32:35]
    v_mfma_f32_16x16x32_bf16 v[40:43], v[148:151], a[116:119], v[40:43]
    ds_read_b64_tr_b16 a[242:243], v234 offset:4096
    v_mfma_f32_16x16x32_bf16 v[40:43], v[144:147], a[100:103], v[40:43]
    buffer_load_dwordx2 v[184:185], v228, s[24:27], s90 offen offset:0
    v_mfma_f32_16x16x32_bf16 v[48:51], v[144:147], a[104:107], v[48:51]
    ds_read_b64_tr_b16 a[244:245], v234 offset:8192
    v_mfma_f32_16x16x32_bf16 v[48:51], v[148:151], a[120:123], v[48:51]
    v_mfma_f32_16x16x32_bf16 v[56:59], v[148:151], a[124:127], v[56:59]
    ds_read_b64_tr_b16 a[246:247], v234 offset:12288
    v_mfma_f32_16x16x32_bf16 v[56:59], v[144:147], a[108:111], v[56:59]
    v_mfma_f32_16x16x32_bf16 v[60:63], v[152:155], a[108:111], v[60:63]
    ds_read_b64_tr_b16 v[128:129], v164 offset:49152
    v_mfma_f32_16x16x32_bf16 v[60:63], v[156:159], a[124:127], v[60:63]
    v_mfma_f32_16x16x32_bf16 v[52:55], v[156:159], a[120:123], v[52:55]
    ds_read_b64_tr_b16 v[130:131], v164 offset:53248
    v_mfma_f32_16x16x32_bf16 v[52:55], v[152:155], a[104:107], v[52:55]
    buffer_load_dwordx2 v[186:187], v228, s[24:27], s90 offen offset:32
    v_mfma_f32_16x16x32_bf16 v[44:47], v[152:155], a[100:103], v[44:47]
    ds_read_b64_tr_b16 v[132:133], v164 offset:57344
    v_mfma_f32_16x16x32_bf16 v[44:47], v[156:159], a[116:119], v[44:47]
    v_mfma_f32_16x16x32_bf16 v[36:39], v[156:159], a[112:115], v[36:39]
    ds_read_b64_tr_b16 v[134:135], v164 offset:61440
    v_mfma_f32_16x16x32_bf16 v[36:39], v[152:155], a[96:99], v[36:39]
    s_waitcnt lgkmcnt(4)
    v_mfma_f32_16x16x32_bf16 v[64:67], a[232:235], a[32:35], v[64:67]
    ds_read_b64_tr_b16 v[136:137], v165 offset:49152
    v_mfma_f32_16x16x32_bf16 v[64:67], a[236:239], a[48:51], v[64:67]
    buffer_load_dwordx2 v[188:189], v228, s[24:27], s91 offen offset:0
    v_mfma_f32_16x16x32_bf16 v[72:75], a[236:239], a[52:55], v[72:75]
    ds_read_b64_tr_b16 v[138:139], v165 offset:53248
    v_mfma_f32_16x16x32_bf16 v[72:75], a[232:235], a[36:39], v[72:75]
    v_mfma_f32_16x16x32_bf16 v[80:83], a[232:235], a[40:43], v[80:83]
    ds_read_b64_tr_b16 v[140:141], v165 offset:57344
    v_mfma_f32_16x16x32_bf16 v[80:83], a[236:239], a[56:59], v[80:83]
    v_mfma_f32_16x16x32_bf16 v[88:91], a[236:239], a[60:63], v[88:91]
    ds_read_b64_tr_b16 v[142:143], v165 offset:61440
    v_mfma_f32_16x16x32_bf16 v[88:91], a[232:235], a[44:47], v[88:91]
    s_waitcnt vmcnt(29)
    s_barrier
    v_mfma_f32_16x16x32_bf16 v[92:95], a[240:243], a[44:47], v[92:95]
    ds_read_b64_tr_b16 v[144:145], v162 offset:16384
    v_mfma_f32_16x16x32_bf16 v[92:95], a[244:247], a[60:63], v[92:95]
    buffer_load_dwordx2 v[190:191], v228, s[24:27], s91 offen offset:32
    v_mfma_f32_16x16x32_bf16 v[84:87], a[244:247], a[56:59], v[84:87]
    ds_read_b64_tr_b16 v[146:147], v162 offset:20480
    v_mfma_f32_16x16x32_bf16 v[84:87], a[240:243], a[40:43], v[84:87]
    v_mfma_f32_16x16x32_bf16 v[76:79], a[240:243], a[36:39], v[76:79]
    ds_read_b64_tr_b16 v[148:149], v162 offset:24576
    v_mfma_f32_16x16x32_bf16 v[76:79], a[244:247], a[52:55], v[76:79]
    v_mfma_f32_16x16x32_bf16 v[68:71], a[244:247], a[48:51], v[68:71]
    ds_read_b64_tr_b16 v[150:151], v162 offset:28672
    v_mfma_f32_16x16x32_bf16 v[68:71], a[240:243], a[32:35], v[68:71]
    s_waitcnt lgkmcnt(4)
    v_mfma_f32_16x16x32_bf16 v[64:67], v[128:131], a[64:67], v[64:67]
    ds_read_b64_tr_b16 v[152:153], v163 offset:16384
    v_mfma_f32_16x16x32_bf16 v[64:67], v[132:135], a[80:83], v[64:67]
    v_mfma_f32_16x16x32_bf16 v[72:75], v[132:135], a[84:87], v[72:75]
    ds_read_b64_tr_b16 v[154:155], v163 offset:20480
    v_mfma_f32_16x16x32_bf16 v[72:75], v[128:131], a[68:71], v[72:75]
    v_mfma_f32_16x16x32_bf16 v[80:83], v[128:131], a[72:75], v[80:83]
    ds_read_b64_tr_b16 v[156:157], v163 offset:24576
    v_mfma_f32_16x16x32_bf16 v[80:83], v[132:135], a[88:91], v[80:83]
    v_mfma_f32_16x16x32_bf16 v[88:91], v[132:135], a[92:95], v[88:91]
    ds_read_b64_tr_b16 v[158:159], v163 offset:28672
    v_mfma_f32_16x16x32_bf16 v[88:91], v[128:131], a[76:79], v[88:91]
    v_mfma_f32_16x16x32_bf16 v[92:95], v[136:139], a[76:79], v[92:95]
    ds_read_b64_tr_b16 a[232:233], v164 offset:0
    v_mfma_f32_16x16x32_bf16 v[92:95], v[140:143], a[92:95], v[92:95]
    v_mfma_f32_16x16x32_bf16 v[84:87], v[140:143], a[88:91], v[84:87]
    ds_read_b64_tr_b16 a[234:235], v164 offset:4096
    v_mfma_f32_16x16x32_bf16 v[84:87], v[136:139], a[72:75], v[84:87]
    buffer_load_dword v170, v230, s[44:47], s77 offen offset:768 sc1
    v_mfma_f32_16x16x32_bf16 v[76:79], v[136:139], a[68:71], v[76:79]
    ds_read_b64_tr_b16 a[236:237], v164 offset:8192
    v_mfma_f32_16x16x32_bf16 v[76:79], v[140:143], a[84:87], v[76:79]
    v_mfma_f32_16x16x32_bf16 v[68:71], v[140:143], a[80:83], v[68:71]
    ds_read_b64_tr_b16 a[238:239], v164 offset:12288
    v_mfma_f32_16x16x32_bf16 v[68:71], v[136:139], a[64:67], v[68:71]
    s_waitcnt vmcnt(23) lgkmcnt(4)
    v_mfma_f32_16x16x32_bf16 v[32:35], v[144:147], a[136:139], v[32:35]
    ds_read_b64_tr_b16 a[240:241], v165 offset:0
    v_mfma_f32_16x16x32_bf16 v[32:35], v[148:151], a[152:155], v[32:35]
    v_mfma_f32_16x16x32_bf16 v[40:43], v[148:151], a[156:159], v[40:43]
    ds_read_b64_tr_b16 a[242:243], v165 offset:4096
    v_mfma_f32_16x16x32_bf16 v[40:43], v[144:147], a[140:143], v[40:43]
    v_mfma_f32_16x16x32_bf16 v[48:51], v[144:147], a[144:147], v[48:51]
    ds_read_b64_tr_b16 a[244:245], v165 offset:8192
    v_mfma_f32_16x16x32_bf16 v[48:51], v[148:151], a[160:163], v[48:51]
    v_mfma_f32_16x16x32_bf16 v[56:59], v[148:151], a[164:167], v[56:59]
    ds_read_b64_tr_b16 a[246:247], v165 offset:12288
    v_mfma_f32_16x16x32_bf16 v[56:59], v[144:147], a[148:151], v[56:59]
    v_mfma_f32_16x16x32_bf16 v[60:63], v[152:155], a[148:151], v[60:63]
    ds_read_b64_tr_b16 v[128:129], v164 offset:16384
    v_mfma_f32_16x16x32_bf16 v[60:63], v[156:159], a[164:167], v[60:63]
    v_mfma_f32_16x16x32_bf16 v[52:55], v[156:159], a[160:163], v[52:55]
    ds_read_b64_tr_b16 v[130:131], v164 offset:20480
    v_mfma_f32_16x16x32_bf16 v[52:55], v[152:155], a[144:147], v[52:55]
    v_mfma_f32_16x16x32_bf16 v[44:47], v[152:155], a[140:143], v[44:47]
    ds_read_b64_tr_b16 v[132:133], v164 offset:24576
    v_mfma_f32_16x16x32_bf16 v[44:47], v[156:159], a[156:159], v[44:47]
    v_mfma_f32_16x16x32_bf16 v[36:39], v[156:159], a[152:155], v[36:39]
    ds_read_b64_tr_b16 v[134:135], v164 offset:28672
    v_mfma_f32_16x16x32_bf16 v[36:39], v[152:155], a[136:139], v[36:39]
    s_waitcnt lgkmcnt(4)
    v_mfma_f32_16x16x32_bf16 v[64:67], a[232:235], a[96:99], v[64:67]
    ds_read_b64_tr_b16 v[136:137], v165 offset:16384
    v_mfma_f32_16x16x32_bf16 v[64:67], a[236:239], a[112:115], v[64:67]
    v_mfma_f32_16x16x32_bf16 v[72:75], a[236:239], a[116:119], v[72:75]
    ds_read_b64_tr_b16 v[138:139], v165 offset:20480
    v_mfma_f32_16x16x32_bf16 v[72:75], a[232:235], a[100:103], v[72:75]
    v_mfma_f32_16x16x32_bf16 v[80:83], a[232:235], a[104:107], v[80:83]
    ds_read_b64_tr_b16 v[140:141], v165 offset:24576
    v_mfma_f32_16x16x32_bf16 v[80:83], a[236:239], a[120:123], v[80:83]
    v_mfma_f32_16x16x32_bf16 v[88:91], a[236:239], a[124:127], v[88:91]
    ds_read_b64_tr_b16 v[142:143], v165 offset:28672
    v_mfma_f32_16x16x32_bf16 v[88:91], a[232:235], a[108:111], v[88:91]
    s_waitcnt vmcnt(19)
    s_barrier
    v_mfma_f32_16x16x32_bf16 v[92:95], a[240:243], a[108:111], v[92:95]
    ds_read_b64_tr_b16 v[144:145], v162 offset:32768
    v_mfma_f32_16x16x32_bf16 v[92:95], a[244:247], a[124:127], v[92:95]
    v_mfma_f32_16x16x32_bf16 v[84:87], a[244:247], a[120:123], v[84:87]
    ds_read_b64_tr_b16 v[146:147], v162 offset:36864
    v_mfma_f32_16x16x32_bf16 v[84:87], a[240:243], a[104:107], v[84:87]
    v_mfma_f32_16x16x32_bf16 v[76:79], a[240:243], a[100:103], v[76:79]
    ds_read_b64_tr_b16 v[148:149], v162 offset:40960
    v_mfma_f32_16x16x32_bf16 v[76:79], a[244:247], a[116:119], v[76:79]
    v_mfma_f32_16x16x32_bf16 v[68:71], a[244:247], a[112:115], v[68:71]
    ds_read_b64_tr_b16 v[150:151], v162 offset:45056
    v_mfma_f32_16x16x32_bf16 v[68:71], a[240:243], a[96:99], v[68:71]
    s_waitcnt lgkmcnt(4)
    v_mfma_f32_16x16x32_bf16 v[64:67], v[128:131], a[136:139], v[64:67]
    ds_read_b64_tr_b16 v[152:153], v163 offset:32768
    v_mfma_f32_16x16x32_bf16 v[64:67], v[132:135], a[152:155], v[64:67]
    v_mfma_f32_16x16x32_bf16 v[72:75], v[132:135], a[156:159], v[72:75]
    ds_read_b64_tr_b16 v[154:155], v163 offset:36864
    v_mfma_f32_16x16x32_bf16 v[72:75], v[128:131], a[140:143], v[72:75]
    v_mfma_f32_16x16x32_bf16 v[80:83], v[128:131], a[144:147], v[80:83]
    ds_read_b64_tr_b16 v[156:157], v163 offset:40960
    v_mfma_f32_16x16x32_bf16 v[80:83], v[132:135], a[160:163], v[80:83]
    v_mfma_f32_16x16x32_bf16 v[88:91], v[132:135], a[164:167], v[88:91]
    ds_read_b64_tr_b16 v[158:159], v163 offset:45056
    v_mfma_f32_16x16x32_bf16 v[88:91], v[128:131], a[148:151], v[88:91]
    v_mfma_f32_16x16x32_bf16 v[92:95], v[136:139], a[148:151], v[92:95]
    ds_read_b64_tr_b16 a[232:233], v164 offset:32768
    v_mfma_f32_16x16x32_bf16 v[92:95], v[140:143], a[164:167], v[92:95]
    v_mfma_f32_16x16x32_bf16 v[84:87], v[140:143], a[160:163], v[84:87]
    ds_read_b64_tr_b16 a[234:235], v164 offset:36864
    v_mfma_f32_16x16x32_bf16 v[84:87], v[136:139], a[144:147], v[84:87]
    ds_read_b64_tr_b16 a[236:237], v164 offset:40960
    v_mfma_f32_16x16x32_bf16 v[76:79], v[136:139], a[140:143], v[76:79]
    ds_read_b64_tr_b16 a[238:239], v164 offset:45056
    v_mfma_f32_16x16x32_bf16 v[76:79], v[140:143], a[156:159], v[76:79]
    ds_read_b64_tr_b16 a[240:241], v165 offset:32768
    v_mfma_f32_16x16x32_bf16 v[68:71], v[140:143], a[152:155], v[68:71]
    ds_read_b64_tr_b16 a[242:243], v165 offset:36864
    v_mfma_f32_16x16x32_bf16 v[68:71], v[136:139], a[136:139], v[68:71]
    s_waitcnt vmcnt(11) lgkmcnt(6)
    v_mfma_f32_16x16x32_bf16 v[32:35], v[144:147], a[168:171], v[32:35]
    ds_read_b64_tr_b16 a[244:245], v165 offset:40960
    v_mfma_f32_16x16x32_bf16 v[32:35], v[148:151], a[184:187], v[32:35]
    ds_read_b64_tr_b16 a[246:247], v165 offset:45056
    v_mfma_f32_16x16x32_bf16 v[36:39], v[156:159], a[184:187], v[36:39]
    ds_read_b64_tr_b16 v[128:129], v235 offset:49152
    v_mfma_f32_16x16x32_bf16 v[36:39], v[152:155], a[168:171], v[36:39]
    ds_read_b64_tr_b16 v[130:131], v235 offset:53248
    v_mfma_f32_16x16x32_bf16 v[44:47], v[152:155], a[172:175], v[44:47]
    ds_read_b64_tr_b16 v[132:133], v235 offset:57344
    v_mfma_f32_16x16x32_bf16 v[44:47], v[156:159], a[188:191], v[44:47]
    ds_read_b64_tr_b16 v[134:135], v235 offset:61440
    v_mfma_f32_16x16x32_bf16 v[40:43], v[148:151], a[188:191], v[40:43]
    s_waitcnt vmcnt(0)
    v_cmp_eq_u32 s[4:5], v239, v170
    v_mfma_f32_16x16x32_bf16 v[40:43], v[144:147], a[172:175], v[40:43]
    ds_read_b64_tr_b16 v[136:137], v236 offset:49152
    v_mfma_f32_16x16x32_bf16 v[48:51], v[144:147], a[176:179], v[48:51]
    s_or_b32 s4, s4, s5
    s_cmp_eq_u32 s4, -1
    s_cbranch_scc0 L_slow_p410
L_back_p410:
    v_mfma_f32_16x16x32_bf16 v[48:51], v[148:151], a[192:195], v[48:51]
    v_cvt_pk_bf16_f32 v32, v32, v33
    v_cvt_pk_bf16_f32 v33, v34, v35
    v_mfma_f32_16x16x32_bf16 v[52:55], v[156:159], a[192:195], v[52:55]
    v_cvt_pk_bf16_f32 v34, v36, v37
    v_cvt_pk_bf16_f32 v35, v38, v39
    v_or_b32 v32, 1, v32
    v_mfma_f32_16x16x32_bf16 v[52:55], v[152:155], a[176:179], v[52:55]
    buffer_store_dwordx4 v[32:35], v240, s[40:43], s13 offen sc1
    v_mfma_f32_16x16x32_bf16 v[60:63], v[152:155], a[180:183], v[60:63]
    v_cvt_pk_bf16_f32 v40, v40, v41
    v_cvt_pk_bf16_f32 v41, v42, v43
    v_mfma_f32_16x16x32_bf16 v[60:63], v[156:159], a[196:199], v[60:63]
    v_cvt_pk_bf16_f32 v42, v44, v45
    v_cvt_pk_bf16_f32 v43, v46, v47
    v_or_b32 v40, 1, v40
    v_mfma_f32_16x16x32_bf16 v[56:59], v[148:151], a[196:199], v[56:59]
    buffer_store_dwordx4 v[40:43], v241, s[40:43], s13 offen sc1
    v_mfma_f32_16x16x32_bf16 v[56:59], v[144:147], a[180:183], v[56:59]
    s_waitcnt lgkmcnt(5)
    v_mfma_f32_16x16x32_bf16 v[64:67], a[232:235], a[168:171], v[64:67]
    v_cvt_pk_bf16_f32 v48, v48, v49
    v_cvt_pk_bf16_f32 v49, v50, v51
    v_mfma_f32_16x16x32_bf16 v[64:67], a[236:239], a[184:187], v[64:67]
    ds_read_b64_tr_b16 v[138:139], v236 offset:53248
    v_mfma_f32_16x16x32_bf16 v[68:71], a[244:247], a[184:187], v[68:71]
    v_cvt_pk_bf16_f32 v50, v52, v53
    v_cvt_pk_bf16_f32 v51, v54, v55
    v_or_b32 v48, 1, v48
    v_mfma_f32_16x16x32_bf16 v[68:71], a[240:243], a[168:171], v[68:71]
    ds_read_b64_tr_b16 v[140:141], v236 offset:57344
    v_mfma_f32_16x16x32_bf16 v[76:79], a[240:243], a[172:175], v[76:79]
    ds_read_b64_tr_b16 v[142:143], v236 offset:61440
    v_mfma_f32_16x16x32_bf16 v[76:79], a[244:247], a[188:191], v[76:79]
    buffer_store_dwordx4 v[48:51], v242, s[40:43], s13 offen sc1
    v_mfma_f32_16x16x32_bf16 v[72:75], a[236:239], a[188:191], v[72:75]
    v_cvt_pk_bf16_f32 v56, v56, v57
    v_cvt_pk_bf16_f32 v57, v58, v59
    v_mfma_f32_16x16x32_bf16 v[72:75], a[232:235], a[172:175], v[72:75]
    ds_read_b64_tr_b16 v[144:145], v235 offset:0
    v_mfma_f32_16x16x32_bf16 v[80:83], a[232:235], a[176:179], v[80:83]
    v_cvt_pk_bf16_f32 v58, v60, v61
    v_cvt_pk_bf16_f32 v59, v62, v63
    v_or_b32 v56, 1, v56
    v_mfma_f32_16x16x32_bf16 v[80:83], a[236:239], a[192:195], v[80:83]
    ds_read_b64_tr_b16 v[146:147], v235 offset:4096
    v_mfma_f32_16x16x32_bf16 v[84:87], a[244:247], a[192:195], v[84:87]
    ds_read_b64_tr_b16 v[148:149], v235 offset:8192
    v_mfma_f32_16x16x32_bf16 v[84:87], a[240:243], a[176:179], v[84:87]
    buffer_store_dwordx4 v[56:59], v243, s[40:43], s13 offen sc1
    v_mfma_f32_16x16x32_bf16 v[92:95], a[240:243], a[180:183], v[92:95]
    v_cvt_pk_bf16_f32 v64, v64, v65
    v_cvt_pk_bf16_f32 v65, v66, v67
    v_mfma_f32_16x16x32_bf16 v[92:95], a[244:247], a[196:199], v[92:95]
    ds_read_b64_tr_b16 v[150:151], v235 offset:12288
    v_mfma_f32_16x16x32_bf16 v[88:91], a[236:239], a[196:199], v[88:91]
    v_cvt_pk_bf16_f32 v66, v68, v69
    v_cvt_pk_bf16_f32 v67, v70, v71
    v_or_b32 v64, 1, v64
    v_mfma_f32_16x16x32_bf16 v[88:91], a[232:235], a[180:183], v[88:91]
    s_waitcnt lgkmcnt(4)
    v_mfma_f32_16x16x32_bf16 v[96:99], v[128:131], a[0:3], v[96:99]
    ds_read_b64_tr_b16 v[152:153], v236 offset:0
    v_mfma_f32_16x16x32_bf16 v[96:99], v[132:135], a[16:19], v[96:99]
    v_mfma_f32_16x16x32_bf16 v[104:107], v[132:135], a[20:23], v[104:107]
    ds_read_b64_tr_b16 v[154:155], v236 offset:4096
    v_mfma_f32_16x16x32_bf16 v[104:107], v[128:131], a[4:7], v[104:107]
    buffer_store_dwordx4 v[64:67], v240, s[40:43], s14 offen sc1
    v_mfma_f32_16x16x32_bf16 v[112:115], v[128:131], a[8:11], v[112:115]
    ds_read_b64_tr_b16 v[156:157], v236 offset:8192
    v_mfma_f32_16x16x32_bf16 v[112:115], v[132:135], a[24:27], v[112:115]
    v_cvt_pk_bf16_f32 v72, v72, v73
    v_cvt_pk_bf16_f32 v73, v74, v75
    v_mfma_f32_16x16x32_bf16 v[120:123], v[132:135], a[28:31], v[120:123]
    ds_read_b64_tr_b16 v[158:159], v236 offset:12288
    v_mfma_f32_16x16x32_bf16 v[120:123], v[128:131], a[12:15], v[120:123]
    v_cvt_pk_bf16_f32 v74, v76, v77
    v_cvt_pk_bf16_f32 v75, v78, v79
    v_or_b32 v72, 1, v72
    v_mfma_f32_16x16x32_bf16 v[124:127], v[136:139], a[12:15], v[124:127]
    ds_read_b64_tr_b16 a[232:233], v166 offset:49152
    v_mfma_f32_16x16x32_bf16 v[124:127], v[140:143], a[28:31], v[124:127]
    buffer_store_dwordx4 v[72:75], v241, s[40:43], s14 offen sc1
    v_mfma_f32_16x16x32_bf16 v[116:119], v[140:143], a[24:27], v[116:119]
    ds_read_b64_tr_b16 a[234:235], v166 offset:53248
    v_mfma_f32_16x16x32_bf16 v[116:119], v[136:139], a[8:11], v[116:119]
    v_cvt_pk_bf16_f32 v80, v80, v81
    v_cvt_pk_bf16_f32 v81, v82, v83
    v_mfma_f32_16x16x32_bf16 v[108:111], v[136:139], a[4:7], v[108:111]
    ds_read_b64_tr_b16 a[236:237], v166 offset:57344
    v_mfma_f32_16x16x32_bf16 v[108:111], v[140:143], a[20:23], v[108:111]
    v_cvt_pk_bf16_f32 v82, v84, v85
    v_cvt_pk_bf16_f32 v83, v86, v87
    v_or_b32 v80, 1, v80
    v_mfma_f32_16x16x32_bf16 v[100:103], v[140:143], a[16:19], v[100:103]
    ds_read_b64_tr_b16 a[238:239], v166 offset:61440
    v_mfma_f32_16x16x32_bf16 v[100:103], v[136:139], a[0:3], v[100:103]
    s_waitcnt lgkmcnt(4)
    v_mfma_f32_16x16x32_bf16 v[96:99], v[144:147], a[32:35], v[96:99]
    ds_read_b64_tr_b16 a[240:241], v167 offset:49152
    v_mfma_f32_16x16x32_bf16 v[96:99], v[148:151], a[48:51], v[96:99]
    buffer_store_dwordx4 v[80:83], v242, s[40:43], s14 offen sc1
    v_mfma_f32_16x16x32_bf16 v[104:107], v[148:151], a[52:55], v[104:107]
    ds_read_b64_tr_b16 a[242:243], v167 offset:53248
    v_mfma_f32_16x16x32_bf16 v[104:107], v[144:147], a[36:39], v[104:107]
    v_cvt_pk_bf16_f32 v88, v88, v89
    v_cvt_pk_bf16_f32 v89, v90, v91
    v_mfma_f32_16x16x32_bf16 v[112:115], v[144:147], a[40:43], v[112:115]
    ds_read_b64_tr_b16 a[244:245], v167 offset:57344
    v_mfma_f32_16x16x32_bf16 v[112:115], v[148:151], a[56:59], v[112:115]
    v_cvt_pk_bf16_f32 v90, v92, v93
    v_cvt_pk_bf16_f32 v91, v94, v95
    v_or_b32 v88, 1, v88
    v_mfma_f32_16x16x32_bf16 v[120:123], v[148:151], a[60:63], v[120:123]
    ds_read_b64_tr_b16 a[246:247], v167 offset:61440
    v_mfma_f32_16x16x32_bf16 v[120:123], v[144:147], a[44:47], v[120:123]
    buffer_store_dwordx4 v[88:91], v243, s[40:43], s14 offen sc1
    v_mfma_f32_16x16x32_bf16 v[124:127], v[152:155], a[44:47], v[124:127]
    ds_read_b64_tr_b16 v[128:129], v166 offset:0
    v_mfma_f32_16x16x32_bf16 v[124:127], v[156:159], a[60:63], v[124:127]
    v_mfma_f32_16x16x32_bf16 v[116:119], v[156:159], a[56:59], v[116:119]
    ds_read_b64_tr_b16 v[130:131], v166 offset:4096
    v_mfma_f32_16x16x32_bf16 v[116:119], v[152:155], a[40:43], v[116:119]
    v_mfma_f32_16x16x32_bf16 v[108:111], v[152:155], a[36:39], v[108:111]
    ds_read_b64_tr_b16 v[132:133], v166 offset:8192
    v_mfma_f32_16x16x32_bf16 v[108:111], v[156:159], a[52:55], v[108:111]
    v_mfma_f32_16x16x32_bf16 v[100:103], v[156:159], a[48:51], v[100:103]
    ds_read_b64_tr_b16 v[134:135], v166 offset:12288
    v_mfma_f32_16x16x32_bf16 v[100:103], v[152:155], a[32:35], v[100:103]
    s_waitcnt lgkmcnt(4)
    v_mfma_f32_16x16x32_bf16 v[96:99], a[232:235], a[64:67], v[96:99]
    ds_read_b64_tr_b16 v[136:137], v167 offset:0
    v_mfma_f32_16x16x32_bf16 v[96:99], a[236:239], a[80:83], v[96:99]
    v_mfma_f32_16x16x32_bf16 v[104:107], a[236:239], a[84:87], v[104:107]
    ds_read_b64_tr_b16 v[138:139], v167 offset:4096
    v_mfma_f32_16x16x32_bf16 v[104:107], a[232:235], a[68:71], v[104:107]
    v_mfma_f32_16x16x32_bf16 v[112:115], a[232:235], a[72:75], v[112:115]
    ds_read_b64_tr_b16 v[140:141], v167 offset:8192
    v_mfma_f32_16x16x32_bf16 v[112:115], a[236:239], a[88:91], v[112:115]
    v_mfma_f32_16x16x32_bf16 v[120:123], a[236:239], a[92:95], v[120:123]
    ds_read_b64_tr_b16 v[142:143], v167 offset:12288
    v_mfma_f32_16x16x32_bf16 v[120:123], a[232:235], a[76:79], v[120:123]
    v_mfma_f32_16x16x32_bf16 v[124:127], a[240:243], a[76:79], v[124:127]
    ds_read_b64_tr_b16 v[144:145], v166 offset:16384
    v_mfma_f32_16x16x32_bf16 v[124:127], a[244:247], a[92:95], v[124:127]
    v_mfma_f32_16x16x32_bf16 v[116:119], a[244:247], a[88:91], v[116:119]
    ds_read_b64_tr_b16 v[146:147], v166 offset:20480
    v_mfma_f32_16x16x32_bf16 v[116:119], a[240:243], a[72:75], v[116:119]
    v_mfma_f32_16x16x32_bf16 v[108:111], a[240:243], a[68:71], v[108:111]
    ds_read_b64_tr_b16 v[148:149], v166 offset:24576
    v_mfma_f32_16x16x32_bf16 v[108:111], a[244:247], a[84:87], v[108:111]
    v_mfma_f32_16x16x32_bf16 v[100:103], a[244:247], a[80:83], v[100:103]
    ds_read_b64_tr_b16 v[150:151], v166 offset:28672
    v_mfma_f32_16x16x32_bf16 v[100:103], a[240:243], a[64:67], v[100:103]
    s_waitcnt lgkmcnt(4)
    v_mfma_f32_16x16x32_bf16 v[96:99], v[128:131], a[96:99], v[96:99]
    ds_read_b64_tr_b16 v[152:153], v167 offset:16384
    v_mfma_f32_16x16x32_bf16 v[96:99], v[132:135], a[112:115], v[96:99]
    v_mfma_f32_16x16x32_bf16 v[104:107], v[132:135], a[116:119], v[104:107]
    ds_read_b64_tr_b16 v[154:155], v167 offset:20480
    v_mfma_f32_16x16x32_bf16 v[104:107], v[128:131], a[100:103], v[104:107]
    v_mfma_f32_16x16x32_bf16 v[112:115], v[128:131], a[104:107], v[112:115]
    ds_read_b64_tr_b16 v[156:157], v167 offset:24576
    v_mfma_f32_16x16x32_bf16 v[112:115], v[132:135], a[120:123], v[112:115]
    v_mfma_f32_16x16x32_bf16 v[120:123], v[132:135], a[124:127], v[120:123]
    ds_read_b64_tr_b16 v[158:159], v167 offset:28672
    v_mfma_f32_16x16x32_bf16 v[120:123], v[128:131], a[108:111], v[120:123]
    v_mfma_f32_16x16x32_bf16 v[124:127], v[136:139], a[108:111], v[124:127]
    ds_read_b64_tr_b16 a[232:233], v166 offset:32768
    v_mfma_f32_16x16x32_bf16 v[124:127], v[140:143], a[124:127], v[124:127]
    v_mfma_f32_16x16x32_bf16 v[116:119], v[140:143], a[120:123], v[116:119]
    ds_read_b64_tr_b16 a[234:235], v166 offset:36864
    v_mfma_f32_16x16x32_bf16 v[116:119], v[136:139], a[104:107], v[116:119]
    v_mfma_f32_16x16x32_bf16 v[108:111], v[136:139], a[100:103], v[108:111]
    ds_read_b64_tr_b16 a[236:237], v166 offset:40960
    v_mfma_f32_16x16x32_bf16 v[108:111], v[140:143], a[116:119], v[108:111]
    v_mfma_f32_16x16x32_bf16 v[100:103], v[140:143], a[112:115], v[100:103]
    ds_read_b64_tr_b16 a[238:239], v166 offset:45056
    v_mfma_f32_16x16x32_bf16 v[100:103], v[136:139], a[96:99], v[100:103]
    s_waitcnt lgkmcnt(4)
    v_mfma_f32_16x16x32_bf16 v[96:99], v[144:147], a[136:139], v[96:99]
    ds_read_b64_tr_b16 a[240:241], v167 offset:32768
    v_mfma_f32_16x16x32_bf16 v[96:99], v[148:151], a[152:155], v[96:99]
    v_mfma_f32_16x16x32_bf16 v[104:107], v[148:151], a[156:159], v[104:107]
    ds_read_b64_tr_b16 a[242:243], v167 offset:36864
    v_mfma_f32_16x16x32_bf16 v[104:107], v[144:147], a[140:143], v[104:107]
    v_mfma_f32_16x16x32_bf16 v[112:115], v[144:147], a[144:147], v[112:115]
    ds_read_b64_tr_b16 a[244:245], v167 offset:40960
    v_mfma_f32_16x16x32_bf16 v[112:115], v[148:151], a[160:163], v[112:115]
    v_mfma_f32_16x16x32_bf16 v[120:123], v[148:151], a[164:167], v[120:123]
    ds_read_b64_tr_b16 a[246:247], v167 offset:45056
    v_mfma_f32_16x16x32_bf16 v[120:123], v[144:147], a[148:151], v[120:123]
    v_mfma_f32_16x16x32_bf16 v[124:127], v[152:155], a[148:151], v[124:127]
    ds_read_b64_tr_b16 v[128:129], v250 offset:49152
    v_mfma_f32_16x16x32_bf16 v[124:127], v[156:159], a[164:167], v[124:127]
    v_mfma_f32_16x16x32_bf16 v[116:119], v[156:159], a[160:163], v[116:119]
    ds_read_b64_tr_b16 v[130:131], v250 offset:53248
    v_mfma_f32_16x16x32_bf16 v[116:119], v[152:155], a[144:147], v[116:119]
    v_mfma_f32_16x16x32_bf16 v[108:111], v[152:155], a[140:143], v[108:111]
    ds_read_b64_tr_b16 v[132:133], v250 offset:57344
    v_mfma_f32_16x16x32_bf16 v[108:111], v[156:159], a[156:159], v[108:111]
    v_mfma_f32_16x16x32_bf16 v[100:103], v[156:159], a[152:155], v[100:103]
    ds_read_b64_tr_b16 v[134:135], v250 offset:61440
    v_mfma_f32_16x16x32_bf16 v[100:103], v[152:155], a[136:139], v[100:103]
    s_waitcnt lgkmcnt(4)
    v_mfma_f32_16x16x32_bf16 v[96:99], a[232:235], a[168:171], v[96:99]
    ds_read_b64_tr_b16 v[136:137], v251 offset:49152
    v_mfma_f32_16x16x32_bf16 v[96:99], a[236:239], a[184:187], v[96:99]
    v_mfma_f32_16x16x32_bf16 v[100:103], a[244:247], a[184:187], v[100:103]
    ds_read_b64_tr_b16 v[138:139], v251 offset:53248
    v_mfma_f32_16x16x32_bf16 v[100:103], a[240:243], a[168:171], v[100:103]
    v_mfma_f32_16x16x32_bf16 v[108:111], a[240:243], a[172:175], v[108:111]
    ds_read_b64_tr_b16 v[140:141], v251 offset:57344
    v_mfma_f32_16x16x32_bf16 v[108:111], a[244:247], a[188:191], v[108:111]
    v_mfma_f32_16x16x32_bf16 v[104:107], a[236:239], a[188:191], v[104:107]
    ds_read_b64_tr_b16 v[142:143], v251 offset:61440
    v_mfma_f32_16x16x32_bf16 v[104:107], a[232:235], a[172:175], v[104:107]
    v_cvt_pk_bf16_f32 v96, v96, v97
    v_cvt_pk_bf16_f32 v97, v98, v99
    v_mfma_f32_16x16x32_bf16 v[112:115], a[232:235], a[176:179], v[112:115]
    v_cvt_pk_bf16_f32 v98, v100, v101
    v_cvt_pk_bf16_f32 v99, v102, v103
    v_or_b32 v96, 1, v96
    v_mfma_f32_16x16x32_bf16 v[112:115], a[236:239], a[192:195], v[112:115]
    ds_read_b64_tr_b16 v[144:145], v250 offset:0
    v_mfma_f32_16x16x32_bf16 v[116:119], a[244:247], a[192:195], v[116:119]
    buffer_store_dwordx4 v[96:99], v240, s[40:43], s15 offen sc1
    v_mfma_f32_16x16x32_bf16 v[116:119], a[240:243], a[176:179], v[116:119]
    ds_read_b64_tr_b16 v[146:147], v250 offset:4096
    v_mfma_f32_16x16x32_bf16 v[124:127], a[240:243], a[180:183], v[124:127]
    v_cvt_pk_bf16_f32 v104, v104, v105
    v_cvt_pk_bf16_f32 v105, v106, v107
    v_mfma_f32_16x16x32_bf16 v[124:127], a[244:247], a[196:199], v[124:127]
    v_cvt_pk_bf16_f32 v106, v108, v109
    v_cvt_pk_bf16_f32 v107, v110, v111
    v_or_b32 v104, 1, v104
    v_mfma_f32_16x16x32_bf16 v[120:123], a[236:239], a[196:199], v[120:123]
    ds_read_b64_tr_b16 v[148:149], v250 offset:8192
    v_mfma_f32_16x16x32_bf16 v[120:123], a[232:235], a[180:183], v[120:123]
    s_waitcnt lgkmcnt(3)
    v_mfma_f32_16x16x32_bf16 v[0:3], v[128:131], a[0:3], v[0:3]
    buffer_store_dwordx4 v[104:107], v241, s[40:43], s15 offen sc1
    v_mfma_f32_16x16x32_bf16 v[0:3], v[132:135], a[16:19], v[0:3]
    ds_read_b64_tr_b16 v[150:151], v250 offset:12288
    v_mfma_f32_16x16x32_bf16 v[8:11], v[132:135], a[20:23], v[8:11]
    v_cvt_pk_bf16_f32 v112, v112, v113
    v_cvt_pk_bf16_f32 v113, v114, v115
    v_mfma_f32_16x16x32_bf16 v[8:11], v[128:131], a[4:7], v[8:11]
    v_cvt_pk_bf16_f32 v114, v116, v117
    v_cvt_pk_bf16_f32 v115, v118, v119
    v_or_b32 v112, 1, v112
    v_mfma_f32_16x16x32_bf16 v[16:19], v[128:131], a[8:11], v[16:19]
    ds_read_b64_tr_b16 v[152:153], v251 offset:0
    v_mfma_f32_16x16x32_bf16 v[16:19], v[132:135], a[24:27], v[16:19]
    buffer_store_dwordx4 v[112:115], v242, s[40:43], s15 offen sc1
    v_mfma_f32_16x16x32_bf16 v[24:27], v[132:135], a[28:31], v[24:27]
    ds_read_b64_tr_b16 v[154:155], v251 offset:4096
    v_mfma_f32_16x16x32_bf16 v[24:27], v[128:131], a[12:15], v[24:27]
    v_cvt_pk_bf16_f32 v120, v120, v121
    v_cvt_pk_bf16_f32 v121, v122, v123
    v_mfma_f32_16x16x32_bf16 v[28:31], v[136:139], a[12:15], v[28:31]
    v_cvt_pk_bf16_f32 v122, v124, v125
    v_cvt_pk_bf16_f32 v123, v126, v127
    v_or_b32 v120, 1, v120
    v_mfma_f32_16x16x32_bf16 v[28:31], v[140:143], a[28:31], v[28:31]
    ds_read_b64_tr_b16 v[156:157], v251 offset:8192
    v_mfma_f32_16x16x32_bf16 v[20:23], v[140:143], a[24:27], v[20:23]
    buffer_store_dwordx4 v[120:123], v243, s[40:43], s15 offen sc1
    v_mfma_f32_16x16x32_bf16 v[20:23], v[136:139], a[8:11], v[20:23]
    ds_read_b64_tr_b16 v[158:159], v251 offset:12288
    v_mfma_f32_16x16x32_bf16 v[12:15], v[136:139], a[4:7], v[12:15]
    ds_read_b64_tr_b16 a[232:233], v160 offset:49152
    v_mfma_f32_16x16x32_bf16 v[12:15], v[140:143], a[20:23], v[12:15]
    ds_read_b64_tr_b16 a[234:235], v160 offset:53248
    v_mfma_f32_16x16x32_bf16 v[4:7], v[140:143], a[16:19], v[4:7]
    ds_read_b64_tr_b16 a[236:237], v160 offset:57344
    v_mfma_f32_16x16x32_bf16 v[4:7], v[136:139], a[0:3], v[4:7]
    s_waitcnt lgkmcnt(3)
    v_mfma_f32_16x16x32_bf16 v[0:3], v[144:147], a[32:35], v[0:3]
    ds_read_b64_tr_b16 a[238:239], v160 offset:61440
    v_mfma_f32_16x16x32_bf16 v[0:3], v[148:151], a[48:51], v[0:3]
    ds_read_b64_tr_b16 a[240:241], v161 offset:49152
    v_mfma_f32_16x16x32_bf16 v[8:11], v[148:151], a[52:55], v[8:11]
    ds_read_b64_tr_b16 a[242:243], v161 offset:53248
    v_mfma_f32_16x16x32_bf16 v[8:11], v[144:147], a[36:39], v[8:11]
    v_mfma_f32_16x16x32_bf16 v[16:19], v[144:147], a[40:43], v[16:19]
    ds_read_b64_tr_b16 a[244:245], v161 offset:57344
    v_mfma_f32_16x16x32_bf16 v[16:19], v[148:151], a[56:59], v[16:19]
    v_mfma_f32_16x16x32_bf16 v[24:27], v[148:151], a[60:63], v[24:27]
    ds_read_b64_tr_b16 a[246:247], v161 offset:61440
    v_mfma_f32_16x16x32_bf16 v[24:27], v[144:147], a[44:47], v[24:27]
    v_mfma_f32_16x16x32_bf16 v[28:31], v[152:155], a[44:47], v[28:31]
    ds_read_b64_tr_b16 v[128:129], v160 offset:0
    v_mfma_f32_16x16x32_bf16 v[28:31], v[156:159], a[60:63], v[28:31]
    v_mfma_f32_16x16x32_bf16 v[20:23], v[156:159], a[56:59], v[20:23]
    ds_read_b64_tr_b16 v[130:131], v160 offset:4096
    v_mfma_f32_16x16x32_bf16 v[20:23], v[152:155], a[40:43], v[20:23]
    v_mfma_f32_16x16x32_bf16 v[12:15], v[152:155], a[36:39], v[12:15]
    ds_read_b64_tr_b16 v[132:133], v160 offset:8192
    v_mfma_f32_16x16x32_bf16 v[12:15], v[156:159], a[52:55], v[12:15]
    v_mfma_f32_16x16x32_bf16 v[4:7], v[156:159], a[48:51], v[4:7]
    ds_read_b64_tr_b16 v[134:135], v160 offset:12288
    v_mfma_f32_16x16x32_bf16 v[4:7], v[152:155], a[32:35], v[4:7]
    s_waitcnt lgkmcnt(4)
    v_mfma_f32_16x16x32_bf16 v[0:3], a[232:235], a[64:67], v[0:3]
    ds_read_b64_tr_b16 v[136:137], v161 offset:0
    v_mfma_f32_16x16x32_bf16 v[0:3], a[236:239], a[80:83], v[0:3]
    v_mfma_f32_16x16x32_bf16 v[8:11], a[236:239], a[84:87], v[8:11]
    ds_read_b64_tr_b16 v[138:139], v161 offset:4096
    v_mfma_f32_16x16x32_bf16 v[8:11], a[232:235], a[68:71], v[8:11]
    v_mfma_f32_16x16x32_bf16 v[16:19], a[232:235], a[72:75], v[16:19]
    ds_read_b64_tr_b16 v[140:141], v161 offset:8192
    v_mfma_f32_16x16x32_bf16 v[16:19], a[236:239], a[88:91], v[16:19]
    v_mfma_f32_16x16x32_bf16 v[24:27], a[236:239], a[92:95], v[24:27]
    ds_read_b64_tr_b16 v[142:143], v161 offset:12288
    v_mfma_f32_16x16x32_bf16 v[24:27], a[232:235], a[76:79], v[24:27]
    v_mfma_f32_16x16x32_bf16 v[28:31], a[240:243], a[76:79], v[28:31]
    ds_read_b64_tr_b16 v[144:145], v160 offset:16384
    v_mfma_f32_16x16x32_bf16 v[28:31], a[244:247], a[92:95], v[28:31]
    v_mfma_f32_16x16x32_bf16 v[20:23], a[244:247], a[88:91], v[20:23]
    ds_read_b64_tr_b16 v[146:147], v160 offset:20480
    v_mfma_f32_16x16x32_bf16 v[20:23], a[240:243], a[72:75], v[20:23]
    v_mfma_f32_16x16x32_bf16 v[12:15], a[240:243], a[68:71], v[12:15]
    ds_read_b64_tr_b16 v[148:149], v160 offset:24576
    v_mfma_f32_16x16x32_bf16 v[12:15], a[244:247], a[84:87], v[12:15]
    v_mfma_f32_16x16x32_bf16 v[4:7], a[244:247], a[80:83], v[4:7]
    ds_read_b64_tr_b16 v[150:151], v160 offset:28672
    v_mfma_f32_16x16x32_bf16 v[4:7], a[240:243], a[64:67], v[4:7]
    s_waitcnt lgkmcnt(4)
    v_mfma_f32_16x16x32_bf16 v[0:3], v[128:131], a[96:99], v[0:3]
    ds_read_b64_tr_b16 v[152:153], v161 offset:16384
    v_mfma_f32_16x16x32_bf16 v[0:3], v[132:135], a[112:115], v[0:3]
    v_mfma_f32_16x16x32_bf16 v[8:11], v[132:135], a[116:119], v[8:11]
    ds_read_b64_tr_b16 v[154:155], v161 offset:20480
    v_mfma_f32_16x16x32_bf16 v[8:11], v[128:131], a[100:103], v[8:11]
    v_mfma_f32_16x16x32_bf16 v[16:19], v[128:131], a[104:107], v[16:19]
    ds_read_b64_tr_b16 v[156:157], v161 offset:24576
    v_mfma_f32_16x16x32_bf16 v[16:19], v[132:135], a[120:123], v[16:19]
    v_mfma_f32_16x16x32_bf16 v[24:27], v[132:135], a[124:127], v[24:27]
    ds_read_b64_tr_b16 v[158:159], v161 offset:28672
    v_mfma_f32_16x16x32_bf16 v[24:27], v[128:131], a[108:111], v[24:27]
    v_mfma_f32_16x16x32_bf16 v[28:31], v[136:139], a[108:111], v[28:31]
    ds_read_b64_tr_b16 a[232:233], v160 offset:32768
    v_mfma_f32_16x16x32_bf16 v[28:31], v[140:143], a[124:127], v[28:31]
    v_mfma_f32_16x16x32_bf16 v[20:23], v[140:143], a[120:123], v[20:23]
    ds_read_b64_tr_b16 a[234:235], v160 offset:36864
    v_mfma_f32_16x16x32_bf16 v[20:23], v[136:139], a[104:107], v[20:23]
    v_mfma_f32_16x16x32_bf16 v[12:15], v[136:139], a[100:103], v[12:15]
    ds_read_b64_tr_b16 a[236:237], v160 offset:40960
    v_mfma_f32_16x16x32_bf16 v[12:15], v[140:143], a[116:119], v[12:15]
    v_mfma_f32_16x16x32_bf16 v[4:7], v[140:143], a[112:115], v[4:7]
    ds_read_b64_tr_b16 a[238:239], v160 offset:45056
    v_mfma_f32_16x16x32_bf16 v[4:7], v[136:139], a[96:99], v[4:7]
    s_waitcnt lgkmcnt(4)
    v_mfma_f32_16x16x32_bf16 v[0:3], v[144:147], a[136:139], v[0:3]
    ds_read_b64_tr_b16 a[240:241], v161 offset:32768
    v_mfma_f32_16x16x32_bf16 v[0:3], v[148:151], a[152:155], v[0:3]
    v_mfma_f32_16x16x32_bf16 v[8:11], v[148:151], a[156:159], v[8:11]
    ds_read_b64_tr_b16 a[242:243], v161 offset:36864
    v_mfma_f32_16x16x32_bf16 v[8:11], v[144:147], a[140:143], v[8:11]
    v_mfma_f32_16x16x32_bf16 v[16:19], v[144:147], a[144:147], v[16:19]
    ds_read_b64_tr_b16 a[244:245], v161 offset:40960
    v_mfma_f32_16x16x32_bf16 v[16:19], v[148:151], a[160:163], v[16:19]
    v_mfma_f32_16x16x32_bf16 v[24:27], v[148:151], a[164:167], v[24:27]
    ds_read_b64_tr_b16 a[246:247], v161 offset:45056
    v_mfma_f32_16x16x32_bf16 v[24:27], v[144:147], a[148:151], v[24:27]
    v_mfma_f32_16x16x32_bf16 v[28:31], v[152:155], a[148:151], v[28:31]
    v_mfma_f32_16x16x32_bf16 v[28:31], v[156:159], a[164:167], v[28:31]
    v_mfma_f32_16x16x32_bf16 v[20:23], v[156:159], a[160:163], v[20:23]
    v_mfma_f32_16x16x32_bf16 v[20:23], v[152:155], a[144:147], v[20:23]
    v_mfma_f32_16x16x32_bf16 v[12:15], v[152:155], a[140:143], v[12:15]
    v_mfma_f32_16x16x32_bf16 v[12:15], v[156:159], a[156:159], v[12:15]
    v_mfma_f32_16x16x32_bf16 v[4:7], v[156:159], a[152:155], v[4:7]
    v_mfma_f32_16x16x32_bf16 v[4:7], v[152:155], a[136:139], v[4:7]
    s_waitcnt lgkmcnt(0)
    v_mfma_f32_16x16x32_bf16 v[0:3], a[232:235], a[168:171], v[0:3]
    buffer_load_dwordx4 v[192:195], v240, s[40:43], s82 offen sc1
    v_mfma_f32_16x16x32_bf16 v[0:3], a[236:239], a[184:187], v[0:3]
    v_mfma_f32_16x16x32_bf16 v[4:7], a[244:247], a[184:187], v[4:7]
    buffer_load_dwordx4 v[196:199], v241, s[40:43], s82 offen sc1
    v_mfma_f32_16x16x32_bf16 v[4:7], a[240:243], a[168:171], v[4:7]
    v_mfma_f32_16x16x32_bf16 v[12:15], a[240:243], a[172:175], v[12:15]
    buffer_load_dwordx4 v[200:203], v242, s[40:43], s82 offen sc1
    v_mfma_f32_16x16x32_bf16 v[12:15], a[244:247], a[188:191], v[12:15]
    v_mfma_f32_16x16x32_bf16 v[8:11], a[236:239], a[188:191], v[8:11]
    buffer_load_dwordx4 v[204:207], v243, s[40:43], s82 offen sc1
    v_mfma_f32_16x16x32_bf16 v[8:11], a[232:235], a[172:175], v[8:11]
    v_mfma_f32_16x16x32_bf16 v[16:19], a[232:235], a[176:179], v[16:19]
    v_mfma_f32_16x16x32_bf16 v[16:19], a[236:239], a[192:195], v[16:19]
    v_mfma_f32_16x16x32_bf16 v[20:23], a[244:247], a[192:195], v[20:23]
    v_mfma_f32_16x16x32_bf16 v[20:23], a[240:243], a[176:179], v[20:23]
    v_mfma_f32_16x16x32_bf16 v[28:31], a[240:243], a[180:183], v[28:31]
    v_mfma_f32_16x16x32_bf16 v[28:31], a[244:247], a[196:199], v[28:31]
    v_mfma_f32_16x16x32_bf16 v[24:27], a[236:239], a[196:199], v[24:27]
    v_mfma_f32_16x16x32_bf16 v[24:27], a[232:235], a[180:183], v[24:27]
    s_branch L_g2_fin
L_eg11:
    s_waitcnt vmcnt(34)
    s_barrier
    v_mfma_f32_16x16x32_bf16 v[92:95], a[240:243], a[12:15], v[92:95]
    ds_read_b64_tr_b16 v[144:145], v252 offset:0
    v_mfma_f32_16x16x32_bf16 v[92:95], a[244:247], a[28:31], v[92:95]
    buffer_load_dwordx4 v245, s[48:51], s93 offen lds
    v_mfma_f32_16x16x32_bf16 v[84:87], a[244:247], a[24:27], v[84:87]
    ds_read_b64_tr_b16 v[146:147], v252 offset:4096
    v_mfma_f32_16x16x32_bf16 v[84:87], a[240:243], a[8:11], v[84:87]
    v_readlane_b32 s94, v247, 33
    v_mfma_f32_16x16x32_bf16 v[76:79], a[240:243], a[4:7], v[76:79]
    ds_read_b64_tr_b16 v[148:149], v252 offset:8192
    s_add_u32 m0, s3, 106496
    v_mfma_f32_16x16x32_bf16 v[76:79], a[244:247], a[20:23], v[76:79]
    v_mfma_f32_16x16x32_bf16 v[68:71], a[244:247], a[16:19], v[68:71]
    ds_read_b64_tr_b16 v[150:151], v252 offset:12288
    v_mfma_f32_16x16x32_bf16 v[68:71], a[240:243], a[0:3], v[68:71]
    s_waitcnt lgkmcnt(4)
    v_mfma_f32_16x16x32_bf16 v[96:99], v[128:131], a[0:3], v[96:99]
    ds_read_b64_tr_b16 v[152:153], v253 offset:0
    v_mfma_f32_16x16x32_bf16 v[96:99], v[132:135], a[16:19], v[96:99]
    buffer_load_dwordx4 v244, s[48:51], s94 offen lds
    v_mfma_f32_16x16x32_bf16 v[104:107], v[132:135], a[20:23], v[104:107]
    ds_read_b64_tr_b16 v[154:155], v253 offset:4096
    s_add_u32 m0, s3, 108544
    v_mfma_f32_16x16x32_bf16 v[104:107], v[128:131], a[4:7], v[104:107]
    buffer_load_dwordx4 v245, s[48:51], s94 offen lds
    v_mfma_f32_16x16x32_bf16 v[112:115], v[128:131], a[8:11], v[112:115]
    ds_read_b64_tr_b16 v[156:157], v253 offset:8192
    v_mfma_f32_16x16x32_bf16 v[112:115], v[132:135], a[24:27], v[112:115]
    v_readlane_b32 s95, v246, 32
    v_mfma_f32_16x16x32_bf16 v[120:123], v[132:135], a[28:31], v[120:123]
    ds_read_b64_tr_b16 v[158:159], v253 offset:12288
    v_mfma_f32_16x16x32_bf16 v[120:123], v[128:131], a[12:15], v[120:123]
    s_waitcnt vmcnt(32)
    v_cmp_eq_u32 s[4:5], v239, v169
    v_mfma_f32_16x16x32_bf16 v[124:127], v[136:139], a[12:15], v[124:127]
    ds_read_b64_tr_b16 a[232:233], v162 offset:49152
    v_mfma_f32_16x16x32_bf16 v[124:127], v[140:143], a[28:31], v[124:127]
    s_mov_b64 exec, 1
    buffer_store_dword v239, v254, s[44:47], s10 offen offset:768
    buffer_store_dword v239, v254, s[44:47], s10 offen offset:896 sc1
    s_mov_b64 exec, -1
    v_mfma_f32_16x16x32_bf16 v[116:119], v[140:143], a[24:27], v[116:119]
    ds_read_b64_tr_b16 a[234:235], v162 offset:53248
    v_mfma_f32_16x16x32_bf16 v[116:119], v[136:139], a[8:11], v[116:119]
    s_or_b32 s4, s5, s5
    s_cmp_eq_u32 s4, -1
    s_cbranch_scc0 L_slow_p311
L_back_p311:
    v_mfma_f32_16x16x32_bf16 v[108:111], v[136:139], a[4:7], v[108:111]
    ds_read_b64_tr_b16 a[236:237], v162 offset:57344
    v_mfma_f32_16x16x32_bf16 v[108:111], v[140:143], a[20:23], v[108:111]
    buffer_load_dwordx4 a[200:203], v240, s[40:43], s95 offen sc1
    v_mfma_f32_16x16x32_bf16 v[100:103], v[140:143], a[16:19], v[100:103]
    ds_read_b64_tr_b16 a[238:239], v162 offset:61440
    v_mfma_f32_16x16x32_bf16 v[100:103], v[136:139], a[0:3], v[100:103]
    s_waitcnt lgkmcnt(4)
    v_mfma_f32_16x16x32_bf16 v[32:35], v[144:147], a[32:35], v[32:35]
    ds_read_b64_tr_b16 a[240:241], v163 offset:49152
    v_mfma_f32_16x16x32_bf16 v[32:35], v[148:151], a[48:51], v[32:35]
    buffer_load_dwordx4 a[204:207], v241, s[40:43], s95 offen sc1
    v_mfma_f32_16x16x32_bf16 v[40:43], v[148:151], a[52:55], v[40:43]
    ds_read_b64_tr_b16 a[242:243], v163 offset:53248
    v_mfma_f32_16x16x32_bf16 v[40:43], v[144:147], a[36:39], v[40:43]
    buffer_load_dwordx4 a[208:211], v242, s[40:43], s95 offen sc1
    v_mfma_f32_16x16x32_bf16 v[48:51], v[144:147], a[40:43], v[48:51]
    ds_read_b64_tr_b16 a[244:245], v163 offset:57344
    v_mfma_f32_16x16x32_bf16 v[48:51], v[148:151], a[56:59], v[48:51]
    buffer_load_dwordx4 a[212:215], v243, s[40:43], s95 offen sc1
    v_mfma_f32_16x16x32_bf16 v[56:59], v[148:151], a[60:63], v[56:59]
    ds_read_b64_tr_b16 a[246:247], v163 offset:61440
    v_mfma_f32_16x16x32_bf16 v[56:59], v[144:147], a[44:47], v[56:59]
    v_readlane_b32 s92, v246, 33
    v_mfma_f32_16x16x32_bf16 v[60:63], v[152:155], a[44:47], v[60:63]
    ds_read_b64_tr_b16 v[128:129], v162 offset:0
    v_mfma_f32_16x16x32_bf16 v[60:63], v[156:159], a[60:63], v[60:63]
    v_mfma_f32_16x16x32_bf16 v[52:55], v[156:159], a[56:59], v[52:55]
    ds_read_b64_tr_b16 v[130:131], v162 offset:4096
    v_mfma_f32_16x16x32_bf16 v[52:55], v[152:155], a[40:43], v[52:55]
    buffer_load_dwordx4 a[216:219], v240, s[40:43], s92 offen sc1
    v_mfma_f32_16x16x32_bf16 v[44:47], v[152:155], a[36:39], v[44:47]
    ds_read_b64_tr_b16 v[132:133], v162 offset:8192
    v_mfma_f32_16x16x32_bf16 v[44:47], v[156:159], a[52:55], v[44:47]
    buffer_load_dwordx4 a[220:223], v241, s[40:43], s92 offen sc1
    v_mfma_f32_16x16x32_bf16 v[36:39], v[156:159], a[48:51], v[36:39]
    ds_read_b64_tr_b16 v[134:135], v162 offset:12288
    v_mfma_f32_16x16x32_bf16 v[36:39], v[152:155], a[32:35], v[36:39]
    s_waitcnt lgkmcnt(4)
    v_mfma_f32_16x16x32_bf16 v[32:35], a[232:235], a[64:67], v[32:35]
    ds_read_b64_tr_b16 v[136:137], v163 offset:0
    v_mfma_f32_16x16x32_bf16 v[32:35], a[236:239], a[80:83], v[32:35]
    buffer_load_dwordx4 a[224:227], v242, s[40:43], s92 offen sc1
    v_mfma_f32_16x16x32_bf16 v[40:43], a[236:239], a[84:87], v[40:43]
    ds_read_b64_tr_b16 v[138:139], v163 offset:4096
    v_mfma_f32_16x16x32_bf16 v[40:43], a[232:235], a[68:71], v[40:43]
    buffer_load_dwordx4 a[228:231], v243, s[40:43], s92 offen sc1
    v_mfma_f32_16x16x32_bf16 v[48:51], a[232:235], a[72:75], v[48:51]
    ds_read_b64_tr_b16 v[140:141], v163 offset:8192
    v_mfma_f32_16x16x32_bf16 v[48:51], a[236:239], a[88:91], v[48:51]
    v_mfma_f32_16x16x32_bf16 v[56:59], a[236:239], a[92:95], v[56:59]
    ds_read_b64_tr_b16 v[142:143], v163 offset:12288
    v_mfma_f32_16x16x32_bf16 v[56:59], a[232:235], a[76:79], v[56:59]
    s_waitcnt vmcnt(34)
    s_barrier
    v_mfma_f32_16x16x32_bf16 v[60:63], a[240:243], a[76:79], v[60:63]
    ds_read_b64_tr_b16 v[144:145], v162 offset:16384
    v_mfma_f32_16x16x32_bf16 v[60:63], a[244:247], a[92:95], v[60:63]
    v_mfma_f32_16x16x32_bf16 v[52:55], a[244:247], a[88:91], v[52:55]
    ds_read_b64_tr_b16 v[146:147], v162 offset:20480
    v_mfma_f32_16x16x32_bf16 v[52:55], a[240:243], a[72:75], v[52:55]
    v_mfma_f32_16x16x32_bf16 v[44:47], a[240:243], a[68:71], v[44:47]
    ds_read_b64_tr_b16 v[148:149], v162 offset:24576
    v_mfma_f32_16x16x32_bf16 v[44:47], a[244:247], a[84:87], v[44:47]
    v_mfma_f32_16x16x32_bf16 v[36:39], a[244:247], a[80:83], v[36:39]
    ds_read_b64_tr_b16 v[150:151], v162 offset:28672
    v_mfma_f32_16x16x32_bf16 v[36:39], a[240:243], a[64:67], v[36:39]
    s_waitcnt lgkmcnt(4)
    v_mfma_f32_16x16x32_bf16 v[32:35], v[128:131], a[96:99], v[32:35]
    ds_read_b64_tr_b16 v[152:153], v163 offset:16384
    v_mfma_f32_16x16x32_bf16 v[32:35], v[132:135], a[112:115], v[32:35]
    v_mfma_f32_16x16x32_bf16 v[40:43], v[132:135], a[116:119], v[40:43]
    ds_read_b64_tr_b16 v[154:155], v163 offset:20480
    v_mfma_f32_16x16x32_bf16 v[40:43], v[128:131], a[100:103], v[40:43]
    v_mfma_f32_16x16x32_bf16 v[48:51], v[128:131], a[104:107], v[48:51]
    ds_read_b64_tr_b16 v[156:157], v163 offset:24576
    v_mfma_f32_16x16x32_bf16 v[48:51], v[132:135], a[120:123], v[48:51]
    buffer_load_dwordx2 v[176:177], v228, s[24:27], s88 offen offset:0
    v_mfma_f32_16x16x32_bf16 v[56:59], v[132:135], a[124:127], v[56:59]
    ds_read_b64_tr_b16 v[158:159], v163 offset:28672
    v_mfma_f32_16x16x32_bf16 v[56:59], v[128:131], a[108:111], v[56:59]
    v_mfma_f32_16x16x32_bf16 v[60:63], v[136:139], a[108:111], v[60:63]
    ds_read_b64_tr_b16 a[232:233], v249 offset:0
    v_mfma_f32_16x16x32_bf16 v[60:63], v[140:143], a[124:127], v[60:63]
    v_mfma_f32_16x16x32_bf16 v[52:55], v[140:143], a[120:123], v[52:55]
    ds_read_b64_tr_b16 a[234:235], v249 offset:4096
    v_mfma_f32_16x16x32_bf16 v[52:55], v[136:139], a[104:107], v[52:55]
    v_mfma_f32_16x16x32_bf16 v[44:47], v[136:139], a[100:103], v[44:47]
    ds_read_b64_tr_b16 a[236:237], v249 offset:8192
    v_mfma_f32_16x16x32_bf16 v[44:47], v[140:143], a[116:119], v[44:47]
    buffer_load_dwordx2 v[178:179], v228, s[24:27], s88 offen offset:32
    v_mfma_f32_16x16x32_bf16 v[36:39], v[140:143], a[112:115], v[36:39]
    ds_read_b64_tr_b16 a[238:239], v249 offset:12288
    v_mfma_f32_16x16x32_bf16 v[36:39], v[136:139], a[96:99], v[36:39]
    s_waitcnt vmcnt(28) lgkmcnt(4)
    v_mfma_f32_16x16x32_bf16 v[32:35], v[144:147], a[136:139], v[32:35]
    ds_read_b64_tr_b16 a[240:241], v234 offset:0
    v_mfma_f32_16x16x32_bf16 v[32:35], v[148:151], a[152:155], v[32:35]
    v_mfma_f32_16x16x32_bf16 v[40:43], v[148:151], a[156:159], v[40:43]
    ds_read_b64_tr_b16 a[242:243], v234 offset:4096
    v_mfma_f32_16x16x32_bf16 v[40:43], v[144:147], a[140:143], v[40:43]
    buffer_load_dwordx2 v[180:181], v228, s[24:27], s89 offen offset:0
    v_mfma_f32_16x16x32_bf16 v[48:51], v[144:147], a[144:147], v[48:51]
    ds_read_b64_tr_b16 a[244:245], v234 offset:8192
    v_mfma_f32_16x16x32_bf16 v[48:51], v[148:151], a[160:163], v[48:51]
    v_mfma_f32_16x16x32_bf16 v[56:59], v[148:151], a[164:167], v[56:59]
    ds_read_b64_tr_b16 a[246:247], v234 offset:12288
    v_mfma_f32_16x16x32_bf16 v[56:59], v[144:147], a[148:151], v[56:59]
    v_mfma_f32_16x16x32_bf16 v[60:63], v[152:155], a[148:151], v[60:63]
    ds_read_b64_tr_b16 v[128:129], v164 offset:49152
    v_mfma_f32_16x16x32_bf16 v[60:63], v[156:159], a[164:167], v[60:63]
    v_mfma_f32_16x16x32_bf16 v[52:55], v[156:159], a[160:163], v[52:55]
    ds_read_b64_tr_b16 v[130:131], v164 offset:53248
    v_mfma_f32_16x16x32_bf16 v[52:55], v[152:155], a[144:147], v[52:55]
    buffer_load_dwordx2 v[182:183], v228, s[24:27], s89 offen offset:32
    v_mfma_f32_16x16x32_bf16 v[44:47], v[152:155], a[140:143], v[44:47]
    ds_read_b64_tr_b16 v[132:133], v164 offset:57344
    v_mfma_f32_16x16x32_bf16 v[44:47], v[156:159], a[156:159], v[44:47]
    v_mfma_f32_16x16x32_bf16 v[36:39], v[156:159], a[152:155], v[36:39]
    ds_read_b64_tr_b16 v[134:135], v164 offset:61440
    v_mfma_f32_16x16x32_bf16 v[36:39], v[152:155], a[136:139], v[36:39]
    s_waitcnt lgkmcnt(4)
    v_mfma_f32_16x16x32_bf16 v[64:67], a[232:235], a[32:35], v[64:67]
    ds_read_b64_tr_b16 v[136:137], v165 offset:49152
    v_mfma_f32_16x16x32_bf16 v[64:67], a[236:239], a[48:51], v[64:67]
    v_mfma_f32_16x16x32_bf16 v[72:75], a[236:239], a[52:55], v[72:75]
    ds_read_b64_tr_b16 v[138:139], v165 offset:53248
    v_mfma_f32_16x16x32_bf16 v[72:75], a[232:235], a[36:39], v[72:75]
    buffer_load_dwordx2 v[184:185], v228, s[24:27], s90 offen offset:0
    v_mfma_f32_16x16x32_bf16 v[80:83], a[232:235], a[40:43], v[80:83]
    ds_read_b64_tr_b16 v[140:141], v165 offset:57344
    v_mfma_f32_16x16x32_bf16 v[80:83], a[236:239], a[56:59], v[80:83]
    v_mfma_f32_16x16x32_bf16 v[88:91], a[236:239], a[60:63], v[88:91]
    ds_read_b64_tr_b16 v[142:143], v165 offset:61440
    v_mfma_f32_16x16x32_bf16 v[88:91], a[232:235], a[44:47], v[88:91]
    s_waitcnt vmcnt(27)
    s_barrier
    v_mfma_f32_16x16x32_bf16 v[92:95], a[240:243], a[44:47], v[92:95]
    ds_read_b64_tr_b16 v[144:145], v162 offset:32768
    v_mfma_f32_16x16x32_bf16 v[92:95], a[244:247], a[60:63], v[92:95]
    v_mfma_f32_16x16x32_bf16 v[84:87], a[244:247], a[56:59], v[84:87]
    ds_read_b64_tr_b16 v[146:147], v162 offset:36864
    v_mfma_f32_16x16x32_bf16 v[84:87], a[240:243], a[40:43], v[84:87]
    buffer_load_dwordx2 v[186:187], v228, s[24:27], s90 offen offset:32
    v_mfma_f32_16x16x32_bf16 v[76:79], a[240:243], a[36:39], v[76:79]
    ds_read_b64_tr_b16 v[148:149], v162 offset:40960
    v_mfma_f32_16x16x32_bf16 v[76:79], a[244:247], a[52:55], v[76:79]
    v_mfma_f32_16x16x32_bf16 v[68:71], a[244:247], a[48:51], v[68:71]
    ds_read_b64_tr_b16 v[150:151], v162 offset:45056
    v_mfma_f32_16x16x32_bf16 v[68:71], a[240:243], a[32:35], v[68:71]
    s_waitcnt lgkmcnt(4)
    v_mfma_f32_16x16x32_bf16 v[64:67], v[128:131], a[64:67], v[64:67]
    ds_read_b64_tr_b16 v[152:153], v163 offset:32768
    v_mfma_f32_16x16x32_bf16 v[64:67], v[132:135], a[80:83], v[64:67]
    buffer_load_dwordx2 v[188:189], v228, s[24:27], s91 offen offset:0
    v_mfma_f32_16x16x32_bf16 v[72:75], v[132:135], a[84:87], v[72:75]
    ds_read_b64_tr_b16 v[154:155], v163 offset:36864
    v_mfma_f32_16x16x32_bf16 v[72:75], v[128:131], a[68:71], v[72:75]
    v_mfma_f32_16x16x32_bf16 v[80:83], v[128:131], a[72:75], v[80:83]
    ds_read_b64_tr_b16 v[156:157], v163 offset:40960
    v_mfma_f32_16x16x32_bf16 v[80:83], v[132:135], a[88:91], v[80:83]
    v_mfma_f32_16x16x32_bf16 v[88:91], v[132:135], a[92:95], v[88:91]
    ds_read_b64_tr_b16 v[158:159], v163 offset:45056
    v_mfma_f32_16x16x32_bf16 v[88:91], v[128:131], a[76:79], v[88:91]
    v_mfma_f32_16x16x32_bf16 v[92:95], v[136:139], a[76:79], v[92:95]
    ds_read_b64_tr_b16 a[232:233], v164 offset:0
    v_mfma_f32_16x16x32_bf16 v[92:95], v[140:143], a[92:95], v[92:95]
    buffer_load_dwordx2 v[190:191], v228, s[24:27], s91 offen offset:32
    v_mfma_f32_16x16x32_bf16 v[84:87], v[140:143], a[88:91], v[84:87]
    ds_read_b64_tr_b16 a[234:235], v164 offset:4096
    v_mfma_f32_16x16x32_bf16 v[84:87], v[136:139], a[72:75], v[84:87]
    buffer_load_dword v170, v230, s[44:47], s77 offen offset:768 sc1
    v_mfma_f32_16x16x32_bf16 v[76:79], v[136:139], a[68:71], v[76:79]
    ds_read_b64_tr_b16 a[236:237], v164 offset:8192
    v_mfma_f32_16x16x32_bf16 v[76:79], v[140:143], a[84:87], v[76:79]
    v_mfma_f32_16x16x32_bf16 v[68:71], v[140:143], a[80:83], v[68:71]
    ds_read_b64_tr_b16 a[238:239], v164 offset:12288
    v_mfma_f32_16x16x32_bf16 v[68:71], v[136:139], a[64:67], v[68:71]
    s_waitcnt vmcnt(23) lgkmcnt(4)
    v_mfma_f32_16x16x32_bf16 v[32:35], v[144:147], a[168:171], v[32:35]
    ds_read_b64_tr_b16 a[240:241], v165 offset:0
    v_mfma_f32_16x16x32_bf16 v[32:35], v[148:151], a[184:187], v[32:35]
    v_mfma_f32_16x16x32_bf16 v[40:43], v[148:151], a[188:191], v[40:43]
    ds_read_b64_tr_b16 a[242:243], v165 offset:4096
    v_mfma_f32_16x16x32_bf16 v[40:43], v[144:147], a[172:175], v[40:43]
    v_mfma_f32_16x16x32_bf16 v[48:51], v[144:147], a[176:179], v[48:51]
    ds_read_b64_tr_b16 a[244:245], v165 offset:8192
    v_mfma_f32_16x16x32_bf16 v[48:51], v[148:151], a[192:195], v[48:51]
    v_mfma_f32_16x16x32_bf16 v[56:59], v[148:151], a[196:199], v[56:59]
    ds_read_b64_tr_b16 a[246:247], v165 offset:12288
    v_mfma_f32_16x16x32_bf16 v[56:59], v[144:147], a[180:183], v[56:59]
    v_mfma_f32_16x16x32_bf16 v[60:63], v[152:155], a[180:183], v[60:63]
    ds_read_b64_tr_b16 v[128:129], v164 offset:16384
    v_mfma_f32_16x16x32_bf16 v[60:63], v[156:159], a[196:199], v[60:63]
    v_mfma_f32_16x16x32_bf16 v[52:55], v[156:159], a[192:195], v[52:55]
    ds_read_b64_tr_b16 v[130:131], v164 offset:20480
    v_mfma_f32_16x16x32_bf16 v[52:55], v[152:155], a[176:179], v[52:55]
    v_mfma_f32_16x16x32_bf16 v[44:47], v[152:155], a[172:175], v[44:47]
    ds_read_b64_tr_b16 v[132:133], v164 offset:24576
    v_mfma_f32_16x16x32_bf16 v[44:47], v[156:159], a[188:191], v[44:47]
    v_mfma_f32_16x16x32_bf16 v[36:39], v[156:159], a[184:187], v[36:39]
    ds_read_b64_tr_b16 v[134:135], v164 offset:28672
    v_mfma_f32_16x16x32_bf16 v[36:39], v[152:155], a[168:171], v[36:39]
    s_waitcnt lgkmcnt(4)
    v_mfma_f32_16x16x32_bf16 v[64:67], a[232:235], a[96:99], v[64:67]
    ds_read_b64_tr_b16 v[136:137], v165 offset:16384
    v_mfma_f32_16x16x32_bf16 v[64:67], a[236:239], a[112:115], v[64:67]
    v_mfma_f32_16x16x32_bf16 v[72:75], a[236:239], a[116:119], v[72:75]
    ds_read_b64_tr_b16 v[138:139], v165 offset:20480
    v_mfma_f32_16x16x32_bf16 v[72:75], a[232:235], a[100:103], v[72:75]
    v_mfma_f32_16x16x32_bf16 v[80:83], a[232:235], a[104:107], v[80:83]
    ds_read_b64_tr_b16 v[140:141], v165 offset:24576
    v_mfma_f32_16x16x32_bf16 v[80:83], a[236:239], a[120:123], v[80:83]
    v_mfma_f32_16x16x32_bf16 v[88:91], a[236:239], a[124:127], v[88:91]
    ds_read_b64_tr_b16 v[142:143], v165 offset:28672
    v_mfma_f32_16x16x32_bf16 v[88:91], a[232:235], a[108:111], v[88:91]
    s_waitcnt vmcnt(19)
    s_barrier
    v_mfma_f32_16x16x32_bf16 v[92:95], a[240:243], a[108:111], v[92:95]
    ds_read_b64_tr_b16 v[144:145], v252 offset:16384
    v_mfma_f32_16x16x32_bf16 v[92:95], a[244:247], a[124:127], v[92:95]
    v_mfma_f32_16x16x32_bf16 v[84:87], a[244:247], a[120:123], v[84:87]
    ds_read_b64_tr_b16 v[146:147], v252 offset:20480
    v_mfma_f32_16x16x32_bf16 v[84:87], a[240:243], a[104:107], v[84:87]
    v_mfma_f32_16x16x32_bf16 v[76:79], a[240:243], a[100:103], v[76:79]
    ds_read_b64_tr_b16 v[148:149], v252 offset:24576
    v_mfma_f32_16x16x32_bf16 v[76:79], a[244:247], a[116:119], v[76:79]
    v_mfma_f32_16x16x32_bf16 v[68:71], a[244:247], a[112:115], v[68:71]
    ds_read_b64_tr_b16 v[150:151], v252 offset:28672
    v_mfma_f32_16x16x32_bf16 v[68:71], a[240:243], a[96:99], v[68:71]
    s_waitcnt lgkmcnt(4)
    v_mfma_f32_16x16x32_bf16 v[64:67], v[128:131], a[136:139], v[64:67]
    ds_read_b64_tr_b16 v[152:153], v253 offset:16384
    v_mfma_f32_16x16x32_bf16 v[64:67], v[132:135], a[152:155], v[64:67]
    v_mfma_f32_16x16x32_bf16 v[72:75], v[132:135], a[156:159], v[72:75]
    ds_read_b64_tr_b16 v[154:155], v253 offset:20480
    v_mfma_f32_16x16x32_bf16 v[72:75], v[128:131], a[140:143], v[72:75]
    v_mfma_f32_16x16x32_bf16 v[80:83], v[128:131], a[144:147], v[80:83]
    ds_read_b64_tr_b16 v[156:157], v253 offset:24576
    v_mfma_f32_16x16x32_bf16 v[80:83], v[132:135], a[160:163], v[80:83]
    v_mfma_f32_16x16x32_bf16 v[88:91], v[132:135], a[164:167], v[88:91]
    ds_read_b64_tr_b16 v[158:159], v253 offset:28672
    v_mfma_f32_16x16x32_bf16 v[88:91], v[128:131], a[148:151], v[88:91]
    v_mfma_f32_16x16x32_bf16 v[92:95], v[136:139], a[148:151], v[92:95]
    ds_read_b64_tr_b16 a[232:233], v164 offset:32768
    v_mfma_f32_16x16x32_bf16 v[92:95], v[140:143], a[164:167], v[92:95]
    v_mfma_f32_16x16x32_bf16 v[84:87], v[140:143], a[160:163], v[84:87]
    ds_read_b64_tr_b16 a[234:235], v164 offset:36864
    v_mfma_f32_16x16x32_bf16 v[84:87], v[136:139], a[144:147], v[84:87]
    v_mfma_f32_16x16x32_bf16 v[76:79], v[136:139], a[140:143], v[76:79]
    ds_read_b64_tr_b16 a[236:237], v164 offset:40960
    v_mfma_f32_16x16x32_bf16 v[76:79], v[140:143], a[156:159], v[76:79]
    v_mfma_f32_16x16x32_bf16 v[68:71], v[140:143], a[152:155], v[68:71]
    ds_read_b64_tr_b16 a[238:239], v164 offset:45056
    v_mfma_f32_16x16x32_bf16 v[68:71], v[136:139], a[136:139], v[68:71]
    s_waitcnt vmcnt(9) lgkmcnt(4)
    v_mfma_f32_16x16x32_bf16 v[32:35], v[144:147], a[200:203], v[32:35]
    ds_read_b64_tr_b16 a[240:241], v165 offset:32768
    v_mfma_f32_16x16x32_bf16 v[32:35], v[148:151], a[216:219], v[32:35]
    ds_read_b64_tr_b16 a[242:243], v165 offset:36864
    v_mfma_f32_16x16x32_bf16 v[36:39], v[156:159], a[216:219], v[36:39]
    ds_read_b64_tr_b16 a[244:245], v165 offset:40960
    v_mfma_f32_16x16x32_bf16 v[36:39], v[152:155], a[200:203], v[36:39]
    ds_read_b64_tr_b16 a[246:247], v165 offset:45056
    v_mfma_f32_16x16x32_bf16 v[44:47], v[152:155], a[204:207], v[44:47]
    ds_read_b64_tr_b16 v[128:129], v249 offset:16384
    v_mfma_f32_16x16x32_bf16 v[44:47], v[156:159], a[220:223], v[44:47]
    ds_read_b64_tr_b16 v[130:131], v249 offset:20480
    v_mfma_f32_16x16x32_bf16 v[40:43], v[148:151], a[220:223], v[40:43]
    s_waitcnt vmcnt(0)
    v_cmp_eq_u32 s[4:5], v239, v170
    v_mfma_f32_16x16x32_bf16 v[40:43], v[144:147], a[204:207], v[40:43]
    ds_read_b64_tr_b16 v[132:133], v249 offset:24576
    v_mfma_f32_16x16x32_bf16 v[48:51], v[144:147], a[208:211], v[48:51]
    s_or_b32 s4, s4, s5
    s_cmp_eq_u32 s4, -1
    s_cbranch_scc0 L_slow_p411
L_back_p411:
    v_mfma_f32_16x16x32_bf16 v[48:51], v[148:151], a[224:227], v[48:51]
    v_cvt_pk_bf16_f32 v32, v32, v33
    v_cvt_pk_bf16_f32 v33, v34, v35
    v_mfma_f32_16x16x32_bf16 v[52:55], v[156:159], a[224:227], v[52:55]
    v_cvt_pk_bf16_f32 v34, v36, v37
    v_cvt_pk_bf16_f32 v35, v38, v39
    v_or_b32 v32, 1, v32
    v_mfma_f32_16x16x32_bf16 v[52:55], v[152:155], a[208:211], v[52:55]
    buffer_store_dwordx4 v[32:35], v240, s[40:43], s13 offen sc1
    v_mfma_f32_16x16x32_bf16 v[60:63], v[152:155], a[212:215], v[60:63]
    v_cvt_pk_bf16_f32 v40, v40, v41
    v_cvt_pk_bf16_f32 v41, v42, v43
    v_mfma_f32_16x16x32_bf16 v[60:63], v[156:159], a[228:231], v[60:63]
    v_cvt_pk_bf16_f32 v42, v44, v45
    v_cvt_pk_bf16_f32 v43, v46, v47
    v_or_b32 v40, 1, v40
    v_mfma_f32_16x16x32_bf16 v[56:59], v[148:151], a[228:231], v[56:59]
    ds_read_b64_tr_b16 v[134:135], v249 offset:28672
    v_mfma_f32_16x16x32_bf16 v[56:59], v[144:147], a[212:215], v[56:59]
    s_waitcnt lgkmcnt(4)
    v_mfma_f32_16x16x32_bf16 v[64:67], a[232:235], a[168:171], v[64:67]
    ds_read_b64_tr_b16 v[136:137], v234 offset:16384
    v_mfma_f32_16x16x32_bf16 v[64:67], a[236:239], a[184:187], v[64:67]
    buffer_store_dwordx4 v[40:43], v241, s[40:43], s13 offen sc1
    v_mfma_f32_16x16x32_bf16 v[72:75], a[236:239], a[188:191], v[72:75]
    ds_read_b64_tr_b16 v[138:139], v234 offset:20480
    v_mfma_f32_16x16x32_bf16 v[72:75], a[232:235], a[172:175], v[72:75]
    v_cvt_pk_bf16_f32 v48, v48, v49
    v_cvt_pk_bf16_f32 v49, v50, v51
    v_mfma_f32_16x16x32_bf16 v[80:83], a[232:235], a[176:179], v[80:83]
    ds_read_b64_tr_b16 v[140:141], v234 offset:24576
    v_mfma_f32_16x16x32_bf16 v[80:83], a[236:239], a[192:195], v[80:83]
    v_cvt_pk_bf16_f32 v50, v52, v53
    v_cvt_pk_bf16_f32 v51, v54, v55
    v_or_b32 v48, 1, v48
    v_mfma_f32_16x16x32_bf16 v[88:91], a[236:239], a[196:199], v[88:91]
    ds_read_b64_tr_b16 v[142:143], v234 offset:28672
    v_mfma_f32_16x16x32_bf16 v[88:91], a[232:235], a[180:183], v[88:91]
    buffer_store_dwordx4 v[48:51], v242, s[40:43], s13 offen sc1
    v_mfma_f32_16x16x32_bf16 v[92:95], a[240:243], a[180:183], v[92:95]
    ds_read_b64_tr_b16 v[144:145], v235 offset:0
    v_mfma_f32_16x16x32_bf16 v[92:95], a[244:247], a[196:199], v[92:95]
    v_cvt_pk_bf16_f32 v56, v56, v57
    v_cvt_pk_bf16_f32 v57, v58, v59
    v_mfma_f32_16x16x32_bf16 v[84:87], a[244:247], a[192:195], v[84:87]
    ds_read_b64_tr_b16 v[146:147], v235 offset:4096
    v_mfma_f32_16x16x32_bf16 v[84:87], a[240:243], a[176:179], v[84:87]
    v_cvt_pk_bf16_f32 v58, v60, v61
    v_cvt_pk_bf16_f32 v59, v62, v63
    v_or_b32 v56, 1, v56
    v_mfma_f32_16x16x32_bf16 v[76:79], a[240:243], a[172:175], v[76:79]
    ds_read_b64_tr_b16 v[148:149], v235 offset:8192
    v_mfma_f32_16x16x32_bf16 v[76:79], a[244:247], a[188:191], v[76:79]
    buffer_store_dwordx4 v[56:59], v243, s[40:43], s13 offen sc1
    v_mfma_f32_16x16x32_bf16 v[68:71], a[244:247], a[184:187], v[68:71]
    ds_read_b64_tr_b16 v[150:151], v235 offset:12288
    v_mfma_f32_16x16x32_bf16 v[68:71], a[240:243], a[168:171], v[68:71]
    s_waitcnt lgkmcnt(4)
    v_mfma_f32_16x16x32_bf16 v[64:67], v[128:131], a[200:203], v[64:67]
    ds_read_b64_tr_b16 v[152:153], v236 offset:0
    v_mfma_f32_16x16x32_bf16 v[64:67], v[132:135], a[216:219], v[64:67]
    ds_read_b64_tr_b16 v[154:155], v236 offset:4096
    v_mfma_f32_16x16x32_bf16 v[68:71], v[140:143], a[216:219], v[68:71]
    ds_read_b64_tr_b16 v[156:157], v236 offset:8192
    v_mfma_f32_16x16x32_bf16 v[68:71], v[136:139], a[200:203], v[68:71]
    ds_read_b64_tr_b16 v[158:159], v236 offset:12288
    v_mfma_f32_16x16x32_bf16 v[76:79], v[136:139], a[204:207], v[76:79]
    ds_read_b64_tr_b16 a[232:233], v166 offset:49152
    v_mfma_f32_16x16x32_bf16 v[76:79], v[140:143], a[220:223], v[76:79]
    ds_read_b64_tr_b16 a[234:235], v166 offset:53248
    v_mfma_f32_16x16x32_bf16 v[72:75], v[132:135], a[220:223], v[72:75]
    v_cvt_pk_bf16_f32 v64, v64, v65
    v_cvt_pk_bf16_f32 v65, v66, v67
    v_mfma_f32_16x16x32_bf16 v[72:75], v[128:131], a[204:207], v[72:75]
    v_cvt_pk_bf16_f32 v66, v68, v69
    v_cvt_pk_bf16_f32 v67, v70, v71
    v_or_b32 v64, 1, v64
    v_mfma_f32_16x16x32_bf16 v[80:83], v[128:131], a[208:211], v[80:83]
    buffer_store_dwordx4 v[64:67], v240, s[40:43], s14 offen sc1
    v_mfma_f32_16x16x32_bf16 v[80:83], v[132:135], a[224:227], v[80:83]
    ds_read_b64_tr_b16 a[236:237], v166 offset:57344
    v_mfma_f32_16x16x32_bf16 v[84:87], v[140:143], a[224:227], v[84:87]
    v_cvt_pk_bf16_f32 v72, v72, v73
    v_cvt_pk_bf16_f32 v73, v74, v75
    v_mfma_f32_16x16x32_bf16 v[84:87], v[136:139], a[208:211], v[84:87]
    v_cvt_pk_bf16_f32 v74, v76, v77
    v_cvt_pk_bf16_f32 v75, v78, v79
    v_or_b32 v72, 1, v72
    v_mfma_f32_16x16x32_bf16 v[92:95], v[136:139], a[212:215], v[92:95]
    ds_read_b64_tr_b16 a[238:239], v166 offset:61440
    v_mfma_f32_16x16x32_bf16 v[92:95], v[140:143], a[228:231], v[92:95]
    buffer_store_dwordx4 v[72:75], v241, s[40:43], s14 offen sc1
    v_mfma_f32_16x16x32_bf16 v[88:91], v[132:135], a[228:231], v[88:91]
    v_cvt_pk_bf16_f32 v80, v80, v81
    v_cvt_pk_bf16_f32 v81, v82, v83
    v_mfma_f32_16x16x32_bf16 v[88:91], v[128:131], a[212:215], v[88:91]
    s_waitcnt lgkmcnt(4)
    v_mfma_f32_16x16x32_bf16 v[96:99], v[144:147], a[32:35], v[96:99]
    ds_read_b64_tr_b16 a[240:241], v167 offset:49152
    v_mfma_f32_16x16x32_bf16 v[96:99], v[148:151], a[48:51], v[96:99]
    v_cvt_pk_bf16_f32 v82, v84, v85
    v_cvt_pk_bf16_f32 v83, v86, v87
    v_or_b32 v80, 1, v80
    v_mfma_f32_16x16x32_bf16 v[104:107], v[148:151], a[52:55], v[104:107]
    ds_read_b64_tr_b16 a[242:243], v167 offset:53248
    v_mfma_f32_16x16x32_bf16 v[104:107], v[144:147], a[36:39], v[104:107]
    v_mfma_f32_16x16x32_bf16 v[112:115], v[144:147], a[40:43], v[112:115]
    ds_read_b64_tr_b16 a[244:245], v167 offset:57344
    v_mfma_f32_16x16x32_bf16 v[112:115], v[148:151], a[56:59], v[112:115]
    buffer_store_dwordx4 v[80:83], v242, s[40:43], s14 offen sc1
    v_mfma_f32_16x16x32_bf16 v[120:123], v[148:151], a[60:63], v[120:123]
    ds_read_b64_tr_b16 a[246:247], v167 offset:61440
    v_mfma_f32_16x16x32_bf16 v[120:123], v[144:147], a[44:47], v[120:123]
    v_cvt_pk_bf16_f32 v88, v88, v89
    v_cvt_pk_bf16_f32 v89, v90, v91
    v_mfma_f32_16x16x32_bf16 v[124:127], v[152:155], a[44:47], v[124:127]
    ds_read_b64_tr_b16 v[128:129], v166 offset:0
    v_mfma_f32_16x16x32_bf16 v[124:127], v[156:159], a[60:63], v[124:127]
    v_cvt_pk_bf16_f32 v90, v92, v93
    v_cvt_pk_bf16_f32 v91, v94, v95
    v_or_b32 v88, 1, v88
    v_mfma_f32_16x16x32_bf16 v[116:119], v[156:159], a[56:59], v[116:119]
    ds_read_b64_tr_b16 v[130:131], v166 offset:4096
    v_mfma_f32_16x16x32_bf16 v[116:119], v[152:155], a[40:43], v[116:119]
    buffer_store_dwordx4 v[88:91], v243, s[40:43], s14 offen sc1
    v_mfma_f32_16x16x32_bf16 v[108:111], v[152:155], a[36:39], v[108:111]
    ds_read_b64_tr_b16 v[132:133], v166 offset:8192
    v_mfma_f32_16x16x32_bf16 v[108:111], v[156:159], a[52:55], v[108:111]
    v_mfma_f32_16x16x32_bf16 v[100:103], v[156:159], a[48:51], v[100:103]
    ds_read_b64_tr_b16 v[134:135], v166 offset:12288
    v_mfma_f32_16x16x32_bf16 v[100:103], v[152:155], a[32:35], v[100:103]
    s_waitcnt lgkmcnt(4)
    v_mfma_f32_16x16x32_bf16 v[96:99], a[232:235], a[64:67], v[96:99]
    ds_read_b64_tr_b16 v[136:137], v167 offset:0
    v_mfma_f32_16x16x32_bf16 v[96:99], a[236:239], a[80:83], v[96:99]
    v_mfma_f32_16x16x32_bf16 v[104:107], a[236:239], a[84:87], v[104:107]
    ds_read_b64_tr_b16 v[138:139], v167 offset:4096
    v_mfma_f32_16x16x32_bf16 v[104:107], a[232:235], a[68:71], v[104:107]
    v_mfma_f32_16x16x32_bf16 v[112:115], a[232:235], a[72:75], v[112:115]
    ds_read_b64_tr_b16 v[140:141], v167 offset:8192
    v_mfma_f32_16x16x32_bf16 v[112:115], a[236:239], a[88:91], v[112:115]
    v_mfma_f32_16x16x32_bf16 v[120:123], a[236:239], a[92:95], v[120:123]
    ds_read_b64_tr_b16 v[142:143], v167 offset:12288
    v_mfma_f32_16x16x32_bf16 v[120:123], a[232:235], a[76:79], v[120:123]
    v_mfma_f32_16x16x32_bf16 v[124:127], a[240:243], a[76:79], v[124:127]
    ds_read_b64_tr_b16 v[144:145], v166 offset:16384
    v_mfma_f32_16x16x32_bf16 v[124:127], a[244:247], a[92:95], v[124:127]
    v_mfma_f32_16x16x32_bf16 v[116:119], a[244:247], a[88:91], v[116:119]
    ds_read_b64_tr_b16 v[146:147], v166 offset:20480
    v_mfma_f32_16x16x32_bf16 v[116:119], a[240:243], a[72:75], v[116:119]
    v_mfma_f32_16x16x32_bf16 v[108:111], a[240:243], a[68:71], v[108:111]
    ds_read_b64_tr_b16 v[148:149], v166 offset:24576
    v_mfma_f32_16x16x32_bf16 v[108:111], a[244:247], a[84:87], v[108:111]
    v_mfma_f32_16x16x32_bf16 v[100:103], a[244:247], a[80:83], v[100:103]
    ds_read_b64_tr_b16 v[150:151], v166 offset:28672
    v_mfma_f32_16x16x32_bf16 v[100:103], a[240:243], a[64:67], v[100:103]
    s_waitcnt lgkmcnt(4)
    v_mfma_f32_16x16x32_bf16 v[96:99], v[128:131], a[96:99], v[96:99]
    ds_read_b64_tr_b16 v[152:153], v167 offset:16384
    v_mfma_f32_16x16x32_bf16 v[96:99], v[132:135], a[112:115], v[96:99]
    v_mfma_f32_16x16x32_bf16 v[104:107], v[132:135], a[116:119], v[104:107]
    ds_read_b64_tr_b16 v[154:155], v167 offset:20480
    v_mfma_f32_16x16x32_bf16 v[104:107], v[128:131], a[100:103], v[104:107]
    v_mfma_f32_16x16x32_bf16 v[112:115], v[128:131], a[104:107], v[112:115]
    ds_read_b64_tr_b16 v[156:157], v167 offset:24576
    v_mfma_f32_16x16x32_bf16 v[112:115], v[132:135], a[120:123], v[112:115]
    v_mfma_f32_16x16x32_bf16 v[120:123], v[132:135], a[124:127], v[120:123]
    ds_read_b64_tr_b16 v[158:159], v167 offset:28672
    v_mfma_f32_16x16x32_bf16 v[120:123], v[128:131], a[108:111], v[120:123]
    v_mfma_f32_16x16x32_bf16 v[124:127], v[136:139], a[108:111], v[124:127]
    ds_read_b64_tr_b16 a[232:233], v166 offset:32768
    v_mfma_f32_16x16x32_bf16 v[124:127], v[140:143], a[124:127], v[124:127]
    v_mfma_f32_16x16x32_bf16 v[116:119], v[140:143], a[120:123], v[116:119]
    ds_read_b64_tr_b16 a[234:235], v166 offset:36864
    v_mfma_f32_16x16x32_bf16 v[116:119], v[136:139], a[104:107], v[116:119]
    v_mfma_f32_16x16x32_bf16 v[108:111], v[136:139], a[100:103], v[108:111]
    ds_read_b64_tr_b16 a[236:237], v166 offset:40960
    v_mfma_f32_16x16x32_bf16 v[108:111], v[140:143], a[116:119], v[108:111]
    v_mfma_f32_16x16x32_bf16 v[100:103], v[140:143], a[112:115], v[100:103]
    ds_read_b64_tr_b16 a[238:239], v166 offset:45056
    v_mfma_f32_16x16x32_bf16 v[100:103], v[136:139], a[96:99], v[100:103]
    s_waitcnt lgkmcnt(4)
    v_mfma_f32_16x16x32_bf16 v[96:99], v[144:147], a[136:139], v[96:99]
    ds_read_b64_tr_b16 a[240:241], v167 offset:32768
    v_mfma_f32_16x16x32_bf16 v[96:99], v[148:151], a[152:155], v[96:99]
    v_mfma_f32_16x16x32_bf16 v[104:107], v[148:151], a[156:159], v[104:107]
    ds_read_b64_tr_b16 a[242:243], v167 offset:36864
    v_mfma_f32_16x16x32_bf16 v[104:107], v[144:147], a[140:143], v[104:107]
    v_mfma_f32_16x16x32_bf16 v[112:115], v[144:147], a[144:147], v[112:115]
    ds_read_b64_tr_b16 a[244:245], v167 offset:40960
    v_mfma_f32_16x16x32_bf16 v[112:115], v[148:151], a[160:163], v[112:115]
    v_mfma_f32_16x16x32_bf16 v[120:123], v[148:151], a[164:167], v[120:123]
    ds_read_b64_tr_b16 a[246:247], v167 offset:45056
    v_mfma_f32_16x16x32_bf16 v[120:123], v[144:147], a[148:151], v[120:123]
    v_mfma_f32_16x16x32_bf16 v[124:127], v[152:155], a[148:151], v[124:127]
    ds_read_b64_tr_b16 v[128:129], v235 offset:16384
    v_mfma_f32_16x16x32_bf16 v[124:127], v[156:159], a[164:167], v[124:127]
    v_mfma_f32_16x16x32_bf16 v[116:119], v[156:159], a[160:163], v[116:119]
    ds_read_b64_tr_b16 v[130:131], v235 offset:20480
    v_mfma_f32_16x16x32_bf16 v[116:119], v[152:155], a[144:147], v[116:119]
    v_mfma_f32_16x16x32_bf16 v[108:111], v[152:155], a[140:143], v[108:111]
    ds_read_b64_tr_b16 v[132:133], v235 offset:24576
    v_mfma_f32_16x16x32_bf16 v[108:111], v[156:159], a[156:159], v[108:111]
    v_mfma_f32_16x16x32_bf16 v[100:103], v[156:159], a[152:155], v[100:103]
    ds_read_b64_tr_b16 v[134:135], v235 offset:28672
    v_mfma_f32_16x16x32_bf16 v[100:103], v[152:155], a[136:139], v[100:103]
    s_waitcnt lgkmcnt(4)
    v_mfma_f32_16x16x32_bf16 v[96:99], a[232:235], a[168:171], v[96:99]
    ds_read_b64_tr_b16 v[136:137], v236 offset:16384
    v_mfma_f32_16x16x32_bf16 v[96:99], a[236:239], a[184:187], v[96:99]
    v_mfma_f32_16x16x32_bf16 v[104:107], a[236:239], a[188:191], v[104:107]
    ds_read_b64_tr_b16 v[138:139], v236 offset:20480
    v_mfma_f32_16x16x32_bf16 v[104:107], a[232:235], a[172:175], v[104:107]
    v_mfma_f32_16x16x32_bf16 v[112:115], a[232:235], a[176:179], v[112:115]
    ds_read_b64_tr_b16 v[140:141], v236 offset:24576
    v_mfma_f32_16x16x32_bf16 v[112:115], a[236:239], a[192:195], v[112:115]
    v_mfma_f32_16x16x32_bf16 v[120:123], a[236:239], a[196:199], v[120:123]
    ds_read_b64_tr_b16 v[142:143], v236 offset:28672
    v_mfma_f32_16x16x32_bf16 v[120:123], a[232:235], a[180:183], v[120:123]
    v_mfma_f32_16x16x32_bf16 v[124:127], a[240:243], a[180:183], v[124:127]
    ds_read_b64_tr_b16 v[144:145], v250 offset:0
    v_mfma_f32_16x16x32_bf16 v[124:127], a[244:247], a[196:199], v[124:127]
    v_mfma_f32_16x16x32_bf16 v[116:119], a[244:247], a[192:195], v[116:119]
    ds_read_b64_tr_b16 v[146:147], v250 offset:4096
    v_mfma_f32_16x16x32_bf16 v[116:119], a[240:243], a[176:179], v[116:119]
    v_mfma_f32_16x16x32_bf16 v[108:111], a[240:243], a[172:175], v[108:111]
    ds_read_b64_tr_b16 v[148:149], v250 offset:8192
    v_mfma_f32_16x16x32_bf16 v[108:111], a[244:247], a[188:191], v[108:111]
    v_mfma_f32_16x16x32_bf16 v[100:103], a[244:247], a[184:187], v[100:103]
    ds_read_b64_tr_b16 v[150:151], v250 offset:12288
    v_mfma_f32_16x16x32_bf16 v[100:103], a[240:243], a[168:171], v[100:103]
    s_waitcnt lgkmcnt(4)
    v_mfma_f32_16x16x32_bf16 v[96:99], v[128:131], a[200:203], v[96:99]
    ds_read_b64_tr_b16 v[152:153], v251 offset:0
    v_mfma_f32_16x16x32_bf16 v[96:99], v[132:135], a[216:219], v[96:99]
    v_mfma_f32_16x16x32_bf16 v[100:103], v[140:143], a[216:219], v[100:103]
    ds_read_b64_tr_b16 v[154:155], v251 offset:4096
    v_mfma_f32_16x16x32_bf16 v[100:103], v[136:139], a[200:203], v[100:103]
    v_mfma_f32_16x16x32_bf16 v[108:111], v[136:139], a[204:207], v[108:111]
    ds_read_b64_tr_b16 v[156:157], v251 offset:8192
    v_mfma_f32_16x16x32_bf16 v[108:111], v[140:143], a[220:223], v[108:111]
    v_mfma_f32_16x16x32_bf16 v[104:107], v[132:135], a[220:223], v[104:107]
    ds_read_b64_tr_b16 v[158:159], v251 offset:12288
    v_mfma_f32_16x16x32_bf16 v[104:107], v[128:131], a[204:207], v[104:107]
    v_cvt_pk_bf16_f32 v96, v96, v97
    v_cvt_pk_bf16_f32 v97, v98, v99
    v_mfma_f32_16x16x32_bf16 v[112:115], v[128:131], a[208:211], v[112:115]
    v_cvt_pk_bf16_f32 v98, v100, v101
    v_cvt_pk_bf16_f32 v99, v102, v103
    v_or_b32 v96, 1, v96
    v_mfma_f32_16x16x32_bf16 v[112:115], v[132:135], a[224:227], v[112:115]
    ds_read_b64_tr_b16 a[232:233], v160 offset:49152
    v_mfma_f32_16x16x32_bf16 v[116:119], v[140:143], a[224:227], v[116:119]
    buffer_store_dwordx4 v[96:99], v240, s[40:43], s15 offen sc1
    v_mfma_f32_16x16x32_bf16 v[116:119], v[136:139], a[208:211], v[116:119]
    ds_read_b64_tr_b16 a[234:235], v160 offset:53248
    v_mfma_f32_16x16x32_bf16 v[124:127], v[136:139], a[212:215], v[124:127]
    v_cvt_pk_bf16_f32 v104, v104, v105
    v_cvt_pk_bf16_f32 v105, v106, v107
    v_mfma_f32_16x16x32_bf16 v[124:127], v[140:143], a[228:231], v[124:127]
    v_cvt_pk_bf16_f32 v106, v108, v109
    v_cvt_pk_bf16_f32 v107, v110, v111
    v_or_b32 v104, 1, v104
    v_mfma_f32_16x16x32_bf16 v[120:123], v[132:135], a[228:231], v[120:123]
    ds_read_b64_tr_b16 a[236:237], v160 offset:57344
    v_mfma_f32_16x16x32_bf16 v[120:123], v[128:131], a[212:215], v[120:123]
    s_waitcnt lgkmcnt(3)
    v_mfma_f32_16x16x32_bf16 v[0:3], v[144:147], a[32:35], v[0:3]
    buffer_store_dwordx4 v[104:107], v241, s[40:43], s15 offen sc1
    v_mfma_f32_16x16x32_bf16 v[0:3], v[148:151], a[48:51], v[0:3]
    ds_read_b64_tr_b16 a[238:239], v160 offset:61440
    v_mfma_f32_16x16x32_bf16 v[8:11], v[148:151], a[52:55], v[8:11]
    v_cvt_pk_bf16_f32 v112, v112, v113
    v_cvt_pk_bf16_f32 v113, v114, v115
    v_mfma_f32_16x16x32_bf16 v[8:11], v[144:147], a[36:39], v[8:11]
    v_cvt_pk_bf16_f32 v114, v116, v117
    v_cvt_pk_bf16_f32 v115, v118, v119
    v_or_b32 v112, 1, v112
    v_mfma_f32_16x16x32_bf16 v[16:19], v[144:147], a[40:43], v[16:19]
    ds_read_b64_tr_b16 a[240:241], v161 offset:49152
    v_mfma_f32_16x16x32_bf16 v[16:19], v[148:151], a[56:59], v[16:19]
    buffer_store_dwordx4 v[112:115], v242, s[40:43], s15 offen sc1
    v_mfma_f32_16x16x32_bf16 v[24:27], v[148:151], a[60:63], v[24:27]
    ds_read_b64_tr_b16 a[242:243], v161 offset:53248
    v_mfma_f32_16x16x32_bf16 v[24:27], v[144:147], a[44:47], v[24:27]
    v_cvt_pk_bf16_f32 v120, v120, v121
    v_cvt_pk_bf16_f32 v121, v122, v123
    v_mfma_f32_16x16x32_bf16 v[28:31], v[152:155], a[44:47], v[28:31]
    v_cvt_pk_bf16_f32 v122, v124, v125
    v_cvt_pk_bf16_f32 v123, v126, v127
    v_or_b32 v120, 1, v120
    v_mfma_f32_16x16x32_bf16 v[28:31], v[156:159], a[60:63], v[28:31]
    ds_read_b64_tr_b16 a[244:245], v161 offset:57344
    v_mfma_f32_16x16x32_bf16 v[20:23], v[156:159], a[56:59], v[20:23]
    buffer_store_dwordx4 v[120:123], v243, s[40:43], s15 offen sc1
    v_mfma_f32_16x16x32_bf16 v[20:23], v[152:155], a[40:43], v[20:23]
    ds_read_b64_tr_b16 a[246:247], v161 offset:61440
    v_mfma_f32_16x16x32_bf16 v[12:15], v[152:155], a[36:39], v[12:15]
    ds_read_b64_tr_b16 v[128:129], v160 offset:0
    v_mfma_f32_16x16x32_bf16 v[12:15], v[156:159], a[52:55], v[12:15]
    ds_read_b64_tr_b16 v[130:131], v160 offset:4096
    v_mfma_f32_16x16x32_bf16 v[4:7], v[156:159], a[48:51], v[4:7]
    ds_read_b64_tr_b16 v[132:133], v160 offset:8192
    v_mfma_f32_16x16x32_bf16 v[4:7], v[152:155], a[32:35], v[4:7]
    s_waitcnt lgkmcnt(3)
    v_mfma_f32_16x16x32_bf16 v[0:3], a[232:235], a[64:67], v[0:3]
    ds_read_b64_tr_b16 v[134:135], v160 offset:12288
    v_mfma_f32_16x16x32_bf16 v[0:3], a[236:239], a[80:83], v[0:3]
    ds_read_b64_tr_b16 v[136:137], v161 offset:0
    v_mfma_f32_16x16x32_bf16 v[8:11], a[236:239], a[84:87], v[8:11]
    ds_read_b64_tr_b16 v[138:139], v161 offset:4096
    v_mfma_f32_16x16x32_bf16 v[8:11], a[232:235], a[68:71], v[8:11]
    v_mfma_f32_16x16x32_bf16 v[16:19], a[232:235], a[72:75], v[16:19]
    ds_read_b64_tr_b16 v[140:141], v161 offset:8192
    v_mfma_f32_16x16x32_bf16 v[16:19], a[236:239], a[88:91], v[16:19]
    v_mfma_f32_16x16x32_bf16 v[24:27], a[236:239], a[92:95], v[24:27]
    ds_read_b64_tr_b16 v[142:143], v161 offset:12288
    v_mfma_f32_16x16x32_bf16 v[24:27], a[232:235], a[76:79], v[24:27]
    v_mfma_f32_16x16x32_bf16 v[28:31], a[240:243], a[76:79], v[28:31]
    ds_read_b64_tr_b16 v[144:145], v160 offset:16384
    v_mfma_f32_16x16x32_bf16 v[28:31], a[244:247], a[92:95], v[28:31]
    v_mfma_f32_16x16x32_bf16 v[20:23], a[244:247], a[88:91], v[20:23]
    ds_read_b64_tr_b16 v[146:147], v160 offset:20480
    v_mfma_f32_16x16x32_bf16 v[20:23], a[240:243], a[72:75], v[20:23]
    v_mfma_f32_16x16x32_bf16 v[12:15], a[240:243], a[68:71], v[12:15]
    ds_read_b64_tr_b16 v[148:149], v160 offset:24576
    v_mfma_f32_16x16x32_bf16 v[12:15], a[244:247], a[84:87], v[12:15]
    v_mfma_f32_16x16x32_bf16 v[4:7], a[244:247], a[80:83], v[4:7]
    ds_read_b64_tr_b16 v[150:151], v160 offset:28672
    v_mfma_f32_16x16x32_bf16 v[4:7], a[240:243], a[64:67], v[4:7]
    s_waitcnt lgkmcnt(4)
    v_mfma_f32_16x16x32_bf16 v[0:3], v[128:131], a[96:99], v[0:3]
    ds_read_b64_tr_b16 v[152:153], v161 offset:16384
    v_mfma_f32_16x16x32_bf16 v[0:3], v[132:135], a[112:115], v[0:3]
    v_mfma_f32_16x16x32_bf16 v[8:11], v[132:135], a[116:119], v[8:11]
    ds_read_b64_tr_b16 v[154:155], v161 offset:20480
    v_mfma_f32_16x16x32_bf16 v[8:11], v[128:131], a[100:103], v[8:11]
    v_mfma_f32_16x16x32_bf16 v[16:19], v[128:131], a[104:107], v[16:19]
    ds_read_b64_tr_b16 v[156:157], v161 offset:24576
    v_mfma_f32_16x16x32_bf16 v[16:19], v[132:135], a[120:123], v[16:19]
    v_mfma_f32_16x16x32_bf16 v[24:27], v[132:135], a[124:127], v[24:27]
    ds_read_b64_tr_b16 v[158:159], v161 offset:28672
    v_mfma_f32_16x16x32_bf16 v[24:27], v[128:131], a[108:111], v[24:27]
    v_mfma_f32_16x16x32_bf16 v[28:31], v[136:139], a[108:111], v[28:31]
    ds_read_b64_tr_b16 a[232:233], v160 offset:32768
    v_mfma_f32_16x16x32_bf16 v[28:31], v[140:143], a[124:127], v[28:31]
    v_mfma_f32_16x16x32_bf16 v[20:23], v[140:143], a[120:123], v[20:23]
    ds_read_b64_tr_b16 a[234:235], v160 offset:36864
    v_mfma_f32_16x16x32_bf16 v[20:23], v[136:139], a[104:107], v[20:23]
    v_mfma_f32_16x16x32_bf16 v[12:15], v[136:139], a[100:103], v[12:15]
    ds_read_b64_tr_b16 a[236:237], v160 offset:40960
    v_mfma_f32_16x16x32_bf16 v[12:15], v[140:143], a[116:119], v[12:15]
    v_mfma_f32_16x16x32_bf16 v[4:7], v[140:143], a[112:115], v[4:7]
    ds_read_b64_tr_b16 a[238:239], v160 offset:45056
    v_mfma_f32_16x16x32_bf16 v[4:7], v[136:139], a[96:99], v[4:7]
    s_waitcnt lgkmcnt(4)
    v_mfma_f32_16x16x32_bf16 v[0:3], v[144:147], a[136:139], v[0:3]
    ds_read_b64_tr_b16 a[240:241], v161 offset:32768
    v_mfma_f32_16x16x32_bf16 v[0:3], v[148:151], a[152:155], v[0:3]
    v_mfma_f32_16x16x32_bf16 v[8:11], v[148:151], a[156:159], v[8:11]
    ds_read_b64_tr_b16 a[242:243], v161 offset:36864
    v_mfma_f32_16x16x32_bf16 v[8:11], v[144:147], a[140:143], v[8:11]
    v_mfma_f32_16x16x32_bf16 v[16:19], v[144:147], a[144:147], v[16:19]
    ds_read_b64_tr_b16 a[244:245], v161 offset:40960
    v_mfma_f32_16x16x32_bf16 v[16:19], v[148:151], a[160:163], v[16:19]
    v_mfma_f32_16x16x32_bf16 v[24:27], v[148:151], a[164:167], v[24:27]
    ds_read_b64_tr_b16 a[246:247], v161 offset:45056
    v_mfma_f32_16x16x32_bf16 v[24:27], v[144:147], a[148:151], v[24:27]
    v_mfma_f32_16x16x32_bf16 v[28:31], v[152:155], a[148:151], v[28:31]
    ds_read_b64_tr_b16 v[128:129], v250 offset:16384
    v_mfma_f32_16x16x32_bf16 v[28:31], v[156:159], a[164:167], v[28:31]
    v_mfma_f32_16x16x32_bf16 v[20:23], v[156:159], a[160:163], v[20:23]
    ds_read_b64_tr_b16 v[130:131], v250 offset:20480
    v_mfma_f32_16x16x32_bf16 v[20:23], v[152:155], a[144:147], v[20:23]
    v_mfma_f32_16x16x32_bf16 v[12:15], v[152:155], a[140:143], v[12:15]
    ds_read_b64_tr_b16 v[132:133], v250 offset:24576
    v_mfma_f32_16x16x32_bf16 v[12:15], v[156:159], a[156:159], v[12:15]
    v_mfma_f32_16x16x32_bf16 v[4:7], v[156:159], a[152:155], v[4:7]
    ds_read_b64_tr_b16 v[134:135], v250 offset:28672
    v_mfma_f32_16x16x32_bf16 v[4:7], v[152:155], a[136:139], v[4:7]
    s_waitcnt lgkmcnt(4)
    v_mfma_f32_16x16x32_bf16 v[0:3], a[232:235], a[168:171], v[0:3]
    ds_read_b64_tr_b16 v[136:137], v251 offset:16384
    v_mfma_f32_16x16x32_bf16 v[0:3], a[236:239], a[184:187], v[0:3]
    v_mfma_f32_16x16x32_bf16 v[8:11], a[236:239], a[188:191], v[8:11]
    ds_read_b64_tr_b16 v[138:139], v251 offset:20480
    v_mfma_f32_16x16x32_bf16 v[8:11], a[232:235], a[172:175], v[8:11]
    v_mfma_f32_16x16x32_bf16 v[16:19], a[232:235], a[176:179], v[16:19]
    ds_read_b64_tr_b16 v[140:141], v251 offset:24576
    v_mfma_f32_16x16x32_bf16 v[16:19], a[236:239], a[192:195], v[16:19]
    v_mfma_f32_16x16x32_bf16 v[24:27], a[236:239], a[196:199], v[24:27]
    ds_read_b64_tr_b16 v[142:143], v251 offset:28672
    v_mfma_f32_16x16x32_bf16 v[24:27], a[232:235], a[180:183], v[24:27]
    v_mfma_f32_16x16x32_bf16 v[28:31], a[240:243], a[180:183], v[28:31]
    v_mfma_f32_16x16x32_bf16 v[28:31], a[244:247], a[196:199], v[28:31]
    v_mfma_f32_16x16x32_bf16 v[20:23], a[244:247], a[192:195], v[20:23]
    v_mfma_f32_16x16x32_bf16 v[20:23], a[240:243], a[176:179], v[20:23]
    v_mfma_f32_16x16x32_bf16 v[12:15], a[240:243], a[172:175], v[12:15]
    v_mfma_f32_16x16x32_bf16 v[12:15], a[244:247], a[188:191], v[12:15]
    v_mfma_f32_16x16x32_bf16 v[4:7], a[244:247], a[184:187], v[4:7]
    v_mfma_f32_16x16x32_bf16 v[4:7], a[240:243], a[168:171], v[4:7]
    s_waitcnt lgkmcnt(0)
    v_mfma_f32_16x16x32_bf16 v[0:3], v[128:131], a[200:203], v[0:3]
    buffer_load_dwordx4 v[192:195], v240, s[40:43], s82 offen sc1
    v_mfma_f32_16x16x32_bf16 v[0:3], v[132:135], a[216:219], v[0:3]
    v_mfma_f32_16x16x32_bf16 v[4:7], v[140:143], a[216:219], v[4:7]
    buffer_load_dwordx4 v[196:199], v241, s[40:43], s82 offen sc1
    v_mfma_f32_16x16x32_bf16 v[4:7], v[136:139], a[200:203], v[4:7]
    v_mfma_f32_16x16x32_bf16 v[12:15], v[136:139], a[204:207], v[12:15]
    buffer_load_dwordx4 v[200:203], v242, s[40:43], s82 offen sc1
    v_mfma_f32_16x16x32_bf16 v[12:15], v[140:143], a[220:223], v[12:15]
    v_mfma_f32_16x16x32_bf16 v[8:11], v[132:135], a[220:223], v[8:11]
    buffer_load_dwordx4 v[204:207], v243, s[40:43], s82 offen sc1
    v_mfma_f32_16x16x32_bf16 v[8:11], v[128:131], a[204:207], v[8:11]
    v_mfma_f32_16x16x32_bf16 v[16:19], v[128:131], a[208:211], v[16:19]
    v_mfma_f32_16x16x32_bf16 v[16:19], v[132:135], a[224:227], v[16:19]
    v_mfma_f32_16x16x32_bf16 v[20:23], v[140:143], a[224:227], v[20:23]
    v_mfma_f32_16x16x32_bf16 v[20:23], v[136:139], a[208:211], v[20:23]
    v_mfma_f32_16x16x32_bf16 v[28:31], v[136:139], a[212:215], v[28:31]
    v_mfma_f32_16x16x32_bf16 v[28:31], v[140:143], a[228:231], v[28:31]
    v_mfma_f32_16x16x32_bf16 v[24:27], v[132:135], a[228:231], v[24:27]
    v_mfma_f32_16x16x32_bf16 v[24:27], v[128:131], a[212:215], v[24:27]
    s_branch L_g2_fin
L_eg12:
    s_waitcnt vmcnt(39)
    s_barrier
    v_mfma_f32_16x16x32_bf16 v[92:95], v[136:139], a[44:47], v[92:95]
    ds_read_b64_tr_b16 a[232:233], v162 offset:49152
    v_mfma_f32_16x16x32_bf16 v[92:95], v[140:143], a[60:63], v[92:95]
    buffer_load_dwordx4 a[4:7], v241, s[40:43], s95 offen sc1
    v_mfma_f32_16x16x32_bf16 v[84:87], v[140:143], a[56:59], v[84:87]
    ds_read_b64_tr_b16 a[234:235], v162 offset:53248
    v_mfma_f32_16x16x32_bf16 v[84:87], v[136:139], a[40:43], v[84:87]
    buffer_load_dwordx4 a[8:11], v242, s[40:43], s95 offen sc1
    v_mfma_f32_16x16x32_bf16 v[76:79], v[136:139], a[36:39], v[76:79]
    ds_read_b64_tr_b16 a[236:237], v162 offset:57344
    v_mfma_f32_16x16x32_bf16 v[76:79], v[140:143], a[52:55], v[76:79]
    v_mfma_f32_16x16x32_bf16 v[68:71], v[140:143], a[48:51], v[68:71]
    ds_read_b64_tr_b16 a[238:239], v162 offset:61440
    v_mfma_f32_16x16x32_bf16 v[68:71], v[136:139], a[32:35], v[68:71]
    s_waitcnt lgkmcnt(4)
    v_mfma_f32_16x16x32_bf16 v[96:99], v[144:147], a[32:35], v[96:99]
    ds_read_b64_tr_b16 a[240:241], v163 offset:49152
    v_mfma_f32_16x16x32_bf16 v[96:99], v[148:151], a[48:51], v[96:99]
    buffer_load_dwordx4 a[12:15], v243, s[40:43], s95 offen sc1
    v_mfma_f32_16x16x32_bf16 v[104:107], v[148:151], a[52:55], v[104:107]
    ds_read_b64_tr_b16 a[242:243], v163 offset:53248
    v_mfma_f32_16x16x32_bf16 v[104:107], v[144:147], a[36:39], v[104:107]
    v_readlane_b32 s92, v246, 35
    v_mfma_f32_16x16x32_bf16 v[112:115], v[144:147], a[40:43], v[112:115]
    ds_read_b64_tr_b16 a[244:245], v163 offset:57344
    v_mfma_f32_16x16x32_bf16 v[112:115], v[148:151], a[56:59], v[112:115]
    v_mfma_f32_16x16x32_bf16 v[120:123], v[148:151], a[60:63], v[120:123]
    ds_read_b64_tr_b16 a[246:247], v163 offset:61440
    v_mfma_f32_16x16x32_bf16 v[120:123], v[144:147], a[44:47], v[120:123]
    buffer_load_dwordx4 a[16:19], v240, s[40:43], s92 offen sc1
    v_mfma_f32_16x16x32_bf16 v[124:127], v[152:155], a[44:47], v[124:127]
    ds_read_b64_tr_b16 v[128:129], v162 offset:0
    v_mfma_f32_16x16x32_bf16 v[124:127], v[156:159], a[60:63], v[124:127]
    buffer_load_dwordx4 a[20:23], v241, s[40:43], s92 offen sc1
    v_mfma_f32_16x16x32_bf16 v[116:119], v[156:159], a[56:59], v[116:119]
    ds_read_b64_tr_b16 v[130:131], v162 offset:4096
    v_mfma_f32_16x16x32_bf16 v[116:119], v[152:155], a[40:43], v[116:119]
    buffer_load_dwordx4 a[24:27], v242, s[40:43], s92 offen sc1
    v_mfma_f32_16x16x32_bf16 v[108:111], v[152:155], a[36:39], v[108:111]
    ds_read_b64_tr_b16 v[132:133], v162 offset:8192
    v_mfma_f32_16x16x32_bf16 v[108:111], v[156:159], a[52:55], v[108:111]
    v_mfma_f32_16x16x32_bf16 v[100:103], v[156:159], a[48:51], v[100:103]
    ds_read_b64_tr_b16 v[134:135], v162 offset:12288
    v_mfma_f32_16x16x32_bf16 v[100:103], v[152:155], a[32:35], v[100:103]
    s_waitcnt lgkmcnt(4)
    v_mfma_f32_16x16x32_bf16 v[32:35], a[232:235], a[64:67], v[32:35]
    ds_read_b64_tr_b16 v[136:137], v163 offset:0
    v_mfma_f32_16x16x32_bf16 v[32:35], a[236:239], a[80:83], v[32:35]
    buffer_load_dwordx4 a[28:31], v243, s[40:43], s92 offen sc1
    v_mfma_f32_16x16x32_bf16 v[40:43], a[236:239], a[84:87], v[40:43]
    ds_read_b64_tr_b16 v[138:139], v163 offset:4096
    v_mfma_f32_16x16x32_bf16 v[40:43], a[232:235], a[68:71], v[40:43]
    v_mfma_f32_16x16x32_bf16 v[48:51], a[232:235], a[72:75], v[48:51]
    ds_read_b64_tr_b16 v[140:141], v163 offset:8192
    v_mfma_f32_16x16x32_bf16 v[48:51], a[236:239], a[88:91], v[48:51]
    v_mfma_f32_16x16x32_bf16 v[56:59], a[236:239], a[92:95], v[56:59]
    ds_read_b64_tr_b16 v[142:143], v163 offset:12288
    v_mfma_f32_16x16x32_bf16 v[56:59], a[232:235], a[76:79], v[56:59]
    v_mfma_f32_16x16x32_bf16 v[60:63], a[240:243], a[76:79], v[60:63]
    ds_read_b64_tr_b16 v[144:145], v162 offset:16384
    v_mfma_f32_16x16x32_bf16 v[60:63], a[244:247], a[92:95], v[60:63]
    v_mfma_f32_16x16x32_bf16 v[52:55], a[244:247], a[88:91], v[52:55]
    ds_read_b64_tr_b16 v[146:147], v162 offset:20480
    v_mfma_f32_16x16x32_bf16 v[52:55], a[240:243], a[72:75], v[52:55]
    v_mfma_f32_16x16x32_bf16 v[44:47], a[240:243], a[68:71], v[44:47]
    ds_read_b64_tr_b16 v[148:149], v162 offset:24576
    v_mfma_f32_16x16x32_bf16 v[44:47], a[244:247], a[84:87], v[44:47]
    v_mfma_f32_16x16x32_bf16 v[36:39], a[244:247], a[80:83], v[36:39]
    ds_read_b64_tr_b16 v[150:151], v162 offset:28672
    v_mfma_f32_16x16x32_bf16 v[36:39], a[240:243], a[64:67], v[36:39]
    s_waitcnt lgkmcnt(4)
    v_mfma_f32_16x16x32_bf16 v[32:35], v[128:131], a[96:99], v[32:35]
    ds_read_b64_tr_b16 v[152:153], v163 offset:16384
    v_mfma_f32_16x16x32_bf16 v[32:35], v[132:135], a[112:115], v[32:35]
    v_mfma_f32_16x16x32_bf16 v[40:43], v[132:135], a[116:119], v[40:43]
    ds_read_b64_tr_b16 v[154:155], v163 offset:20480
    v_mfma_f32_16x16x32_bf16 v[40:43], v[128:131], a[100:103], v[40:43]
    v_mfma_f32_16x16x32_bf16 v[48:51], v[128:131], a[104:107], v[48:51]
    ds_read_b64_tr_b16 v[156:157], v163 offset:24576
    v_mfma_f32_16x16x32_bf16 v[48:51], v[132:135], a[120:123], v[48:51]
    v_mfma_f32_16x16x32_bf16 v[56:59], v[132:135], a[124:127], v[56:59]
    ds_read_b64_tr_b16 v[158:159], v163 offset:28672
    v_mfma_f32_16x16x32_bf16 v[56:59], v[128:131], a[108:111], v[56:59]
    s_waitcnt vmcnt(34)
    s_barrier
    v_mfma_f32_16x16x32_bf16 v[60:63], v[136:139], a[108:111], v[60:63]
    ds_read_b64_tr_b16 a[232:233], v162 offset:32768
    v_mfma_f32_16x16x32_bf16 v[60:63], v[140:143], a[124:127], v[60:63]
    v_mfma_f32_16x16x32_bf16 v[52:55], v[140:143], a[120:123], v[52:55]
    ds_read_b64_tr_b16 a[234:235], v162 offset:36864
    v_mfma_f32_16x16x32_bf16 v[52:55], v[136:139], a[104:107], v[52:55]
    v_mfma_f32_16x16x32_bf16 v[44:47], v[136:139], a[100:103], v[44:47]
    ds_read_b64_tr_b16 a[236:237], v162 offset:40960
    v_mfma_f32_16x16x32_bf16 v[44:47], v[140:143], a[116:119], v[44:47]
    v_mfma_f32_16x16x32_bf16 v[36:39], v[140:143], a[112:115], v[36:39]
    ds_read_b64_tr_b16 a[238:239], v162 offset:45056
    v_mfma_f32_16x16x32_bf16 v[36:39], v[136:139], a[96:99], v[36:39]
    s_waitcnt lgkmcnt(4)
    v_mfma_f32_16x16x32_bf16 v[32:35], v[144:147], a[136:139], v[32:35]
    ds_read_b64_tr_b16 a[240:241], v163 offset:32768
    v_mfma_f32_16x16x32_bf16 v[32:35], v[148:151], a[152:155], v[32:35]
    v_mfma_f32_16x16x32_bf16 v[40:43], v[148:151], a[156:159], v[40:43]
    ds_read_b64_tr_b16 a[242:243], v163 offset:36864
    v_mfma_f32_16x16x32_bf16 v[40:43], v[144:147], a[140:143], v[40:43]
    v_mfma_f32_16x16x32_bf16 v[48:51], v[144:147], a[144:147], v[48:51]
    ds_read_b64_tr_b16 a[244:245], v163 offset:40960
    v_mfma_f32_16x16x32_bf16 v[48:51], v[148:151], a[160:163], v[48:51]
    buffer_load_dwordx2 v[176:177], v228, s[24:27], s88 offen offset:0
    v_mfma_f32_16x16x32_bf16 v[56:59], v[148:151], a[164:167], v[56:59]
    ds_read_b64_tr_b16 a[246:247], v163 offset:45056
    v_mfma_f32_16x16x32_bf16 v[56:59], v[144:147], a[148:151], v[56:59]
    v_mfma_f32_16x16x32_bf16 v[60:63], v[152:155], a[148:151], v[60:63]
    ds_read_b64_tr_b16 v[128:129], v164 offset:49152
    v_mfma_f32_16x16x32_bf16 v[60:63], v[156:159], a[164:167], v[60:63]
    v_mfma_f32_16x16x32_bf16 v[52:55], v[156:159], a[160:163], v[52:55]
    ds_read_b64_tr_b16 v[130:131], v164 offset:53248
    v_mfma_f32_16x16x32_bf16 v[52:55], v[152:155], a[144:147], v[52:55]
    v_mfma_f32_16x16x32_bf16 v[44:47], v[152:155], a[140:143], v[44:47]
    ds_read_b64_tr_b16 v[132:133], v164 offset:57344
    v_mfma_f32_16x16x32_bf16 v[44:47], v[156:159], a[156:159], v[44:47]
    buffer_load_dwordx2 v[178:179], v228, s[24:27], s88 offen offset:32
    v_mfma_f32_16x16x32_bf16 v[36:39], v[156:159], a[152:155], v[36:39]
    ds_read_b64_tr_b16 v[134:135], v164 offset:61440
    v_mfma_f32_16x16x32_bf16 v[36:39], v[152:155], a[136:139], v[36:39]
    s_waitcnt vmcnt(28) lgkmcnt(4)
    v_mfma_f32_16x16x32_bf16 v[32:35], a[232:235], a[168:171], v[32:35]
    ds_read_b64_tr_b16 v[136:137], v165 offset:49152
    v_mfma_f32_16x16x32_bf16 v[32:35], a[236:239], a[184:187], v[32:35]
    v_mfma_f32_16x16x32_bf16 v[40:43], a[236:239], a[188:191], v[40:43]
    ds_read_b64_tr_b16 v[138:139], v165 offset:53248
    v_mfma_f32_16x16x32_bf16 v[40:43], a[232:235], a[172:175], v[40:43]
    buffer_load_dwordx2 v[180:181], v228, s[24:27], s89 offen offset:0
    v_mfma_f32_16x16x32_bf16 v[48:51], a[232:235], a[176:179], v[48:51]
    ds_read_b64_tr_b16 v[140:141], v165 offset:57344
    v_mfma_f32_16x16x32_bf16 v[48:51], a[236:239], a[192:195], v[48:51]
    v_mfma_f32_16x16x32_bf16 v[56:59], a[236:239], a[196:199], v[56:59]
    ds_read_b64_tr_b16 v[142:143], v165 offset:61440
    v_mfma_f32_16x16x32_bf16 v[56:59], a[232:235], a[180:183], v[56:59]
    s_waitcnt vmcnt(25)
    s_barrier
    v_mfma_f32_16x16x32_bf16 v[60:63], a[240:243], a[180:183], v[60:63]
    ds_read_b64_tr_b16 v[144:145], v252 offset:16384
    v_mfma_f32_16x16x32_bf16 v[60:63], a[244:247], a[196:199], v[60:63]
    v_mfma_f32_16x16x32_bf16 v[52:55], a[244:247], a[192:195], v[52:55]
    ds_read_b64_tr_b16 v[146:147], v252 offset:20480
    v_mfma_f32_16x16x32_bf16 v[52:55], a[240:243], a[176:179], v[52:55]
    buffer_load_dwordx2 v[182:183], v228, s[24:27], s89 offen offset:32
    v_mfma_f32_16x16x32_bf16 v[44:47], a[240:243], a[172:175], v[44:47]
    ds_read_b64_tr_b16 v[148:149], v252 offset:24576
    v_mfma_f32_16x16x32_bf16 v[44:47], a[244:247], a[188:191], v[44:47]
    v_mfma_f32_16x16x32_bf16 v[36:39], a[244:247], a[184:187], v[36:39]
    ds_read_b64_tr_b16 v[150:151], v252 offset:28672
    v_mfma_f32_16x16x32_bf16 v[36:39], a[240:243], a[168:171], v[36:39]
    s_waitcnt lgkmcnt(4)
    v_mfma_f32_16x16x32_bf16 v[64:67], v[128:131], a[64:67], v[64:67]
    ds_read_b64_tr_b16 v[152:153], v253 offset:16384
    v_mfma_f32_16x16x32_bf16 v[64:67], v[132:135], a[80:83], v[64:67]
    v_mfma_f32_16x16x32_bf16 v[72:75], v[132:135], a[84:87], v[72:75]
    ds_read_b64_tr_b16 v[154:155], v253 offset:20480
    v_mfma_f32_16x16x32_bf16 v[72:75], v[128:131], a[68:71], v[72:75]
    buffer_load_dwordx2 v[184:185], v228, s[24:27], s90 offen offset:0
    v_mfma_f32_16x16x32_bf16 v[80:83], v[128:131], a[72:75], v[80:83]
    ds_read_b64_tr_b16 v[156:157], v253 offset:24576
    v_mfma_f32_16x16x32_bf16 v[80:83], v[132:135], a[88:91], v[80:83]
    v_mfma_f32_16x16x32_bf16 v[88:91], v[132:135], a[92:95], v[88:91]
    ds_read_b64_tr_b16 v[158:159], v253 offset:28672
    v_mfma_f32_16x16x32_bf16 v[88:91], v[128:131], a[76:79], v[88:91]
    v_mfma_f32_16x16x32_bf16 v[92:95], v[136:139], a[76:79], v[92:95]
    ds_read_b64_tr_b16 a[232:233], v164 offset:0
    v_mfma_f32_16x16x32_bf16 v[92:95], v[140:143], a[92:95], v[92:95]
    v_mfma_f32_16x16x32_bf16 v[84:87], v[140:143], a[88:91], v[84:87]
    ds_read_b64_tr_b16 a[234:235], v164 offset:4096
    v_mfma_f32_16x16x32_bf16 v[84:87], v[136:139], a[72:75], v[84:87]
    buffer_load_dwordx2 v[186:187], v228, s[24:27], s90 offen offset:32
    v_mfma_f32_16x16x32_bf16 v[76:79], v[136:139], a[68:71], v[76:79]
    ds_read_b64_tr_b16 a[236:237], v164 offset:8192
    v_mfma_f32_16x16x32_bf16 v[76:79], v[140:143], a[84:87], v[76:79]
    buffer_load_dword v170, v230, s[44:47], s77 offen offset:768 sc1
    v_mfma_f32_16x16x32_bf16 v[68:71], v[140:143], a[80:83], v[68:71]
    ds_read_b64_tr_b16 a[238:239], v164 offset:12288
    v_mfma_f32_16x16x32_bf16 v[68:71], v[136:139], a[64:67], v[68:71]
    s_waitcnt vmcnt(19) lgkmcnt(4)
    v_mfma_f32_16x16x32_bf16 v[32:35], v[144:147], a[200:203], v[32:35]
    ds_read_b64_tr_b16 a[240:241], v165 offset:0
    v_mfma_f32_16x16x32_bf16 v[32:35], v[148:151], a[216:219], v[32:35]
    buffer_load_dwordx2 v[188:189], v228, s[24:27], s91 offen offset:0
    v_mfma_f32_16x16x32_bf16 v[40:43], v[148:151], a[220:223], v[40:43]
    ds_read_b64_tr_b16 a[242:243], v165 offset:4096
    v_mfma_f32_16x16x32_bf16 v[40:43], v[144:147], a[204:207], v[40:43]
    v_mfma_f32_16x16x32_bf16 v[48:51], v[144:147], a[208:211], v[48:51]
    ds_read_b64_tr_b16 a[244:245], v165 offset:8192
    v_mfma_f32_16x16x32_bf16 v[48:51], v[148:151], a[224:227], v[48:51]
    v_mfma_f32_16x16x32_bf16 v[56:59], v[148:151], a[228:231], v[56:59]
    ds_read_b64_tr_b16 a[246:247], v165 offset:12288
    v_mfma_f32_16x16x32_bf16 v[56:59], v[144:147], a[212:215], v[56:59]
    v_mfma_f32_16x16x32_bf16 v[60:63], v[152:155], a[212:215], v[60:63]
    ds_read_b64_tr_b16 v[128:129], v164 offset:16384
    v_mfma_f32_16x16x32_bf16 v[60:63], v[156:159], a[228:231], v[60:63]
    buffer_load_dwordx2 v[190:191], v228, s[24:27], s91 offen offset:32
    v_mfma_f32_16x16x32_bf16 v[52:55], v[156:159], a[224:227], v[52:55]
    ds_read_b64_tr_b16 v[130:131], v164 offset:20480
    v_mfma_f32_16x16x32_bf16 v[52:55], v[152:155], a[208:211], v[52:55]
    v_mfma_f32_16x16x32_bf16 v[44:47], v[152:155], a[204:207], v[44:47]
    ds_read_b64_tr_b16 v[132:133], v164 offset:24576
    v_mfma_f32_16x16x32_bf16 v[44:47], v[156:159], a[220:223], v[44:47]
    v_mfma_f32_16x16x32_bf16 v[36:39], v[156:159], a[216:219], v[36:39]
    ds_read_b64_tr_b16 v[134:135], v164 offset:28672
    v_mfma_f32_16x16x32_bf16 v[36:39], v[152:155], a[200:203], v[36:39]
    s_waitcnt lgkmcnt(4)
    v_mfma_f32_16x16x32_bf16 v[64:67], a[232:235], a[96:99], v[64:67]
    ds_read_b64_tr_b16 v[136:137], v165 offset:16384
    v_mfma_f32_16x16x32_bf16 v[64:67], a[236:239], a[112:115], v[64:67]
    v_mfma_f32_16x16x32_bf16 v[72:75], a[236:239], a[116:119], v[72:75]
    ds_read_b64_tr_b16 v[138:139], v165 offset:20480
    v_mfma_f32_16x16x32_bf16 v[72:75], a[232:235], a[100:103], v[72:75]
    v_mfma_f32_16x16x32_bf16 v[80:83], a[232:235], a[104:107], v[80:83]
    ds_read_b64_tr_b16 v[140:141], v165 offset:24576
    v_mfma_f32_16x16x32_bf16 v[80:83], a[236:239], a[120:123], v[80:83]
    v_mfma_f32_16x16x32_bf16 v[88:91], a[236:239], a[124:127], v[88:91]
    ds_read_b64_tr_b16 v[142:143], v165 offset:28672
    v_mfma_f32_16x16x32_bf16 v[88:91], a[232:235], a[108:111], v[88:91]
    s_waitcnt vmcnt(17)
    s_barrier
    v_mfma_f32_16x16x32_bf16 v[92:95], a[240:243], a[108:111], v[92:95]
    ds_read_b64_tr_b16 v[144:145], v252 offset:32768
    v_mfma_f32_16x16x32_bf16 v[92:95], a[244:247], a[124:127], v[92:95]
    v_mfma_f32_16x16x32_bf16 v[84:87], a[244:247], a[120:123], v[84:87]
    ds_read_b64_tr_b16 v[146:147], v252 offset:36864
    v_mfma_f32_16x16x32_bf16 v[84:87], a[240:243], a[104:107], v[84:87]
    v_mfma_f32_16x16x32_bf16 v[76:79], a[240:243], a[100:103], v[76:79]
    ds_read_b64_tr_b16 v[148:149], v252 offset:40960
    v_mfma_f32_16x16x32_bf16 v[76:79], a[244:247], a[116:119], v[76:79]
    v_mfma_f32_16x16x32_bf16 v[68:71], a[244:247], a[112:115], v[68:71]
    ds_read_b64_tr_b16 v[150:151], v252 offset:45056
    v_mfma_f32_16x16x32_bf16 v[68:71], a[240:243], a[96:99], v[68:71]
    s_waitcnt lgkmcnt(4)
    v_mfma_f32_16x16x32_bf16 v[64:67], v[128:131], a[136:139], v[64:67]
    ds_read_b64_tr_b16 v[152:153], v253 offset:32768
    v_mfma_f32_16x16x32_bf16 v[64:67], v[132:135], a[152:155], v[64:67]
    v_mfma_f32_16x16x32_bf16 v[72:75], v[132:135], a[156:159], v[72:75]
    ds_read_b64_tr_b16 v[154:155], v253 offset:36864
    v_mfma_f32_16x16x32_bf16 v[72:75], v[128:131], a[140:143], v[72:75]
    v_mfma_f32_16x16x32_bf16 v[80:83], v[128:131], a[144:147], v[80:83]
    ds_read_b64_tr_b16 v[156:157], v253 offset:40960
    v_mfma_f32_16x16x32_bf16 v[80:83], v[132:135], a[160:163], v[80:83]
    v_mfma_f32_16x16x32_bf16 v[88:91], v[132:135], a[164:167], v[88:91]
    ds_read_b64_tr_b16 v[158:159], v253 offset:45056
    v_mfma_f32_16x16x32_bf16 v[88:91], v[128:131], a[148:151], v[88:91]
    v_mfma_f32_16x16x32_bf16 v[92:95], v[136:139], a[148:151], v[92:95]
    ds_read_b64_tr_b16 a[232:233], v164 offset:32768
    v_mfma_f32_16x16x32_bf16 v[92:95], v[140:143], a[164:167], v[92:95]
    v_mfma_f32_16x16x32_bf16 v[84:87], v[140:143], a[160:163], v[84:87]
    ds_read_b64_tr_b16 a[234:235], v164 offset:36864
    v_mfma_f32_16x16x32_bf16 v[84:87], v[136:139], a[144:147], v[84:87]
    v_mfma_f32_16x16x32_bf16 v[76:79], v[136:139], a[140:143], v[76:79]
    ds_read_b64_tr_b16 a[236:237], v164 offset:40960
    v_mfma_f32_16x16x32_bf16 v[76:79], v[140:143], a[156:159], v[76:79]
    v_mfma_f32_16x16x32_bf16 v[68:71], v[140:143], a[152:155], v[68:71]
    ds_read_b64_tr_b16 a[238:239], v164 offset:45056
    v_mfma_f32_16x16x32_bf16 v[68:71], v[136:139], a[136:139], v[68:71]
    s_waitcnt vmcnt(9) lgkmcnt(4)
    v_mfma_f32_16x16x32_bf16 v[32:35], v[144:147], a[0:3], v[32:35]
    ds_read_b64_tr_b16 a[240:241], v165 offset:32768
    v_mfma_f32_16x16x32_bf16 v[32:35], v[148:151], a[16:19], v[32:35]
    v_mfma_f32_16x16x32_bf16 v[36:39], v[156:159], a[16:19], v[36:39]
    ds_read_b64_tr_b16 a[242:243], v165 offset:36864
    v_mfma_f32_16x16x32_bf16 v[36:39], v[152:155], a[0:3], v[36:39]
    v_mfma_f32_16x16x32_bf16 v[44:47], v[152:155], a[4:7], v[44:47]
    ds_read_b64_tr_b16 a[244:245], v165 offset:40960
    v_mfma_f32_16x16x32_bf16 v[44:47], v[156:159], a[20:23], v[44:47]
    v_mfma_f32_16x16x32_bf16 v[40:43], v[148:151], a[20:23], v[40:43]
    ds_read_b64_tr_b16 a[246:247], v165 offset:45056
    v_mfma_f32_16x16x32_bf16 v[40:43], v[144:147], a[4:7], v[40:43]
    s_waitcnt vmcnt(2)
    v_cmp_eq_u32 s[4:5], v239, v170
    v_mfma_f32_16x16x32_bf16 v[48:51], v[144:147], a[8:11], v[48:51]
    ds_read_b64_tr_b16 v[128:129], v249 offset:16384
    v_mfma_f32_16x16x32_bf16 v[48:51], v[148:151], a[24:27], v[48:51]
    s_or_b32 s4, s4, s5
    s_cmp_eq_u32 s4, -1
    s_cbranch_scc0 L_slow_p412
L_back_p412:
    v_mfma_f32_16x16x32_bf16 v[52:55], v[156:159], a[24:27], v[52:55]
    ds_read_b64_tr_b16 v[130:131], v249 offset:20480
    v_mfma_f32_16x16x32_bf16 v[52:55], v[152:155], a[8:11], v[52:55]
    v_cvt_pk_bf16_f32 v32, v32, v33
    v_cvt_pk_bf16_f32 v33, v34, v35
    v_mfma_f32_16x16x32_bf16 v[60:63], v[152:155], a[12:15], v[60:63]
    ds_read_b64_tr_b16 v[132:133], v249 offset:24576
    v_mfma_f32_16x16x32_bf16 v[60:63], v[156:159], a[28:31], v[60:63]
    v_cvt_pk_bf16_f32 v34, v36, v37
    v_cvt_pk_bf16_f32 v35, v38, v39
    v_or_b32 v32, 1, v32
    v_mfma_f32_16x16x32_bf16 v[56:59], v[148:151], a[28:31], v[56:59]
    ds_read_b64_tr_b16 v[134:135], v249 offset:28672
    v_mfma_f32_16x16x32_bf16 v[56:59], v[144:147], a[12:15], v[56:59]
    s_waitcnt lgkmcnt(4)
    v_mfma_f32_16x16x32_bf16 v[64:67], a[232:235], a[168:171], v[64:67]
    ds_read_b64_tr_b16 v[136:137], v234 offset:16384
    v_mfma_f32_16x16x32_bf16 v[64:67], a[236:239], a[184:187], v[64:67]
    buffer_store_dwordx4 v[32:35], v240, s[40:43], s13 offen sc1
    v_mfma_f32_16x16x32_bf16 v[72:75], a[236:239], a[188:191], v[72:75]
    ds_read_b64_tr_b16 v[138:139], v234 offset:20480
    v_mfma_f32_16x16x32_bf16 v[72:75], a[232:235], a[172:175], v[72:75]
    v_cvt_pk_bf16_f32 v40, v40, v41
    v_cvt_pk_bf16_f32 v41, v42, v43
    v_mfma_f32_16x16x32_bf16 v[80:83], a[232:235], a[176:179], v[80:83]
    ds_read_b64_tr_b16 v[140:141], v234 offset:24576
    v_mfma_f32_16x16x32_bf16 v[80:83], a[236:239], a[192:195], v[80:83]
    v_cvt_pk_bf16_f32 v42, v44, v45
    v_cvt_pk_bf16_f32 v43, v46, v47
    v_or_b32 v40, 1, v40
    v_mfma_f32_16x16x32_bf16 v[88:91], a[236:239], a[196:199], v[88:91]
    ds_read_b64_tr_b16 v[142:143], v234 offset:28672
    v_mfma_f32_16x16x32_bf16 v[88:91], a[232:235], a[180:183], v[88:91]
    buffer_store_dwordx4 v[40:43], v241, s[40:43], s13 offen sc1
    v_mfma_f32_16x16x32_bf16 v[92:95], a[240:243], a[180:183], v[92:95]
    ds_read_b64_tr_b16 v[144:145], v249 offset:32768
    v_mfma_f32_16x16x32_bf16 v[92:95], a[244:247], a[196:199], v[92:95]
    v_cvt_pk_bf16_f32 v48, v48, v49
    v_cvt_pk_bf16_f32 v49, v50, v51
    v_mfma_f32_16x16x32_bf16 v[84:87], a[244:247], a[192:195], v[84:87]
    ds_read_b64_tr_b16 v[146:147], v249 offset:36864
    v_mfma_f32_16x16x32_bf16 v[84:87], a[240:243], a[176:179], v[84:87]
    v_cvt_pk_bf16_f32 v50, v52, v53
    v_cvt_pk_bf16_f32 v51, v54, v55
    v_or_b32 v48, 1, v48
    v_mfma_f32_16x16x32_bf16 v[76:79], a[240:243], a[172:175], v[76:79]
    ds_read_b64_tr_b16 v[148:149], v249 offset:40960
    v_mfma_f32_16x16x32_bf16 v[76:79], a[244:247], a[188:191], v[76:79]
    buffer_store_dwordx4 v[48:51], v242, s[40:43], s13 offen sc1
    v_mfma_f32_16x16x32_bf16 v[68:71], a[244:247], a[184:187], v[68:71]
    ds_read_b64_tr_b16 v[150:151], v249 offset:45056
    v_mfma_f32_16x16x32_bf16 v[68:71], a[240:243], a[168:171], v[68:71]
    s_waitcnt lgkmcnt(4)
    v_mfma_f32_16x16x32_bf16 v[64:67], v[128:131], a[200:203], v[64:67]
    ds_read_b64_tr_b16 v[152:153], v234 offset:32768
    v_mfma_f32_16x16x32_bf16 v[64:67], v[132:135], a[216:219], v[64:67]
    v_cvt_pk_bf16_f32 v56, v56, v57
    v_cvt_pk_bf16_f32 v57, v58, v59
    v_mfma_f32_16x16x32_bf16 v[72:75], v[132:135], a[220:223], v[72:75]
    ds_read_b64_tr_b16 v[154:155], v234 offset:36864
    v_mfma_f32_16x16x32_bf16 v[72:75], v[128:131], a[204:207], v[72:75]
    v_cvt_pk_bf16_f32 v58, v60, v61
    v_cvt_pk_bf16_f32 v59, v62, v63
    v_or_b32 v56, 1, v56
    v_mfma_f32_16x16x32_bf16 v[80:83], v[128:131], a[208:211], v[80:83]
    ds_read_b64_tr_b16 v[156:157], v234 offset:40960
    v_mfma_f32_16x16x32_bf16 v[80:83], v[132:135], a[224:227], v[80:83]
    buffer_store_dwordx4 v[56:59], v243, s[40:43], s13 offen sc1
    v_mfma_f32_16x16x32_bf16 v[88:91], v[132:135], a[228:231], v[88:91]
    ds_read_b64_tr_b16 v[158:159], v234 offset:45056
    v_mfma_f32_16x16x32_bf16 v[88:91], v[128:131], a[212:215], v[88:91]
    v_mfma_f32_16x16x32_bf16 v[92:95], v[136:139], a[212:215], v[92:95]
    ds_read_b64_tr_b16 a[232:233], v166 offset:49152
    v_mfma_f32_16x16x32_bf16 v[92:95], v[140:143], a[228:231], v[92:95]
    v_mfma_f32_16x16x32_bf16 v[84:87], v[140:143], a[224:227], v[84:87]
    ds_read_b64_tr_b16 a[234:235], v166 offset:53248
    v_mfma_f32_16x16x32_bf16 v[84:87], v[136:139], a[208:211], v[84:87]
    v_mfma_f32_16x16x32_bf16 v[76:79], v[136:139], a[204:207], v[76:79]
    ds_read_b64_tr_b16 a[236:237], v166 offset:57344
    v_mfma_f32_16x16x32_bf16 v[76:79], v[140:143], a[220:223], v[76:79]
    v_mfma_f32_16x16x32_bf16 v[68:71], v[140:143], a[216:219], v[68:71]
    ds_read_b64_tr_b16 a[238:239], v166 offset:61440
    v_mfma_f32_16x16x32_bf16 v[68:71], v[136:139], a[200:203], v[68:71]
    s_waitcnt lgkmcnt(4)
    v_mfma_f32_16x16x32_bf16 v[64:67], v[144:147], a[0:3], v[64:67]
    ds_read_b64_tr_b16 a[240:241], v167 offset:49152
    v_mfma_f32_16x16x32_bf16 v[64:67], v[148:151], a[16:19], v[64:67]
    ds_read_b64_tr_b16 a[242:243], v167 offset:53248
    v_mfma_f32_16x16x32_bf16 v[68:71], v[156:159], a[16:19], v[68:71]
    ds_read_b64_tr_b16 a[244:245], v167 offset:57344
    v_mfma_f32_16x16x32_bf16 v[68:71], v[152:155], a[0:3], v[68:71]
    ds_read_b64_tr_b16 a[246:247], v167 offset:61440
    v_mfma_f32_16x16x32_bf16 v[76:79], v[152:155], a[4:7], v[76:79]
    ds_read_b64_tr_b16 v[128:129], v166 offset:0
    v_mfma_f32_16x16x32_bf16 v[76:79], v[156:159], a[20:23], v[76:79]
    ds_read_b64_tr_b16 v[130:131], v166 offset:4096
    v_mfma_f32_16x16x32_bf16 v[72:75], v[148:151], a[20:23], v[72:75]
    v_cvt_pk_bf16_f32 v64, v64, v65
    v_cvt_pk_bf16_f32 v65, v66, v67
    v_mfma_f32_16x16x32_bf16 v[72:75], v[144:147], a[4:7], v[72:75]
    v_cvt_pk_bf16_f32 v66, v68, v69
    v_cvt_pk_bf16_f32 v67, v70, v71
    v_or_b32 v64, 1, v64
    v_mfma_f32_16x16x32_bf16 v[80:83], v[144:147], a[8:11], v[80:83]
    buffer_store_dwordx4 v[64:67], v240, s[40:43], s14 offen sc1
    v_mfma_f32_16x16x32_bf16 v[80:83], v[148:151], a[24:27], v[80:83]
    ds_read_b64_tr_b16 v[132:133], v166 offset:8192
    v_mfma_f32_16x16x32_bf16 v[84:87], v[156:159], a[24:27], v[84:87]
    v_cvt_pk_bf16_f32 v72, v72, v73
    v_cvt_pk_bf16_f32 v73, v74, v75
    v_mfma_f32_16x16x32_bf16 v[84:87], v[152:155], a[8:11], v[84:87]
    v_cvt_pk_bf16_f32 v74, v76, v77
    v_cvt_pk_bf16_f32 v75, v78, v79
    v_or_b32 v72, 1, v72
    v_mfma_f32_16x16x32_bf16 v[92:95], v[152:155], a[12:15], v[92:95]
    ds_read_b64_tr_b16 v[134:135], v166 offset:12288
    v_mfma_f32_16x16x32_bf16 v[92:95], v[156:159], a[28:31], v[92:95]
    buffer_store_dwordx4 v[72:75], v241, s[40:43], s14 offen sc1
    v_mfma_f32_16x16x32_bf16 v[88:91], v[148:151], a[28:31], v[88:91]
    v_cvt_pk_bf16_f32 v80, v80, v81
    v_cvt_pk_bf16_f32 v81, v82, v83
    v_mfma_f32_16x16x32_bf16 v[88:91], v[144:147], a[12:15], v[88:91]
    s_waitcnt lgkmcnt(4)
    v_mfma_f32_16x16x32_bf16 v[96:99], a[232:235], a[64:67], v[96:99]
    ds_read_b64_tr_b16 v[136:137], v167 offset:0
    v_mfma_f32_16x16x32_bf16 v[96:99], a[236:239], a[80:83], v[96:99]
    v_cvt_pk_bf16_f32 v82, v84, v85
    v_cvt_pk_bf16_f32 v83, v86, v87
    v_or_b32 v80, 1, v80
    v_mfma_f32_16x16x32_bf16 v[104:107], a[236:239], a[84:87], v[104:107]
    ds_read_b64_tr_b16 v[138:139], v167 offset:4096
    v_mfma_f32_16x16x32_bf16 v[104:107], a[232:235], a[68:71], v[104:107]
    v_mfma_f32_16x16x32_bf16 v[112:115], a[232:235], a[72:75], v[112:115]
    ds_read_b64_tr_b16 v[140:141], v167 offset:8192
    v_mfma_f32_16x16x32_bf16 v[112:115], a[236:239], a[88:91], v[112:115]
    buffer_store_dwordx4 v[80:83], v242, s[40:43], s14 offen sc1
    v_mfma_f32_16x16x32_bf16 v[120:123], a[236:239], a[92:95], v[120:123]
    ds_read_b64_tr_b16 v[142:143], v167 offset:12288
    v_mfma_f32_16x16x32_bf16 v[120:123], a[232:235], a[76:79], v[120:123]
    v_cvt_pk_bf16_f32 v88, v88, v89
    v_cvt_pk_bf16_f32 v89, v90, v91
    v_mfma_f32_16x16x32_bf16 v[124:127], a[240:243], a[76:79], v[124:127]
    ds_read_b64_tr_b16 v[144:145], v166 offset:16384
    v_mfma_f32_16x16x32_bf16 v[124:127], a[244:247], a[92:95], v[124:127]
    v_cvt_pk_bf16_f32 v90, v92, v93
    v_cvt_pk_bf16_f32 v91, v94, v95
    v_or_b32 v88, 1, v88
    v_mfma_f32_16x16x32_bf16 v[116:119], a[244:247], a[88:91], v[116:119]
    ds_read_b64_tr_b16 v[146:147], v166 offset:20480
    v_mfma_f32_16x16x32_bf16 v[116:119], a[240:243], a[72:75], v[116:119]
    buffer_store_dwordx4 v[88:91], v243, s[40:43], s14 offen sc1
    v_mfma_f32_16x16x32_bf16 v[108:111], a[240:243], a[68:71], v[108:111]
    ds_read_b64_tr_b16 v[148:149], v166 offset:24576
    v_mfma_f32_16x16x32_bf16 v[108:111], a[244:247], a[84:87], v[108:111]
    v_mfma_f32_16x16x32_bf16 v[100:103], a[244:247], a[80:83], v[100:103]
    ds_read_b64_tr_b16 v[150:151], v166 offset:28672
    v_mfma_f32_16x16x32_bf16 v[100:103], a[240:243], a[64:67], v[100:103]
    s_waitcnt lgkmcnt(4)
    v_mfma_f32_16x16x32_bf16 v[96:99], v[128:131], a[96:99], v[96:99]
    ds_read_b64_tr_b16 v[152:153], v167 offset:16384
    v_mfma_f32_16x16x32_bf16 v[96:99], v[132:135], a[112:115], v[96:99]
    v_mfma_f32_16x16x32_bf16 v[104:107], v[132:135], a[116:119], v[104:107]
    ds_read_b64_tr_b16 v[154:155], v167 offset:20480
    v_mfma_f32_16x16x32_bf16 v[104:107], v[128:131], a[100:103], v[104:107]
    v_mfma_f32_16x16x32_bf16 v[112:115], v[128:131], a[104:107], v[112:115]
    ds_read_b64_tr_b16 v[156:157], v167 offset:24576
    v_mfma_f32_16x16x32_bf16 v[112:115], v[132:135], a[120:123], v[112:115]
    v_mfma_f32_16x16x32_bf16 v[120:123], v[132:135], a[124:127], v[120:123]
    ds_read_b64_tr_b16 v[158:159], v167 offset:28672
    v_mfma_f32_16x16x32_bf16 v[120:123], v[128:131], a[108:111], v[120:123]
    v_mfma_f32_16x16x32_bf16 v[124:127], v[136:139], a[108:111], v[124:127]
    ds_read_b64_tr_b16 a[232:233], v166 offset:32768
    v_mfma_f32_16x16x32_bf16 v[124:127], v[140:143], a[124:127], v[124:127]
    v_mfma_f32_16x16x32_bf16 v[116:119], v[140:143], a[120:123], v[116:119]
    ds_read_b64_tr_b16 a[234:235], v166 offset:36864
    v_mfma_f32_16x16x32_bf16 v[116:119], v[136:139], a[104:107], v[116:119]
    v_mfma_f32_16x16x32_bf16 v[108:111], v[136:139], a[100:103], v[108:111]
    ds_read_b64_tr_b16 a[236:237], v166 offset:40960
    v_mfma_f32_16x16x32_bf16 v[108:111], v[140:143], a[116:119], v[108:111]
    v_mfma_f32_16x16x32_bf16 v[100:103], v[140:143], a[112:115], v[100:103]
    ds_read_b64_tr_b16 a[238:239], v166 offset:45056
    v_mfma_f32_16x16x32_bf16 v[100:103], v[136:139], a[96:99], v[100:103]
    s_waitcnt lgkmcnt(4)
    v_mfma_f32_16x16x32_bf16 v[96:99], v[144:147], a[136:139], v[96:99]
    ds_read_b64_tr_b16 a[240:241], v167 offset:32768
    v_mfma_f32_16x16x32_bf16 v[96:99], v[148:151], a[152:155], v[96:99]
    v_mfma_f32_16x16x32_bf16 v[104:107], v[148:151], a[156:159], v[104:107]
    ds_read_b64_tr_b16 a[242:243], v167 offset:36864
    v_mfma_f32_16x16x32_bf16 v[104:107], v[144:147], a[140:143], v[104:107]
    v_mfma_f32_16x16x32_bf16 v[112:115], v[144:147], a[144:147], v[112:115]
    ds_read_b64_tr_b16 a[244:245], v167 offset:40960
    v_mfma_f32_16x16x32_bf16 v[112:115], v[148:151], a[160:163], v[112:115]
    v_mfma_f32_16x16x32_bf16 v[120:123], v[148:151], a[164:167], v[120:123]
    ds_read_b64_tr_b16 a[246:247], v167 offset:45056
    v_mfma_f32_16x16x32_bf16 v[120:123], v[144:147], a[148:151], v[120:123]
    v_mfma_f32_16x16x32_bf16 v[124:127], v[152:155], a[148:151], v[124:127]
    ds_read_b64_tr_b16 v[128:129], v235 offset:16384
    v_mfma_f32_16x16x32_bf16 v[124:127], v[156:159], a[164:167], v[124:127]
    v_mfma_f32_16x16x32_bf16 v[116:119], v[156:159], a[160:163], v[116:119]
    ds_read_b64_tr_b16 v[130:131], v235 offset:20480
    v_mfma_f32_16x16x32_bf16 v[116:119], v[152:155], a[144:147], v[116:119]
    v_mfma_f32_16x16x32_bf16 v[108:111], v[152:155], a[140:143], v[108:111]
    ds_read_b64_tr_b16 v[132:133], v235 offset:24576
    v_mfma_f32_16x16x32_bf16 v[108:111], v[156:159], a[156:159], v[108:111]
    v_mfma_f32_16x16x32_bf16 v[100:103], v[156:159], a[152:155], v[100:103]
    ds_read_b64_tr_b16 v[134:135], v235 offset:28672
    v_mfma_f32_16x16x32_bf16 v[100:103], v[152:155], a[136:139], v[100:103]
    s_waitcnt lgkmcnt(4)
    v_mfma_f32_16x16x32_bf16 v[96:99], a[232:235], a[168:171], v[96:99]
    ds_read_b64_tr_b16 v[136:137], v236 offset:16384
    v_mfma_f32_16x16x32_bf16 v[96:99], a[236:239], a[184:187], v[96:99]
    v_mfma_f32_16x16x32_bf16 v[104:107], a[236:239], a[188:191], v[104:107]
    ds_read_b64_tr_b16 v[138:139], v236 offset:20480
    v_mfma_f32_16x16x32_bf16 v[104:107], a[232:235], a[172:175], v[104:107]
    v_mfma_f32_16x16x32_bf16 v[112:115], a[232:235], a[176:179], v[112:115]
    ds_read_b64_tr_b16 v[140:141], v236 offset:24576
    v_mfma_f32_16x16x32_bf16 v[112:115], a[236:239], a[192:195], v[112:115]
    v_mfma_f32_16x16x32_bf16 v[120:123], a[236:239], a[196:199], v[120:123]
    ds_read_b64_tr_b16 v[142:143], v236 offset:28672
    v_mfma_f32_16x16x32_bf16 v[120:123], a[232:235], a[180:183], v[120:123]
    v_mfma_f32_16x16x32_bf16 v[124:127], a[240:243], a[180:183], v[124:127]
    ds_read_b64_tr_b16 v[144:145], v235 offset:32768
    v_mfma_f32_16x16x32_bf16 v[124:127], a[244:247], a[196:199], v[124:127]
    v_mfma_f32_16x16x32_bf16 v[116:119], a[244:247], a[192:195], v[116:119]
    ds_read_b64_tr_b16 v[146:147], v235 offset:36864
    v_mfma_f32_16x16x32_bf16 v[116:119], a[240:243], a[176:179], v[116:119]
    v_mfma_f32_16x16x32_bf16 v[108:111], a[240:243], a[172:175], v[108:111]
    ds_read_b64_tr_b16 v[148:149], v235 offset:40960
    v_mfma_f32_16x16x32_bf16 v[108:111], a[244:247], a[188:191], v[108:111]
    v_mfma_f32_16x16x32_bf16 v[100:103], a[244:247], a[184:187], v[100:103]
    ds_read_b64_tr_b16 v[150:151], v235 offset:45056
    v_mfma_f32_16x16x32_bf16 v[100:103], a[240:243], a[168:171], v[100:103]
    s_waitcnt lgkmcnt(4)
    v_mfma_f32_16x16x32_bf16 v[96:99], v[128:131], a[200:203], v[96:99]
    ds_read_b64_tr_b16 v[152:153], v236 offset:32768
    v_mfma_f32_16x16x32_bf16 v[96:99], v[132:135], a[216:219], v[96:99]
    v_mfma_f32_16x16x32_bf16 v[104:107], v[132:135], a[220:223], v[104:107]
    ds_read_b64_tr_b16 v[154:155], v236 offset:36864
    v_mfma_f32_16x16x32_bf16 v[104:107], v[128:131], a[204:207], v[104:107]
    v_mfma_f32_16x16x32_bf16 v[112:115], v[128:131], a[208:211], v[112:115]
    ds_read_b64_tr_b16 v[156:157], v236 offset:40960
    v_mfma_f32_16x16x32_bf16 v[112:115], v[132:135], a[224:227], v[112:115]
    v_mfma_f32_16x16x32_bf16 v[120:123], v[132:135], a[228:231], v[120:123]
    ds_read_b64_tr_b16 v[158:159], v236 offset:45056
    v_mfma_f32_16x16x32_bf16 v[120:123], v[128:131], a[212:215], v[120:123]
    v_mfma_f32_16x16x32_bf16 v[124:127], v[136:139], a[212:215], v[124:127]
    ds_read_b64_tr_b16 a[232:233], v160 offset:49152
    v_mfma_f32_16x16x32_bf16 v[124:127], v[140:143], a[228:231], v[124:127]
    v_mfma_f32_16x16x32_bf16 v[116:119], v[140:143], a[224:227], v[116:119]
    ds_read_b64_tr_b16 a[234:235], v160 offset:53248
    v_mfma_f32_16x16x32_bf16 v[116:119], v[136:139], a[208:211], v[116:119]
    v_mfma_f32_16x16x32_bf16 v[108:111], v[136:139], a[204:207], v[108:111]
    ds_read_b64_tr_b16 a[236:237], v160 offset:57344
    v_mfma_f32_16x16x32_bf16 v[108:111], v[140:143], a[220:223], v[108:111]
    v_mfma_f32_16x16x32_bf16 v[100:103], v[140:143], a[216:219], v[100:103]
    ds_read_b64_tr_b16 a[238:239], v160 offset:61440
    v_mfma_f32_16x16x32_bf16 v[100:103], v[136:139], a[200:203], v[100:103]
    s_waitcnt lgkmcnt(4)
    v_mfma_f32_16x16x32_bf16 v[96:99], v[144:147], a[0:3], v[96:99]
    ds_read_b64_tr_b16 a[240:241], v161 offset:49152
    v_mfma_f32_16x16x32_bf16 v[96:99], v[148:151], a[16:19], v[96:99]
    v_mfma_f32_16x16x32_bf16 v[100:103], v[156:159], a[16:19], v[100:103]
    ds_read_b64_tr_b16 a[242:243], v161 offset:53248
    v_mfma_f32_16x16x32_bf16 v[100:103], v[152:155], a[0:3], v[100:103]
    v_mfma_f32_16x16x32_bf16 v[108:111], v[152:155], a[4:7], v[108:111]
    ds_read_b64_tr_b16 a[244:245], v161 offset:57344
    v_mfma_f32_16x16x32_bf16 v[108:111], v[156:159], a[20:23], v[108:111]
    v_mfma_f32_16x16x32_bf16 v[104:107], v[148:151], a[20:23], v[104:107]
    ds_read_b64_tr_b16 a[246:247], v161 offset:61440
    v_mfma_f32_16x16x32_bf16 v[104:107], v[144:147], a[4:7], v[104:107]
    v_cvt_pk_bf16_f32 v96, v96, v97
    v_cvt_pk_bf16_f32 v97, v98, v99
    v_mfma_f32_16x16x32_bf16 v[112:115], v[144:147], a[8:11], v[112:115]
    v_cvt_pk_bf16_f32 v98, v100, v101
    v_cvt_pk_bf16_f32 v99, v102, v103
    v_or_b32 v96, 1, v96
    v_mfma_f32_16x16x32_bf16 v[112:115], v[148:151], a[24:27], v[112:115]
    ds_read_b64_tr_b16 v[128:129], v160 offset:0
    v_mfma_f32_16x16x32_bf16 v[116:119], v[156:159], a[24:27], v[116:119]
    buffer_store_dwordx4 v[96:99], v240, s[40:43], s15 offen sc1
    v_mfma_f32_16x16x32_bf16 v[116:119], v[152:155], a[8:11], v[116:119]
    ds_read_b64_tr_b16 v[130:131], v160 offset:4096
    v_mfma_f32_16x16x32_bf16 v[124:127], v[152:155], a[12:15], v[124:127]
    v_cvt_pk_bf16_f32 v104, v104, v105
    v_cvt_pk_bf16_f32 v105, v106, v107
    v_mfma_f32_16x16x32_bf16 v[124:127], v[156:159], a[28:31], v[124:127]
    v_cvt_pk_bf16_f32 v106, v108, v109
    v_cvt_pk_bf16_f32 v107, v110, v111
    v_or_b32 v104, 1, v104
    v_mfma_f32_16x16x32_bf16 v[120:123], v[148:151], a[28:31], v[120:123]
    ds_read_b64_tr_b16 v[132:133], v160 offset:8192
    v_mfma_f32_16x16x32_bf16 v[120:123], v[144:147], a[12:15], v[120:123]
    s_waitcnt lgkmcnt(3)
    v_mfma_f32_16x16x32_bf16 v[0:3], a[232:235], a[64:67], v[0:3]
    buffer_store_dwordx4 v[104:107], v241, s[40:43], s15 offen sc1
    v_mfma_f32_16x16x32_bf16 v[0:3], a[236:239], a[80:83], v[0:3]
    ds_read_b64_tr_b16 v[134:135], v160 offset:12288
    v_mfma_f32_16x16x32_bf16 v[8:11], a[236:239], a[84:87], v[8:11]
    v_cvt_pk_bf16_f32 v112, v112, v113
    v_cvt_pk_bf16_f32 v113, v114, v115
    v_mfma_f32_16x16x32_bf16 v[8:11], a[232:235], a[68:71], v[8:11]
    v_cvt_pk_bf16_f32 v114, v116, v117
    v_cvt_pk_bf16_f32 v115, v118, v119
    v_or_b32 v112, 1, v112
    v_mfma_f32_16x16x32_bf16 v[16:19], a[232:235], a[72:75], v[16:19]
    ds_read_b64_tr_b16 v[136:137], v161 offset:0
    v_mfma_f32_16x16x32_bf16 v[16:19], a[236:239], a[88:91], v[16:19]
    buffer_store_dwordx4 v[112:115], v242, s[40:43], s15 offen sc1
    v_mfma_f32_16x16x32_bf16 v[24:27], a[236:239], a[92:95], v[24:27]
    ds_read_b64_tr_b16 v[138:139], v161 offset:4096
    v_mfma_f32_16x16x32_bf16 v[24:27], a[232:235], a[76:79], v[24:27]
    v_cvt_pk_bf16_f32 v120, v120, v121
    v_cvt_pk_bf16_f32 v121, v122, v123
    v_mfma_f32_16x16x32_bf16 v[28:31], a[240:243], a[76:79], v[28:31]
    v_cvt_pk_bf16_f32 v122, v124, v125
    v_cvt_pk_bf16_f32 v123, v126, v127
    v_or_b32 v120, 1, v120
    v_mfma_f32_16x16x32_bf16 v[28:31], a[244:247], a[92:95], v[28:31]
    ds_read_b64_tr_b16 v[140:141], v161 offset:8192
    v_mfma_f32_16x16x32_bf16 v[20:23], a[244:247], a[88:91], v[20:23]
    buffer_store_dwordx4 v[120:123], v243, s[40:43], s15 offen sc1
    v_mfma_f32_16x16x32_bf16 v[20:23], a[240:243], a[72:75], v[20:23]
    ds_read_b64_tr_b16 v[142:143], v161 offset:12288
    v_mfma_f32_16x16x32_bf16 v[12:15], a[240:243], a[68:71], v[12:15]
    ds_read_b64_tr_b16 v[144:145], v160 offset:16384
    v_mfma_f32_16x16x32_bf16 v[12:15], a[244:247], a[84:87], v[12:15]
    ds_read_b64_tr_b16 v[146:147], v160 offset:20480
    v_mfma_f32_16x16x32_bf16 v[4:7], a[244:247], a[80:83], v[4:7]
    ds_read_b64_tr_b16 v[148:149], v160 offset:24576
    v_mfma_f32_16x16x32_bf16 v[4:7], a[240:243], a[64:67], v[4:7]
    s_waitcnt lgkmcnt(3)
    v_mfma_f32_16x16x32_bf16 v[0:3], v[128:131], a[96:99], v[0:3]
    ds_read_b64_tr_b16 v[150:151], v160 offset:28672
    v_mfma_f32_16x16x32_bf16 v[0:3], v[132:135], a[112:115], v[0:3]
    ds_read_b64_tr_b16 v[152:153], v161 offset:16384
    v_mfma_f32_16x16x32_bf16 v[8:11], v[132:135], a[116:119], v[8:11]
    ds_read_b64_tr_b16 v[154:155], v161 offset:20480
    v_mfma_f32_16x16x32_bf16 v[8:11], v[128:131], a[100:103], v[8:11]
    v_mfma_f32_16x16x32_bf16 v[16:19], v[128:131], a[104:107], v[16:19]
    ds_read_b64_tr_b16 v[156:157], v161 offset:24576
    v_mfma_f32_16x16x32_bf16 v[16:19], v[132:135], a[120:123], v[16:19]
    v_mfma_f32_16x16x32_bf16 v[24:27], v[132:135], a[124:127], v[24:27]
    ds_read_b64_tr_b16 v[158:159], v161 offset:28672
    v_mfma_f32_16x16x32_bf16 v[24:27], v[128:131], a[108:111], v[24:27]
    v_mfma_f32_16x16x32_bf16 v[28:31], v[136:139], a[108:111], v[28:31]
    ds_read_b64_tr_b16 a[232:233], v160 offset:32768
    v_mfma_f32_16x16x32_bf16 v[28:31], v[140:143], a[124:127], v[28:31]
    v_mfma_f32_16x16x32_bf16 v[20:23], v[140:143], a[120:123], v[20:23]
    ds_read_b64_tr_b16 a[234:235], v160 offset:36864
    v_mfma_f32_16x16x32_bf16 v[20:23], v[136:139], a[104:107], v[20:23]
    v_mfma_f32_16x16x32_bf16 v[12:15], v[136:139], a[100:103], v[12:15]
    ds_read_b64_tr_b16 a[236:237], v160 offset:40960
    v_mfma_f32_16x16x32_bf16 v[12:15], v[140:143], a[116:119], v[12:15]
    v_mfma_f32_16x16x32_bf16 v[4:7], v[140:143], a[112:115], v[4:7]
    ds_read_b64_tr_b16 a[238:239], v160 offset:45056
    v_mfma_f32_16x16x32_bf16 v[4:7], v[136:139], a[96:99], v[4:7]
    s_waitcnt lgkmcnt(4)
    v_mfma_f32_16x16x32_bf16 v[0:3], v[144:147], a[136:139], v[0:3]
    ds_read_b64_tr_b16 a[240:241], v161 offset:32768
    v_mfma_f32_16x16x32_bf16 v[0:3], v[148:151], a[152:155], v[0:3]
    v_mfma_f32_16x16x32_bf16 v[8:11], v[148:151], a[156:159], v[8:11]
    ds_read_b64_tr_b16 a[242:243], v161 offset:36864
    v_mfma_f32_16x16x32_bf16 v[8:11], v[144:147], a[140:143], v[8:11]
    v_mfma_f32_16x16x32_bf16 v[16:19], v[144:147], a[144:147], v[16:19]
    ds_read_b64_tr_b16 a[244:245], v161 offset:40960
    v_mfma_f32_16x16x32_bf16 v[16:19], v[148:151], a[160:163], v[16:19]
    v_mfma_f32_16x16x32_bf16 v[24:27], v[148:151], a[164:167], v[24:27]
    ds_read_b64_tr_b16 a[246:247], v161 offset:45056
    v_mfma_f32_16x16x32_bf16 v[24:27], v[144:147], a[148:151], v[24:27]
    v_mfma_f32_16x16x32_bf16 v[28:31], v[152:155], a[148:151], v[28:31]
    ds_read_b64_tr_b16 v[128:129], v250 offset:16384
    v_mfma_f32_16x16x32_bf16 v[28:31], v[156:159], a[164:167], v[28:31]
    v_mfma_f32_16x16x32_bf16 v[20:23], v[156:159], a[160:163], v[20:23]
    ds_read_b64_tr_b16 v[130:131], v250 offset:20480
    v_mfma_f32_16x16x32_bf16 v[20:23], v[152:155], a[144:147], v[20:23]
    v_mfma_f32_16x16x32_bf16 v[12:15], v[152:155], a[140:143], v[12:15]
    ds_read_b64_tr_b16 v[132:133], v250 offset:24576
    v_mfma_f32_16x16x32_bf16 v[12:15], v[156:159], a[156:159], v[12:15]
    v_mfma_f32_16x16x32_bf16 v[4:7], v[156:159], a[152:155], v[4:7]
    ds_read_b64_tr_b16 v[134:135], v250 offset:28672
    v_mfma_f32_16x16x32_bf16 v[4:7], v[152:155], a[136:139], v[4:7]
    s_waitcnt lgkmcnt(4)
    v_mfma_f32_16x16x32_bf16 v[0:3], a[232:235], a[168:171], v[0:3]
    ds_read_b64_tr_b16 v[136:137], v251 offset:16384
    v_mfma_f32_16x16x32_bf16 v[0:3], a[236:239], a[184:187], v[0:3]
    v_mfma_f32_16x16x32_bf16 v[8:11], a[236:239], a[188:191], v[8:11]
    ds_read_b64_tr_b16 v[138:139], v251 offset:20480
    v_mfma_f32_16x16x32_bf16 v[8:11], a[232:235], a[172:175], v[8:11]
    v_mfma_f32_16x16x32_bf16 v[16:19], a[232:235], a[176:179], v[16:19]
    ds_read_b64_tr_b16 v[140:141], v251 offset:24576
    v_mfma_f32_16x16x32_bf16 v[16:19], a[236:239], a[192:195], v[16:19]
    v_mfma_f32_16x16x32_bf16 v[24:27], a[236:239], a[196:199], v[24:27]
    ds_read_b64_tr_b16 v[142:143], v251 offset:28672
    v_mfma_f32_16x16x32_bf16 v[24:27], a[232:235], a[180:183], v[24:27]
    v_mfma_f32_16x16x32_bf16 v[28:31], a[240:243], a[180:183], v[28:31]
    ds_read_b64_tr_b16 v[144:145], v250 offset:32768
    v_mfma_f32_16x16x32_bf16 v[28:31], a[244:247], a[196:199], v[28:31]
    v_mfma_f32_16x16x32_bf16 v[20:23], a[244:247], a[192:195], v[20:23]
    ds_read_b64_tr_b16 v[146:147], v250 offset:36864
    v_mfma_f32_16x16x32_bf16 v[20:23], a[240:243], a[176:179], v[20:23]
    v_mfma_f32_16x16x32_bf16 v[12:15], a[240:243], a[172:175], v[12:15]
    ds_read_b64_tr_b16 v[148:149], v250 offset:40960
    v_mfma_f32_16x16x32_bf16 v[12:15], a[244:247], a[188:191], v[12:15]
    v_mfma_f32_16x16x32_bf16 v[4:7], a[244:247], a[184:187], v[4:7]
    ds_read_b64_tr_b16 v[150:151], v250 offset:45056
    v_mfma_f32_16x16x32_bf16 v[4:7], a[240:243], a[168:171], v[4:7]
    s_waitcnt lgkmcnt(4)
    v_mfma_f32_16x16x32_bf16 v[0:3], v[128:131], a[200:203], v[0:3]
    ds_read_b64_tr_b16 v[152:153], v251 offset:32768
    v_mfma_f32_16x16x32_bf16 v[0:3], v[132:135], a[216:219], v[0:3]
    v_mfma_f32_16x16x32_bf16 v[8:11], v[132:135], a[220:223], v[8:11]
    ds_read_b64_tr_b16 v[154:155], v251 offset:36864
    v_mfma_f32_16x16x32_bf16 v[8:11], v[128:131], a[204:207], v[8:11]
    v_mfma_f32_16x16x32_bf16 v[16:19], v[128:131], a[208:211], v[16:19]
    ds_read_b64_tr_b16 v[156:157], v251 offset:40960
    v_mfma_f32_16x16x32_bf16 v[16:19], v[132:135], a[224:227], v[16:19]
    v_mfma_f32_16x16x32_bf16 v[24:27], v[132:135], a[228:231], v[24:27]
    ds_read_b64_tr_b16 v[158:159], v251 offset:45056
    v_mfma_f32_16x16x32_bf16 v[24:27], v[128:131], a[212:215], v[24:27]
    v_mfma_f32_16x16x32_bf16 v[28:31], v[136:139], a[212:215], v[28:31]
    v_mfma_f32_16x16x32_bf16 v[28:31], v[140:143], a[228:231], v[28:31]
    v_mfma_f32_16x16x32_bf16 v[20:23], v[140:143], a[224:227], v[20:23]
    v_mfma_f32_16x16x32_bf16 v[20:23], v[136:139], a[208:211], v[20:23]
    v_mfma_f32_16x16x32_bf16 v[12:15], v[136:139], a[204:207], v[12:15]
    v_mfma_f32_16x16x32_bf16 v[12:15], v[140:143], a[220:223], v[12:15]
    v_mfma_f32_16x16x32_bf16 v[4:7], v[140:143], a[216:219], v[4:7]
    v_mfma_f32_16x16x32_bf16 v[4:7], v[136:139], a[200:203], v[4:7]
    s_waitcnt lgkmcnt(0)
    v_mfma_f32_16x16x32_bf16 v[0:3], v[144:147], a[0:3], v[0:3]
    buffer_load_dwordx4 v[192:195], v240, s[40:43], s82 offen sc1
    v_mfma_f32_16x16x32_bf16 v[0:3], v[148:151], a[16:19], v[0:3]
    v_mfma_f32_16x16x32_bf16 v[4:7], v[156:159], a[16:19], v[4:7]
    buffer_load_dwordx4 v[196:199], v241, s[40:43], s82 offen sc1
    v_mfma_f32_16x16x32_bf16 v[4:7], v[152:155], a[0:3], v[4:7]
    v_mfma_f32_16x16x32_bf16 v[12:15], v[152:155], a[4:7], v[12:15]
    buffer_load_dwordx4 v[200:203], v242, s[40:43], s82 offen sc1
    v_mfma_f32_16x16x32_bf16 v[12:15], v[156:159], a[20:23], v[12:15]
    v_mfma_f32_16x16x32_bf16 v[8:11], v[148:151], a[20:23], v[8:11]
    buffer_load_dwordx4 v[204:207], v243, s[40:43], s82 offen sc1
    v_mfma_f32_16x16x32_bf16 v[8:11], v[144:147], a[4:7], v[8:11]
    v_mfma_f32_16x16x32_bf16 v[16:19], v[144:147], a[8:11], v[16:19]
    v_mfma_f32_16x16x32_bf16 v[16:19], v[148:151], a[24:27], v[16:19]
    v_mfma_f32_16x16x32_bf16 v[20:23], v[156:159], a[24:27], v[20:23]
    v_mfma_f32_16x16x32_bf16 v[20:23], v[152:155], a[8:11], v[20:23]
    v_mfma_f32_16x16x32_bf16 v[28:31], v[152:155], a[12:15], v[28:31]
    v_mfma_f32_16x16x32_bf16 v[28:31], v[156:159], a[28:31], v[28:31]
    v_mfma_f32_16x16x32_bf16 v[24:27], v[148:151], a[28:31], v[24:27]
    v_mfma_f32_16x16x32_bf16 v[24:27], v[144:147], a[12:15], v[24:27]
    s_branch L_g2_fin
L_eg13:
    s_waitcnt vmcnt(43)
    s_barrier
    v_mfma_f32_16x16x32_bf16 v[92:95], v[152:155], a[76:79], v[92:95]
    ds_read_b64_tr_b16 v[128:129], v162 offset:0
    v_mfma_f32_16x16x32_bf16 v[92:95], v[156:159], a[92:95], v[92:95]
    buffer_load_dwordx4 a[52:55], v241, s[40:43], s92 offen sc1
    v_mfma_f32_16x16x32_bf16 v[84:87], v[156:159], a[88:91], v[84:87]
    ds_read_b64_tr_b16 v[130:131], v162 offset:4096
    v_mfma_f32_16x16x32_bf16 v[84:87], v[152:155], a[72:75], v[84:87]
    buffer_load_dwordx4 a[56:59], v242, s[40:43], s92 offen sc1
    v_mfma_f32_16x16x32_bf16 v[76:79], v[152:155], a[68:71], v[76:79]
    ds_read_b64_tr_b16 v[132:133], v162 offset:8192
    v_mfma_f32_16x16x32_bf16 v[76:79], v[156:159], a[84:87], v[76:79]
    v_mfma_f32_16x16x32_bf16 v[68:71], v[156:159], a[80:83], v[68:71]
    ds_read_b64_tr_b16 v[134:135], v162 offset:12288
    v_mfma_f32_16x16x32_bf16 v[68:71], v[152:155], a[64:67], v[68:71]
    s_waitcnt lgkmcnt(4)
    v_mfma_f32_16x16x32_bf16 v[96:99], a[232:235], a[64:67], v[96:99]
    ds_read_b64_tr_b16 v[136:137], v163 offset:0
    v_mfma_f32_16x16x32_bf16 v[96:99], a[236:239], a[80:83], v[96:99]
    buffer_load_dwordx4 a[60:63], v243, s[40:43], s92 offen sc1
    v_mfma_f32_16x16x32_bf16 v[104:107], a[236:239], a[84:87], v[104:107]
    ds_read_b64_tr_b16 v[138:139], v163 offset:4096
    v_mfma_f32_16x16x32_bf16 v[104:107], a[232:235], a[68:71], v[104:107]
    v_mfma_f32_16x16x32_bf16 v[112:115], a[232:235], a[72:75], v[112:115]
    ds_read_b64_tr_b16 v[140:141], v163 offset:8192
    v_mfma_f32_16x16x32_bf16 v[112:115], a[236:239], a[88:91], v[112:115]
    v_mfma_f32_16x16x32_bf16 v[120:123], a[236:239], a[92:95], v[120:123]
    ds_read_b64_tr_b16 v[142:143], v163 offset:12288
    v_mfma_f32_16x16x32_bf16 v[120:123], a[232:235], a[76:79], v[120:123]
    v_mfma_f32_16x16x32_bf16 v[124:127], a[240:243], a[76:79], v[124:127]
    ds_read_b64_tr_b16 v[144:145], v162 offset:16384
    v_mfma_f32_16x16x32_bf16 v[124:127], a[244:247], a[92:95], v[124:127]
    v_mfma_f32_16x16x32_bf16 v[116:119], a[244:247], a[88:91], v[116:119]
    ds_read_b64_tr_b16 v[146:147], v162 offset:20480
    v_mfma_f32_16x16x32_bf16 v[116:119], a[240:243], a[72:75], v[116:119]
    v_mfma_f32_16x16x32_bf16 v[108:111], a[240:243], a[68:71], v[108:111]
    ds_read_b64_tr_b16 v[148:149], v162 offset:24576
    v_mfma_f32_16x16x32_bf16 v[108:111], a[244:247], a[84:87], v[108:111]
    v_mfma_f32_16x16x32_bf16 v[100:103], a[244:247], a[80:83], v[100:103]
    ds_read_b64_tr_b16 v[150:151], v162 offset:28672
    v_mfma_f32_16x16x32_bf16 v[100:103], a[240:243], a[64:67], v[100:103]
    s_waitcnt lgkmcnt(4)
    v_mfma_f32_16x16x32_bf16 v[32:35], v[128:131], a[96:99], v[32:35]
    ds_read_b64_tr_b16 v[152:153], v163 offset:16384
    v_mfma_f32_16x16x32_bf16 v[32:35], v[132:135], a[112:115], v[32:35]
    v_mfma_f32_16x16x32_bf16 v[40:43], v[132:135], a[116:119], v[40:43]
    ds_read_b64_tr_b16 v[154:155], v163 offset:20480
    v_mfma_f32_16x16x32_bf16 v[40:43], v[128:131], a[100:103], v[40:43]
    v_mfma_f32_16x16x32_bf16 v[48:51], v[128:131], a[104:107], v[48:51]
    ds_read_b64_tr_b16 v[156:157], v163 offset:24576
    v_mfma_f32_16x16x32_bf16 v[48:51], v[132:135], a[120:123], v[48:51]
    v_mfma_f32_16x16x32_bf16 v[56:59], v[132:135], a[124:127], v[56:59]
    ds_read_b64_tr_b16 v[158:159], v163 offset:28672
    v_mfma_f32_16x16x32_bf16 v[56:59], v[128:131], a[108:111], v[56:59]
    v_mfma_f32_16x16x32_bf16 v[60:63], v[136:139], a[108:111], v[60:63]
    ds_read_b64_tr_b16 a[232:233], v162 offset:32768
    v_mfma_f32_16x16x32_bf16 v[60:63], v[140:143], a[124:127], v[60:63]
    v_mfma_f32_16x16x32_bf16 v[52:55], v[140:143], a[120:123], v[52:55]
    ds_read_b64_tr_b16 a[234:235], v162 offset:36864
    v_mfma_f32_16x16x32_bf16 v[52:55], v[136:139], a[104:107], v[52:55]
    v_mfma_f32_16x16x32_bf16 v[44:47], v[136:139], a[100:103], v[44:47]
    ds_read_b64_tr_b16 a[236:237], v162 offset:40960
    v_mfma_f32_16x16x32_bf16 v[44:47], v[140:143], a[116:119], v[44:47]
    v_mfma_f32_16x16x32_bf16 v[36:39], v[140:143], a[112:115], v[36:39]
    ds_read_b64_tr_b16 a[238:239], v162 offset:45056
    v_mfma_f32_16x16x32_bf16 v[36:39], v[136:139], a[96:99], v[36:39]
    s_waitcnt lgkmcnt(4)
    v_mfma_f32_16x16x32_bf16 v[32:35], v[144:147], a[136:139], v[32:35]
    ds_read_b64_tr_b16 a[240:241], v163 offset:32768
    v_mfma_f32_16x16x32_bf16 v[32:35], v[148:151], a[152:155], v[32:35]
    v_mfma_f32_16x16x32_bf16 v[40:43], v[148:151], a[156:159], v[40:43]
    ds_read_b64_tr_b16 a[242:243], v163 offset:36864
    v_mfma_f32_16x16x32_bf16 v[40:43], v[144:147], a[140:143], v[40:43]
    v_mfma_f32_16x16x32_bf16 v[48:51], v[144:147], a[144:147], v[48:51]
    ds_read_b64_tr_b16 a[244:245], v163 offset:40960
    v_mfma_f32_16x16x32_bf16 v[48:51], v[148:151], a[160:163], v[48:51]
    v_mfma_f32_16x16x32_bf16 v[56:59], v[148:151], a[164:167], v[56:59]
    ds_read_b64_tr_b16 a[246:247], v163 offset:45056
    v_mfma_f32_16x16x32_bf16 v[56:59], v[144:147], a[148:151], v[56:59]
    s_waitcnt vmcnt(34)
    s_barrier
    v_mfma_f32_16x16x32_bf16 v[60:63], v[152:155], a[148:151], v[60:63]
    ds_read_b64_tr_b16 v[128:129], v252 offset:16384
    v_mfma_f32_16x16x32_bf16 v[60:63], v[156:159], a[164:167], v[60:63]
    v_mfma_f32_16x16x32_bf16 v[52:55], v[156:159], a[160:163], v[52:55]
    ds_read_b64_tr_b16 v[130:131], v252 offset:20480
    v_mfma_f32_16x16x32_bf16 v[52:55], v[152:155], a[144:147], v[52:55]
    v_mfma_f32_16x16x32_bf16 v[44:47], v[152:155], a[140:143], v[44:47]
    ds_read_b64_tr_b16 v[132:133], v252 offset:24576
    v_mfma_f32_16x16x32_bf16 v[44:47], v[156:159], a[156:159], v[44:47]
    v_mfma_f32_16x16x32_bf16 v[36:39], v[156:159], a[152:155], v[36:39]
    ds_read_b64_tr_b16 v[134:135], v252 offset:28672
    v_mfma_f32_16x16x32_bf16 v[36:39], v[152:155], a[136:139], v[36:39]
    s_waitcnt lgkmcnt(4)
    v_mfma_f32_16x16x32_bf16 v[32:35], a[232:235], a[168:171], v[32:35]
    ds_read_b64_tr_b16 v[136:137], v253 offset:16384
    v_mfma_f32_16x16x32_bf16 v[32:35], a[236:239], a[184:187], v[32:35]
    v_mfma_f32_16x16x32_bf16 v[40:43], a[236:239], a[188:191], v[40:43]
    ds_read_b64_tr_b16 v[138:139], v253 offset:20480
    v_mfma_f32_16x16x32_bf16 v[40:43], a[232:235], a[172:175], v[40:43]
    v_mfma_f32_16x16x32_bf16 v[48:51], a[232:235], a[176:179], v[48:51]
    ds_read_b64_tr_b16 v[140:141], v253 offset:24576
    v_mfma_f32_16x16x32_bf16 v[48:51], a[236:239], a[192:195], v[48:51]
    buffer_load_dwordx2 v[176:177], v228, s[24:27], s88 offen offset:0
    v_mfma_f32_16x16x32_bf16 v[56:59], a[236:239], a[196:199], v[56:59]
    ds_read_b64_tr_b16 v[142:143], v253 offset:28672
    v_mfma_f32_16x16x32_bf16 v[56:59], a[232:235], a[180:183], v[56:59]
    s_waitcnt vmcnt(21)
    s_barrier
    v_mfma_f32_16x16x32_bf16 v[60:63], a[240:243], a[180:183], v[60:63]
    ds_read_b64_tr_b16 v[144:145], v252 offset:32768
    v_mfma_f32_16x16x32_bf16 v[60:63], a[244:247], a[196:199], v[60:63]
    v_mfma_f32_16x16x32_bf16 v[52:55], a[244:247], a[192:195], v[52:55]
    ds_read_b64_tr_b16 v[146:147], v252 offset:36864
    v_mfma_f32_16x16x32_bf16 v[52:55], a[240:243], a[176:179], v[52:55]
    v_mfma_f32_16x16x32_bf16 v[44:47], a[240:243], a[172:175], v[44:47]
    ds_read_b64_tr_b16 v[148:149], v252 offset:40960
    v_mfma_f32_16x16x32_bf16 v[44:47], a[244:247], a[188:191], v[44:47]
    buffer_load_dwordx2 v[178:179], v228, s[24:27], s88 offen offset:32
    v_mfma_f32_16x16x32_bf16 v[36:39], a[244:247], a[184:187], v[36:39]
    ds_read_b64_tr_b16 v[150:151], v252 offset:45056
    v_mfma_f32_16x16x32_bf16 v[36:39], a[240:243], a[168:171], v[36:39]
    s_waitcnt lgkmcnt(4)
    v_mfma_f32_16x16x32_bf16 v[32:35], v[128:131], a[200:203], v[32:35]
    ds_read_b64_tr_b16 v[152:153], v253 offset:32768
    v_mfma_f32_16x16x32_bf16 v[32:35], v[132:135], a[216:219], v[32:35]
    v_mfma_f32_16x16x32_bf16 v[40:43], v[132:135], a[220:223], v[40:43]
    ds_read_b64_tr_b16 v[154:155], v253 offset:36864
    v_mfma_f32_16x16x32_bf16 v[40:43], v[128:131], a[204:207], v[40:43]
    buffer_load_dwordx2 v[180:181], v228, s[24:27], s89 offen offset:0
    v_mfma_f32_16x16x32_bf16 v[48:51], v[128:131], a[208:211], v[48:51]
    ds_read_b64_tr_b16 v[156:157], v253 offset:40960
    v_mfma_f32_16x16x32_bf16 v[48:51], v[132:135], a[224:227], v[48:51]
    v_mfma_f32_16x16x32_bf16 v[56:59], v[132:135], a[228:231], v[56:59]
    ds_read_b64_tr_b16 v[158:159], v253 offset:45056
    v_mfma_f32_16x16x32_bf16 v[56:59], v[128:131], a[212:215], v[56:59]
    v_mfma_f32_16x16x32_bf16 v[60:63], v[136:139], a[212:215], v[60:63]
    ds_read_b64_tr_b16 a[232:233], v164 offset:0
    v_mfma_f32_16x16x32_bf16 v[60:63], v[140:143], a[228:231], v[60:63]
    v_mfma_f32_16x16x32_bf16 v[52:55], v[140:143], a[224:227], v[52:55]
    ds_read_b64_tr_b16 a[234:235], v164 offset:4096
    v_mfma_f32_16x16x32_bf16 v[52:55], v[136:139], a[208:211], v[52:55]
    buffer_load_dword v170, v230, s[44:47], s77 offen offset:768 sc1
    v_mfma_f32_16x16x32_bf16 v[44:47], v[136:139], a[204:207], v[44:47]
    ds_read_b64_tr_b16 a[236:237], v164 offset:8192
    v_mfma_f32_16x16x32_bf16 v[44:47], v[140:143], a[220:223], v[44:47]
    buffer_load_dwordx2 v[182:183], v228, s[24:27], s89 offen offset:32
    v_mfma_f32_16x16x32_bf16 v[36:39], v[140:143], a[216:219], v[36:39]
    ds_read_b64_tr_b16 a[238:239], v164 offset:12288
    v_mfma_f32_16x16x32_bf16 v[36:39], v[136:139], a[200:203], v[36:39]
    s_waitcnt vmcnt(17) lgkmcnt(4)
    v_mfma_f32_16x16x32_bf16 v[32:35], v[144:147], a[0:3], v[32:35]
    ds_read_b64_tr_b16 a[240:241], v165 offset:0
    v_mfma_f32_16x16x32_bf16 v[32:35], v[148:151], a[16:19], v[32:35]
    v_mfma_f32_16x16x32_bf16 v[40:43], v[148:151], a[20:23], v[40:43]
    ds_read_b64_tr_b16 a[242:243], v165 offset:4096
    v_mfma_f32_16x16x32_bf16 v[40:43], v[144:147], a[4:7], v[40:43]
    buffer_load_dwordx2 v[184:185], v228, s[24:27], s90 offen offset:0
    v_mfma_f32_16x16x32_bf16 v[48:51], v[144:147], a[8:11], v[48:51]
    ds_read_b64_tr_b16 a[244:245], v165 offset:8192
    v_mfma_f32_16x16x32_bf16 v[48:51], v[148:151], a[24:27], v[48:51]
    v_mfma_f32_16x16x32_bf16 v[56:59], v[148:151], a[28:31], v[56:59]
    ds_read_b64_tr_b16 a[246:247], v165 offset:12288
    v_mfma_f32_16x16x32_bf16 v[56:59], v[144:147], a[12:15], v[56:59]
    v_mfma_f32_16x16x32_bf16 v[60:63], v[152:155], a[12:15], v[60:63]
    ds_read_b64_tr_b16 v[128:129], v164 offset:16384
    v_mfma_f32_16x16x32_bf16 v[60:63], v[156:159], a[28:31], v[60:63]
    v_mfma_f32_16x16x32_bf16 v[52:55], v[156:159], a[24:27], v[52:55]
    ds_read_b64_tr_b16 v[130:131], v164 offset:20480
    v_mfma_f32_16x16x32_bf16 v[52:55], v[152:155], a[8:11], v[52:55]
    buffer_load_dwordx2 v[186:187], v228, s[24:27], s90 offen offset:32
    v_mfma_f32_16x16x32_bf16 v[44:47], v[152:155], a[4:7], v[44:47]
    ds_read_b64_tr_b16 v[132:133], v164 offset:24576
    v_mfma_f32_16x16x32_bf16 v[44:47], v[156:159], a[20:23], v[44:47]
    v_mfma_f32_16x16x32_bf16 v[36:39], v[156:159], a[16:19], v[36:39]
    ds_read_b64_tr_b16 v[134:135], v164 offset:28672
    v_mfma_f32_16x16x32_bf16 v[36:39], v[152:155], a[0:3], v[36:39]
    s_waitcnt lgkmcnt(4)
    v_mfma_f32_16x16x32_bf16 v[64:67], a[232:235], a[96:99], v[64:67]
    ds_read_b64_tr_b16 v[136:137], v165 offset:16384
    v_mfma_f32_16x16x32_bf16 v[64:67], a[236:239], a[112:115], v[64:67]
    buffer_load_dwordx2 v[188:189], v228, s[24:27], s91 offen offset:0
    v_mfma_f32_16x16x32_bf16 v[72:75], a[236:239], a[116:119], v[72:75]
    ds_read_b64_tr_b16 v[138:139], v165 offset:20480
    v_mfma_f32_16x16x32_bf16 v[72:75], a[232:235], a[100:103], v[72:75]
    v_mfma_f32_16x16x32_bf16 v[80:83], a[232:235], a[104:107], v[80:83]
    ds_read_b64_tr_b16 v[140:141], v165 offset:24576
    v_mfma_f32_16x16x32_bf16 v[80:83], a[236:239], a[120:123], v[80:83]
    v_mfma_f32_16x16x32_bf16 v[88:91], a[236:239], a[124:127], v[88:91]
    ds_read_b64_tr_b16 v[142:143], v165 offset:28672
    v_mfma_f32_16x16x32_bf16 v[88:91], a[232:235], a[108:111], v[88:91]
    s_waitcnt vmcnt(16)
    s_barrier
    v_mfma_f32_16x16x32_bf16 v[92:95], a[240:243], a[108:111], v[92:95]
    ds_read_b64_tr_b16 v[144:145], v252 offset:49152
    v_mfma_f32_16x16x32_bf16 v[92:95], a[244:247], a[124:127], v[92:95]
    buffer_load_dwordx2 v[190:191], v228, s[24:27], s91 offen offset:32
    v_mfma_f32_16x16x32_bf16 v[84:87], a[244:247], a[120:123], v[84:87]
    ds_read_b64_tr_b16 v[146:147], v252 offset:53248
    v_mfma_f32_16x16x32_bf16 v[84:87], a[240:243], a[104:107], v[84:87]
    v_mfma_f32_16x16x32_bf16 v[76:79], a[240:243], a[100:103], v[76:79]
    ds_read_b64_tr_b16 v[148:149], v252 offset:57344
    v_mfma_f32_16x16x32_bf16 v[76:79], a[244:247], a[116:119], v[76:79]
    v_mfma_f32_16x16x32_bf16 v[68:71], a[244:247], a[112:115], v[68:71]
    ds_read_b64_tr_b16 v[150:151], v252 offset:61440
    v_mfma_f32_16x16x32_bf16 v[68:71], a[240:243], a[96:99], v[68:71]
    s_waitcnt lgkmcnt(4)
    v_mfma_f32_16x16x32_bf16 v[64:67], v[128:131], a[136:139], v[64:67]
    ds_read_b64_tr_b16 v[152:153], v253 offset:49152
    v_mfma_f32_16x16x32_bf16 v[64:67], v[132:135], a[152:155], v[64:67]
    v_mfma_f32_16x16x32_bf16 v[72:75], v[132:135], a[156:159], v[72:75]
    ds_read_b64_tr_b16 v[154:155], v253 offset:53248
    v_mfma_f32_16x16x32_bf16 v[72:75], v[128:131], a[140:143], v[72:75]
    v_mfma_f32_16x16x32_bf16 v[80:83], v[128:131], a[144:147], v[80:83]
    ds_read_b64_tr_b16 v[156:157], v253 offset:57344
    v_mfma_f32_16x16x32_bf16 v[80:83], v[132:135], a[160:163], v[80:83]
    v_mfma_f32_16x16x32_bf16 v[88:91], v[132:135], a[164:167], v[88:91]
    ds_read_b64_tr_b16 v[158:159], v253 offset:61440
    v_mfma_f32_16x16x32_bf16 v[88:91], v[128:131], a[148:151], v[88:91]
    v_mfma_f32_16x16x32_bf16 v[92:95], v[136:139], a[148:151], v[92:95]
    ds_read_b64_tr_b16 a[232:233], v164 offset:32768
    v_mfma_f32_16x16x32_bf16 v[92:95], v[140:143], a[164:167], v[92:95]
    v_mfma_f32_16x16x32_bf16 v[84:87], v[140:143], a[160:163], v[84:87]
    ds_read_b64_tr_b16 a[234:235], v164 offset:36864
    v_mfma_f32_16x16x32_bf16 v[84:87], v[136:139], a[144:147], v[84:87]
    v_mfma_f32_16x16x32_bf16 v[76:79], v[136:139], a[140:143], v[76:79]
    ds_read_b64_tr_b16 a[236:237], v164 offset:40960
    v_mfma_f32_16x16x32_bf16 v[76:79], v[140:143], a[156:159], v[76:79]
    v_mfma_f32_16x16x32_bf16 v[68:71], v[140:143], a[152:155], v[68:71]
    ds_read_b64_tr_b16 a[238:239], v164 offset:45056
    v_mfma_f32_16x16x32_bf16 v[68:71], v[136:139], a[136:139], v[68:71]
    s_waitcnt vmcnt(9) lgkmcnt(4)
    v_mfma_f32_16x16x32_bf16 v[32:35], v[144:147], a[32:35], v[32:35]
    ds_read_b64_tr_b16 a[240:241], v165 offset:32768
    v_mfma_f32_16x16x32_bf16 v[32:35], v[148:151], a[48:51], v[32:35]
    v_mfma_f32_16x16x32_bf16 v[36:39], v[156:159], a[48:51], v[36:39]
    ds_read_b64_tr_b16 a[242:243], v165 offset:36864
    v_mfma_f32_16x16x32_bf16 v[36:39], v[152:155], a[32:35], v[36:39]
    v_mfma_f32_16x16x32_bf16 v[44:47], v[152:155], a[36:39], v[44:47]
    ds_read_b64_tr_b16 a[244:245], v165 offset:40960
    v_mfma_f32_16x16x32_bf16 v[44:47], v[156:159], a[52:55], v[44:47]
    v_mfma_f32_16x16x32_bf16 v[40:43], v[148:151], a[52:55], v[40:43]
    ds_read_b64_tr_b16 a[246:247], v165 offset:45056
    v_mfma_f32_16x16x32_bf16 v[40:43], v[144:147], a[36:39], v[40:43]
    s_waitcnt vmcnt(5)
    v_cmp_eq_u32 s[4:5], v239, v170
    v_mfma_f32_16x16x32_bf16 v[48:51], v[144:147], a[40:43], v[48:51]
    ds_read_b64_tr_b16 v[128:129], v249 offset:16384
    v_mfma_f32_16x16x32_bf16 v[48:51], v[148:151], a[56:59], v[48:51]
    s_or_b32 s4, s4, s5
    s_cmp_eq_u32 s4, -1
    s_cbranch_scc0 L_slow_p413
L_back_p413:
    v_mfma_f32_16x16x32_bf16 v[52:55], v[156:159], a[56:59], v[52:55]
    ds_read_b64_tr_b16 v[130:131], v249 offset:20480
    v_mfma_f32_16x16x32_bf16 v[52:55], v[152:155], a[40:43], v[52:55]
    v_cvt_pk_bf16_f32 v32, v32, v33
    v_cvt_pk_bf16_f32 v33, v34, v35
    v_mfma_f32_16x16x32_bf16 v[60:63], v[152:155], a[44:47], v[60:63]
    ds_read_b64_tr_b16 v[132:133], v249 offset:24576
    v_mfma_f32_16x16x32_bf16 v[60:63], v[156:159], a[60:63], v[60:63]
    v_cvt_pk_bf16_f32 v34, v36, v37
    v_cvt_pk_bf16_f32 v35, v38, v39
    v_or_b32 v32, 1, v32
    v_mfma_f32_16x16x32_bf16 v[56:59], v[148:151], a[60:63], v[56:59]
    ds_read_b64_tr_b16 v[134:135], v249 offset:28672
    v_mfma_f32_16x16x32_bf16 v[56:59], v[144:147], a[44:47], v[56:59]
    s_waitcnt lgkmcnt(4)
    v_mfma_f32_16x16x32_bf16 v[64:67], a[232:235], a[168:171], v[64:67]
    ds_read_b64_tr_b16 v[136:137], v234 offset:16384
    v_mfma_f32_16x16x32_bf16 v[64:67], a[236:239], a[184:187], v[64:67]
    buffer_store_dwordx4 v[32:35], v240, s[40:43], s13 offen sc1
    v_mfma_f32_16x16x32_bf16 v[72:75], a[236:239], a[188:191], v[72:75]
    ds_read_b64_tr_b16 v[138:139], v234 offset:20480
    v_mfma_f32_16x16x32_bf16 v[72:75], a[232:235], a[172:175], v[72:75]
    v_cvt_pk_bf16_f32 v40, v40, v41
    v_cvt_pk_bf16_f32 v41, v42, v43
    v_mfma_f32_16x16x32_bf16 v[80:83], a[232:235], a[176:179], v[80:83]
    ds_read_b64_tr_b16 v[140:141], v234 offset:24576
    v_mfma_f32_16x16x32_bf16 v[80:83], a[236:239], a[192:195], v[80:83]
    v_cvt_pk_bf16_f32 v42, v44, v45
    v_cvt_pk_bf16_f32 v43, v46, v47
    v_or_b32 v40, 1, v40
    v_mfma_f32_16x16x32_bf16 v[88:91], a[236:239], a[196:199], v[88:91]
    ds_read_b64_tr_b16 v[142:143], v234 offset:28672
    v_mfma_f32_16x16x32_bf16 v[88:91], a[232:235], a[180:183], v[88:91]
    buffer_store_dwordx4 v[40:43], v241, s[40:43], s13 offen sc1
    v_mfma_f32_16x16x32_bf16 v[92:95], a[240:243], a[180:183], v[92:95]
    ds_read_b64_tr_b16 v[144:145], v249 offset:32768
    v_mfma_f32_16x16x32_bf16 v[92:95], a[244:247], a[196:199], v[92:95]
    v_cvt_pk_bf16_f32 v48, v48, v49
    v_cvt_pk_bf16_f32 v49, v50, v51
    v_mfma_f32_16x16x32_bf16 v[84:87], a[244:247], a[192:195], v[84:87]
    ds_read_b64_tr_b16 v[146:147], v249 offset:36864
    v_mfma_f32_16x16x32_bf16 v[84:87], a[240:243], a[176:179], v[84:87]
    v_cvt_pk_bf16_f32 v50, v52, v53
    v_cvt_pk_bf16_f32 v51, v54, v55
    v_or_b32 v48, 1, v48
    v_mfma_f32_16x16x32_bf16 v[76:79], a[240:243], a[172:175], v[76:79]
    ds_read_b64_tr_b16 v[148:149], v249 offset:40960
    v_mfma_f32_16x16x32_bf16 v[76:79], a[244:247], a[188:191], v[76:79]
    buffer_store_dwordx4 v[48:51], v242, s[40:43], s13 offen sc1
    v_mfma_f32_16x16x32_bf16 v[68:71], a[244:247], a[184:187], v[68:71]
    ds_read_b64_tr_b16 v[150:151], v249 offset:45056
    v_mfma_f32_16x16x32_bf16 v[68:71], a[240:243], a[168:171], v[68:71]
    s_waitcnt lgkmcnt(4)
    v_mfma_f32_16x16x32_bf16 v[64:67], v[128:131], a[200:203], v[64:67]
    ds_read_b64_tr_b16 v[152:153], v234 offset:32768
    v_mfma_f32_16x16x32_bf16 v[64:67], v[132:135], a[216:219], v[64:67]
    v_cvt_pk_bf16_f32 v56, v56, v57
    v_cvt_pk_bf16_f32 v57, v58, v59
    v_mfma_f32_16x16x32_bf16 v[72:75], v[132:135], a[220:223], v[72:75]
    ds_read_b64_tr_b16 v[154:155], v234 offset:36864
    v_mfma_f32_16x16x32_bf16 v[72:75], v[128:131], a[204:207], v[72:75]
    v_cvt_pk_bf16_f32 v58, v60, v61
    v_cvt_pk_bf16_f32 v59, v62, v63
    v_or_b32 v56, 1, v56
    v_mfma_f32_16x16x32_bf16 v[80:83], v[128:131], a[208:211], v[80:83]
    ds_read_b64_tr_b16 v[156:157], v234 offset:40960
    v_mfma_f32_16x16x32_bf16 v[80:83], v[132:135], a[224:227], v[80:83]
    buffer_store_dwordx4 v[56:59], v243, s[40:43], s13 offen sc1
    v_mfma_f32_16x16x32_bf16 v[88:91], v[132:135], a[228:231], v[88:91]
    ds_read_b64_tr_b16 v[158:159], v234 offset:45056
    v_mfma_f32_16x16x32_bf16 v[88:91], v[128:131], a[212:215], v[88:91]
    v_mfma_f32_16x16x32_bf16 v[92:95], v[136:139], a[212:215], v[92:95]
    ds_read_b64_tr_b16 a[232:233], v249 offset:49152
    v_mfma_f32_16x16x32_bf16 v[92:95], v[140:143], a[228:231], v[92:95]
    v_mfma_f32_16x16x32_bf16 v[84:87], v[140:143], a[224:227], v[84:87]
    ds_read_b64_tr_b16 a[234:235], v249 offset:53248
    v_mfma_f32_16x16x32_bf16 v[84:87], v[136:139], a[208:211], v[84:87]
    v_mfma_f32_16x16x32_bf16 v[76:79], v[136:139], a[204:207], v[76:79]
    ds_read_b64_tr_b16 a[236:237], v249 offset:57344
    v_mfma_f32_16x16x32_bf16 v[76:79], v[140:143], a[220:223], v[76:79]
    v_mfma_f32_16x16x32_bf16 v[68:71], v[140:143], a[216:219], v[68:71]
    ds_read_b64_tr_b16 a[238:239], v249 offset:61440
    v_mfma_f32_16x16x32_bf16 v[68:71], v[136:139], a[200:203], v[68:71]
    s_waitcnt lgkmcnt(4)
    v_mfma_f32_16x16x32_bf16 v[64:67], v[144:147], a[0:3], v[64:67]
    ds_read_b64_tr_b16 a[240:241], v234 offset:49152
    v_mfma_f32_16x16x32_bf16 v[64:67], v[148:151], a[16:19], v[64:67]
    v_mfma_f32_16x16x32_bf16 v[72:75], v[148:151], a[20:23], v[72:75]
    ds_read_b64_tr_b16 a[242:243], v234 offset:53248
    v_mfma_f32_16x16x32_bf16 v[72:75], v[144:147], a[4:7], v[72:75]
    v_mfma_f32_16x16x32_bf16 v[80:83], v[144:147], a[8:11], v[80:83]
    ds_read_b64_tr_b16 a[244:245], v234 offset:57344
    v_mfma_f32_16x16x32_bf16 v[80:83], v[148:151], a[24:27], v[80:83]
    v_mfma_f32_16x16x32_bf16 v[88:91], v[148:151], a[28:31], v[88:91]
    ds_read_b64_tr_b16 a[246:247], v234 offset:61440
    v_mfma_f32_16x16x32_bf16 v[88:91], v[144:147], a[12:15], v[88:91]
    v_mfma_f32_16x16x32_bf16 v[92:95], v[152:155], a[12:15], v[92:95]
    ds_read_b64_tr_b16 v[128:129], v166 offset:0
    v_mfma_f32_16x16x32_bf16 v[92:95], v[156:159], a[28:31], v[92:95]
    v_mfma_f32_16x16x32_bf16 v[84:87], v[156:159], a[24:27], v[84:87]
    ds_read_b64_tr_b16 v[130:131], v166 offset:4096
    v_mfma_f32_16x16x32_bf16 v[84:87], v[152:155], a[8:11], v[84:87]
    v_mfma_f32_16x16x32_bf16 v[76:79], v[152:155], a[4:7], v[76:79]
    ds_read_b64_tr_b16 v[132:133], v166 offset:8192
    v_mfma_f32_16x16x32_bf16 v[76:79], v[156:159], a[20:23], v[76:79]
    v_mfma_f32_16x16x32_bf16 v[68:71], v[156:159], a[16:19], v[68:71]
    ds_read_b64_tr_b16 v[134:135], v166 offset:12288
    v_mfma_f32_16x16x32_bf16 v[68:71], v[152:155], a[0:3], v[68:71]
    s_waitcnt lgkmcnt(4)
    v_mfma_f32_16x16x32_bf16 v[64:67], a[232:235], a[32:35], v[64:67]
    ds_read_b64_tr_b16 v[136:137], v167 offset:0
    v_mfma_f32_16x16x32_bf16 v[64:67], a[236:239], a[48:51], v[64:67]
    ds_read_b64_tr_b16 v[138:139], v167 offset:4096
    v_mfma_f32_16x16x32_bf16 v[68:71], a[244:247], a[48:51], v[68:71]
    ds_read_b64_tr_b16 v[140:141], v167 offset:8192
    v_mfma_f32_16x16x32_bf16 v[68:71], a[240:243], a[32:35], v[68:71]
    ds_read_b64_tr_b16 v[142:143], v167 offset:12288
    v_mfma_f32_16x16x32_bf16 v[76:79], a[240:243], a[36:39], v[76:79]
    ds_read_b64_tr_b16 v[144:145], v166 offset:16384
    v_mfma_f32_16x16x32_bf16 v[76:79], a[244:247], a[52:55], v[76:79]
    ds_read_b64_tr_b16 v[146:147], v166 offset:20480
    v_mfma_f32_16x16x32_bf16 v[72:75], a[236:239], a[52:55], v[72:75]
    v_cvt_pk_bf16_f32 v64, v64, v65
    v_cvt_pk_bf16_f32 v65, v66, v67
    v_mfma_f32_16x16x32_bf16 v[72:75], a[232:235], a[36:39], v[72:75]
    v_cvt_pk_bf16_f32 v66, v68, v69
    v_cvt_pk_bf16_f32 v67, v70, v71
    v_or_b32 v64, 1, v64
    v_mfma_f32_16x16x32_bf16 v[80:83], a[232:235], a[40:43], v[80:83]
    buffer_store_dwordx4 v[64:67], v240, s[40:43], s14 offen sc1
    v_mfma_f32_16x16x32_bf16 v[80:83], a[236:239], a[56:59], v[80:83]
    ds_read_b64_tr_b16 v[148:149], v166 offset:24576
    v_mfma_f32_16x16x32_bf16 v[84:87], a[244:247], a[56:59], v[84:87]
    v_cvt_pk_bf16_f32 v72, v72, v73
    v_cvt_pk_bf16_f32 v73, v74, v75
    v_mfma_f32_16x16x32_bf16 v[84:87], a[240:243], a[40:43], v[84:87]
    v_cvt_pk_bf16_f32 v74, v76, v77
    v_cvt_pk_bf16_f32 v75, v78, v79
    v_or_b32 v72, 1, v72
    v_mfma_f32_16x16x32_bf16 v[92:95], a[240:243], a[44:47], v[92:95]
    ds_read_b64_tr_b16 v[150:151], v166 offset:28672
    v_mfma_f32_16x16x32_bf16 v[92:95], a[244:247], a[60:63], v[92:95]
    buffer_store_dwordx4 v[72:75], v241, s[40:43], s14 offen sc1
    v_mfma_f32_16x16x32_bf16 v[88:91], a[236:239], a[60:63], v[88:91]
    v_cvt_pk_bf16_f32 v80, v80, v81
    v_cvt_pk_bf16_f32 v81, v82, v83
    v_mfma_f32_16x16x32_bf16 v[88:91], a[232:235], a[44:47], v[88:91]
    s_waitcnt lgkmcnt(4)
    v_mfma_f32_16x16x32_bf16 v[96:99], v[128:131], a[96:99], v[96:99]
    ds_read_b64_tr_b16 v[152:153], v167 offset:16384
    v_mfma_f32_16x16x32_bf16 v[96:99], v[132:135], a[112:115], v[96:99]
    v_cvt_pk_bf16_f32 v82, v84, v85
    v_cvt_pk_bf16_f32 v83, v86, v87
    v_or_b32 v80, 1, v80
    v_mfma_f32_16x16x32_bf16 v[104:107], v[132:135], a[116:119], v[104:107]
    ds_read_b64_tr_b16 v[154:155], v167 offset:20480
    v_mfma_f32_16x16x32_bf16 v[104:107], v[128:131], a[100:103], v[104:107]
    v_mfma_f32_16x16x32_bf16 v[112:115], v[128:131], a[104:107], v[112:115]
    ds_read_b64_tr_b16 v[156:157], v167 offset:24576
    v_mfma_f32_16x16x32_bf16 v[112:115], v[132:135], a[120:123], v[112:115]
    buffer_store_dwordx4 v[80:83], v242, s[40:43], s14 offen sc1
    v_mfma_f32_16x16x32_bf16 v[120:123], v[132:135], a[124:127], v[120:123]
    ds_read_b64_tr_b16 v[158:159], v167 offset:28672
    v_mfma_f32_16x16x32_bf16 v[120:123], v[128:131], a[108:111], v[120:123]
    v_cvt_pk_bf16_f32 v88, v88, v89
    v_cvt_pk_bf16_f32 v89, v90, v91
    v_mfma_f32_16x16x32_bf16 v[124:127], v[136:139], a[108:111], v[124:127]
    ds_read_b64_tr_b16 a[232:233], v166 offset:32768
    v_mfma_f32_16x16x32_bf16 v[124:127], v[140:143], a[124:127], v[124:127]
    v_cvt_pk_bf16_f32 v90, v92, v93
    v_cvt_pk_bf16_f32 v91, v94, v95
    v_or_b32 v88, 1, v88
    v_mfma_f32_16x16x32_bf16 v[116:119], v[140:143], a[120:123], v[116:119]
    ds_read_b64_tr_b16 a[234:235], v166 offset:36864
    v_mfma_f32_16x16x32_bf16 v[116:119], v[136:139], a[104:107], v[116:119]
    buffer_store_dwordx4 v[88:91], v243, s[40:43], s14 offen sc1
    v_mfma_f32_16x16x32_bf16 v[108:111], v[136:139], a[100:103], v[108:111]
    ds_read_b64_tr_b16 a[236:237], v166 offset:40960
    v_mfma_f32_16x16x32_bf16 v[108:111], v[140:143], a[116:119], v[108:111]
    v_mfma_f32_16x16x32_bf16 v[100:103], v[140:143], a[112:115], v[100:103]
    ds_read_b64_tr_b16 a[238:239], v166 offset:45056
    v_mfma_f32_16x16x32_bf16 v[100:103], v[136:139], a[96:99], v[100:103]
    s_waitcnt lgkmcnt(4)
    v_mfma_f32_16x16x32_bf16 v[96:99], v[144:147], a[136:139], v[96:99]
    ds_read_b64_tr_b16 a[240:241], v167 offset:32768
    v_mfma_f32_16x16x32_bf16 v[96:99], v[148:151], a[152:155], v[96:99]
    v_mfma_f32_16x16x32_bf16 v[104:107], v[148:151], a[156:159], v[104:107]
    ds_read_b64_tr_b16 a[242:243], v167 offset:36864
    v_mfma_f32_16x16x32_bf16 v[104:107], v[144:147], a[140:143], v[104:107]
    v_mfma_f32_16x16x32_bf16 v[112:115], v[144:147], a[144:147], v[112:115]
    ds_read_b64_tr_b16 a[244:245], v167 offset:40960
    v_mfma_f32_16x16x32_bf16 v[112:115], v[148:151], a[160:163], v[112:115]
    v_mfma_f32_16x16x32_bf16 v[120:123], v[148:151], a[164:167], v[120:123]
    ds_read_b64_tr_b16 a[246:247], v167 offset:45056
    v_mfma_f32_16x16x32_bf16 v[120:123], v[144:147], a[148:151], v[120:123]
    v_mfma_f32_16x16x32_bf16 v[124:127], v[152:155], a[148:151], v[124:127]
    ds_read_b64_tr_b16 v[128:129], v235 offset:16384
    v_mfma_f32_16x16x32_bf16 v[124:127], v[156:159], a[164:167], v[124:127]
    v_mfma_f32_16x16x32_bf16 v[116:119], v[156:159], a[160:163], v[116:119]
    ds_read_b64_tr_b16 v[130:131], v235 offset:20480
    v_mfma_f32_16x16x32_bf16 v[116:119], v[152:155], a[144:147], v[116:119]
    v_mfma_f32_16x16x32_bf16 v[108:111], v[152:155], a[140:143], v[108:111]
    ds_read_b64_tr_b16 v[132:133], v235 offset:24576
    v_mfma_f32_16x16x32_bf16 v[108:111], v[156:159], a[156:159], v[108:111]
    v_mfma_f32_16x16x32_bf16 v[100:103], v[156:159], a[152:155], v[100:103]
    ds_read_b64_tr_b16 v[134:135], v235 offset:28672
    v_mfma_f32_16x16x32_bf16 v[100:103], v[152:155], a[136:139], v[100:103]
    s_waitcnt lgkmcnt(4)
    v_mfma_f32_16x16x32_bf16 v[96:99], a[232:235], a[168:171], v[96:99]
    ds_read_b64_tr_b16 v[136:137], v236 offset:16384
    v_mfma_f32_16x16x32_bf16 v[96:99], a[236:239], a[184:187], v[96:99]
    v_mfma_f32_16x16x32_bf16 v[104:107], a[236:239], a[188:191], v[104:107]
    ds_read_b64_tr_b16 v[138:139], v236 offset:20480
    v_mfma_f32_16x16x32_bf16 v[104:107], a[232:235], a[172:175], v[104:107]
    v_mfma_f32_16x16x32_bf16 v[112:115], a[232:235], a[176:179], v[112:115]
    ds_read_b64_tr_b16 v[140:141], v236 offset:24576
    v_mfma_f32_16x16x32_bf16 v[112:115], a[236:239], a[192:195], v[112:115]
    v_mfma_f32_16x16x32_bf16 v[120:123], a[236:239], a[196:199], v[120:123]
    ds_read_b64_tr_b16 v[142:143], v236 offset:28672
    v_mfma_f32_16x16x32_bf16 v[120:123], a[232:235], a[180:183], v[120:123]
    v_mfma_f32_16x16x32_bf16 v[124:127], a[240:243], a[180:183], v[124:127]
    ds_read_b64_tr_b16 v[144:145], v235 offset:32768
    v_mfma_f32_16x16x32_bf16 v[124:127], a[244:247], a[196:199], v[124:127]
    v_mfma_f32_16x16x32_bf16 v[116:119], a[244:247], a[192:195], v[116:119]
    ds_read_b64_tr_b16 v[146:147], v235 offset:36864
    v_mfma_f32_16x16x32_bf16 v[116:119], a[240:243], a[176:179], v[116:119]
    v_mfma_f32_16x16x32_bf16 v[108:111], a[240:243], a[172:175], v[108:111]
    ds_read_b64_tr_b16 v[148:149], v235 offset:40960
    v_mfma_f32_16x16x32_bf16 v[108:111], a[244:247], a[188:191], v[108:111]
    v_mfma_f32_16x16x32_bf16 v[100:103], a[244:247], a[184:187], v[100:103]
    ds_read_b64_tr_b16 v[150:151], v235 offset:45056
    v_mfma_f32_16x16x32_bf16 v[100:103], a[240:243], a[168:171], v[100:103]
    s_waitcnt lgkmcnt(4)
    v_mfma_f32_16x16x32_bf16 v[96:99], v[128:131], a[200:203], v[96:99]
    ds_read_b64_tr_b16 v[152:153], v236 offset:32768
    v_mfma_f32_16x16x32_bf16 v[96:99], v[132:135], a[216:219], v[96:99]
    v_mfma_f32_16x16x32_bf16 v[104:107], v[132:135], a[220:223], v[104:107]
    ds_read_b64_tr_b16 v[154:155], v236 offset:36864
    v_mfma_f32_16x16x32_bf16 v[104:107], v[128:131], a[204:207], v[104:107]
    v_mfma_f32_16x16x32_bf16 v[112:115], v[128:131], a[208:211], v[112:115]
    ds_read_b64_tr_b16 v[156:157], v236 offset:40960
    v_mfma_f32_16x16x32_bf16 v[112:115], v[132:135], a[224:227], v[112:115]
    v_mfma_f32_16x16x32_bf16 v[120:123], v[132:135], a[228:231], v[120:123]
    ds_read_b64_tr_b16 v[158:159], v236 offset:45056
    v_mfma_f32_16x16x32_bf16 v[120:123], v[128:131], a[212:215], v[120:123]
    v_mfma_f32_16x16x32_bf16 v[124:127], v[136:139], a[212:215], v[124:127]
    ds_read_b64_tr_b16 a[232:233], v235 offset:49152
    v_mfma_f32_16x16x32_bf16 v[124:127], v[140:143], a[228:231], v[124:127]
    v_mfma_f32_16x16x32_bf16 v[116:119], v[140:143], a[224:227], v[116:119]
    ds_read_b64_tr_b16 a[234:235], v235 offset:53248
    v_mfma_f32_16x16x32_bf16 v[116:119], v[136:139], a[208:211], v[116:119]
    v_mfma_f32_16x16x32_bf16 v[108:111], v[136:139], a[204:207], v[108:111]
    ds_read_b64_tr_b16 a[236:237], v235 offset:57344
    v_mfma_f32_16x16x32_bf16 v[108:111], v[140:143], a[220:223], v[108:111]
    v_mfma_f32_16x16x32_bf16 v[100:103], v[140:143], a[216:219], v[100:103]
    ds_read_b64_tr_b16 a[238:239], v235 offset:61440
    v_mfma_f32_16x16x32_bf16 v[100:103], v[136:139], a[200:203], v[100:103]
    s_waitcnt lgkmcnt(4)
    v_mfma_f32_16x16x32_bf16 v[96:99], v[144:147], a[0:3], v[96:99]
    ds_read_b64_tr_b16 a[240:241], v236 offset:49152
    v_mfma_f32_16x16x32_bf16 v[96:99], v[148:151], a[16:19], v[96:99]
    v_mfma_f32_16x16x32_bf16 v[104:107], v[148:151], a[20:23], v[104:107]
    ds_read_b64_tr_b16 a[242:243], v236 offset:53248
    v_mfma_f32_16x16x32_bf16 v[104:107], v[144:147], a[4:7], v[104:107]
    v_mfma_f32_16x16x32_bf16 v[112:115], v[144:147], a[8:11], v[112:115]
    ds_read_b64_tr_b16 a[244:245], v236 offset:57344
    v_mfma_f32_16x16x32_bf16 v[112:115], v[148:151], a[24:27], v[112:115]
    v_mfma_f32_16x16x32_bf16 v[120:123], v[148:151], a[28:31], v[120:123]
    ds_read_b64_tr_b16 a[246:247], v236 offset:61440
    v_mfma_f32_16x16x32_bf16 v[120:123], v[144:147], a[12:15], v[120:123]
    v_mfma_f32_16x16x32_bf16 v[124:127], v[152:155], a[12:15], v[124:127]
    ds_read_b64_tr_b16 v[128:129], v160 offset:0
    v_mfma_f32_16x16x32_bf16 v[124:127], v[156:159], a[28:31], v[124:127]
    v_mfma_f32_16x16x32_bf16 v[116:119], v[156:159], a[24:27], v[116:119]
    ds_read_b64_tr_b16 v[130:131], v160 offset:4096
    v_mfma_f32_16x16x32_bf16 v[116:119], v[152:155], a[8:11], v[116:119]
    v_mfma_f32_16x16x32_bf16 v[108:111], v[152:155], a[4:7], v[108:111]
    ds_read_b64_tr_b16 v[132:133], v160 offset:8192
    v_mfma_f32_16x16x32_bf16 v[108:111], v[156:159], a[20:23], v[108:111]
    v_mfma_f32_16x16x32_bf16 v[100:103], v[156:159], a[16:19], v[100:103]
    ds_read_b64_tr_b16 v[134:135], v160 offset:12288
    v_mfma_f32_16x16x32_bf16 v[100:103], v[152:155], a[0:3], v[100:103]
    s_waitcnt lgkmcnt(4)
    v_mfma_f32_16x16x32_bf16 v[96:99], a[232:235], a[32:35], v[96:99]
    ds_read_b64_tr_b16 v[136:137], v161 offset:0
    v_mfma_f32_16x16x32_bf16 v[96:99], a[236:239], a[48:51], v[96:99]
    v_mfma_f32_16x16x32_bf16 v[100:103], a[244:247], a[48:51], v[100:103]
    ds_read_b64_tr_b16 v[138:139], v161 offset:4096
    v_mfma_f32_16x16x32_bf16 v[100:103], a[240:243], a[32:35], v[100:103]
    v_mfma_f32_16x16x32_bf16 v[108:111], a[240:243], a[36:39], v[108:111]
    ds_read_b64_tr_b16 v[140:141], v161 offset:8192
    v_mfma_f32_16x16x32_bf16 v[108:111], a[244:247], a[52:55], v[108:111]
    v_mfma_f32_16x16x32_bf16 v[104:107], a[236:239], a[52:55], v[104:107]
    ds_read_b64_tr_b16 v[142:143], v161 offset:12288
    v_mfma_f32_16x16x32_bf16 v[104:107], a[232:235], a[36:39], v[104:107]
    v_cvt_pk_bf16_f32 v96, v96, v97
    v_cvt_pk_bf16_f32 v97, v98, v99
    v_mfma_f32_16x16x32_bf16 v[112:115], a[232:235], a[40:43], v[112:115]
    v_cvt_pk_bf16_f32 v98, v100, v101
    v_cvt_pk_bf16_f32 v99, v102, v103
    v_or_b32 v96, 1, v96
    v_mfma_f32_16x16x32_bf16 v[112:115], a[236:239], a[56:59], v[112:115]
    ds_read_b64_tr_b16 v[144:145], v160 offset:16384
    v_mfma_f32_16x16x32_bf16 v[116:119], a[244:247], a[56:59], v[116:119]
    buffer_store_dwordx4 v[96:99], v240, s[40:43], s15 offen sc1
    v_mfma_f32_16x16x32_bf16 v[116:119], a[240:243], a[40:43], v[116:119]
    ds_read_b64_tr_b16 v[146:147], v160 offset:20480
    v_mfma_f32_16x16x32_bf16 v[124:127], a[240:243], a[44:47], v[124:127]
    v_cvt_pk_bf16_f32 v104, v104, v105
    v_cvt_pk_bf16_f32 v105, v106, v107
    v_mfma_f32_16x16x32_bf16 v[124:127], a[244:247], a[60:63], v[124:127]
    v_cvt_pk_bf16_f32 v106, v108, v109
    v_cvt_pk_bf16_f32 v107, v110, v111
    v_or_b32 v104, 1, v104
    v_mfma_f32_16x16x32_bf16 v[120:123], a[236:239], a[60:63], v[120:123]
    ds_read_b64_tr_b16 v[148:149], v160 offset:24576
    v_mfma_f32_16x16x32_bf16 v[120:123], a[232:235], a[44:47], v[120:123]
    s_waitcnt lgkmcnt(3)
    v_mfma_f32_16x16x32_bf16 v[0:3], v[128:131], a[96:99], v[0:3]
    buffer_store_dwordx4 v[104:107], v241, s[40:43], s15 offen sc1
    v_mfma_f32_16x16x32_bf16 v[0:3], v[132:135], a[112:115], v[0:3]
    ds_read_b64_tr_b16 v[150:151], v160 offset:28672
    v_mfma_f32_16x16x32_bf16 v[8:11], v[132:135], a[116:119], v[8:11]
    v_cvt_pk_bf16_f32 v112, v112, v113
    v_cvt_pk_bf16_f32 v113, v114, v115
    v_mfma_f32_16x16x32_bf16 v[8:11], v[128:131], a[100:103], v[8:11]
    v_cvt_pk_bf16_f32 v114, v116, v117
    v_cvt_pk_bf16_f32 v115, v118, v119
    v_or_b32 v112, 1, v112
    v_mfma_f32_16x16x32_bf16 v[16:19], v[128:131], a[104:107], v[16:19]
    ds_read_b64_tr_b16 v[152:153], v161 offset:16384
    v_mfma_f32_16x16x32_bf16 v[16:19], v[132:135], a[120:123], v[16:19]
    buffer_store_dwordx4 v[112:115], v242, s[40:43], s15 offen sc1
    v_mfma_f32_16x16x32_bf16 v[24:27], v[132:135], a[124:127], v[24:27]
    ds_read_b64_tr_b16 v[154:155], v161 offset:20480
    v_mfma_f32_16x16x32_bf16 v[24:27], v[128:131], a[108:111], v[24:27]
    v_cvt_pk_bf16_f32 v120, v120, v121
    v_cvt_pk_bf16_f32 v121, v122, v123
    v_mfma_f32_16x16x32_bf16 v[28:31], v[136:139], a[108:111], v[28:31]
    v_cvt_pk_bf16_f32 v122, v124, v125
    v_cvt_pk_bf16_f32 v123, v126, v127
    v_or_b32 v120, 1, v120
    v_mfma_f32_16x16x32_bf16 v[28:31], v[140:143], a[124:127], v[28:31]
    ds_read_b64_tr_b16 v[156:157], v161 offset:24576
    v_mfma_f32_16x16x32_bf16 v[20:23], v[140:143], a[120:123], v[20:23]
    buffer_store_dwordx4 v[120:123], v243, s[40:43], s15 offen sc1
    v_mfma_f32_16x16x32_bf16 v[20:23], v[136:139], a[104:107], v[20:23]
    ds_read_b64_tr_b16 v[158:159], v161 offset:28672
    v_mfma_f32_16x16x32_bf16 v[12:15], v[136:139], a[100:103], v[12:15]
    ds_read_b64_tr_b16 a[232:233], v160 offset:32768
    v_mfma_f32_16x16x32_bf16 v[12:15], v[140:143], a[116:119], v[12:15]
    ds_read_b64_tr_b16 a[234:235], v160 offset:36864
    v_mfma_f32_16x16x32_bf16 v[4:7], v[140:143], a[112:115], v[4:7]
    ds_read_b64_tr_b16 a[236:237], v160 offset:40960
    v_mfma_f32_16x16x32_bf16 v[4:7], v[136:139], a[96:99], v[4:7]
    s_waitcnt lgkmcnt(3)
    v_mfma_f32_16x16x32_bf16 v[0:3], v[144:147], a[136:139], v[0:3]
    ds_read_b64_tr_b16 a[238:239], v160 offset:45056
    v_mfma_f32_16x16x32_bf16 v[0:3], v[148:151], a[152:155], v[0:3]
    ds_read_b64_tr_b16 a[240:241], v161 offset:32768
    v_mfma_f32_16x16x32_bf16 v[8:11], v[148:151], a[156:159], v[8:11]
    ds_read_b64_tr_b16 a[242:243], v161 offset:36864
    v_mfma_f32_16x16x32_bf16 v[8:11], v[144:147], a[140:143], v[8:11]
    v_mfma_f32_16x16x32_bf16 v[16:19], v[144:147], a[144:147], v[16:19]
    ds_read_b64_tr_b16 a[244:245], v161 offset:40960
    v_mfma_f32_16x16x32_bf16 v[16:19], v[148:151], a[160:163], v[16:19]
    v_mfma_f32_16x16x32_bf16 v[24:27], v[148:151], a[164:167], v[24:27]
    ds_read_b64_tr_b16 a[246:247], v161 offset:45056
    v_mfma_f32_16x16x32_bf16 v[24:27], v[144:147], a[148:151], v[24:27]
    v_mfma_f32_16x16x32_bf16 v[28:31], v[152:155], a[148:151], v[28:31]
    ds_read_b64_tr_b16 v[128:129], v250 offset:16384
    v_mfma_f32_16x16x32_bf16 v[28:31], v[156:159], a[164:167], v[28:31]
    v_mfma_f32_16x16x32_bf16 v[20:23], v[156:159], a[160:163], v[20:23]
    ds_read_b64_tr_b16 v[130:131], v250 offset:20480
    v_mfma_f32_16x16x32_bf16 v[20:23], v[152:155], a[144:147], v[20:23]
    v_mfma_f32_16x16x32_bf16 v[12:15], v[152:155], a[140:143], v[12:15]
    ds_read_b64_tr_b16 v[132:133], v250 offset:24576
    v_mfma_f32_16x16x32_bf16 v[12:15], v[156:159], a[156:159], v[12:15]
    v_mfma_f32_16x16x32_bf16 v[4:7], v[156:159], a[152:155], v[4:7]
    ds_read_b64_tr_b16 v[134:135], v250 offset:28672
    v_mfma_f32_16x16x32_bf16 v[4:7], v[152:155], a[136:139], v[4:7]
    s_waitcnt lgkmcnt(4)
    v_mfma_f32_16x16x32_bf16 v[0:3], a[232:235], a[168:171], v[0:3]
    ds_read_b64_tr_b16 v[136:137], v251 offset:16384
    v_mfma_f32_16x16x32_bf16 v[0:3], a[236:239], a[184:187], v[0:3]
    v_mfma_f32_16x16x32_bf16 v[8:11], a[236:239], a[188:191], v[8:11]
    ds_read_b64_tr_b16 v[138:139], v251 offset:20480
    v_mfma_f32_16x16x32_bf16 v[8:11], a[232:235], a[172:175], v[8:11]
    v_mfma_f32_16x16x32_bf16 v[16:19], a[232:235], a[176:179], v[16:19]
    ds_read_b64_tr_b16 v[140:141], v251 offset:24576
    v_mfma_f32_16x16x32_bf16 v[16:19], a[236:239], a[192:195], v[16:19]
    v_mfma_f32_16x16x32_bf16 v[24:27], a[236:239], a[196:199], v[24:27]
    ds_read_b64_tr_b16 v[142:143], v251 offset:28672
    v_mfma_f32_16x16x32_bf16 v[24:27], a[232:235], a[180:183], v[24:27]
    v_mfma_f32_16x16x32_bf16 v[28:31], a[240:243], a[180:183], v[28:31]
    ds_read_b64_tr_b16 v[144:145], v250 offset:32768
    v_mfma_f32_16x16x32_bf16 v[28:31], a[244:247], a[196:199], v[28:31]
    v_mfma_f32_16x16x32_bf16 v[20:23], a[244:247], a[192:195], v[20:23]
    ds_read_b64_tr_b16 v[146:147], v250 offset:36864
    v_mfma_f32_16x16x32_bf16 v[20:23], a[240:243], a[176:179], v[20:23]
    v_mfma_f32_16x16x32_bf16 v[12:15], a[240:243], a[172:175], v[12:15]
    ds_read_b64_tr_b16 v[148:149], v250 offset:40960
    v_mfma_f32_16x16x32_bf16 v[12:15], a[244:247], a[188:191], v[12:15]
    v_mfma_f32_16x16x32_bf16 v[4:7], a[244:247], a[184:187], v[4:7]
    ds_read_b64_tr_b16 v[150:151], v250 offset:45056
    v_mfma_f32_16x16x32_bf16 v[4:7], a[240:243], a[168:171], v[4:7]
    s_waitcnt lgkmcnt(4)
    v_mfma_f32_16x16x32_bf16 v[0:3], v[128:131], a[200:203], v[0:3]
    ds_read_b64_tr_b16 v[152:153], v251 offset:32768
    v_mfma_f32_16x16x32_bf16 v[0:3], v[132:135], a[216:219], v[0:3]
    v_mfma_f32_16x16x32_bf16 v[8:11], v[132:135], a[220:223], v[8:11]
    ds_read_b64_tr_b16 v[154:155], v251 offset:36864
    v_mfma_f32_16x16x32_bf16 v[8:11], v[128:131], a[204:207], v[8:11]
    v_mfma_f32_16x16x32_bf16 v[16:19], v[128:131], a[208:211], v[16:19]
    ds_read_b64_tr_b16 v[156:157], v251 offset:40960
    v_mfma_f32_16x16x32_bf16 v[16:19], v[132:135], a[224:227], v[16:19]
    v_mfma_f32_16x16x32_bf16 v[24:27], v[132:135], a[228:231], v[24:27]
    ds_read_b64_tr_b16 v[158:159], v251 offset:45056
    v_mfma_f32_16x16x32_bf16 v[24:27], v[128:131], a[212:215], v[24:27]
    v_mfma_f32_16x16x32_bf16 v[28:31], v[136:139], a[212:215], v[28:31]
    ds_read_b64_tr_b16 a[232:233], v250 offset:49152
    v_mfma_f32_16x16x32_bf16 v[28:31], v[140:143], a[228:231], v[28:31]
    v_mfma_f32_16x16x32_bf16 v[20:23], v[140:143], a[224:227], v[20:23]
    ds_read_b64_tr_b16 a[234:235], v250 offset:53248
    v_mfma_f32_16x16x32_bf16 v[20:23], v[136:139], a[208:211], v[20:23]
    v_mfma_f32_16x16x32_bf16 v[12:15], v[136:139], a[204:207], v[12:15]
    ds_read_b64_tr_b16 a[236:237], v250 offset:57344
    v_mfma_f32_16x16x32_bf16 v[12:15], v[140:143], a[220:223], v[12:15]
    v_mfma_f32_16x16x32_bf16 v[4:7], v[140:143], a[216:219], v[4:7]
    ds_read_b64_tr_b16 a[238:239], v250 offset:61440
    v_mfma_f32_16x16x32_bf16 v[4:7], v[136:139], a[200:203], v[4:7]
    s_waitcnt lgkmcnt(4)
    v_mfma_f32_16x16x32_bf16 v[0:3], v[144:147], a[0:3], v[0:3]
    ds_read_b64_tr_b16 a[240:241], v251 offset:49152
    v_mfma_f32_16x16x32_bf16 v[0:3], v[148:151], a[16:19], v[0:3]
    v_mfma_f32_16x16x32_bf16 v[8:11], v[148:151], a[20:23], v[8:11]
    ds_read_b64_tr_b16 a[242:243], v251 offset:53248
    v_mfma_f32_16x16x32_bf16 v[8:11], v[144:147], a[4:7], v[8:11]
    v_mfma_f32_16x16x32_bf16 v[16:19], v[144:147], a[8:11], v[16:19]
    ds_read_b64_tr_b16 a[244:245], v251 offset:57344
    v_mfma_f32_16x16x32_bf16 v[16:19], v[148:151], a[24:27], v[16:19]
    v_mfma_f32_16x16x32_bf16 v[24:27], v[148:151], a[28:31], v[24:27]
    ds_read_b64_tr_b16 a[246:247], v251 offset:61440
    v_mfma_f32_16x16x32_bf16 v[24:27], v[144:147], a[12:15], v[24:27]
    v_mfma_f32_16x16x32_bf16 v[28:31], v[152:155], a[12:15], v[28:31]
    v_mfma_f32_16x16x32_bf16 v[28:31], v[156:159], a[28:31], v[28:31]
    v_mfma_f32_16x16x32_bf16 v[20:23], v[156:159], a[24:27], v[20:23]
    v_mfma_f32_16x16x32_bf16 v[20:23], v[152:155], a[8:11], v[20:23]
    v_mfma_f32_16x16x32_bf16 v[12:15], v[152:155], a[4:7], v[12:15]
    v_mfma_f32_16x16x32_bf16 v[12:15], v[156:159], a[20:23], v[12:15]
    v_mfma_f32_16x16x32_bf16 v[4:7], v[156:159], a[16:19], v[4:7]
    v_mfma_f32_16x16x32_bf16 v[4:7], v[152:155], a[0:3], v[4:7]
    s_waitcnt lgkmcnt(0)
    v_mfma_f32_16x16x32_bf16 v[0:3], a[232:235], a[32:35], v[0:3]
    buffer_load_dwordx4 v[192:195], v240, s[40:43], s82 offen sc1
    v_mfma_f32_16x16x32_bf16 v[0:3], a[236:239], a[48:51], v[0:3]
    v_mfma_f32_16x16x32_bf16 v[4:7], a[244:247], a[48:51], v[4:7]
    buffer_load_dwordx4 v[196:199], v241, s[40:43], s82 offen sc1
    v_mfma_f32_16x16x32_bf16 v[4:7], a[240:243], a[32:35], v[4:7]
    v_mfma_f32_16x16x32_bf16 v[12:15], a[240:243], a[36:39], v[12:15]
    buffer_load_dwordx4 v[200:203], v242, s[40:43], s82 offen sc1
    v_mfma_f32_16x16x32_bf16 v[12:15], a[244:247], a[52:55], v[12:15]
    v_mfma_f32_16x16x32_bf16 v[8:11], a[236:239], a[52:55], v[8:11]
    buffer_load_dwordx4 v[204:207], v243, s[40:43], s82 offen sc1
    v_mfma_f32_16x16x32_bf16 v[8:11], a[232:235], a[36:39], v[8:11]
    v_mfma_f32_16x16x32_bf16 v[16:19], a[232:235], a[40:43], v[16:19]
    v_mfma_f32_16x16x32_bf16 v[16:19], a[236:239], a[56:59], v[16:19]
    v_mfma_f32_16x16x32_bf16 v[20:23], a[244:247], a[56:59], v[20:23]
    v_mfma_f32_16x16x32_bf16 v[20:23], a[240:243], a[40:43], v[20:23]
    v_mfma_f32_16x16x32_bf16 v[28:31], a[240:243], a[44:47], v[28:31]
    v_mfma_f32_16x16x32_bf16 v[28:31], a[244:247], a[60:63], v[28:31]
    v_mfma_f32_16x16x32_bf16 v[24:27], a[236:239], a[60:63], v[24:27]
    v_mfma_f32_16x16x32_bf16 v[24:27], a[232:235], a[44:47], v[24:27]
L_g2_fin:
    v_dot2_f32_bf16 v0, v176, s72, v0
    v_dot2_f32_bf16 v1, v176, s73, v1
    v_dot2_f32_bf16 v2, v177, s72, v2
    v_dot2_f32_bf16 v3, v177, s73, v3
    s_waitcnt vmcnt(22)
    v_dot2_f32_bf16 v4, v178, s72, v4
    v_dot2_f32_bf16 v5, v178, s73, v5
    v_dot2_f32_bf16 v6, v179, s72, v6
    v_dot2_f32_bf16 v7, v179, s73, v7
    s_waitcnt vmcnt(21)
    v_dot2_f32_bf16 v8, v180, s72, v8
    v_dot2_f32_bf16 v9, v180, s73, v9
    v_dot2_f32_bf16 v10, v181, s72, v10
    v_dot2_f32_bf16 v11, v181, s73, v11
    s_waitcnt vmcnt(20)
    v_dot2_f32_bf16 v12, v182, s72, v12
    v_dot2_f32_bf16 v13, v182, s73, v13
    v_dot2_f32_bf16 v14, v183, s72, v14
    v_dot2_f32_bf16 v15, v183, s73, v15
    s_waitcnt vmcnt(19)
    v_dot2_f32_bf16 v16, v184, s72, v16
    v_dot2_f32_bf16 v17, v184, s73, v17
    v_dot2_f32_bf16 v18, v185, s72, v18
    v_dot2_f32_bf16 v19, v185, s73, v19
    s_waitcnt vmcnt(18)
    v_dot2_f32_bf16 v20, v186, s72, v20
    v_dot2_f32_bf16 v21, v186, s73, v21
    v_dot2_f32_bf16 v22, v187, s72, v22
    v_dot2_f32_bf16 v23, v187, s73, v23
    s_waitcnt vmcnt(17)
    v_dot2_f32_bf16 v24, v188, s72, v24
    v_dot2_f32_bf16 v25, v188, s73, v25
    v_dot2_f32_bf16 v26, v189, s72, v26
    v_dot2_f32_bf16 v27, v189, s73, v27
    s_waitcnt vmcnt(16)
    v_dot2_f32_bf16 v28, v190, s72, v28
    v_dot2_f32_bf16 v29, v190, s73, v29
    v_dot2_f32_bf16 v30, v191, s72, v30
    v_dot2_f32_bf16 v31, v191, s73, v31
    s_waitcnt vmcnt(4)
    buffer_load_dwordx4 v[208:211], v240, s[40:43], s81 offen sc1
    buffer_load_dwordx4 v[212:215], v241, s[40:43], s81 offen sc1
    buffer_load_dwordx4 v[216:219], v242, s[40:43], s81 offen sc1
    buffer_load_dwordx4 v[220:223], v243, s[40:43], s81 offen sc1
    buffer_load_dwordx4 v[48:51], v240, s[40:43], s80 offen sc1
    buffer_load_dwordx4 v[52:55], v241, s[40:43], s80 offen sc1
    buffer_load_dwordx4 v[56:59], v242, s[40:43], s80 offen sc1
    buffer_load_dwordx4 v[60:63], v243, s[40:43], s80 offen sc1
    s_waitcnt vmcnt(10)
    v_and_b32 v224, v192, v196
    s_waitcnt vmcnt(8)
    v_and_b32 v225, v200, v204
    v_and_b32 v224, 1, v224
    v_and_b32 v224, v224, v225
    v_cmp_eq_u32 vcc, 0, v224
    s_nop 1
    s_cmp_lg_u64 vcc, 0
    s_cbranch_scc1 L_rt2
L_ok2:
    v_dot2_f32_bf16 v0, v192, s72, v0
    v_dot2_f32_bf16 v1, v192, s73, v1
    v_dot2_f32_bf16 v2, v193, s72, v2
    v_dot2_f32_bf16 v3, v193, s73, v3
    v_dot2_f32_bf16 v4, v194, s72, v4
    v_dot2_f32_bf16 v5, v194, s73, v5
    v_dot2_f32_bf16 v6, v195, s72, v6
    v_dot2_f32_bf16 v7, v195, s73, v7
    v_dot2_f32_bf16 v8, v196, s72, v8
    v_dot2_f32_bf16 v9, v196, s73, v9
    v_dot2_f32_bf16 v10, v197, s72, v10
    v_dot2_f32_bf16 v11, v197, s73, v11
    v_dot2_f32_bf16 v12, v198, s72, v12
    v_dot2_f32_bf16 v13, v198, s73, v13
    v_dot2_f32_bf16 v14, v199, s72, v14
    v_dot2_f32_bf16 v15, v199, s73, v15
    v_dot2_f32_bf16 v16, v200, s72, v16
    v_dot2_f32_bf16 v17, v200, s73, v17
    v_dot2_f32_bf16 v18, v201, s72, v18
    v_dot2_f32_bf16 v19, v201, s73, v19
    v_dot2_f32_bf16 v20, v202, s72, v20
    v_dot2_f32_bf16 v21, v202, s73, v21
    v_dot2_f32_bf16 v22, v203, s72, v22
    v_dot2_f32_bf16 v23, v203, s73, v23
    v_dot2_f32_bf16 v24, v204, s72, v24
    v_dot2_f32_bf16 v25, v204, s73, v25
    v_dot2_f32_bf16 v26, v205, s72, v26
    v_dot2_f32_bf16 v27, v205, s73, v27
    v_dot2_f32_bf16 v28, v206, s72, v28
    v_dot2_f32_bf16 v29, v206, s73, v29
    v_dot2_f32_bf16 v30, v207, s72, v30
    v_dot2_f32_bf16 v31, v207, s73, v31
    s_waitcnt vmcnt(6)
    v_and_b32 v224, v208, v212
    s_waitcnt vmcnt(4)
    v_and_b32 v225, v216, v220
    v_and_b32 v224, 1, v224
    v_and_b32 v224, v224, v225
    v_cmp_eq_u32 vcc, 0, v224
    s_nop 1
    s_cmp_lg_u64 vcc, 0
    s_cbranch_scc1 L_rt1
L_ok1:
    v_dot2_f32_bf16 v0, v208, s72, v0
    v_dot2_f32_bf16 v1, v208, s73, v1
    v_dot2_f32_bf16 v2, v209, s72, v2
    v_dot2_f32_bf16 v3, v209, s73, v3
    v_dot2_f32_bf16 v4, v210, s72, v4
    v_dot2_f32_bf16 v5, v210, s73, v5
    v_dot2_f32_bf16 v6, v211, s72, v6
    v_dot2_f32_bf16 v7, v211, s73, v7
    v_dot2_f32_bf16 v8, v212, s72, v8
    v_dot2_f32_bf16 v9, v212, s73, v9
    v_dot2_f32_bf16 v10, v213, s72, v10
    v_dot2_f32_bf16 v11, v213, s73, v11
    v_dot2_f32_bf16 v12, v214, s72, v12
    v_dot2_f32_bf16 v13, v214, s73, v13
    v_dot2_f32_bf16 v14, v215, s72, v14
    v_dot2_f32_bf16 v15, v215, s73, v15
    v_dot2_f32_bf16 v16, v216, s72, v16
    v_dot2_f32_bf16 v17, v216, s73, v17
    v_dot2_f32_bf16 v18, v217, s72, v18
    v_dot2_f32_bf16 v19, v217, s73, v19
    v_dot2_f32_bf16 v20, v218, s72, v20
    v_dot2_f32_bf16 v21, v218, s73, v21
    v_dot2_f32_bf16 v22, v219, s72, v22
    v_dot2_f32_bf16 v23, v219, s73, v23
    v_dot2_f32_bf16 v24, v220, s72, v24
    v_dot2_f32_bf16 v25, v220, s73, v25
    v_dot2_f32_bf16 v26, v221, s72, v26
    v_dot2_f32_bf16 v27, v221, s73, v27
    v_dot2_f32_bf16 v28, v222, s72, v28
    v_dot2_f32_bf16 v29, v222, s73, v29
    v_dot2_f32_bf16 v30, v223, s72, v30
    v_dot2_f32_bf16 v31, v223, s73, v31
    s_waitcnt vmcnt(2)
    v_and_b32 v224, v48, v52
    s_waitcnt vmcnt(0)
    v_and_b32 v225, v56, v60
    v_and_b32 v224, 1, v224
    v_and_b32 v224, v224, v225
    v_cmp_eq_u32 vcc, 0, v224
    s_nop 1
    s_cmp_lg_u64 vcc, 0
    s_cbranch_scc1 L_rt0
L_ok0:
    v_dot2_f32_bf16 v0, v48, s72, v0
    v_dot2_f32_bf16 v1, v48, s73, v1
    v_dot2_f32_bf16 v2, v49, s72, v2
    v_dot2_f32_bf16 v3, v49, s73, v3
    v_dot2_f32_bf16 v4, v50, s72, v4
    v_dot2_f32_bf16 v5, v50, s73, v5
    v_dot2_f32_bf16 v6, v51, s72, v6
    v_dot2_f32_bf16 v7, v51, s73, v7
    v_dot2_f32_bf16 v8, v52, s72, v8
    v_dot2_f32_bf16 v9, v52, s73, v9
    v_dot2_f32_bf16 v10, v53, s72, v10
    v_dot2_f32_bf16 v11, v53, s73, v11
    v_dot2_f32_bf16 v12, v54, s72, v12
    v_dot2_f32_bf16 v13, v54, s73, v13
    v_dot2_f32_bf16 v14, v55, s72, v14
    v_dot2_f32_bf16 v15, v55, s73, v15
    v_dot2_f32_bf16 v16, v56, s72, v16
    v_dot2_f32_bf16 v17, v56, s73, v17
    v_dot2_f32_bf16 v18, v57, s72, v18
    v_dot2_f32_bf16 v19, v57, s73, v19
    v_dot2_f32_bf16 v20, v58, s72, v20
    v_dot2_f32_bf16 v21, v58, s73, v21
    v_dot2_f32_bf16 v22, v59, s72, v22
    v_dot2_f32_bf16 v23, v59, s73, v23
    v_dot2_f32_bf16 v24, v60, s72, v24
    v_dot2_f32_bf16 v25, v60, s73, v25
    v_dot2_f32_bf16 v26, v61, s72, v26
    v_dot2_f32_bf16 v27, v61, s73, v27
    v_dot2_f32_bf16 v28, v62, s72, v28
    v_dot2_f32_bf16 v29, v62, s73, v29
    v_dot2_f32_bf16 v30, v63, s72, v30
    v_dot2_f32_bf16 v31, v63, s73, v31
    v_cvt_pk_bf16_f32 v128, v0, v1
    v_cvt_pk_bf16_f32 v129, v2, v3
    v_cvt_pk_bf16_f32 v130, v4, v5
    v_cvt_pk_bf16_f32 v131, v6, v7
    s_nop 0
    v_permlane16_swap_b32 v128, v130
    v_permlane16_swap_b32 v129, v131
    buffer_store_dwordx4 v[128:131], v229, s[56:59], s88 offen
    v_cvt_pk_bf16_f32 v132, v8, v9
    v_cvt_pk_bf16_f32 v133, v10, v11
    v_cvt_pk_bf16_f32 v134, v12, v13
    v_cvt_pk_bf16_f32 v135, v14, v15
    s_nop 0
    v_permlane16_swap_b32 v132, v134
    v_permlane16_swap_b32 v133, v135
    buffer_store_dwordx4 v[132:135], v229, s[56:59], s89 offen
    v_cvt_pk_bf16_f32 v136, v16, v17
    v_cvt_pk_bf16_f32 v137, v18, v19
    v_cvt_pk_bf16_f32 v138, v20, v21
    v_cvt_pk_bf16_f32 v139, v22, v23
    s_nop 0
    v_permlane16_swap_b32 v136, v138
    v_permlane16_swap_b32 v137, v139
    buffer_store_dwordx4 v[136:139], v229, s[56:59], s90 offen
    v_cvt_pk_bf16_f32 v140, v24, v25
    v_cvt_pk_bf16_f32 v141, v26, v27
    v_cvt_pk_bf16_f32 v142, v28, v29
    v_cvt_pk_bf16_f32 v143, v30, v31
    s_nop 0
    v_permlane16_swap_b32 v140, v142
    v_permlane16_swap_b32 v141, v143
    buffer_store_dwordx4 v[140:143], v229, s[56:59], s91 offen
L_end:
    s_endpgm
L_ns0:
    s_mov_b32 s85, 0
    s_mov_b32 s96, s20
    s_mov_b32 s97, s21
    s_mov_b32 s98, 256
    s_mov_b32 s99, 0x20000
L_nl0:
    buffer_load_dword v239, off, s[96:99], 0 sc1
    s_waitcnt vmcnt(0)
    v_readfirstlane_b32 s86, v239
    s_add_u32 s85, s85, 1
    s_cmp_ge_u32 s85, 100000
    s_cbranch_scc1 L_nb0
    s_cmp_eq_u32 s86, 0
    s_cbranch_scc1 L_nl0
    s_branch L_nb0
L_hs0:
    s_waitcnt vmcnt(11)
    v_dot2_f32_bf16 v252, v232, v228, 0
    v_dot2_f32_bf16 v253, v232, v232, 0
    v_dot2_f32_bf16 v252, v233, v228, v252
    v_dot2_f32_bf16 v253, v233, v233, v253
    v_dot2_f32_bf16 v252, v234, v228, v252
    v_dot2_f32_bf16 v253, v234, v234, v253
    v_dot2_f32_bf16 v252, v235, v228, v252
    v_dot2_f32_bf16 v253, v235, v235, v253
    v_dot2_f32_bf16 v252, v240, v228, v252
    v_dot2_f32_bf16 v253, v240, v240, v253
    v_dot2_f32_bf16 v252, v241, v228, v252
    v_dot2_f32_bf16 v253, v241, v241, v253
    v_dot2_f32_bf16 v252, v242, v228, v252
    v_dot2_f32_bf16 v253, v242, v242, v253
    v_dot2_f32_bf16 v252, v243, v228, v252
    v_dot2_f32_bf16 v253, v243, v243, v253
    v_dot2_f32_bf16 v252, v244, v228, v252
    v_dot2_f32_bf16 v253, v244, v244, v253
    v_dot2_f32_bf16 v252, v245, v228, v252
    v_dot2_f32_bf16 v253, v245, v245, v253
    v_dot2_f32_bf16 v252, v246, v228, v252
    v_dot2_f32_bf16 v253, v246, v246, v253
    v_dot2_f32_bf16 v252, v247, v228, v252
    v_dot2_f32_bf16 v253, v247, v247, v253
    v_dot2_f32_bf16 v252, v248, v228, v252
    v_dot2_f32_bf16 v253, v248, v248, v253
    v_dot2_f32_bf16 v252, v249, v228, v252
    v_dot2_f32_bf16 v253, v249, v249, v253
    v_dot2_f32_bf16 v252, v250, v228, v252
    v_dot2_f32_bf16 v253, v250, v250, v253
    v_dot2_f32_bf16 v252, v251, v228, v252
    v_dot2_f32_bf16 v253, v251, v251, v253
    s_nop 1
    v_add_f32_dpp v252, v252, v252 row_ror:8 row_mask:0xf bank_mask:0xf
    v_add_f32_dpp v253, v253, v253 row_ror:8 row_mask:0xf bank_mask:0xf
    s_nop 0
    v_add_f32_dpp v252, v252, v252 row_ror:4 row_mask:0xf bank_mask:0xf
    v_add_f32_dpp v253, v253, v253 row_ror:4 row_mask:0xf bank_mask:0xf
    s_nop 0
    v_add_f32_dpp v252, v252, v252 row_ror:2 row_mask:0xf bank_mask:0xf
    v_add_f32_dpp v253, v253, v253 row_ror:2 row_mask:0xf bank_mask:0xf
    s_nop 0
    v_add_f32_dpp v252, v252, v252 row_ror:1 row_mask:0xf bank_mask:0xf
    v_add_f32_dpp v253, v253, v253 row_ror:1 row_mask:0xf bank_mask:0xf
    v_mov_b32 v232, v252
    v_mov_b32 v233, v253
    s_nop 0
    v_permlane16_swap_b32 v252, v232
    v_permlane16_swap_b32 v253, v233
    v_add_f32 v252, v252, v232
    v_add_f32 v253, v253, v233
    v_mul_f32 v252, 981467136, v252
    v_mul_f32 v253, 981467136, v253
    v_fma_f32 v253, -v252, v252, v253
    v_max_f32 v253, 0, v253
    v_cvt_pk_bf16_f32 v253, v253, v253
    v_and_b32 v253, 0xffff0000, v253
    v_add_f32 v253, 925353388, v253
    v_cvt_pk_bf16_f32 v253, v253, v253
    v_and_b32 v253, 0xffff0000, v253
    v_sqrt_f32 v253, v253
    s_nop 0
    v_cvt_pk_bf16_f32 v238, v252, v253
    s_branch L_hb0
L_skp0_00:
    s_waitcnt lgkmcnt(0)
    v_mfma_f32_16x16x32_bf16 v[208:211], v[228:231], a[200:203], 0
    v_mfma_f32_16x16x32_bf16 v[208:211], v[228:231], a[204:207], v[208:211]
    v_mfma_f32_16x16x32_bf16 v[212:215], v[228:231], a[216:219], 0
    v_mfma_f32_16x16x32_bf16 v[212:215], v[228:231], a[220:223], v[212:215]
    s_branch L_sbp0_00
L_skp0_02:
    s_waitcnt lgkmcnt(0)
    v_mfma_f32_16x16x32_bf16 v[216:219], v[228:231], a[200:203], 0
    v_mfma_f32_16x16x32_bf16 v[216:219], v[228:231], a[204:207], v[216:219]
    v_mfma_f32_16x16x32_bf16 v[220:223], v[228:231], a[216:219], 0
    v_mfma_f32_16x16x32_bf16 v[220:223], v[228:231], a[220:223], v[220:223]
    s_branch L_sbp0_02
L_skp0_04:
    s_waitcnt lgkmcnt(0)
    v_mfma_f32_16x16x32_bf16 v[224:227], v[228:231], a[200:203], 0
    v_mfma_f32_16x16x32_bf16 v[224:227], v[228:231], a[204:207], v[224:227]
    v_mfma_f32_16x16x32_bf16 v[208:211], v[228:231], a[216:219], v[208:211]
    v_mfma_f32_16x16x32_bf16 v[208:211], v[228:231], a[220:223], v[208:211]
    s_branch L_sbp0_04
L_skh0_00:
    s_waitcnt lgkmcnt(0)
    v_mfma_f32_16x16x32_bf16 v[208:211], v[228:231], a[200:203], 0
    v_mfma_f32_16x16x32_bf16 v[208:211], v[228:231], a[204:207], v[208:211]
    v_mfma_f32_16x16x32_bf16 v[212:215], v[228:231], a[216:219], 0
    v_mfma_f32_16x16x32_bf16 v[212:215], v[228:231], a[220:223], v[212:215]
    s_lshl_b32 s84, s68, 4
    s_add_u32 s84, s84, s65
    s_lshl_b32 s84, s84, 12
    s_add_u32 s84, s84, 724992
    buffer_store_dwordx4 a[128:131], v254, s[44:47], s84 offen offset:0 sc1
    buffer_store_dwordx4 a[128:131], v254, s[44:47], s84 offen offset:1024 sc1
    s_branch L_sbh0_00
L_skh0_02:
    s_waitcnt lgkmcnt(0)
    v_mfma_f32_16x16x32_bf16 v[216:219], v[228:231], a[200:203], 0
    v_mfma_f32_16x16x32_bf16 v[216:219], v[228:231], a[204:207], v[216:219]
    v_mfma_f32_16x16x32_bf16 v[220:223], v[228:231], a[216:219], 0
    v_mfma_f32_16x16x32_bf16 v[220:223], v[228:231], a[220:223], v[220:223]
    s_branch L_sbh0_02
L_skh0_04:
    s_waitcnt lgkmcnt(0)
    v_mfma_f32_16x16x32_bf16 v[224:227], v[228:231], a[200:203], 0
    v_mfma_f32_16x16x32_bf16 v[224:227], v[228:231], a[204:207], v[224:227]
    v_mfma_f32_16x16x32_bf16 v[208:211], v[228:231], a[216:219], v[208:211]
    v_mfma_f32_16x16x32_bf16 v[208:211], v[228:231], a[220:223], v[208:211]
    s_branch L_sbh0_04
L_skh0_11:
    s_waitcnt lgkmcnt(0)
    v_mfma_f32_16x16x32_bf16 v[212:215], v[228:231], a[200:203], v[212:215]
    v_mfma_f32_16x16x32_bf16 v[212:215], v[228:231], a[204:207], v[212:215]
    v_mfma_f32_16x16x32_bf16 v[216:219], v[228:231], a[216:219], v[216:219]
    v_mfma_f32_16x16x32_bf16 v[216:219], v[228:231], a[220:223], v[216:219]
    s_branch L_sbh0_11
L_skh0_13:
    s_waitcnt lgkmcnt(0)
    v_mfma_f32_16x16x32_bf16 v[220:223], v[228:231], a[200:203], v[220:223]
    v_mfma_f32_16x16x32_bf16 v[220:223], v[228:231], a[204:207], v[220:223]
    v_mfma_f32_16x16x32_bf16 v[224:227], v[228:231], a[216:219], v[224:227]
    v_mfma_f32_16x16x32_bf16 v[224:227], v[228:231], a[220:223], v[224:227]
    s_waitcnt vmcnt(8)
    v_readfirstlane_b32 s86, v239
    s_lshl_b32 s84, s68, 3
    s_add_u32 s84, s84, s65
    s_mul_i32 s84, s84, 2560
    s_add_u32 s84, s84, 65536
    v_lshrrev_b32 v229, 1, v254
    s_cmp_eq_u32 s86, 0
    s_cbranch_scc1 L_ns0
L_nb0:
    v_mov_b32 v209, v239
    v_mov_b32 v213, v239
    v_mov_b32 v217, v239
    v_mov_b32 v221, v239
    v_mov_b32 v225, v239
    s_mov_b64 exec, 0xffff
    buffer_store_dwordx2 v[208:209], v229, s[44:47], s84 offen offset:768 sc1
    buffer_store_dwordx2 v[212:213], v229, s[44:47], s84 offen offset:256 sc1
    buffer_store_dwordx2 v[216:217], v229, s[44:47], s84 offen offset:512 sc1
    buffer_store_dwordx2 v[220:221], v229, s[44:47], s84 offen offset:0 sc1
    buffer_store_dwordx2 v[224:225], v229, s[44:47], s84 offen offset:1024 sc1
    s_mov_b64 exec, -1
    s_branch L_sbh0_13
L_gs0:
    s_mov_b32 s76, 0
L_gl0:
    buffer_load_dwordx2 v[224:225], v203, s[44:47], s4 offen sc1
    v_and_b32 v226, 0x78, v203
    buffer_load_dwordx2 v[226:227], v226, s[44:47], s5 offen sc1
    buffer_load_dwordx4 v[208:211], v202, s[44:47], s6 offen offset:0 sc1
    buffer_load_dwordx4 v[192:195], v202, s[44:47], s6 offen offset:2560 sc1
    s_add_u32 s75, s6, 5120
    buffer_load_dwordx4 v[196:199], v202, s[44:47], s75 offen offset:0 sc1
    buffer_load_dwordx4 v[212:215], v202, s[44:47], s75 offen offset:2560 sc1
    s_add_u32 s75, s6, 10240
    buffer_load_dwordx4 v[216:219], v202, s[44:47], s75 offen offset:0 sc1
    buffer_load_dwordx4 v[220:223], v202, s[44:47], s75 offen offset:2560 sc1
    s_add_u32 s75, s6, 15360
    buffer_load_dwordx4 v[228:231], v202, s[44:47], s75 offen offset:0 sc1
    buffer_load_dwordx4 v[232:235], v202, s[44:47], s75 offen offset:2560 sc1
    s_waitcnt vmcnt(0)
    v_min3_u32 v252, v239, v225, v227
    v_max3_u32 v253, v239, v225, v227
    v_min3_u32 v252, v252, v209, v211
    v_max3_u32 v253, v253, v209, v211
    v_min3_u32 v252, v252, v193, v195
    v_max3_u32 v253, v253, v193, v195
    v_add_f32 v208, v208, v192
    v_add_f32 v210, v210, v194
    v_min3_u32 v252, v252, v197, v199
    v_max3_u32 v253, v253, v197, v199
    v_add_f32 v208, v208, v196
    v_add_f32 v210, v210, v198
    v_min3_u32 v252, v252, v213, v215
    v_max3_u32 v253, v253, v213, v215
    v_add_f32 v208, v208, v212
    v_add_f32 v210, v210, v214
    v_min3_u32 v252, v252, v217, v219
    v_max3_u32 v253, v253, v217, v219
    v_add_f32 v208, v208, v216
    v_add_f32 v210, v210, v218
    v_min3_u32 v252, v252, v221, v223
    v_max3_u32 v253, v253, v221, v223
    v_add_f32 v208, v208, v220
    v_add_f32 v210, v210, v222
    v_min3_u32 v252, v252, v229, v231
    v_max3_u32 v253, v253, v229, v231
    v_add_f32 v208, v208, v228
    v_add_f32 v210, v210, v230
    v_min3_u32 v252, v252, v233, v235
    v_max3_u32 v253, v253, v233, v235
    v_add_f32 v208, v208, v232
    v_add_f32 v210, v210, v234
    s_add_u32 s76, s76, 1
    s_cmp_ge_u32 s76, 100000
    s_cbranch_scc1 L_gb0
    v_cmp_ne_u32 vcc, v252, v253
    s_cbranch_vccnz L_gl0
    s_branch L_gb0
L_ns1:
    s_mov_b32 s85, 0
    s_mov_b32 s96, s20
    s_mov_b32 s97, s21
    s_mov_b32 s98, 256
    s_mov_b32 s99, 0x20000
L_nl1:
    buffer_load_dword v239, off, s[96:99], 0 sc1
    s_waitcnt vmcnt(0)
    v_readfirstlane_b32 s86, v239
    s_add_u32 s85, s85, 1
    s_cmp_ge_u32 s85, 100000
    s_cbranch_scc1 L_nb1
    s_cmp_eq_u32 s86, 0
    s_cbranch_scc1 L_nl1
    s_branch L_nb1
L_hs1:
    s_waitcnt vmcnt(11)
    v_dot2_f32_bf16 v252, v232, v228, 0
    v_dot2_f32_bf16 v253, v232, v232, 0
    v_dot2_f32_bf16 v252, v233, v228, v252
    v_dot2_f32_bf16 v253, v233, v233, v253
    v_dot2_f32_bf16 v252, v234, v228, v252
    v_dot2_f32_bf16 v253, v234, v234, v253
    v_dot2_f32_bf16 v252, v235, v228, v252
    v_dot2_f32_bf16 v253, v235, v235, v253
    v_dot2_f32_bf16 v252, v240, v228, v252
    v_dot2_f32_bf16 v253, v240, v240, v253
    v_dot2_f32_bf16 v252, v241, v228, v252
    v_dot2_f32_bf16 v253, v241, v241, v253
    v_dot2_f32_bf16 v252, v242, v228, v252
    v_dot2_f32_bf16 v253, v242, v242, v253
    v_dot2_f32_bf16 v252, v243, v228, v252
    v_dot2_f32_bf16 v253, v243, v243, v253
    v_dot2_f32_bf16 v252, v244, v228, v252
    v_dot2_f32_bf16 v253, v244, v244, v253
    v_dot2_f32_bf16 v252, v245, v228, v252
    v_dot2_f32_bf16 v253, v245, v245, v253
    v_dot2_f32_bf16 v252, v246, v228, v252
    v_dot2_f32_bf16 v253, v246, v246, v253
    v_dot2_f32_bf16 v252, v247, v228, v252
    v_dot2_f32_bf16 v253, v247, v247, v253
    v_dot2_f32_bf16 v252, v248, v228, v252
    v_dot2_f32_bf16 v253, v248, v248, v253
    v_dot2_f32_bf16 v252, v249, v228, v252
    v_dot2_f32_bf16 v253, v249, v249, v253
    v_dot2_f32_bf16 v252, v250, v228, v252
    v_dot2_f32_bf16 v253, v250, v250, v253
    v_dot2_f32_bf16 v252, v251, v228, v252
    v_dot2_f32_bf16 v253, v251, v251, v253
    s_nop 1
    v_add_f32_dpp v252, v252, v252 row_ror:8 row_mask:0xf bank_mask:0xf
    v_add_f32_dpp v253, v253, v253 row_ror:8 row_mask:0xf bank_mask:0xf
    s_nop 0
    v_add_f32_dpp v252, v252, v252 row_ror:4 row_mask:0xf bank_mask:0xf
    v_add_f32_dpp v253, v253, v253 row_ror:4 row_mask:0xf bank_mask:0xf
    s_nop 0
    v_add_f32_dpp v252, v252, v252 row_ror:2 row_mask:0xf bank_mask:0xf
    v_add_f32_dpp v253, v253, v253 row_ror:2 row_mask:0xf bank_mask:0xf
    s_nop 0
    v_add_f32_dpp v252, v252, v252 row_ror:1 row_mask:0xf bank_mask:0xf
    v_add_f32_dpp v253, v253, v253 row_ror:1 row_mask:0xf bank_mask:0xf
    v_mov_b32 v232, v252
    v_mov_b32 v233, v253
    s_nop 0
    v_permlane16_swap_b32 v252, v232
    v_permlane16_swap_b32 v253, v233
    v_add_f32 v252, v252, v232
    v_add_f32 v253, v253, v233
    v_mul_f32 v252, 981467136, v252
    v_mul_f32 v253, 981467136, v253
    v_fma_f32 v253, -v252, v252, v253
    v_max_f32 v253, 0, v253
    v_cvt_pk_bf16_f32 v253, v253, v253
    v_and_b32 v253, 0xffff0000, v253
    v_add_f32 v253, 925353388, v253
    v_cvt_pk_bf16_f32 v253, v253, v253
    v_and_b32 v253, 0xffff0000, v253
    v_sqrt_f32 v253, v253
    s_nop 0
    v_cvt_pk_bf16_f32 v238, v252, v253
    s_branch L_hb1
L_skp1_00:
    s_waitcnt lgkmcnt(0)
    v_mfma_f32_16x16x32_bf16 v[208:211], v[228:231], a[208:211], 0
    v_mfma_f32_16x16x32_bf16 v[208:211], v[228:231], a[212:215], v[208:211]
    v_mfma_f32_16x16x32_bf16 v[212:215], v[228:231], a[224:227], 0
    v_mfma_f32_16x16x32_bf16 v[212:215], v[228:231], a[228:231], v[212:215]
    s_branch L_sbp1_00
L_skp1_02:
    s_waitcnt lgkmcnt(0)
    v_mfma_f32_16x16x32_bf16 v[216:219], v[228:231], a[208:211], 0
    v_mfma_f32_16x16x32_bf16 v[216:219], v[228:231], a[212:215], v[216:219]
    v_mfma_f32_16x16x32_bf16 v[220:223], v[228:231], a[224:227], 0
    v_mfma_f32_16x16x32_bf16 v[220:223], v[228:231], a[228:231], v[220:223]
    s_branch L_sbp1_02
L_skp1_04:
    s_waitcnt lgkmcnt(0)
    v_mfma_f32_16x16x32_bf16 v[224:227], v[228:231], a[208:211], 0
    v_mfma_f32_16x16x32_bf16 v[224:227], v[228:231], a[212:215], v[224:227]
    v_mfma_f32_16x16x32_bf16 v[208:211], v[228:231], a[224:227], v[208:211]
    v_mfma_f32_16x16x32_bf16 v[208:211], v[228:231], a[228:231], v[208:211]
    s_branch L_sbp1_04
L_skh1_00:
    s_waitcnt lgkmcnt(0)
    v_mfma_f32_16x16x32_bf16 v[208:211], v[228:231], a[208:211], 0
    v_mfma_f32_16x16x32_bf16 v[208:211], v[228:231], a[212:215], v[208:211]
    v_mfma_f32_16x16x32_bf16 v[212:215], v[228:231], a[224:227], 0
    v_mfma_f32_16x16x32_bf16 v[212:215], v[228:231], a[228:231], v[212:215]
    s_lshl_b32 s84, s68, 4
    s_add_u32 s84, s84, s65
    s_lshl_b32 s84, s84, 12
    s_add_u32 s84, s84, 727040
    buffer_store_dwordx4 a[128:131], v254, s[44:47], s84 offen offset:0 sc1
    buffer_store_dwordx4 a[128:131], v254, s[44:47], s84 offen offset:1024 sc1
    s_branch L_sbh1_00
L_skh1_02:
    s_waitcnt lgkmcnt(0)
    v_mfma_f32_16x16x32_bf16 v[216:219], v[228:231], a[208:211], 0
    v_mfma_f32_16x16x32_bf16 v[216:219], v[228:231], a[212:215], v[216:219]
    v_mfma_f32_16x16x32_bf16 v[220:223], v[228:231], a[224:227], 0
    v_mfma_f32_16x16x32_bf16 v[220:223], v[228:231], a[228:231], v[220:223]
    s_branch L_sbh1_02
L_skh1_04:
    s_waitcnt lgkmcnt(0)
    v_mfma_f32_16x16x32_bf16 v[224:227], v[228:231], a[208:211], 0
    v_mfma_f32_16x16x32_bf16 v[224:227], v[228:231], a[212:215], v[224:227]
    v_mfma_f32_16x16x32_bf16 v[208:211], v[228:231], a[224:227], v[208:211]
    v_mfma_f32_16x16x32_bf16 v[208:211], v[228:231], a[228:231], v[208:211]
    s_branch L_sbh1_04
L_skh1_11:
    s_waitcnt lgkmcnt(0)
    v_mfma_f32_16x16x32_bf16 v[212:215], v[228:231], a[208:211], v[212:215]
    v_mfma_f32_16x16x32_bf16 v[212:215], v[228:231], a[212:215], v[212:215]
    v_mfma_f32_16x16x32_bf16 v[216:219], v[228:231], a[224:227], v[216:219]
    v_mfma_f32_16x16x32_bf16 v[216:219], v[228:231], a[228:231], v[216:219]
    s_branch L_sbh1_11
L_skh1_13:
    s_waitcnt lgkmcnt(0)
    v_mfma_f32_16x16x32_bf16 v[220:223], v[228:231], a[208:211], v[220:223]
    v_mfma_f32_16x16x32_bf16 v[220:223], v[228:231], a[212:215], v[220:223]
    v_mfma_f32_16x16x32_bf16 v[224:227], v[228:231], a[224:227], v[224:227]
    v_mfma_f32_16x16x32_bf16 v[224:227], v[228:231], a[228:231], v[224:227]
    s_waitcnt vmcnt(6)
    v_readfirstlane_b32 s86, v239
    s_lshl_b32 s84, s68, 3
    s_add_u32 s84, s84, s65
    s_mul_i32 s84, s84, 2560
    s_add_u32 s84, s84, 65536
    v_lshrrev_b32 v229, 1, v254
    s_cmp_eq_u32 s86, 0
    s_cbranch_scc1 L_ns1
L_nb1:
    v_mov_b32 v209, v239
    v_mov_b32 v213, v239
    v_mov_b32 v217, v239
    v_mov_b32 v221, v239
    v_mov_b32 v225, v239
    s_mov_b64 exec, 0xffff
    buffer_store_dwordx2 v[208:209], v229, s[44:47], s84 offen offset:896 sc1
    buffer_store_dwordx2 v[212:213], v229, s[44:47], s84 offen offset:384 sc1
    buffer_store_dwordx2 v[216:217], v229, s[44:47], s84 offen offset:640 sc1
    buffer_store_dwordx2 v[220:221], v229, s[44:47], s84 offen offset:128 sc1
    buffer_store_dwordx2 v[224:225], v229, s[44:47], s84 offen offset:1152 sc1
    s_mov_b64 exec, -1
    s_branch L_sbh1_13
L_gs1:
    s_mov_b32 s76, 0
L_gl1:
    buffer_load_dwordx2 v[224:225], v203, s[44:47], s4 offen sc1
    v_and_b32 v226, 0x78, v203
    buffer_load_dwordx2 v[226:227], v226, s[44:47], s5 offen sc1
    buffer_load_dwordx4 v[208:211], v202, s[44:47], s6 offen offset:0 sc1
    buffer_load_dwordx4 v[192:195], v202, s[44:47], s6 offen offset:2560 sc1
    s_add_u32 s75, s6, 5120
    buffer_load_dwordx4 v[196:199], v202, s[44:47], s75 offen offset:0 sc1
    buffer_load_dwordx4 v[212:215], v202, s[44:47], s75 offen offset:2560 sc1
    s_add_u32 s75, s6, 10240
    buffer_load_dwordx4 v[216:219], v202, s[44:47], s75 offen offset:0 sc1
    buffer_load_dwordx4 v[220:223], v202, s[44:47], s75 offen offset:2560 sc1
    s_add_u32 s75, s6, 15360
    buffer_load_dwordx4 v[228:231], v202, s[44:47], s75 offen offset:0 sc1
    buffer_load_dwordx4 v[232:235], v202, s[44:47], s75 offen offset:2560 sc1
    s_waitcnt vmcnt(0)
    v_min3_u32 v252, v239, v225, v227
    v_max3_u32 v253, v239, v225, v227
    v_min3_u32 v252, v252, v209, v211
    v_max3_u32 v253, v253, v209, v211
    v_min3_u32 v252, v252, v193, v195
    v_max3_u32 v253, v253, v193, v195
    v_add_f32 v208, v208, v192
    v_add_f32 v210, v210, v194
    v_min3_u32 v252, v252, v197, v199
    v_max3_u32 v253, v253, v197, v199
    v_add_f32 v208, v208, v196
    v_add_f32 v210, v210, v198
    v_min3_u32 v252, v252, v213, v215
    v_max3_u32 v253, v253, v213, v215
    v_add_f32 v208, v208, v212
    v_add_f32 v210, v210, v214
    v_min3_u32 v252, v252, v217, v219
    v_max3_u32 v253, v253, v217, v219
    v_add_f32 v208, v208, v216
    v_add_f32 v210, v210, v218
    v_min3_u32 v252, v252, v221, v223
    v_max3_u32 v253, v253, v221, v223
    v_add_f32 v208, v208, v220
    v_add_f32 v210, v210, v222
    v_min3_u32 v252, v252, v229, v231
    v_max3_u32 v253, v253, v229, v231
    v_add_f32 v208, v208, v228
    v_add_f32 v210, v210, v230
    v_min3_u32 v252, v252, v233, v235
    v_max3_u32 v253, v253, v233, v235
    v_add_f32 v208, v208, v232
    v_add_f32 v210, v210, v234
    s_add_u32 s76, s76, 1
    s_cmp_ge_u32 s76, 100000
    s_cbranch_scc1 L_gb1
    v_cmp_ne_u32 vcc, v252, v253
    s_cbranch_vccnz L_gl1
    s_branch L_gb1
L_hxs:
    s_mov_b32 s86, 0
L_hxl:
    buffer_load_dwordx4 v[200:203], v254, s[44:47], s75 offen offset:0 sc1
    buffer_load_dwordx4 v[204:207], v254, s[44:47], s75 offen offset:1024 sc1
    s_waitcnt vmcnt(0)
    s_add_u32 s86, s86, 1
    s_cmp_ge_u32 s86, 100000
    s_cbranch_scc1 L_hxb
    v_max_u32 v228, v200, v204
    v_cmp_eq_u32 vcc, -1, v228
    s_nop 1
    s_cmp_lg_u64 vcc, 0
    s_cbranch_scc1 L_hxl
    s_branch L_hxb
L_ns2:
    s_mov_b32 s85, 0
    s_mov_b32 s96, s20
    s_mov_b32 s97, s21
    s_mov_b32 s98, 256
    s_mov_b32 s99, 0x20000
L_nl2:
    buffer_load_dword v239, off, s[96:99], 0 sc1
    s_waitcnt vmcnt(0)
    v_readfirstlane_b32 s86, v239
    s_add_u32 s85, s85, 1
    s_cmp_ge_u32 s85, 100000
    s_cbranch_scc1 L_nb2
    s_cmp_eq_u32 s86, 0
    s_cbranch_scc1 L_nl2
    s_branch L_nb2
L_hs2:
    s_waitcnt vmcnt(15)
    v_dot2_f32_bf16 v252, v232, v228, 0
    v_dot2_f32_bf16 v253, v232, v232, 0
    v_dot2_f32_bf16 v252, v233, v228, v252
    v_dot2_f32_bf16 v253, v233, v233, v253
    v_dot2_f32_bf16 v252, v234, v228, v252
    v_dot2_f32_bf16 v253, v234, v234, v253
    v_dot2_f32_bf16 v252, v235, v228, v252
    v_dot2_f32_bf16 v253, v235, v235, v253
    v_dot2_f32_bf16 v252, v240, v228, v252
    v_dot2_f32_bf16 v253, v240, v240, v253
    v_dot2_f32_bf16 v252, v241, v228, v252
    v_dot2_f32_bf16 v253, v241, v241, v253
    v_dot2_f32_bf16 v252, v242, v228, v252
    v_dot2_f32_bf16 v253, v242, v242, v253
    v_dot2_f32_bf16 v252, v243, v228, v252
    v_dot2_f32_bf16 v253, v243, v243, v253
    v_dot2_f32_bf16 v252, v244, v228, v252
    v_dot2_f32_bf16 v253, v244, v244, v253
    v_dot2_f32_bf16 v252, v245, v228, v252
    v_dot2_f32_bf16 v253, v245, v245, v253
    v_dot2_f32_bf16 v252, v246, v228, v252
    v_dot2_f32_bf16 v253, v246, v246, v253
    v_dot2_f32_bf16 v252, v247, v228, v252
    v_dot2_f32_bf16 v253, v247, v247, v253
    v_dot2_f32_bf16 v252, v248, v228, v252
    v_dot2_f32_bf16 v253, v248, v248, v253
    v_dot2_f32_bf16 v252, v249, v228, v252
    v_dot2_f32_bf16 v253, v249, v249, v253
    v_dot2_f32_bf16 v252, v250, v228, v252
    v_dot2_f32_bf16 v253, v250, v250, v253
    v_dot2_f32_bf16 v252, v251, v228, v252
    v_dot2_f32_bf16 v253, v251, v251, v253
    s_nop 1
    v_add_f32_dpp v252, v252, v252 row_ror:8 row_mask:0xf bank_mask:0xf
    v_add_f32_dpp v253, v253, v253 row_ror:8 row_mask:0xf bank_mask:0xf
    s_nop 0
    v_add_f32_dpp v252, v252, v252 row_ror:4 row_mask:0xf bank_mask:0xf
    v_add_f32_dpp v253, v253, v253 row_ror:4 row_mask:0xf bank_mask:0xf
    s_nop 0
    v_add_f32_dpp v252, v252, v252 row_ror:2 row_mask:0xf bank_mask:0xf
    v_add_f32_dpp v253, v253, v253 row_ror:2 row_mask:0xf bank_mask:0xf
    s_nop 0
    v_add_f32_dpp v252, v252, v252 row_ror:1 row_mask:0xf bank_mask:0xf
    v_add_f32_dpp v253, v253, v253 row_ror:1 row_mask:0xf bank_mask:0xf
    v_mov_b32 v232, v252
    v_mov_b32 v233, v253
    s_nop 0
    v_permlane16_swap_b32 v252, v232
    v_permlane16_swap_b32 v253, v233
    v_add_f32 v252, v252, v232
    v_add_f32 v253, v253, v233
    v_mul_f32 v252, 981467136, v252
    v_mul_f32 v253, 981467136, v253
    v_fma_f32 v253, -v252, v252, v253
    v_max_f32 v253, 0, v253
    v_cvt_pk_bf16_f32 v253, v253, v253
    v_and_b32 v253, 0xffff0000, v253
    v_add_f32 v253, 925353388, v253
    v_cvt_pk_bf16_f32 v253, v253, v253
    v_and_b32 v253, 0xffff0000, v253
    v_sqrt_f32 v253, v253
    s_nop 0
    v_cvt_pk_bf16_f32 v238, v252, v253
    s_branch L_hb2
L_skp2_00:
    s_waitcnt lgkmcnt(0)
    v_mfma_f32_16x16x32_bf16 v[208:211], v[228:231], a[200:203], 0
    v_mfma_f32_16x16x32_bf16 v[208:211], v[228:231], a[204:207], v[208:211]
    v_mfma_f32_16x16x32_bf16 v[212:215], v[228:231], a[216:219], 0
    v_mfma_f32_16x16x32_bf16 v[212:215], v[228:231], a[220:223], v[212:215]
    s_branch L_sbp2_00
L_skp2_02:
    s_waitcnt lgkmcnt(0)
    v_mfma_f32_16x16x32_bf16 v[216:219], v[228:231], a[200:203], 0
    v_mfma_f32_16x16x32_bf16 v[216:219], v[228:231], a[204:207], v[216:219]
    v_mfma_f32_16x16x32_bf16 v[220:223], v[228:231], a[216:219], 0
    v_mfma_f32_16x16x32_bf16 v[220:223], v[228:231], a[220:223], v[220:223]
    s_branch L_sbp2_02
L_skp2_04:
    s_waitcnt lgkmcnt(0)
    v_mfma_f32_16x16x32_bf16 v[224:227], v[228:231], a[200:203], 0
    v_mfma_f32_16x16x32_bf16 v[224:227], v[228:231], a[204:207], v[224:227]
    v_mfma_f32_16x16x32_bf16 v[208:211], v[228:231], a[216:219], v[208:211]
    v_mfma_f32_16x16x32_bf16 v[208:211], v[228:231], a[220:223], v[208:211]
    s_branch L_sbp2_04
L_skh2_00:
    s_waitcnt lgkmcnt(0)
    v_mfma_f32_16x16x32_bf16 v[208:211], v[228:231], a[200:203], 0
    v_mfma_f32_16x16x32_bf16 v[208:211], v[228:231], a[204:207], v[208:211]
    v_mfma_f32_16x16x32_bf16 v[212:215], v[228:231], a[216:219], 0
    v_mfma_f32_16x16x32_bf16 v[212:215], v[228:231], a[220:223], v[212:215]
    s_branch L_sbh2_00
L_skh2_02:
    s_waitcnt lgkmcnt(0)
    v_mfma_f32_16x16x32_bf16 v[216:219], v[228:231], a[200:203], 0
    v_mfma_f32_16x16x32_bf16 v[216:219], v[228:231], a[204:207], v[216:219]
    v_mfma_f32_16x16x32_bf16 v[220:223], v[228:231], a[216:219], 0
    v_mfma_f32_16x16x32_bf16 v[220:223], v[228:231], a[220:223], v[220:223]
    s_branch L_sbh2_02
L_skh2_04:
    s_waitcnt lgkmcnt(0)
    v_mfma_f32_16x16x32_bf16 v[224:227], v[228:231], a[200:203], 0
    v_mfma_f32_16x16x32_bf16 v[224:227], v[228:231], a[204:207], v[224:227]
    v_mfma_f32_16x16x32_bf16 v[208:211], v[228:231], a[216:219], v[208:211]
    v_mfma_f32_16x16x32_bf16 v[208:211], v[228:231], a[220:223], v[208:211]
    s_branch L_sbh2_04
L_skh2_11:
    s_waitcnt lgkmcnt(0)
    v_mfma_f32_16x16x32_bf16 v[212:215], v[228:231], a[200:203], v[212:215]
    v_mfma_f32_16x16x32_bf16 v[212:215], v[228:231], a[204:207], v[212:215]
    v_mfma_f32_16x16x32_bf16 v[216:219], v[228:231], a[216:219], v[216:219]
    v_mfma_f32_16x16x32_bf16 v[216:219], v[228:231], a[220:223], v[216:219]
    s_branch L_sbh2_11
L_skh2_13:
    s_waitcnt lgkmcnt(0)
    v_mfma_f32_16x16x32_bf16 v[220:223], v[228:231], a[200:203], v[220:223]
    v_mfma_f32_16x16x32_bf16 v[220:223], v[228:231], a[204:207], v[220:223]
    v_mfma_f32_16x16x32_bf16 v[224:227], v[228:231], a[216:219], v[224:227]
    v_mfma_f32_16x16x32_bf16 v[224:227], v[228:231], a[220:223], v[224:227]
    s_waitcnt vmcnt(8)
    v_readfirstlane_b32 s86, v239
    s_lshl_b32 s84, s68, 3
    s_add_u32 s84, s84, s65
    s_mul_i32 s84, s84, 2560
    s_add_u32 s84, s84, 65536
    v_lshrrev_b32 v229, 1, v254
    s_cmp_eq_u32 s86, 0
    s_cbranch_scc1 L_ns2
L_nb2:
    v_mov_b32 v209, v239
    v_mov_b32 v213, v239
    v_mov_b32 v217, v239
    v_mov_b32 v221, v239
    v_mov_b32 v225, v239
    s_mov_b64 exec, 0xffff
    buffer_store_dwordx2 v[208:209], v229, s[44:47], s84 offen offset:1280 sc1
    buffer_store_dwordx2 v[212:213], v229, s[44:47], s84 offen offset:1536 sc1
    buffer_store_dwordx2 v[216:217], v229, s[44:47], s84 offen offset:1792 sc1
    buffer_store_dwordx2 v[220:221], v229, s[44:47], s84 offen offset:2048 sc1
    buffer_store_dwordx2 v[224:225], v229, s[44:47], s84 offen offset:2304 sc1
    s_mov_b64 exec, -1
    s_branch L_sbh2_13
L_ns3:
    s_mov_b32 s85, 0
    s_mov_b32 s96, s20
    s_mov_b32 s97, s21
    s_mov_b32 s98, 256
    s_mov_b32 s99, 0x20000
L_nl3:
    buffer_load_dword v239, off, s[96:99], 0 sc1
    s_waitcnt vmcnt(0)
    v_readfirstlane_b32 s86, v239
    s_add_u32 s85, s85, 1
    s_cmp_ge_u32 s85, 100000
    s_cbranch_scc1 L_nb3
    s_cmp_eq_u32 s86, 0
    s_cbranch_scc1 L_nl3
    s_branch L_nb3
L_hs3:
    s_waitcnt vmcnt(9)
    v_dot2_f32_bf16 v252, v232, v228, 0
    v_dot2_f32_bf16 v253, v232, v232, 0
    v_dot2_f32_bf16 v252, v233, v228, v252
    v_dot2_f32_bf16 v253, v233, v233, v253
    v_dot2_f32_bf16 v252, v234, v228, v252
    v_dot2_f32_bf16 v253, v234, v234, v253
    v_dot2_f32_bf16 v252, v235, v228, v252
    v_dot2_f32_bf16 v253, v235, v235, v253
    v_dot2_f32_bf16 v252, v240, v228, v252
    v_dot2_f32_bf16 v253, v240, v240, v253
    v_dot2_f32_bf16 v252, v241, v228, v252
    v_dot2_f32_bf16 v253, v241, v241, v253
    v_dot2_f32_bf16 v252, v242, v228, v252
    v_dot2_f32_bf16 v253, v242, v242, v253
    v_dot2_f32_bf16 v252, v243, v228, v252
    v_dot2_f32_bf16 v253, v243, v243, v253
    v_dot2_f32_bf16 v252, v244, v228, v252
    v_dot2_f32_bf16 v253, v244, v244, v253
    v_dot2_f32_bf16 v252, v245, v228, v252
    v_dot2_f32_bf16 v253, v245, v245, v253
    v_dot2_f32_bf16 v252, v246, v228, v252
    v_dot2_f32_bf16 v253, v246, v246, v253
    v_dot2_f32_bf16 v252, v247, v228, v252
    v_dot2_f32_bf16 v253, v247, v247, v253
    v_dot2_f32_bf16 v252, v248, v228, v252
    v_dot2_f32_bf16 v253, v248, v248, v253
    v_dot2_f32_bf16 v252, v249, v228, v252
    v_dot2_f32_bf16 v253, v249, v249, v253
    v_dot2_f32_bf16 v252, v250, v228, v252
    v_dot2_f32_bf16 v253, v250, v250, v253
    v_dot2_f32_bf16 v252, v251, v228, v252
    v_dot2_f32_bf16 v253, v251, v251, v253
    s_nop 1
    v_add_f32_dpp v252, v252, v252 row_ror:8 row_mask:0xf bank_mask:0xf
    v_add_f32_dpp v253, v253, v253 row_ror:8 row_mask:0xf bank_mask:0xf
    s_nop 0
    v_add_f32_dpp v252, v252, v252 row_ror:4 row_mask:0xf bank_mask:0xf
    v_add_f32_dpp v253, v253, v253 row_ror:4 row_mask:0xf bank_mask:0xf
    s_nop 0
    v_add_f32_dpp v252, v252, v252 row_ror:2 row_mask:0xf bank_mask:0xf
    v_add_f32_dpp v253, v253, v253 row_ror:2 row_mask:0xf bank_mask:0xf
    s_nop 0
    v_add_f32_dpp v252, v252, v252 row_ror:1 row_mask:0xf bank_mask:0xf
    v_add_f32_dpp v253, v253, v253 row_ror:1 row_mask:0xf bank_mask:0xf
    v_mov_b32 v232, v252
    v_mov_b32 v233, v253
    s_nop 0
    v_permlane16_swap_b32 v252, v232
    v_permlane16_swap_b32 v253, v233
    v_add_f32 v252, v252, v232
    v_add_f32 v253, v253, v233
    v_mul_f32 v252, 981467136, v252
    v_mul_f32 v253, 981467136, v253
    v_fma_f32 v253, -v252, v252, v253
    v_max_f32 v253, 0, v253
    v_cvt_pk_bf16_f32 v253, v253, v253
    v_and_b32 v253, 0xffff0000, v253
    v_add_f32 v253, 925353388, v253
    v_cvt_pk_bf16_f32 v253, v253, v253
    v_and_b32 v253, 0xffff0000, v253
    v_sqrt_f32 v253, v253
    s_nop 0
    v_cvt_pk_bf16_f32 v238, v252, v253
    s_branch L_hb3
L_skp3_00:
    s_waitcnt lgkmcnt(0)
    v_mfma_f32_16x16x32_bf16 v[208:211], v[228:231], a[208:211], 0
    v_mfma_f32_16x16x32_bf16 v[208:211], v[228:231], a[212:215], v[208:211]
    v_mfma_f32_16x16x32_bf16 v[212:215], v[228:231], a[224:227], 0
    v_mfma_f32_16x16x32_bf16 v[212:215], v[228:231], a[228:231], v[212:215]
    s_branch L_sbp3_00
L_skp3_02:
    s_waitcnt lgkmcnt(0)
    v_mfma_f32_16x16x32_bf16 v[216:219], v[228:231], a[208:211], 0
    v_mfma_f32_16x16x32_bf16 v[216:219], v[228:231], a[212:215], v[216:219]
    v_mfma_f32_16x16x32_bf16 v[220:223], v[228:231], a[224:227], 0
    v_mfma_f32_16x16x32_bf16 v[220:223], v[228:231], a[228:231], v[220:223]
    s_branch L_sbp3_02
L_skp3_04:
    s_waitcnt lgkmcnt(0)
    v_mfma_f32_16x16x32_bf16 v[224:227], v[228:231], a[208:211], 0
    v_mfma_f32_16x16x32_bf16 v[224:227], v[228:231], a[212:215], v[224:227]
    v_mfma_f32_16x16x32_bf16 v[208:211], v[228:231], a[224:227], v[208:211]
    v_mfma_f32_16x16x32_bf16 v[208:211], v[228:231], a[228:231], v[208:211]
    s_branch L_sbp3_04
L_skh3_00:
    s_waitcnt lgkmcnt(0)
    v_mfma_f32_16x16x32_bf16 v[208:211], v[228:231], a[208:211], 0
    v_mfma_f32_16x16x32_bf16 v[208:211], v[228:231], a[212:215], v[208:211]
    v_mfma_f32_16x16x32_bf16 v[212:215], v[228:231], a[224:227], 0
    v_mfma_f32_16x16x32_bf16 v[212:215], v[228:231], a[228:231], v[212:215]
    s_branch L_sbh3_00
L_skh3_02:
    s_waitcnt lgkmcnt(0)
    v_mfma_f32_16x16x32_bf16 v[216:219], v[228:231], a[208:211], 0
    v_mfma_f32_16x16x32_bf16 v[216:219], v[228:231], a[212:215], v[216:219]
    v_mfma_f32_16x16x32_bf16 v[220:223], v[228:231], a[224:227], 0
    v_mfma_f32_16x16x32_bf16 v[220:223], v[228:231], a[228:231], v[220:223]
    s_branch L_sbh3_02
L_skh3_04:
    s_waitcnt lgkmcnt(0)
    v_mfma_f32_16x16x32_bf16 v[224:227], v[228:231], a[208:211], 0
    v_mfma_f32_16x16x32_bf16 v[224:227], v[228:231], a[212:215], v[224:227]
    v_mfma_f32_16x16x32_bf16 v[208:211], v[228:231], a[224:227], v[208:211]
    v_mfma_f32_16x16x32_bf16 v[208:211], v[228:231], a[228:231], v[208:211]
    s_branch L_sbh3_04
L_skh3_11:
    s_waitcnt lgkmcnt(0)
    v_mfma_f32_16x16x32_bf16 v[212:215], v[228:231], a[208:211], v[212:215]
    v_mfma_f32_16x16x32_bf16 v[212:215], v[228:231], a[212:215], v[212:215]
    v_mfma_f32_16x16x32_bf16 v[216:219], v[228:231], a[224:227], v[216:219]
    v_mfma_f32_16x16x32_bf16 v[216:219], v[228:231], a[228:231], v[216:219]
    s_branch L_sbh3_11
L_skh3_13:
    s_waitcnt lgkmcnt(0)
    v_mfma_f32_16x16x32_bf16 v[220:223], v[228:231], a[208:211], v[220:223]
    v_mfma_f32_16x16x32_bf16 v[220:223], v[228:231], a[212:215], v[220:223]
    v_mfma_f32_16x16x32_bf16 v[224:227], v[228:231], a[224:227], v[224:227]
    v_mfma_f32_16x16x32_bf16 v[224:227], v[228:231], a[228:231], v[224:227]
    s_waitcnt vmcnt(8)
    v_readfirstlane_b32 s86, v239
    s_lshl_b32 s84, s68, 3
    s_add_u32 s84, s84, s65
    s_mul_i32 s84, s84, 2560
    s_add_u32 s84, s84, 65536
    v_lshrrev_b32 v229, 1, v254
    s_cmp_eq_u32 s86, 0
    s_cbranch_scc1 L_ns3
L_nb3:
    v_mov_b32 v209, v239
    v_mov_b32 v213, v239
    v_mov_b32 v217, v239
    v_mov_b32 v221, v239
    v_mov_b32 v225, v239
    s_mov_b64 exec, 0xffff
    buffer_store_dwordx2 v[208:209], v229, s[44:47], s84 offen offset:1408 sc1
    buffer_store_dwordx2 v[212:213], v229, s[44:47], s84 offen offset:1664 sc1
    buffer_store_dwordx2 v[216:217], v229, s[44:47], s84 offen offset:1920 sc1
    buffer_store_dwordx2 v[220:221], v229, s[44:47], s84 offen offset:2176 sc1
    buffer_store_dwordx2 v[224:225], v229, s[44:47], s84 offen offset:2432 sc1
    s_mov_b64 exec, 1
    s_getreg_b32 s84, hwreg(HW_REG_XCC_ID, 0, 4)
    s_add_u32 s84, s84, 1
    v_add_u32 v210, s84, v239
    s_lshl_b32 s84, s67, 2
    s_add_u32 s84, s84, s77
    buffer_store_dword v210, v254, s[44:47], s84 offen offset:512 sc1
    s_mov_b64 exec, -1
    s_branch L_sbh3_13
L_gs2:
    s_mov_b32 s76, 0
L_gl2:
    buffer_load_dwordx2 v[224:225], v203, s[44:47], s4 offen sc1
    v_and_b32 v226, 0x78, v203
    buffer_load_dwordx2 v[226:227], v226, s[44:47], s5 offen sc1
    buffer_load_dwordx4 v[208:211], v202, s[44:47], s6 offen offset:0 sc1
    buffer_load_dwordx4 v[192:195], v202, s[44:47], s6 offen offset:2560 sc1
    s_add_u32 s75, s6, 5120
    buffer_load_dwordx4 v[196:199], v202, s[44:47], s75 offen offset:0 sc1
    buffer_load_dwordx4 v[212:215], v202, s[44:47], s75 offen offset:2560 sc1
    s_add_u32 s75, s6, 10240
    buffer_load_dwordx4 v[216:219], v202, s[44:47], s75 offen offset:0 sc1
    buffer_load_dwordx4 v[220:223], v202, s[44:47], s75 offen offset:2560 sc1
    s_add_u32 s75, s6, 15360
    buffer_load_dwordx4 v[228:231], v202, s[44:47], s75 offen offset:0 sc1
    buffer_load_dwordx4 v[232:235], v202, s[44:47], s75 offen offset:2560 sc1
    s_waitcnt vmcnt(0)
    v_min3_u32 v252, v239, v225, v227
    v_max3_u32 v253, v239, v225, v227
    v_min3_u32 v252, v252, v209, v211
    v_max3_u32 v253, v253, v209, v211
    v_min3_u32 v252, v252, v193, v195
    v_max3_u32 v253, v253, v193, v195
    v_add_f32 v208, v208, v192
    v_add_f32 v210, v210, v194
    v_min3_u32 v252, v252, v197, v199
    v_max3_u32 v253, v253, v197, v199
    v_add_f32 v208, v208, v196
    v_add_f32 v210, v210, v198
    v_min3_u32 v252, v252, v213, v215
    v_max3_u32 v253, v253, v213, v215
    v_add_f32 v208, v208, v212
    v_add_f32 v210, v210, v214
    v_min3_u32 v252, v252, v217, v219
    v_max3_u32 v253, v253, v217, v219
    v_add_f32 v208, v208, v216
    v_add_f32 v210, v210, v218
    v_min3_u32 v252, v252, v221, v223
    v_max3_u32 v253, v253, v221, v223
    v_add_f32 v208, v208, v220
    v_add_f32 v210, v210, v222
    v_min3_u32 v252, v252, v229, v231
    v_max3_u32 v253, v253, v229, v231
    v_add_f32 v208, v208, v228
    v_add_f32 v210, v210, v230
    v_min3_u32 v252, v252, v233, v235
    v_max3_u32 v253, v253, v233, v235
    v_add_f32 v208, v208, v232
    v_add_f32 v210, v210, v234
    s_add_u32 s76, s76, 1
    s_cmp_ge_u32 s76, 100000
    s_cbranch_scc1 L_gb2
    v_cmp_ne_u32 vcc, v252, v253
    s_cbranch_vccnz L_gl2
    s_branch L_gb2
L_ds:
    s_mov_b32 s86, 0
L_dl:
    buffer_load_dwordx2 v[224:225], v226, s[44:47], s28 offen sc1
    s_waitcnt vmcnt(0)
    s_add_u32 s86, s86, 1
    s_cmp_ge_u32 s86, 100000
    s_cbranch_scc1 L_db
    v_cmp_ne_u32 vcc, v239, v225
    s_nop 1
    s_cmp_lg_u64 vcc, 0
    s_cbranch_scc1 L_dl
    s_branch L_db
L_fw_g2:
    buffer_wbl2 sc1
    s_waitcnt vmcnt(0)
    s_branch L_fl_g2
L_slow_p1:
    s_mov_b32 s86, 0
    v_lshrrev_b32 v230, 2, v254
L_slowl_p1:
    buffer_load_dword v238, v230, s[44:47], s77 offen offset:0 sc1
    s_waitcnt vmcnt(0)
    s_add_u32 s86, s86, 1
    s_cmp_ge_u32 s86, 100000
    s_cbranch_scc1 L_back_p1
    v_cmp_eq_u32 s[4:5], v239, v238
    s_nop 1
    s_or_b32 s4, s4, s5
    s_or_b32 s4, s4, s11
    s_cmp_eq_u32 s4, -1
    s_cbranch_scc0 L_slowl_p1
    s_branch L_back_p1
L_slow_p2:
    s_mov_b32 s86, 0
    v_lshrrev_b32 v230, 2, v254
L_slowl_p2:
    buffer_load_dword v168, v230, s[44:47], s77 offen offset:256 sc1
    s_waitcnt vmcnt(0)
    s_add_u32 s86, s86, 1
    s_cmp_ge_u32 s86, 100000
    s_cbranch_scc1 L_back_p2
    v_cmp_eq_u32 s[4:5], v239, v168
    s_nop 1
    s_or_b32 s4, s4, s5
    s_cmp_eq_u32 s4, -1
    s_cbranch_scc0 L_slowl_p2
    s_branch L_back_p2
L_slow_p3c:
    s_mov_b32 s86, 0
    v_lshrrev_b32 v230, 2, v254
L_slowl_p3c:
    buffer_load_dword v169, v230, s[44:47], s30 offen offset:256 sc1
    s_waitcnt vmcnt(0)
    s_add_u32 s86, s86, 1
    s_cmp_ge_u32 s86, 100000
    s_cbranch_scc1 L_back_p3c
    v_cmp_eq_u32 s[4:5], v239, v169
    s_nop 1
    s_or_b32 s4, s5, s5
    s_cmp_eq_u32 s4, -1
    s_cbranch_scc0 L_slowl_p3c
    s_branch L_back_p3c
L_slow_p414:
    s_mov_b32 s86, 0
    v_lshrrev_b32 v230, 2, v254
L_slowl_p414:
    buffer_load_dword v170, v230, s[44:47], s77 offen offset:768 sc1
    s_waitcnt vmcnt(0)
    s_add_u32 s86, s86, 1
    s_cmp_ge_u32 s86, 100000
    s_cbranch_scc1 L_back_p414
    v_cmp_eq_u32 s[4:5], v239, v170
    s_nop 1
    s_or_b32 s4, s4, s5
    s_cmp_eq_u32 s4, -1
    s_cbranch_scc0 L_slowl_p414
    s_branch L_back_p414
L_slow_p410:
    s_mov_b32 s86, 0
    v_lshrrev_b32 v230, 2, v254
L_slowl_p410:
    buffer_load_dword v170, v230, s[44:47], s77 offen offset:768 sc1
    s_waitcnt vmcnt(0)
    s_add_u32 s86, s86, 1
    s_cmp_ge_u32 s86, 100000
    s_cbranch_scc1 L_back_p410
    v_cmp_eq_u32 s[4:5], v239, v170
    s_nop 1
    s_or_b32 s4, s4, s5
    s_cmp_eq_u32 s4, -1
    s_cbranch_scc0 L_slowl_p410
    s_branch L_back_p410
L_slow_p311:
    s_mov_b32 s86, 0
    v_lshrrev_b32 v230, 2, v254
L_slowl_p311:
    buffer_load_dword v169, v230, s[44:47], s30 offen offset:256 sc1
    s_waitcnt vmcnt(0)
    s_add_u32 s86, s86, 1
    s_cmp_ge_u32 s86, 100000
    s_cbranch_scc1 L_back_p311
    v_cmp_eq_u32 s[4:5], v239, v169
    s_nop 1
    s_or_b32 s4, s5, s5
    s_cmp_eq_u32 s4, -1
    s_cbranch_scc0 L_slowl_p311
    s_branch L_back_p311
L_slow_p411:
    s_mov_b32 s86, 0
    v_lshrrev_b32 v230, 2, v254
L_slowl_p411:
    buffer_load_dword v170, v230, s[44:47], s77 offen offset:768 sc1
    s_waitcnt vmcnt(0)
    s_add_u32 s86, s86, 1
    s_cmp_ge_u32 s86, 100000
    s_cbranch_scc1 L_back_p411
    v_cmp_eq_u32 s[4:5], v239, v170
    s_nop 1
    s_or_b32 s4, s4, s5
    s_cmp_eq_u32 s4, -1
    s_cbranch_scc0 L_slowl_p411
    s_branch L_back_p411
L_slow_p412:
    s_mov_b32 s86, 0
    v_lshrrev_b32 v230, 2, v254
L_slowl_p412:
    buffer_load_dword v170, v230, s[44:47], s77 offen offset:768 sc1
    s_waitcnt vmcnt(0)
    s_add_u32 s86, s86, 1
    s_cmp_ge_u32 s86, 100000
    s_cbranch_scc1 L_back_p412
    v_cmp_eq_u32 s[4:5], v239, v170
    s_nop 1
    s_or_b32 s4, s4, s5
    s_cmp_eq_u32 s4, -1
    s_cbranch_scc0 L_slowl_p412
    s_branch L_back_p412
L_slow_p413:
    s_mov_b32 s86, 0
    v_lshrrev_b32 v230, 2, v254
L_slowl_p413:
    buffer_load_dword v170, v230, s[44:47], s77 offen offset:768 sc1
    s_waitcnt vmcnt(0)
    s_add_u32 s86, s86, 1
    s_cmp_ge_u32 s86, 100000
    s_cbranch_scc1 L_back_p413
    v_cmp_eq_u32 s[4:5], v239, v170
    s_nop 1
    s_or_b32 s4, s4, s5
    s_cmp_eq_u32 s4, -1
    s_cbranch_scc0 L_slowl_p413
    s_branch L_back_p413
L_rt2:
    s_mov_b32 s86, 0
    buffer_load_dwordx4 v[192:195], v240, s[40:43], s82 offen sc1
    buffer_load_dwordx4 v[196:199], v241, s[40:43], s82 offen sc1
    buffer_load_dwordx4 v[200:203], v242, s[40:43], s82 offen sc1
    buffer_load_dwordx4 v[204:207], v243, s[40:43], s82 offen sc1
    s_branch L_rc2
L_rl2:
    buffer_load_dwordx4 v[192:195], v240, s[40:43], s82 offen sc1
    buffer_load_dwordx4 v[196:199], v241, s[40:43], s82 offen sc1
    buffer_load_dwordx4 v[200:203], v242, s[40:43], s82 offen sc1
    buffer_load_dwordx4 v[204:207], v243, s[40:43], s82 offen sc1
    v_and_b32 v224, v208, v212
    v_and_b32 v225, v216, v220
    v_and_b32 v224, 1, v224
    v_and_b32 v224, v224, v225
    v_cmp_eq_u32 vcc, 0, v224
    s_nop 1
    s_cmp_lg_u64 vcc, 0
    s_cbranch_scc0 L_rs21
    buffer_load_dwordx4 v[208:211], v240, s[40:43], s81 offen sc1
    buffer_load_dwordx4 v[212:215], v241, s[40:43], s81 offen sc1
    buffer_load_dwordx4 v[216:219], v242, s[40:43], s81 offen sc1
    buffer_load_dwordx4 v[220:223], v243, s[40:43], s81 offen sc1
L_rs21:
    v_and_b32 v224, v48, v52
    v_and_b32 v225, v56, v60
    v_and_b32 v224, 1, v224
    v_and_b32 v224, v224, v225
    v_cmp_eq_u32 vcc, 0, v224
    s_nop 1
    s_cmp_lg_u64 vcc, 0
    s_cbranch_scc0 L_rs20
    buffer_load_dwordx4 v[48:51], v240, s[40:43], s80 offen sc1
    buffer_load_dwordx4 v[52:55], v241, s[40:43], s80 offen sc1
    buffer_load_dwordx4 v[56:59], v242, s[40:43], s80 offen sc1
    buffer_load_dwordx4 v[60:63], v243, s[40:43], s80 offen sc1
L_rs20:
L_rc2:
    s_waitcnt vmcnt(0)
    s_add_u32 s86, s86, 1
    s_cmp_ge_u32 s86, 100000
    s_cbranch_scc1 L_ok2
    v_and_b32 v224, v192, v196
    v_and_b32 v225, v200, v204
    v_and_b32 v224, 1, v224
    v_and_b32 v224, v224, v225
    v_cmp_eq_u32 vcc, 0, v224
    s_nop 1
    s_cmp_lg_u64 vcc, 0
    s_cbranch_scc1 L_rl2
    s_branch L_ok2
L_rt1:
    s_mov_b32 s86, 0
    s_waitcnt vmcnt(0)
L_rl1:
    buffer_load_dwordx4 v[208:211], v240, s[40:43], s81 offen sc1
    buffer_load_dwordx4 v[212:215], v241, s[40:43], s81 offen sc1
    buffer_load_dwordx4 v[216:219], v242, s[40:43], s81 offen sc1
    buffer_load_dwordx4 v[220:223], v243, s[40:43], s81 offen sc1
    v_and_b32 v224, v48, v52
    v_and_b32 v225, v56, v60
    v_and_b32 v224, 1, v224
    v_and_b32 v224, v224, v225
    v_cmp_eq_u32 vcc, 0, v224
    s_nop 1
    s_cmp_lg_u64 vcc, 0
    s_cbranch_scc0 L_rs10
    buffer_load_dwordx4 v[48:51], v240, s[40:43], s80 offen sc1
    buffer_load_dwordx4 v[52:55], v241, s[40:43], s80 offen sc1
    buffer_load_dwordx4 v[56:59], v242, s[40:43], s80 offen sc1
    buffer_load_dwordx4 v[60:63], v243, s[40:43], s80 offen sc1
L_rs10:
L_rc1:
    s_waitcnt vmcnt(0)
    s_add_u32 s86, s86, 1
    s_cmp_ge_u32 s86, 100000
    s_cbranch_scc1 L_ok1
    v_and_b32 v224, v208, v212
    v_and_b32 v225, v216, v220
    v_and_b32 v224, 1, v224
    v_and_b32 v224, v224, v225
    v_cmp_eq_u32 vcc, 0, v224
    s_nop 1
    s_cmp_lg_u64 vcc, 0
    s_cbranch_scc1 L_rl1
    s_branch L_ok1
L_rt0:
    s_mov_b32 s86, 0
    s_waitcnt vmcnt(0)
L_rl0:
    buffer_load_dwordx4 v[48:51], v240, s[40:43], s80 offen sc1
    buffer_load_dwordx4 v[52:55], v241, s[40:43], s80 offen sc1
    buffer_load_dwordx4 v[56:59], v242, s[40:43], s80 offen sc1
    buffer_load_dwordx4 v[60:63], v243, s[40:43], s80 offen sc1
L_rc0:
    s_waitcnt vmcnt(0)
    s_add_u32 s86, s86, 1
    s_cmp_ge_u32 s86, 100000
    s_cbranch_scc1 L_ok0
    v_and_b32 v224, v48, v52
    v_and_b32 v225, v56, v60
    v_and_b32 v224, 1, v224
    v_and_b32 v224, v224, v225
    v_cmp_eq_u32 vcc, 0, v224
    s_nop 1
    s_cmp_lg_u64 vcc, 0
    s_cbranch_scc1 L_rl0
    s_branch L_ok0
L_codeend:
    s_endpgm
.section .rodata,"a"
.p2align 6
.amdhsa_kernel parallel_sum__sliding_local_dilated__glu_gated_glu__prompt_kernel
  .amdhsa_next_free_vgpr 512
  .amdhsa_next_free_sgpr 102
  .amdhsa_accum_offset 256
  .amdhsa_group_segment_fixed_size 0
  .amdhsa_kernarg_size 80
  .amdhsa_user_sgpr_count 2
  .amdhsa_user_sgpr_kernarg_segment_ptr 1
  .amdhsa_system_sgpr_workgroup_id_x 1
  .amdhsa_float_denorm_mode_32 3
.end_amdhsa_kernel
```
